```python
import torch

def _softmax(x, axis=-1):
    return torch.softmax(x, dim=axis)

def _gelu(x):
    return torch.nn.functional.gelu(x, approximate='tanh')

def _silu(x):
    return torch.nn.functional.silu(x)

def _sigmoid(x):
    return torch.sigmoid(x)

def _layernorm(x, axis=-1, eps=1e-05):
    m = x.mean(dim=axis, keepdim=True)
    v = x.var(dim=axis, keepdim=True, unbiased=False)
    return (x - m) / torch.sqrt(v + eps)

def _scatter_add(tgt, idx, src, axis=0):
    return tgt.clone().index_add_(axis, idx, src)

def _segment_sum(src, seg, n):
    out = torch.zeros((n,) + src.shape[1:], dtype=src.dtype)
    return out.index_add_(0, seg, src)

def _pad(x, pw):
    flat = tuple((v for pair in reversed(pw) for v in pair))
    return torch.nn.functional.pad(x, flat)
kernel_name = 'recurrent_scan__memory_aug_recurrent_mem_tr__swiglu_ffn__prompt'

def setup_inputs():

    _w = lambda a: (lambda t: t.to(torch.bfloat16) if t.is_floating_point() else t)(torch.as_tensor(a))

    def _A_setup():
        B, S, Dm = (1, 2048, 448)
        H, Dh = (16, 256)
        M, seg = (8, 32)
        seg = min(seg, S)
        S = S // seg * seg
        return {'x': _w((lambda *s: torch.randn(*s, dtype=torch.bfloat16) * 0.05)(B, S, Dm)), 'mem0': _w((lambda *s: torch.randn(*s, dtype=torch.bfloat16) * 0.2)(B, M, Dm)), 'Wq': _w((lambda *s: torch.randn(*s, dtype=torch.bfloat16) * 1.6)(Dm, H, Dh) * Dm ** (-0.5)), 'Wk': _w((lambda *s: torch.randn(*s, dtype=torch.bfloat16) * 1.6)(Dm, H, Dh) * Dm ** (-0.5)), 'Wv': _w((lambda *s: torch.randn(*s, dtype=torch.bfloat16) * 0.2)(Dm, H, Dh) * Dm ** (-0.5)), 'Wo': _w((lambda *s: torch.randn(*s, dtype=torch.bfloat16) * 0.2)(H, Dh, Dm) * (H * Dh) ** (-0.5)), 'seg_len': seg}
    _A_in = _A_setup()

    def _B_setup():
        B, S, D, F = (1, 2048, 448, 1792)
        return {'x': _w((lambda *s: torch.randn(*s, dtype=torch.bfloat16) * 0.05)(B, S, D)), 'w_gate': _w((lambda *s: torch.randn(*s, dtype=torch.bfloat16) * 0.1)(D, F)), 'w_up': _w((lambda *s: torch.randn(*s, dtype=torch.bfloat16) * 0.1)(D, F)), 'w_down': _w((lambda *s: torch.randn(*s, dtype=torch.bfloat16) * 0.1)(F, D))}
    _B_in = _B_setup()
    return {'A_x': _A_in['x'], 'A_mem0': _A_in['mem0'], 'A_Wq': _A_in['Wq'], 'A_Wk': _A_in['Wk'], 'A_Wv': _A_in['Wv'], 'A_Wo': _A_in['Wo'], 'A_seg_len': _A_in['seg_len'], 'B_x': _B_in['x'], 'B_w_gate': _B_in['w_gate'], 'B_w_up': _B_in['w_up'], 'B_w_down': _B_in['w_down']}

def reference(A_x, A_mem0, A_Wq, A_Wk, A_Wv, A_Wo, A_seg_len, B_x, B_w_gate, B_w_up, B_w_down):

    def _A_ref(x, mem0, Wq, Wk, Wv, Wo, seg_len):
        B, S, Dm = x.shape
        H, Dh = (Wq.shape[1], Wq.shape[2])
        M = mem0.shape[1]
        scale = Dh ** (-0.5)
        n_seg = S // seg_len
        L = M + seg_len
        idx = torch.arange(L)
        mask = (idx[:, None] < M) | (idx[:, None] >= idx[None, :])
        mem = mem0
        outs = []
        for s in range(n_seg):
            xs = x[:, s * seg_len:(s + 1) * seg_len, :].clone()
            h = torch.concatenate([mem, xs], axis=1)
            q = torch.einsum('btd,dhe->bhte', h, Wq)
            k = torch.einsum('btd,dhe->bhte', h, Wk)
            v = torch.einsum('btd,dhe->bhte', h, Wv)
            scores = torch.einsum('bhqe,bhke->bhqk', q, k) * scale
            scores = torch.where(mask[None, None], scores, -1000000000.0)
            p = _softmax(scores, axis=-1)
            o = torch.einsum('bhqk,bhke->bhqe', p, v)
            o = torch.einsum('bhte,hed->btd', o, Wo)
            mem = o[:, :M, :].clone()
            outs.append(o[:, M:, :])
        return torch.concatenate(outs, axis=1)

    def _B_ref(x, w_gate, w_up, w_down):
        g = _silu(x @ w_gate)
        u = x @ w_up
        return g * u @ w_down
    x = A_x
    xn = _layernorm(x, axis=-1)
    s = _A_ref(xn, A_mem0, A_Wq, A_Wk, A_Wv, A_Wo, A_seg_len)
    g = _silu(_B_ref(xn, B_w_gate, B_w_up, B_w_down))
    return x + s * g
```

```asm
; @launch kernel=main_kernel grid=(256,1,1) block=(256,1,1) lds=163840
.amdgcn_target "amdgcn-amd-amdhsa--gfx950"
.text
.globl main_kernel
.p2align 8
.type main_kernel,@function
main_kernel:
    s_cmp_ge_u32 s2, 256
    s_cbranch_scc1 mega_exit
    s_getpc_b64 s[8:9]
code_lo:
    s_lshr_b32 s10, s2, 3
    s_lshl_b32 s10, s10, 12
    v_lshl_add_u32 v126, v0, 4, s10
    v_min_u32 v126, code_hi-code_lo-16, v126
    global_load_dwordx4 v[252:255], v126, s[8:9]
    s_load_dwordx16 s[16:31], s[0:1], 0
    s_load_dwordx8 s[32:39], s[0:1], 64
    s_load_dwordx4 s[40:43], s[0:1], 96
    s_waitcnt lgkmcnt(0)
    s_mov_b32 s44, s42
    s_and_b32 s45, s43, 0xffff
    s_mov_b32 s46, 0x10000000
    s_mov_b32 s47, 0x20000
    v_lshrrev_b32 v1, 6, v0
    s_nop 0
    v_readfirstlane_b32 s6, v1
    v_and_b32 v0, 63, v0
    v_lshlrev_b32 v1, 4, v0
    v_mov_b32 v2, 0
    v_and_b32 v3, 15, v0
    v_lshrrev_b32 v4, 4, v0
    s_getreg_b32 s5, hwreg(HW_REG_XCC_ID, 0, 4)
    s_mov_b32 s4, s5
    s_mov_b32 s60, s40
    s_and_b32 s61, s41, 0xffff
    s_mov_b32 s62, 0x100
    s_mov_b32 s63, 0x20000
    s_cmp_lg_u32 s6, 0
    s_cbranch_scc1 el_drawn
    s_and_b32 s70, s4, 3
    s_lshl_b32 s70, s70, 2
    s_and_b32 s73, s4, 4
    s_lshl_b32 s73, s73, 5
    s_add_u32 s70, s70, s73
    s_mov_b64 exec, 1
    v_mov_b32 v124, 1
    buffer_atomic_add v124, off, s[60:63], s70 offset:68 sc0 sc1
    s_mov_b64 exec, -1
el_drawn:
    s_cmp_lg_u32 s6, 0
    s_cbranch_scc1 el_done
    s_waitcnt vmcnt(0)
    v_readfirstlane_b32 s7, v124
    s_cmp_ge_u32 s7, 32
    s_cbranch_scc1 el_ovf
    s_and_b32 s8, s4, 7
    s_lshl_b32 s8, s8, 5
    s_add_u32 s7, s7, s8
el_put:
    v_mov_b32 v5, s7
    v_mov_b32 v6, 163776
    ds_write_b32 v6, v5
    s_waitcnt lgkmcnt(0)
el_done:
    s_barrier
    v_mov_b32 v6, 163776
    ds_read_b32 v5, v6
    s_waitcnt lgkmcnt(0)
    v_readfirstlane_b32 s7, v5
    s_sub_u32 s7, s7, 32
    s_and_b32 s7, s7, 255
    s_sub_u32 s8, s7, 32
    s_lshr_b32 s9, s8, 5
    s_and_b32 s10, s8, 31
    s_mul_i32 s3, s10, 6
    s_add_u32 s3, s3, s9
    s_add_u32 s3, s3, 32
    s_cmp_lt_u32 s8, 192
    s_cselect_b32 s3, s3, s7
    s_cmp_ge_u32 s7, 224
    s_cbranch_scc0 p1_w
    s_sub_u32 s75, s7, 224
    s_lshl_b32 s9, s75, 1
    s_lshl_b32 s11, s6, 10
    v_add_u32 v11, s11, v1
    v_mov_b32 v24, 0
    v_mov_b32 v28, -1
    v_mov_b32 v25, 0
    v_mov_b32 v29, -1
    v_mov_b32 v26, 0
    v_mov_b32 v30, -1
    v_mov_b32 v27, 0
    v_mov_b32 v31, -1
    v_lshrrev_b32 v12, 1, v11
    s_lshl_b32 s11, s75, 11
    s_add_u32 s11, s11, 95014912
    buffer_store_dwordx2 v[24:25], v12, s[44:47], s11 offen sc1
    s_mov_b32 s80, s44
    s_mov_b32 s81, s45
    s_mov_b32 s82, 95011840
    s_mov_b32 s83, 0x20000
    s_lshl_b32 s11, s75, 12
    s_add_u32 s11, s11, 94904320
    buffer_store_dwordx4 v[28:31], v11, s[80:83], s11 offen sc1
    s_lshl_b32 s11, s75, 14
    s_add_u32 s11, s11, 91750400
    s_cmp_eq_u32 s75, 0
    s_cselect_b32 s12, 8192, 0
    s_max_u32 s13, s12, 0
    s_add_u32 s13, s13, s11
    buffer_store_dwordx4 v[28:31], v11, s[44:47], s13 offen sc1
    s_max_u32 s13, s12, 4096
    s_add_u32 s13, s13, s11
    buffer_store_dwordx4 v[28:31], v11, s[44:47], s13 offen sc1
    s_max_u32 s13, s12, 8192
    s_add_u32 s13, s13, s11
    buffer_store_dwordx4 v[28:31], v11, s[44:47], s13 offen sc1
    s_max_u32 s13, s12, 12288
    s_add_u32 s13, s13, s11
    buffer_store_dwordx4 v[28:31], v11, s[44:47], s13 offen sc1
    s_waitcnt vmcnt(5)
    s_barrier
    s_cmp_lg_u32 s6, 0
    s_cbranch_scc1 ini_d
    s_mov_b64 exec, 1
    v_mov_b32 v12, 1
    buffer_atomic_add v12, off, s[60:63], 0 offset:64 sc1
    s_mov_b64 exec, -1
ini_d:
    s_mov_b32 s80, s16
    s_and_b32 s81, s17, 0xffff
    s_mov_b32 s82, 0x1c0000
    s_mov_b32 s83, 0x20000
    v_mul_u32_u24 v10, 912, v3
    v_lshrrev_b32 v11, 1, v4
    v_lshl_add_u32 v10, v11, 5, v10
    v_and_b32 v11, 1, v4
    v_lshl_add_u32 v10, v11, 3, v10
    s_and_b32 s11, s6, 1
    s_lshr_b32 s12, s6, 1
    s_lshl_b32 s13, s9, 1
    s_add_u32 s12, s12, s13
    s_mul_i32 s15, s9, 28672
    s_mul_i32 s13, s6, 14336
    s_add_u32 s15, s15, s13
    s_mul_i32 m0, s6, 14592
    s_add_u32 s13, m0, 14592
    s_bfm_b64 exec, 56, 0
ln_dma:
    buffer_load_dwordx4 v1, s[80:83], s15 offen lds
    s_add_u32 s15, s15, 896
    s_add_u32 m0, m0, 912
    s_cmp_lt_u32 m0, s13
    s_cbranch_scc1 ln_dma
    s_mov_b64 exec, -1
    s_lshr_b32 s13, s6, 1
    s_mul_i32 s13, s13, 14592
    s_mul_i32 s15, s11, 448
    s_add_u32 s15, s15, s13
    v_add_u32 v9, s15, v10
    s_mul_i32 s75, s12, 14336
    s_mul_i32 s11, s11, 7168
    s_add_u32 s75, s75, s11
    s_add_u32 s75, s75, 0
    s_waitcnt vmcnt(0)
    s_barrier
    v_add_u32 v20, 4096, v1
    v_add_u32 v21, 1835008, v1
    v_add_u32 v22, 4096, v21
    s_mov_b32 s14, 0x3f803f80
    s_lshl_b32 s11, s6, 9
    s_add_u32 s11, s11, 147456
    v_lshl_add_u32 v10, v0, 3, s11
    v_xor_b32 v11, 0x200, v10
ln_loop:
    ds_read2_b64 v[32:35], v9 offset0:0 offset1:2
    ds_read2_b64 v[36:39], v9 offset0:8 offset1:10
    ds_read2_b64 v[40:43], v9 offset0:16 offset1:18
    ds_read2_b64 v[44:47], v9 offset0:24 offset1:26
    ds_read2_b64 v[48:51], v9 offset0:32 offset1:34
    ds_read2_b64 v[52:55], v9 offset0:40 offset1:42
    ds_read2_b64 v[56:59], v9 offset0:48 offset1:50
    v_add_u32 v9, 29184, v9
    s_waitcnt lgkmcnt(0)
    v_dot2_f32_bf16 v12, v32, s14, 0
    v_dot2_f32_bf16 v13, v32, v32, 0
    v_dot2_f32_bf16 v12, v33, s14, v12
    v_dot2_f32_bf16 v13, v33, v33, v13
    v_dot2_f32_bf16 v12, v34, s14, v12
    v_dot2_f32_bf16 v13, v34, v34, v13
    v_dot2_f32_bf16 v12, v35, s14, v12
    v_dot2_f32_bf16 v13, v35, v35, v13
    v_dot2_f32_bf16 v12, v36, s14, v12
    v_dot2_f32_bf16 v13, v36, v36, v13
    v_dot2_f32_bf16 v12, v37, s14, v12
    v_dot2_f32_bf16 v13, v37, v37, v13
    v_dot2_f32_bf16 v12, v38, s14, v12
    v_dot2_f32_bf16 v13, v38, v38, v13
    v_dot2_f32_bf16 v12, v39, s14, v12
    v_dot2_f32_bf16 v13, v39, v39, v13
    v_dot2_f32_bf16 v12, v40, s14, v12
    v_dot2_f32_bf16 v13, v40, v40, v13
    v_dot2_f32_bf16 v12, v41, s14, v12
    v_dot2_f32_bf16 v13, v41, v41, v13
    v_dot2_f32_bf16 v12, v42, s14, v12
    v_dot2_f32_bf16 v13, v42, v42, v13
    v_dot2_f32_bf16 v12, v43, s14, v12
    v_dot2_f32_bf16 v13, v43, v43, v13
    v_dot2_f32_bf16 v12, v44, s14, v12
    v_dot2_f32_bf16 v13, v44, v44, v13
    v_dot2_f32_bf16 v12, v45, s14, v12
    v_dot2_f32_bf16 v13, v45, v45, v13
    v_dot2_f32_bf16 v12, v46, s14, v12
    v_dot2_f32_bf16 v13, v46, v46, v13
    v_dot2_f32_bf16 v12, v47, s14, v12
    v_dot2_f32_bf16 v13, v47, v47, v13
    v_dot2_f32_bf16 v12, v48, s14, v12
    v_dot2_f32_bf16 v13, v48, v48, v13
    v_dot2_f32_bf16 v12, v49, s14, v12
    v_dot2_f32_bf16 v13, v49, v49, v13
    v_dot2_f32_bf16 v12, v50, s14, v12
    v_dot2_f32_bf16 v13, v50, v50, v13
    v_dot2_f32_bf16 v12, v51, s14, v12
    v_dot2_f32_bf16 v13, v51, v51, v13
    v_dot2_f32_bf16 v12, v52, s14, v12
    v_dot2_f32_bf16 v13, v52, v52, v13
    v_dot2_f32_bf16 v12, v53, s14, v12
    v_dot2_f32_bf16 v13, v53, v53, v13
    v_dot2_f32_bf16 v12, v54, s14, v12
    v_dot2_f32_bf16 v13, v54, v54, v13
    v_dot2_f32_bf16 v12, v55, s14, v12
    v_dot2_f32_bf16 v13, v55, v55, v13
    v_dot2_f32_bf16 v12, v56, s14, v12
    v_dot2_f32_bf16 v13, v56, v56, v13
    v_dot2_f32_bf16 v12, v57, s14, v12
    v_dot2_f32_bf16 v13, v57, v57, v13
    v_dot2_f32_bf16 v12, v58, s14, v12
    v_dot2_f32_bf16 v13, v58, v58, v13
    v_dot2_f32_bf16 v12, v59, s14, v12
    v_dot2_f32_bf16 v13, v59, v59, v13
    s_nop 1
    v_mov_b32 v14, v12
    s_nop 1
    v_permlane32_swap_b32 v12, v14
    v_add_f32 v12, v12, v14
    v_mov_b32 v14, v12
    s_nop 1
    v_permlane16_swap_b32 v12, v14
    v_add_f32 v12, v12, v14
    v_mov_b32 v14, v13
    s_nop 1
    v_permlane32_swap_b32 v13, v14
    v_add_f32 v13, v13, v14
    v_mov_b32 v14, v13
    s_nop 1
    v_permlane16_swap_b32 v13, v14
    v_add_f32 v13, v13, v14
    ds_write_b64 v10, v[12:13]
    s_waitcnt lgkmcnt(0)
    s_barrier
    ds_read_b64 v[14:15], v11
    s_waitcnt lgkmcnt(0)
    s_barrier
    v_add_f32 v12, v12, v14
    v_add_f32 v13, v13, v15
    v_mul_f32 v12, 0x3b124925, v12
    v_mul_f32 v13, 0x3b124925, v13
    v_fma_f32 v14, -v12, v12, v13
    v_max_f32 v14, 0, v14
    v_cvt_pk_bf16_f32 v12, v12, v12
    v_and_b32 v12, 0xffff0000, v12
    v_cvt_pk_bf16_f32 v14, v14, v14
    v_and_b32 v14, 0xffff0000, v14
    v_add_f32 v14, 0x3727c5ac, v14
    v_cvt_pk_bf16_f32 v14, v14, v14
    v_and_b32 v14, 0xffff0000, v14
    v_sqrt_f32 v14, v14
    s_nop 0
    v_cvt_pk_bf16_f32 v14, v14, v14
    v_and_b32 v14, 0xffff0000, v14
    v_rcp_f32 v14, v14
    v_lshlrev_b32 v16, 16, v32
    v_and_b32 v17, 0xffff0000, v32
    v_pk_add_f32 v[16:17], v[16:17], v[12:13] op_sel_hi:[1,0] neg_lo:[0,1] neg_hi:[0,1]
    v_cvt_pk_bf16_f32 v18, v16, v17
    v_lshlrev_b32 v16, 16, v18
    v_and_b32 v17, 0xffff0000, v18
    v_pk_mul_f32 v[16:17], v[16:17], v[14:15] op_sel_hi:[1,0]
    v_cvt_pk_bf16_f32 v96, v16, v17
    v_mov_b32 v100, v96
    v_lshlrev_b32 v16, 16, v33
    v_and_b32 v17, 0xffff0000, v33
    v_pk_add_f32 v[16:17], v[16:17], v[12:13] op_sel_hi:[1,0] neg_lo:[0,1] neg_hi:[0,1]
    v_cvt_pk_bf16_f32 v18, v16, v17
    v_lshlrev_b32 v16, 16, v18
    v_and_b32 v17, 0xffff0000, v18
    v_pk_mul_f32 v[16:17], v[16:17], v[14:15] op_sel_hi:[1,0]
    v_cvt_pk_bf16_f32 v97, v16, v17
    v_mov_b32 v102, v97
    v_lshlrev_b32 v16, 16, v34
    v_and_b32 v17, 0xffff0000, v34
    v_pk_add_f32 v[16:17], v[16:17], v[12:13] op_sel_hi:[1,0] neg_lo:[0,1] neg_hi:[0,1]
    v_cvt_pk_bf16_f32 v18, v16, v17
    v_lshlrev_b32 v16, 16, v18
    v_and_b32 v17, 0xffff0000, v18
    v_pk_mul_f32 v[16:17], v[16:17], v[14:15] op_sel_hi:[1,0]
    v_cvt_pk_bf16_f32 v98, v16, v17
    v_mov_b32 v101, v98
    v_lshlrev_b32 v16, 16, v35
    v_and_b32 v17, 0xffff0000, v35
    v_pk_add_f32 v[16:17], v[16:17], v[12:13] op_sel_hi:[1,0] neg_lo:[0,1] neg_hi:[0,1]
    v_cvt_pk_bf16_f32 v18, v16, v17
    v_lshlrev_b32 v16, 16, v18
    v_and_b32 v17, 0xffff0000, v18
    v_pk_mul_f32 v[16:17], v[16:17], v[14:15] op_sel_hi:[1,0]
    v_cvt_pk_bf16_f32 v99, v16, v17
    v_mov_b32 v103, v99
    buffer_store_dwordx4 v[96:99], v21, s[44:47], s75 offen offset:0 sc1
    buffer_store_dwordx4 v[100:103], v1, s[44:47], s75 offen offset:0 sc1
    v_lshlrev_b32 v16, 16, v36
    v_and_b32 v17, 0xffff0000, v36
    v_pk_add_f32 v[16:17], v[16:17], v[12:13] op_sel_hi:[1,0] neg_lo:[0,1] neg_hi:[0,1]
    v_cvt_pk_bf16_f32 v18, v16, v17
    v_lshlrev_b32 v16, 16, v18
    v_and_b32 v17, 0xffff0000, v18
    v_pk_mul_f32 v[16:17], v[16:17], v[14:15] op_sel_hi:[1,0]
    v_cvt_pk_bf16_f32 v104, v16, v17
    v_mov_b32 v108, v104
    v_lshlrev_b32 v16, 16, v37
    v_and_b32 v17, 0xffff0000, v37
    v_pk_add_f32 v[16:17], v[16:17], v[12:13] op_sel_hi:[1,0] neg_lo:[0,1] neg_hi:[0,1]
    v_cvt_pk_bf16_f32 v18, v16, v17
    v_lshlrev_b32 v16, 16, v18
    v_and_b32 v17, 0xffff0000, v18
    v_pk_mul_f32 v[16:17], v[16:17], v[14:15] op_sel_hi:[1,0]
    v_cvt_pk_bf16_f32 v105, v16, v17
    v_mov_b32 v110, v105
    v_lshlrev_b32 v16, 16, v38
    v_and_b32 v17, 0xffff0000, v38
    v_pk_add_f32 v[16:17], v[16:17], v[12:13] op_sel_hi:[1,0] neg_lo:[0,1] neg_hi:[0,1]
    v_cvt_pk_bf16_f32 v18, v16, v17
    v_lshlrev_b32 v16, 16, v18
    v_and_b32 v17, 0xffff0000, v18
    v_pk_mul_f32 v[16:17], v[16:17], v[14:15] op_sel_hi:[1,0]
    v_cvt_pk_bf16_f32 v106, v16, v17
    v_mov_b32 v109, v106
    v_lshlrev_b32 v16, 16, v39
    v_and_b32 v17, 0xffff0000, v39
    v_pk_add_f32 v[16:17], v[16:17], v[12:13] op_sel_hi:[1,0] neg_lo:[0,1] neg_hi:[0,1]
    v_cvt_pk_bf16_f32 v18, v16, v17
    v_lshlrev_b32 v16, 16, v18
    v_and_b32 v17, 0xffff0000, v18
    v_pk_mul_f32 v[16:17], v[16:17], v[14:15] op_sel_hi:[1,0]
    v_cvt_pk_bf16_f32 v107, v16, v17
    v_mov_b32 v111, v107
    buffer_store_dwordx4 v[104:107], v21, s[44:47], s75 offen offset:1024 sc1
    buffer_store_dwordx4 v[108:111], v1, s[44:47], s75 offen offset:1024 sc1
    v_lshlrev_b32 v16, 16, v40
    v_and_b32 v17, 0xffff0000, v40
    v_pk_add_f32 v[16:17], v[16:17], v[12:13] op_sel_hi:[1,0] neg_lo:[0,1] neg_hi:[0,1]
    v_cvt_pk_bf16_f32 v18, v16, v17
    v_lshlrev_b32 v16, 16, v18
    v_and_b32 v17, 0xffff0000, v18
    v_pk_mul_f32 v[16:17], v[16:17], v[14:15] op_sel_hi:[1,0]
    v_cvt_pk_bf16_f32 v96, v16, v17
    v_mov_b32 v100, v96
    v_lshlrev_b32 v16, 16, v41
    v_and_b32 v17, 0xffff0000, v41
    v_pk_add_f32 v[16:17], v[16:17], v[12:13] op_sel_hi:[1,0] neg_lo:[0,1] neg_hi:[0,1]
    v_cvt_pk_bf16_f32 v18, v16, v17
    v_lshlrev_b32 v16, 16, v18
    v_and_b32 v17, 0xffff0000, v18
    v_pk_mul_f32 v[16:17], v[16:17], v[14:15] op_sel_hi:[1,0]
    v_cvt_pk_bf16_f32 v97, v16, v17
    v_mov_b32 v102, v97
    v_lshlrev_b32 v16, 16, v42
    v_and_b32 v17, 0xffff0000, v42
    v_pk_add_f32 v[16:17], v[16:17], v[12:13] op_sel_hi:[1,0] neg_lo:[0,1] neg_hi:[0,1]
    v_cvt_pk_bf16_f32 v18, v16, v17
    v_lshlrev_b32 v16, 16, v18
    v_and_b32 v17, 0xffff0000, v18
    v_pk_mul_f32 v[16:17], v[16:17], v[14:15] op_sel_hi:[1,0]
    v_cvt_pk_bf16_f32 v98, v16, v17
    v_mov_b32 v101, v98
    v_lshlrev_b32 v16, 16, v43
    v_and_b32 v17, 0xffff0000, v43
    v_pk_add_f32 v[16:17], v[16:17], v[12:13] op_sel_hi:[1,0] neg_lo:[0,1] neg_hi:[0,1]
    v_cvt_pk_bf16_f32 v18, v16, v17
    v_lshlrev_b32 v16, 16, v18
    v_and_b32 v17, 0xffff0000, v18
    v_pk_mul_f32 v[16:17], v[16:17], v[14:15] op_sel_hi:[1,0]
    v_cvt_pk_bf16_f32 v99, v16, v17
    v_mov_b32 v103, v99
    buffer_store_dwordx4 v[96:99], v21, s[44:47], s75 offen offset:2048 sc1
    buffer_store_dwordx4 v[100:103], v1, s[44:47], s75 offen offset:2048 sc1
    v_lshlrev_b32 v16, 16, v44
    v_and_b32 v17, 0xffff0000, v44
    v_pk_add_f32 v[16:17], v[16:17], v[12:13] op_sel_hi:[1,0] neg_lo:[0,1] neg_hi:[0,1]
    v_cvt_pk_bf16_f32 v18, v16, v17
    v_lshlrev_b32 v16, 16, v18
    v_and_b32 v17, 0xffff0000, v18
    v_pk_mul_f32 v[16:17], v[16:17], v[14:15] op_sel_hi:[1,0]
    v_cvt_pk_bf16_f32 v104, v16, v17
    v_mov_b32 v108, v104
    v_lshlrev_b32 v16, 16, v45
    v_and_b32 v17, 0xffff0000, v45
    v_pk_add_f32 v[16:17], v[16:17], v[12:13] op_sel_hi:[1,0] neg_lo:[0,1] neg_hi:[0,1]
    v_cvt_pk_bf16_f32 v18, v16, v17
    v_lshlrev_b32 v16, 16, v18
    v_and_b32 v17, 0xffff0000, v18
    v_pk_mul_f32 v[16:17], v[16:17], v[14:15] op_sel_hi:[1,0]
    v_cvt_pk_bf16_f32 v105, v16, v17
    v_mov_b32 v110, v105
    v_lshlrev_b32 v16, 16, v46
    v_and_b32 v17, 0xffff0000, v46
    v_pk_add_f32 v[16:17], v[16:17], v[12:13] op_sel_hi:[1,0] neg_lo:[0,1] neg_hi:[0,1]
    v_cvt_pk_bf16_f32 v18, v16, v17
    v_lshlrev_b32 v16, 16, v18
    v_and_b32 v17, 0xffff0000, v18
    v_pk_mul_f32 v[16:17], v[16:17], v[14:15] op_sel_hi:[1,0]
    v_cvt_pk_bf16_f32 v106, v16, v17
    v_mov_b32 v109, v106
    v_lshlrev_b32 v16, 16, v47
    v_and_b32 v17, 0xffff0000, v47
    v_pk_add_f32 v[16:17], v[16:17], v[12:13] op_sel_hi:[1,0] neg_lo:[0,1] neg_hi:[0,1]
    v_cvt_pk_bf16_f32 v18, v16, v17
    v_lshlrev_b32 v16, 16, v18
    v_and_b32 v17, 0xffff0000, v18
    v_pk_mul_f32 v[16:17], v[16:17], v[14:15] op_sel_hi:[1,0]
    v_cvt_pk_bf16_f32 v107, v16, v17
    v_mov_b32 v111, v107
    buffer_store_dwordx4 v[104:107], v21, s[44:47], s75 offen offset:3072 sc1
    buffer_store_dwordx4 v[108:111], v1, s[44:47], s75 offen offset:3072 sc1
    v_lshlrev_b32 v16, 16, v48
    v_and_b32 v17, 0xffff0000, v48
    v_pk_add_f32 v[16:17], v[16:17], v[12:13] op_sel_hi:[1,0] neg_lo:[0,1] neg_hi:[0,1]
    v_cvt_pk_bf16_f32 v18, v16, v17
    v_lshlrev_b32 v16, 16, v18
    v_and_b32 v17, 0xffff0000, v18
    v_pk_mul_f32 v[16:17], v[16:17], v[14:15] op_sel_hi:[1,0]
    v_cvt_pk_bf16_f32 v96, v16, v17
    v_mov_b32 v100, v96
    v_lshlrev_b32 v16, 16, v49
    v_and_b32 v17, 0xffff0000, v49
    v_pk_add_f32 v[16:17], v[16:17], v[12:13] op_sel_hi:[1,0] neg_lo:[0,1] neg_hi:[0,1]
    v_cvt_pk_bf16_f32 v18, v16, v17
    v_lshlrev_b32 v16, 16, v18
    v_and_b32 v17, 0xffff0000, v18
    v_pk_mul_f32 v[16:17], v[16:17], v[14:15] op_sel_hi:[1,0]
    v_cvt_pk_bf16_f32 v97, v16, v17
    v_mov_b32 v102, v97
    v_lshlrev_b32 v16, 16, v50
    v_and_b32 v17, 0xffff0000, v50
    v_pk_add_f32 v[16:17], v[16:17], v[12:13] op_sel_hi:[1,0] neg_lo:[0,1] neg_hi:[0,1]
    v_cvt_pk_bf16_f32 v18, v16, v17
    v_lshlrev_b32 v16, 16, v18
    v_and_b32 v17, 0xffff0000, v18
    v_pk_mul_f32 v[16:17], v[16:17], v[14:15] op_sel_hi:[1,0]
    v_cvt_pk_bf16_f32 v98, v16, v17
    v_mov_b32 v101, v98
    v_lshlrev_b32 v16, 16, v51
    v_and_b32 v17, 0xffff0000, v51
    v_pk_add_f32 v[16:17], v[16:17], v[12:13] op_sel_hi:[1,0] neg_lo:[0,1] neg_hi:[0,1]
    v_cvt_pk_bf16_f32 v18, v16, v17
    v_lshlrev_b32 v16, 16, v18
    v_and_b32 v17, 0xffff0000, v18
    v_pk_mul_f32 v[16:17], v[16:17], v[14:15] op_sel_hi:[1,0]
    v_cvt_pk_bf16_f32 v99, v16, v17
    v_mov_b32 v103, v99
    buffer_store_dwordx4 v[96:99], v22, s[44:47], s75 offen offset:0 sc1
    buffer_store_dwordx4 v[100:103], v20, s[44:47], s75 offen offset:0 sc1
    v_lshlrev_b32 v16, 16, v52
    v_and_b32 v17, 0xffff0000, v52
    v_pk_add_f32 v[16:17], v[16:17], v[12:13] op_sel_hi:[1,0] neg_lo:[0,1] neg_hi:[0,1]
    v_cvt_pk_bf16_f32 v18, v16, v17
    v_lshlrev_b32 v16, 16, v18
    v_and_b32 v17, 0xffff0000, v18
    v_pk_mul_f32 v[16:17], v[16:17], v[14:15] op_sel_hi:[1,0]
    v_cvt_pk_bf16_f32 v104, v16, v17
    v_mov_b32 v108, v104
    v_lshlrev_b32 v16, 16, v53
    v_and_b32 v17, 0xffff0000, v53
    v_pk_add_f32 v[16:17], v[16:17], v[12:13] op_sel_hi:[1,0] neg_lo:[0,1] neg_hi:[0,1]
    v_cvt_pk_bf16_f32 v18, v16, v17
    v_lshlrev_b32 v16, 16, v18
    v_and_b32 v17, 0xffff0000, v18
    v_pk_mul_f32 v[16:17], v[16:17], v[14:15] op_sel_hi:[1,0]
    v_cvt_pk_bf16_f32 v105, v16, v17
    v_mov_b32 v110, v105
    v_lshlrev_b32 v16, 16, v54
    v_and_b32 v17, 0xffff0000, v54
    v_pk_add_f32 v[16:17], v[16:17], v[12:13] op_sel_hi:[1,0] neg_lo:[0,1] neg_hi:[0,1]
    v_cvt_pk_bf16_f32 v18, v16, v17
    v_lshlrev_b32 v16, 16, v18
    v_and_b32 v17, 0xffff0000, v18
    v_pk_mul_f32 v[16:17], v[16:17], v[14:15] op_sel_hi:[1,0]
    v_cvt_pk_bf16_f32 v106, v16, v17
    v_mov_b32 v109, v106
    v_lshlrev_b32 v16, 16, v55
    v_and_b32 v17, 0xffff0000, v55
    v_pk_add_f32 v[16:17], v[16:17], v[12:13] op_sel_hi:[1,0] neg_lo:[0,1] neg_hi:[0,1]
    v_cvt_pk_bf16_f32 v18, v16, v17
    v_lshlrev_b32 v16, 16, v18
    v_and_b32 v17, 0xffff0000, v18
    v_pk_mul_f32 v[16:17], v[16:17], v[14:15] op_sel_hi:[1,0]
    v_cvt_pk_bf16_f32 v107, v16, v17
    v_mov_b32 v111, v107
    buffer_store_dwordx4 v[104:107], v22, s[44:47], s75 offen offset:1024 sc1
    buffer_store_dwordx4 v[108:111], v20, s[44:47], s75 offen offset:1024 sc1
    v_lshlrev_b32 v16, 16, v56
    v_and_b32 v17, 0xffff0000, v56
    v_pk_add_f32 v[16:17], v[16:17], v[12:13] op_sel_hi:[1,0] neg_lo:[0,1] neg_hi:[0,1]
    v_cvt_pk_bf16_f32 v18, v16, v17
    v_lshlrev_b32 v16, 16, v18
    v_and_b32 v17, 0xffff0000, v18
    v_pk_mul_f32 v[16:17], v[16:17], v[14:15] op_sel_hi:[1,0]
    v_cvt_pk_bf16_f32 v96, v16, v17
    v_mov_b32 v100, v96
    v_lshlrev_b32 v16, 16, v57
    v_and_b32 v17, 0xffff0000, v57
    v_pk_add_f32 v[16:17], v[16:17], v[12:13] op_sel_hi:[1,0] neg_lo:[0,1] neg_hi:[0,1]
    v_cvt_pk_bf16_f32 v18, v16, v17
    v_lshlrev_b32 v16, 16, v18
    v_and_b32 v17, 0xffff0000, v18
    v_pk_mul_f32 v[16:17], v[16:17], v[14:15] op_sel_hi:[1,0]
    v_cvt_pk_bf16_f32 v97, v16, v17
    v_mov_b32 v102, v97
    v_lshlrev_b32 v16, 16, v58
    v_and_b32 v17, 0xffff0000, v58
    v_pk_add_f32 v[16:17], v[16:17], v[12:13] op_sel_hi:[1,0] neg_lo:[0,1] neg_hi:[0,1]
    v_cvt_pk_bf16_f32 v18, v16, v17
    v_lshlrev_b32 v16, 16, v18
    v_and_b32 v17, 0xffff0000, v18
    v_pk_mul_f32 v[16:17], v[16:17], v[14:15] op_sel_hi:[1,0]
    v_cvt_pk_bf16_f32 v98, v16, v17
    v_mov_b32 v101, v98
    v_lshlrev_b32 v16, 16, v59
    v_and_b32 v17, 0xffff0000, v59
    v_pk_add_f32 v[16:17], v[16:17], v[12:13] op_sel_hi:[1,0] neg_lo:[0,1] neg_hi:[0,1]
    v_cvt_pk_bf16_f32 v18, v16, v17
    v_lshlrev_b32 v16, 16, v18
    v_and_b32 v17, 0xffff0000, v18
    v_pk_mul_f32 v[16:17], v[16:17], v[14:15] op_sel_hi:[1,0]
    v_cvt_pk_bf16_f32 v99, v16, v17
    v_mov_b32 v103, v99
    buffer_store_dwordx4 v[96:99], v22, s[44:47], s75 offen offset:2048 sc1
    buffer_store_dwordx4 v[100:103], v20, s[44:47], s75 offen offset:2048 sc1
    s_bitcmp1_b32 s9, 0
    s_cbranch_scc1 p1_lnd
    s_add_u32 s9, s9, 1
    s_add_u32 s75, s75, 28672
    s_branch ln_loop
p1_lnd:
    s_cmp_lg_u32 s7, 255
    s_cbranch_scc1 ini_nma
    s_mov_b32 s52, s18
    s_and_b32 s53, s19, 0xffff
    s_mov_b32 s54, 0x1c00
    s_mov_b32 s55, 0x20000
    s_mov_b32 s56, s44
    s_mov_b32 s57, s45
    s_mov_b32 s58, 91757568
    s_mov_b32 s59, 0x20000
    s_lshl_b32 s11, s6, 10
    v_add_u32 v22, s11, v1
    v_lshrrev_b32 v20, 8, v22
    v_add_u32 v20, 0, v20
    v_lshlrev_b32 v20, 5, v20
    v_lshrrev_b32 v21, 2, v3
    v_mul_u32_u24 v21, 1792, v21
    v_add_u32 v20, v20, v21
    v_and_b32 v21, 1, v3
    v_mul_u32_u24 v21, 896, v21
    v_add_u32 v20, v20, v21
    v_bfe_u32 v21, v3, 1, 1
    v_lshl_add_u32 v20, v21, 4, v20
    buffer_load_dwordx4 v[16:19], v20, s[52:55], 0 offen
    s_waitcnt vmcnt(0)
    v_min_u32 v16, -2, v16
    v_min_u32 v17, -2, v17
    v_min_u32 v18, -2, v18
    v_min_u32 v19, -2, v19
    s_mov_b32 s11, 91750400
    buffer_store_dwordx4 v[16:19], v22, s[56:59], s11 offen sc1
    s_mov_b32 s11, 94896128
    buffer_store_dwordx4 v[16:19], v22, s[44:47], s11 offen sc1
    v_lshrrev_b32 v20, 8, v22
    v_add_u32 v20, 16, v20
    v_lshlrev_b32 v20, 5, v20
    v_lshrrev_b32 v21, 2, v3
    v_mul_u32_u24 v21, 1792, v21
    v_add_u32 v20, v20, v21
    v_and_b32 v21, 1, v3
    v_mul_u32_u24 v21, 896, v21
    v_add_u32 v20, v20, v21
    v_bfe_u32 v21, v3, 1, 1
    v_lshl_add_u32 v20, v21, 4, v20
    buffer_load_dwordx4 v[16:19], v20, s[52:55], 0 offen
    s_waitcnt vmcnt(0)
    v_min_u32 v16, -2, v16
    v_min_u32 v17, -2, v17
    v_min_u32 v18, -2, v18
    v_min_u32 v19, -2, v19
    s_mov_b32 s11, 91754496
    buffer_store_dwordx4 v[16:19], v22, s[56:59], s11 offen sc1
    s_mov_b32 s11, 94900224
    buffer_store_dwordx4 v[16:19], v22, s[44:47], s11 offen sc1
ini_nma:
    s_mov_b32 s99, 0
p1c_clr:
    buffer_load_dword v23, off, s[60:63], 0 offset:64 sc1
    s_add_u32 s99, s99, 1
    s_cmp_ge_u32 s99, 400000
    s_cbranch_scc1 mega_abort
    s_waitcnt vmcnt(0)
    v_readfirstlane_b32 s11, v23
    s_cmp_lt_u32 s11, 32
    s_cbranch_scc1 p1c_clr
    s_barrier
    s_cmp_lg_u32 s6, 0
    s_cbranch_scc1 p1c_ar
    s_lshr_b32 s11, s7, 5
    s_lshl_b32 s11, s11, 7
    s_add_u32 s11, s11, 95072768
    s_mov_b64 exec, 1
    v_mov_b32 v10, 1
    buffer_atomic_add v10, off, s[44:47], s11 sc1
    s_mov_b64 exec, -1
p1c_ar:
    s_branch p1_end
p1_w:
    s_mov_b32 s48, s24
    s_and_b32 s49, s25, 0xffff
    s_mov_b32 s50, 0x380000
    s_mov_b32 s51, 0x20000
    s_mov_b32 s52, s26
    s_and_b32 s53, s27, 0xffff
    s_mov_b32 s54, 0x380000
    s_mov_b32 s55, 0x20000
    s_mov_b32 s56, s20
    s_and_b32 s57, s21, 0xffff
    s_mov_b32 s58, 0x380000
    s_mov_b32 s59, 0x20000
    s_mov_b32 s76, s22
    s_and_b32 s77, s23, 0xffff
    s_mov_b32 s78, 0x380000
    s_mov_b32 s79, 0x20000
    s_cmp_ge_u32 s7, 112
    s_cselect_b32 s10, 1, 0
    s_mul_i32 s11, s10, 112
    s_sub_u32 s9, s7, s11
    s_mul_i32 s8, s9, 9363
    s_lshr_b32 s8, s8, 16
    s_mul_i32 s11, s8, 7
    s_sub_u32 s9, s9, s11
    v_lshrrev_b32 v6, 3, v0
    v_and_b32 v7, 7, v0
    v_xor_b32 v5, v6, v7
    v_lshlrev_b32 v5, 4, v5
    v_lshl_add_u32 v5, v6, 13, v5
    v_mul_u32_u24 v6, 896, v6
    v_lshl_add_u32 v6, v7, 4, v6
    s_lshl_b32 s11, s8, 9
    s_mul_i32 s64, s6, 458752
    s_add_u32 s64, s64, s11
    s_mul_i32 s12, s10, 1835008
    s_add_u32 s64, s64, s12
    s_mul_i32 s65, s8, 229376
    s_lshl_b32 s12, s9, 7
    s_add_u32 s65, s65, s12
    s_mul_i32 s12, s6, 14336
    s_add_u32 s65, s65, s12
    s_lshl_b32 s72, s9, 19
    s_add_u32 s72, s72, s11
    s_lshl_b32 s12, s6, 17
    s_add_u32 s72, s72, s12
    s_mul_i32 s66, s6, 7168
    s_lshl_b32 s67, s6, 11
    s_add_u32 s67, s67, 28672
    s_add_u32 s71, s9, s8
    s_mov_b32 s73, 0
fb_d4:
    s_and_b32 s71, s71, 3
    s_lshl_b32 s11, s71, 7
    s_add_u32 s11, s11, s64
    s_mul_i32 s12, s71, 57344
    s_add_u32 s12, s12, s65
    s_add_u32 s71, s71, 1
    s_add_u32 m0, s66, s73
    s_add_u32 s13, m0, 7168
fb_d:
    buffer_load_dwordx4 v5, s[48:51], s11 offen lds
    s_add_u32 s11, s11, 65536
    s_add_u32 m0, m0, 1024
    s_cmp_lt_u32 m0, s13
    s_cbranch_scc1 fb_d
    s_add_u32 m0, s67, s73
    s_add_u32 s11, s12, 7168
    buffer_load_dwordx4 v6, s[52:55], s12 offen lds
    s_add_u32 m0, m0, 1024
    s_add_u32 s73, s73, 36864
    buffer_load_dwordx4 v6, s[52:55], s11 offen lds
    s_cmp_lt_u32 s73, 147456
    s_cbranch_scc1 fb_d4
    v_bfe_u32 v7, v0, 2, 1
    v_lshlrev_b32 v7, 4, v7
    v_bfe_u32 v8, v0, 1, 1
    v_lshl_add_u32 v7, v8, 3, v7
    v_bfe_u32 v8, v0, 4, 1
    v_lshl_add_u32 v7, v8, 2, v7
    v_bfe_u32 v8, v0, 3, 1
    v_lshl_add_u32 v7, v8, 1, v7
    v_and_b32 v8, 1, v0
    v_add_u32 v7, v7, v8
    v_lshrrev_b32 v9, 5, v0
    s_lshl_b32 s74, s6, 1
    s_min_u32 s74, s74, 5
    s_lshl_b32 s12, s74, 12
    v_add_u32 v8, 0, v9
    v_xor_b32 v8, v8, v7
    v_and_b32 v8, 7, v8
    v_lshlrev_b32 v8, 4, v8
    v_lshl_add_u32 v8, v7, 7, v8
    v_add_u32 v112, s12, v8
    v_add_u32 v8, 2, v9
    v_xor_b32 v8, v8, v7
    v_and_b32 v8, 7, v8
    v_lshlrev_b32 v8, 4, v8
    v_lshl_add_u32 v8, v7, 7, v8
    v_add_u32 v113, s12, v8
    v_add_u32 v8, 4, v9
    v_xor_b32 v8, v8, v7
    v_and_b32 v8, 7, v8
    v_lshlrev_b32 v8, 4, v8
    v_lshl_add_u32 v8, v7, 7, v8
    v_add_u32 v114, s12, v8
    v_add_u32 v8, 6, v9
    v_xor_b32 v8, v8, v7
    v_and_b32 v8, 7, v8
    v_lshlrev_b32 v8, 4, v8
    v_lshl_add_u32 v8, v7, 7, v8
    v_add_u32 v115, s12, v8
    v_lshlrev_b32 v120, 3, v9
    v_bfe_u32 v8, v0, 2, 2
    v_add_u32 v120, v120, v8
    v_lshlrev_b32 v120, 7, v120
    v_bfe_u32 v8, v0, 4, 1
    v_lshl_add_u32 v120, v8, 5, v120
    v_and_b32 v8, 3, v0
    v_lshl_add_u32 v120, v8, 3, v120
    v_add_u32 v120, 28672, v120
    v_and_b32 v7, 31, v0
    v_add_u32 v8, 0, v9
    v_xor_b32 v8, v8, v7
    v_and_b32 v8, 7, v8
    v_lshlrev_b32 v8, 4, v8
    v_lshl_add_u32 v8, v7, 7, v8
    v_add_u32 v116, 28672, v8
    v_add_u32 v8, 2, v9
    v_xor_b32 v8, v8, v7
    v_and_b32 v8, 7, v8
    v_lshlrev_b32 v8, 4, v8
    v_lshl_add_u32 v8, v7, 7, v8
    v_add_u32 v117, 28672, v8
    v_add_u32 v8, 4, v9
    v_xor_b32 v8, v8, v7
    v_and_b32 v8, 7, v8
    v_lshlrev_b32 v8, 4, v8
    v_lshl_add_u32 v8, v7, 7, v8
    v_add_u32 v118, 28672, v8
    v_add_u32 v8, 6, v9
    v_xor_b32 v8, v8, v7
    v_and_b32 v8, 7, v8
    v_lshlrev_b32 v8, 4, v8
    v_lshl_add_u32 v8, v7, 7, v8
    v_add_u32 v119, 28672, v8
    s_mul_i32 s12, s10, 7
    s_add_u32 s74, s74, s12
    s_lshl_b32 s74, s74, 10
    v_bfe_u32 v8, v0, 4, 1
    v_mul_u32_u24 v121, 229376, v8
    v_lshl_add_u32 v121, v9, 9, v121
    v_lshl_add_u32 v121, v3, 4, v121
    v_bfe_u32 v8, v0, 4, 1
    v_mul_u32_u24 v122, 14336, v8
    v_lshl_add_u32 v122, v9, 9, v122
    v_lshl_add_u32 v122, v3, 4, v122
    s_mul_i32 s68, s9, 917504
    s_mul_i32 s11, s8, 14336
    s_add_u32 s68, s68, s11
    s_add_u32 s68, s68, s74
    s_add_u32 s68, s68, 10092544
    s_add_u32 s69, s68, 458752
    v_pk_mov_b32 v[128:129], 0, 0
    v_pk_mov_b32 v[130:131], 0, 0
    v_pk_mov_b32 v[132:133], 0, 0
    v_pk_mov_b32 v[134:135], 0, 0
    v_pk_mov_b32 v[136:137], 0, 0
    v_pk_mov_b32 v[138:139], 0, 0
    v_pk_mov_b32 v[140:141], 0, 0
    v_pk_mov_b32 v[142:143], 0, 0
    v_pk_mov_b32 v[144:145], 0, 0
    v_pk_mov_b32 v[146:147], 0, 0
    v_pk_mov_b32 v[148:149], 0, 0
    v_pk_mov_b32 v[150:151], 0, 0
    v_pk_mov_b32 v[152:153], 0, 0
    v_pk_mov_b32 v[154:155], 0, 0
    v_pk_mov_b32 v[156:157], 0, 0
    v_pk_mov_b32 v[158:159], 0, 0
    v_pk_mov_b32 v[160:161], 0, 0
    v_pk_mov_b32 v[162:163], 0, 0
    v_pk_mov_b32 v[164:165], 0, 0
    v_pk_mov_b32 v[166:167], 0, 0
    v_pk_mov_b32 v[168:169], 0, 0
    v_pk_mov_b32 v[170:171], 0, 0
    v_pk_mov_b32 v[172:173], 0, 0
    v_pk_mov_b32 v[174:175], 0, 0
    v_pk_mov_b32 v[176:177], 0, 0
    v_pk_mov_b32 v[178:179], 0, 0
    v_pk_mov_b32 v[180:181], 0, 0
    v_pk_mov_b32 v[182:183], 0, 0
    v_pk_mov_b32 v[184:185], 0, 0
    v_pk_mov_b32 v[186:187], 0, 0
    v_pk_mov_b32 v[188:189], 0, 0
    v_pk_mov_b32 v[190:191], 0, 0
    s_mov_b32 s70, 0
    s_mov_b32 s73, 0
fb_loop:
    s_cmp_eq_u32 s70, 0
    s_cbranch_scc0 fb_w0
    s_waitcnt vmcnt(27)
fb_w0:
    s_cmp_eq_u32 s70, 1
    s_cbranch_scc0 fb_w1
    s_waitcnt vmcnt(18)
fb_w1:
    s_cmp_eq_u32 s70, 2
    s_cbranch_scc0 fb_w2
    s_waitcnt vmcnt(9)
fb_w2:
    s_cmp_eq_u32 s70, 3
    s_cbranch_scc0 fb_w3
    s_waitcnt vmcnt(0)
fb_w3:
    s_barrier
    ds_read_b64_tr_b16 v[200:201], v120 offset:0
    ds_read_b64_tr_b16 v[202:203], v120 offset:512
    ds_read_b64_tr_b16 v[204:205], v120 offset:64
    ds_read_b64_tr_b16 v[206:207], v120 offset:576
    ds_read_b128 v[192:195], v112 offset:0
    ds_read_b128 v[196:199], v112 offset:4096
    ds_read_b64_tr_b16 v[216:217], v120 offset:2048
    ds_read_b64_tr_b16 v[218:219], v120 offset:2560
    ds_read_b64_tr_b16 v[220:221], v120 offset:2112
    ds_read_b64_tr_b16 v[222:223], v120 offset:2624
    ds_read_b128 v[208:211], v113 offset:0
    ds_read_b128 v[212:215], v113 offset:4096
    s_waitcnt lgkmcnt(6)
    v_mfma_f32_32x32x16_bf16 v[128:143], v[192:195], v[200:203], v[128:143]
    v_mfma_f32_32x32x16_bf16 v[144:159], v[192:195], v[204:207], v[144:159]
    v_mfma_f32_32x32x16_bf16 v[160:175], v[196:199], v[200:203], v[160:175]
    v_mfma_f32_32x32x16_bf16 v[176:191], v[196:199], v[204:207], v[176:191]
    ds_read_b64_tr_b16 v[200:201], v120 offset:4096
    ds_read_b64_tr_b16 v[202:203], v120 offset:4608
    ds_read_b64_tr_b16 v[204:205], v120 offset:4160
    ds_read_b64_tr_b16 v[206:207], v120 offset:4672
    ds_read_b128 v[192:195], v114 offset:0
    ds_read_b128 v[196:199], v114 offset:4096
    s_waitcnt lgkmcnt(6)
    v_mfma_f32_32x32x16_bf16 v[128:143], v[208:211], v[216:219], v[128:143]
    v_mfma_f32_32x32x16_bf16 v[144:159], v[208:211], v[220:223], v[144:159]
    v_mfma_f32_32x32x16_bf16 v[160:175], v[212:215], v[216:219], v[160:175]
    v_mfma_f32_32x32x16_bf16 v[176:191], v[212:215], v[220:223], v[176:191]
    ds_read_b64_tr_b16 v[216:217], v120 offset:6144
    ds_read_b64_tr_b16 v[218:219], v120 offset:6656
    ds_read_b64_tr_b16 v[220:221], v120 offset:6208
    ds_read_b64_tr_b16 v[222:223], v120 offset:6720
    ds_read_b128 v[208:211], v115 offset:0
    ds_read_b128 v[212:215], v115 offset:4096
    s_waitcnt lgkmcnt(6)
    v_mfma_f32_32x32x16_bf16 v[128:143], v[192:195], v[200:203], v[128:143]
    v_mfma_f32_32x32x16_bf16 v[144:159], v[192:195], v[204:207], v[144:159]
    v_mfma_f32_32x32x16_bf16 v[160:175], v[196:199], v[200:203], v[160:175]
    v_mfma_f32_32x32x16_bf16 v[176:191], v[196:199], v[204:207], v[176:191]
    s_waitcnt lgkmcnt(0)
    v_mfma_f32_32x32x16_bf16 v[128:143], v[208:211], v[216:219], v[128:143]
    v_mfma_f32_32x32x16_bf16 v[144:159], v[208:211], v[220:223], v[144:159]
    v_mfma_f32_32x32x16_bf16 v[160:175], v[212:215], v[216:219], v[160:175]
    v_mfma_f32_32x32x16_bf16 v[176:191], v[212:215], v[220:223], v[176:191]
    v_add_u32 v112, 36864, v112
    v_add_u32 v113, 36864, v113
    v_add_u32 v114, 36864, v114
    v_add_u32 v115, 36864, v115
    v_add_u32 v120, 36864, v120
    s_add_u32 s70, s70, 1
    s_cmp_lt_u32 s70, 4
    s_cbranch_scc1 fb_loop
    s_nop 0
    v_cvt_pk_bf16_f32 v128, v128, v129
    v_cvt_pk_bf16_f32 v129, v130, v131
    v_cvt_pk_bf16_f32 v130, v132, v133
    v_cvt_pk_bf16_f32 v131, v134, v135
    v_cvt_pk_bf16_f32 v132, v136, v137
    v_cvt_pk_bf16_f32 v133, v138, v139
    v_cvt_pk_bf16_f32 v134, v140, v141
    v_cvt_pk_bf16_f32 v135, v142, v143
    buffer_store_dwordx4 v[128:131], v121, s[44:47], s68 offen offset:0 sc1
    buffer_store_dwordx4 v[132:135], v121, s[44:47], s68 offen offset:256 sc1
    v_cvt_pk_bf16_f32 v144, v144, v145
    v_cvt_pk_bf16_f32 v145, v146, v147
    v_cvt_pk_bf16_f32 v146, v148, v149
    v_cvt_pk_bf16_f32 v147, v150, v151
    v_cvt_pk_bf16_f32 v148, v152, v153
    v_cvt_pk_bf16_f32 v149, v154, v155
    v_cvt_pk_bf16_f32 v150, v156, v157
    v_cvt_pk_bf16_f32 v151, v158, v159
    buffer_store_dwordx4 v[144:147], v121, s[44:47], s69 offen offset:0 sc1
    buffer_store_dwordx4 v[148:151], v121, s[44:47], s69 offen offset:256 sc1
    v_cvt_pk_bf16_f32 v160, v160, v161
    v_cvt_pk_bf16_f32 v161, v162, v163
    v_cvt_pk_bf16_f32 v162, v164, v165
    v_cvt_pk_bf16_f32 v163, v166, v167
    v_cvt_pk_bf16_f32 v164, v168, v169
    v_cvt_pk_bf16_f32 v165, v170, v171
    v_cvt_pk_bf16_f32 v166, v172, v173
    v_cvt_pk_bf16_f32 v167, v174, v175
    buffer_store_dwordx4 v[160:163], v121, s[44:47], s68 offen offset:1024 sc1
    buffer_store_dwordx4 v[164:167], v121, s[44:47], s68 offen offset:1280 sc1
    v_cvt_pk_bf16_f32 v176, v176, v177
    v_cvt_pk_bf16_f32 v177, v178, v179
    v_cvt_pk_bf16_f32 v178, v180, v181
    v_cvt_pk_bf16_f32 v179, v182, v183
    v_cvt_pk_bf16_f32 v180, v184, v185
    v_cvt_pk_bf16_f32 v181, v186, v187
    v_cvt_pk_bf16_f32 v182, v188, v189
    v_cvt_pk_bf16_f32 v183, v190, v191
    buffer_store_dwordx4 v[176:179], v121, s[44:47], s69 offen offset:1024 sc1
    buffer_store_dwordx4 v[180:183], v121, s[44:47], s69 offen offset:1280 sc1
    s_mov_b32 s99, 0
p1_clr:
    buffer_load_dword v23, off, s[60:63], 0 offset:64 sc1
    s_add_u32 s99, s99, 1
    s_cmp_ge_u32 s99, 400000
    s_cbranch_scc1 mega_abort
    s_waitcnt vmcnt(0)
    v_readfirstlane_b32 s11, v23
    s_cmp_lt_u32 s11, 32
    s_cbranch_scc1 p1_clr
    s_barrier
    s_cmp_lg_u32 s6, 0
    s_cbranch_scc1 p1a_ar
    s_lshr_b32 s11, s7, 5
    s_lshl_b32 s11, s11, 7
    s_add_u32 s11, s11, 95072768
    s_mov_b64 exec, 1
    v_mov_b32 v10, 1
    buffer_atomic_add v10, off, s[44:47], s11 sc1
    s_mov_b64 exec, -1
p1a_ar:
    s_mov_b32 s75, s7
    s_cmp_ge_u32 s75, 112
    s_cselect_b32 s10, 1, 0
    s_mul_i32 s11, s10, 112
    s_sub_u32 s9, s75, s11
    s_mul_i32 s8, s9, 9363
    s_lshr_b32 s8, s8, 16
    s_mul_i32 s11, s8, 7
    s_sub_u32 s9, s9, s11
    v_lshrrev_b32 v6, 3, v0
    v_and_b32 v7, 7, v0
    v_xor_b32 v5, v6, v7
    v_lshlrev_b32 v5, 4, v5
    v_lshl_add_u32 v5, v6, 13, v5
    v_mul_u32_u24 v6, 896, v6
    v_lshl_add_u32 v6, v7, 4, v6
    s_lshl_b32 s11, s8, 9
    s_mul_i32 s64, s6, 458752
    s_add_u32 s64, s64, s11
    s_mul_i32 s12, s10, 1835008
    s_add_u32 s64, s64, s12
    s_mul_i32 s65, s8, 229376
    s_lshl_b32 s12, s9, 7
    s_add_u32 s65, s65, s12
    s_mul_i32 s12, s6, 14336
    s_add_u32 s65, s65, s12
    s_lshl_b32 s72, s9, 19
    s_add_u32 s72, s72, s11
    s_lshl_b32 s12, s6, 17
    s_add_u32 s72, s72, s12
    s_mul_i32 s66, s6, 7168
    s_lshl_b32 s67, s6, 11
    s_add_u32 s67, s67, 28672
    s_add_u32 s71, s9, s8
    s_mov_b32 s73, 0
fa_d4:
    s_and_b32 s71, s71, 3
    s_lshl_b32 s11, s71, 7
    s_add_u32 s11, s11, s64
    s_mul_i32 s12, s71, 128
    s_add_u32 s12, s12, s72
    s_add_u32 s71, s71, 1
    s_add_u32 m0, s66, s73
    s_add_u32 s13, m0, 7168
fa_d:
    buffer_load_dwordx4 v5, s[56:59], s11 offen lds
    s_add_u32 s11, s11, 65536
    s_add_u32 m0, m0, 1024
    s_cmp_lt_u32 m0, s13
    s_cbranch_scc1 fa_d
    s_add_u32 m0, s67, s73
    s_add_u32 s11, s12, 65536
    buffer_load_dwordx4 v5, s[76:79], s12 offen lds
    s_add_u32 m0, m0, 1024
    s_add_u32 s73, s73, 36864
    buffer_load_dwordx4 v5, s[76:79], s11 offen lds
    s_cmp_lt_u32 s73, 147456
    s_cbranch_scc1 fa_d4
    v_bfe_u32 v7, v0, 2, 1
    v_lshlrev_b32 v7, 4, v7
    v_bfe_u32 v8, v0, 1, 1
    v_lshl_add_u32 v7, v8, 3, v7
    v_bfe_u32 v8, v0, 4, 1
    v_lshl_add_u32 v7, v8, 2, v7
    v_bfe_u32 v8, v0, 3, 1
    v_lshl_add_u32 v7, v8, 1, v7
    v_and_b32 v8, 1, v0
    v_add_u32 v7, v7, v8
    v_lshrrev_b32 v9, 5, v0
    s_lshl_b32 s74, s6, 1
    s_min_u32 s74, s74, 5
    s_lshl_b32 s12, s74, 12
    v_add_u32 v8, 0, v9
    v_xor_b32 v8, v8, v7
    v_and_b32 v8, 7, v8
    v_lshlrev_b32 v8, 4, v8
    v_lshl_add_u32 v8, v7, 7, v8
    v_add_u32 v112, s12, v8
    v_add_u32 v8, 2, v9
    v_xor_b32 v8, v8, v7
    v_and_b32 v8, 7, v8
    v_lshlrev_b32 v8, 4, v8
    v_lshl_add_u32 v8, v7, 7, v8
    v_add_u32 v113, s12, v8
    v_add_u32 v8, 4, v9
    v_xor_b32 v8, v8, v7
    v_and_b32 v8, 7, v8
    v_lshlrev_b32 v8, 4, v8
    v_lshl_add_u32 v8, v7, 7, v8
    v_add_u32 v114, s12, v8
    v_add_u32 v8, 6, v9
    v_xor_b32 v8, v8, v7
    v_and_b32 v8, 7, v8
    v_lshlrev_b32 v8, 4, v8
    v_lshl_add_u32 v8, v7, 7, v8
    v_add_u32 v115, s12, v8
    v_lshlrev_b32 v120, 3, v9
    v_bfe_u32 v8, v0, 2, 2
    v_add_u32 v120, v120, v8
    v_lshlrev_b32 v120, 7, v120
    v_bfe_u32 v8, v0, 4, 1
    v_lshl_add_u32 v120, v8, 5, v120
    v_and_b32 v8, 3, v0
    v_lshl_add_u32 v120, v8, 3, v120
    v_add_u32 v120, 28672, v120
    v_and_b32 v7, 31, v0
    v_add_u32 v8, 0, v9
    v_xor_b32 v8, v8, v7
    v_and_b32 v8, 7, v8
    v_lshlrev_b32 v8, 4, v8
    v_lshl_add_u32 v8, v7, 7, v8
    v_add_u32 v116, 28672, v8
    v_add_u32 v8, 2, v9
    v_xor_b32 v8, v8, v7
    v_and_b32 v8, 7, v8
    v_lshlrev_b32 v8, 4, v8
    v_lshl_add_u32 v8, v7, 7, v8
    v_add_u32 v117, 28672, v8
    v_add_u32 v8, 4, v9
    v_xor_b32 v8, v8, v7
    v_and_b32 v8, 7, v8
    v_lshlrev_b32 v8, 4, v8
    v_lshl_add_u32 v8, v7, 7, v8
    v_add_u32 v118, 28672, v8
    v_add_u32 v8, 6, v9
    v_xor_b32 v8, v8, v7
    v_and_b32 v8, 7, v8
    v_lshlrev_b32 v8, 4, v8
    v_lshl_add_u32 v8, v7, 7, v8
    v_add_u32 v119, 28672, v8
    s_mul_i32 s12, s10, 7
    s_add_u32 s74, s74, s12
    s_lshl_b32 s74, s74, 10
    v_bfe_u32 v8, v0, 4, 1
    v_mul_u32_u24 v121, 229376, v8
    v_lshl_add_u32 v121, v9, 9, v121
    v_lshl_add_u32 v121, v3, 4, v121
    v_bfe_u32 v8, v0, 4, 1
    v_mul_u32_u24 v122, 14336, v8
    v_lshl_add_u32 v122, v9, 9, v122
    v_lshl_add_u32 v122, v3, 4, v122
    s_mul_i32 s68, s8, 401408
    s_mul_i32 s11, s9, 57344
    s_add_u32 s68, s68, s11
    s_add_u32 s68, s68, s74
    s_add_u32 s68, s68, 3670016
    s_add_u32 s69, s68, 28672
    v_pk_mov_b32 v[128:129], 0, 0
    v_pk_mov_b32 v[130:131], 0, 0
    v_pk_mov_b32 v[132:133], 0, 0
    v_pk_mov_b32 v[134:135], 0, 0
    v_pk_mov_b32 v[136:137], 0, 0
    v_pk_mov_b32 v[138:139], 0, 0
    v_pk_mov_b32 v[140:141], 0, 0
    v_pk_mov_b32 v[142:143], 0, 0
    v_pk_mov_b32 v[144:145], 0, 0
    v_pk_mov_b32 v[146:147], 0, 0
    v_pk_mov_b32 v[148:149], 0, 0
    v_pk_mov_b32 v[150:151], 0, 0
    v_pk_mov_b32 v[152:153], 0, 0
    v_pk_mov_b32 v[154:155], 0, 0
    v_pk_mov_b32 v[156:157], 0, 0
    v_pk_mov_b32 v[158:159], 0, 0
    v_pk_mov_b32 v[160:161], 0, 0
    v_pk_mov_b32 v[162:163], 0, 0
    v_pk_mov_b32 v[164:165], 0, 0
    v_pk_mov_b32 v[166:167], 0, 0
    v_pk_mov_b32 v[168:169], 0, 0
    v_pk_mov_b32 v[170:171], 0, 0
    v_pk_mov_b32 v[172:173], 0, 0
    v_pk_mov_b32 v[174:175], 0, 0
    v_pk_mov_b32 v[176:177], 0, 0
    v_pk_mov_b32 v[178:179], 0, 0
    v_pk_mov_b32 v[180:181], 0, 0
    v_pk_mov_b32 v[182:183], 0, 0
    v_pk_mov_b32 v[184:185], 0, 0
    v_pk_mov_b32 v[186:187], 0, 0
    v_pk_mov_b32 v[188:189], 0, 0
    v_pk_mov_b32 v[190:191], 0, 0
    s_mov_b32 s70, 0
    s_mov_b32 s73, 0
fa_loop:
    s_cmp_eq_u32 s70, 0
    s_cbranch_scc0 fa_w0
    s_waitcnt vmcnt(27)
fa_w0:
    s_cmp_eq_u32 s70, 1
    s_cbranch_scc0 fa_w1
    s_waitcnt vmcnt(18)
fa_w1:
    s_cmp_eq_u32 s70, 2
    s_cbranch_scc0 fa_w2
    s_waitcnt vmcnt(9)
fa_w2:
    s_cmp_eq_u32 s70, 3
    s_cbranch_scc0 fa_w3
    s_waitcnt vmcnt(0)
fa_w3:
    s_barrier
    ds_read_b128 v[200:203], v116 offset:0
    ds_read_b128 v[204:207], v116 offset:4096
    ds_read_b128 v[192:195], v112 offset:0
    ds_read_b128 v[196:199], v112 offset:4096
    ds_read_b128 v[216:219], v117 offset:0
    ds_read_b128 v[220:223], v117 offset:4096
    ds_read_b128 v[208:211], v113 offset:0
    ds_read_b128 v[212:215], v113 offset:4096
    s_waitcnt lgkmcnt(4)
    v_mfma_f32_32x32x16_bf16 v[128:143], v[192:195], v[200:203], v[128:143]
    v_mfma_f32_32x32x16_bf16 v[144:159], v[192:195], v[204:207], v[144:159]
    v_mfma_f32_32x32x16_bf16 v[160:175], v[196:199], v[200:203], v[160:175]
    v_mfma_f32_32x32x16_bf16 v[176:191], v[196:199], v[204:207], v[176:191]
    ds_read_b128 v[200:203], v118 offset:0
    ds_read_b128 v[204:207], v118 offset:4096
    ds_read_b128 v[192:195], v114 offset:0
    ds_read_b128 v[196:199], v114 offset:4096
    s_waitcnt lgkmcnt(4)
    v_mfma_f32_32x32x16_bf16 v[128:143], v[208:211], v[216:219], v[128:143]
    v_mfma_f32_32x32x16_bf16 v[144:159], v[208:211], v[220:223], v[144:159]
    v_mfma_f32_32x32x16_bf16 v[160:175], v[212:215], v[216:219], v[160:175]
    v_mfma_f32_32x32x16_bf16 v[176:191], v[212:215], v[220:223], v[176:191]
    ds_read_b128 v[216:219], v119 offset:0
    ds_read_b128 v[220:223], v119 offset:4096
    ds_read_b128 v[208:211], v115 offset:0
    ds_read_b128 v[212:215], v115 offset:4096
    s_waitcnt lgkmcnt(4)
    v_mfma_f32_32x32x16_bf16 v[128:143], v[192:195], v[200:203], v[128:143]
    v_mfma_f32_32x32x16_bf16 v[144:159], v[192:195], v[204:207], v[144:159]
    v_mfma_f32_32x32x16_bf16 v[160:175], v[196:199], v[200:203], v[160:175]
    v_mfma_f32_32x32x16_bf16 v[176:191], v[196:199], v[204:207], v[176:191]
    s_waitcnt lgkmcnt(0)
    v_mfma_f32_32x32x16_bf16 v[128:143], v[208:211], v[216:219], v[128:143]
    v_mfma_f32_32x32x16_bf16 v[144:159], v[208:211], v[220:223], v[144:159]
    v_mfma_f32_32x32x16_bf16 v[160:175], v[212:215], v[216:219], v[160:175]
    v_mfma_f32_32x32x16_bf16 v[176:191], v[212:215], v[220:223], v[176:191]
    v_add_u32 v112, 36864, v112
    v_add_u32 v113, 36864, v113
    v_add_u32 v114, 36864, v114
    v_add_u32 v115, 36864, v115
    v_add_u32 v116, 36864, v116
    v_add_u32 v117, 36864, v117
    v_add_u32 v118, 36864, v118
    v_add_u32 v119, 36864, v119
    s_add_u32 s70, s70, 1
    s_cmp_lt_u32 s70, 4
    s_cbranch_scc1 fa_loop
    v_cvt_pk_bf16_f32 v128, v128, v129
    v_cvt_pk_bf16_f32 v129, v130, v131
    v_cvt_pk_bf16_f32 v130, v132, v133
    v_cvt_pk_bf16_f32 v131, v134, v135
    v_cvt_pk_bf16_f32 v132, v136, v137
    v_cvt_pk_bf16_f32 v133, v138, v139
    v_cvt_pk_bf16_f32 v134, v140, v141
    v_cvt_pk_bf16_f32 v135, v142, v143
    buffer_store_dwordx4 v[128:131], v122, s[44:47], s68 offen offset:0 sc1
    buffer_store_dwordx4 v[132:135], v122, s[44:47], s68 offen offset:256 sc1
    v_cvt_pk_bf16_f32 v144, v144, v145
    v_cvt_pk_bf16_f32 v145, v146, v147
    v_cvt_pk_bf16_f32 v146, v148, v149
    v_cvt_pk_bf16_f32 v147, v150, v151
    v_cvt_pk_bf16_f32 v148, v152, v153
    v_cvt_pk_bf16_f32 v149, v154, v155
    v_cvt_pk_bf16_f32 v150, v156, v157
    v_cvt_pk_bf16_f32 v151, v158, v159
    buffer_store_dwordx4 v[144:147], v122, s[44:47], s69 offen offset:0 sc1
    buffer_store_dwordx4 v[148:151], v122, s[44:47], s69 offen offset:256 sc1
    v_cvt_pk_bf16_f32 v160, v160, v161
    v_cvt_pk_bf16_f32 v161, v162, v163
    v_cvt_pk_bf16_f32 v162, v164, v165
    v_cvt_pk_bf16_f32 v163, v166, v167
    v_cvt_pk_bf16_f32 v164, v168, v169
    v_cvt_pk_bf16_f32 v165, v170, v171
    v_cvt_pk_bf16_f32 v166, v172, v173
    v_cvt_pk_bf16_f32 v167, v174, v175
    buffer_store_dwordx4 v[160:163], v122, s[44:47], s68 offen offset:1024 sc1
    buffer_store_dwordx4 v[164:167], v122, s[44:47], s68 offen offset:1280 sc1
    v_cvt_pk_bf16_f32 v176, v176, v177
    v_cvt_pk_bf16_f32 v177, v178, v179
    v_cvt_pk_bf16_f32 v178, v180, v181
    v_cvt_pk_bf16_f32 v179, v182, v183
    v_cvt_pk_bf16_f32 v180, v184, v185
    v_cvt_pk_bf16_f32 v181, v186, v187
    v_cvt_pk_bf16_f32 v182, v188, v189
    v_cvt_pk_bf16_f32 v183, v190, v191
    buffer_store_dwordx4 v[176:179], v122, s[44:47], s69 offen offset:1024 sc1
    buffer_store_dwordx4 v[180:183], v122, s[44:47], s69 offen offset:1280 sc1
    s_waitcnt vmcnt(0)
    s_barrier
    s_cmp_lg_u32 s6, 0
    s_cbranch_scc1 p1b_ar
    s_lshr_b32 s11, s7, 5
    s_lshl_b32 s11, s11, 7
    s_add_u32 s11, s11, 95073792
    s_mov_b64 exec, 1
    v_mov_b32 v10, 1
    buffer_atomic_add v10, off, s[44:47], s11 sc1
    s_mov_b64 exec, -1
p1b_ar:
p1_end:
    s_mov_b32 s7, s3
    v_mov_b32 v2, 0
    s_branch el_roles
el_ovf:
    s_mov_b64 exec, 1
    v_mov_b32 v5, 1
    buffer_atomic_add v5, off, s[60:63], 0 offset:192 sc0 sc1
    s_mov_b64 exec, -1
    v_and_b32 v6, 3, v0
    v_lshlrev_b32 v6, 2, v6
    v_and_b32 v7, 4, v0
    v_lshl_add_u32 v6, v7, 5, v6
    s_waitcnt vmcnt(0)
    v_readfirstlane_b32 s10, v5
    s_mov_b32 s99, 0
el_ow:
    buffer_load_dword v5, v6, s[60:63], 0 offen offset:68 sc1
    s_add_u32 s99, s99, 1
    s_cmp_ge_u32 s99, 400000
    s_cbranch_scc1 mega_abort
    s_waitcnt vmcnt(0)
    s_mov_b32 s11, 0
    v_readlane_b32 s12, v5, 0
    s_add_u32 s11, s11, s12
    v_readlane_b32 s12, v5, 1
    s_add_u32 s11, s11, s12
    v_readlane_b32 s12, v5, 2
    s_add_u32 s11, s11, s12
    v_readlane_b32 s12, v5, 3
    s_add_u32 s11, s11, s12
    v_readlane_b32 s12, v5, 4
    s_add_u32 s11, s11, s12
    v_readlane_b32 s12, v5, 5
    s_add_u32 s11, s11, s12
    v_readlane_b32 s12, v5, 6
    s_add_u32 s11, s11, s12
    v_readlane_b32 s12, v5, 7
    s_add_u32 s11, s11, s12
    s_cmp_lt_u32 s11, 256
    s_cbranch_scc1 el_ow
    v_readlane_b32 s12, v5, 0
    s_min_u32 s12, s12, 32
    s_add_u32 s7, s12, s10
    s_add_u32 s7, s7, 0
    s_sub_u32 s12, 32, s12
    s_cmp_lt_u32 s10, s12
    s_cbranch_scc1 el_put
    s_sub_u32 s10, s10, s12
    v_readlane_b32 s12, v5, 1
    s_min_u32 s12, s12, 32
    s_add_u32 s7, s12, s10
    s_add_u32 s7, s7, 32
    s_sub_u32 s12, 32, s12
    s_cmp_lt_u32 s10, s12
    s_cbranch_scc1 el_put
    s_sub_u32 s10, s10, s12
    v_readlane_b32 s12, v5, 2
    s_min_u32 s12, s12, 32
    s_add_u32 s7, s12, s10
    s_add_u32 s7, s7, 64
    s_sub_u32 s12, 32, s12
    s_cmp_lt_u32 s10, s12
    s_cbranch_scc1 el_put
    s_sub_u32 s10, s10, s12
    v_readlane_b32 s12, v5, 3
    s_min_u32 s12, s12, 32
    s_add_u32 s7, s12, s10
    s_add_u32 s7, s7, 96
    s_sub_u32 s12, 32, s12
    s_cmp_lt_u32 s10, s12
    s_cbranch_scc1 el_put
    s_sub_u32 s10, s10, s12
    v_readlane_b32 s12, v5, 4
    s_min_u32 s12, s12, 32
    s_add_u32 s7, s12, s10
    s_add_u32 s7, s7, 128
    s_sub_u32 s12, 32, s12
    s_cmp_lt_u32 s10, s12
    s_cbranch_scc1 el_put
    s_sub_u32 s10, s10, s12
    v_readlane_b32 s12, v5, 5
    s_min_u32 s12, s12, 32
    s_add_u32 s7, s12, s10
    s_add_u32 s7, s7, 160
    s_sub_u32 s12, 32, s12
    s_cmp_lt_u32 s10, s12
    s_cbranch_scc1 el_put
    s_sub_u32 s10, s10, s12
    v_readlane_b32 s12, v5, 6
    s_min_u32 s12, s12, 32
    s_add_u32 s7, s12, s10
    s_add_u32 s7, s7, 192
    s_sub_u32 s12, 32, s12
    s_cmp_lt_u32 s10, s12
    s_cbranch_scc1 el_put
    s_sub_u32 s10, s10, s12
    v_readlane_b32 s12, v5, 7
    s_min_u32 s12, s12, 32
    s_add_u32 s7, s12, s10
    s_add_u32 s7, s7, 224
    s_sub_u32 s12, 32, s12
    s_cmp_lt_u32 s10, s12
    s_cbranch_scc1 el_put
    s_sub_u32 s10, s10, s12
    s_branch mega_abort
el_roles:
    s_cmp_lt_u32 s7, 16
    s_cbranch_scc1 role_f1
    s_cmp_lt_u32 s7, 32
    s_cbranch_scc1 role_f2
    s_cmp_lt_u32 s7, 88
    s_cbranch_scc1 role_vx
    s_cmp_lt_u32 s7, 144
    s_cbranch_scc1 role_tx
    s_cmp_lt_u32 s7, 200
    s_cbranch_scc1 role_ffn
    s_cmp_lt_u32 s7, 224
    s_cbranch_scc1 role_f2b
    s_cmp_lt_u32 s7, 256
    s_cbranch_scc1 role_chain
mega_exit:
    s_endpgm
mega_abort:
    s_mov_b32 s60, s40
    s_and_b32 s61, s41, 0xffff
    s_mov_b32 s62, 0x100
    s_mov_b32 s63, 0x20000
    v_mov_b32 v2, 0
    v_mov_b32 v5, 3735879695
    buffer_store_dword v5, v2, s[60:63], 0 offen offset:60
    s_endpgm
role_f1:
    s_cmp_lg_u32 s6, 0
    s_cbranch_scc1 sw_1
    v_min_u32 v13, 7, v0
    v_lshlrev_b32 v13, 7, v13
    s_mov_b32 s98, 95072768
    s_mov_b32 s99, 0
ws_2:
    buffer_load_dword v12, v13, s[44:47], s98 offen sc1
    s_add_u32 s99, s99, 1
    s_cmp_ge_u32 s99, 400000
    s_cbranch_scc1 mega_abort
    s_waitcnt vmcnt(0)
    v_cmp_gt_u32 vcc, 32, v12
    s_cbranch_vccz wt_3
    s_sleep 4
    s_branch ws_2
wt_3:
    buffer_inv sc1
sw_1:
    s_barrier
    s_mov_b32 s80, 0x3db8aa3b
    s_and_b32 s8, s7, 3
    s_lshr_b32 s64, s7, 2
    v_and_b32 v6, 13, v3
    v_lshlrev_b32 v6, 4, v6
    v_lshrrev_b32 v7, 1, v4
    v_lshl_add_u32 v6, v7, 8, v6
    v_and_b32 v7, 1, v4
    v_lshl_add_u32 v6, v7, 3, v6
    v_add_u32 v16, 0, v1
    v_add_u32 v17, 4096, v1
    v_add_u32 v18, 8192, v1
    v_add_u32 v19, 12288, v1
    v_add_u32 v20, 16384, v1
    v_add_u32 v21, 20480, v1
    v_add_u32 v22, 24576, v1
    v_add_u32 v24, 0, v6
    v_add_u32 v25, 2048, v6
    v_add_u32 v26, 4096, v6
    v_add_u32 v27, 6144, v6
    v_lshl_add_u32 v7, v4, 2, 0
    v_cmp_le_u32 s[72:73], v7, v3
    v_lshl_add_u32 v7, v4, 2, 1
    v_cmp_le_u32 s[74:75], v7, v3
    v_lshl_add_u32 v7, v4, 2, 2
    v_cmp_le_u32 s[76:77], v7, v3
    v_lshl_add_u32 v7, v4, 2, 3
    v_cmp_le_u32 s[78:79], v7, v3
    v_mov_b32 v8, 0xce6e6b28
    s_and_b32 s65, s6, 1
    s_lshl_b32 s65, s65, 2
    s_lshr_b32 s66, s6, 1
    s_lshl_b32 s66, s66, 11
    s_add_u32 s65, s65, s66
    v_add_u32 v9, s65, v1
    v_add_u32 v10, 4096, v9
    s_lshl_b32 s65, s6, 2
    s_add_u32 s65, s65, 8192
    v_add_u32 v11, s65, v1
    v_mov_b32 v96, -1
    v_mov_b32 v97, -1
    v_mov_b32 v98, -1
    v_mov_b32 v99, -1
    s_lshl_b32 s65, s6, 10
    v_add_u32 v12, s65, v1
    s_mul_i32 s66, s64, 40960
    s_mul_i32 s65, s8, 10240
    s_add_u32 s66, s66, s65
    s_add_u32 s66, s66, 92274688
    s_add_u32 s67, s66, 2621440
f1_clr:
    buffer_store_dwordx4 v[96:99], v12, s[44:47], s66 offen sc1
    s_add_u32 s65, s66, 4096
    buffer_store_dwordx4 v[96:99], v12, s[44:47], s65 offen sc1
    s_add_u32 s65, s66, 6144
    buffer_store_dwordx4 v[96:99], v12, s[44:47], s65 offen sc1
    s_add_u32 s66, s66, 163840
    s_cmp_lt_u32 s66, s67
    s_cbranch_scc1 f1_clr
    s_mov_b32 s69, 95072256
    s_waitcnt vmcnt(0)
    s_barrier
    s_cmp_lg_u32 s6, 0
    s_cbranch_scc1 sg_4
    s_mov_b64 exec, 1
    v_mov_b32 v13, 1
    buffer_atomic_add v13, v2, s[44:47], s69 offen sc1
    s_mov_b64 exec, -1
sg_4:
f1_loop:
    s_lshl_b32 s69, s64, 7
    s_add_u32 s69, s69, 95023104
    s_mul_i32 s66, s64, 28672
    s_add_u32 s66, s66, 0
    buffer_load_dwordx4 a[112:115], v16, s[44:47], s66 offen offset:0
    buffer_load_dwordx4 a[116:119], v16, s[44:47], s66 offen offset:1024
    buffer_load_dwordx4 a[120:123], v16, s[44:47], s66 offen offset:2048
    buffer_load_dwordx4 a[124:127], v16, s[44:47], s66 offen offset:3072
    buffer_load_dwordx4 a[128:131], v17, s[44:47], s66 offen offset:0
    buffer_load_dwordx4 a[132:135], v17, s[44:47], s66 offen offset:1024
    buffer_load_dwordx4 a[136:139], v17, s[44:47], s66 offen offset:2048
    buffer_load_dwordx4 a[140:143], v17, s[44:47], s66 offen offset:3072
    buffer_load_dwordx4 a[144:147], v18, s[44:47], s66 offen offset:0
    buffer_load_dwordx4 a[148:151], v18, s[44:47], s66 offen offset:1024
    buffer_load_dwordx4 a[152:155], v18, s[44:47], s66 offen offset:2048
    buffer_load_dwordx4 a[156:159], v18, s[44:47], s66 offen offset:3072
    buffer_load_dwordx4 a[160:163], v19, s[44:47], s66 offen offset:0
    buffer_load_dwordx4 a[164:167], v19, s[44:47], s66 offen offset:1024
    buffer_load_dwordx4 a[168:171], v19, s[44:47], s66 offen offset:2048
    buffer_load_dwordx4 a[172:175], v19, s[44:47], s66 offen offset:3072
    buffer_load_dwordx4 a[176:179], v20, s[44:47], s66 offen offset:0
    buffer_load_dwordx4 a[180:183], v20, s[44:47], s66 offen offset:1024
    buffer_load_dwordx4 a[184:187], v20, s[44:47], s66 offen offset:2048
    buffer_load_dwordx4 a[188:191], v20, s[44:47], s66 offen offset:3072
    buffer_load_dwordx4 a[192:195], v21, s[44:47], s66 offen offset:0
    buffer_load_dwordx4 a[196:199], v21, s[44:47], s66 offen offset:1024
    buffer_load_dwordx4 a[200:203], v21, s[44:47], s66 offen offset:2048
    buffer_load_dwordx4 a[204:207], v21, s[44:47], s66 offen offset:3072
    buffer_load_dwordx4 a[208:211], v22, s[44:47], s66 offen offset:0
    buffer_load_dwordx4 a[212:215], v22, s[44:47], s66 offen offset:1024
    buffer_load_dwordx4 a[216:219], v22, s[44:47], s66 offen offset:2048
    buffer_load_dwordx4 a[220:223], v22, s[44:47], s66 offen offset:3072
    s_mov_b32 s99, 0
wc_5:
    buffer_load_dword v12, v2, s[44:47], s69 offen sc1
    s_waitcnt vmcnt(0)
    v_readfirstlane_b32 s98, v12
    s_cmp_ge_u32 s98, 28
    s_cbranch_scc1 wd_6
    s_sleep 2
    s_add_u32 s99, s99, 1
    s_cmp_lt_u32 s99, 400000
    s_cbranch_scc1 wc_5
    s_mov_b32 s60, s40
    s_and_b32 s61, s41, 0xffff
    s_mov_b32 s62, 0x100
    s_mov_b32 s63, 0x20000
    v_mov_b32 v2, 0
    v_mov_b32 v5, 3735879685
    buffer_store_dword v5, v2, s[60:63], 0 offen offset:20
    s_endpgm
wd_6:
    s_lshl_b32 s65, s8, 2
    s_add_u32 s65, s65, s6
    s_mul_i32 s65, s65, 28672
    s_mul_i32 s66, s64, 458752
    s_add_u32 s65, s65, s66
    s_add_u32 s65, s65, 45875200
    buffer_load_dwordx4 a[0:3], v16, s[44:47], s65 offen offset:0 sc1
    buffer_load_dwordx4 a[4:7], v16, s[44:47], s65 offen offset:1024 sc1
    buffer_load_dwordx4 a[8:11], v16, s[44:47], s65 offen offset:2048 sc1
    buffer_load_dwordx4 a[12:15], v16, s[44:47], s65 offen offset:3072 sc1
    buffer_load_dwordx4 a[16:19], v17, s[44:47], s65 offen offset:0 sc1
    buffer_load_dwordx4 a[20:23], v17, s[44:47], s65 offen offset:1024 sc1
    buffer_load_dwordx4 a[24:27], v17, s[44:47], s65 offen offset:2048 sc1
    buffer_load_dwordx4 a[28:31], v17, s[44:47], s65 offen offset:3072 sc1
    buffer_load_dwordx4 a[32:35], v18, s[44:47], s65 offen offset:0 sc1
    buffer_load_dwordx4 a[36:39], v18, s[44:47], s65 offen offset:1024 sc1
    buffer_load_dwordx4 a[40:43], v18, s[44:47], s65 offen offset:2048 sc1
    buffer_load_dwordx4 a[44:47], v18, s[44:47], s65 offen offset:3072 sc1
    buffer_load_dwordx4 a[48:51], v19, s[44:47], s65 offen offset:0 sc1
    buffer_load_dwordx4 a[52:55], v19, s[44:47], s65 offen offset:1024 sc1
    buffer_load_dwordx4 a[56:59], v19, s[44:47], s65 offen offset:2048 sc1
    buffer_load_dwordx4 a[60:63], v19, s[44:47], s65 offen offset:3072 sc1
    buffer_load_dwordx4 a[64:67], v20, s[44:47], s65 offen offset:0 sc1
    buffer_load_dwordx4 a[68:71], v20, s[44:47], s65 offen offset:1024 sc1
    buffer_load_dwordx4 a[72:75], v20, s[44:47], s65 offen offset:2048 sc1
    buffer_load_dwordx4 a[76:79], v20, s[44:47], s65 offen offset:3072 sc1
    buffer_load_dwordx4 a[80:83], v21, s[44:47], s65 offen offset:0 sc1
    buffer_load_dwordx4 a[84:87], v21, s[44:47], s65 offen offset:1024 sc1
    buffer_load_dwordx4 a[88:91], v21, s[44:47], s65 offen offset:2048 sc1
    buffer_load_dwordx4 a[92:95], v21, s[44:47], s65 offen offset:3072 sc1
    buffer_load_dwordx4 a[96:99], v22, s[44:47], s65 offen offset:0 sc1
    buffer_load_dwordx4 a[100:103], v22, s[44:47], s65 offen offset:1024 sc1
    buffer_load_dwordx4 a[104:107], v22, s[44:47], s65 offen offset:2048 sc1
    buffer_load_dwordx4 a[108:111], v22, s[44:47], s65 offen offset:3072 sc1
    s_waitcnt vmcnt(26)
    v_mfma_f32_16x16x32_bf16 v[64:67], a[112:115], a[0:3], 0
    v_mfma_f32_16x16x32_bf16 v[68:71], a[112:115], a[4:7], 0
    v_mfma_f32_16x16x32_bf16 v[76:79], a[168:171], a[4:7], 0
    s_waitcnt vmcnt(24)
    v_mfma_f32_16x16x32_bf16 v[64:67], a[116:119], a[8:11], v[64:67]
    v_mfma_f32_16x16x32_bf16 v[68:71], a[116:119], a[12:15], v[68:71]
    v_mfma_f32_16x16x32_bf16 v[76:79], a[172:175], a[12:15], v[76:79]
    s_waitcnt vmcnt(22)
    v_mfma_f32_16x16x32_bf16 v[64:67], a[120:123], a[16:19], v[64:67]
    v_mfma_f32_16x16x32_bf16 v[68:71], a[120:123], a[20:23], v[68:71]
    v_mfma_f32_16x16x32_bf16 v[76:79], a[176:179], a[20:23], v[76:79]
    s_waitcnt vmcnt(20)
    v_mfma_f32_16x16x32_bf16 v[64:67], a[124:127], a[24:27], v[64:67]
    v_mfma_f32_16x16x32_bf16 v[68:71], a[124:127], a[28:31], v[68:71]
    v_mfma_f32_16x16x32_bf16 v[76:79], a[180:183], a[28:31], v[76:79]
    s_waitcnt vmcnt(18)
    v_mfma_f32_16x16x32_bf16 v[64:67], a[128:131], a[32:35], v[64:67]
    v_mfma_f32_16x16x32_bf16 v[68:71], a[128:131], a[36:39], v[68:71]
    v_mfma_f32_16x16x32_bf16 v[76:79], a[184:187], a[36:39], v[76:79]
    s_waitcnt vmcnt(16)
    v_mfma_f32_16x16x32_bf16 v[64:67], a[132:135], a[40:43], v[64:67]
    v_mfma_f32_16x16x32_bf16 v[68:71], a[132:135], a[44:47], v[68:71]
    v_mfma_f32_16x16x32_bf16 v[76:79], a[188:191], a[44:47], v[76:79]
    s_waitcnt vmcnt(14)
    v_mfma_f32_16x16x32_bf16 v[64:67], a[136:139], a[48:51], v[64:67]
    v_mfma_f32_16x16x32_bf16 v[68:71], a[136:139], a[52:55], v[68:71]
    v_mfma_f32_16x16x32_bf16 v[76:79], a[192:195], a[52:55], v[76:79]
    s_waitcnt vmcnt(12)
    v_mfma_f32_16x16x32_bf16 v[64:67], a[140:143], a[56:59], v[64:67]
    v_mfma_f32_16x16x32_bf16 v[68:71], a[140:143], a[60:63], v[68:71]
    v_mfma_f32_16x16x32_bf16 v[76:79], a[196:199], a[60:63], v[76:79]
    s_waitcnt vmcnt(10)
    v_mfma_f32_16x16x32_bf16 v[64:67], a[144:147], a[64:67], v[64:67]
    v_mfma_f32_16x16x32_bf16 v[68:71], a[144:147], a[68:71], v[68:71]
    v_mfma_f32_16x16x32_bf16 v[76:79], a[200:203], a[68:71], v[76:79]
    s_waitcnt vmcnt(8)
    v_mfma_f32_16x16x32_bf16 v[64:67], a[148:151], a[72:75], v[64:67]
    v_mfma_f32_16x16x32_bf16 v[68:71], a[148:151], a[76:79], v[68:71]
    v_mfma_f32_16x16x32_bf16 v[76:79], a[204:207], a[76:79], v[76:79]
    s_waitcnt vmcnt(6)
    v_mfma_f32_16x16x32_bf16 v[64:67], a[152:155], a[80:83], v[64:67]
    v_mfma_f32_16x16x32_bf16 v[68:71], a[152:155], a[84:87], v[68:71]
    v_mfma_f32_16x16x32_bf16 v[76:79], a[208:211], a[84:87], v[76:79]
    s_waitcnt vmcnt(4)
    v_mfma_f32_16x16x32_bf16 v[64:67], a[156:159], a[88:91], v[64:67]
    v_mfma_f32_16x16x32_bf16 v[68:71], a[156:159], a[92:95], v[68:71]
    v_mfma_f32_16x16x32_bf16 v[76:79], a[212:215], a[92:95], v[76:79]
    s_waitcnt vmcnt(2)
    v_mfma_f32_16x16x32_bf16 v[64:67], a[160:163], a[96:99], v[64:67]
    v_mfma_f32_16x16x32_bf16 v[68:71], a[160:163], a[100:103], v[68:71]
    v_mfma_f32_16x16x32_bf16 v[76:79], a[216:219], a[100:103], v[76:79]
    s_waitcnt vmcnt(0)
    v_mfma_f32_16x16x32_bf16 v[64:67], a[164:167], a[104:107], v[64:67]
    v_mfma_f32_16x16x32_bf16 v[68:71], a[164:167], a[108:111], v[68:71]
    v_mfma_f32_16x16x32_bf16 v[76:79], a[220:223], a[108:111], v[76:79]
    s_nop 5
    v_cndmask_b32 v64, v8, v64, s[72:73]
    v_cndmask_b32 v65, v8, v65, s[74:75]
    v_cndmask_b32 v66, v8, v66, s[76:77]
    v_cndmask_b32 v67, v8, v67, s[78:79]
    v_cndmask_b32 v76, v8, v76, s[72:73]
    v_cndmask_b32 v77, v8, v77, s[74:75]
    v_cndmask_b32 v78, v8, v78, s[76:77]
    v_cndmask_b32 v79, v8, v79, s[78:79]
    s_max_u32 s69, s64, 1
    s_sub_u32 s69, s69, 1
    s_lshl_b32 s69, s69, 7
    s_add_u32 s69, s69, 95055872
    s_mov_b32 s99, 0
wc_8:
    buffer_load_dword v12, v2, s[44:47], s69 offen sc1
    s_waitcnt vmcnt(0)
    v_readfirstlane_b32 s98, v12
    s_cmp_ge_u32 s98, 1
    s_cbranch_scc1 wd_9
    s_sleep 2
    s_add_u32 s99, s99, 1
    s_cmp_lt_u32 s99, 400000
    s_cbranch_scc1 wc_8
    s_mov_b32 s60, s40
    s_and_b32 s61, s41, 0xffff
    s_mov_b32 s62, 0x100
    s_mov_b32 s63, 0x20000
    v_mov_b32 v2, 0
    v_mov_b32 v5, 3735879686
    buffer_store_dword v5, v2, s[60:63], 0 offen offset:24
    s_endpgm
wd_9:
    s_lshl_b32 s66, s64, 13
    s_lshl_b32 m0, s6, 11
    s_add_u32 s66, s66, m0
    s_add_u32 s66, s66, 91750400
    s_mov_b32 s99, 0
f1_mp:
    buffer_load_dwordx4 v1, s[44:47], s66 offen offset:0 sc1 lds
    buffer_load_dwordx4 v1, s[44:47], s66 offen offset:1024 sc1 lds
    s_add_u32 s99, s99, 1
    s_cmp_ge_u32 s99, 400000
    s_cbranch_scc1 mega_abort
    s_waitcnt vmcnt(0)
    s_barrier
    ds_read2_b64 v[128:131], v24 offset0:0 offset1:4
    ds_read2_b64 v[132:135], v24 offset0:64 offset1:68
    ds_read2_b64 v[136:139], v24 offset0:128 offset1:132
    ds_read2_b64 v[140:143], v24 offset0:192 offset1:196
    ds_read2_b64 v[144:147], v25 offset0:0 offset1:4
    ds_read2_b64 v[148:151], v25 offset0:64 offset1:68
    ds_read2_b64 v[152:155], v25 offset0:128 offset1:132
    ds_read2_b64 v[156:159], v25 offset0:192 offset1:196
    ds_read2_b64 v[160:163], v26 offset0:0 offset1:4
    ds_read2_b64 v[164:167], v26 offset0:64 offset1:68
    ds_read2_b64 v[168:171], v26 offset0:128 offset1:132
    ds_read2_b64 v[172:175], v26 offset0:192 offset1:196
    ds_read2_b64 v[176:179], v27 offset0:0 offset1:4
    ds_read2_b64 v[180:183], v27 offset0:64 offset1:68
    s_waitcnt lgkmcnt(0)
    s_barrier
    v_max3_u32 v12, v128, v129, v130
    v_max3_u32 v12, v12, v131, v132
    v_max3_u32 v12, v12, v133, v134
    v_max3_u32 v12, v12, v135, v136
    v_max3_u32 v12, v12, v137, v138
    v_max3_u32 v12, v12, v139, v140
    v_max3_u32 v12, v12, v141, v142
    v_max3_u32 v12, v12, v143, v144
    v_max3_u32 v12, v12, v145, v146
    v_max3_u32 v12, v12, v147, v148
    v_max3_u32 v12, v12, v149, v150
    v_max3_u32 v12, v12, v151, v152
    v_max3_u32 v12, v12, v153, v154
    v_max3_u32 v12, v12, v155, v156
    v_max3_u32 v12, v12, v157, v158
    v_max3_u32 v12, v12, v159, v160
    v_max3_u32 v12, v12, v161, v162
    v_max3_u32 v12, v12, v163, v164
    v_max3_u32 v12, v12, v165, v166
    v_max3_u32 v12, v12, v167, v168
    v_max3_u32 v12, v12, v169, v170
    v_max3_u32 v12, v12, v171, v172
    v_max3_u32 v12, v12, v173, v174
    v_max3_u32 v12, v12, v175, v176
    v_max3_u32 v12, v12, v177, v178
    v_max3_u32 v12, v12, v179, v180
    v_max3_u32 v12, v12, v181, v182
    v_max_u32 v12, v12, v183
    v_cmp_eq_u32 vcc, -1, v12
    s_cbranch_vccnz f1_mp
    v_swap_b32 v129, v130
    s_nop 1
    v_mfma_f32_16x16x32_bf16 v[80:83], v[128:131], a[0:3], 0
    v_mfma_f32_16x16x32_bf16 v[84:87], v[128:131], a[4:7], 0
    v_swap_b32 v133, v134
    s_nop 1
    v_mfma_f32_16x16x32_bf16 v[80:83], v[132:135], a[8:11], v[80:83]
    v_mfma_f32_16x16x32_bf16 v[84:87], v[132:135], a[12:15], v[84:87]
    v_swap_b32 v137, v138
    s_nop 1
    v_mfma_f32_16x16x32_bf16 v[80:83], v[136:139], a[16:19], v[80:83]
    v_mfma_f32_16x16x32_bf16 v[84:87], v[136:139], a[20:23], v[84:87]
    v_swap_b32 v141, v142
    s_nop 1
    v_mfma_f32_16x16x32_bf16 v[80:83], v[140:143], a[24:27], v[80:83]
    v_mfma_f32_16x16x32_bf16 v[84:87], v[140:143], a[28:31], v[84:87]
    v_swap_b32 v145, v146
    s_nop 1
    v_mfma_f32_16x16x32_bf16 v[80:83], v[144:147], a[32:35], v[80:83]
    v_mfma_f32_16x16x32_bf16 v[84:87], v[144:147], a[36:39], v[84:87]
    v_swap_b32 v149, v150
    s_nop 1
    v_mfma_f32_16x16x32_bf16 v[80:83], v[148:151], a[40:43], v[80:83]
    v_mfma_f32_16x16x32_bf16 v[84:87], v[148:151], a[44:47], v[84:87]
    v_swap_b32 v153, v154
    s_nop 1
    v_mfma_f32_16x16x32_bf16 v[80:83], v[152:155], a[48:51], v[80:83]
    v_mfma_f32_16x16x32_bf16 v[84:87], v[152:155], a[52:55], v[84:87]
    v_swap_b32 v157, v158
    s_nop 1
    v_mfma_f32_16x16x32_bf16 v[80:83], v[156:159], a[56:59], v[80:83]
    v_mfma_f32_16x16x32_bf16 v[84:87], v[156:159], a[60:63], v[84:87]
    v_swap_b32 v161, v162
    s_nop 1
    v_mfma_f32_16x16x32_bf16 v[80:83], v[160:163], a[64:67], v[80:83]
    v_mfma_f32_16x16x32_bf16 v[84:87], v[160:163], a[68:71], v[84:87]
    v_swap_b32 v165, v166
    s_nop 1
    v_mfma_f32_16x16x32_bf16 v[80:83], v[164:167], a[72:75], v[80:83]
    v_mfma_f32_16x16x32_bf16 v[84:87], v[164:167], a[76:79], v[84:87]
    v_swap_b32 v169, v170
    s_nop 1
    v_mfma_f32_16x16x32_bf16 v[80:83], v[168:171], a[80:83], v[80:83]
    v_mfma_f32_16x16x32_bf16 v[84:87], v[168:171], a[84:87], v[84:87]
    v_swap_b32 v173, v174
    s_nop 1
    v_mfma_f32_16x16x32_bf16 v[80:83], v[172:175], a[88:91], v[80:83]
    v_mfma_f32_16x16x32_bf16 v[84:87], v[172:175], a[92:95], v[84:87]
    v_swap_b32 v177, v178
    s_nop 1
    v_mfma_f32_16x16x32_bf16 v[80:83], v[176:179], a[96:99], v[80:83]
    v_mfma_f32_16x16x32_bf16 v[84:87], v[176:179], a[100:103], v[84:87]
    v_swap_b32 v181, v182
    s_nop 1
    v_mfma_f32_16x16x32_bf16 v[80:83], v[180:183], a[104:107], v[80:83]
    v_mfma_f32_16x16x32_bf16 v[84:87], v[180:183], a[108:111], v[84:87]
    s_mul_i32 s66, s64, 40960
    s_mul_i32 s65, s8, 10240
    s_add_u32 s66, s66, s65
    s_add_u32 s66, s66, 92274688
    v_max3_f32 v96, v64, v65, v66
    s_nop 1
    v_max3_f32 v96, v96, v67, v80
    v_max_f32 v96, v96, v81
    v_mov_b32 v97, v96
    s_nop 1
    v_permlane32_swap_b32 v96, v97
    v_max_f32 v96, v96, v97
    v_mov_b32 v97, v96
    s_nop 1
    v_permlane16_swap_b32 v96, v97
    v_max_f32 v96, v96, v97
    v_mul_f32 v96, s80, v96
    v_fma_f32 v64, v64, s80, -v96
    v_fma_f32 v65, v65, s80, -v96
    v_fma_f32 v66, v66, s80, -v96
    v_fma_f32 v67, v67, s80, -v96
    v_fma_f32 v80, v80, s80, -v96
    v_fma_f32 v81, v81, s80, -v96
    v_exp_f32 v64, v64
    v_exp_f32 v65, v65
    v_exp_f32 v66, v66
    v_exp_f32 v67, v67
    v_exp_f32 v80, v80
    v_exp_f32 v81, v81
    v_add_f32 v98, v64, v65
    v_add_f32 v98, v98, v66
    v_add_f32 v98, v98, v67
    v_add_f32 v98, v98, v80
    v_add_f32 v98, v98, v81
    v_mov_b32 v97, v98
    s_nop 1
    v_permlane32_swap_b32 v98, v97
    v_add_f32 v98, v98, v97
    v_mov_b32 v97, v98
    s_nop 1
    v_permlane16_swap_b32 v98, v97
    v_add_f32 v98, v98, v97
    v_rcp_f32 v98, v98
    s_nop 0
    v_mul_f32 v64, v64, v98
    v_mul_f32 v65, v65, v98
    v_mul_f32 v66, v66, v98
    v_mul_f32 v67, v67, v98
    v_mul_f32 v80, v80, v98
    v_mul_f32 v81, v81, v98
    v_cvt_pk_bf16_f32 v100, v64, v65
    v_min_u32 v100, -2, v100
    buffer_store_dword v100, v9, s[44:47], s66 offen offset:0 sc1
    v_cvt_pk_bf16_f32 v101, v66, v67
    v_min_u32 v101, -2, v101
    buffer_store_dword v101, v9, s[44:47], s66 offen offset:8 sc1
    v_cvt_pk_bf16_f32 v102, v80, v81
    v_min_u32 v102, -2, v102
    buffer_store_dword v102, v11, s[44:47], s66 offen offset:0 sc1
    v_max3_f32 v96, v68, v69, v70
    v_max3_f32 v96, v96, v71, v76
    v_max3_f32 v96, v96, v77, v78
    v_max3_f32 v96, v96, v79, v84
    v_max_f32 v96, v96, v85
    v_mov_b32 v97, v96
    s_nop 1
    v_permlane32_swap_b32 v96, v97
    v_max_f32 v96, v96, v97
    v_mov_b32 v97, v96
    s_nop 1
    v_permlane16_swap_b32 v96, v97
    v_max_f32 v96, v96, v97
    v_mul_f32 v96, s80, v96
    v_fma_f32 v68, v68, s80, -v96
    v_fma_f32 v69, v69, s80, -v96
    v_fma_f32 v70, v70, s80, -v96
    v_fma_f32 v71, v71, s80, -v96
    v_fma_f32 v76, v76, s80, -v96
    v_fma_f32 v77, v77, s80, -v96
    v_fma_f32 v78, v78, s80, -v96
    v_fma_f32 v79, v79, s80, -v96
    v_fma_f32 v84, v84, s80, -v96
    v_fma_f32 v85, v85, s80, -v96
    v_exp_f32 v68, v68
    v_exp_f32 v69, v69
    v_exp_f32 v70, v70
    v_exp_f32 v71, v71
    v_exp_f32 v76, v76
    v_exp_f32 v77, v77
    v_exp_f32 v78, v78
    v_exp_f32 v79, v79
    v_exp_f32 v84, v84
    v_exp_f32 v85, v85
    v_add_f32 v98, v68, v69
    v_add_f32 v98, v98, v70
    v_add_f32 v98, v98, v71
    v_add_f32 v98, v98, v76
    v_add_f32 v98, v98, v77
    v_add_f32 v98, v98, v78
    v_add_f32 v98, v98, v79
    v_add_f32 v98, v98, v84
    v_add_f32 v98, v98, v85
    v_mov_b32 v97, v98
    s_nop 1
    v_permlane32_swap_b32 v98, v97
    v_add_f32 v98, v98, v97
    v_mov_b32 v97, v98
    s_nop 1
    v_permlane16_swap_b32 v98, v97
    v_add_f32 v98, v98, v97
    v_rcp_f32 v98, v98
    s_nop 0
    v_mul_f32 v68, v68, v98
    v_mul_f32 v69, v69, v98
    v_mul_f32 v70, v70, v98
    v_mul_f32 v71, v71, v98
    v_mul_f32 v76, v76, v98
    v_mul_f32 v77, v77, v98
    v_mul_f32 v78, v78, v98
    v_mul_f32 v79, v79, v98
    v_mul_f32 v84, v84, v98
    v_mul_f32 v85, v85, v98
    v_cvt_pk_bf16_f32 v108, v68, v69
    v_min_u32 v108, -2, v108
    buffer_store_dword v108, v9, s[44:47], s66 offen offset:1024 sc1
    v_cvt_pk_bf16_f32 v109, v70, v71
    v_min_u32 v109, -2, v109
    buffer_store_dword v109, v9, s[44:47], s66 offen offset:1032 sc1
    v_cvt_pk_bf16_f32 v110, v76, v77
    v_min_u32 v110, -2, v110
    buffer_store_dword v110, v10, s[44:47], s66 offen offset:1024 sc1
    v_cvt_pk_bf16_f32 v111, v78, v79
    v_min_u32 v111, -2, v111
    buffer_store_dword v111, v10, s[44:47], s66 offen offset:1032 sc1
    v_cvt_pk_bf16_f32 v112, v84, v85
    v_min_u32 v112, -2, v112
    buffer_store_dword v112, v11, s[44:47], s66 offen offset:1024 sc1
    s_add_u32 s64, s64, 4
    s_cmp_lt_u32 s64, 64
    s_cbranch_scc1 f1_loop
    s_endpgm
role_f2:
    s_sub_u32 s7, s7, 16
    s_cmp_lg_u32 s6, 0
    s_cbranch_scc1 sw_11
    v_min_u32 v13, 7, v0
    v_lshlrev_b32 v13, 7, v13
    s_mov_b32 s98, 95072768
    s_mov_b32 s99, 0
ws_12:
    buffer_load_dword v12, v13, s[44:47], s98 offen sc1
    s_add_u32 s99, s99, 1
    s_cmp_ge_u32 s99, 400000
    s_cbranch_scc1 mega_abort
    s_waitcnt vmcnt(0)
    v_cmp_gt_u32 vcc, 32, v12
    s_cbranch_vccz wt_13
    s_sleep 4
    s_branch ws_12
wt_13:
sw_11:
    s_barrier
    s_cmp_lg_u32 s6, 0
    s_cbranch_scc1 sw_14
    v_min_u32 v13, 0, v0
    v_lshlrev_b32 v13, 7, v13
    s_mov_b32 s98, 95072256
    s_mov_b32 s99, 0
ws_15:
    buffer_load_dword v12, v13, s[44:47], s98 offen sc1
    s_add_u32 s99, s99, 1
    s_cmp_ge_u32 s99, 400000
    s_cbranch_scc1 mega_abort
    s_waitcnt vmcnt(0)
    v_cmp_gt_u32 vcc, 16, v12
    s_cbranch_vccz wt_16
    s_sleep 4
    s_branch ws_15
wt_16:
sw_14:
    s_barrier
    s_mov_b32 s48, s16
    s_and_b32 s49, s17, 0xffff
    s_mov_b32 s50, 0x1c0000
    s_mov_b32 s51, 0x20000
    s_mov_b32 s52, s38
    s_and_b32 s53, s39, 0xffff
    s_mov_b32 s54, 0x1c0000
    s_mov_b32 s55, 0x20000
    v_add_u32 v16, 0, v1
    v_add_u32 v17, 4096, v1
    v_add_u32 v18, 8192, v1
    v_add_u32 v19, 12288, v1
    v_add_u32 v20, 16384, v1
    v_add_u32 v21, 20480, v1
    v_add_u32 v22, 24576, v1
    v_add_u32 v23, 28672, v1
    v_add_u32 v24, 32768, v1
    v_add_u32 v25, 36864, v1
    v_mul_u32_u24 v6, 896, v3
    v_lshl_add_u32 v6, v4, 3, v6
    s_lshl_b32 s65, s6, 5
    v_add_u32 v6, s65, v6
    v_add_u32 v7, 14336, v6
    s_mul_i32 s65, s6, 10240
    v_add_u32 v8, s65, v1
    s_mov_b32 s63, s7
f2_loop:
    s_mul_i32 s64, s63, 9363
    s_lshr_b32 s64, s64, 16
    s_mul_i32 s65, s64, 7
    s_sub_u32 s8, s63, s65
    s_lshl_b32 s9, s8, 2
    s_add_u32 s9, s9, s6
    s_lshl_b32 s68, s64, 7
    s_add_u32 s69, s68, 95014912
    s_mov_b32 s99, 0
wc_17:
    buffer_load_dword v12, v2, s[44:47], s69 offen sc1
    s_waitcnt vmcnt(0)
    v_readfirstlane_b32 s98, v12
    s_cmp_ge_u32 s98, 28
    s_cbranch_scc1 wd_18
    s_sleep 2
    s_add_u32 s99, s99, 1
    s_cmp_lt_u32 s99, 400000
    s_cbranch_scc1 wc_17
    s_mov_b32 s60, s40
    s_and_b32 s61, s41, 0xffff
    s_mov_b32 s62, 0x100
    s_mov_b32 s63, 0x20000
    v_mov_b32 v2, 0
    v_mov_b32 v5, 3735879687
    buffer_store_dword v5, v2, s[60:63], 0 offen offset:28
    s_endpgm
wd_18:
    s_mul_i32 s65, s64, 458752
    s_lshl_b32 s66, s9, 14
    s_add_u32 s65, s65, s66
    s_add_u32 s65, s65, 16515072
    buffer_load_dwordx4 a[0:3], v16, s[44:47], s65 offen offset:0 sc1
    buffer_load_dwordx4 a[4:7], v16, s[44:47], s65 offen offset:1024 sc1
    buffer_load_dwordx4 a[8:11], v16, s[44:47], s65 offen offset:2048 sc1
    buffer_load_dwordx4 a[12:15], v16, s[44:47], s65 offen offset:3072 sc1
    buffer_load_dwordx4 a[16:19], v17, s[44:47], s65 offen offset:0 sc1
    buffer_load_dwordx4 a[20:23], v17, s[44:47], s65 offen offset:1024 sc1
    buffer_load_dwordx4 a[24:27], v17, s[44:47], s65 offen offset:2048 sc1
    buffer_load_dwordx4 a[28:31], v17, s[44:47], s65 offen offset:3072 sc1
    buffer_load_dwordx4 a[32:35], v18, s[44:47], s65 offen offset:0 sc1
    buffer_load_dwordx4 a[36:39], v18, s[44:47], s65 offen offset:1024 sc1
    buffer_load_dwordx4 a[40:43], v18, s[44:47], s65 offen offset:2048 sc1
    buffer_load_dwordx4 a[44:47], v18, s[44:47], s65 offen offset:3072 sc1
    buffer_load_dwordx4 a[48:51], v19, s[44:47], s65 offen offset:0 sc1
    buffer_load_dwordx4 a[52:55], v19, s[44:47], s65 offen offset:1024 sc1
    buffer_load_dwordx4 a[56:59], v19, s[44:47], s65 offen offset:2048 sc1
    buffer_load_dwordx4 a[60:63], v19, s[44:47], s65 offen offset:3072 sc1
    s_mul_i32 s70, s64, 28672
    s_lshl_b32 s66, s8, 7
    s_add_u32 s70, s70, s66
    buffer_load_dwordx2 v[40:41], v6, s[48:51], s70 offen
    buffer_load_dwordx2 v[42:43], v7, s[48:51], s70 offen
    s_add_u32 s69, s68, 95039488
    s_mov_b32 s99, 0
wc_20:
    buffer_load_dword v12, v2, s[44:47], s69 offen sc1
    s_waitcnt vmcnt(0)
    v_readfirstlane_b32 s98, v12
    s_cmp_ge_u32 s98, 7
    s_cbranch_scc1 wd_21
    s_sleep 2
    s_add_u32 s99, s99, 1
    s_cmp_lt_u32 s99, 400000
    s_cbranch_scc1 wc_20
    s_mov_b32 s60, s40
    s_and_b32 s61, s41, 0xffff
    s_mov_b32 s62, 0x100
    s_mov_b32 s63, 0x20000
    v_mov_b32 v2, 0
    v_mov_b32 v5, 3735879688
    buffer_store_dword v5, v2, s[60:63], 0 offen offset:32
    s_endpgm
wd_21:
    s_add_u32 s71, s70, 82575360
    buffer_load_dwordx2 v[44:45], v6, s[44:47], s71 offen sc1
    buffer_load_dwordx2 v[46:47], v7, s[44:47], s71 offen sc1
    s_add_u32 s69, s68, 95064064
    s_mov_b32 s99, 0
wc_23:
    buffer_load_dword v12, v2, s[44:47], s69 offen sc1
    s_waitcnt vmcnt(0)
    v_readfirstlane_b32 s98, v12
    s_cmp_ge_u32 s98, 28
    s_cbranch_scc1 wd_24
    s_sleep 1
    s_add_u32 s99, s99, 1
    s_cmp_lt_u32 s99, 400000
    s_cbranch_scc1 wc_23
    s_mov_b32 s60, s40
    s_and_b32 s61, s41, 0xffff
    s_mov_b32 s62, 0x100
    s_mov_b32 s63, 0x20000
    v_mov_b32 v2, 0
    v_mov_b32 v5, 3735879689
    buffer_store_dword v5, v2, s[60:63], 0 offen offset:36
    s_endpgm
wd_24:
    s_mul_i32 s65, s64, 114688
    s_lshl_b32 s66, s9, 12
    s_add_u32 s65, s65, s66
    s_add_u32 s65, s65, 84410368
    buffer_load_dwordx4 a[64:67], v1, s[44:47], s65 offen offset:0 sc1
    buffer_load_dwordx4 a[68:71], v1, s[44:47], s65 offen offset:1024 sc1
    buffer_load_dwordx4 a[72:75], v1, s[44:47], s65 offen offset:2048 sc1
    buffer_load_dwordx4 a[76:79], v1, s[44:47], s65 offen offset:3072 sc1
    s_mul_i32 s65, s64, 40960
    s_mul_i32 s66, s6, 10240
    s_add_u32 s65, s65, s66
    s_add_u32 s65, s65, 92274688
    s_mov_b32 s99, 0
f2_pp:
    s_add_u32 m0, s66, 0
    s_nop 0
    buffer_load_dwordx4 v16, s[44:47], s65 offen offset:0 sc1 lds
    buffer_load_dwordx4 v16, s[44:47], s65 offen offset:1024 sc1 lds
    buffer_load_dwordx4 v16, s[44:47], s65 offen offset:2048 sc1 lds
    buffer_load_dwordx4 v16, s[44:47], s65 offen offset:3072 sc1 lds
    s_add_u32 m0, s66, 4096
    s_nop 0
    buffer_load_dwordx4 v17, s[44:47], s65 offen offset:1024 sc1 lds
    buffer_load_dwordx4 v17, s[44:47], s65 offen offset:3072 sc1 lds
    s_add_u32 m0, s66, 8192
    s_nop 0
    buffer_load_dwordx4 v18, s[44:47], s65 offen offset:0 sc1 lds
    buffer_load_dwordx4 v18, s[44:47], s65 offen offset:1024 sc1 lds
    s_add_u32 s99, s99, 1
    s_cmp_ge_u32 s99, 400000
    s_cbranch_scc1 mega_abort
    s_waitcnt vmcnt(0)
    ds_read_b128 v[64:67], v8 offset:0
    ds_read_b128 v[68:71], v8 offset:1024
    ds_read_b128 v[72:75], v8 offset:2048
    ds_read_b128 v[76:79], v8 offset:3072
    ds_read_b128 v[80:83], v8 offset:5120
    ds_read_b128 v[84:87], v8 offset:7168
    ds_read_b128 v[88:91], v8 offset:8192
    ds_read_b128 v[92:95], v8 offset:9216
    s_waitcnt lgkmcnt(0)
    v_max3_u32 v12, v64, v65, v66
    v_max3_u32 v12, v12, v67, v68
    v_max3_u32 v12, v12, v69, v70
    v_max3_u32 v12, v12, v71, v72
    v_max3_u32 v12, v12, v73, v74
    v_max3_u32 v12, v12, v75, v76
    v_max3_u32 v12, v12, v77, v78
    v_max3_u32 v12, v12, v79, v80
    v_max3_u32 v12, v12, v81, v82
    v_max3_u32 v12, v12, v83, v84
    v_max3_u32 v12, v12, v85, v86
    v_max3_u32 v12, v12, v87, v88
    v_max3_u32 v12, v12, v89, v90
    v_max3_u32 v12, v12, v91, v92
    v_max3_u32 v12, v12, v93, v94
    v_max_u32 v12, v12, v95
    v_cmp_eq_u32 vcc, -1, v12
    s_cbranch_vccnz f2_pp
    s_barrier
    ds_read_b128 v[64:67], v1 offset:0
    ds_read_b128 v[68:71], v1 offset:1024
    ds_read_b128 v[72:75], v1 offset:2048
    ds_read_b128 v[76:79], v1 offset:3072
    ds_read_b128 v[80:83], v1 offset:5120
    ds_read_b128 v[84:87], v1 offset:7168
    ds_read_b128 v[88:91], v1 offset:8192
    s_waitcnt lgkmcnt(6)
    v_mfma_f32_16x16x32_bf16 v[32:35], a[0:3], v[64:67], 0
    ds_read_b128 v[92:95], v1 offset:9216
    s_waitcnt lgkmcnt(6)
    v_mfma_f32_16x16x32_bf16 v[36:39], a[0:3], v[68:71], 0
    ds_read_b128 v[64:67], v1 offset:10240
    s_waitcnt lgkmcnt(6)
    v_mfma_f32_16x16x32_bf16 v[32:35], a[4:7], v[72:75], v[32:35]
    ds_read_b128 v[68:71], v1 offset:11264
    s_waitcnt lgkmcnt(6)
    v_mfma_f32_16x16x32_bf16 v[36:39], a[4:7], v[76:79], v[36:39]
    ds_read_b128 v[72:75], v1 offset:12288
    s_waitcnt lgkmcnt(6)
    v_mfma_f32_16x16x32_bf16 v[36:39], a[8:11], v[80:83], v[36:39]
    ds_read_b128 v[76:79], v1 offset:13312
    s_waitcnt lgkmcnt(6)
    v_mfma_f32_16x16x32_bf16 v[36:39], a[12:15], v[84:87], v[36:39]
    ds_read_b128 v[80:83], v1 offset:15360
    s_waitcnt lgkmcnt(6)
    v_mfma_f32_16x16x32_bf16 v[32:35], a[64:67], v[88:91], v[32:35]
    ds_read_b128 v[84:87], v1 offset:17408
    s_waitcnt lgkmcnt(6)
    v_mfma_f32_16x16x32_bf16 v[36:39], a[64:67], v[92:95], v[36:39]
    ds_read_b128 v[88:91], v1 offset:18432
    s_waitcnt lgkmcnt(6)
    v_mfma_f32_16x16x32_bf16 v[32:35], a[16:19], v[64:67], v[32:35]
    ds_read_b128 v[92:95], v1 offset:19456
    s_waitcnt lgkmcnt(6)
    v_mfma_f32_16x16x32_bf16 v[36:39], a[16:19], v[68:71], v[36:39]
    ds_read_b128 v[64:67], v1 offset:20480
    s_waitcnt lgkmcnt(6)
    v_mfma_f32_16x16x32_bf16 v[32:35], a[20:23], v[72:75], v[32:35]
    ds_read_b128 v[68:71], v1 offset:21504
    s_waitcnt lgkmcnt(6)
    v_mfma_f32_16x16x32_bf16 v[36:39], a[20:23], v[76:79], v[36:39]
    ds_read_b128 v[72:75], v1 offset:22528
    s_waitcnt lgkmcnt(6)
    v_mfma_f32_16x16x32_bf16 v[36:39], a[24:27], v[80:83], v[36:39]
    ds_read_b128 v[76:79], v1 offset:23552
    s_waitcnt lgkmcnt(6)
    v_mfma_f32_16x16x32_bf16 v[36:39], a[28:31], v[84:87], v[36:39]
    ds_read_b128 v[80:83], v1 offset:25600
    s_waitcnt lgkmcnt(6)
    v_mfma_f32_16x16x32_bf16 v[32:35], a[68:71], v[88:91], v[32:35]
    ds_read_b128 v[84:87], v1 offset:27648
    s_waitcnt lgkmcnt(6)
    v_mfma_f32_16x16x32_bf16 v[36:39], a[68:71], v[92:95], v[36:39]
    ds_read_b128 v[88:91], v1 offset:28672
    s_waitcnt lgkmcnt(6)
    v_mfma_f32_16x16x32_bf16 v[32:35], a[32:35], v[64:67], v[32:35]
    ds_read_b128 v[92:95], v1 offset:29696
    s_waitcnt lgkmcnt(6)
    v_mfma_f32_16x16x32_bf16 v[36:39], a[32:35], v[68:71], v[36:39]
    ds_read_b128 v[64:67], v1 offset:30720
    s_waitcnt lgkmcnt(6)
    v_mfma_f32_16x16x32_bf16 v[32:35], a[36:39], v[72:75], v[32:35]
    ds_read_b128 v[68:71], v1 offset:31744
    s_waitcnt lgkmcnt(6)
    v_mfma_f32_16x16x32_bf16 v[36:39], a[36:39], v[76:79], v[36:39]
    ds_read_b128 v[72:75], v1 offset:32768
    s_waitcnt lgkmcnt(6)
    v_mfma_f32_16x16x32_bf16 v[36:39], a[40:43], v[80:83], v[36:39]
    ds_read_b128 v[76:79], v1 offset:33792
    s_waitcnt lgkmcnt(6)
    v_mfma_f32_16x16x32_bf16 v[36:39], a[44:47], v[84:87], v[36:39]
    ds_read_b128 v[80:83], v1 offset:35840
    s_waitcnt lgkmcnt(6)
    v_mfma_f32_16x16x32_bf16 v[32:35], a[72:75], v[88:91], v[32:35]
    ds_read_b128 v[84:87], v1 offset:37888
    s_waitcnt lgkmcnt(6)
    v_mfma_f32_16x16x32_bf16 v[36:39], a[72:75], v[92:95], v[36:39]
    ds_read_b128 v[88:91], v1 offset:38912
    s_waitcnt lgkmcnt(6)
    v_mfma_f32_16x16x32_bf16 v[32:35], a[48:51], v[64:67], v[32:35]
    ds_read_b128 v[92:95], v1 offset:39936
    s_waitcnt lgkmcnt(6)
    v_mfma_f32_16x16x32_bf16 v[36:39], a[48:51], v[68:71], v[36:39]
    s_waitcnt lgkmcnt(5)
    v_mfma_f32_16x16x32_bf16 v[32:35], a[52:55], v[72:75], v[32:35]
    s_waitcnt lgkmcnt(4)
    v_mfma_f32_16x16x32_bf16 v[36:39], a[52:55], v[76:79], v[36:39]
    s_waitcnt lgkmcnt(3)
    v_mfma_f32_16x16x32_bf16 v[36:39], a[56:59], v[80:83], v[36:39]
    s_waitcnt lgkmcnt(2)
    v_mfma_f32_16x16x32_bf16 v[36:39], a[60:63], v[84:87], v[36:39]
    s_waitcnt lgkmcnt(1)
    v_mfma_f32_16x16x32_bf16 v[32:35], a[76:79], v[88:91], v[32:35]
    s_waitcnt lgkmcnt(0)
    v_mfma_f32_16x16x32_bf16 v[36:39], a[76:79], v[92:95], v[36:39]
    s_barrier
    s_nop 4
    v_cvt_pk_bf16_f32 v48, v32, v33
    v_lshlrev_b32 v32, 16, v48
    v_and_b32 v33, 0xffff0000, v48
    v_lshlrev_b32 v49, 16, v44
    v_and_b32 v50, 0xffff0000, v44
    v_mul_f32 v32, v32, v49
    v_mul_f32 v33, v33, v50
    v_cvt_pk_bf16_f32 v48, v32, v33
    v_lshlrev_b32 v32, 16, v48
    v_and_b32 v33, 0xffff0000, v48
    v_lshlrev_b32 v49, 16, v40
    v_and_b32 v50, 0xffff0000, v40
    v_add_f32 v32, v32, v49
    v_add_f32 v33, v33, v50
    v_cvt_pk_bf16_f32 v52, v32, v33
    v_cvt_pk_bf16_f32 v48, v34, v35
    v_lshlrev_b32 v34, 16, v48
    v_and_b32 v35, 0xffff0000, v48
    v_lshlrev_b32 v49, 16, v45
    v_and_b32 v50, 0xffff0000, v45
    v_mul_f32 v34, v34, v49
    v_mul_f32 v35, v35, v50
    v_cvt_pk_bf16_f32 v48, v34, v35
    v_lshlrev_b32 v34, 16, v48
    v_and_b32 v35, 0xffff0000, v48
    v_lshlrev_b32 v49, 16, v41
    v_and_b32 v50, 0xffff0000, v41
    v_add_f32 v34, v34, v49
    v_add_f32 v35, v35, v50
    v_cvt_pk_bf16_f32 v53, v34, v35
    buffer_store_dwordx2 v[52:53], v6, s[52:55], s70 offen
    v_cvt_pk_bf16_f32 v48, v36, v37
    v_lshlrev_b32 v36, 16, v48
    v_and_b32 v37, 0xffff0000, v48
    v_lshlrev_b32 v49, 16, v46
    v_and_b32 v50, 0xffff0000, v46
    v_mul_f32 v36, v36, v49
    v_mul_f32 v37, v37, v50
    v_cvt_pk_bf16_f32 v48, v36, v37
    v_lshlrev_b32 v36, 16, v48
    v_and_b32 v37, 0xffff0000, v48
    v_lshlrev_b32 v49, 16, v42
    v_and_b32 v50, 0xffff0000, v42
    v_add_f32 v36, v36, v49
    v_add_f32 v37, v37, v50
    v_cvt_pk_bf16_f32 v54, v36, v37
    v_cvt_pk_bf16_f32 v48, v38, v39
    v_lshlrev_b32 v38, 16, v48
    v_and_b32 v39, 0xffff0000, v48
    v_lshlrev_b32 v49, 16, v47
    v_and_b32 v50, 0xffff0000, v47
    v_mul_f32 v38, v38, v49
    v_mul_f32 v39, v39, v50
    v_cvt_pk_bf16_f32 v48, v38, v39
    v_lshlrev_b32 v38, 16, v48
    v_and_b32 v39, 0xffff0000, v48
    v_lshlrev_b32 v49, 16, v43
    v_and_b32 v50, 0xffff0000, v43
    v_add_f32 v38, v38, v49
    v_add_f32 v39, v39, v50
    v_cvt_pk_bf16_f32 v55, v38, v39
    buffer_store_dwordx2 v[54:55], v7, s[52:55], s70 offen
    s_add_u32 s63, s63, 40
    s_cmp_lt_u32 s63, 448
    s_cbranch_scc1 f2_loop
    s_waitcnt vmcnt(0)
    s_endpgm
role_vx:
    s_sub_u32 s7, s7, 32
    s_cmp_lg_u32 s6, 0
    s_cbranch_scc1 sw_26
    v_min_u32 v13, 7, v0
    v_lshlrev_b32 v13, 7, v13
    s_mov_b32 s98, 95072768
    s_mov_b32 s99, 0
ws_27:
    buffer_load_dword v12, v13, s[44:47], s98 offen sc1
    s_add_u32 s99, s99, 1
    s_cmp_ge_u32 s99, 400000
    s_cbranch_scc1 mega_abort
    s_waitcnt vmcnt(0)
    v_cmp_gt_u32 vcc, 32, v12
    s_cbranch_vccz wt_28
    s_sleep 4
    s_branch ws_27
wt_28:
    buffer_inv sc1
sw_26:
    s_barrier
    s_cmp_ge_u32 s7, 28
    s_cselect_b32 s8, 1, 0
    s_mul_i32 s66, s8, 28
    s_sub_u32 s66, s7, s66
    s_lshl_b32 s65, s66, 4
    s_lshl_b32 s66, s6, 2
    s_add_u32 s65, s65, s66
    s_mul_i32 s8, s8, 3
    s_mov_b32 s9, 2
    s_mov_b32 s10, 0
    s_mov_b32 s11, 28672
    s_lshl_b32 s12, s65, 10
    s_add_u32 s12, s12, 16515072
    s_mov_b32 s13, 458752
    s_mov_b32 s14, 95014912
    s_waitcnt vmcnt(0)
    s_barrier
    s_mov_b32 s62, s65
    s_mov_b32 s64, s8
    s_mul_i32 s71, s6, 7168
    s_add_u32 s10, s10, s71
    s_add_u32 s73, s71, 86016
    s_mov_b32 s72, 0
    s_min_u32 s65, s64, 63
    s_mul_i32 s65, s65, s11
    s_add_u32 s65, s65, s10
    s_add_u32 s69, s65, 0
    s_add_u32 m0, s71, 0
    s_nop 0
    buffer_load_dwordx4 v1, s[44:47], s69 offen offset:0 lds
    buffer_load_dwordx4 v1, s[44:47], s69 offen offset:1024 lds
    buffer_load_dwordx4 v1, s[44:47], s69 offen offset:2048 lds
    buffer_load_dwordx4 v1, s[44:47], s69 offen offset:3072 lds
    s_add_u32 s69, s65, 4096
    s_add_u32 m0, s71, 4096
    s_nop 0
    buffer_load_dwordx4 v1, s[44:47], s69 offen offset:0 lds
    buffer_load_dwordx4 v1, s[44:47], s69 offen offset:1024 lds
    buffer_load_dwordx4 v1, s[44:47], s69 offen offset:2048 lds
    s_add_u32 s71, s71, 28672
    s_cmp_ge_u32 s71, s73
    s_cselect_b32 s69, 86016, 0
    s_sub_u32 s71, s71, s69
    s_cmp_lt_u32 s64, 2
    s_cselect_b32 s69, 1, 2
    s_add_u32 s70, s64, s69
    s_min_u32 s65, s70, 63
    s_mul_i32 s65, s65, s11
    s_add_u32 s65, s65, s10
    s_add_u32 s69, s65, 0
    s_add_u32 m0, s71, 0
    s_nop 0
    buffer_load_dwordx4 v1, s[44:47], s69 offen offset:0 lds
    buffer_load_dwordx4 v1, s[44:47], s69 offen offset:1024 lds
    buffer_load_dwordx4 v1, s[44:47], s69 offen offset:2048 lds
    buffer_load_dwordx4 v1, s[44:47], s69 offen offset:3072 lds
    s_add_u32 s69, s65, 4096
    s_add_u32 m0, s71, 4096
    s_nop 0
    buffer_load_dwordx4 v1, s[44:47], s69 offen offset:0 lds
    buffer_load_dwordx4 v1, s[44:47], s69 offen offset:1024 lds
    buffer_load_dwordx4 v1, s[44:47], s69 offen offset:2048 lds
    s_add_u32 s71, s71, 28672
    s_cmp_ge_u32 s71, s73
    s_cselect_b32 s69, 86016, 0
    s_sub_u32 s71, s71, s69
    s_mov_b32 s67, -1
    s_waitcnt vmcnt(7)
    s_mul_i32 s74, s62, 14336
    s_add_u32 s74, s74, 10092544
    buffer_load_dwordx4 a[0:3], v1, s[44:47], s74 offen offset:0 sc1
    buffer_load_dwordx4 a[4:7], v1, s[44:47], s74 offen offset:1024 sc1
    buffer_load_dwordx4 a[8:11], v1, s[44:47], s74 offen offset:2048 sc1
    buffer_load_dwordx4 a[12:15], v1, s[44:47], s74 offen offset:3072 sc1
    s_add_u32 s74, s74, 4096
    buffer_load_dwordx4 a[16:19], v1, s[44:47], s74 offen offset:0 sc1
    buffer_load_dwordx4 a[20:23], v1, s[44:47], s74 offen offset:1024 sc1
    buffer_load_dwordx4 a[24:27], v1, s[44:47], s74 offen offset:2048 sc1
    buffer_load_dwordx4 a[28:31], v1, s[44:47], s74 offen offset:3072 sc1
    s_add_u32 s74, s74, 4096
    buffer_load_dwordx4 a[32:35], v1, s[44:47], s74 offen offset:0 sc1
    buffer_load_dwordx4 a[36:39], v1, s[44:47], s74 offen offset:1024 sc1
    buffer_load_dwordx4 a[40:43], v1, s[44:47], s74 offen offset:2048 sc1
    buffer_load_dwordx4 a[44:47], v1, s[44:47], s74 offen offset:3072 sc1
    s_add_u32 s74, s74, 4096
    buffer_load_dwordx4 a[48:51], v1, s[44:47], s74 offen offset:0 sc1
    buffer_load_dwordx4 a[52:55], v1, s[44:47], s74 offen offset:1024 sc1
    buffer_load_dwordx4 a[56:59], v1, s[44:47], s74 offen offset:2048 sc1
    buffer_load_dwordx4 a[60:63], v1, s[44:47], s74 offen offset:3072 sc1
    s_add_u32 s74, s74, 4096
    buffer_load_dwordx4 a[64:67], v1, s[44:47], s74 offen offset:0 sc1
    buffer_load_dwordx4 a[68:71], v1, s[44:47], s74 offen offset:1024 sc1
    buffer_load_dwordx4 a[72:75], v1, s[44:47], s74 offen offset:2048 sc1
    buffer_load_dwordx4 a[76:79], v1, s[44:47], s74 offen offset:3072 sc1
    s_add_u32 s74, s74, 4096
    buffer_load_dwordx4 a[80:83], v1, s[44:47], s74 offen offset:0 sc1
    buffer_load_dwordx4 a[84:87], v1, s[44:47], s74 offen offset:1024 sc1
    buffer_load_dwordx4 a[88:91], v1, s[44:47], s74 offen offset:2048 sc1
    buffer_load_dwordx4 a[92:95], v1, s[44:47], s74 offen offset:3072 sc1
    s_add_u32 s74, s74, 4096
    buffer_load_dwordx4 a[96:99], v1, s[44:47], s74 offen offset:0 sc1
    buffer_load_dwordx4 a[100:103], v1, s[44:47], s74 offen offset:1024 sc1
    buffer_load_dwordx4 a[104:107], v1, s[44:47], s74 offen offset:2048 sc1
    buffer_load_dwordx4 a[108:111], v1, s[44:47], s74 offen offset:3072 sc1
    s_add_u32 s74, s74, 4096
    buffer_load_dwordx4 a[112:115], v1, s[44:47], s74 offen offset:0 sc1
    buffer_load_dwordx4 a[116:119], v1, s[44:47], s74 offen offset:1024 sc1
    buffer_load_dwordx4 a[120:123], v1, s[44:47], s74 offen offset:2048 sc1
    buffer_load_dwordx4 a[124:127], v1, s[44:47], s74 offen offset:3072 sc1
    s_add_u32 s74, s74, 4096
    buffer_load_dwordx4 a[128:131], v1, s[44:47], s74 offen offset:0 sc1
    buffer_load_dwordx4 a[132:135], v1, s[44:47], s74 offen offset:1024 sc1
    buffer_load_dwordx4 a[136:139], v1, s[44:47], s74 offen offset:2048 sc1
    buffer_load_dwordx4 a[140:143], v1, s[44:47], s74 offen offset:3072 sc1
    s_add_u32 s74, s74, 4096
    buffer_load_dwordx4 a[144:147], v1, s[44:47], s74 offen offset:0 sc1
    buffer_load_dwordx4 a[148:151], v1, s[44:47], s74 offen offset:1024 sc1
    buffer_load_dwordx4 a[152:155], v1, s[44:47], s74 offen offset:2048 sc1
    buffer_load_dwordx4 a[156:159], v1, s[44:47], s74 offen offset:3072 sc1
    s_add_u32 s74, s74, 4096
    buffer_load_dwordx4 a[160:163], v1, s[44:47], s74 offen offset:0 sc1
    buffer_load_dwordx4 a[164:167], v1, s[44:47], s74 offen offset:1024 sc1
    buffer_load_dwordx4 a[168:171], v1, s[44:47], s74 offen offset:2048 sc1
    buffer_load_dwordx4 a[172:175], v1, s[44:47], s74 offen offset:3072 sc1
    s_add_u32 s74, s74, 4096
    buffer_load_dwordx4 a[176:179], v1, s[44:47], s74 offen offset:0 sc1
    buffer_load_dwordx4 a[180:183], v1, s[44:47], s74 offen offset:1024 sc1
    buffer_load_dwordx4 a[184:187], v1, s[44:47], s74 offen offset:2048 sc1
    buffer_load_dwordx4 a[188:191], v1, s[44:47], s74 offen offset:3072 sc1
    s_add_u32 s74, s74, 4096
    buffer_load_dwordx4 a[192:195], v1, s[44:47], s74 offen offset:0 sc1
    buffer_load_dwordx4 a[196:199], v1, s[44:47], s74 offen offset:1024 sc1
    buffer_load_dwordx4 a[200:203], v1, s[44:47], s74 offen offset:2048 sc1
    buffer_load_dwordx4 a[204:207], v1, s[44:47], s74 offen offset:3072 sc1
    s_add_u32 s74, s74, 4096
    buffer_load_dwordx4 a[208:211], v1, s[44:47], s74 offen offset:0 sc1
    buffer_load_dwordx4 a[212:215], v1, s[44:47], s74 offen offset:1024 sc1
    buffer_load_dwordx4 a[216:219], v1, s[44:47], s74 offen offset:2048 sc1
    buffer_load_dwordx4 a[220:223], v1, s[44:47], s74 offen offset:3072 sc1
    s_add_u32 s74, s74, 4096
    s_waitcnt vmcnt(0)
    s_waitcnt vmcnt(7)
eng_vx_loop:
    s_cmp_lt_u32 s64, 2
    s_cselect_b32 s69, 1, 2
    s_add_u32 s68, s64, s69
    v_add_u32 v16, s72, v1
    s_barrier
    ds_read_b128 v[128:131], v16 offset:0
    ds_read_b128 v[132:135], v16 offset:14336
    ds_read_b128 v[136:139], v16 offset:1024
    ds_read_b128 v[140:143], v16 offset:15360
    ds_read_b128 v[144:147], v16 offset:2048
    s_cmp_lt_u32 s68, 2
    s_cselect_b32 s69, 1, 2
    s_add_u32 s70, s68, s69
    s_min_u32 s65, s70, 63
    s_mul_i32 s65, s65, s11
    s_add_u32 s65, s65, s10
    s_add_u32 s72, s72, 28672
    s_cmp_ge_u32 s72, 86016
    s_cselect_b32 s72, 0, s72
    s_mul_i32 s66, s64, s13
    s_add_u32 s66, s66, s12
    s_waitcnt lgkmcnt(4)
    v_mfma_f32_16x16x32_bf16 v[64:67], v[128:131], a[0:3], 0
    ds_read_b128 v[148:151], v16 offset:16384
    v_mfma_f32_16x16x32_bf16 v[68:71], v[128:131], a[56:59], 0
    v_mfma_f32_16x16x32_bf16 v[72:75], v[128:131], a[112:115], 0
    s_add_u32 s69, s65, 0
    s_add_u32 m0, s71, 0
    s_nop 0
    buffer_load_dwordx4 v1, s[44:47], s69 offen offset:0 lds
    v_mfma_f32_16x16x32_bf16 v[76:79], v[128:131], a[168:171], 0
    s_waitcnt lgkmcnt(4)
    v_mfma_f32_16x16x32_bf16 v[80:83], v[132:135], a[0:3], 0
    ds_read_b128 v[128:131], v16 offset:3072
    v_mfma_f32_16x16x32_bf16 v[84:87], v[132:135], a[56:59], 0
    v_mfma_f32_16x16x32_bf16 v[88:91], v[132:135], a[112:115], 0
    buffer_load_dwordx4 v1, s[44:47], s69 offen offset:1024 lds
    v_mfma_f32_16x16x32_bf16 v[92:95], v[132:135], a[168:171], 0
    s_waitcnt lgkmcnt(4)
    v_mfma_f32_16x16x32_bf16 v[64:67], v[136:139], a[4:7], v[64:67]
    ds_read_b128 v[132:135], v16 offset:17408
    v_mfma_f32_16x16x32_bf16 v[68:71], v[136:139], a[60:63], v[68:71]
    v_mfma_f32_16x16x32_bf16 v[72:75], v[136:139], a[116:119], v[72:75]
    buffer_load_dwordx4 v1, s[44:47], s69 offen offset:2048 lds
    v_mfma_f32_16x16x32_bf16 v[76:79], v[136:139], a[172:175], v[76:79]
    s_waitcnt lgkmcnt(4)
    v_mfma_f32_16x16x32_bf16 v[80:83], v[140:143], a[4:7], v[80:83]
    ds_read_b128 v[136:139], v16 offset:4096
    v_mfma_f32_16x16x32_bf16 v[84:87], v[140:143], a[60:63], v[84:87]
    v_mfma_f32_16x16x32_bf16 v[88:91], v[140:143], a[116:119], v[88:91]
    buffer_load_dwordx4 v1, s[44:47], s69 offen offset:3072 lds
    v_mfma_f32_16x16x32_bf16 v[92:95], v[140:143], a[172:175], v[92:95]
    s_waitcnt lgkmcnt(4)
    v_mfma_f32_16x16x32_bf16 v[64:67], v[144:147], a[8:11], v[64:67]
    ds_read_b128 v[140:143], v16 offset:18432
    v_mfma_f32_16x16x32_bf16 v[68:71], v[144:147], a[64:67], v[68:71]
    v_mfma_f32_16x16x32_bf16 v[72:75], v[144:147], a[120:123], v[72:75]
    s_add_u32 s69, s65, 4096
    s_add_u32 m0, s71, 4096
    s_nop 0
    buffer_load_dwordx4 v1, s[44:47], s69 offen offset:0 lds
    v_mfma_f32_16x16x32_bf16 v[76:79], v[144:147], a[176:179], v[76:79]
    s_waitcnt lgkmcnt(4)
    v_mfma_f32_16x16x32_bf16 v[80:83], v[148:151], a[8:11], v[80:83]
    ds_read_b128 v[144:147], v16 offset:5120
    v_mfma_f32_16x16x32_bf16 v[84:87], v[148:151], a[64:67], v[84:87]
    v_mfma_f32_16x16x32_bf16 v[88:91], v[148:151], a[120:123], v[88:91]
    buffer_load_dwordx4 v1, s[44:47], s69 offen offset:1024 lds
    v_mfma_f32_16x16x32_bf16 v[92:95], v[148:151], a[176:179], v[92:95]
    s_waitcnt lgkmcnt(4)
    v_mfma_f32_16x16x32_bf16 v[64:67], v[128:131], a[12:15], v[64:67]
    ds_read_b128 v[148:151], v16 offset:19456
    v_mfma_f32_16x16x32_bf16 v[68:71], v[128:131], a[68:71], v[68:71]
    v_mfma_f32_16x16x32_bf16 v[72:75], v[128:131], a[124:127], v[72:75]
    buffer_load_dwordx4 v1, s[44:47], s69 offen offset:2048 lds
    v_mfma_f32_16x16x32_bf16 v[76:79], v[128:131], a[180:183], v[76:79]
    s_waitcnt lgkmcnt(4)
    v_mfma_f32_16x16x32_bf16 v[80:83], v[132:135], a[12:15], v[80:83]
    ds_read_b128 v[128:131], v16 offset:6144
    v_mfma_f32_16x16x32_bf16 v[84:87], v[132:135], a[68:71], v[84:87]
    v_mfma_f32_16x16x32_bf16 v[88:91], v[132:135], a[124:127], v[88:91]
    v_mfma_f32_16x16x32_bf16 v[92:95], v[132:135], a[180:183], v[92:95]
    s_add_u32 s71, s71, 28672
    s_cmp_ge_u32 s71, s73
    s_cselect_b32 s69, 86016, 0
    s_sub_u32 s71, s71, s69
    s_waitcnt lgkmcnt(4)
    v_mfma_f32_16x16x32_bf16 v[64:67], v[136:139], a[16:19], v[64:67]
    ds_read_b128 v[132:135], v16 offset:20480
    v_mfma_f32_16x16x32_bf16 v[68:71], v[136:139], a[72:75], v[68:71]
    v_mfma_f32_16x16x32_bf16 v[72:75], v[136:139], a[128:131], v[72:75]
    v_mfma_f32_16x16x32_bf16 v[76:79], v[136:139], a[184:187], v[76:79]
    s_waitcnt lgkmcnt(4)
    v_mfma_f32_16x16x32_bf16 v[80:83], v[140:143], a[16:19], v[80:83]
    ds_read_b128 v[136:139], v16 offset:7168
    v_mfma_f32_16x16x32_bf16 v[84:87], v[140:143], a[72:75], v[84:87]
    v_mfma_f32_16x16x32_bf16 v[88:91], v[140:143], a[128:131], v[88:91]
    v_mfma_f32_16x16x32_bf16 v[92:95], v[140:143], a[184:187], v[92:95]
    s_waitcnt lgkmcnt(4)
    v_mfma_f32_16x16x32_bf16 v[64:67], v[144:147], a[20:23], v[64:67]
    ds_read_b128 v[140:143], v16 offset:21504
    v_mfma_f32_16x16x32_bf16 v[68:71], v[144:147], a[76:79], v[68:71]
    v_mfma_f32_16x16x32_bf16 v[72:75], v[144:147], a[132:135], v[72:75]
    v_mfma_f32_16x16x32_bf16 v[76:79], v[144:147], a[188:191], v[76:79]
    s_waitcnt lgkmcnt(4)
    v_mfma_f32_16x16x32_bf16 v[80:83], v[148:151], a[20:23], v[80:83]
    ds_read_b128 v[144:147], v16 offset:8192
    v_mfma_f32_16x16x32_bf16 v[84:87], v[148:151], a[76:79], v[84:87]
    v_mfma_f32_16x16x32_bf16 v[88:91], v[148:151], a[132:135], v[88:91]
    v_mfma_f32_16x16x32_bf16 v[92:95], v[148:151], a[188:191], v[92:95]
    s_waitcnt vmcnt(7)
    s_barrier
    s_cmp_eq_u32 s67, -1
    s_cbranch_scc1 ns_29
    s_cmp_lg_u32 s6, 0
    s_cbranch_scc1 sg_30
    s_mov_b64 exec, 1
    v_mov_b32 v13, 1
    buffer_atomic_add v13, v2, s[44:47], s67 offen sc1
    s_mov_b64 exec, -1
sg_30:
ns_29:
    s_waitcnt lgkmcnt(4)
    v_mfma_f32_16x16x32_bf16 v[64:67], v[128:131], a[24:27], v[64:67]
    ds_read_b128 v[148:151], v16 offset:22528
    v_mfma_f32_16x16x32_bf16 v[68:71], v[128:131], a[80:83], v[68:71]
    v_mfma_f32_16x16x32_bf16 v[72:75], v[128:131], a[136:139], v[72:75]
    v_mfma_f32_16x16x32_bf16 v[76:79], v[128:131], a[192:195], v[76:79]
    s_waitcnt lgkmcnt(4)
    v_mfma_f32_16x16x32_bf16 v[80:83], v[132:135], a[24:27], v[80:83]
    ds_read_b128 v[128:131], v16 offset:9216
    v_mfma_f32_16x16x32_bf16 v[84:87], v[132:135], a[80:83], v[84:87]
    v_mfma_f32_16x16x32_bf16 v[88:91], v[132:135], a[136:139], v[88:91]
    v_mfma_f32_16x16x32_bf16 v[92:95], v[132:135], a[192:195], v[92:95]
    s_waitcnt lgkmcnt(4)
    v_mfma_f32_16x16x32_bf16 v[64:67], v[136:139], a[28:31], v[64:67]
    ds_read_b128 v[132:135], v16 offset:23552
    v_mfma_f32_16x16x32_bf16 v[68:71], v[136:139], a[84:87], v[68:71]
    v_mfma_f32_16x16x32_bf16 v[72:75], v[136:139], a[140:143], v[72:75]
    v_mfma_f32_16x16x32_bf16 v[76:79], v[136:139], a[196:199], v[76:79]
    s_waitcnt lgkmcnt(4)
    v_mfma_f32_16x16x32_bf16 v[80:83], v[140:143], a[28:31], v[80:83]
    ds_read_b128 v[136:139], v16 offset:10240
    v_mfma_f32_16x16x32_bf16 v[84:87], v[140:143], a[84:87], v[84:87]
    v_mfma_f32_16x16x32_bf16 v[88:91], v[140:143], a[140:143], v[88:91]
    v_mfma_f32_16x16x32_bf16 v[92:95], v[140:143], a[196:199], v[92:95]
    s_waitcnt lgkmcnt(4)
    v_mfma_f32_16x16x32_bf16 v[64:67], v[144:147], a[32:35], v[64:67]
    ds_read_b128 v[140:143], v16 offset:24576
    v_mfma_f32_16x16x32_bf16 v[68:71], v[144:147], a[88:91], v[68:71]
    v_mfma_f32_16x16x32_bf16 v[72:75], v[144:147], a[144:147], v[72:75]
    v_mfma_f32_16x16x32_bf16 v[76:79], v[144:147], a[200:203], v[76:79]
    s_waitcnt lgkmcnt(4)
    v_mfma_f32_16x16x32_bf16 v[80:83], v[148:151], a[32:35], v[80:83]
    ds_read_b128 v[144:147], v16 offset:11264
    v_mfma_f32_16x16x32_bf16 v[84:87], v[148:151], a[88:91], v[84:87]
    v_mfma_f32_16x16x32_bf16 v[88:91], v[148:151], a[144:147], v[88:91]
    v_mfma_f32_16x16x32_bf16 v[92:95], v[148:151], a[200:203], v[92:95]
    s_waitcnt lgkmcnt(4)
    v_mfma_f32_16x16x32_bf16 v[64:67], v[128:131], a[36:39], v[64:67]
    ds_read_b128 v[148:151], v16 offset:25600
    v_mfma_f32_16x16x32_bf16 v[68:71], v[128:131], a[92:95], v[68:71]
    v_mfma_f32_16x16x32_bf16 v[72:75], v[128:131], a[148:151], v[72:75]
    v_mfma_f32_16x16x32_bf16 v[76:79], v[128:131], a[204:207], v[76:79]
    s_waitcnt lgkmcnt(4)
    v_mfma_f32_16x16x32_bf16 v[80:83], v[132:135], a[36:39], v[80:83]
    ds_read_b128 v[128:131], v16 offset:12288
    v_mfma_f32_16x16x32_bf16 v[84:87], v[132:135], a[92:95], v[84:87]
    v_mfma_f32_16x16x32_bf16 v[88:91], v[132:135], a[148:151], v[88:91]
    v_mfma_f32_16x16x32_bf16 v[92:95], v[132:135], a[204:207], v[92:95]
    s_waitcnt lgkmcnt(4)
    v_mfma_f32_16x16x32_bf16 v[64:67], v[136:139], a[40:43], v[64:67]
    ds_read_b128 v[132:135], v16 offset:26624
    v_mfma_f32_16x16x32_bf16 v[68:71], v[136:139], a[96:99], v[68:71]
    v_mfma_f32_16x16x32_bf16 v[72:75], v[136:139], a[152:155], v[72:75]
    v_mfma_f32_16x16x32_bf16 v[76:79], v[136:139], a[208:211], v[76:79]
    s_waitcnt lgkmcnt(4)
    v_mfma_f32_16x16x32_bf16 v[80:83], v[140:143], a[40:43], v[80:83]
    ds_read_b128 v[136:139], v16 offset:13312
    v_mfma_f32_16x16x32_bf16 v[84:87], v[140:143], a[96:99], v[84:87]
    v_mfma_f32_16x16x32_bf16 v[88:91], v[140:143], a[152:155], v[88:91]
    v_mfma_f32_16x16x32_bf16 v[92:95], v[140:143], a[208:211], v[92:95]
    s_waitcnt lgkmcnt(4)
    v_mfma_f32_16x16x32_bf16 v[64:67], v[144:147], a[44:47], v[64:67]
    ds_read_b128 v[140:143], v16 offset:27648
    v_mfma_f32_16x16x32_bf16 v[68:71], v[144:147], a[100:103], v[68:71]
    v_mfma_f32_16x16x32_bf16 v[72:75], v[144:147], a[156:159], v[72:75]
    v_mfma_f32_16x16x32_bf16 v[76:79], v[144:147], a[212:215], v[76:79]
    s_waitcnt lgkmcnt(4)
    v_mfma_f32_16x16x32_bf16 v[80:83], v[148:151], a[44:47], v[80:83]
    v_mfma_f32_16x16x32_bf16 v[84:87], v[148:151], a[100:103], v[84:87]
    v_mfma_f32_16x16x32_bf16 v[88:91], v[148:151], a[156:159], v[88:91]
    v_mfma_f32_16x16x32_bf16 v[92:95], v[148:151], a[212:215], v[92:95]
    s_waitcnt lgkmcnt(3)
    v_mfma_f32_16x16x32_bf16 v[64:67], v[128:131], a[48:51], v[64:67]
    v_mfma_f32_16x16x32_bf16 v[68:71], v[128:131], a[104:107], v[68:71]
    v_mfma_f32_16x16x32_bf16 v[72:75], v[128:131], a[160:163], v[72:75]
    v_mfma_f32_16x16x32_bf16 v[76:79], v[128:131], a[216:219], v[76:79]
    s_waitcnt lgkmcnt(2)
    v_mfma_f32_16x16x32_bf16 v[80:83], v[132:135], a[48:51], v[80:83]
    v_mfma_f32_16x16x32_bf16 v[84:87], v[132:135], a[104:107], v[84:87]
    v_mfma_f32_16x16x32_bf16 v[88:91], v[132:135], a[160:163], v[88:91]
    v_mfma_f32_16x16x32_bf16 v[92:95], v[132:135], a[216:219], v[92:95]
    s_waitcnt lgkmcnt(1)
    v_mfma_f32_16x16x32_bf16 v[64:67], v[136:139], a[52:55], v[64:67]
    v_mfma_f32_16x16x32_bf16 v[68:71], v[136:139], a[108:111], v[68:71]
    v_mfma_f32_16x16x32_bf16 v[72:75], v[136:139], a[164:167], v[72:75]
    v_mfma_f32_16x16x32_bf16 v[76:79], v[136:139], a[220:223], v[76:79]
    s_waitcnt lgkmcnt(0)
    v_mfma_f32_16x16x32_bf16 v[80:83], v[140:143], a[52:55], v[80:83]
    v_mfma_f32_16x16x32_bf16 v[84:87], v[140:143], a[108:111], v[84:87]
    v_mfma_f32_16x16x32_bf16 v[88:91], v[140:143], a[164:167], v[88:91]
    v_mfma_f32_16x16x32_bf16 v[92:95], v[140:143], a[220:223], v[92:95]
    v_cvt_pk_bf16_f32 v96, v64, v65
    v_cvt_pk_bf16_f32 v97, v68, v69
    v_cvt_pk_bf16_f32 v98, v66, v67
    v_cvt_pk_bf16_f32 v99, v70, v71
    buffer_store_dwordx4 v[96:99], v1, s[44:47], s66 offen offset:0 sc1
    v_cvt_pk_bf16_f32 v100, v72, v73
    v_cvt_pk_bf16_f32 v101, v76, v77
    v_cvt_pk_bf16_f32 v102, v74, v75
    v_cvt_pk_bf16_f32 v103, v78, v79
    buffer_store_dwordx4 v[100:103], v1, s[44:47], s66 offen offset:1024 sc1
    v_cvt_pk_bf16_f32 v104, v80, v81
    v_cvt_pk_bf16_f32 v105, v84, v85
    v_cvt_pk_bf16_f32 v106, v82, v83
    v_cvt_pk_bf16_f32 v107, v86, v87
    buffer_store_dwordx4 v[104:107], v1, s[44:47], s66 offen offset:2048 sc1
    v_cvt_pk_bf16_f32 v108, v88, v89
    v_cvt_pk_bf16_f32 v109, v92, v93
    v_cvt_pk_bf16_f32 v110, v90, v91
    v_cvt_pk_bf16_f32 v111, v94, v95
    buffer_store_dwordx4 v[108:111], v1, s[44:47], s66 offen offset:3072 sc1
    s_lshl_b32 s67, s64, 7
    s_add_u32 s67, s67, s14
    s_mov_b32 s75, s66
    s_mov_b32 s64, s68
    s_cmp_lt_u32 s64, 64
    s_cbranch_scc1 eng_vx_loop
    s_waitcnt vmcnt(0)
    s_barrier
    s_cmp_lg_u32 s6, 0
    s_cbranch_scc1 sg_31
    s_mov_b64 exec, 1
    v_mov_b32 v13, 1
    buffer_atomic_add v13, v2, s[44:47], s67 offen sc1
    s_mov_b64 exec, -1
sg_31:
    v_bfe_u32 v5, v3, 1, 1
    v_mul_u32_u24 v5, 0xaaaa, v5
    v_add_u32 v5, 0x4444, v5
    v_mov_b32 v16, v1
    v_add_u32 v17, 4096, v1
    s_lshl_b32 s12, s62, 8
    s_add_u32 s12, s12, 84410368
    s_and_b32 s64, s8, 1
u_loop:
    v_mov_b32 v64, 0
    v_mov_b32 v65, 0
    v_mov_b32 v66, 0
    v_mov_b32 v67, 0
    v_mov_b32 v68, 0
    v_mov_b32 v69, 0
    v_mov_b32 v70, 0
    v_mov_b32 v71, 0
    v_mov_b32 v72, 0
    v_mov_b32 v73, 0
    v_mov_b32 v74, 0
    v_mov_b32 v75, 0
    v_mov_b32 v76, 0
    v_mov_b32 v77, 0
    v_mov_b32 v78, 0
    v_mov_b32 v79, 0
    s_lshl_b32 s68, s64, 7
    s_max_u32 s69, s64, 1
    s_sub_u32 s69, s69, 1
    s_lshl_b32 s69, s69, 7
    s_add_u32 s69, s69, 95055872
    s_mov_b32 s99, 0
wc_32:
    buffer_load_dword v12, v2, s[44:47], s69 offen sc1
    s_waitcnt vmcnt(0)
    v_readfirstlane_b32 s98, v12
    s_cmp_ge_u32 s98, 1
    s_cbranch_scc1 wd_33
    s_sleep 2
    s_add_u32 s99, s99, 1
    s_cmp_lt_u32 s99, 400000
    s_cbranch_scc1 wc_32
    s_mov_b32 s60, s40
    s_and_b32 s61, s41, 0xffff
    s_mov_b32 s62, 0x100
    s_mov_b32 s63, 0x20000
    v_mov_b32 v2, 0
    v_mov_b32 v5, 3735879693
    buffer_store_dword v5, v2, s[60:63], 0 offen offset:52
    s_endpgm
wd_33:
    s_lshl_b32 s65, s64, 13
    s_add_u32 s65, s65, 91750400
    s_mul_i32 s66, s64, 114688
    s_add_u32 s66, s66, s12
    s_mov_b32 s99, 0
u_mp:
    buffer_load_dwordx4 v[128:131], v16, s[44:47], s65 offen offset:0 sc1
    buffer_load_dwordx4 v[132:135], v16, s[44:47], s65 offen offset:1024 sc1
    buffer_load_dwordx4 v[136:139], v16, s[44:47], s65 offen offset:2048 sc1
    buffer_load_dwordx4 v[140:143], v16, s[44:47], s65 offen offset:3072 sc1
    buffer_load_dwordx4 v[144:147], v17, s[44:47], s65 offen offset:0 sc1
    buffer_load_dwordx4 v[148:151], v17, s[44:47], s65 offen offset:1024 sc1
    buffer_load_dwordx4 v[152:155], v17, s[44:47], s65 offen offset:2048 sc1
    s_add_u32 s99, s99, 1
    s_cmp_ge_u32 s99, 400000
    s_cbranch_scc1 mega_abort
    s_waitcnt vmcnt(0)
    v_max3_u32 v12, v128, v129, v130
    v_max3_u32 v12, v12, v131, v132
    v_max3_u32 v12, v12, v133, v134
    v_max3_u32 v12, v12, v135, v136
    v_max3_u32 v12, v12, v137, v138
    v_max3_u32 v12, v12, v139, v140
    v_max3_u32 v12, v12, v141, v142
    v_max3_u32 v12, v12, v143, v144
    v_max3_u32 v12, v12, v145, v146
    v_max3_u32 v12, v12, v147, v148
    v_max3_u32 v12, v12, v149, v150
    v_max3_u32 v12, v12, v151, v152
    v_max3_u32 v12, v12, v153, v154
    v_max_u32 v12, v12, v155
    v_cmp_eq_u32 vcc, -1, v12
    s_cbranch_vccnz u_mp
    v_smfmac_f32_16x16x64_bf16 v[64:67], v[128:131], a[0:7], v5
    v_smfmac_f32_16x16x64_bf16 v[68:71], v[128:131], a[56:63], v5
    v_smfmac_f32_16x16x64_bf16 v[72:75], v[128:131], a[112:119], v5
    v_smfmac_f32_16x16x64_bf16 v[76:79], v[128:131], a[168:175], v5
    v_smfmac_f32_16x16x64_bf16 v[64:67], v[132:135], a[8:15], v5
    v_smfmac_f32_16x16x64_bf16 v[68:71], v[132:135], a[64:71], v5
    v_smfmac_f32_16x16x64_bf16 v[72:75], v[132:135], a[120:127], v5
    v_smfmac_f32_16x16x64_bf16 v[76:79], v[132:135], a[176:183], v5
    v_smfmac_f32_16x16x64_bf16 v[64:67], v[136:139], a[16:23], v5
    v_smfmac_f32_16x16x64_bf16 v[68:71], v[136:139], a[72:79], v5
    v_smfmac_f32_16x16x64_bf16 v[72:75], v[136:139], a[128:135], v5
    v_smfmac_f32_16x16x64_bf16 v[76:79], v[136:139], a[184:191], v5
    v_smfmac_f32_16x16x64_bf16 v[64:67], v[140:143], a[24:31], v5
    v_smfmac_f32_16x16x64_bf16 v[68:71], v[140:143], a[80:87], v5
    v_smfmac_f32_16x16x64_bf16 v[72:75], v[140:143], a[136:143], v5
    v_smfmac_f32_16x16x64_bf16 v[76:79], v[140:143], a[192:199], v5
    v_smfmac_f32_16x16x64_bf16 v[64:67], v[144:147], a[32:39], v5
    v_smfmac_f32_16x16x64_bf16 v[68:71], v[144:147], a[88:95], v5
    v_smfmac_f32_16x16x64_bf16 v[72:75], v[144:147], a[144:151], v5
    v_smfmac_f32_16x16x64_bf16 v[76:79], v[144:147], a[200:207], v5
    v_smfmac_f32_16x16x64_bf16 v[64:67], v[148:151], a[40:47], v5
    v_smfmac_f32_16x16x64_bf16 v[68:71], v[148:151], a[96:103], v5
    v_smfmac_f32_16x16x64_bf16 v[72:75], v[148:151], a[152:159], v5
    v_smfmac_f32_16x16x64_bf16 v[76:79], v[148:151], a[208:215], v5
    v_smfmac_f32_16x16x64_bf16 v[64:67], v[152:155], a[48:55], v5
    v_smfmac_f32_16x16x64_bf16 v[68:71], v[152:155], a[104:111], v5
    v_smfmac_f32_16x16x64_bf16 v[72:75], v[152:155], a[160:167], v5
    v_smfmac_f32_16x16x64_bf16 v[76:79], v[152:155], a[216:223], v5
    s_nop 4
    v_add_f32 v64, v64, v66
    v_add_f32 v65, v65, v67
    v_cvt_pk_bf16_f32 v96, v64, v65
    v_add_f32 v68, v68, v70
    v_add_f32 v69, v69, v71
    v_cvt_pk_bf16_f32 v97, v68, v69
    v_add_f32 v72, v72, v74
    v_add_f32 v73, v73, v75
    v_cvt_pk_bf16_f32 v98, v72, v73
    v_add_f32 v76, v76, v78
    v_add_f32 v77, v77, v79
    v_cvt_pk_bf16_f32 v99, v76, v77
    buffer_store_dwordx4 v[96:99], v1, s[44:47], s66 offen sc1
    s_add_u32 s69, s68, 95064064
    s_waitcnt vmcnt(0)
    s_barrier
    s_cmp_lg_u32 s6, 0
    s_cbranch_scc1 sg_35
    s_mov_b64 exec, 1
    v_mov_b32 v13, 1
    buffer_atomic_add v13, v2, s[44:47], s69 offen sc1
    s_mov_b64 exec, -1
sg_35:
    s_add_u32 s64, s64, 2
    s_cmp_lt_u32 s64, 63
    s_cbranch_scc1 u_loop
    s_endpgm
role_tx:
    s_sub_u32 s7, s7, 88
    s_cmp_lg_u32 s6, 0
    s_cbranch_scc1 sw_36
    v_min_u32 v13, 0, v0
    v_lshlrev_b32 v13, 7, v13
    s_mov_b32 s98, 95072384
    s_mov_b32 s99, 0
ws_37:
    buffer_load_dword v12, v13, s[44:47], s98 offen sc1
    s_add_u32 s99, s99, 1
    s_cmp_ge_u32 s99, 400000
    s_cbranch_scc1 mega_abort
    s_waitcnt vmcnt(0)
    v_cmp_gt_u32 vcc, 32, v12
    s_cbranch_vccz wt_38
    s_sleep 4
    s_branch ws_37
wt_38:
sw_36:
    s_barrier
    s_cmp_lg_u32 s6, 0
    s_cbranch_scc1 sw_39
    v_min_u32 v13, 7, v0
    v_lshlrev_b32 v13, 7, v13
    s_mov_b32 s98, 95072768
    s_mov_b32 s99, 0
ws_40:
    buffer_load_dword v12, v13, s[44:47], s98 offen sc1
    s_add_u32 s99, s99, 1
    s_cmp_ge_u32 s99, 400000
    s_cbranch_scc1 mega_abort
    s_waitcnt vmcnt(0)
    v_cmp_gt_u32 vcc, 32, v12
    s_cbranch_vccz wt_41
    s_sleep 4
    s_branch ws_40
wt_41:
sw_39:
    s_barrier
    s_cmp_lg_u32 s6, 0
    s_cbranch_scc1 sw_42
    v_min_u32 v13, 6, v0
    v_lshlrev_b32 v13, 7, v13
    s_mov_b32 s98, 95073792
    s_mov_b32 s99, 0
ws_43:
    buffer_load_dword v12, v13, s[44:47], s98 offen sc1
    s_add_u32 s99, s99, 1
    s_cmp_ge_u32 s99, 400000
    s_cbranch_scc1 mega_abort
    s_waitcnt vmcnt(0)
    v_cmp_gt_u32 vcc, 32, v12
    s_cbranch_vccz wt_44
    s_sleep 4
    s_branch ws_43
wt_44:
    buffer_inv sc1
sw_42:
    s_barrier
    s_cmp_ge_u32 s7, 28
    s_cselect_b32 s8, 1, 0
    s_mul_i32 s64, s8, 28
    s_sub_u32 s64, s7, s64
    s_mov_b32 s9, 2
    s_lshl_b32 s65, s64, 3
    s_lshl_b32 s66, s6, 1
    s_add_u32 s65, s65, s66
    v_lshrrev_b32 v5, 3, v3
    v_mul_u32_u24 v5, 14336, v5
    v_lshl_add_u32 v5, v4, 8, v5
    v_bfe_u32 v6, v3, 1, 1
    v_lshl_add_u32 v5, v6, 7, v5
    v_bfe_u32 v6, v3, 2, 1
    v_lshl_add_u32 v5, v6, 6, v5
    v_and_b32 v6, 1, v3
    v_lshl_add_u32 v5, v6, 4, v5
    s_add_u32 s66, s65, 0
    s_mul_i32 s66, s66, 28672
    s_add_u32 s66, s66, 3670016
    buffer_load_dwordx4 a[0:3], v5, s[44:47], s66 offen offset:0 sc1
    buffer_load_dwordx4 a[56:59], v5, s[44:47], s66 offen offset:32 sc1
    buffer_load_dwordx4 a[4:7], v5, s[44:47], s66 offen offset:1024 sc1
    buffer_load_dwordx4 a[60:63], v5, s[44:47], s66 offen offset:1056 sc1
    buffer_load_dwordx4 a[8:11], v5, s[44:47], s66 offen offset:2048 sc1
    buffer_load_dwordx4 a[64:67], v5, s[44:47], s66 offen offset:2080 sc1
    buffer_load_dwordx4 a[12:15], v5, s[44:47], s66 offen offset:3072 sc1
    buffer_load_dwordx4 a[68:71], v5, s[44:47], s66 offen offset:3104 sc1
    s_add_u32 s66, s66, 4096
    buffer_load_dwordx4 a[16:19], v5, s[44:47], s66 offen offset:0 sc1
    buffer_load_dwordx4 a[72:75], v5, s[44:47], s66 offen offset:32 sc1
    buffer_load_dwordx4 a[20:23], v5, s[44:47], s66 offen offset:1024 sc1
    buffer_load_dwordx4 a[76:79], v5, s[44:47], s66 offen offset:1056 sc1
    buffer_load_dwordx4 a[24:27], v5, s[44:47], s66 offen offset:2048 sc1
    buffer_load_dwordx4 a[80:83], v5, s[44:47], s66 offen offset:2080 sc1
    buffer_load_dwordx4 a[28:31], v5, s[44:47], s66 offen offset:3072 sc1
    buffer_load_dwordx4 a[84:87], v5, s[44:47], s66 offen offset:3104 sc1
    s_add_u32 s66, s66, 4096
    buffer_load_dwordx4 a[32:35], v5, s[44:47], s66 offen offset:0 sc1
    buffer_load_dwordx4 a[88:91], v5, s[44:47], s66 offen offset:32 sc1
    buffer_load_dwordx4 a[36:39], v5, s[44:47], s66 offen offset:1024 sc1
    buffer_load_dwordx4 a[92:95], v5, s[44:47], s66 offen offset:1056 sc1
    buffer_load_dwordx4 a[40:43], v5, s[44:47], s66 offen offset:2048 sc1
    buffer_load_dwordx4 a[96:99], v5, s[44:47], s66 offen offset:2080 sc1
    buffer_load_dwordx4 a[44:47], v5, s[44:47], s66 offen offset:3072 sc1
    buffer_load_dwordx4 a[100:103], v5, s[44:47], s66 offen offset:3104 sc1
    s_add_u32 s66, s66, 4096
    buffer_load_dwordx4 a[48:51], v5, s[44:47], s66 offen offset:0 sc1
    buffer_load_dwordx4 a[104:107], v5, s[44:47], s66 offen offset:32 sc1
    buffer_load_dwordx4 a[52:55], v5, s[44:47], s66 offen offset:1024 sc1
    buffer_load_dwordx4 a[108:111], v5, s[44:47], s66 offen offset:1056 sc1
    s_add_u32 s66, s65, 1
    s_mul_i32 s66, s66, 28672
    s_add_u32 s66, s66, 3670016
    buffer_load_dwordx4 a[112:115], v5, s[44:47], s66 offen offset:0 sc1
    buffer_load_dwordx4 a[168:171], v5, s[44:47], s66 offen offset:32 sc1
    buffer_load_dwordx4 a[116:119], v5, s[44:47], s66 offen offset:1024 sc1
    buffer_load_dwordx4 a[172:175], v5, s[44:47], s66 offen offset:1056 sc1
    buffer_load_dwordx4 a[120:123], v5, s[44:47], s66 offen offset:2048 sc1
    buffer_load_dwordx4 a[176:179], v5, s[44:47], s66 offen offset:2080 sc1
    buffer_load_dwordx4 a[124:127], v5, s[44:47], s66 offen offset:3072 sc1
    buffer_load_dwordx4 a[180:183], v5, s[44:47], s66 offen offset:3104 sc1
    s_add_u32 s66, s66, 4096
    buffer_load_dwordx4 a[128:131], v5, s[44:47], s66 offen offset:0 sc1
    buffer_load_dwordx4 a[184:187], v5, s[44:47], s66 offen offset:32 sc1
    buffer_load_dwordx4 a[132:135], v5, s[44:47], s66 offen offset:1024 sc1
    buffer_load_dwordx4 a[188:191], v5, s[44:47], s66 offen offset:1056 sc1
    buffer_load_dwordx4 a[136:139], v5, s[44:47], s66 offen offset:2048 sc1
    buffer_load_dwordx4 a[192:195], v5, s[44:47], s66 offen offset:2080 sc1
    buffer_load_dwordx4 a[140:143], v5, s[44:47], s66 offen offset:3072 sc1
    buffer_load_dwordx4 a[196:199], v5, s[44:47], s66 offen offset:3104 sc1
    s_add_u32 s66, s66, 4096
    buffer_load_dwordx4 a[144:147], v5, s[44:47], s66 offen offset:0 sc1
    buffer_load_dwordx4 a[200:203], v5, s[44:47], s66 offen offset:32 sc1
    buffer_load_dwordx4 a[148:151], v5, s[44:47], s66 offen offset:1024 sc1
    buffer_load_dwordx4 a[204:207], v5, s[44:47], s66 offen offset:1056 sc1
    buffer_load_dwordx4 a[152:155], v5, s[44:47], s66 offen offset:2048 sc1
    buffer_load_dwordx4 a[208:211], v5, s[44:47], s66 offen offset:2080 sc1
    buffer_load_dwordx4 a[156:159], v5, s[44:47], s66 offen offset:3072 sc1
    buffer_load_dwordx4 a[212:215], v5, s[44:47], s66 offen offset:3104 sc1
    s_add_u32 s66, s66, 4096
    buffer_load_dwordx4 a[160:163], v5, s[44:47], s66 offen offset:0 sc1
    buffer_load_dwordx4 a[216:219], v5, s[44:47], s66 offen offset:32 sc1
    buffer_load_dwordx4 a[164:167], v5, s[44:47], s66 offen offset:1024 sc1
    buffer_load_dwordx4 a[220:223], v5, s[44:47], s66 offen offset:1056 sc1
    s_mov_b32 s10, 0
    s_mov_b32 s11, 28672
    s_lshl_b32 s12, s65, 11
    s_add_u32 s12, s12, 45875200
    s_mov_b32 s13, 458752
    s_mov_b32 s14, 95023104
    s_waitcnt vmcnt(30)
    s_barrier
    s_mov_b32 s64, s8
    s_mul_i32 s71, s6, 7168
    s_add_u32 s10, s10, s71
    s_add_u32 s73, s71, 86016
    s_mov_b32 s72, 0
    s_min_u32 s65, s64, 63
    s_mul_i32 s65, s65, s11
    s_add_u32 s65, s65, s10
    s_add_u32 s69, s65, 0
    s_add_u32 m0, s71, 0
    s_nop 0
    buffer_load_dwordx4 v1, s[44:47], s69 offen offset:0 lds
    buffer_load_dwordx4 v1, s[44:47], s69 offen offset:1024 lds
    buffer_load_dwordx4 v1, s[44:47], s69 offen offset:2048 lds
    buffer_load_dwordx4 v1, s[44:47], s69 offen offset:3072 lds
    s_add_u32 s69, s65, 4096
    s_add_u32 m0, s71, 4096
    s_nop 0
    buffer_load_dwordx4 v1, s[44:47], s69 offen offset:0 lds
    buffer_load_dwordx4 v1, s[44:47], s69 offen offset:1024 lds
    buffer_load_dwordx4 v1, s[44:47], s69 offen offset:2048 lds
    s_add_u32 s71, s71, 28672
    s_cmp_ge_u32 s71, s73
    s_cselect_b32 s69, 86016, 0
    s_sub_u32 s71, s71, s69
    s_add_u32 s70, s64, s9
    s_min_u32 s65, s70, 63
    s_mul_i32 s65, s65, s11
    s_add_u32 s65, s65, s10
    s_add_u32 s69, s65, 0
    s_add_u32 m0, s71, 0
    s_nop 0
    buffer_load_dwordx4 v1, s[44:47], s69 offen offset:0 lds
    buffer_load_dwordx4 v1, s[44:47], s69 offen offset:1024 lds
    buffer_load_dwordx4 v1, s[44:47], s69 offen offset:2048 lds
    buffer_load_dwordx4 v1, s[44:47], s69 offen offset:3072 lds
    s_add_u32 s69, s65, 4096
    s_add_u32 m0, s71, 4096
    s_nop 0
    buffer_load_dwordx4 v1, s[44:47], s69 offen offset:0 lds
    buffer_load_dwordx4 v1, s[44:47], s69 offen offset:1024 lds
    buffer_load_dwordx4 v1, s[44:47], s69 offen offset:2048 lds
    s_add_u32 s71, s71, 28672
    s_cmp_ge_u32 s71, s73
    s_cselect_b32 s69, 86016, 0
    s_sub_u32 s71, s71, s69
    s_mov_b32 s67, -1
    s_waitcnt vmcnt(7)
eng_tx_loop:
    s_add_u32 s68, s64, s9
    v_add_u32 v16, s72, v1
    s_barrier
    ds_read_b128 v[128:131], v16 offset:0
    ds_read_b128 v[132:135], v16 offset:14336
    ds_read_b128 v[136:139], v16 offset:1024
    ds_read_b128 v[140:143], v16 offset:15360
    ds_read_b128 v[144:147], v16 offset:2048
    s_add_u32 s70, s68, s9
    s_min_u32 s65, s70, 63
    s_mul_i32 s65, s65, s11
    s_add_u32 s65, s65, s10
    s_add_u32 s72, s72, 28672
    s_cmp_ge_u32 s72, 86016
    s_cselect_b32 s72, 0, s72
    s_mul_i32 s66, s64, s13
    s_add_u32 s66, s66, s12
    s_waitcnt lgkmcnt(4)
    v_mfma_f32_16x16x32_bf16 v[64:67], a[0:3], v[128:131], 0
    ds_read_b128 v[148:151], v16 offset:16384
    v_mfma_f32_16x16x32_bf16 v[68:71], a[56:59], v[128:131], 0
    v_mfma_f32_16x16x32_bf16 v[72:75], a[112:115], v[128:131], 0
    s_add_u32 s69, s65, 0
    s_add_u32 m0, s71, 0
    s_nop 0
    buffer_load_dwordx4 v1, s[44:47], s69 offen offset:0 lds
    v_mfma_f32_16x16x32_bf16 v[76:79], a[168:171], v[128:131], 0
    s_waitcnt lgkmcnt(4)
    v_mfma_f32_16x16x32_bf16 v[80:83], a[0:3], v[132:135], 0
    ds_read_b128 v[128:131], v16 offset:3072
    v_mfma_f32_16x16x32_bf16 v[84:87], a[56:59], v[132:135], 0
    v_mfma_f32_16x16x32_bf16 v[88:91], a[112:115], v[132:135], 0
    buffer_load_dwordx4 v1, s[44:47], s69 offen offset:1024 lds
    v_mfma_f32_16x16x32_bf16 v[92:95], a[168:171], v[132:135], 0
    s_waitcnt lgkmcnt(4)
    v_mfma_f32_16x16x32_bf16 v[64:67], a[4:7], v[136:139], v[64:67]
    ds_read_b128 v[132:135], v16 offset:17408
    v_mfma_f32_16x16x32_bf16 v[68:71], a[60:63], v[136:139], v[68:71]
    v_mfma_f32_16x16x32_bf16 v[72:75], a[116:119], v[136:139], v[72:75]
    buffer_load_dwordx4 v1, s[44:47], s69 offen offset:2048 lds
    v_mfma_f32_16x16x32_bf16 v[76:79], a[172:175], v[136:139], v[76:79]
    s_waitcnt lgkmcnt(4)
    v_mfma_f32_16x16x32_bf16 v[80:83], a[4:7], v[140:143], v[80:83]
    ds_read_b128 v[136:139], v16 offset:4096
    v_mfma_f32_16x16x32_bf16 v[84:87], a[60:63], v[140:143], v[84:87]
    v_mfma_f32_16x16x32_bf16 v[88:91], a[116:119], v[140:143], v[88:91]
    buffer_load_dwordx4 v1, s[44:47], s69 offen offset:3072 lds
    v_mfma_f32_16x16x32_bf16 v[92:95], a[172:175], v[140:143], v[92:95]
    s_waitcnt lgkmcnt(4)
    v_mfma_f32_16x16x32_bf16 v[64:67], a[8:11], v[144:147], v[64:67]
    ds_read_b128 v[140:143], v16 offset:18432
    v_mfma_f32_16x16x32_bf16 v[68:71], a[64:67], v[144:147], v[68:71]
    v_mfma_f32_16x16x32_bf16 v[72:75], a[120:123], v[144:147], v[72:75]
    s_add_u32 s69, s65, 4096
    s_add_u32 m0, s71, 4096
    s_nop 0
    buffer_load_dwordx4 v1, s[44:47], s69 offen offset:0 lds
    v_mfma_f32_16x16x32_bf16 v[76:79], a[176:179], v[144:147], v[76:79]
    s_waitcnt lgkmcnt(4)
    v_mfma_f32_16x16x32_bf16 v[80:83], a[8:11], v[148:151], v[80:83]
    ds_read_b128 v[144:147], v16 offset:5120
    v_mfma_f32_16x16x32_bf16 v[84:87], a[64:67], v[148:151], v[84:87]
    v_mfma_f32_16x16x32_bf16 v[88:91], a[120:123], v[148:151], v[88:91]
    buffer_load_dwordx4 v1, s[44:47], s69 offen offset:1024 lds
    v_mfma_f32_16x16x32_bf16 v[92:95], a[176:179], v[148:151], v[92:95]
    s_waitcnt lgkmcnt(4)
    v_mfma_f32_16x16x32_bf16 v[64:67], a[12:15], v[128:131], v[64:67]
    ds_read_b128 v[148:151], v16 offset:19456
    v_mfma_f32_16x16x32_bf16 v[68:71], a[68:71], v[128:131], v[68:71]
    v_mfma_f32_16x16x32_bf16 v[72:75], a[124:127], v[128:131], v[72:75]
    buffer_load_dwordx4 v1, s[44:47], s69 offen offset:2048 lds
    v_mfma_f32_16x16x32_bf16 v[76:79], a[180:183], v[128:131], v[76:79]
    s_waitcnt lgkmcnt(4)
    v_mfma_f32_16x16x32_bf16 v[80:83], a[12:15], v[132:135], v[80:83]
    ds_read_b128 v[128:131], v16 offset:6144
    v_mfma_f32_16x16x32_bf16 v[84:87], a[68:71], v[132:135], v[84:87]
    v_mfma_f32_16x16x32_bf16 v[88:91], a[124:127], v[132:135], v[88:91]
    v_mfma_f32_16x16x32_bf16 v[92:95], a[180:183], v[132:135], v[92:95]
    s_add_u32 s71, s71, 28672
    s_cmp_ge_u32 s71, s73
    s_cselect_b32 s69, 86016, 0
    s_sub_u32 s71, s71, s69
    s_waitcnt lgkmcnt(4)
    v_mfma_f32_16x16x32_bf16 v[64:67], a[16:19], v[136:139], v[64:67]
    ds_read_b128 v[132:135], v16 offset:20480
    v_mfma_f32_16x16x32_bf16 v[68:71], a[72:75], v[136:139], v[68:71]
    v_mfma_f32_16x16x32_bf16 v[72:75], a[128:131], v[136:139], v[72:75]
    v_mfma_f32_16x16x32_bf16 v[76:79], a[184:187], v[136:139], v[76:79]
    s_waitcnt lgkmcnt(4)
    v_mfma_f32_16x16x32_bf16 v[80:83], a[16:19], v[140:143], v[80:83]
    ds_read_b128 v[136:139], v16 offset:7168
    v_mfma_f32_16x16x32_bf16 v[84:87], a[72:75], v[140:143], v[84:87]
    v_mfma_f32_16x16x32_bf16 v[88:91], a[128:131], v[140:143], v[88:91]
    v_mfma_f32_16x16x32_bf16 v[92:95], a[184:187], v[140:143], v[92:95]
    s_waitcnt lgkmcnt(4)
    v_mfma_f32_16x16x32_bf16 v[64:67], a[20:23], v[144:147], v[64:67]
    ds_read_b128 v[140:143], v16 offset:21504
    v_mfma_f32_16x16x32_bf16 v[68:71], a[76:79], v[144:147], v[68:71]
    v_mfma_f32_16x16x32_bf16 v[72:75], a[132:135], v[144:147], v[72:75]
    v_mfma_f32_16x16x32_bf16 v[76:79], a[188:191], v[144:147], v[76:79]
    s_waitcnt lgkmcnt(4)
    v_mfma_f32_16x16x32_bf16 v[80:83], a[20:23], v[148:151], v[80:83]
    ds_read_b128 v[144:147], v16 offset:8192
    v_mfma_f32_16x16x32_bf16 v[84:87], a[76:79], v[148:151], v[84:87]
    v_mfma_f32_16x16x32_bf16 v[88:91], a[132:135], v[148:151], v[88:91]
    v_mfma_f32_16x16x32_bf16 v[92:95], a[188:191], v[148:151], v[92:95]
    s_waitcnt vmcnt(7)
    s_barrier
    s_cmp_eq_u32 s67, -1
    s_cbranch_scc1 ns_45
    s_cmp_lg_u32 s6, 0
    s_cbranch_scc1 sg_46
    s_mov_b64 exec, 1
    v_mov_b32 v13, 1
    buffer_atomic_add v13, v2, s[44:47], s67 offen sc1
    s_mov_b64 exec, -1
sg_46:
ns_45:
    s_waitcnt lgkmcnt(4)
    v_mfma_f32_16x16x32_bf16 v[64:67], a[24:27], v[128:131], v[64:67]
    ds_read_b128 v[148:151], v16 offset:22528
    v_mfma_f32_16x16x32_bf16 v[68:71], a[80:83], v[128:131], v[68:71]
    v_mfma_f32_16x16x32_bf16 v[72:75], a[136:139], v[128:131], v[72:75]
    v_mfma_f32_16x16x32_bf16 v[76:79], a[192:195], v[128:131], v[76:79]
    s_waitcnt lgkmcnt(4)
    v_mfma_f32_16x16x32_bf16 v[80:83], a[24:27], v[132:135], v[80:83]
    ds_read_b128 v[128:131], v16 offset:9216
    v_mfma_f32_16x16x32_bf16 v[84:87], a[80:83], v[132:135], v[84:87]
    v_mfma_f32_16x16x32_bf16 v[88:91], a[136:139], v[132:135], v[88:91]
    v_mfma_f32_16x16x32_bf16 v[92:95], a[192:195], v[132:135], v[92:95]
    s_waitcnt lgkmcnt(4)
    v_mfma_f32_16x16x32_bf16 v[64:67], a[28:31], v[136:139], v[64:67]
    ds_read_b128 v[132:135], v16 offset:23552
    v_mfma_f32_16x16x32_bf16 v[68:71], a[84:87], v[136:139], v[68:71]
    v_mfma_f32_16x16x32_bf16 v[72:75], a[140:143], v[136:139], v[72:75]
    v_mfma_f32_16x16x32_bf16 v[76:79], a[196:199], v[136:139], v[76:79]
    s_waitcnt lgkmcnt(4)
    v_mfma_f32_16x16x32_bf16 v[80:83], a[28:31], v[140:143], v[80:83]
    ds_read_b128 v[136:139], v16 offset:10240
    v_mfma_f32_16x16x32_bf16 v[84:87], a[84:87], v[140:143], v[84:87]
    v_mfma_f32_16x16x32_bf16 v[88:91], a[140:143], v[140:143], v[88:91]
    v_mfma_f32_16x16x32_bf16 v[92:95], a[196:199], v[140:143], v[92:95]
    s_waitcnt lgkmcnt(4)
    v_mfma_f32_16x16x32_bf16 v[64:67], a[32:35], v[144:147], v[64:67]
    ds_read_b128 v[140:143], v16 offset:24576
    v_mfma_f32_16x16x32_bf16 v[68:71], a[88:91], v[144:147], v[68:71]
    v_mfma_f32_16x16x32_bf16 v[72:75], a[144:147], v[144:147], v[72:75]
    v_mfma_f32_16x16x32_bf16 v[76:79], a[200:203], v[144:147], v[76:79]
    s_waitcnt lgkmcnt(4)
    v_mfma_f32_16x16x32_bf16 v[80:83], a[32:35], v[148:151], v[80:83]
    ds_read_b128 v[144:147], v16 offset:11264
    v_mfma_f32_16x16x32_bf16 v[84:87], a[88:91], v[148:151], v[84:87]
    v_mfma_f32_16x16x32_bf16 v[88:91], a[144:147], v[148:151], v[88:91]
    v_mfma_f32_16x16x32_bf16 v[92:95], a[200:203], v[148:151], v[92:95]
    s_waitcnt lgkmcnt(4)
    v_mfma_f32_16x16x32_bf16 v[64:67], a[36:39], v[128:131], v[64:67]
    ds_read_b128 v[148:151], v16 offset:25600
    v_mfma_f32_16x16x32_bf16 v[68:71], a[92:95], v[128:131], v[68:71]
    v_mfma_f32_16x16x32_bf16 v[72:75], a[148:151], v[128:131], v[72:75]
    v_mfma_f32_16x16x32_bf16 v[76:79], a[204:207], v[128:131], v[76:79]
    s_waitcnt lgkmcnt(4)
    v_mfma_f32_16x16x32_bf16 v[80:83], a[36:39], v[132:135], v[80:83]
    ds_read_b128 v[128:131], v16 offset:12288
    v_mfma_f32_16x16x32_bf16 v[84:87], a[92:95], v[132:135], v[84:87]
    v_mfma_f32_16x16x32_bf16 v[88:91], a[148:151], v[132:135], v[88:91]
    v_mfma_f32_16x16x32_bf16 v[92:95], a[204:207], v[132:135], v[92:95]
    s_waitcnt lgkmcnt(4)
    v_mfma_f32_16x16x32_bf16 v[64:67], a[40:43], v[136:139], v[64:67]
    ds_read_b128 v[132:135], v16 offset:26624
    v_mfma_f32_16x16x32_bf16 v[68:71], a[96:99], v[136:139], v[68:71]
    v_mfma_f32_16x16x32_bf16 v[72:75], a[152:155], v[136:139], v[72:75]
    v_mfma_f32_16x16x32_bf16 v[76:79], a[208:211], v[136:139], v[76:79]
    s_waitcnt lgkmcnt(4)
    v_mfma_f32_16x16x32_bf16 v[80:83], a[40:43], v[140:143], v[80:83]
    ds_read_b128 v[136:139], v16 offset:13312
    v_mfma_f32_16x16x32_bf16 v[84:87], a[96:99], v[140:143], v[84:87]
    v_mfma_f32_16x16x32_bf16 v[88:91], a[152:155], v[140:143], v[88:91]
    v_mfma_f32_16x16x32_bf16 v[92:95], a[208:211], v[140:143], v[92:95]
    s_waitcnt lgkmcnt(4)
    v_mfma_f32_16x16x32_bf16 v[64:67], a[44:47], v[144:147], v[64:67]
    ds_read_b128 v[140:143], v16 offset:27648
    v_mfma_f32_16x16x32_bf16 v[68:71], a[100:103], v[144:147], v[68:71]
    v_mfma_f32_16x16x32_bf16 v[72:75], a[156:159], v[144:147], v[72:75]
    v_mfma_f32_16x16x32_bf16 v[76:79], a[212:215], v[144:147], v[76:79]
    s_waitcnt lgkmcnt(4)
    v_mfma_f32_16x16x32_bf16 v[80:83], a[44:47], v[148:151], v[80:83]
    v_mfma_f32_16x16x32_bf16 v[84:87], a[100:103], v[148:151], v[84:87]
    v_mfma_f32_16x16x32_bf16 v[88:91], a[156:159], v[148:151], v[88:91]
    v_mfma_f32_16x16x32_bf16 v[92:95], a[212:215], v[148:151], v[92:95]
    s_waitcnt lgkmcnt(3)
    v_mfma_f32_16x16x32_bf16 v[64:67], a[48:51], v[128:131], v[64:67]
    v_mfma_f32_16x16x32_bf16 v[68:71], a[104:107], v[128:131], v[68:71]
    v_mfma_f32_16x16x32_bf16 v[72:75], a[160:163], v[128:131], v[72:75]
    v_mfma_f32_16x16x32_bf16 v[76:79], a[216:219], v[128:131], v[76:79]
    s_waitcnt lgkmcnt(2)
    v_mfma_f32_16x16x32_bf16 v[80:83], a[48:51], v[132:135], v[80:83]
    v_mfma_f32_16x16x32_bf16 v[84:87], a[104:107], v[132:135], v[84:87]
    v_mfma_f32_16x16x32_bf16 v[88:91], a[160:163], v[132:135], v[88:91]
    v_mfma_f32_16x16x32_bf16 v[92:95], a[216:219], v[132:135], v[92:95]
    s_waitcnt lgkmcnt(1)
    v_mfma_f32_16x16x32_bf16 v[64:67], a[52:55], v[136:139], v[64:67]
    v_mfma_f32_16x16x32_bf16 v[68:71], a[108:111], v[136:139], v[68:71]
    v_mfma_f32_16x16x32_bf16 v[72:75], a[164:167], v[136:139], v[72:75]
    v_mfma_f32_16x16x32_bf16 v[76:79], a[220:223], v[136:139], v[76:79]
    s_waitcnt lgkmcnt(0)
    v_mfma_f32_16x16x32_bf16 v[80:83], a[52:55], v[140:143], v[80:83]
    v_mfma_f32_16x16x32_bf16 v[84:87], a[108:111], v[140:143], v[84:87]
    v_mfma_f32_16x16x32_bf16 v[88:91], a[164:167], v[140:143], v[88:91]
    v_mfma_f32_16x16x32_bf16 v[92:95], a[220:223], v[140:143], v[92:95]
    v_cvt_pk_bf16_f32 v96, v64, v65
    v_cvt_pk_bf16_f32 v97, v66, v67
    v_cvt_pk_bf16_f32 v98, v68, v69
    v_cvt_pk_bf16_f32 v99, v70, v71
    buffer_store_dwordx4 v[96:99], v1, s[44:47], s66 offen offset:0 sc1
    v_cvt_pk_bf16_f32 v100, v80, v81
    v_cvt_pk_bf16_f32 v101, v82, v83
    v_cvt_pk_bf16_f32 v102, v84, v85
    v_cvt_pk_bf16_f32 v103, v86, v87
    buffer_store_dwordx4 v[100:103], v1, s[44:47], s66 offen offset:1024 sc1
    v_cvt_pk_bf16_f32 v104, v72, v73
    v_cvt_pk_bf16_f32 v105, v74, v75
    v_cvt_pk_bf16_f32 v106, v76, v77
    v_cvt_pk_bf16_f32 v107, v78, v79
    buffer_store_dwordx4 v[104:107], v1, s[44:47], s66 offen offset:2048 sc1
    v_cvt_pk_bf16_f32 v108, v88, v89
    v_cvt_pk_bf16_f32 v109, v90, v91
    v_cvt_pk_bf16_f32 v110, v92, v93
    v_cvt_pk_bf16_f32 v111, v94, v95
    buffer_store_dwordx4 v[108:111], v1, s[44:47], s66 offen offset:3072 sc1
    s_lshl_b32 s67, s64, 7
    s_add_u32 s67, s67, s14
    s_mov_b32 s75, s66
    s_mov_b32 s64, s68
    s_cmp_lt_u32 s64, 64
    s_cbranch_scc1 eng_tx_loop
    s_waitcnt vmcnt(0)
    s_barrier
    s_cmp_lg_u32 s6, 0
    s_cbranch_scc1 sg_47
    s_mov_b64 exec, 1
    v_mov_b32 v13, 1
    buffer_atomic_add v13, v2, s[44:47], s67 offen sc1
    s_mov_b64 exec, -1
sg_47:
    s_endpgm
role_ffn:
    s_sub_u32 s7, s7, 144
    s_cmp_lg_u32 s6, 0
    s_cbranch_scc1 sw_48
    v_min_u32 v13, 0, v0
    v_lshlrev_b32 v13, 7, v13
    s_mov_b32 s98, 95072384
    s_mov_b32 s99, 0
ws_49:
    buffer_load_dword v12, v13, s[44:47], s98 offen sc1
    s_add_u32 s99, s99, 1
    s_cmp_ge_u32 s99, 400000
    s_cbranch_scc1 mega_abort
    s_waitcnt vmcnt(0)
    v_cmp_gt_u32 vcc, 32, v12
    s_cbranch_vccz wt_50
    s_sleep 4
    s_branch ws_49
wt_50:
sw_48:
    s_barrier
    s_cmp_lg_u32 s6, 0
    s_cbranch_scc1 sw_51
    v_min_u32 v13, 7, v0
    v_lshlrev_b32 v13, 7, v13
    s_mov_b32 s98, 95072768
    s_mov_b32 s99, 0
ws_52:
    buffer_load_dword v12, v13, s[44:47], s98 offen sc1
    s_add_u32 s99, s99, 1
    s_cmp_ge_u32 s99, 400000
    s_cbranch_scc1 mega_abort
    s_waitcnt vmcnt(0)
    v_cmp_gt_u32 vcc, 32, v12
    s_cbranch_vccz wt_53
    s_sleep 4
    s_branch ws_52
wt_53:
    buffer_inv sc1
sw_51:
    s_barrier
    s_mul_i32 s8, s7, 4682
    s_lshr_b32 s8, s8, 16
    s_mul_i32 s64, s8, 14
    s_sub_u32 s64, s7, s64
    s_mov_b32 s9, 4
    s_mov_b32 s48, s32
    s_and_b32 s49, s33, 0xffff
    s_mov_b32 s50, 0x188000
    s_mov_b32 s51, 0x20000
    s_mov_b32 s52, s34
    s_and_b32 s53, s35, 0xffff
    s_mov_b32 s54, 0x188000
    s_mov_b32 s55, 0x20000
    v_mul_u32_u24 v5, 3584, v4
    v_lshl_add_u32 v5, v3, 4, v5
    v_lshrrev_b32 v6, 1, v4
    v_lshlrev_b32 v6, 12, v6
    v_bfe_u32 v7, v3, 3, 1
    v_lshl_add_u32 v6, v7, 11, v6
    v_and_b32 v7, 1, v4
    v_lshl_add_u32 v6, v7, 10, v6
    v_bfe_u32 v7, v3, 2, 1
    v_lshl_add_u32 v6, v7, 8, v6
    v_and_b32 v7, 3, v3
    v_lshl_add_u32 v6, v7, 3, v6
    s_lshl_b32 s65, s6, 6
    v_add_u32 v6, s65, v6
    v_add_u32 v7, 57344, v6
    s_mul_i32 s65, s6, 401408
    s_lshl_b32 s66, s64, 8
    s_add_u32 s65, s65, s66
    s_mul_i32 s66, s6, 28672
    s_mov_b32 m0, s66
    s_nop 0
    buffer_load_dwordx4 v5, s[48:51], s65 offen lds
    s_add_u32 s65, s65, 14336
    s_add_u32 s66, s66, 1024
    s_mov_b32 m0, s66
    s_nop 0
    buffer_load_dwordx4 v5, s[48:51], s65 offen lds
    s_add_u32 s65, s65, 14336
    s_add_u32 s66, s66, 1024
    s_mov_b32 m0, s66
    s_nop 0
    buffer_load_dwordx4 v5, s[48:51], s65 offen lds
    s_add_u32 s65, s65, 14336
    s_add_u32 s66, s66, 1024
    s_mov_b32 m0, s66
    s_nop 0
    buffer_load_dwordx4 v5, s[48:51], s65 offen lds
    s_add_u32 s65, s65, 14336
    s_add_u32 s66, s66, 1024
    s_mov_b32 m0, s66
    s_nop 0
    buffer_load_dwordx4 v5, s[48:51], s65 offen lds
    s_add_u32 s65, s65, 14336
    s_add_u32 s66, s66, 1024
    s_mov_b32 m0, s66
    s_nop 0
    buffer_load_dwordx4 v5, s[48:51], s65 offen lds
    s_add_u32 s65, s65, 14336
    s_add_u32 s66, s66, 1024
    s_mov_b32 m0, s66
    s_nop 0
    buffer_load_dwordx4 v5, s[48:51], s65 offen lds
    s_add_u32 s65, s65, 14336
    s_add_u32 s66, s66, 1024
    s_mov_b32 m0, s66
    s_nop 0
    buffer_load_dwordx4 v5, s[48:51], s65 offen lds
    s_add_u32 s65, s65, 14336
    s_add_u32 s66, s66, 1024
    s_mov_b32 m0, s66
    s_nop 0
    buffer_load_dwordx4 v5, s[48:51], s65 offen lds
    s_add_u32 s65, s65, 14336
    s_add_u32 s66, s66, 1024
    s_mov_b32 m0, s66
    s_nop 0
    buffer_load_dwordx4 v5, s[48:51], s65 offen lds
    s_add_u32 s65, s65, 14336
    s_add_u32 s66, s66, 1024
    s_mov_b32 m0, s66
    s_nop 0
    buffer_load_dwordx4 v5, s[48:51], s65 offen lds
    s_add_u32 s65, s65, 14336
    s_add_u32 s66, s66, 1024
    s_mov_b32 m0, s66
    s_nop 0
    buffer_load_dwordx4 v5, s[48:51], s65 offen lds
    s_add_u32 s65, s65, 14336
    s_add_u32 s66, s66, 1024
    s_mov_b32 m0, s66
    s_nop 0
    buffer_load_dwordx4 v5, s[48:51], s65 offen lds
    s_add_u32 s65, s65, 14336
    s_add_u32 s66, s66, 1024
    s_mov_b32 m0, s66
    s_nop 0
    buffer_load_dwordx4 v5, s[48:51], s65 offen lds
    s_add_u32 s65, s65, 14336
    s_add_u32 s66, s66, 1024
    s_mov_b32 m0, s66
    s_nop 0
    buffer_load_dwordx4 v5, s[48:51], s65 offen lds
    s_add_u32 s65, s65, 14336
    s_add_u32 s66, s66, 1024
    s_mov_b32 m0, s66
    s_nop 0
    buffer_load_dwordx4 v5, s[48:51], s65 offen lds
    s_add_u32 s65, s65, 14336
    s_add_u32 s66, s66, 1024
    s_mov_b32 m0, s66
    s_nop 0
    buffer_load_dwordx4 v5, s[48:51], s65 offen lds
    s_add_u32 s65, s65, 14336
    s_add_u32 s66, s66, 1024
    s_mov_b32 m0, s66
    s_nop 0
    buffer_load_dwordx4 v5, s[48:51], s65 offen lds
    s_add_u32 s65, s65, 14336
    s_add_u32 s66, s66, 1024
    s_mov_b32 m0, s66
    s_nop 0
    buffer_load_dwordx4 v5, s[48:51], s65 offen lds
    s_add_u32 s65, s65, 14336
    s_add_u32 s66, s66, 1024
    s_mov_b32 m0, s66
    s_nop 0
    buffer_load_dwordx4 v5, s[48:51], s65 offen lds
    s_add_u32 s65, s65, 14336
    s_add_u32 s66, s66, 1024
    s_mov_b32 m0, s66
    s_nop 0
    buffer_load_dwordx4 v5, s[48:51], s65 offen lds
    s_add_u32 s65, s65, 14336
    s_add_u32 s66, s66, 1024
    s_mov_b32 m0, s66
    s_nop 0
    buffer_load_dwordx4 v5, s[48:51], s65 offen lds
    s_add_u32 s65, s65, 14336
    s_add_u32 s66, s66, 1024
    s_mov_b32 m0, s66
    s_nop 0
    buffer_load_dwordx4 v5, s[48:51], s65 offen lds
    s_add_u32 s65, s65, 14336
    s_add_u32 s66, s66, 1024
    s_mov_b32 m0, s66
    s_nop 0
    buffer_load_dwordx4 v5, s[48:51], s65 offen lds
    s_add_u32 s65, s65, 14336
    s_add_u32 s66, s66, 1024
    s_mov_b32 m0, s66
    s_nop 0
    buffer_load_dwordx4 v5, s[48:51], s65 offen lds
    s_add_u32 s65, s65, 14336
    s_add_u32 s66, s66, 1024
    s_mov_b32 m0, s66
    s_nop 0
    buffer_load_dwordx4 v5, s[48:51], s65 offen lds
    s_add_u32 s65, s65, 14336
    s_add_u32 s66, s66, 1024
    s_mov_b32 m0, s66
    s_nop 0
    buffer_load_dwordx4 v5, s[48:51], s65 offen lds
    s_add_u32 s65, s65, 14336
    s_add_u32 s66, s66, 1024
    s_mov_b32 m0, s66
    s_nop 0
    buffer_load_dwordx4 v5, s[48:51], s65 offen lds
    s_add_u32 s65, s65, 14336
    s_add_u32 s66, s66, 1024
    s_waitcnt vmcnt(0)
    s_barrier
    ds_read_b64_tr_b16 a[0:1], v6 offset:0
    ds_read_b64_tr_b16 a[2:3], v6 offset:512
    ds_read_b64_tr_b16 a[4:5], v6 offset:8192
    ds_read_b64_tr_b16 a[6:7], v6 offset:8704
    ds_read_b64_tr_b16 a[8:9], v6 offset:16384
    ds_read_b64_tr_b16 a[10:11], v6 offset:16896
    ds_read_b64_tr_b16 a[12:13], v6 offset:24576
    ds_read_b64_tr_b16 a[14:15], v6 offset:25088
    ds_read_b64_tr_b16 a[16:17], v6 offset:32768
    ds_read_b64_tr_b16 a[18:19], v6 offset:33280
    ds_read_b64_tr_b16 a[20:21], v6 offset:40960
    ds_read_b64_tr_b16 a[22:23], v6 offset:41472
    ds_read_b64_tr_b16 a[24:25], v6 offset:49152
    ds_read_b64_tr_b16 a[26:27], v6 offset:49664
    ds_read_b64_tr_b16 a[28:29], v7 offset:0
    ds_read_b64_tr_b16 a[30:31], v7 offset:512
    ds_read_b64_tr_b16 a[32:33], v7 offset:8192
    ds_read_b64_tr_b16 a[34:35], v7 offset:8704
    ds_read_b64_tr_b16 a[36:37], v7 offset:16384
    ds_read_b64_tr_b16 a[38:39], v7 offset:16896
    ds_read_b64_tr_b16 a[40:41], v7 offset:24576
    ds_read_b64_tr_b16 a[42:43], v7 offset:25088
    ds_read_b64_tr_b16 a[44:45], v7 offset:32768
    ds_read_b64_tr_b16 a[46:47], v7 offset:33280
    ds_read_b64_tr_b16 a[48:49], v7 offset:40960
    ds_read_b64_tr_b16 a[50:51], v7 offset:41472
    ds_read_b64_tr_b16 a[52:53], v7 offset:49152
    ds_read_b64_tr_b16 a[54:55], v7 offset:49664
    ds_read_b64_tr_b16 a[56:57], v6 offset:32
    ds_read_b64_tr_b16 a[58:59], v6 offset:544
    ds_read_b64_tr_b16 a[60:61], v6 offset:8224
    ds_read_b64_tr_b16 a[62:63], v6 offset:8736
    ds_read_b64_tr_b16 a[64:65], v6 offset:16416
    ds_read_b64_tr_b16 a[66:67], v6 offset:16928
    ds_read_b64_tr_b16 a[68:69], v6 offset:24608
    ds_read_b64_tr_b16 a[70:71], v6 offset:25120
    ds_read_b64_tr_b16 a[72:73], v6 offset:32800
    ds_read_b64_tr_b16 a[74:75], v6 offset:33312
    ds_read_b64_tr_b16 a[76:77], v6 offset:40992
    ds_read_b64_tr_b16 a[78:79], v6 offset:41504
    ds_read_b64_tr_b16 a[80:81], v6 offset:49184
    ds_read_b64_tr_b16 a[82:83], v6 offset:49696
    ds_read_b64_tr_b16 a[84:85], v7 offset:32
    ds_read_b64_tr_b16 a[86:87], v7 offset:544
    ds_read_b64_tr_b16 a[88:89], v7 offset:8224
    ds_read_b64_tr_b16 a[90:91], v7 offset:8736
    ds_read_b64_tr_b16 a[92:93], v7 offset:16416
    ds_read_b64_tr_b16 a[94:95], v7 offset:16928
    ds_read_b64_tr_b16 a[96:97], v7 offset:24608
    ds_read_b64_tr_b16 a[98:99], v7 offset:25120
    ds_read_b64_tr_b16 a[100:101], v7 offset:32800
    ds_read_b64_tr_b16 a[102:103], v7 offset:33312
    ds_read_b64_tr_b16 a[104:105], v7 offset:40992
    ds_read_b64_tr_b16 a[106:107], v7 offset:41504
    ds_read_b64_tr_b16 a[108:109], v7 offset:49184
    ds_read_b64_tr_b16 a[110:111], v7 offset:49696
    s_waitcnt lgkmcnt(0)
    s_barrier
    s_mul_i32 s65, s6, 401408
    s_lshl_b32 s66, s64, 8
    s_add_u32 s65, s65, s66
    s_mul_i32 s66, s6, 28672
    s_mov_b32 m0, s66
    s_nop 0
    buffer_load_dwordx4 v5, s[52:55], s65 offen lds
    s_add_u32 s65, s65, 14336
    s_add_u32 s66, s66, 1024
    s_mov_b32 m0, s66
    s_nop 0
    buffer_load_dwordx4 v5, s[52:55], s65 offen lds
    s_add_u32 s65, s65, 14336
    s_add_u32 s66, s66, 1024
    s_mov_b32 m0, s66
    s_nop 0
    buffer_load_dwordx4 v5, s[52:55], s65 offen lds
    s_add_u32 s65, s65, 14336
    s_add_u32 s66, s66, 1024
    s_mov_b32 m0, s66
    s_nop 0
    buffer_load_dwordx4 v5, s[52:55], s65 offen lds
    s_add_u32 s65, s65, 14336
    s_add_u32 s66, s66, 1024
    s_mov_b32 m0, s66
    s_nop 0
    buffer_load_dwordx4 v5, s[52:55], s65 offen lds
    s_add_u32 s65, s65, 14336
    s_add_u32 s66, s66, 1024
    s_mov_b32 m0, s66
    s_nop 0
    buffer_load_dwordx4 v5, s[52:55], s65 offen lds
    s_add_u32 s65, s65, 14336
    s_add_u32 s66, s66, 1024
    s_mov_b32 m0, s66
    s_nop 0
    buffer_load_dwordx4 v5, s[52:55], s65 offen lds
    s_add_u32 s65, s65, 14336
    s_add_u32 s66, s66, 1024
    s_mov_b32 m0, s66
    s_nop 0
    buffer_load_dwordx4 v5, s[52:55], s65 offen lds
    s_add_u32 s65, s65, 14336
    s_add_u32 s66, s66, 1024
    s_mov_b32 m0, s66
    s_nop 0
    buffer_load_dwordx4 v5, s[52:55], s65 offen lds
    s_add_u32 s65, s65, 14336
    s_add_u32 s66, s66, 1024
    s_mov_b32 m0, s66
    s_nop 0
    buffer_load_dwordx4 v5, s[52:55], s65 offen lds
    s_add_u32 s65, s65, 14336
    s_add_u32 s66, s66, 1024
    s_mov_b32 m0, s66
    s_nop 0
    buffer_load_dwordx4 v5, s[52:55], s65 offen lds
    s_add_u32 s65, s65, 14336
    s_add_u32 s66, s66, 1024
    s_mov_b32 m0, s66
    s_nop 0
    buffer_load_dwordx4 v5, s[52:55], s65 offen lds
    s_add_u32 s65, s65, 14336
    s_add_u32 s66, s66, 1024
    s_mov_b32 m0, s66
    s_nop 0
    buffer_load_dwordx4 v5, s[52:55], s65 offen lds
    s_add_u32 s65, s65, 14336
    s_add_u32 s66, s66, 1024
    s_mov_b32 m0, s66
    s_nop 0
    buffer_load_dwordx4 v5, s[52:55], s65 offen lds
    s_add_u32 s65, s65, 14336
    s_add_u32 s66, s66, 1024
    s_mov_b32 m0, s66
    s_nop 0
    buffer_load_dwordx4 v5, s[52:55], s65 offen lds
    s_add_u32 s65, s65, 14336
    s_add_u32 s66, s66, 1024
    s_mov_b32 m0, s66
    s_nop 0
    buffer_load_dwordx4 v5, s[52:55], s65 offen lds
    s_add_u32 s65, s65, 14336
    s_add_u32 s66, s66, 1024
    s_mov_b32 m0, s66
    s_nop 0
    buffer_load_dwordx4 v5, s[52:55], s65 offen lds
    s_add_u32 s65, s65, 14336
    s_add_u32 s66, s66, 1024
    s_mov_b32 m0, s66
    s_nop 0
    buffer_load_dwordx4 v5, s[52:55], s65 offen lds
    s_add_u32 s65, s65, 14336
    s_add_u32 s66, s66, 1024
    s_mov_b32 m0, s66
    s_nop 0
    buffer_load_dwordx4 v5, s[52:55], s65 offen lds
    s_add_u32 s65, s65, 14336
    s_add_u32 s66, s66, 1024
    s_mov_b32 m0, s66
    s_nop 0
    buffer_load_dwordx4 v5, s[52:55], s65 offen lds
    s_add_u32 s65, s65, 14336
    s_add_u32 s66, s66, 1024
    s_mov_b32 m0, s66
    s_nop 0
    buffer_load_dwordx4 v5, s[52:55], s65 offen lds
    s_add_u32 s65, s65, 14336
    s_add_u32 s66, s66, 1024
    s_mov_b32 m0, s66
    s_nop 0
    buffer_load_dwordx4 v5, s[52:55], s65 offen lds
    s_add_u32 s65, s65, 14336
    s_add_u32 s66, s66, 1024
    s_mov_b32 m0, s66
    s_nop 0
    buffer_load_dwordx4 v5, s[52:55], s65 offen lds
    s_add_u32 s65, s65, 14336
    s_add_u32 s66, s66, 1024
    s_mov_b32 m0, s66
    s_nop 0
    buffer_load_dwordx4 v5, s[52:55], s65 offen lds
    s_add_u32 s65, s65, 14336
    s_add_u32 s66, s66, 1024
    s_mov_b32 m0, s66
    s_nop 0
    buffer_load_dwordx4 v5, s[52:55], s65 offen lds
    s_add_u32 s65, s65, 14336
    s_add_u32 s66, s66, 1024
    s_mov_b32 m0, s66
    s_nop 0
    buffer_load_dwordx4 v5, s[52:55], s65 offen lds
    s_add_u32 s65, s65, 14336
    s_add_u32 s66, s66, 1024
    s_mov_b32 m0, s66
    s_nop 0
    buffer_load_dwordx4 v5, s[52:55], s65 offen lds
    s_add_u32 s65, s65, 14336
    s_add_u32 s66, s66, 1024
    s_mov_b32 m0, s66
    s_nop 0
    buffer_load_dwordx4 v5, s[52:55], s65 offen lds
    s_add_u32 s65, s65, 14336
    s_add_u32 s66, s66, 1024
    s_waitcnt vmcnt(0)
    s_barrier
    ds_read_b64_tr_b16 a[112:113], v6 offset:0
    ds_read_b64_tr_b16 a[114:115], v6 offset:512
    ds_read_b64_tr_b16 a[116:117], v6 offset:8192
    ds_read_b64_tr_b16 a[118:119], v6 offset:8704
    ds_read_b64_tr_b16 a[120:121], v6 offset:16384
    ds_read_b64_tr_b16 a[122:123], v6 offset:16896
    ds_read_b64_tr_b16 a[124:125], v6 offset:24576
    ds_read_b64_tr_b16 a[126:127], v6 offset:25088
    ds_read_b64_tr_b16 a[128:129], v6 offset:32768
    ds_read_b64_tr_b16 a[130:131], v6 offset:33280
    ds_read_b64_tr_b16 a[132:133], v6 offset:40960
    ds_read_b64_tr_b16 a[134:135], v6 offset:41472
    ds_read_b64_tr_b16 a[136:137], v6 offset:49152
    ds_read_b64_tr_b16 a[138:139], v6 offset:49664
    ds_read_b64_tr_b16 a[140:141], v7 offset:0
    ds_read_b64_tr_b16 a[142:143], v7 offset:512
    ds_read_b64_tr_b16 a[144:145], v7 offset:8192
    ds_read_b64_tr_b16 a[146:147], v7 offset:8704
    ds_read_b64_tr_b16 a[148:149], v7 offset:16384
    ds_read_b64_tr_b16 a[150:151], v7 offset:16896
    ds_read_b64_tr_b16 a[152:153], v7 offset:24576
    ds_read_b64_tr_b16 a[154:155], v7 offset:25088
    ds_read_b64_tr_b16 a[156:157], v7 offset:32768
    ds_read_b64_tr_b16 a[158:159], v7 offset:33280
    ds_read_b64_tr_b16 a[160:161], v7 offset:40960
    ds_read_b64_tr_b16 a[162:163], v7 offset:41472
    ds_read_b64_tr_b16 a[164:165], v7 offset:49152
    ds_read_b64_tr_b16 a[166:167], v7 offset:49664
    ds_read_b64_tr_b16 a[168:169], v6 offset:32
    ds_read_b64_tr_b16 a[170:171], v6 offset:544
    ds_read_b64_tr_b16 a[172:173], v6 offset:8224
    ds_read_b64_tr_b16 a[174:175], v6 offset:8736
    ds_read_b64_tr_b16 a[176:177], v6 offset:16416
    ds_read_b64_tr_b16 a[178:179], v6 offset:16928
    ds_read_b64_tr_b16 a[180:181], v6 offset:24608
    ds_read_b64_tr_b16 a[182:183], v6 offset:25120
    ds_read_b64_tr_b16 a[184:185], v6 offset:32800
    ds_read_b64_tr_b16 a[186:187], v6 offset:33312
    ds_read_b64_tr_b16 a[188:189], v6 offset:40992
    ds_read_b64_tr_b16 a[190:191], v6 offset:41504
    ds_read_b64_tr_b16 a[192:193], v6 offset:49184
    ds_read_b64_tr_b16 a[194:195], v6 offset:49696
    ds_read_b64_tr_b16 a[196:197], v7 offset:32
    ds_read_b64_tr_b16 a[198:199], v7 offset:544
    ds_read_b64_tr_b16 a[200:201], v7 offset:8224
    ds_read_b64_tr_b16 a[202:203], v7 offset:8736
    ds_read_b64_tr_b16 a[204:205], v7 offset:16416
    ds_read_b64_tr_b16 a[206:207], v7 offset:16928
    ds_read_b64_tr_b16 a[208:209], v7 offset:24608
    ds_read_b64_tr_b16 a[210:211], v7 offset:25120
    ds_read_b64_tr_b16 a[212:213], v7 offset:32800
    ds_read_b64_tr_b16 a[214:215], v7 offset:33312
    ds_read_b64_tr_b16 a[216:217], v7 offset:40992
    ds_read_b64_tr_b16 a[218:219], v7 offset:41504
    ds_read_b64_tr_b16 a[220:221], v7 offset:49184
    ds_read_b64_tr_b16 a[222:223], v7 offset:49696
    s_waitcnt lgkmcnt(0)
    s_barrier
    s_mov_b32 s10, 0
    s_mov_b32 s11, 28672
    s_lshl_b32 s12, s64, 2
    s_add_u32 s12, s12, s6
    s_lshl_b32 s12, s12, 11
    s_add_u32 s12, s12, 75235328
    s_mov_b32 s13, 114688
    s_mov_b32 s14, 95031296
    s_mov_b32 s64, s8
    s_mul_i32 s71, s6, 7168
    s_add_u32 s10, s10, s71
    s_add_u32 s73, s71, 86016
    s_mov_b32 s72, 0
    s_min_u32 s65, s64, 63
    s_mul_i32 s65, s65, s11
    s_add_u32 s65, s65, s10
    s_add_u32 s69, s65, 0
    s_add_u32 m0, s71, 0
    s_nop 0
    buffer_load_dwordx4 v1, s[44:47], s69 offen offset:0 lds
    buffer_load_dwordx4 v1, s[44:47], s69 offen offset:1024 lds
    buffer_load_dwordx4 v1, s[44:47], s69 offen offset:2048 lds
    buffer_load_dwordx4 v1, s[44:47], s69 offen offset:3072 lds
    s_add_u32 s69, s65, 4096
    s_add_u32 m0, s71, 4096
    s_nop 0
    buffer_load_dwordx4 v1, s[44:47], s69 offen offset:0 lds
    buffer_load_dwordx4 v1, s[44:47], s69 offen offset:1024 lds
    buffer_load_dwordx4 v1, s[44:47], s69 offen offset:2048 lds
    s_add_u32 s71, s71, 28672
    s_cmp_ge_u32 s71, s73
    s_cselect_b32 s69, 86016, 0
    s_sub_u32 s71, s71, s69
    s_add_u32 s70, s64, s9
    s_min_u32 s65, s70, 63
    s_mul_i32 s65, s65, s11
    s_add_u32 s65, s65, s10
    s_add_u32 s69, s65, 0
    s_add_u32 m0, s71, 0
    s_nop 0
    buffer_load_dwordx4 v1, s[44:47], s69 offen offset:0 lds
    buffer_load_dwordx4 v1, s[44:47], s69 offen offset:1024 lds
    buffer_load_dwordx4 v1, s[44:47], s69 offen offset:2048 lds
    buffer_load_dwordx4 v1, s[44:47], s69 offen offset:3072 lds
    s_add_u32 s69, s65, 4096
    s_add_u32 m0, s71, 4096
    s_nop 0
    buffer_load_dwordx4 v1, s[44:47], s69 offen offset:0 lds
    buffer_load_dwordx4 v1, s[44:47], s69 offen offset:1024 lds
    buffer_load_dwordx4 v1, s[44:47], s69 offen offset:2048 lds
    s_add_u32 s71, s71, 28672
    s_cmp_ge_u32 s71, s73
    s_cselect_b32 s69, 86016, 0
    s_sub_u32 s71, s71, s69
    s_mov_b32 s67, -1
    s_waitcnt vmcnt(7)
eng_gu_loop:
    s_add_u32 s68, s64, s9
    v_add_u32 v16, s72, v1
    s_barrier
    ds_read_b128 v[128:131], v16 offset:0
    ds_read_b128 v[132:135], v16 offset:14336
    ds_read_b128 v[136:139], v16 offset:1024
    ds_read_b128 v[140:143], v16 offset:15360
    ds_read_b128 v[144:147], v16 offset:2048
    s_add_u32 s70, s68, s9
    s_min_u32 s65, s70, 63
    s_mul_i32 s65, s65, s11
    s_add_u32 s65, s65, s10
    s_add_u32 s72, s72, 28672
    s_cmp_ge_u32 s72, 86016
    s_cselect_b32 s72, 0, s72
    s_mul_i32 s66, s64, s13
    s_add_u32 s66, s66, s12
    s_waitcnt lgkmcnt(4)
    v_mfma_f32_16x16x32_bf16 v[64:67], a[0:3], v[128:131], 0
    ds_read_b128 v[148:151], v16 offset:16384
    v_mfma_f32_16x16x32_bf16 v[68:71], a[56:59], v[128:131], 0
    v_mfma_f32_16x16x32_bf16 v[72:75], a[112:115], v[128:131], 0
    s_add_u32 s69, s65, 0
    s_add_u32 m0, s71, 0
    s_nop 0
    buffer_load_dwordx4 v1, s[44:47], s69 offen offset:0 lds
    v_mfma_f32_16x16x32_bf16 v[76:79], a[168:171], v[128:131], 0
    s_waitcnt lgkmcnt(4)
    v_mfma_f32_16x16x32_bf16 v[80:83], a[0:3], v[132:135], 0
    ds_read_b128 v[128:131], v16 offset:3072
    v_mfma_f32_16x16x32_bf16 v[84:87], a[56:59], v[132:135], 0
    v_mfma_f32_16x16x32_bf16 v[88:91], a[112:115], v[132:135], 0
    buffer_load_dwordx4 v1, s[44:47], s69 offen offset:1024 lds
    v_mfma_f32_16x16x32_bf16 v[92:95], a[168:171], v[132:135], 0
    s_waitcnt lgkmcnt(4)
    v_mfma_f32_16x16x32_bf16 v[64:67], a[4:7], v[136:139], v[64:67]
    ds_read_b128 v[132:135], v16 offset:17408
    v_mfma_f32_16x16x32_bf16 v[68:71], a[60:63], v[136:139], v[68:71]
    v_mfma_f32_16x16x32_bf16 v[72:75], a[116:119], v[136:139], v[72:75]
    buffer_load_dwordx4 v1, s[44:47], s69 offen offset:2048 lds
    v_mfma_f32_16x16x32_bf16 v[76:79], a[172:175], v[136:139], v[76:79]
    s_waitcnt lgkmcnt(4)
    v_mfma_f32_16x16x32_bf16 v[80:83], a[4:7], v[140:143], v[80:83]
    ds_read_b128 v[136:139], v16 offset:4096
    v_mfma_f32_16x16x32_bf16 v[84:87], a[60:63], v[140:143], v[84:87]
    v_mfma_f32_16x16x32_bf16 v[88:91], a[116:119], v[140:143], v[88:91]
    buffer_load_dwordx4 v1, s[44:47], s69 offen offset:3072 lds
    v_mfma_f32_16x16x32_bf16 v[92:95], a[172:175], v[140:143], v[92:95]
    s_waitcnt lgkmcnt(4)
    v_mfma_f32_16x16x32_bf16 v[64:67], a[8:11], v[144:147], v[64:67]
    ds_read_b128 v[140:143], v16 offset:18432
    v_mfma_f32_16x16x32_bf16 v[68:71], a[64:67], v[144:147], v[68:71]
    v_mfma_f32_16x16x32_bf16 v[72:75], a[120:123], v[144:147], v[72:75]
    s_add_u32 s69, s65, 4096
    s_add_u32 m0, s71, 4096
    s_nop 0
    buffer_load_dwordx4 v1, s[44:47], s69 offen offset:0 lds
    v_mfma_f32_16x16x32_bf16 v[76:79], a[176:179], v[144:147], v[76:79]
    s_waitcnt lgkmcnt(4)
    v_mfma_f32_16x16x32_bf16 v[80:83], a[8:11], v[148:151], v[80:83]
    ds_read_b128 v[144:147], v16 offset:5120
    v_mfma_f32_16x16x32_bf16 v[84:87], a[64:67], v[148:151], v[84:87]
    v_mfma_f32_16x16x32_bf16 v[88:91], a[120:123], v[148:151], v[88:91]
    buffer_load_dwordx4 v1, s[44:47], s69 offen offset:1024 lds
    v_mfma_f32_16x16x32_bf16 v[92:95], a[176:179], v[148:151], v[92:95]
    s_waitcnt lgkmcnt(4)
    v_mfma_f32_16x16x32_bf16 v[64:67], a[12:15], v[128:131], v[64:67]
    ds_read_b128 v[148:151], v16 offset:19456
    v_mfma_f32_16x16x32_bf16 v[68:71], a[68:71], v[128:131], v[68:71]
    v_mfma_f32_16x16x32_bf16 v[72:75], a[124:127], v[128:131], v[72:75]
    buffer_load_dwordx4 v1, s[44:47], s69 offen offset:2048 lds
    v_mfma_f32_16x16x32_bf16 v[76:79], a[180:183], v[128:131], v[76:79]
    s_waitcnt lgkmcnt(4)
    v_mfma_f32_16x16x32_bf16 v[80:83], a[12:15], v[132:135], v[80:83]
    ds_read_b128 v[128:131], v16 offset:6144
    v_mfma_f32_16x16x32_bf16 v[84:87], a[68:71], v[132:135], v[84:87]
    v_mfma_f32_16x16x32_bf16 v[88:91], a[124:127], v[132:135], v[88:91]
    v_mfma_f32_16x16x32_bf16 v[92:95], a[180:183], v[132:135], v[92:95]
    s_add_u32 s71, s71, 28672
    s_cmp_ge_u32 s71, s73
    s_cselect_b32 s69, 86016, 0
    s_sub_u32 s71, s71, s69
    s_waitcnt lgkmcnt(4)
    v_mfma_f32_16x16x32_bf16 v[64:67], a[16:19], v[136:139], v[64:67]
    ds_read_b128 v[132:135], v16 offset:20480
    v_mfma_f32_16x16x32_bf16 v[68:71], a[72:75], v[136:139], v[68:71]
    v_mfma_f32_16x16x32_bf16 v[72:75], a[128:131], v[136:139], v[72:75]
    v_mfma_f32_16x16x32_bf16 v[76:79], a[184:187], v[136:139], v[76:79]
    s_waitcnt lgkmcnt(4)
    v_mfma_f32_16x16x32_bf16 v[80:83], a[16:19], v[140:143], v[80:83]
    ds_read_b128 v[136:139], v16 offset:7168
    v_mfma_f32_16x16x32_bf16 v[84:87], a[72:75], v[140:143], v[84:87]
    v_mfma_f32_16x16x32_bf16 v[88:91], a[128:131], v[140:143], v[88:91]
    v_mfma_f32_16x16x32_bf16 v[92:95], a[184:187], v[140:143], v[92:95]
    s_waitcnt lgkmcnt(4)
    v_mfma_f32_16x16x32_bf16 v[64:67], a[20:23], v[144:147], v[64:67]
    ds_read_b128 v[140:143], v16 offset:21504
    v_mfma_f32_16x16x32_bf16 v[68:71], a[76:79], v[144:147], v[68:71]
    v_mfma_f32_16x16x32_bf16 v[72:75], a[132:135], v[144:147], v[72:75]
    v_mfma_f32_16x16x32_bf16 v[76:79], a[188:191], v[144:147], v[76:79]
    s_waitcnt lgkmcnt(4)
    v_mfma_f32_16x16x32_bf16 v[80:83], a[20:23], v[148:151], v[80:83]
    ds_read_b128 v[144:147], v16 offset:8192
    v_mfma_f32_16x16x32_bf16 v[84:87], a[76:79], v[148:151], v[84:87]
    v_mfma_f32_16x16x32_bf16 v[88:91], a[132:135], v[148:151], v[88:91]
    v_mfma_f32_16x16x32_bf16 v[92:95], a[188:191], v[148:151], v[92:95]
    s_waitcnt vmcnt(7)
    s_barrier
    s_cmp_eq_u32 s67, -1
    s_cbranch_scc1 ns_54
    s_cmp_lg_u32 s6, 0
    s_cbranch_scc1 sg_55
    s_mov_b64 exec, 1
    v_mov_b32 v13, 1
    buffer_atomic_add v13, v2, s[44:47], s67 offen sc1
    s_mov_b64 exec, -1
sg_55:
ns_54:
    s_waitcnt lgkmcnt(4)
    v_mfma_f32_16x16x32_bf16 v[64:67], a[24:27], v[128:131], v[64:67]
    ds_read_b128 v[148:151], v16 offset:22528
    v_mfma_f32_16x16x32_bf16 v[68:71], a[80:83], v[128:131], v[68:71]
    v_mfma_f32_16x16x32_bf16 v[72:75], a[136:139], v[128:131], v[72:75]
    v_mfma_f32_16x16x32_bf16 v[76:79], a[192:195], v[128:131], v[76:79]
    s_waitcnt lgkmcnt(4)
    v_mfma_f32_16x16x32_bf16 v[80:83], a[24:27], v[132:135], v[80:83]
    ds_read_b128 v[128:131], v16 offset:9216
    v_mfma_f32_16x16x32_bf16 v[84:87], a[80:83], v[132:135], v[84:87]
    v_mfma_f32_16x16x32_bf16 v[88:91], a[136:139], v[132:135], v[88:91]
    v_mfma_f32_16x16x32_bf16 v[92:95], a[192:195], v[132:135], v[92:95]
    s_waitcnt lgkmcnt(4)
    v_mfma_f32_16x16x32_bf16 v[64:67], a[28:31], v[136:139], v[64:67]
    ds_read_b128 v[132:135], v16 offset:23552
    v_mfma_f32_16x16x32_bf16 v[68:71], a[84:87], v[136:139], v[68:71]
    v_mfma_f32_16x16x32_bf16 v[72:75], a[140:143], v[136:139], v[72:75]
    v_mfma_f32_16x16x32_bf16 v[76:79], a[196:199], v[136:139], v[76:79]
    s_waitcnt lgkmcnt(4)
    v_mfma_f32_16x16x32_bf16 v[80:83], a[28:31], v[140:143], v[80:83]
    ds_read_b128 v[136:139], v16 offset:10240
    v_mfma_f32_16x16x32_bf16 v[84:87], a[84:87], v[140:143], v[84:87]
    v_mfma_f32_16x16x32_bf16 v[88:91], a[140:143], v[140:143], v[88:91]
    v_mfma_f32_16x16x32_bf16 v[92:95], a[196:199], v[140:143], v[92:95]
    s_waitcnt lgkmcnt(4)
    v_mfma_f32_16x16x32_bf16 v[64:67], a[32:35], v[144:147], v[64:67]
    ds_read_b128 v[140:143], v16 offset:24576
    v_mfma_f32_16x16x32_bf16 v[68:71], a[88:91], v[144:147], v[68:71]
    v_mfma_f32_16x16x32_bf16 v[72:75], a[144:147], v[144:147], v[72:75]
    v_mfma_f32_16x16x32_bf16 v[76:79], a[200:203], v[144:147], v[76:79]
    s_waitcnt lgkmcnt(4)
    v_mfma_f32_16x16x32_bf16 v[80:83], a[32:35], v[148:151], v[80:83]
    ds_read_b128 v[144:147], v16 offset:11264
    v_mfma_f32_16x16x32_bf16 v[84:87], a[88:91], v[148:151], v[84:87]
    v_mfma_f32_16x16x32_bf16 v[88:91], a[144:147], v[148:151], v[88:91]
    v_mfma_f32_16x16x32_bf16 v[92:95], a[200:203], v[148:151], v[92:95]
    s_waitcnt lgkmcnt(4)
    v_mfma_f32_16x16x32_bf16 v[64:67], a[36:39], v[128:131], v[64:67]
    ds_read_b128 v[148:151], v16 offset:25600
    v_mfma_f32_16x16x32_bf16 v[68:71], a[92:95], v[128:131], v[68:71]
    v_mfma_f32_16x16x32_bf16 v[72:75], a[148:151], v[128:131], v[72:75]
    v_mfma_f32_16x16x32_bf16 v[76:79], a[204:207], v[128:131], v[76:79]
    s_waitcnt lgkmcnt(4)
    v_mfma_f32_16x16x32_bf16 v[80:83], a[36:39], v[132:135], v[80:83]
    ds_read_b128 v[128:131], v16 offset:12288
    v_mfma_f32_16x16x32_bf16 v[84:87], a[92:95], v[132:135], v[84:87]
    v_mfma_f32_16x16x32_bf16 v[88:91], a[148:151], v[132:135], v[88:91]
    v_mfma_f32_16x16x32_bf16 v[92:95], a[204:207], v[132:135], v[92:95]
    s_waitcnt lgkmcnt(4)
    v_mfma_f32_16x16x32_bf16 v[64:67], a[40:43], v[136:139], v[64:67]
    ds_read_b128 v[132:135], v16 offset:26624
    v_mfma_f32_16x16x32_bf16 v[68:71], a[96:99], v[136:139], v[68:71]
    v_mfma_f32_16x16x32_bf16 v[72:75], a[152:155], v[136:139], v[72:75]
    v_mfma_f32_16x16x32_bf16 v[76:79], a[208:211], v[136:139], v[76:79]
    s_waitcnt lgkmcnt(4)
    v_mfma_f32_16x16x32_bf16 v[80:83], a[40:43], v[140:143], v[80:83]
    ds_read_b128 v[136:139], v16 offset:13312
    v_mfma_f32_16x16x32_bf16 v[84:87], a[96:99], v[140:143], v[84:87]
    v_mfma_f32_16x16x32_bf16 v[88:91], a[152:155], v[140:143], v[88:91]
    v_mfma_f32_16x16x32_bf16 v[92:95], a[208:211], v[140:143], v[92:95]
    s_waitcnt lgkmcnt(4)
    v_mfma_f32_16x16x32_bf16 v[64:67], a[44:47], v[144:147], v[64:67]
    ds_read_b128 v[140:143], v16 offset:27648
    v_mfma_f32_16x16x32_bf16 v[68:71], a[100:103], v[144:147], v[68:71]
    v_mfma_f32_16x16x32_bf16 v[72:75], a[156:159], v[144:147], v[72:75]
    v_mfma_f32_16x16x32_bf16 v[76:79], a[212:215], v[144:147], v[76:79]
    s_waitcnt lgkmcnt(4)
    v_mfma_f32_16x16x32_bf16 v[80:83], a[44:47], v[148:151], v[80:83]
    v_mfma_f32_16x16x32_bf16 v[84:87], a[100:103], v[148:151], v[84:87]
    v_mfma_f32_16x16x32_bf16 v[88:91], a[156:159], v[148:151], v[88:91]
    v_mfma_f32_16x16x32_bf16 v[92:95], a[212:215], v[148:151], v[92:95]
    s_waitcnt lgkmcnt(3)
    v_mfma_f32_16x16x32_bf16 v[64:67], a[48:51], v[128:131], v[64:67]
    v_mfma_f32_16x16x32_bf16 v[68:71], a[104:107], v[128:131], v[68:71]
    v_mfma_f32_16x16x32_bf16 v[72:75], a[160:163], v[128:131], v[72:75]
    v_mfma_f32_16x16x32_bf16 v[76:79], a[216:219], v[128:131], v[76:79]
    s_waitcnt lgkmcnt(2)
    v_mfma_f32_16x16x32_bf16 v[80:83], a[48:51], v[132:135], v[80:83]
    v_mfma_f32_16x16x32_bf16 v[84:87], a[104:107], v[132:135], v[84:87]
    v_mfma_f32_16x16x32_bf16 v[88:91], a[160:163], v[132:135], v[88:91]
    v_mfma_f32_16x16x32_bf16 v[92:95], a[216:219], v[132:135], v[92:95]
    s_waitcnt lgkmcnt(1)
    v_mfma_f32_16x16x32_bf16 v[64:67], a[52:55], v[136:139], v[64:67]
    v_mfma_f32_16x16x32_bf16 v[68:71], a[108:111], v[136:139], v[68:71]
    v_mfma_f32_16x16x32_bf16 v[72:75], a[164:167], v[136:139], v[72:75]
    v_mfma_f32_16x16x32_bf16 v[76:79], a[220:223], v[136:139], v[76:79]
    s_waitcnt lgkmcnt(0)
    v_mfma_f32_16x16x32_bf16 v[80:83], a[52:55], v[140:143], v[80:83]
    v_mfma_f32_16x16x32_bf16 v[84:87], a[108:111], v[140:143], v[84:87]
    v_mfma_f32_16x16x32_bf16 v[88:91], a[164:167], v[140:143], v[88:91]
    v_mfma_f32_16x16x32_bf16 v[92:95], a[220:223], v[140:143], v[92:95]
    v_cvt_pk_bf16_f32 v104, v64, v65
    v_lshlrev_b32 v64, 16, v104
    v_and_b32 v65, 0xffff0000, v104
    v_cvt_pk_bf16_f32 v105, v72, v73
    v_lshlrev_b32 v72, 16, v105
    v_and_b32 v73, 0xffff0000, v105
    v_mul_f32 v106, 0xbfb8aa3b, v64
    v_exp_f32 v106, v106
    s_nop 0
    v_add_f32 v106, 1.0, v106
    v_rcp_f32 v106, v106
    s_nop 0
    v_mul_f32 v64, v64, v106
    v_mul_f32 v107, 0xbfb8aa3b, v65
    v_exp_f32 v107, v107
    s_nop 0
    v_add_f32 v107, 1.0, v107
    v_rcp_f32 v107, v107
    s_nop 0
    v_mul_f32 v65, v65, v107
    v_cvt_pk_bf16_f32 v104, v64, v65
    v_lshlrev_b32 v64, 16, v104
    v_and_b32 v65, 0xffff0000, v104
    v_mul_f32 v64, v64, v72
    v_mul_f32 v65, v65, v73
    v_cvt_pk_bf16_f32 v96, v64, v65
    v_cvt_pk_bf16_f32 v104, v66, v67
    v_lshlrev_b32 v66, 16, v104
    v_and_b32 v67, 0xffff0000, v104
    v_cvt_pk_bf16_f32 v105, v74, v75
    v_lshlrev_b32 v74, 16, v105
    v_and_b32 v75, 0xffff0000, v105
    v_mul_f32 v106, 0xbfb8aa3b, v66
    v_exp_f32 v106, v106
    s_nop 0
    v_add_f32 v106, 1.0, v106
    v_rcp_f32 v106, v106
    s_nop 0
    v_mul_f32 v66, v66, v106
    v_mul_f32 v107, 0xbfb8aa3b, v67
    v_exp_f32 v107, v107
    s_nop 0
    v_add_f32 v107, 1.0, v107
    v_rcp_f32 v107, v107
    s_nop 0
    v_mul_f32 v67, v67, v107
    v_cvt_pk_bf16_f32 v104, v66, v67
    v_lshlrev_b32 v66, 16, v104
    v_and_b32 v67, 0xffff0000, v104
    v_mul_f32 v66, v66, v74
    v_mul_f32 v67, v67, v75
    v_cvt_pk_bf16_f32 v97, v66, v67
    v_cvt_pk_bf16_f32 v104, v68, v69
    v_lshlrev_b32 v68, 16, v104
    v_and_b32 v69, 0xffff0000, v104
    v_cvt_pk_bf16_f32 v105, v76, v77
    v_lshlrev_b32 v76, 16, v105
    v_and_b32 v77, 0xffff0000, v105
    v_mul_f32 v106, 0xbfb8aa3b, v68
    v_exp_f32 v106, v106
    s_nop 0
    v_add_f32 v106, 1.0, v106
    v_rcp_f32 v106, v106
    s_nop 0
    v_mul_f32 v68, v68, v106
    v_mul_f32 v107, 0xbfb8aa3b, v69
    v_exp_f32 v107, v107
    s_nop 0
    v_add_f32 v107, 1.0, v107
    v_rcp_f32 v107, v107
    s_nop 0
    v_mul_f32 v69, v69, v107
    v_cvt_pk_bf16_f32 v104, v68, v69
    v_lshlrev_b32 v68, 16, v104
    v_and_b32 v69, 0xffff0000, v104
    v_mul_f32 v68, v68, v76
    v_mul_f32 v69, v69, v77
    v_cvt_pk_bf16_f32 v98, v68, v69
    v_cvt_pk_bf16_f32 v104, v70, v71
    v_lshlrev_b32 v70, 16, v104
    v_and_b32 v71, 0xffff0000, v104
    v_cvt_pk_bf16_f32 v105, v78, v79
    v_lshlrev_b32 v78, 16, v105
    v_and_b32 v79, 0xffff0000, v105
    v_mul_f32 v106, 0xbfb8aa3b, v70
    v_exp_f32 v106, v106
    s_nop 0
    v_add_f32 v106, 1.0, v106
    v_rcp_f32 v106, v106
    s_nop 0
    v_mul_f32 v70, v70, v106
    v_mul_f32 v107, 0xbfb8aa3b, v71
    v_exp_f32 v107, v107
    s_nop 0
    v_add_f32 v107, 1.0, v107
    v_rcp_f32 v107, v107
    s_nop 0
    v_mul_f32 v71, v71, v107
    v_cvt_pk_bf16_f32 v104, v70, v71
    v_lshlrev_b32 v70, 16, v104
    v_and_b32 v71, 0xffff0000, v104
    v_mul_f32 v70, v70, v78
    v_mul_f32 v71, v71, v79
    v_cvt_pk_bf16_f32 v99, v70, v71
    buffer_store_dwordx4 v[96:99], v1, s[44:47], s66 offen offset:0 sc1
    v_cvt_pk_bf16_f32 v104, v80, v81
    v_lshlrev_b32 v80, 16, v104
    v_and_b32 v81, 0xffff0000, v104
    v_cvt_pk_bf16_f32 v105, v88, v89
    v_lshlrev_b32 v88, 16, v105
    v_and_b32 v89, 0xffff0000, v105
    v_mul_f32 v106, 0xbfb8aa3b, v80
    v_exp_f32 v106, v106
    s_nop 0
    v_add_f32 v106, 1.0, v106
    v_rcp_f32 v106, v106
    s_nop 0
    v_mul_f32 v80, v80, v106
    v_mul_f32 v107, 0xbfb8aa3b, v81
    v_exp_f32 v107, v107
    s_nop 0
    v_add_f32 v107, 1.0, v107
    v_rcp_f32 v107, v107
    s_nop 0
    v_mul_f32 v81, v81, v107
    v_cvt_pk_bf16_f32 v104, v80, v81
    v_lshlrev_b32 v80, 16, v104
    v_and_b32 v81, 0xffff0000, v104
    v_mul_f32 v80, v80, v88
    v_mul_f32 v81, v81, v89
    v_cvt_pk_bf16_f32 v100, v80, v81
    v_cvt_pk_bf16_f32 v104, v82, v83
    v_lshlrev_b32 v82, 16, v104
    v_and_b32 v83, 0xffff0000, v104
    v_cvt_pk_bf16_f32 v105, v90, v91
    v_lshlrev_b32 v90, 16, v105
    v_and_b32 v91, 0xffff0000, v105
    v_mul_f32 v106, 0xbfb8aa3b, v82
    v_exp_f32 v106, v106
    s_nop 0
    v_add_f32 v106, 1.0, v106
    v_rcp_f32 v106, v106
    s_nop 0
    v_mul_f32 v82, v82, v106
    v_mul_f32 v107, 0xbfb8aa3b, v83
    v_exp_f32 v107, v107
    s_nop 0
    v_add_f32 v107, 1.0, v107
    v_rcp_f32 v107, v107
    s_nop 0
    v_mul_f32 v83, v83, v107
    v_cvt_pk_bf16_f32 v104, v82, v83
    v_lshlrev_b32 v82, 16, v104
    v_and_b32 v83, 0xffff0000, v104
    v_mul_f32 v82, v82, v90
    v_mul_f32 v83, v83, v91
    v_cvt_pk_bf16_f32 v101, v82, v83
    v_cvt_pk_bf16_f32 v104, v84, v85
    v_lshlrev_b32 v84, 16, v104
    v_and_b32 v85, 0xffff0000, v104
    v_cvt_pk_bf16_f32 v105, v92, v93
    v_lshlrev_b32 v92, 16, v105
    v_and_b32 v93, 0xffff0000, v105
    v_mul_f32 v106, 0xbfb8aa3b, v84
    v_exp_f32 v106, v106
    s_nop 0
    v_add_f32 v106, 1.0, v106
    v_rcp_f32 v106, v106
    s_nop 0
    v_mul_f32 v84, v84, v106
    v_mul_f32 v107, 0xbfb8aa3b, v85
    v_exp_f32 v107, v107
    s_nop 0
    v_add_f32 v107, 1.0, v107
    v_rcp_f32 v107, v107
    s_nop 0
    v_mul_f32 v85, v85, v107
    v_cvt_pk_bf16_f32 v104, v84, v85
    v_lshlrev_b32 v84, 16, v104
    v_and_b32 v85, 0xffff0000, v104
    v_mul_f32 v84, v84, v92
    v_mul_f32 v85, v85, v93
    v_cvt_pk_bf16_f32 v102, v84, v85
    v_cvt_pk_bf16_f32 v104, v86, v87
    v_lshlrev_b32 v86, 16, v104
    v_and_b32 v87, 0xffff0000, v104
    v_cvt_pk_bf16_f32 v105, v94, v95
    v_lshlrev_b32 v94, 16, v105
    v_and_b32 v95, 0xffff0000, v105
    v_mul_f32 v106, 0xbfb8aa3b, v86
    v_exp_f32 v106, v106
    s_nop 0
    v_add_f32 v106, 1.0, v106
    v_rcp_f32 v106, v106
    s_nop 0
    v_mul_f32 v86, v86, v106
    v_mul_f32 v107, 0xbfb8aa3b, v87
    v_exp_f32 v107, v107
    s_nop 0
    v_add_f32 v107, 1.0, v107
    v_rcp_f32 v107, v107
    s_nop 0
    v_mul_f32 v87, v87, v107
    v_cvt_pk_bf16_f32 v104, v86, v87
    v_lshlrev_b32 v86, 16, v104
    v_and_b32 v87, 0xffff0000, v104
    v_mul_f32 v86, v86, v94
    v_mul_f32 v87, v87, v95
    v_cvt_pk_bf16_f32 v103, v86, v87
    buffer_store_dwordx4 v[100:103], v1, s[44:47], s66 offen offset:1024 sc1
    s_lshl_b32 s67, s64, 7
    s_add_u32 s67, s67, s14
    s_mov_b32 s75, s66
    s_mov_b32 s64, s68
    s_cmp_lt_u32 s64, 64
    s_cbranch_scc1 eng_gu_loop
    s_waitcnt vmcnt(0)
    s_barrier
    s_cmp_lg_u32 s6, 0
    s_cbranch_scc1 sg_56
    s_mov_b64 exec, 1
    v_mov_b32 v13, 1
    buffer_atomic_add v13, v2, s[44:47], s67 offen sc1
    s_mov_b64 exec, -1
sg_56:
    s_mul_i32 s8, s7, 9363
    s_lshr_b32 s8, s8, 16
    s_mul_i32 s64, s8, 7
    s_sub_u32 s64, s7, s64
    s_mov_b32 s9, 8
    s_mov_b32 s48, s36
    s_and_b32 s49, s37, 0xffff
    s_mov_b32 s50, 0x188000
    s_mov_b32 s51, 0x20000
    v_lshrrev_b32 v5, 3, v0
    v_mul_u32_u24 v5, 896, v5
    v_and_b32 v6, 7, v0
    v_lshl_add_u32 v5, v6, 4, v5
    v_lshrrev_b32 v6, 2, v3
    v_lshl_add_u32 v6, v4, 2, v6
    v_lshlrev_b32 v6, 7, v6
    v_and_b32 v7, 3, v3
    v_lshl_add_u32 v6, v7, 3, v6
    s_mul_i32 s65, s6, 28672
    v_add_u32 v6, s65, v6
    s_mul_i32 s65, s6, 401408
    s_lshl_b32 s66, s64, 7
    s_add_u32 s65, s65, s66
    s_mul_i32 s66, s6, 28672
    s_mov_b32 m0, s66
    s_nop 0
    buffer_load_dwordx4 v5, s[48:51], s65 offen lds
    s_add_u32 s65, s65, 7168
    s_add_u32 s66, s66, 1024
    s_mov_b32 m0, s66
    s_nop 0
    buffer_load_dwordx4 v5, s[48:51], s65 offen lds
    s_add_u32 s65, s65, 7168
    s_add_u32 s66, s66, 1024
    s_mov_b32 m0, s66
    s_nop 0
    buffer_load_dwordx4 v5, s[48:51], s65 offen lds
    s_add_u32 s65, s65, 7168
    s_add_u32 s66, s66, 1024
    s_mov_b32 m0, s66
    s_nop 0
    buffer_load_dwordx4 v5, s[48:51], s65 offen lds
    s_add_u32 s65, s65, 7168
    s_add_u32 s66, s66, 1024
    s_mov_b32 m0, s66
    s_nop 0
    buffer_load_dwordx4 v5, s[48:51], s65 offen lds
    s_add_u32 s65, s65, 7168
    s_add_u32 s66, s66, 1024
    s_mov_b32 m0, s66
    s_nop 0
    buffer_load_dwordx4 v5, s[48:51], s65 offen lds
    s_add_u32 s65, s65, 7168
    s_add_u32 s66, s66, 1024
    s_mov_b32 m0, s66
    s_nop 0
    buffer_load_dwordx4 v5, s[48:51], s65 offen lds
    s_add_u32 s65, s65, 7168
    s_add_u32 s66, s66, 1024
    s_mov_b32 m0, s66
    s_nop 0
    buffer_load_dwordx4 v5, s[48:51], s65 offen lds
    s_add_u32 s65, s65, 7168
    s_add_u32 s66, s66, 1024
    s_mov_b32 m0, s66
    s_nop 0
    buffer_load_dwordx4 v5, s[48:51], s65 offen lds
    s_add_u32 s65, s65, 7168
    s_add_u32 s66, s66, 1024
    s_mov_b32 m0, s66
    s_nop 0
    buffer_load_dwordx4 v5, s[48:51], s65 offen lds
    s_add_u32 s65, s65, 7168
    s_add_u32 s66, s66, 1024
    s_mov_b32 m0, s66
    s_nop 0
    buffer_load_dwordx4 v5, s[48:51], s65 offen lds
    s_add_u32 s65, s65, 7168
    s_add_u32 s66, s66, 1024
    s_mov_b32 m0, s66
    s_nop 0
    buffer_load_dwordx4 v5, s[48:51], s65 offen lds
    s_add_u32 s65, s65, 7168
    s_add_u32 s66, s66, 1024
    s_mov_b32 m0, s66
    s_nop 0
    buffer_load_dwordx4 v5, s[48:51], s65 offen lds
    s_add_u32 s65, s65, 7168
    s_add_u32 s66, s66, 1024
    s_mov_b32 m0, s66
    s_nop 0
    buffer_load_dwordx4 v5, s[48:51], s65 offen lds
    s_add_u32 s65, s65, 7168
    s_add_u32 s66, s66, 1024
    s_mov_b32 m0, s66
    s_nop 0
    buffer_load_dwordx4 v5, s[48:51], s65 offen lds
    s_add_u32 s65, s65, 7168
    s_add_u32 s66, s66, 1024
    s_mov_b32 m0, s66
    s_nop 0
    buffer_load_dwordx4 v5, s[48:51], s65 offen lds
    s_add_u32 s65, s65, 7168
    s_add_u32 s66, s66, 1024
    s_mov_b32 m0, s66
    s_nop 0
    buffer_load_dwordx4 v5, s[48:51], s65 offen lds
    s_add_u32 s65, s65, 7168
    s_add_u32 s66, s66, 1024
    s_mov_b32 m0, s66
    s_nop 0
    buffer_load_dwordx4 v5, s[48:51], s65 offen lds
    s_add_u32 s65, s65, 7168
    s_add_u32 s66, s66, 1024
    s_mov_b32 m0, s66
    s_nop 0
    buffer_load_dwordx4 v5, s[48:51], s65 offen lds
    s_add_u32 s65, s65, 7168
    s_add_u32 s66, s66, 1024
    s_mov_b32 m0, s66
    s_nop 0
    buffer_load_dwordx4 v5, s[48:51], s65 offen lds
    s_add_u32 s65, s65, 7168
    s_add_u32 s66, s66, 1024
    s_mov_b32 m0, s66
    s_nop 0
    buffer_load_dwordx4 v5, s[48:51], s65 offen lds
    s_add_u32 s65, s65, 7168
    s_add_u32 s66, s66, 1024
    s_mov_b32 m0, s66
    s_nop 0
    buffer_load_dwordx4 v5, s[48:51], s65 offen lds
    s_add_u32 s65, s65, 7168
    s_add_u32 s66, s66, 1024
    s_mov_b32 m0, s66
    s_nop 0
    buffer_load_dwordx4 v5, s[48:51], s65 offen lds
    s_add_u32 s65, s65, 7168
    s_add_u32 s66, s66, 1024
    s_mov_b32 m0, s66
    s_nop 0
    buffer_load_dwordx4 v5, s[48:51], s65 offen lds
    s_add_u32 s65, s65, 7168
    s_add_u32 s66, s66, 1024
    s_mov_b32 m0, s66
    s_nop 0
    buffer_load_dwordx4 v5, s[48:51], s65 offen lds
    s_add_u32 s65, s65, 7168
    s_add_u32 s66, s66, 1024
    s_mov_b32 m0, s66
    s_nop 0
    buffer_load_dwordx4 v5, s[48:51], s65 offen lds
    s_add_u32 s65, s65, 7168
    s_add_u32 s66, s66, 1024
    s_mov_b32 m0, s66
    s_nop 0
    buffer_load_dwordx4 v5, s[48:51], s65 offen lds
    s_add_u32 s65, s65, 7168
    s_add_u32 s66, s66, 1024
    s_mov_b32 m0, s66
    s_nop 0
    buffer_load_dwordx4 v5, s[48:51], s65 offen lds
    s_add_u32 s65, s65, 7168
    s_add_u32 s66, s66, 1024
    s_waitcnt vmcnt(0)
    ds_read_b64_tr_b16 a[0:1], v6 offset:0
    ds_read_b64_tr_b16 a[2:3], v6 offset:2048
    ds_read_b64_tr_b16 a[4:5], v6 offset:4096
    ds_read_b64_tr_b16 a[6:7], v6 offset:6144
    ds_read_b64_tr_b16 a[8:9], v6 offset:8192
    ds_read_b64_tr_b16 a[10:11], v6 offset:10240
    ds_read_b64_tr_b16 a[12:13], v6 offset:12288
    ds_read_b64_tr_b16 a[14:15], v6 offset:14336
    ds_read_b64_tr_b16 a[16:17], v6 offset:16384
    ds_read_b64_tr_b16 a[18:19], v6 offset:18432
    ds_read_b64_tr_b16 a[20:21], v6 offset:20480
    ds_read_b64_tr_b16 a[22:23], v6 offset:22528
    ds_read_b64_tr_b16 a[24:25], v6 offset:24576
    ds_read_b64_tr_b16 a[26:27], v6 offset:26624
    ds_read_b64_tr_b16 a[56:57], v6 offset:32
    ds_read_b64_tr_b16 a[58:59], v6 offset:2080
    ds_read_b64_tr_b16 a[60:61], v6 offset:4128
    ds_read_b64_tr_b16 a[62:63], v6 offset:6176
    ds_read_b64_tr_b16 a[64:65], v6 offset:8224
    ds_read_b64_tr_b16 a[66:67], v6 offset:10272
    ds_read_b64_tr_b16 a[68:69], v6 offset:12320
    ds_read_b64_tr_b16 a[70:71], v6 offset:14368
    ds_read_b64_tr_b16 a[72:73], v6 offset:16416
    ds_read_b64_tr_b16 a[74:75], v6 offset:18464
    ds_read_b64_tr_b16 a[76:77], v6 offset:20512
    ds_read_b64_tr_b16 a[78:79], v6 offset:22560
    ds_read_b64_tr_b16 a[80:81], v6 offset:24608
    ds_read_b64_tr_b16 a[82:83], v6 offset:26656
    ds_read_b64_tr_b16 a[112:113], v6 offset:64
    ds_read_b64_tr_b16 a[114:115], v6 offset:2112
    ds_read_b64_tr_b16 a[116:117], v6 offset:4160
    ds_read_b64_tr_b16 a[118:119], v6 offset:6208
    ds_read_b64_tr_b16 a[120:121], v6 offset:8256
    ds_read_b64_tr_b16 a[122:123], v6 offset:10304
    ds_read_b64_tr_b16 a[124:125], v6 offset:12352
    ds_read_b64_tr_b16 a[126:127], v6 offset:14400
    ds_read_b64_tr_b16 a[128:129], v6 offset:16448
    ds_read_b64_tr_b16 a[130:131], v6 offset:18496
    ds_read_b64_tr_b16 a[132:133], v6 offset:20544
    ds_read_b64_tr_b16 a[134:135], v6 offset:22592
    ds_read_b64_tr_b16 a[136:137], v6 offset:24640
    ds_read_b64_tr_b16 a[138:139], v6 offset:26688
    ds_read_b64_tr_b16 a[168:169], v6 offset:96
    ds_read_b64_tr_b16 a[170:171], v6 offset:2144
    ds_read_b64_tr_b16 a[172:173], v6 offset:4192
    ds_read_b64_tr_b16 a[174:175], v6 offset:6240
    ds_read_b64_tr_b16 a[176:177], v6 offset:8288
    ds_read_b64_tr_b16 a[178:179], v6 offset:10336
    ds_read_b64_tr_b16 a[180:181], v6 offset:12384
    ds_read_b64_tr_b16 a[182:183], v6 offset:14432
    ds_read_b64_tr_b16 a[184:185], v6 offset:16480
    ds_read_b64_tr_b16 a[186:187], v6 offset:18528
    ds_read_b64_tr_b16 a[188:189], v6 offset:20576
    ds_read_b64_tr_b16 a[190:191], v6 offset:22624
    ds_read_b64_tr_b16 a[192:193], v6 offset:24672
    ds_read_b64_tr_b16 a[194:195], v6 offset:26720
    s_waitcnt lgkmcnt(0)
    s_mul_i32 s66, s6, 28672
    s_mov_b32 m0, s66
    s_nop 0
    buffer_load_dwordx4 v5, s[48:51], s65 offen lds
    s_add_u32 s65, s65, 7168
    s_add_u32 s66, s66, 1024
    s_mov_b32 m0, s66
    s_nop 0
    buffer_load_dwordx4 v5, s[48:51], s65 offen lds
    s_add_u32 s65, s65, 7168
    s_add_u32 s66, s66, 1024
    s_mov_b32 m0, s66
    s_nop 0
    buffer_load_dwordx4 v5, s[48:51], s65 offen lds
    s_add_u32 s65, s65, 7168
    s_add_u32 s66, s66, 1024
    s_mov_b32 m0, s66
    s_nop 0
    buffer_load_dwordx4 v5, s[48:51], s65 offen lds
    s_add_u32 s65, s65, 7168
    s_add_u32 s66, s66, 1024
    s_mov_b32 m0, s66
    s_nop 0
    buffer_load_dwordx4 v5, s[48:51], s65 offen lds
    s_add_u32 s65, s65, 7168
    s_add_u32 s66, s66, 1024
    s_mov_b32 m0, s66
    s_nop 0
    buffer_load_dwordx4 v5, s[48:51], s65 offen lds
    s_add_u32 s65, s65, 7168
    s_add_u32 s66, s66, 1024
    s_mov_b32 m0, s66
    s_nop 0
    buffer_load_dwordx4 v5, s[48:51], s65 offen lds
    s_add_u32 s65, s65, 7168
    s_add_u32 s66, s66, 1024
    s_mov_b32 m0, s66
    s_nop 0
    buffer_load_dwordx4 v5, s[48:51], s65 offen lds
    s_add_u32 s65, s65, 7168
    s_add_u32 s66, s66, 1024
    s_mov_b32 m0, s66
    s_nop 0
    buffer_load_dwordx4 v5, s[48:51], s65 offen lds
    s_add_u32 s65, s65, 7168
    s_add_u32 s66, s66, 1024
    s_mov_b32 m0, s66
    s_nop 0
    buffer_load_dwordx4 v5, s[48:51], s65 offen lds
    s_add_u32 s65, s65, 7168
    s_add_u32 s66, s66, 1024
    s_mov_b32 m0, s66
    s_nop 0
    buffer_load_dwordx4 v5, s[48:51], s65 offen lds
    s_add_u32 s65, s65, 7168
    s_add_u32 s66, s66, 1024
    s_mov_b32 m0, s66
    s_nop 0
    buffer_load_dwordx4 v5, s[48:51], s65 offen lds
    s_add_u32 s65, s65, 7168
    s_add_u32 s66, s66, 1024
    s_mov_b32 m0, s66
    s_nop 0
    buffer_load_dwordx4 v5, s[48:51], s65 offen lds
    s_add_u32 s65, s65, 7168
    s_add_u32 s66, s66, 1024
    s_mov_b32 m0, s66
    s_nop 0
    buffer_load_dwordx4 v5, s[48:51], s65 offen lds
    s_add_u32 s65, s65, 7168
    s_add_u32 s66, s66, 1024
    s_mov_b32 m0, s66
    s_nop 0
    buffer_load_dwordx4 v5, s[48:51], s65 offen lds
    s_add_u32 s65, s65, 7168
    s_add_u32 s66, s66, 1024
    s_mov_b32 m0, s66
    s_nop 0
    buffer_load_dwordx4 v5, s[48:51], s65 offen lds
    s_add_u32 s65, s65, 7168
    s_add_u32 s66, s66, 1024
    s_mov_b32 m0, s66
    s_nop 0
    buffer_load_dwordx4 v5, s[48:51], s65 offen lds
    s_add_u32 s65, s65, 7168
    s_add_u32 s66, s66, 1024
    s_mov_b32 m0, s66
    s_nop 0
    buffer_load_dwordx4 v5, s[48:51], s65 offen lds
    s_add_u32 s65, s65, 7168
    s_add_u32 s66, s66, 1024
    s_mov_b32 m0, s66
    s_nop 0
    buffer_load_dwordx4 v5, s[48:51], s65 offen lds
    s_add_u32 s65, s65, 7168
    s_add_u32 s66, s66, 1024
    s_mov_b32 m0, s66
    s_nop 0
    buffer_load_dwordx4 v5, s[48:51], s65 offen lds
    s_add_u32 s65, s65, 7168
    s_add_u32 s66, s66, 1024
    s_mov_b32 m0, s66
    s_nop 0
    buffer_load_dwordx4 v5, s[48:51], s65 offen lds
    s_add_u32 s65, s65, 7168
    s_add_u32 s66, s66, 1024
    s_mov_b32 m0, s66
    s_nop 0
    buffer_load_dwordx4 v5, s[48:51], s65 offen lds
    s_add_u32 s65, s65, 7168
    s_add_u32 s66, s66, 1024
    s_mov_b32 m0, s66
    s_nop 0
    buffer_load_dwordx4 v5, s[48:51], s65 offen lds
    s_add_u32 s65, s65, 7168
    s_add_u32 s66, s66, 1024
    s_mov_b32 m0, s66
    s_nop 0
    buffer_load_dwordx4 v5, s[48:51], s65 offen lds
    s_add_u32 s65, s65, 7168
    s_add_u32 s66, s66, 1024
    s_mov_b32 m0, s66
    s_nop 0
    buffer_load_dwordx4 v5, s[48:51], s65 offen lds
    s_add_u32 s65, s65, 7168
    s_add_u32 s66, s66, 1024
    s_mov_b32 m0, s66
    s_nop 0
    buffer_load_dwordx4 v5, s[48:51], s65 offen lds
    s_add_u32 s65, s65, 7168
    s_add_u32 s66, s66, 1024
    s_mov_b32 m0, s66
    s_nop 0
    buffer_load_dwordx4 v5, s[48:51], s65 offen lds
    s_add_u32 s65, s65, 7168
    s_add_u32 s66, s66, 1024
    s_mov_b32 m0, s66
    s_nop 0
    buffer_load_dwordx4 v5, s[48:51], s65 offen lds
    s_add_u32 s65, s65, 7168
    s_add_u32 s66, s66, 1024
    s_waitcnt vmcnt(0)
    ds_read_b64_tr_b16 a[28:29], v6 offset:0
    ds_read_b64_tr_b16 a[30:31], v6 offset:2048
    ds_read_b64_tr_b16 a[32:33], v6 offset:4096
    ds_read_b64_tr_b16 a[34:35], v6 offset:6144
    ds_read_b64_tr_b16 a[36:37], v6 offset:8192
    ds_read_b64_tr_b16 a[38:39], v6 offset:10240
    ds_read_b64_tr_b16 a[40:41], v6 offset:12288
    ds_read_b64_tr_b16 a[42:43], v6 offset:14336
    ds_read_b64_tr_b16 a[44:45], v6 offset:16384
    ds_read_b64_tr_b16 a[46:47], v6 offset:18432
    ds_read_b64_tr_b16 a[48:49], v6 offset:20480
    ds_read_b64_tr_b16 a[50:51], v6 offset:22528
    ds_read_b64_tr_b16 a[52:53], v6 offset:24576
    ds_read_b64_tr_b16 a[54:55], v6 offset:26624
    ds_read_b64_tr_b16 a[84:85], v6 offset:32
    ds_read_b64_tr_b16 a[86:87], v6 offset:2080
    ds_read_b64_tr_b16 a[88:89], v6 offset:4128
    ds_read_b64_tr_b16 a[90:91], v6 offset:6176
    ds_read_b64_tr_b16 a[92:93], v6 offset:8224
    ds_read_b64_tr_b16 a[94:95], v6 offset:10272
    ds_read_b64_tr_b16 a[96:97], v6 offset:12320
    ds_read_b64_tr_b16 a[98:99], v6 offset:14368
    ds_read_b64_tr_b16 a[100:101], v6 offset:16416
    ds_read_b64_tr_b16 a[102:103], v6 offset:18464
    ds_read_b64_tr_b16 a[104:105], v6 offset:20512
    ds_read_b64_tr_b16 a[106:107], v6 offset:22560
    ds_read_b64_tr_b16 a[108:109], v6 offset:24608
    ds_read_b64_tr_b16 a[110:111], v6 offset:26656
    ds_read_b64_tr_b16 a[140:141], v6 offset:64
    ds_read_b64_tr_b16 a[142:143], v6 offset:2112
    ds_read_b64_tr_b16 a[144:145], v6 offset:4160
    ds_read_b64_tr_b16 a[146:147], v6 offset:6208
    ds_read_b64_tr_b16 a[148:149], v6 offset:8256
    ds_read_b64_tr_b16 a[150:151], v6 offset:10304
    ds_read_b64_tr_b16 a[152:153], v6 offset:12352
    ds_read_b64_tr_b16 a[154:155], v6 offset:14400
    ds_read_b64_tr_b16 a[156:157], v6 offset:16448
    ds_read_b64_tr_b16 a[158:159], v6 offset:18496
    ds_read_b64_tr_b16 a[160:161], v6 offset:20544
    ds_read_b64_tr_b16 a[162:163], v6 offset:22592
    ds_read_b64_tr_b16 a[164:165], v6 offset:24640
    ds_read_b64_tr_b16 a[166:167], v6 offset:26688
    ds_read_b64_tr_b16 a[196:197], v6 offset:96
    ds_read_b64_tr_b16 a[198:199], v6 offset:2144
    ds_read_b64_tr_b16 a[200:201], v6 offset:4192
    ds_read_b64_tr_b16 a[202:203], v6 offset:6240
    ds_read_b64_tr_b16 a[204:205], v6 offset:8288
    ds_read_b64_tr_b16 a[206:207], v6 offset:10336
    ds_read_b64_tr_b16 a[208:209], v6 offset:12384
    ds_read_b64_tr_b16 a[210:211], v6 offset:14432
    ds_read_b64_tr_b16 a[212:213], v6 offset:16480
    ds_read_b64_tr_b16 a[214:215], v6 offset:18528
    ds_read_b64_tr_b16 a[216:217], v6 offset:20576
    ds_read_b64_tr_b16 a[218:219], v6 offset:22624
    ds_read_b64_tr_b16 a[220:221], v6 offset:24672
    ds_read_b64_tr_b16 a[222:223], v6 offset:26720
    s_waitcnt lgkmcnt(0)
    s_barrier
    s_lshl_b32 s65, s6, 13
    v_add_u32 v23, s65, v1
    s_lshl_b32 s65, s6, 11
    v_add_u32 v24, s65, v1
    v_mul_u32_u24 v25, 896, v3
    v_lshl_add_u32 v25, v4, 3, v25
    s_lshr_b32 s65, s6, 1
    s_mul_i32 s65, s65, 14336
    s_and_b32 s66, s6, 1
    s_lshl_b32 s66, s66, 6
    s_add_u32 s65, s65, s66
    v_add_u32 v25, s65, v25
    s_mul_i32 s10, s6, 28672
    s_add_u32 s10, s10, 75235328
    s_mov_b32 s11, 114688
    s_lshl_b32 s12, s64, 7
    s_add_u32 s12, s12, 82575360
    s_mov_b32 s13, 28672
    s_mov_b32 s14, 95039488
    s_mov_b32 s15, 95031296
    s_mov_b32 s64, s8
    v_add_u32 v16, 0, v1
    v_add_u32 v17, 4096, v1
    v_add_u32 v18, 8192, v1
    v_add_u32 v19, 12288, v1
    v_add_u32 v20, 16384, v1
    v_add_u32 v21, 20480, v1
    v_add_u32 v22, 24576, v1
    s_lshl_b32 s69, s64, 7
    s_add_u32 s69, s69, s15
    s_mov_b32 s99, 0
wc_57:
    buffer_load_dword v12, v2, s[44:47], s69 offen sc1
    s_waitcnt vmcnt(0)
    v_readfirstlane_b32 s98, v12
    s_cmp_ge_u32 s98, 14
    s_cbranch_scc1 wd_58
    s_sleep 2
    s_add_u32 s99, s99, 1
    s_cmp_lt_u32 s99, 400000
    s_cbranch_scc1 wc_57
    s_mov_b32 s60, s40
    s_and_b32 s61, s41, 0xffff
    s_mov_b32 s62, 0x100
    s_mov_b32 s63, 0x20000
    v_mov_b32 v2, 0
    v_mov_b32 v5, 3735879683
    buffer_store_dword v5, v2, s[60:63], 0 offen offset:12
    s_endpgm
wd_58:
    s_mul_i32 s65, s64, s11
    s_add_u32 s65, s65, s10
    buffer_load_dwordx4 v[128:131], v16, s[44:47], s65 offen offset:0 sc1
    buffer_load_dwordx4 v[132:135], v16, s[44:47], s65 offen offset:1024 sc1
    buffer_load_dwordx4 v[136:139], v16, s[44:47], s65 offen offset:2048 sc1
    buffer_load_dwordx4 v[140:143], v16, s[44:47], s65 offen offset:3072 sc1
    buffer_load_dwordx4 v[144:147], v17, s[44:47], s65 offen offset:0 sc1
    buffer_load_dwordx4 v[148:151], v17, s[44:47], s65 offen offset:1024 sc1
    buffer_load_dwordx4 v[152:155], v17, s[44:47], s65 offen offset:2048 sc1
    buffer_load_dwordx4 v[156:159], v17, s[44:47], s65 offen offset:3072 sc1
    buffer_load_dwordx4 v[160:163], v18, s[44:47], s65 offen offset:0 sc1
    buffer_load_dwordx4 v[164:167], v18, s[44:47], s65 offen offset:1024 sc1
    buffer_load_dwordx4 v[168:171], v18, s[44:47], s65 offen offset:2048 sc1
    buffer_load_dwordx4 v[172:175], v18, s[44:47], s65 offen offset:3072 sc1
    buffer_load_dwordx4 v[176:179], v19, s[44:47], s65 offen offset:0 sc1
    buffer_load_dwordx4 v[180:183], v19, s[44:47], s65 offen offset:1024 sc1
    buffer_load_dwordx4 v[184:187], v19, s[44:47], s65 offen offset:2048 sc1
    buffer_load_dwordx4 v[188:191], v19, s[44:47], s65 offen offset:3072 sc1
    buffer_load_dwordx4 v[192:195], v20, s[44:47], s65 offen offset:0 sc1
    buffer_load_dwordx4 v[196:199], v20, s[44:47], s65 offen offset:1024 sc1
    buffer_load_dwordx4 v[200:203], v20, s[44:47], s65 offen offset:2048 sc1
    buffer_load_dwordx4 v[204:207], v20, s[44:47], s65 offen offset:3072 sc1
    buffer_load_dwordx4 v[208:211], v21, s[44:47], s65 offen offset:0 sc1
    buffer_load_dwordx4 v[212:215], v21, s[44:47], s65 offen offset:1024 sc1
    buffer_load_dwordx4 v[216:219], v21, s[44:47], s65 offen offset:2048 sc1
    buffer_load_dwordx4 v[220:223], v21, s[44:47], s65 offen offset:3072 sc1
    buffer_load_dwordx4 v[224:227], v22, s[44:47], s65 offen offset:0 sc1
    buffer_load_dwordx4 v[228:231], v22, s[44:47], s65 offen offset:1024 sc1
    buffer_load_dwordx4 v[232:235], v22, s[44:47], s65 offen offset:2048 sc1
    buffer_load_dwordx4 v[236:239], v22, s[44:47], s65 offen offset:3072 sc1
    s_mov_b32 s67, -1
    s_waitcnt vmcnt(0)
eng_down_loop:
    s_add_u32 s68, s64, s9
    s_cmp_lt_u32 s68, 64
    s_cselect_b32 s70, s68, s64
    s_lshl_b32 s69, s70, 7
    s_add_u32 s69, s69, s15
    s_mov_b32 s99, 0
wc_60:
    buffer_load_dword v12, v2, s[44:47], s69 offen sc1
    s_waitcnt vmcnt(0)
    v_readfirstlane_b32 s98, v12
    s_cmp_ge_u32 s98, 14
    s_cbranch_scc1 wd_61
    s_sleep 2
    s_add_u32 s99, s99, 1
    s_cmp_lt_u32 s99, 400000
    s_cbranch_scc1 wc_60
    s_mov_b32 s60, s40
    s_and_b32 s61, s41, 0xffff
    s_mov_b32 s62, 0x100
    s_mov_b32 s63, 0x20000
    v_mov_b32 v2, 0
    v_mov_b32 v5, 3735879684
    buffer_store_dword v5, v2, s[60:63], 0 offen offset:16
    s_endpgm
wd_61:
    s_mul_i32 s65, s70, s11
    s_add_u32 s65, s65, s10
    s_mul_i32 s66, s64, s13
    s_add_u32 s66, s66, s12
    s_waitcnt vmcnt(29)
    v_mfma_f32_16x16x32_bf16 v[64:67], a[0:3], v[128:131], 0
    v_mfma_f32_16x16x32_bf16 v[68:71], a[56:59], v[128:131], 0
    v_mfma_f32_16x16x32_bf16 v[72:75], a[112:115], v[128:131], 0
    v_mfma_f32_16x16x32_bf16 v[76:79], a[168:171], v[128:131], 0
    buffer_load_dwordx4 v[128:131], v16, s[44:47], s65 offen offset:0 sc1
    s_waitcnt vmcnt(29)
    v_mfma_f32_16x16x32_bf16 v[80:83], a[0:3], v[132:135], 0
    v_mfma_f32_16x16x32_bf16 v[84:87], a[56:59], v[132:135], 0
    v_mfma_f32_16x16x32_bf16 v[88:91], a[112:115], v[132:135], 0
    v_mfma_f32_16x16x32_bf16 v[92:95], a[168:171], v[132:135], 0
    buffer_load_dwordx4 v[132:135], v16, s[44:47], s65 offen offset:1024 sc1
    s_waitcnt vmcnt(29)
    v_mfma_f32_16x16x32_bf16 v[64:67], a[4:7], v[136:139], v[64:67]
    v_mfma_f32_16x16x32_bf16 v[68:71], a[60:63], v[136:139], v[68:71]
    v_mfma_f32_16x16x32_bf16 v[72:75], a[116:119], v[136:139], v[72:75]
    v_mfma_f32_16x16x32_bf16 v[76:79], a[172:175], v[136:139], v[76:79]
    buffer_load_dwordx4 v[136:139], v16, s[44:47], s65 offen offset:2048 sc1
    s_waitcnt vmcnt(29)
    v_mfma_f32_16x16x32_bf16 v[80:83], a[4:7], v[140:143], v[80:83]
    v_mfma_f32_16x16x32_bf16 v[84:87], a[60:63], v[140:143], v[84:87]
    v_mfma_f32_16x16x32_bf16 v[88:91], a[116:119], v[140:143], v[88:91]
    v_mfma_f32_16x16x32_bf16 v[92:95], a[172:175], v[140:143], v[92:95]
    buffer_load_dwordx4 v[140:143], v16, s[44:47], s65 offen offset:3072 sc1
    s_waitcnt vmcnt(29)
    v_mfma_f32_16x16x32_bf16 v[64:67], a[8:11], v[144:147], v[64:67]
    v_mfma_f32_16x16x32_bf16 v[68:71], a[64:67], v[144:147], v[68:71]
    v_mfma_f32_16x16x32_bf16 v[72:75], a[120:123], v[144:147], v[72:75]
    v_mfma_f32_16x16x32_bf16 v[76:79], a[176:179], v[144:147], v[76:79]
    buffer_load_dwordx4 v[144:147], v17, s[44:47], s65 offen offset:0 sc1
    s_waitcnt vmcnt(29)
    v_mfma_f32_16x16x32_bf16 v[80:83], a[8:11], v[148:151], v[80:83]
    v_mfma_f32_16x16x32_bf16 v[84:87], a[64:67], v[148:151], v[84:87]
    v_mfma_f32_16x16x32_bf16 v[88:91], a[120:123], v[148:151], v[88:91]
    v_mfma_f32_16x16x32_bf16 v[92:95], a[176:179], v[148:151], v[92:95]
    buffer_load_dwordx4 v[148:151], v17, s[44:47], s65 offen offset:1024 sc1
    s_waitcnt vmcnt(29)
    v_mfma_f32_16x16x32_bf16 v[64:67], a[12:15], v[152:155], v[64:67]
    v_mfma_f32_16x16x32_bf16 v[68:71], a[68:71], v[152:155], v[68:71]
    v_mfma_f32_16x16x32_bf16 v[72:75], a[124:127], v[152:155], v[72:75]
    v_mfma_f32_16x16x32_bf16 v[76:79], a[180:183], v[152:155], v[76:79]
    buffer_load_dwordx4 v[152:155], v17, s[44:47], s65 offen offset:2048 sc1
    s_waitcnt vmcnt(29)
    v_mfma_f32_16x16x32_bf16 v[80:83], a[12:15], v[156:159], v[80:83]
    v_mfma_f32_16x16x32_bf16 v[84:87], a[68:71], v[156:159], v[84:87]
    v_mfma_f32_16x16x32_bf16 v[88:91], a[124:127], v[156:159], v[88:91]
    v_mfma_f32_16x16x32_bf16 v[92:95], a[180:183], v[156:159], v[92:95]
    buffer_load_dwordx4 v[156:159], v17, s[44:47], s65 offen offset:3072 sc1
    s_waitcnt vmcnt(29)
    v_mfma_f32_16x16x32_bf16 v[64:67], a[16:19], v[160:163], v[64:67]
    v_mfma_f32_16x16x32_bf16 v[68:71], a[72:75], v[160:163], v[68:71]
    v_mfma_f32_16x16x32_bf16 v[72:75], a[128:131], v[160:163], v[72:75]
    v_mfma_f32_16x16x32_bf16 v[76:79], a[184:187], v[160:163], v[76:79]
    buffer_load_dwordx4 v[160:163], v18, s[44:47], s65 offen offset:0 sc1
    s_waitcnt vmcnt(29)
    v_mfma_f32_16x16x32_bf16 v[80:83], a[16:19], v[164:167], v[80:83]
    v_mfma_f32_16x16x32_bf16 v[84:87], a[72:75], v[164:167], v[84:87]
    v_mfma_f32_16x16x32_bf16 v[88:91], a[128:131], v[164:167], v[88:91]
    v_mfma_f32_16x16x32_bf16 v[92:95], a[184:187], v[164:167], v[92:95]
    buffer_load_dwordx4 v[164:167], v18, s[44:47], s65 offen offset:1024 sc1
    s_waitcnt vmcnt(10)
    s_barrier
    s_cmp_eq_u32 s67, -1
    s_cbranch_scc1 ns_63
    s_cmp_lg_u32 s6, 0
    s_cbranch_scc1 sg_64
    s_mov_b64 exec, 1
    v_mov_b32 v13, 1
    buffer_atomic_add v13, v2, s[44:47], s67 offen sc1
    s_mov_b64 exec, -1
sg_64:
ns_63:
    v_mfma_f32_16x16x32_bf16 v[64:67], a[20:23], v[168:171], v[64:67]
    v_mfma_f32_16x16x32_bf16 v[68:71], a[76:79], v[168:171], v[68:71]
    v_mfma_f32_16x16x32_bf16 v[72:75], a[132:135], v[168:171], v[72:75]
    v_mfma_f32_16x16x32_bf16 v[76:79], a[188:191], v[168:171], v[76:79]
    buffer_load_dwordx4 v[168:171], v18, s[44:47], s65 offen offset:2048 sc1
    s_waitcnt vmcnt(27)
    v_mfma_f32_16x16x32_bf16 v[80:83], a[20:23], v[172:175], v[80:83]
    v_mfma_f32_16x16x32_bf16 v[84:87], a[76:79], v[172:175], v[84:87]
    v_mfma_f32_16x16x32_bf16 v[88:91], a[132:135], v[172:175], v[88:91]
    v_mfma_f32_16x16x32_bf16 v[92:95], a[188:191], v[172:175], v[92:95]
    buffer_load_dwordx4 v[172:175], v18, s[44:47], s65 offen offset:3072 sc1
    s_waitcnt vmcnt(27)
    v_mfma_f32_16x16x32_bf16 v[64:67], a[24:27], v[176:179], v[64:67]
    v_mfma_f32_16x16x32_bf16 v[68:71], a[80:83], v[176:179], v[68:71]
    v_mfma_f32_16x16x32_bf16 v[72:75], a[136:139], v[176:179], v[72:75]
    v_mfma_f32_16x16x32_bf16 v[76:79], a[192:195], v[176:179], v[76:79]
    buffer_load_dwordx4 v[176:179], v19, s[44:47], s65 offen offset:0 sc1
    s_waitcnt vmcnt(27)
    v_mfma_f32_16x16x32_bf16 v[80:83], a[24:27], v[180:183], v[80:83]
    v_mfma_f32_16x16x32_bf16 v[84:87], a[80:83], v[180:183], v[84:87]
    v_mfma_f32_16x16x32_bf16 v[88:91], a[136:139], v[180:183], v[88:91]
    v_mfma_f32_16x16x32_bf16 v[92:95], a[192:195], v[180:183], v[92:95]
    buffer_load_dwordx4 v[180:183], v19, s[44:47], s65 offen offset:1024 sc1
    s_waitcnt vmcnt(27)
    v_mfma_f32_16x16x32_bf16 v[64:67], a[28:31], v[184:187], v[64:67]
    v_mfma_f32_16x16x32_bf16 v[68:71], a[84:87], v[184:187], v[68:71]
    v_mfma_f32_16x16x32_bf16 v[72:75], a[140:143], v[184:187], v[72:75]
    v_mfma_f32_16x16x32_bf16 v[76:79], a[196:199], v[184:187], v[76:79]
    buffer_load_dwordx4 v[184:187], v19, s[44:47], s65 offen offset:2048 sc1
    s_waitcnt vmcnt(27)
    v_mfma_f32_16x16x32_bf16 v[80:83], a[28:31], v[188:191], v[80:83]
    v_mfma_f32_16x16x32_bf16 v[84:87], a[84:87], v[188:191], v[84:87]
    v_mfma_f32_16x16x32_bf16 v[88:91], a[140:143], v[188:191], v[88:91]
    v_mfma_f32_16x16x32_bf16 v[92:95], a[196:199], v[188:191], v[92:95]
    buffer_load_dwordx4 v[188:191], v19, s[44:47], s65 offen offset:3072 sc1
    s_waitcnt vmcnt(27)
    v_mfma_f32_16x16x32_bf16 v[64:67], a[32:35], v[192:195], v[64:67]
    v_mfma_f32_16x16x32_bf16 v[68:71], a[88:91], v[192:195], v[68:71]
    v_mfma_f32_16x16x32_bf16 v[72:75], a[144:147], v[192:195], v[72:75]
    v_mfma_f32_16x16x32_bf16 v[76:79], a[200:203], v[192:195], v[76:79]
    buffer_load_dwordx4 v[192:195], v20, s[44:47], s65 offen offset:0 sc1
    s_waitcnt vmcnt(27)
    v_mfma_f32_16x16x32_bf16 v[80:83], a[32:35], v[196:199], v[80:83]
    v_mfma_f32_16x16x32_bf16 v[84:87], a[88:91], v[196:199], v[84:87]
    v_mfma_f32_16x16x32_bf16 v[88:91], a[144:147], v[196:199], v[88:91]
    v_mfma_f32_16x16x32_bf16 v[92:95], a[200:203], v[196:199], v[92:95]
    buffer_load_dwordx4 v[196:199], v20, s[44:47], s65 offen offset:1024 sc1
    s_waitcnt vmcnt(27)
    v_mfma_f32_16x16x32_bf16 v[64:67], a[36:39], v[200:203], v[64:67]
    v_mfma_f32_16x16x32_bf16 v[68:71], a[92:95], v[200:203], v[68:71]
    v_mfma_f32_16x16x32_bf16 v[72:75], a[148:151], v[200:203], v[72:75]
    v_mfma_f32_16x16x32_bf16 v[76:79], a[204:207], v[200:203], v[76:79]
    buffer_load_dwordx4 v[200:203], v20, s[44:47], s65 offen offset:2048 sc1
    s_waitcnt vmcnt(27)
    v_mfma_f32_16x16x32_bf16 v[80:83], a[36:39], v[204:207], v[80:83]
    v_mfma_f32_16x16x32_bf16 v[84:87], a[92:95], v[204:207], v[84:87]
    v_mfma_f32_16x16x32_bf16 v[88:91], a[148:151], v[204:207], v[88:91]
    v_mfma_f32_16x16x32_bf16 v[92:95], a[204:207], v[204:207], v[92:95]
    buffer_load_dwordx4 v[204:207], v20, s[44:47], s65 offen offset:3072 sc1
    s_waitcnt vmcnt(27)
    v_mfma_f32_16x16x32_bf16 v[64:67], a[40:43], v[208:211], v[64:67]
    v_mfma_f32_16x16x32_bf16 v[68:71], a[96:99], v[208:211], v[68:71]
    v_mfma_f32_16x16x32_bf16 v[72:75], a[152:155], v[208:211], v[72:75]
    v_mfma_f32_16x16x32_bf16 v[76:79], a[208:211], v[208:211], v[76:79]
    buffer_load_dwordx4 v[208:211], v21, s[44:47], s65 offen offset:0 sc1
    s_waitcnt vmcnt(27)
    v_mfma_f32_16x16x32_bf16 v[80:83], a[40:43], v[212:215], v[80:83]
    v_mfma_f32_16x16x32_bf16 v[84:87], a[96:99], v[212:215], v[84:87]
    v_mfma_f32_16x16x32_bf16 v[88:91], a[152:155], v[212:215], v[88:91]
    v_mfma_f32_16x16x32_bf16 v[92:95], a[208:211], v[212:215], v[92:95]
    buffer_load_dwordx4 v[212:215], v21, s[44:47], s65 offen offset:1024 sc1
    s_waitcnt vmcnt(27)
    v_mfma_f32_16x16x32_bf16 v[64:67], a[44:47], v[216:219], v[64:67]
    v_mfma_f32_16x16x32_bf16 v[68:71], a[100:103], v[216:219], v[68:71]
    v_mfma_f32_16x16x32_bf16 v[72:75], a[156:159], v[216:219], v[72:75]
    v_mfma_f32_16x16x32_bf16 v[76:79], a[212:215], v[216:219], v[76:79]
    buffer_load_dwordx4 v[216:219], v21, s[44:47], s65 offen offset:2048 sc1
    s_waitcnt vmcnt(27)
    v_mfma_f32_16x16x32_bf16 v[80:83], a[44:47], v[220:223], v[80:83]
    v_mfma_f32_16x16x32_bf16 v[84:87], a[100:103], v[220:223], v[84:87]
    v_mfma_f32_16x16x32_bf16 v[88:91], a[156:159], v[220:223], v[88:91]
    v_mfma_f32_16x16x32_bf16 v[92:95], a[212:215], v[220:223], v[92:95]
    buffer_load_dwordx4 v[220:223], v21, s[44:47], s65 offen offset:3072 sc1
    s_waitcnt vmcnt(27)
    v_mfma_f32_16x16x32_bf16 v[64:67], a[48:51], v[224:227], v[64:67]
    v_mfma_f32_16x16x32_bf16 v[68:71], a[104:107], v[224:227], v[68:71]
    v_mfma_f32_16x16x32_bf16 v[72:75], a[160:163], v[224:227], v[72:75]
    v_mfma_f32_16x16x32_bf16 v[76:79], a[216:219], v[224:227], v[76:79]
    buffer_load_dwordx4 v[224:227], v22, s[44:47], s65 offen offset:0 sc1
    s_waitcnt vmcnt(27)
    v_mfma_f32_16x16x32_bf16 v[80:83], a[48:51], v[228:231], v[80:83]
    v_mfma_f32_16x16x32_bf16 v[84:87], a[104:107], v[228:231], v[84:87]
    v_mfma_f32_16x16x32_bf16 v[88:91], a[160:163], v[228:231], v[88:91]
    v_mfma_f32_16x16x32_bf16 v[92:95], a[216:219], v[228:231], v[92:95]
    buffer_load_dwordx4 v[228:231], v22, s[44:47], s65 offen offset:1024 sc1
    s_waitcnt vmcnt(27)
    v_mfma_f32_16x16x32_bf16 v[64:67], a[52:55], v[232:235], v[64:67]
    v_mfma_f32_16x16x32_bf16 v[68:71], a[108:111], v[232:235], v[68:71]
    v_mfma_f32_16x16x32_bf16 v[72:75], a[164:167], v[232:235], v[72:75]
    v_mfma_f32_16x16x32_bf16 v[76:79], a[220:223], v[232:235], v[76:79]
    buffer_load_dwordx4 v[232:235], v22, s[44:47], s65 offen offset:2048 sc1
    s_waitcnt vmcnt(27)
    v_mfma_f32_16x16x32_bf16 v[80:83], a[52:55], v[236:239], v[80:83]
    v_mfma_f32_16x16x32_bf16 v[84:87], a[108:111], v[236:239], v[84:87]
    v_mfma_f32_16x16x32_bf16 v[88:91], a[164:167], v[236:239], v[88:91]
    v_mfma_f32_16x16x32_bf16 v[92:95], a[220:223], v[236:239], v[92:95]
    buffer_load_dwordx4 v[236:239], v22, s[44:47], s65 offen offset:3072 sc1
    ds_write_b128 v23, v[64:67] offset:0
    ds_write_b128 v23, v[68:71] offset:1024
    ds_write_b128 v23, v[72:75] offset:2048
    ds_write_b128 v23, v[76:79] offset:3072
    ds_write_b128 v23, v[80:83] offset:4096
    ds_write_b128 v23, v[84:87] offset:5120
    ds_write_b128 v23, v[88:91] offset:6144
    ds_write_b128 v23, v[92:95] offset:7168
    s_waitcnt lgkmcnt(0)
    s_barrier
    ds_read_b128 v[96:99], v24 offset:0
    ds_read_b128 v[100:103], v24 offset:8192
    ds_read_b128 v[104:107], v24 offset:16384
    ds_read_b128 v[108:111], v24 offset:24576
    ds_read_b128 v[112:115], v24 offset:1024
    ds_read_b128 v[116:119], v24 offset:9216
    ds_read_b128 v[120:123], v24 offset:17408
    ds_read_b128 v[124:127], v24 offset:25600
    s_waitcnt lgkmcnt(0)
    s_barrier
    v_add_f32 v96, v96, v100
    v_add_f32 v104, v104, v108
    v_add_f32 v96, v96, v104
    v_add_f32 v97, v97, v101
    v_add_f32 v105, v105, v109
    v_add_f32 v97, v97, v105
    v_add_f32 v98, v98, v102
    v_add_f32 v106, v106, v110
    v_add_f32 v98, v98, v106
    v_add_f32 v99, v99, v103
    v_add_f32 v107, v107, v111
    v_add_f32 v99, v99, v107
    v_cvt_pk_bf16_f32 v100, v96, v97
    v_lshlrev_b32 v96, 16, v100
    v_and_b32 v97, 0xffff0000, v100
    v_cvt_pk_bf16_f32 v101, v98, v99
    v_lshlrev_b32 v98, 16, v101
    v_and_b32 v99, 0xffff0000, v101
    v_mul_f32 v100, 0xbfb8aa3b, v96
    v_exp_f32 v100, v100
    s_nop 0
    v_add_f32 v100, 1.0, v100
    v_rcp_f32 v100, v100
    s_nop 0
    v_mul_f32 v96, v96, v100
    v_mul_f32 v101, 0xbfb8aa3b, v97
    v_exp_f32 v101, v101
    s_nop 0
    v_add_f32 v101, 1.0, v101
    v_rcp_f32 v101, v101
    s_nop 0
    v_mul_f32 v97, v97, v101
    v_mul_f32 v102, 0xbfb8aa3b, v98
    v_exp_f32 v102, v102
    s_nop 0
    v_add_f32 v102, 1.0, v102
    v_rcp_f32 v102, v102
    s_nop 0
    v_mul_f32 v98, v98, v102
    v_mul_f32 v103, 0xbfb8aa3b, v99
    v_exp_f32 v103, v103
    s_nop 0
    v_add_f32 v103, 1.0, v103
    v_rcp_f32 v103, v103
    s_nop 0
    v_mul_f32 v99, v99, v103
    v_cvt_pk_bf16_f32 v104, v96, v97
    v_cvt_pk_bf16_f32 v105, v98, v99
    buffer_store_dwordx2 v[104:105], v25, s[44:47], s66 offen offset:0 sc1
    v_add_f32 v112, v112, v116
    v_add_f32 v120, v120, v124
    v_add_f32 v112, v112, v120
    v_add_f32 v113, v113, v117
    v_add_f32 v121, v121, v125
    v_add_f32 v113, v113, v121
    v_add_f32 v114, v114, v118
    v_add_f32 v122, v122, v126
    v_add_f32 v114, v114, v122
    v_add_f32 v115, v115, v119
    v_add_f32 v123, v123, v127
    v_add_f32 v115, v115, v123
    v_cvt_pk_bf16_f32 v116, v112, v113
    v_lshlrev_b32 v112, 16, v116
    v_and_b32 v113, 0xffff0000, v116
    v_cvt_pk_bf16_f32 v117, v114, v115
    v_lshlrev_b32 v114, 16, v117
    v_and_b32 v115, 0xffff0000, v117
    v_mul_f32 v116, 0xbfb8aa3b, v112
    v_exp_f32 v116, v116
    s_nop 0
    v_add_f32 v116, 1.0, v116
    v_rcp_f32 v116, v116
    s_nop 0
    v_mul_f32 v112, v112, v116
    v_mul_f32 v117, 0xbfb8aa3b, v113
    v_exp_f32 v117, v117
    s_nop 0
    v_add_f32 v117, 1.0, v117
    v_rcp_f32 v117, v117
    s_nop 0
    v_mul_f32 v113, v113, v117
    v_mul_f32 v118, 0xbfb8aa3b, v114
    v_exp_f32 v118, v118
    s_nop 0
    v_add_f32 v118, 1.0, v118
    v_rcp_f32 v118, v118
    s_nop 0
    v_mul_f32 v114, v114, v118
    v_mul_f32 v119, 0xbfb8aa3b, v115
    v_exp_f32 v119, v119
    s_nop 0
    v_add_f32 v119, 1.0, v119
    v_rcp_f32 v119, v119
    s_nop 0
    v_mul_f32 v115, v115, v119
    v_cvt_pk_bf16_f32 v120, v112, v113
    v_cvt_pk_bf16_f32 v121, v114, v115
    buffer_store_dwordx2 v[120:121], v25, s[44:47], s66 offen offset:32 sc1
    s_lshl_b32 s67, s64, 7
    s_add_u32 s67, s67, s14
    s_mov_b32 s75, s66
    s_mov_b32 s64, s68
    s_cmp_lt_u32 s64, 64
    s_cbranch_scc1 eng_down_loop
    s_waitcnt vmcnt(0)
    s_barrier
    s_cmp_lg_u32 s6, 0
    s_cbranch_scc1 sg_65
    s_mov_b64 exec, 1
    v_mov_b32 v13, 1
    buffer_atomic_add v13, v2, s[44:47], s67 offen sc1
    s_mov_b64 exec, -1
sg_65:
    s_endpgm
role_f2b:
    s_sub_u32 s7, s7, 168
    s_branch role_f2
role_chain:
    s_sub_u32 s7, s7, 224
    s_lshr_b32 s80, s7, 1
    s_and_b32 s81, s7, 1
    s_mov_b32 s82, s7
    s_mov_b32 s76, 0x3f803f80
    s_mov_b32 s77, 0xfffefffe
    s_mov_b32 s78, 0x3db8aa3b
    s_mov_b32 s79, s78
    s_cmp_lg_u32 s6, 0
    s_cbranch_scc1 chw1
    s_cmp_ge_u32 s7, 28
    s_cbranch_scc1 chw0a
    s_lshr_b32 s8, s80, 2
    s_mul_i32 s12, s8, 5120
    s_bfe_u32 s8, s80, 0x10001
    s_lshl_b32 s8, s8, 9
    s_add_u32 s12, s12, s8
    s_and_b32 s8, s80, 1
    s_lshl_b32 s8, s8, 5
    s_add_u32 s12, s12, s8
    s_lshl_b32 s8, s81, 11
    s_add_u32 s12, s12, s8
    s_add_u32 s12, s12, 94928896
    s_mul_i32 s13, s7, 640
    s_add_u32 s13, s13, 94928896
    s_lshl_b32 s14, s82, 8
    s_add_u32 s14, s14, 94896128
    s_waitcnt vmcnt(0)
    s_cmp_lg_u32 s6, 0
    s_cbranch_scc1 sw_66
    v_min_u32 v23, 6, v0
    v_lshlrev_b32 v23, 7, v23
    s_mov_b32 s98, 95072768
    s_mov_b32 s99, 0
ws_67:
    buffer_load_dword v22, v23, s[44:47], s98 offen sc1
    s_add_u32 s99, s99, 1
    s_cmp_ge_u32 s99, 400000
    s_cbranch_scc1 mega_abort
    s_waitcnt vmcnt(0)
    v_cmp_gt_u32 vcc, 32, v22
    s_cbranch_vccz wt_68
    s_sleep 4
    s_branch ws_67
wt_68:
sw_66:
    s_barrier
    s_cmp_lg_u32 s6, 0
    s_cbranch_scc1 rv_69
    s_cmp_eq_u32 s5, 0
    s_cselect_b32 s8, 1, 0x10001
    s_mov_b32 s9, 95072512
    s_mov_b64 exec, 1
    v_mov_b32 v22, s8
    buffer_atomic_add v22, off, s[44:47], s9 sc1
    s_mov_b64 exec, -1
rv_69:
    s_lshl_b32 s95, s82, 4
    s_add_u32 s95, s95, 0
    s_mul_i32 s95, s95, 14336
    s_add_u32 s95, s95, 10092544
    s_waitcnt vmcnt(40)
    s_add_u32 s8, s95, 0
    buffer_load_dwordx4 a[224:227], v1, s[44:47], s8 offen offset:0 sc1
    s_add_u32 s8, s95, 0
    buffer_load_dwordx4 a[228:231], v1, s[44:47], s8 offen offset:1024 sc1
    s_add_u32 s8, s95, 0
    buffer_load_dwordx4 a[232:235], v1, s[44:47], s8 offen offset:2048 sc1
    s_add_u32 s8, s95, 0
    buffer_load_dwordx4 a[236:239], v1, s[44:47], s8 offen offset:3072 sc1
    s_add_u32 s8, s95, 4096
    buffer_load_dwordx4 a[240:243], v1, s[44:47], s8 offen offset:0 sc1
    s_add_u32 s8, s95, 4096
    buffer_load_dwordx4 a[244:247], v1, s[44:47], s8 offen offset:1024 sc1
    s_add_u32 s8, s95, 4096
    buffer_load_dwordx4 a[248:251], v1, s[44:47], s8 offen offset:2048 sc1
    s_add_u32 s8, s95, 4096
    buffer_load_dwordx4 a[252:255], v1, s[44:47], s8 offen offset:3072 sc1
    s_add_u32 s8, s95, 8192
    buffer_load_dwordx4 v[120:123], v1, s[44:47], s8 offen offset:0 sc1
    s_add_u32 s8, s95, 8192
    buffer_load_dwordx4 v[124:127], v1, s[44:47], s8 offen offset:1024 sc1
    s_add_u32 s8, s95, 8192
    buffer_load_dwordx4 v[128:131], v1, s[44:47], s8 offen offset:2048 sc1
    s_add_u32 s8, s95, 8192
    buffer_load_dwordx4 v[132:135], v1, s[44:47], s8 offen offset:3072 sc1
    s_add_u32 s8, s95, 12288
    buffer_load_dwordx4 v[136:139], v1, s[44:47], s8 offen offset:0 sc1
    s_add_u32 s8, s95, 12288
    buffer_load_dwordx4 v[140:143], v1, s[44:47], s8 offen offset:1024 sc1
    s_waitcnt vmcnt(40)
    s_add_u32 s8, s95, 12288
    buffer_load_dwordx4 v[144:147], v1, s[44:47], s8 offen offset:2048 sc1
    s_add_u32 s8, s95, 12288
    buffer_load_dwordx4 v[148:151], v1, s[44:47], s8 offen offset:3072 sc1
    s_add_u32 s8, s95, 16384
    buffer_load_dwordx4 v[152:155], v1, s[44:47], s8 offen offset:0 sc1
    s_add_u32 s8, s95, 16384
    buffer_load_dwordx4 v[156:159], v1, s[44:47], s8 offen offset:1024 sc1
    s_add_u32 s8, s95, 16384
    buffer_load_dwordx4 v[160:163], v1, s[44:47], s8 offen offset:2048 sc1
    s_add_u32 s8, s95, 16384
    buffer_load_dwordx4 v[164:167], v1, s[44:47], s8 offen offset:3072 sc1
    s_add_u32 s8, s95, 20480
    buffer_load_dwordx4 v[168:171], v1, s[44:47], s8 offen offset:0 sc1
    s_add_u32 s8, s95, 20480
    buffer_load_dwordx4 v[172:175], v1, s[44:47], s8 offen offset:1024 sc1
    s_add_u32 s8, s95, 20480
    buffer_load_dwordx4 v[176:179], v1, s[44:47], s8 offen offset:2048 sc1
    s_add_u32 s8, s95, 20480
    buffer_load_dwordx4 v[180:183], v1, s[44:47], s8 offen offset:3072 sc1
    s_add_u32 s8, s95, 24576
    buffer_load_dwordx4 v[184:187], v1, s[44:47], s8 offen offset:0 sc1
    s_add_u32 s8, s95, 24576
    buffer_load_dwordx4 v[188:191], v1, s[44:47], s8 offen offset:1024 sc1
    s_add_u32 s8, s95, 24576
    buffer_load_dwordx4 v[192:195], v1, s[44:47], s8 offen offset:2048 sc1
    s_add_u32 s8, s95, 24576
    buffer_load_dwordx4 v[196:199], v1, s[44:47], s8 offen offset:3072 sc1
    s_waitcnt vmcnt(40)
    s_add_u32 s8, s95, 28672
    buffer_load_dwordx4 v[200:203], v1, s[44:47], s8 offen offset:0 sc1
    s_add_u32 s8, s95, 28672
    buffer_load_dwordx4 v[204:207], v1, s[44:47], s8 offen offset:1024 sc1
    s_add_u32 s8, s95, 28672
    buffer_load_dwordx4 v[208:211], v1, s[44:47], s8 offen offset:2048 sc1
    s_add_u32 s8, s95, 28672
    buffer_load_dwordx4 v[212:215], v1, s[44:47], s8 offen offset:3072 sc1
    s_add_u32 s8, s95, 32768
    buffer_load_dwordx4 v[216:219], v1, s[44:47], s8 offen offset:0 sc1
    s_add_u32 s8, s95, 32768
    buffer_load_dwordx4 v[220:223], v1, s[44:47], s8 offen offset:1024 sc1
    s_add_u32 s8, s95, 32768
    buffer_load_dwordx4 v[224:227], v1, s[44:47], s8 offen offset:2048 sc1
    s_add_u32 s8, s95, 32768
    buffer_load_dwordx4 v[228:231], v1, s[44:47], s8 offen offset:3072 sc1
    s_add_u32 s8, s95, 36864
    buffer_load_dwordx4 v[232:235], v1, s[44:47], s8 offen offset:0 sc1
    s_add_u32 s8, s95, 36864
    buffer_load_dwordx4 v[236:239], v1, s[44:47], s8 offen offset:1024 sc1
    s_add_u32 s8, s95, 36864
    buffer_load_dwordx4 v[240:243], v1, s[44:47], s8 offen offset:2048 sc1
    s_add_u32 s8, s95, 36864
    buffer_load_dwordx4 v[244:247], v1, s[44:47], s8 offen offset:3072 sc1
    s_add_u32 s8, s95, 40960
    buffer_load_dwordx4 v[248:251], v1, s[44:47], s8 offen offset:0 sc1
    s_add_u32 s8, s95, 40960
    buffer_load_dwordx4 v[252:255], v1, s[44:47], s8 offen offset:1024 sc1
    s_waitcnt vmcnt(40)
    s_add_u32 s8, s95, 40960
    s_mov_b32 m0, 30720
    s_nop 0
    buffer_load_dwordx4 v1, s[44:47], s8 offen offset:2048 sc1 lds
    s_add_u32 s8, s95, 40960
    s_mov_b32 m0, 30720
    s_nop 0
    buffer_load_dwordx4 v1, s[44:47], s8 offen offset:3072 sc1 lds
    s_add_u32 s8, s95, 45056
    s_mov_b32 m0, 34816
    s_nop 0
    buffer_load_dwordx4 v1, s[44:47], s8 offen offset:0 sc1 lds
    s_add_u32 s8, s95, 45056
    s_mov_b32 m0, 34816
    s_nop 0
    buffer_load_dwordx4 v1, s[44:47], s8 offen offset:1024 sc1 lds
    s_add_u32 s8, s95, 45056
    s_mov_b32 m0, 34816
    s_nop 0
    buffer_load_dwordx4 v1, s[44:47], s8 offen offset:2048 sc1 lds
    s_add_u32 s8, s95, 45056
    s_mov_b32 m0, 34816
    s_nop 0
    buffer_load_dwordx4 v1, s[44:47], s8 offen offset:3072 sc1 lds
    s_add_u32 s8, s95, 49152
    s_mov_b32 m0, 38912
    s_nop 0
    buffer_load_dwordx4 v1, s[44:47], s8 offen offset:0 sc1 lds
    s_add_u32 s8, s95, 49152
    s_mov_b32 m0, 38912
    s_nop 0
    buffer_load_dwordx4 v1, s[44:47], s8 offen offset:1024 sc1 lds
    s_add_u32 s8, s95, 49152
    s_mov_b32 m0, 38912
    s_nop 0
    buffer_load_dwordx4 v1, s[44:47], s8 offen offset:2048 sc1 lds
    s_add_u32 s8, s95, 49152
    s_mov_b32 m0, 38912
    s_nop 0
    buffer_load_dwordx4 v1, s[44:47], s8 offen offset:3072 sc1 lds
    s_add_u32 s8, s95, 53248
    s_mov_b32 m0, 43008
    s_nop 0
    buffer_load_dwordx4 v1, s[44:47], s8 offen offset:0 sc1 lds
    s_add_u32 s8, s95, 53248
    s_mov_b32 m0, 43008
    s_nop 0
    buffer_load_dwordx4 v1, s[44:47], s8 offen offset:1024 sc1 lds
    s_add_u32 s8, s95, 53248
    s_mov_b32 m0, 43008
    s_nop 0
    buffer_load_dwordx4 v1, s[44:47], s8 offen offset:2048 sc1 lds
    s_add_u32 s8, s95, 53248
    s_mov_b32 m0, 43008
    s_nop 0
    buffer_load_dwordx4 v1, s[44:47], s8 offen offset:3072 sc1 lds
    v_mov_b32 v16, 0
    v_mov_b32 v17, 0
    v_lshlrev_b32 v18, 3, v0
    ds_write_b64 v18, v[16:17] offset:11776
    v_lshrrev_b32 v4, 4, v0
    v_bfe_u32 v5, v3, 1, 1
    v_mul_u32_u24 v5, 0xaaaa, v5
    v_add_u32 v5, 0x4444, v5
    v_bfe_u32 v6, v3, 2, 1
    v_lshlrev_b32 v6, 7, v6
    v_lshrrev_b32 v7, 3, v3
    v_lshl_add_u32 v6, v7, 6, v6
    v_and_b32 v7, 1, v3
    v_lshl_add_u32 v6, v7, 5, v6
    v_lshl_add_u32 v6, v4, 3, v6
    v_bfe_u32 v7, v3, 1, 1
    v_lshl_add_u32 v6, v7, 2, v6
    v_add_u32 v6, 8192, v6
    v_lshrrev_b32 v7, 2, v3
    v_lshlrev_b32 v7, 5, v7
    v_lshl_add_u32 v7, v4, 8, v7
    v_and_b32 v8, 3, v3
    v_lshl_add_u32 v7, v8, 3, v7
    v_add_u32 v7, 8192, v7
    v_bfe_u32 v8, v3, 1, 2
    v_lshlrev_b32 v8, 6, v8
    v_and_b32 v9, 1, v3
    v_lshl_add_u32 v8, v9, 4, v8
    v_lshrrev_b32 v9, 1, v4
    v_lshl_add_u32 v8, v9, 8, v8
    v_and_b32 v9, 1, v4
    v_lshl_add_u32 v8, v9, 3, v8
    s_mul_i32 s8, s81, 3584
    v_add_u32 v8, s8, v8
    v_lshlrev_b32 v11, 7, v4
    v_lshl_add_u32 v11, v3, 2, v11
    s_lshl_b32 s8, s6, 9
    s_add_u32 s8, s8, 12288
    v_add_u32 v11, s8, v11
    v_lshlrev_b32 v12, 3, v0
    v_add_u32 v12, 12288, v12
    v_lshrrev_b32 v13, 4, v0
    v_lshlrev_b32 v13, 6, v13
    v_bfe_u32 v14, v0, 2, 1
    v_lshl_add_u32 v13, v14, 5, v13
    v_bfe_u32 v14, v0, 3, 1
    v_lshl_add_u32 v13, v14, 4, v13
    v_and_b32 v14, 3, v0
    v_lshl_add_u32 v13, v14, 2, v13
    s_setreg_imm32_b32 hwreg(HW_REG_MODE, 23, 1), 1
    v_add_u32 v10, 4096, v1
    s_cmp_lg_u32 s6, 0
    s_cbranch_scc1 sw_70
    v_min_u32 v23, 7, v0
    v_lshlrev_b32 v23, 7, v23
    s_mov_b32 s98, 95072768
    s_mov_b32 s99, 0
ws_71:
    buffer_load_dword v22, v23, s[44:47], s98 offen sc1
    s_add_u32 s99, s99, 1
    s_cmp_ge_u32 s99, 400000
    s_cbranch_scc1 mega_abort
    s_waitcnt vmcnt(0)
    v_cmp_gt_u32 vcc, 32, v22
    s_cbranch_vccz wt_72
    s_sleep 4
    s_branch ws_71
wt_72:
sw_70:
    s_barrier
    v_add_u32 v8, 32768, v1
    s_mov_b32 s15, 65536
    v_mov_b32 v3, -1
    v_mov_b32 v104, 0
    v_mov_b32 v105, 0
    v_mov_b32 v106, 0
    v_mov_b32 v107, 0
    v_mov_b32 v108, 0
    v_mov_b32 v109, 0
    v_mov_b32 v110, 0
    v_mov_b32 v111, 0
    v_mov_b32 v117, 0
    v_mov_b32 v119, 0
    v_lshlrev_b32 v4, 2, v0
    s_mul_i32 s72, s81, 7168
    s_add_u32 s72, s72, 1835008
    s_lshl_b32 s71, s82, 14
    s_add_u32 s71, s71, 16515072
    s_mov_b32 s75, 95014912
    s_mov_b32 s73, 95072640
    s_mov_b32 s64, 0
    s_add_u32 s16, s72, 0
    s_add_u32 s20, s15, 0
    s_add_u32 s17, s72, 4096
    s_add_u32 s21, s15, 4096
    s_add_u32 s18, s72, 14336
    s_add_u32 s22, s15, 8192
    s_add_u32 s72, s72, 28672
    s_xor_b32 s15, s15, 0x4000
    s_mov_b32 m0, s20
    s_nop 0
    buffer_load_dwordx4 v1, s[44:47], s16 offen offset:0 sc1 lds
    buffer_load_dwordx4 v1, s[44:47], s16 offen offset:1024 sc1 lds
    buffer_load_dwordx4 v1, s[44:47], s16 offen offset:2048 sc1 lds
    buffer_load_dwordx4 v1, s[44:47], s16 offen offset:3072 sc1 lds
    s_mov_b32 m0, s21
    s_nop 0
    buffer_load_dwordx4 v1, s[44:47], s17 offen offset:0 sc1 lds
    buffer_load_dwordx4 v1, s[44:47], s17 offen offset:1024 sc1 lds
    buffer_load_dwordx4 v1, s[44:47], s17 offen offset:2048 sc1 lds
    s_mov_b32 m0, s22
    s_nop 0
    buffer_load_dwordx4 v1, s[44:47], s18 offen offset:0 sc1 lds
    buffer_load_dwordx4 v1, s[44:47], s18 offen offset:1024 sc1 lds
    s_mov_b32 s100, 0
    s_mov_b32 s101, -1
    v_mov_b32 v2, 0
    s_mov_b32 s9, 95072512
    s_mov_b32 s83, 0
rdv_73:
    buffer_load_dword v2, off, s[44:47], s9 sc1
    s_add_u32 s83, s83, 1
    s_cmp_ge_u32 s83, 2000000
    s_cbranch_scc1 chain_abort
    s_waitcnt vmcnt(0) lgkmcnt(0)
    v_readfirstlane_b32 s8, v2
    s_and_b32 s10, s8, 0xffff
    s_cmp_lt_u32 s10, 32
    s_cbranch_scc1 rdv_73
    s_mov_b32 s95, s8
    s_cmp_lg_u32 s6, 0
    s_cbranch_scc1 sw_74
    v_min_u32 v23, 6, v0
    v_lshlrev_b32 v23, 7, v23
    s_mov_b32 s98, 95073792
    s_mov_b32 s99, 0
ws_75:
    buffer_load_dword v22, v23, s[44:47], s98 offen sc1
    s_add_u32 s99, s99, 1
    s_cmp_ge_u32 s99, 400000
    s_cbranch_scc1 mega_abort
    s_waitcnt vmcnt(0)
    v_cmp_gt_u32 vcc, 32, v22
    s_cbranch_vccz wt_76
    s_sleep 4
    s_branch ws_75
wt_76:
sw_74:
    s_barrier
    s_mul_i32 s10, s80, 28
    s_mul_i32 s9, s81, 14
    s_add_u32 s10, s10, s9
    s_mul_i32 s10, s10, 14336
    s_add_u32 s8, s10, 3670016
    buffer_load_dwordx4 a[0:3], v1, s[44:47], s8 offen offset:0 sc1
    buffer_load_dwordx4 a[4:7], v1, s[44:47], s8 offen offset:1024 sc1
    buffer_load_dwordx4 a[8:11], v1, s[44:47], s8 offen offset:2048 sc1
    buffer_load_dwordx4 a[12:15], v1, s[44:47], s8 offen offset:3072 sc1
    s_add_u32 s8, s8, 4096
    buffer_load_dwordx4 a[16:19], v1, s[44:47], s8 offen offset:0 sc1
    buffer_load_dwordx4 a[20:23], v1, s[44:47], s8 offen offset:1024 sc1
    buffer_load_dwordx4 a[24:27], v1, s[44:47], s8 offen offset:2048 sc1
    buffer_load_dwordx4 a[28:31], v1, s[44:47], s8 offen offset:3072 sc1
    s_add_u32 s8, s8, 4096
    buffer_load_dwordx4 a[32:35], v1, s[44:47], s8 offen offset:0 sc1
    buffer_load_dwordx4 a[36:39], v1, s[44:47], s8 offen offset:1024 sc1
    buffer_load_dwordx4 a[40:43], v1, s[44:47], s8 offen offset:2048 sc1
    buffer_load_dwordx4 a[44:47], v1, s[44:47], s8 offen offset:3072 sc1
    s_add_u32 s8, s8, 4096
    buffer_load_dwordx4 a[48:51], v1, s[44:47], s8 offen offset:0 sc1
    buffer_load_dwordx4 a[52:55], v1, s[44:47], s8 offen offset:1024 sc1
    s_add_u32 s8, s10, 3684352
    buffer_load_dwordx4 a[56:59], v1, s[44:47], s8 offen offset:0 sc1
    buffer_load_dwordx4 a[60:63], v1, s[44:47], s8 offen offset:1024 sc1
    buffer_load_dwordx4 a[64:67], v1, s[44:47], s8 offen offset:2048 sc1
    buffer_load_dwordx4 a[68:71], v1, s[44:47], s8 offen offset:3072 sc1
    s_add_u32 s8, s8, 4096
    buffer_load_dwordx4 a[72:75], v1, s[44:47], s8 offen offset:0 sc1
    buffer_load_dwordx4 a[76:79], v1, s[44:47], s8 offen offset:1024 sc1
    buffer_load_dwordx4 a[80:83], v1, s[44:47], s8 offen offset:2048 sc1
    buffer_load_dwordx4 a[84:87], v1, s[44:47], s8 offen offset:3072 sc1
    s_add_u32 s8, s8, 4096
    buffer_load_dwordx4 a[88:91], v1, s[44:47], s8 offen offset:0 sc1
    buffer_load_dwordx4 a[92:95], v1, s[44:47], s8 offen offset:1024 sc1
    buffer_load_dwordx4 a[96:99], v1, s[44:47], s8 offen offset:2048 sc1
    buffer_load_dwordx4 a[100:103], v1, s[44:47], s8 offen offset:3072 sc1
    s_add_u32 s8, s8, 4096
    buffer_load_dwordx4 a[104:107], v1, s[44:47], s8 offen offset:0 sc1
    buffer_load_dwordx4 a[108:111], v1, s[44:47], s8 offen offset:1024 sc1
    s_add_u32 s8, s10, 3698688
    buffer_load_dwordx4 a[112:115], v1, s[44:47], s8 offen offset:0 sc1
    buffer_load_dwordx4 a[116:119], v1, s[44:47], s8 offen offset:1024 sc1
    buffer_load_dwordx4 a[120:123], v1, s[44:47], s8 offen offset:2048 sc1
    buffer_load_dwordx4 a[124:127], v1, s[44:47], s8 offen offset:3072 sc1
    s_add_u32 s8, s8, 4096
    buffer_load_dwordx4 a[128:131], v1, s[44:47], s8 offen offset:0 sc1
    buffer_load_dwordx4 a[132:135], v1, s[44:47], s8 offen offset:1024 sc1
    buffer_load_dwordx4 a[136:139], v1, s[44:47], s8 offen offset:2048 sc1
    buffer_load_dwordx4 a[140:143], v1, s[44:47], s8 offen offset:3072 sc1
    s_add_u32 s8, s8, 4096
    buffer_load_dwordx4 a[144:147], v1, s[44:47], s8 offen offset:0 sc1
    buffer_load_dwordx4 a[148:151], v1, s[44:47], s8 offen offset:1024 sc1
    buffer_load_dwordx4 a[152:155], v1, s[44:47], s8 offen offset:2048 sc1
    buffer_load_dwordx4 a[156:159], v1, s[44:47], s8 offen offset:3072 sc1
    s_add_u32 s8, s8, 4096
    buffer_load_dwordx4 a[160:163], v1, s[44:47], s8 offen offset:0 sc1
    buffer_load_dwordx4 a[164:167], v1, s[44:47], s8 offen offset:1024 sc1
    s_add_u32 s8, s10, 3842048
    buffer_load_dwordx4 a[168:171], v1, s[44:47], s8 offen offset:0 sc1
    buffer_load_dwordx4 a[172:175], v1, s[44:47], s8 offen offset:1024 sc1
    buffer_load_dwordx4 a[176:179], v1, s[44:47], s8 offen offset:2048 sc1
    buffer_load_dwordx4 a[180:183], v1, s[44:47], s8 offen offset:3072 sc1
    s_add_u32 s8, s8, 4096
    buffer_load_dwordx4 a[184:187], v1, s[44:47], s8 offen offset:0 sc1
    buffer_load_dwordx4 a[188:191], v1, s[44:47], s8 offen offset:1024 sc1
    buffer_load_dwordx4 a[192:195], v1, s[44:47], s8 offen offset:2048 sc1
    buffer_load_dwordx4 a[196:199], v1, s[44:47], s8 offen offset:3072 sc1
    s_add_u32 s8, s8, 4096
    buffer_load_dwordx4 a[200:203], v1, s[44:47], s8 offen offset:0 sc1
    buffer_load_dwordx4 a[204:207], v1, s[44:47], s8 offen offset:1024 sc1
    buffer_load_dwordx4 a[208:211], v1, s[44:47], s8 offen offset:2048 sc1
    buffer_load_dwordx4 a[212:215], v1, s[44:47], s8 offen offset:3072 sc1
    s_add_u32 s8, s8, 4096
    buffer_load_dwordx4 a[216:219], v1, s[44:47], s8 offen offset:0 sc1
    buffer_load_dwordx4 a[220:223], v1, s[44:47], s8 offen offset:1024 sc1
    s_waitcnt vmcnt(30)
    s_mov_b32 s8, 94896128
    buffer_load_dwordx4 v[76:79], v1, s[44:47], s8 offen offset:0 sc1
    buffer_load_dwordx4 v[76:79], v1, s[44:47], s8 offen offset:1024 sc1
    s_mov_b32 s8, 94928896
    buffer_load_dwordx4 v[76:79], v1, s[44:47], s8 offen offset:0 sc1
    buffer_load_dwordx4 v[76:79], v1, s[44:47], s8 offen offset:1024 sc1
    buffer_load_dwordx4 v[76:79], v1, s[44:47], s8 offen offset:2048 sc1
    buffer_load_dwordx4 v[76:79], v1, s[44:47], s8 offen offset:3072 sc1
    buffer_load_dwordx4 v[76:79], v10, s[44:47], s8 offen offset:0 sc1
    s_mov_b32 s8, 94904320
    buffer_load_dwordx4 v[76:79], v1, s[44:47], s8 offen offset:0 sc1
    buffer_load_dwordx4 v[76:79], v1, s[44:47], s8 offen offset:1024 sc1
    s_mov_b32 s8, 94949632
    buffer_load_dwordx4 v[76:79], v1, s[44:47], s8 offen offset:0 sc1
    buffer_load_dwordx4 v[76:79], v1, s[44:47], s8 offen offset:1024 sc1
    buffer_load_dwordx4 v[76:79], v1, s[44:47], s8 offen offset:2048 sc1
    buffer_load_dwordx4 v[76:79], v1, s[44:47], s8 offen offset:3072 sc1
    buffer_load_dwordx4 v[76:79], v10, s[44:47], s8 offen offset:0 sc1
    s_mov_b32 s8, 94912512
    buffer_load_dwordx4 v[76:79], v1, s[44:47], s8 offen offset:0 sc1
    buffer_load_dwordx4 v[76:79], v1, s[44:47], s8 offen offset:1024 sc1
    s_mov_b32 s8, 94970368
    buffer_load_dwordx4 v[76:79], v1, s[44:47], s8 offen offset:0 sc1
    buffer_load_dwordx4 v[76:79], v1, s[44:47], s8 offen offset:1024 sc1
    buffer_load_dwordx4 v[76:79], v1, s[44:47], s8 offen offset:2048 sc1
    buffer_load_dwordx4 v[76:79], v1, s[44:47], s8 offen offset:3072 sc1
    buffer_load_dwordx4 v[76:79], v10, s[44:47], s8 offen offset:0 sc1
    s_mov_b32 s8, 94920704
    buffer_load_dwordx4 v[76:79], v1, s[44:47], s8 offen offset:0 sc1
    buffer_load_dwordx4 v[76:79], v1, s[44:47], s8 offen offset:1024 sc1
    s_mov_b32 s8, 94991104
    buffer_load_dwordx4 v[76:79], v1, s[44:47], s8 offen offset:0 sc1
    buffer_load_dwordx4 v[76:79], v1, s[44:47], s8 offen offset:1024 sc1
    buffer_load_dwordx4 v[76:79], v1, s[44:47], s8 offen offset:2048 sc1
    buffer_load_dwordx4 v[76:79], v1, s[44:47], s8 offen offset:3072 sc1
    buffer_load_dwordx4 v[76:79], v10, s[44:47], s8 offen offset:0 sc1
    v_lshlrev_b32 v113, 7, v0
    s_mov_b32 s99, 0
hz_77:
    buffer_load_dword v115, v113, s[44:47], s75 offen sc1
    s_waitcnt vmcnt(0)
    v_cmp_gt_u32 vcc, 28, v115
    s_ff1_i32_b64 s100, vcc
    s_cmp_eq_u32 s100, -1
    s_cselect_b32 s100, 65, s100
    s_sub_u32 s100, s100, 1
    s_cmp_ge_i32 s100, s64
    s_cbranch_scc1 hd_78
    s_sleep 1
    s_add_u32 s99, s99, 1
    s_cmp_lt_u32 s99, 400000
    s_cbranch_scc1 hz_77
    s_branch chain_abort
hd_78:
    s_mov_b32 m0, 16384
    s_nop 0
    buffer_load_dwordx4 v1, s[44:47], s71 offen offset:0 sc1 lds
    buffer_load_dwordx4 v1, s[44:47], s71 offen offset:1024 sc1 lds
    s_barrier
    s_mov_b32 s9, 95072384
    s_mov_b64 exec, 1
    v_mov_b32 v2, 1
    buffer_atomic_add v2, off, s[44:47], s9 sc1
    s_mov_b64 exec, -1
    s_cmp_gt_u32 s95, 0xffff
    s_cbranch_scc1 ch0bs
    s_branch ch0bf
chw0a:
    s_lshr_b32 s8, s80, 2
    s_mul_i32 s12, s8, 5120
    s_bfe_u32 s8, s80, 0x10001
    s_lshl_b32 s8, s8, 9
    s_add_u32 s12, s12, s8
    s_and_b32 s8, s80, 1
    s_lshl_b32 s8, s8, 5
    s_add_u32 s12, s12, s8
    s_lshl_b32 s8, s81, 11
    s_add_u32 s12, s12, s8
    s_add_u32 s12, s12, 94928896
    s_mul_i32 s13, s7, 640
    s_add_u32 s13, s13, 94928896
    s_lshl_b32 s14, s82, 8
    s_add_u32 s14, s14, 94896128
    s_waitcnt vmcnt(0)
    s_cmp_lg_u32 s6, 0
    s_cbranch_scc1 sw_79
    v_min_u32 v23, 6, v0
    v_lshlrev_b32 v23, 7, v23
    s_mov_b32 s98, 95072768
    s_mov_b32 s99, 0
ws_80:
    buffer_load_dword v22, v23, s[44:47], s98 offen sc1
    s_add_u32 s99, s99, 1
    s_cmp_ge_u32 s99, 400000
    s_cbranch_scc1 mega_abort
    s_waitcnt vmcnt(0)
    v_cmp_gt_u32 vcc, 32, v22
    s_cbranch_vccz wt_81
    s_sleep 4
    s_branch ws_80
wt_81:
sw_79:
    s_barrier
    s_cmp_lg_u32 s6, 0
    s_cbranch_scc1 rv_82
    s_cmp_eq_u32 s5, 0
    s_cselect_b32 s8, 1, 0x10001
    s_mov_b32 s9, 95072512
    s_mov_b64 exec, 1
    v_mov_b32 v22, s8
    buffer_atomic_add v22, off, s[44:47], s9 sc1
    s_mov_b64 exec, -1
rv_82:
    s_lshl_b32 s95, s82, 4
    s_add_u32 s95, s95, 0
    s_mul_i32 s95, s95, 14336
    s_add_u32 s95, s95, 10092544
    v_mov_b32 v16, 0
    v_mov_b32 v17, 0
    v_lshlrev_b32 v18, 3, v0
    ds_write_b64 v18, v[16:17] offset:11776
    v_lshrrev_b32 v4, 4, v0
    v_bfe_u32 v5, v3, 1, 1
    v_mul_u32_u24 v5, 0xaaaa, v5
    v_add_u32 v5, 0x4444, v5
    v_bfe_u32 v6, v3, 2, 1
    v_lshlrev_b32 v6, 7, v6
    v_lshrrev_b32 v7, 3, v3
    v_lshl_add_u32 v6, v7, 6, v6
    v_and_b32 v7, 1, v3
    v_lshl_add_u32 v6, v7, 5, v6
    v_lshl_add_u32 v6, v4, 3, v6
    v_bfe_u32 v7, v3, 1, 1
    v_lshl_add_u32 v6, v7, 2, v6
    v_add_u32 v6, 8192, v6
    v_lshrrev_b32 v7, 2, v3
    v_lshlrev_b32 v7, 5, v7
    v_lshl_add_u32 v7, v4, 8, v7
    v_and_b32 v8, 3, v3
    v_lshl_add_u32 v7, v8, 3, v7
    v_add_u32 v7, 8192, v7
    v_bfe_u32 v8, v3, 1, 2
    v_lshlrev_b32 v8, 6, v8
    v_and_b32 v9, 1, v3
    v_lshl_add_u32 v8, v9, 4, v8
    v_lshrrev_b32 v9, 1, v4
    v_lshl_add_u32 v8, v9, 8, v8
    v_and_b32 v9, 1, v4
    v_lshl_add_u32 v8, v9, 3, v8
    s_mul_i32 s8, s81, 3584
    v_add_u32 v8, s8, v8
    v_lshlrev_b32 v11, 7, v4
    v_lshl_add_u32 v11, v3, 2, v11
    s_lshl_b32 s8, s6, 9
    s_add_u32 s8, s8, 12288
    v_add_u32 v11, s8, v11
    v_lshlrev_b32 v12, 3, v0
    v_add_u32 v12, 12288, v12
    v_lshrrev_b32 v13, 4, v0
    v_lshlrev_b32 v13, 6, v13
    v_bfe_u32 v14, v0, 2, 1
    v_lshl_add_u32 v13, v14, 5, v13
    v_bfe_u32 v14, v0, 3, 1
    v_lshl_add_u32 v13, v14, 4, v13
    v_and_b32 v14, 3, v0
    v_lshl_add_u32 v13, v14, 2, v13
    s_setreg_imm32_b32 hwreg(HW_REG_MODE, 23, 1), 1
    v_add_u32 v10, 4096, v1
    s_cmp_lg_u32 s6, 0
    s_cbranch_scc1 sw_83
    v_min_u32 v23, 7, v0
    v_lshlrev_b32 v23, 7, v23
    s_mov_b32 s98, 95072768
    s_mov_b32 s99, 0
ws_84:
    buffer_load_dword v22, v23, s[44:47], s98 offen sc1
    s_add_u32 s99, s99, 1
    s_cmp_ge_u32 s99, 400000
    s_cbranch_scc1 mega_abort
    s_waitcnt vmcnt(0)
    v_cmp_gt_u32 vcc, 32, v22
    s_cbranch_vccz wt_85
    s_sleep 4
    s_branch ws_84
wt_85:
sw_83:
    s_barrier
    v_add_u32 v8, 32768, v1
    s_mov_b32 s15, 65536
    v_mov_b32 v3, -1
    v_mov_b32 v104, 0
    v_mov_b32 v105, 0
    v_mov_b32 v106, 0
    v_mov_b32 v107, 0
    v_mov_b32 v108, 0
    v_mov_b32 v109, 0
    v_mov_b32 v110, 0
    v_mov_b32 v111, 0
    v_mov_b32 v117, 0
    v_mov_b32 v119, 0
    v_lshlrev_b32 v4, 2, v0
    s_mul_i32 s72, s81, 7168
    s_add_u32 s72, s72, 1835008
    s_sub_u32 s8, s82, 28
    s_mul_i32 s71, s8, 114688
    s_add_u32 s71, s71, 16515072
    s_mov_b32 s75, 95014912
    s_mov_b32 s73, 95072640
    s_mov_b32 s64, 0
    s_add_u32 s16, s72, 0
    s_add_u32 s20, s15, 0
    s_add_u32 s17, s72, 4096
    s_add_u32 s21, s15, 4096
    s_add_u32 s18, s72, 14336
    s_add_u32 s22, s15, 8192
    s_add_u32 s72, s72, 28672
    s_xor_b32 s15, s15, 0x4000
    s_mov_b32 m0, s20
    s_nop 0
    buffer_load_dwordx4 v1, s[44:47], s16 offen offset:0 sc1 lds
    buffer_load_dwordx4 v1, s[44:47], s16 offen offset:1024 sc1 lds
    buffer_load_dwordx4 v1, s[44:47], s16 offen offset:2048 sc1 lds
    buffer_load_dwordx4 v1, s[44:47], s16 offen offset:3072 sc1 lds
    s_mov_b32 m0, s21
    s_nop 0
    buffer_load_dwordx4 v1, s[44:47], s17 offen offset:0 sc1 lds
    buffer_load_dwordx4 v1, s[44:47], s17 offen offset:1024 sc1 lds
    buffer_load_dwordx4 v1, s[44:47], s17 offen offset:2048 sc1 lds
    s_mov_b32 m0, s22
    s_nop 0
    buffer_load_dwordx4 v1, s[44:47], s18 offen offset:0 sc1 lds
    buffer_load_dwordx4 v1, s[44:47], s18 offen offset:1024 sc1 lds
    s_mov_b32 s100, 0
    s_mov_b32 s101, -1
    v_mov_b32 v2, 0
    s_mov_b32 s9, 95072512
    s_mov_b32 s83, 0
rdv_86:
    buffer_load_dword v2, off, s[44:47], s9 sc1
    s_add_u32 s83, s83, 1
    s_cmp_ge_u32 s83, 2000000
    s_cbranch_scc1 chain_abort
    s_waitcnt vmcnt(0) lgkmcnt(0)
    v_readfirstlane_b32 s8, v2
    s_and_b32 s10, s8, 0xffff
    s_cmp_lt_u32 s10, 32
    s_cbranch_scc1 rdv_86
    s_mov_b32 s95, s8
    s_cmp_lg_u32 s6, 0
    s_cbranch_scc1 sw_87
    v_min_u32 v23, 6, v0
    v_lshlrev_b32 v23, 7, v23
    s_mov_b32 s98, 95073792
    s_mov_b32 s99, 0
ws_88:
    buffer_load_dword v22, v23, s[44:47], s98 offen sc1
    s_add_u32 s99, s99, 1
    s_cmp_ge_u32 s99, 400000
    s_cbranch_scc1 mega_abort
    s_waitcnt vmcnt(0)
    v_cmp_gt_u32 vcc, 32, v22
    s_cbranch_vccz wt_89
    s_sleep 4
    s_branch ws_88
wt_89:
sw_87:
    s_barrier
    s_mul_i32 s10, s80, 28
    s_mul_i32 s9, s81, 14
    s_add_u32 s10, s10, s9
    s_mul_i32 s10, s10, 14336
    s_add_u32 s8, s10, 3670016
    buffer_load_dwordx4 a[0:3], v1, s[44:47], s8 offen offset:0 sc1
    buffer_load_dwordx4 a[4:7], v1, s[44:47], s8 offen offset:1024 sc1
    buffer_load_dwordx4 a[8:11], v1, s[44:47], s8 offen offset:2048 sc1
    buffer_load_dwordx4 a[12:15], v1, s[44:47], s8 offen offset:3072 sc1
    s_add_u32 s8, s8, 4096
    buffer_load_dwordx4 a[16:19], v1, s[44:47], s8 offen offset:0 sc1
    buffer_load_dwordx4 a[20:23], v1, s[44:47], s8 offen offset:1024 sc1
    buffer_load_dwordx4 a[24:27], v1, s[44:47], s8 offen offset:2048 sc1
    buffer_load_dwordx4 a[28:31], v1, s[44:47], s8 offen offset:3072 sc1
    s_add_u32 s8, s8, 4096
    buffer_load_dwordx4 a[32:35], v1, s[44:47], s8 offen offset:0 sc1
    buffer_load_dwordx4 a[36:39], v1, s[44:47], s8 offen offset:1024 sc1
    buffer_load_dwordx4 a[40:43], v1, s[44:47], s8 offen offset:2048 sc1
    buffer_load_dwordx4 a[44:47], v1, s[44:47], s8 offen offset:3072 sc1
    s_add_u32 s8, s8, 4096
    buffer_load_dwordx4 a[48:51], v1, s[44:47], s8 offen offset:0 sc1
    buffer_load_dwordx4 a[52:55], v1, s[44:47], s8 offen offset:1024 sc1
    s_add_u32 s8, s10, 3684352
    buffer_load_dwordx4 a[56:59], v1, s[44:47], s8 offen offset:0 sc1
    buffer_load_dwordx4 a[60:63], v1, s[44:47], s8 offen offset:1024 sc1
    buffer_load_dwordx4 a[64:67], v1, s[44:47], s8 offen offset:2048 sc1
    buffer_load_dwordx4 a[68:71], v1, s[44:47], s8 offen offset:3072 sc1
    s_add_u32 s8, s8, 4096
    buffer_load_dwordx4 a[72:75], v1, s[44:47], s8 offen offset:0 sc1
    buffer_load_dwordx4 a[76:79], v1, s[44:47], s8 offen offset:1024 sc1
    buffer_load_dwordx4 a[80:83], v1, s[44:47], s8 offen offset:2048 sc1
    buffer_load_dwordx4 a[84:87], v1, s[44:47], s8 offen offset:3072 sc1
    s_add_u32 s8, s8, 4096
    buffer_load_dwordx4 a[88:91], v1, s[44:47], s8 offen offset:0 sc1
    buffer_load_dwordx4 a[92:95], v1, s[44:47], s8 offen offset:1024 sc1
    buffer_load_dwordx4 a[96:99], v1, s[44:47], s8 offen offset:2048 sc1
    buffer_load_dwordx4 a[100:103], v1, s[44:47], s8 offen offset:3072 sc1
    s_add_u32 s8, s8, 4096
    buffer_load_dwordx4 a[104:107], v1, s[44:47], s8 offen offset:0 sc1
    buffer_load_dwordx4 a[108:111], v1, s[44:47], s8 offen offset:1024 sc1
    s_add_u32 s8, s10, 3698688
    buffer_load_dwordx4 a[112:115], v1, s[44:47], s8 offen offset:0 sc1
    buffer_load_dwordx4 a[116:119], v1, s[44:47], s8 offen offset:1024 sc1
    buffer_load_dwordx4 a[120:123], v1, s[44:47], s8 offen offset:2048 sc1
    buffer_load_dwordx4 a[124:127], v1, s[44:47], s8 offen offset:3072 sc1
    s_add_u32 s8, s8, 4096
    buffer_load_dwordx4 a[128:131], v1, s[44:47], s8 offen offset:0 sc1
    buffer_load_dwordx4 a[132:135], v1, s[44:47], s8 offen offset:1024 sc1
    buffer_load_dwordx4 a[136:139], v1, s[44:47], s8 offen offset:2048 sc1
    buffer_load_dwordx4 a[140:143], v1, s[44:47], s8 offen offset:3072 sc1
    s_add_u32 s8, s8, 4096
    buffer_load_dwordx4 a[144:147], v1, s[44:47], s8 offen offset:0 sc1
    buffer_load_dwordx4 a[148:151], v1, s[44:47], s8 offen offset:1024 sc1
    buffer_load_dwordx4 a[152:155], v1, s[44:47], s8 offen offset:2048 sc1
    buffer_load_dwordx4 a[156:159], v1, s[44:47], s8 offen offset:3072 sc1
    s_add_u32 s8, s8, 4096
    buffer_load_dwordx4 a[160:163], v1, s[44:47], s8 offen offset:0 sc1
    buffer_load_dwordx4 a[164:167], v1, s[44:47], s8 offen offset:1024 sc1
    s_add_u32 s8, s10, 3842048
    buffer_load_dwordx4 a[168:171], v1, s[44:47], s8 offen offset:0 sc1
    buffer_load_dwordx4 a[172:175], v1, s[44:47], s8 offen offset:1024 sc1
    buffer_load_dwordx4 a[176:179], v1, s[44:47], s8 offen offset:2048 sc1
    buffer_load_dwordx4 a[180:183], v1, s[44:47], s8 offen offset:3072 sc1
    s_add_u32 s8, s8, 4096
    buffer_load_dwordx4 a[184:187], v1, s[44:47], s8 offen offset:0 sc1
    buffer_load_dwordx4 a[188:191], v1, s[44:47], s8 offen offset:1024 sc1
    buffer_load_dwordx4 a[192:195], v1, s[44:47], s8 offen offset:2048 sc1
    buffer_load_dwordx4 a[196:199], v1, s[44:47], s8 offen offset:3072 sc1
    s_add_u32 s8, s8, 4096
    buffer_load_dwordx4 a[200:203], v1, s[44:47], s8 offen offset:0 sc1
    buffer_load_dwordx4 a[204:207], v1, s[44:47], s8 offen offset:1024 sc1
    buffer_load_dwordx4 a[208:211], v1, s[44:47], s8 offen offset:2048 sc1
    buffer_load_dwordx4 a[212:215], v1, s[44:47], s8 offen offset:3072 sc1
    s_add_u32 s8, s8, 4096
    buffer_load_dwordx4 a[216:219], v1, s[44:47], s8 offen offset:0 sc1
    buffer_load_dwordx4 a[220:223], v1, s[44:47], s8 offen offset:1024 sc1
    s_waitcnt vmcnt(30)
    s_mov_b32 s8, 94896128
    buffer_load_dwordx4 v[76:79], v1, s[44:47], s8 offen offset:0 sc1
    buffer_load_dwordx4 v[76:79], v1, s[44:47], s8 offen offset:1024 sc1
    s_mov_b32 s8, 94928896
    buffer_load_dwordx4 v[76:79], v1, s[44:47], s8 offen offset:0 sc1
    buffer_load_dwordx4 v[76:79], v1, s[44:47], s8 offen offset:1024 sc1
    buffer_load_dwordx4 v[76:79], v1, s[44:47], s8 offen offset:2048 sc1
    buffer_load_dwordx4 v[76:79], v1, s[44:47], s8 offen offset:3072 sc1
    buffer_load_dwordx4 v[76:79], v10, s[44:47], s8 offen offset:0 sc1
    s_mov_b32 s8, 94904320
    buffer_load_dwordx4 v[76:79], v1, s[44:47], s8 offen offset:0 sc1
    buffer_load_dwordx4 v[76:79], v1, s[44:47], s8 offen offset:1024 sc1
    s_mov_b32 s8, 94949632
    buffer_load_dwordx4 v[76:79], v1, s[44:47], s8 offen offset:0 sc1
    buffer_load_dwordx4 v[76:79], v1, s[44:47], s8 offen offset:1024 sc1
    buffer_load_dwordx4 v[76:79], v1, s[44:47], s8 offen offset:2048 sc1
    buffer_load_dwordx4 v[76:79], v1, s[44:47], s8 offen offset:3072 sc1
    buffer_load_dwordx4 v[76:79], v10, s[44:47], s8 offen offset:0 sc1
    s_mov_b32 s8, 94912512
    buffer_load_dwordx4 v[76:79], v1, s[44:47], s8 offen offset:0 sc1
    buffer_load_dwordx4 v[76:79], v1, s[44:47], s8 offen offset:1024 sc1
    s_mov_b32 s8, 94970368
    buffer_load_dwordx4 v[76:79], v1, s[44:47], s8 offen offset:0 sc1
    buffer_load_dwordx4 v[76:79], v1, s[44:47], s8 offen offset:1024 sc1
    buffer_load_dwordx4 v[76:79], v1, s[44:47], s8 offen offset:2048 sc1
    buffer_load_dwordx4 v[76:79], v1, s[44:47], s8 offen offset:3072 sc1
    buffer_load_dwordx4 v[76:79], v10, s[44:47], s8 offen offset:0 sc1
    s_mov_b32 s8, 94920704
    buffer_load_dwordx4 v[76:79], v1, s[44:47], s8 offen offset:0 sc1
    buffer_load_dwordx4 v[76:79], v1, s[44:47], s8 offen offset:1024 sc1
    s_mov_b32 s8, 94991104
    buffer_load_dwordx4 v[76:79], v1, s[44:47], s8 offen offset:0 sc1
    buffer_load_dwordx4 v[76:79], v1, s[44:47], s8 offen offset:1024 sc1
    buffer_load_dwordx4 v[76:79], v1, s[44:47], s8 offen offset:2048 sc1
    buffer_load_dwordx4 v[76:79], v1, s[44:47], s8 offen offset:3072 sc1
    buffer_load_dwordx4 v[76:79], v10, s[44:47], s8 offen offset:0 sc1
    s_waitcnt vmcnt(0)
    s_barrier
    s_mov_b32 s9, 95072384
    s_mov_b64 exec, 1
    v_mov_b32 v2, 1
    buffer_atomic_add v2, off, s[44:47], s9 sc1
    s_mov_b64 exec, -1
    s_cmp_gt_u32 s95, 0xffff
    s_cbranch_scc1 ch0as
    s_branch ch0af
chw1:
    s_cmp_lg_u32 s6, 1
    s_cbranch_scc1 chw2
    s_cmp_ge_u32 s7, 28
    s_cbranch_scc1 chw1a
    s_lshr_b32 s8, s80, 2
    s_mul_i32 s12, s8, 5120
    s_bfe_u32 s8, s80, 0x10001
    s_lshl_b32 s8, s8, 9
    s_add_u32 s12, s12, s8
    s_and_b32 s8, s80, 1
    s_lshl_b32 s8, s8, 5
    s_add_u32 s12, s12, s8
    s_lshl_b32 s8, s81, 11
    s_add_u32 s12, s12, s8
    s_add_u32 s12, s12, 94928896
    s_mul_i32 s13, s7, 640
    s_add_u32 s13, s13, 94929152
    s_lshl_b32 s14, s82, 8
    s_add_u32 s14, s14, 94896128
    s_waitcnt vmcnt(0)
    s_cmp_lg_u32 s6, 0
    s_cbranch_scc1 sw_90
    v_min_u32 v23, 6, v0
    v_lshlrev_b32 v23, 7, v23
    s_mov_b32 s98, 95072768
    s_mov_b32 s99, 0
ws_91:
    buffer_load_dword v22, v23, s[44:47], s98 offen sc1
    s_add_u32 s99, s99, 1
    s_cmp_ge_u32 s99, 400000
    s_cbranch_scc1 mega_abort
    s_waitcnt vmcnt(0)
    v_cmp_gt_u32 vcc, 32, v22
    s_cbranch_vccz wt_92
    s_sleep 4
    s_branch ws_91
wt_92:
sw_90:
    s_barrier
    s_cmp_lg_u32 s6, 0
    s_cbranch_scc1 rv_93
    s_cmp_eq_u32 s5, 0
    s_cselect_b32 s8, 1, 0x10001
    s_mov_b32 s9, 95072512
    s_mov_b64 exec, 1
    v_mov_b32 v22, s8
    buffer_atomic_add v22, off, s[44:47], s9 sc1
    s_mov_b64 exec, -1
rv_93:
    s_lshl_b32 s95, s82, 4
    s_add_u32 s95, s95, 4
    s_mul_i32 s95, s95, 14336
    s_add_u32 s95, s95, 10092544
    s_waitcnt vmcnt(40)
    s_add_u32 s8, s95, 0
    buffer_load_dwordx4 a[224:227], v1, s[44:47], s8 offen offset:0 sc1
    s_add_u32 s8, s95, 0
    buffer_load_dwordx4 a[228:231], v1, s[44:47], s8 offen offset:1024 sc1
    s_add_u32 s8, s95, 0
    buffer_load_dwordx4 a[232:235], v1, s[44:47], s8 offen offset:2048 sc1
    s_add_u32 s8, s95, 0
    buffer_load_dwordx4 a[236:239], v1, s[44:47], s8 offen offset:3072 sc1
    s_add_u32 s8, s95, 4096
    buffer_load_dwordx4 a[240:243], v1, s[44:47], s8 offen offset:0 sc1
    s_add_u32 s8, s95, 4096
    buffer_load_dwordx4 a[244:247], v1, s[44:47], s8 offen offset:1024 sc1
    s_add_u32 s8, s95, 4096
    buffer_load_dwordx4 a[248:251], v1, s[44:47], s8 offen offset:2048 sc1
    s_add_u32 s8, s95, 4096
    buffer_load_dwordx4 a[252:255], v1, s[44:47], s8 offen offset:3072 sc1
    s_add_u32 s8, s95, 8192
    buffer_load_dwordx4 v[120:123], v1, s[44:47], s8 offen offset:0 sc1
    s_add_u32 s8, s95, 8192
    buffer_load_dwordx4 v[124:127], v1, s[44:47], s8 offen offset:1024 sc1
    s_add_u32 s8, s95, 8192
    buffer_load_dwordx4 v[128:131], v1, s[44:47], s8 offen offset:2048 sc1
    s_add_u32 s8, s95, 8192
    buffer_load_dwordx4 v[132:135], v1, s[44:47], s8 offen offset:3072 sc1
    s_add_u32 s8, s95, 12288
    buffer_load_dwordx4 v[136:139], v1, s[44:47], s8 offen offset:0 sc1
    s_add_u32 s8, s95, 12288
    buffer_load_dwordx4 v[140:143], v1, s[44:47], s8 offen offset:1024 sc1
    s_waitcnt vmcnt(40)
    s_add_u32 s8, s95, 12288
    buffer_load_dwordx4 v[144:147], v1, s[44:47], s8 offen offset:2048 sc1
    s_add_u32 s8, s95, 12288
    buffer_load_dwordx4 v[148:151], v1, s[44:47], s8 offen offset:3072 sc1
    s_add_u32 s8, s95, 16384
    buffer_load_dwordx4 v[152:155], v1, s[44:47], s8 offen offset:0 sc1
    s_add_u32 s8, s95, 16384
    buffer_load_dwordx4 v[156:159], v1, s[44:47], s8 offen offset:1024 sc1
    s_add_u32 s8, s95, 16384
    buffer_load_dwordx4 v[160:163], v1, s[44:47], s8 offen offset:2048 sc1
    s_add_u32 s8, s95, 16384
    buffer_load_dwordx4 v[164:167], v1, s[44:47], s8 offen offset:3072 sc1
    s_add_u32 s8, s95, 20480
    buffer_load_dwordx4 v[168:171], v1, s[44:47], s8 offen offset:0 sc1
    s_add_u32 s8, s95, 20480
    buffer_load_dwordx4 v[172:175], v1, s[44:47], s8 offen offset:1024 sc1
    s_add_u32 s8, s95, 20480
    buffer_load_dwordx4 v[176:179], v1, s[44:47], s8 offen offset:2048 sc1
    s_add_u32 s8, s95, 20480
    buffer_load_dwordx4 v[180:183], v1, s[44:47], s8 offen offset:3072 sc1
    s_add_u32 s8, s95, 24576
    buffer_load_dwordx4 v[184:187], v1, s[44:47], s8 offen offset:0 sc1
    s_add_u32 s8, s95, 24576
    buffer_load_dwordx4 v[188:191], v1, s[44:47], s8 offen offset:1024 sc1
    s_add_u32 s8, s95, 24576
    buffer_load_dwordx4 v[192:195], v1, s[44:47], s8 offen offset:2048 sc1
    s_add_u32 s8, s95, 24576
    buffer_load_dwordx4 v[196:199], v1, s[44:47], s8 offen offset:3072 sc1
    s_waitcnt vmcnt(40)
    s_add_u32 s8, s95, 28672
    buffer_load_dwordx4 v[200:203], v1, s[44:47], s8 offen offset:0 sc1
    s_add_u32 s8, s95, 28672
    buffer_load_dwordx4 v[204:207], v1, s[44:47], s8 offen offset:1024 sc1
    s_add_u32 s8, s95, 28672
    buffer_load_dwordx4 v[208:211], v1, s[44:47], s8 offen offset:2048 sc1
    s_add_u32 s8, s95, 28672
    buffer_load_dwordx4 v[212:215], v1, s[44:47], s8 offen offset:3072 sc1
    s_add_u32 s8, s95, 32768
    buffer_load_dwordx4 v[216:219], v1, s[44:47], s8 offen offset:0 sc1
    s_add_u32 s8, s95, 32768
    buffer_load_dwordx4 v[220:223], v1, s[44:47], s8 offen offset:1024 sc1
    s_add_u32 s8, s95, 32768
    buffer_load_dwordx4 v[224:227], v1, s[44:47], s8 offen offset:2048 sc1
    s_add_u32 s8, s95, 32768
    buffer_load_dwordx4 v[228:231], v1, s[44:47], s8 offen offset:3072 sc1
    s_add_u32 s8, s95, 36864
    buffer_load_dwordx4 v[232:235], v1, s[44:47], s8 offen offset:0 sc1
    s_add_u32 s8, s95, 36864
    buffer_load_dwordx4 v[236:239], v1, s[44:47], s8 offen offset:1024 sc1
    s_add_u32 s8, s95, 36864
    buffer_load_dwordx4 v[240:243], v1, s[44:47], s8 offen offset:2048 sc1
    s_add_u32 s8, s95, 36864
    buffer_load_dwordx4 v[244:247], v1, s[44:47], s8 offen offset:3072 sc1
    s_add_u32 s8, s95, 40960
    buffer_load_dwordx4 v[248:251], v1, s[44:47], s8 offen offset:0 sc1
    s_add_u32 s8, s95, 40960
    buffer_load_dwordx4 v[252:255], v1, s[44:47], s8 offen offset:1024 sc1
    s_waitcnt vmcnt(40)
    s_add_u32 s8, s95, 40960
    s_mov_b32 m0, 45056
    s_nop 0
    buffer_load_dwordx4 v1, s[44:47], s8 offen offset:2048 sc1 lds
    s_add_u32 s8, s95, 40960
    s_mov_b32 m0, 45056
    s_nop 0
    buffer_load_dwordx4 v1, s[44:47], s8 offen offset:3072 sc1 lds
    s_add_u32 s8, s95, 45056
    s_mov_b32 m0, 49152
    s_nop 0
    buffer_load_dwordx4 v1, s[44:47], s8 offen offset:0 sc1 lds
    s_add_u32 s8, s95, 45056
    s_mov_b32 m0, 49152
    s_nop 0
    buffer_load_dwordx4 v1, s[44:47], s8 offen offset:1024 sc1 lds
    s_add_u32 s8, s95, 45056
    s_mov_b32 m0, 49152
    s_nop 0
    buffer_load_dwordx4 v1, s[44:47], s8 offen offset:2048 sc1 lds
    s_add_u32 s8, s95, 45056
    s_mov_b32 m0, 49152
    s_nop 0
    buffer_load_dwordx4 v1, s[44:47], s8 offen offset:3072 sc1 lds
    s_add_u32 s8, s95, 49152
    s_mov_b32 m0, 53248
    s_nop 0
    buffer_load_dwordx4 v1, s[44:47], s8 offen offset:0 sc1 lds
    s_add_u32 s8, s95, 49152
    s_mov_b32 m0, 53248
    s_nop 0
    buffer_load_dwordx4 v1, s[44:47], s8 offen offset:1024 sc1 lds
    s_add_u32 s8, s95, 49152
    s_mov_b32 m0, 53248
    s_nop 0
    buffer_load_dwordx4 v1, s[44:47], s8 offen offset:2048 sc1 lds
    s_add_u32 s8, s95, 49152
    s_mov_b32 m0, 53248
    s_nop 0
    buffer_load_dwordx4 v1, s[44:47], s8 offen offset:3072 sc1 lds
    s_add_u32 s8, s95, 53248
    s_mov_b32 m0, 57344
    s_nop 0
    buffer_load_dwordx4 v1, s[44:47], s8 offen offset:0 sc1 lds
    s_add_u32 s8, s95, 53248
    s_mov_b32 m0, 57344
    s_nop 0
    buffer_load_dwordx4 v1, s[44:47], s8 offen offset:1024 sc1 lds
    s_add_u32 s8, s95, 53248
    s_mov_b32 m0, 57344
    s_nop 0
    buffer_load_dwordx4 v1, s[44:47], s8 offen offset:2048 sc1 lds
    s_add_u32 s8, s95, 53248
    s_mov_b32 m0, 57344
    s_nop 0
    buffer_load_dwordx4 v1, s[44:47], s8 offen offset:3072 sc1 lds
    v_mov_b32 v16, 0
    v_mov_b32 v17, 0
    v_lshlrev_b32 v18, 3, v0
    ds_write_b64 v18, v[16:17] offset:11776
    v_lshrrev_b32 v4, 4, v0
    v_bfe_u32 v5, v3, 1, 1
    v_mul_u32_u24 v5, 0xaaaa, v5
    v_add_u32 v5, 0x4444, v5
    v_bfe_u32 v6, v3, 2, 1
    v_lshlrev_b32 v6, 7, v6
    v_lshrrev_b32 v7, 3, v3
    v_lshl_add_u32 v6, v7, 6, v6
    v_and_b32 v7, 1, v3
    v_lshl_add_u32 v6, v7, 5, v6
    v_lshl_add_u32 v6, v4, 3, v6
    v_bfe_u32 v7, v3, 1, 1
    v_lshl_add_u32 v6, v7, 2, v6
    v_add_u32 v6, 8192, v6
    v_lshrrev_b32 v7, 2, v3
    v_lshlrev_b32 v7, 5, v7
    v_lshl_add_u32 v7, v4, 8, v7
    v_and_b32 v8, 3, v3
    v_lshl_add_u32 v7, v8, 3, v7
    v_add_u32 v7, 8192, v7
    v_bfe_u32 v8, v3, 1, 2
    v_lshlrev_b32 v8, 6, v8
    v_and_b32 v9, 1, v3
    v_lshl_add_u32 v8, v9, 4, v8
    v_lshrrev_b32 v9, 1, v4
    v_lshl_add_u32 v8, v9, 8, v8
    v_and_b32 v9, 1, v4
    v_lshl_add_u32 v8, v9, 3, v8
    s_mul_i32 s8, s81, 3584
    v_add_u32 v8, s8, v8
    v_lshlrev_b32 v11, 7, v4
    v_lshl_add_u32 v11, v3, 2, v11
    s_lshl_b32 s8, s6, 9
    s_add_u32 s8, s8, 12288
    v_add_u32 v11, s8, v11
    v_lshlrev_b32 v12, 3, v0
    v_add_u32 v12, 12288, v12
    v_lshrrev_b32 v13, 4, v0
    v_lshlrev_b32 v13, 6, v13
    v_bfe_u32 v14, v0, 2, 1
    v_lshl_add_u32 v13, v14, 5, v13
    v_bfe_u32 v14, v0, 3, 1
    v_lshl_add_u32 v13, v14, 4, v13
    v_and_b32 v14, 3, v0
    v_lshl_add_u32 v13, v14, 2, v13
    v_lshlrev_b32 v9, 6, v4
    v_and_b32 v22, 1, v3
    v_lshl_add_u32 v9, v22, 4, v9
    v_mov_b32 v14, 0x05040100
    v_mov_b32 v23, 0x03020706
    v_cmp_eq_u32 vcc, 1, v22
    s_nop 1
    v_cndmask_b32 v14, v14, v23, vcc
    v_bfe_u32 v22, v3, 2, 1
    v_lshl_add_u32 v9, v22, 8, v9
    v_bfe_u32 v22, v3, 1, 1
    v_lshl_add_u32 v9, v22, 2, v9
    s_mul_i32 s8, s81, 2040
    s_sub_u32 s8, 4096, s8
    v_add_u32 v9, s8, v9
    v_lshrrev_b32 v22, 3, v3
    v_lshlrev_b32 v22, 30, v22
    v_add_u32 v9, v22, v9
    s_setreg_imm32_b32 hwreg(HW_REG_MODE, 23, 1), 1
    v_add_u32 v10, 4096, v1
    v_add_u32 v13, 2048, v8
    s_cmp_lg_u32 s6, 0
    s_cbranch_scc1 sw_94
    v_min_u32 v23, 7, v0
    v_lshlrev_b32 v23, 7, v23
    s_mov_b32 s98, 95072768
    s_mov_b32 s99, 0
ws_95:
    buffer_load_dword v22, v23, s[44:47], s98 offen sc1
    s_add_u32 s99, s99, 1
    s_cmp_ge_u32 s99, 400000
    s_cbranch_scc1 mega_abort
    s_waitcnt vmcnt(0)
    v_cmp_gt_u32 vcc, 32, v22
    s_cbranch_vccz wt_96
    s_sleep 4
    s_branch ws_95
wt_96:
sw_94:
    s_barrier
    v_add_u32 v12, 47104, v1
    s_mov_b32 s15, 65536
    v_mov_b32 v3, -1
    v_mov_b32 v104, 0
    v_mov_b32 v105, 0
    v_mov_b32 v106, 0
    v_mov_b32 v107, 0
    v_mov_b32 v108, 0
    v_mov_b32 v109, 0
    v_mov_b32 v110, 0
    v_mov_b32 v111, 0
    v_mov_b32 v117, 0
    v_mov_b32 v119, 0
    v_lshlrev_b32 v4, 2, v0
    s_mul_i32 s72, s81, 7168
    s_add_u32 s72, s72, 1835008
    s_lshl_b32 s71, s82, 14
    s_add_u32 s71, s71, 16519168
    s_mov_b32 s75, 95014912
    s_mov_b32 s73, 95072640
    s_mov_b32 s64, 0
    s_add_u32 s16, s72, 14336
    s_add_u32 s20, s15, 8192
    s_add_u32 s17, s72, 18432
    s_add_u32 s21, s15, 12288
    s_add_u32 s72, s72, 28672
    s_xor_b32 s15, s15, 0x4000
    s_mov_b32 m0, s20
    s_nop 0
    buffer_load_dwordx4 v1, s[44:47], s16 offen offset:2048 sc1 lds
    buffer_load_dwordx4 v1, s[44:47], s16 offen offset:3072 sc1 lds
    s_mov_b32 m0, s21
    s_nop 0
    buffer_load_dwordx4 v1, s[44:47], s17 offen offset:0 sc1 lds
    buffer_load_dwordx4 v1, s[44:47], s17 offen offset:1024 sc1 lds
    buffer_load_dwordx4 v1, s[44:47], s17 offen offset:2048 sc1 lds
    s_mov_b32 s100, 0
    s_mov_b32 s101, -1
    v_mov_b32 v2, 0
    s_mov_b32 s9, 95072512
    s_mov_b32 s83, 0
rdv_97:
    buffer_load_dword v2, off, s[44:47], s9 sc1
    s_add_u32 s83, s83, 1
    s_cmp_ge_u32 s83, 2000000
    s_cbranch_scc1 chain_abort
    s_waitcnt vmcnt(0) lgkmcnt(0)
    v_readfirstlane_b32 s8, v2
    s_and_b32 s10, s8, 0xffff
    s_cmp_lt_u32 s10, 32
    s_cbranch_scc1 rdv_97
    s_mov_b32 s95, s8
    s_cmp_lg_u32 s6, 0
    s_cbranch_scc1 sw_98
    v_min_u32 v23, 6, v0
    v_lshlrev_b32 v23, 7, v23
    s_mov_b32 s98, 95073792
    s_mov_b32 s99, 0
ws_99:
    buffer_load_dword v22, v23, s[44:47], s98 offen sc1
    s_add_u32 s99, s99, 1
    s_cmp_ge_u32 s99, 400000
    s_cbranch_scc1 mega_abort
    s_waitcnt vmcnt(0)
    v_cmp_gt_u32 vcc, 32, v22
    s_cbranch_vccz wt_100
    s_sleep 4
    s_branch ws_99
wt_100:
sw_98:
    s_barrier
    s_mul_i32 s10, s80, 28
    s_mul_i32 s9, s81, 14
    s_add_u32 s10, s10, s9
    s_mul_i32 s10, s10, 14336
    s_add_u32 s8, s10, 3713024
    buffer_load_dwordx4 a[0:3], v1, s[44:47], s8 offen offset:0 sc1
    buffer_load_dwordx4 a[4:7], v1, s[44:47], s8 offen offset:1024 sc1
    buffer_load_dwordx4 a[8:11], v1, s[44:47], s8 offen offset:2048 sc1
    buffer_load_dwordx4 a[12:15], v1, s[44:47], s8 offen offset:3072 sc1
    s_add_u32 s8, s8, 4096
    buffer_load_dwordx4 a[16:19], v1, s[44:47], s8 offen offset:0 sc1
    buffer_load_dwordx4 a[20:23], v1, s[44:47], s8 offen offset:1024 sc1
    buffer_load_dwordx4 a[24:27], v1, s[44:47], s8 offen offset:2048 sc1
    buffer_load_dwordx4 a[28:31], v1, s[44:47], s8 offen offset:3072 sc1
    s_add_u32 s8, s8, 4096
    buffer_load_dwordx4 a[32:35], v1, s[44:47], s8 offen offset:0 sc1
    buffer_load_dwordx4 a[36:39], v1, s[44:47], s8 offen offset:1024 sc1
    buffer_load_dwordx4 a[40:43], v1, s[44:47], s8 offen offset:2048 sc1
    buffer_load_dwordx4 a[44:47], v1, s[44:47], s8 offen offset:3072 sc1
    s_add_u32 s8, s8, 4096
    buffer_load_dwordx4 a[48:51], v1, s[44:47], s8 offen offset:0 sc1
    buffer_load_dwordx4 a[52:55], v1, s[44:47], s8 offen offset:1024 sc1
    s_add_u32 s8, s10, 3727360
    buffer_load_dwordx4 a[56:59], v1, s[44:47], s8 offen offset:0 sc1
    buffer_load_dwordx4 a[60:63], v1, s[44:47], s8 offen offset:1024 sc1
    buffer_load_dwordx4 a[64:67], v1, s[44:47], s8 offen offset:2048 sc1
    buffer_load_dwordx4 a[68:71], v1, s[44:47], s8 offen offset:3072 sc1
    s_add_u32 s8, s8, 4096
    buffer_load_dwordx4 a[72:75], v1, s[44:47], s8 offen offset:0 sc1
    buffer_load_dwordx4 a[76:79], v1, s[44:47], s8 offen offset:1024 sc1
    buffer_load_dwordx4 a[80:83], v1, s[44:47], s8 offen offset:2048 sc1
    buffer_load_dwordx4 a[84:87], v1, s[44:47], s8 offen offset:3072 sc1
    s_add_u32 s8, s8, 4096
    buffer_load_dwordx4 a[88:91], v1, s[44:47], s8 offen offset:0 sc1
    buffer_load_dwordx4 a[92:95], v1, s[44:47], s8 offen offset:1024 sc1
    buffer_load_dwordx4 a[96:99], v1, s[44:47], s8 offen offset:2048 sc1
    buffer_load_dwordx4 a[100:103], v1, s[44:47], s8 offen offset:3072 sc1
    s_add_u32 s8, s8, 4096
    buffer_load_dwordx4 a[104:107], v1, s[44:47], s8 offen offset:0 sc1
    buffer_load_dwordx4 a[108:111], v1, s[44:47], s8 offen offset:1024 sc1
    s_add_u32 s8, s10, 3741696
    buffer_load_dwordx4 a[112:115], v1, s[44:47], s8 offen offset:0 sc1
    buffer_load_dwordx4 a[116:119], v1, s[44:47], s8 offen offset:1024 sc1
    buffer_load_dwordx4 a[120:123], v1, s[44:47], s8 offen offset:2048 sc1
    buffer_load_dwordx4 a[124:127], v1, s[44:47], s8 offen offset:3072 sc1
    s_add_u32 s8, s8, 4096
    buffer_load_dwordx4 a[128:131], v1, s[44:47], s8 offen offset:0 sc1
    buffer_load_dwordx4 a[132:135], v1, s[44:47], s8 offen offset:1024 sc1
    buffer_load_dwordx4 a[136:139], v1, s[44:47], s8 offen offset:2048 sc1
    buffer_load_dwordx4 a[140:143], v1, s[44:47], s8 offen offset:3072 sc1
    s_add_u32 s8, s8, 4096
    buffer_load_dwordx4 a[144:147], v1, s[44:47], s8 offen offset:0 sc1
    buffer_load_dwordx4 a[148:151], v1, s[44:47], s8 offen offset:1024 sc1
    buffer_load_dwordx4 a[152:155], v1, s[44:47], s8 offen offset:2048 sc1
    buffer_load_dwordx4 a[156:159], v1, s[44:47], s8 offen offset:3072 sc1
    s_add_u32 s8, s8, 4096
    buffer_load_dwordx4 a[160:163], v1, s[44:47], s8 offen offset:0 sc1
    buffer_load_dwordx4 a[164:167], v1, s[44:47], s8 offen offset:1024 sc1
    s_add_u32 s8, s10, 3856384
    buffer_load_dwordx4 a[168:171], v1, s[44:47], s8 offen offset:0 sc1
    buffer_load_dwordx4 a[172:175], v1, s[44:47], s8 offen offset:1024 sc1
    buffer_load_dwordx4 a[176:179], v1, s[44:47], s8 offen offset:2048 sc1
    buffer_load_dwordx4 a[180:183], v1, s[44:47], s8 offen offset:3072 sc1
    s_add_u32 s8, s8, 4096
    buffer_load_dwordx4 a[184:187], v1, s[44:47], s8 offen offset:0 sc1
    buffer_load_dwordx4 a[188:191], v1, s[44:47], s8 offen offset:1024 sc1
    buffer_load_dwordx4 a[192:195], v1, s[44:47], s8 offen offset:2048 sc1
    buffer_load_dwordx4 a[196:199], v1, s[44:47], s8 offen offset:3072 sc1
    s_add_u32 s8, s8, 4096
    buffer_load_dwordx4 a[200:203], v1, s[44:47], s8 offen offset:0 sc1
    buffer_load_dwordx4 a[204:207], v1, s[44:47], s8 offen offset:1024 sc1
    buffer_load_dwordx4 a[208:211], v1, s[44:47], s8 offen offset:2048 sc1
    buffer_load_dwordx4 a[212:215], v1, s[44:47], s8 offen offset:3072 sc1
    s_add_u32 s8, s8, 4096
    buffer_load_dwordx4 a[216:219], v1, s[44:47], s8 offen offset:0 sc1
    buffer_load_dwordx4 a[220:223], v1, s[44:47], s8 offen offset:1024 sc1
    s_waitcnt vmcnt(30)
    s_mov_b32 s8, 94898176
    buffer_load_dwordx4 v[76:79], v1, s[44:47], s8 offen offset:0 sc1
    buffer_load_dwordx4 v[76:79], v1, s[44:47], s8 offen offset:1024 sc1
    s_mov_b32 s8, 94934016
    buffer_load_dwordx4 v[76:79], v1, s[44:47], s8 offen offset:0 sc1
    buffer_load_dwordx4 v[76:79], v1, s[44:47], s8 offen offset:1024 sc1
    buffer_load_dwordx4 v[76:79], v1, s[44:47], s8 offen offset:2048 sc1
    buffer_load_dwordx4 v[76:79], v1, s[44:47], s8 offen offset:3072 sc1
    buffer_load_dwordx4 v[76:79], v10, s[44:47], s8 offen offset:0 sc1
    s_mov_b32 s8, 94906368
    buffer_load_dwordx4 v[76:79], v1, s[44:47], s8 offen offset:0 sc1
    buffer_load_dwordx4 v[76:79], v1, s[44:47], s8 offen offset:1024 sc1
    s_mov_b32 s8, 94954752
    buffer_load_dwordx4 v[76:79], v1, s[44:47], s8 offen offset:0 sc1
    buffer_load_dwordx4 v[76:79], v1, s[44:47], s8 offen offset:1024 sc1
    buffer_load_dwordx4 v[76:79], v1, s[44:47], s8 offen offset:2048 sc1
    buffer_load_dwordx4 v[76:79], v1, s[44:47], s8 offen offset:3072 sc1
    buffer_load_dwordx4 v[76:79], v10, s[44:47], s8 offen offset:0 sc1
    s_mov_b32 s8, 94914560
    buffer_load_dwordx4 v[76:79], v1, s[44:47], s8 offen offset:0 sc1
    buffer_load_dwordx4 v[76:79], v1, s[44:47], s8 offen offset:1024 sc1
    s_mov_b32 s8, 94975488
    buffer_load_dwordx4 v[76:79], v1, s[44:47], s8 offen offset:0 sc1
    buffer_load_dwordx4 v[76:79], v1, s[44:47], s8 offen offset:1024 sc1
    buffer_load_dwordx4 v[76:79], v1, s[44:47], s8 offen offset:2048 sc1
    buffer_load_dwordx4 v[76:79], v1, s[44:47], s8 offen offset:3072 sc1
    buffer_load_dwordx4 v[76:79], v10, s[44:47], s8 offen offset:0 sc1
    s_mov_b32 s8, 94922752
    buffer_load_dwordx4 v[76:79], v1, s[44:47], s8 offen offset:0 sc1
    buffer_load_dwordx4 v[76:79], v1, s[44:47], s8 offen offset:1024 sc1
    s_mov_b32 s8, 94996224
    buffer_load_dwordx4 v[76:79], v1, s[44:47], s8 offen offset:0 sc1
    buffer_load_dwordx4 v[76:79], v1, s[44:47], s8 offen offset:1024 sc1
    buffer_load_dwordx4 v[76:79], v1, s[44:47], s8 offen offset:2048 sc1
    buffer_load_dwordx4 v[76:79], v1, s[44:47], s8 offen offset:3072 sc1
    buffer_load_dwordx4 v[76:79], v10, s[44:47], s8 offen offset:0 sc1
    v_lshlrev_b32 v113, 7, v0
    s_mov_b32 s99, 0
hz_101:
    buffer_load_dword v115, v113, s[44:47], s75 offen sc1
    s_waitcnt vmcnt(0)
    v_cmp_gt_u32 vcc, 28, v115
    s_ff1_i32_b64 s100, vcc
    s_cmp_eq_u32 s100, -1
    s_cselect_b32 s100, 65, s100
    s_sub_u32 s100, s100, 1
    s_cmp_ge_i32 s100, s64
    s_cbranch_scc1 hd_102
    s_sleep 1
    s_add_u32 s99, s99, 1
    s_cmp_lt_u32 s99, 400000
    s_cbranch_scc1 hz_101
    s_branch chain_abort
hd_102:
    s_mov_b32 m0, 20480
    s_nop 0
    buffer_load_dwordx4 v1, s[44:47], s71 offen offset:0 sc1 lds
    buffer_load_dwordx4 v1, s[44:47], s71 offen offset:1024 sc1 lds
    s_barrier
    s_cmp_gt_u32 s95, 0xffff
    s_cbranch_scc1 ch1bs
    s_branch ch1bf
chw1a:
    s_lshr_b32 s8, s80, 2
    s_mul_i32 s12, s8, 5120
    s_bfe_u32 s8, s80, 0x10001
    s_lshl_b32 s8, s8, 9
    s_add_u32 s12, s12, s8
    s_and_b32 s8, s80, 1
    s_lshl_b32 s8, s8, 5
    s_add_u32 s12, s12, s8
    s_lshl_b32 s8, s81, 11
    s_add_u32 s12, s12, s8
    s_add_u32 s12, s12, 94928896
    s_mul_i32 s13, s7, 640
    s_add_u32 s13, s13, 94929152
    s_lshl_b32 s14, s82, 8
    s_add_u32 s14, s14, 94896128
    s_waitcnt vmcnt(0)
    s_cmp_lg_u32 s6, 0
    s_cbranch_scc1 sw_103
    v_min_u32 v23, 6, v0
    v_lshlrev_b32 v23, 7, v23
    s_mov_b32 s98, 95072768
    s_mov_b32 s99, 0
ws_104:
    buffer_load_dword v22, v23, s[44:47], s98 offen sc1
    s_add_u32 s99, s99, 1
    s_cmp_ge_u32 s99, 400000
    s_cbranch_scc1 mega_abort
    s_waitcnt vmcnt(0)
    v_cmp_gt_u32 vcc, 32, v22
    s_cbranch_vccz wt_105
    s_sleep 4
    s_branch ws_104
wt_105:
sw_103:
    s_barrier
    s_cmp_lg_u32 s6, 0
    s_cbranch_scc1 rv_106
    s_cmp_eq_u32 s5, 0
    s_cselect_b32 s8, 1, 0x10001
    s_mov_b32 s9, 95072512
    s_mov_b64 exec, 1
    v_mov_b32 v22, s8
    buffer_atomic_add v22, off, s[44:47], s9 sc1
    s_mov_b64 exec, -1
rv_106:
    s_lshl_b32 s95, s82, 4
    s_add_u32 s95, s95, 4
    s_mul_i32 s95, s95, 14336
    s_add_u32 s95, s95, 10092544
    v_mov_b32 v16, 0
    v_mov_b32 v17, 0
    v_lshlrev_b32 v18, 3, v0
    ds_write_b64 v18, v[16:17] offset:11776
    v_lshrrev_b32 v4, 4, v0
    v_bfe_u32 v5, v3, 1, 1
    v_mul_u32_u24 v5, 0xaaaa, v5
    v_add_u32 v5, 0x4444, v5
    v_bfe_u32 v6, v3, 2, 1
    v_lshlrev_b32 v6, 7, v6
    v_lshrrev_b32 v7, 3, v3
    v_lshl_add_u32 v6, v7, 6, v6
    v_and_b32 v7, 1, v3
    v_lshl_add_u32 v6, v7, 5, v6
    v_lshl_add_u32 v6, v4, 3, v6
    v_bfe_u32 v7, v3, 1, 1
    v_lshl_add_u32 v6, v7, 2, v6
    v_add_u32 v6, 8192, v6
    v_lshrrev_b32 v7, 2, v3
    v_lshlrev_b32 v7, 5, v7
    v_lshl_add_u32 v7, v4, 8, v7
    v_and_b32 v8, 3, v3
    v_lshl_add_u32 v7, v8, 3, v7
    v_add_u32 v7, 8192, v7
    v_bfe_u32 v8, v3, 1, 2
    v_lshlrev_b32 v8, 6, v8
    v_and_b32 v9, 1, v3
    v_lshl_add_u32 v8, v9, 4, v8
    v_lshrrev_b32 v9, 1, v4
    v_lshl_add_u32 v8, v9, 8, v8
    v_and_b32 v9, 1, v4
    v_lshl_add_u32 v8, v9, 3, v8
    s_mul_i32 s8, s81, 3584
    v_add_u32 v8, s8, v8
    v_lshlrev_b32 v11, 7, v4
    v_lshl_add_u32 v11, v3, 2, v11
    s_lshl_b32 s8, s6, 9
    s_add_u32 s8, s8, 12288
    v_add_u32 v11, s8, v11
    v_lshlrev_b32 v12, 3, v0
    v_add_u32 v12, 12288, v12
    v_lshrrev_b32 v13, 4, v0
    v_lshlrev_b32 v13, 6, v13
    v_bfe_u32 v14, v0, 2, 1
    v_lshl_add_u32 v13, v14, 5, v13
    v_bfe_u32 v14, v0, 3, 1
    v_lshl_add_u32 v13, v14, 4, v13
    v_and_b32 v14, 3, v0
    v_lshl_add_u32 v13, v14, 2, v13
    v_lshlrev_b32 v9, 6, v4
    v_and_b32 v22, 1, v3
    v_lshl_add_u32 v9, v22, 4, v9
    v_mov_b32 v14, 0x05040100
    v_mov_b32 v23, 0x03020706
    v_cmp_eq_u32 vcc, 1, v22
    s_nop 1
    v_cndmask_b32 v14, v14, v23, vcc
    v_bfe_u32 v22, v3, 2, 1
    v_lshl_add_u32 v9, v22, 8, v9
    v_bfe_u32 v22, v3, 1, 1
    v_lshl_add_u32 v9, v22, 2, v9
    s_mul_i32 s8, s81, 2040
    s_sub_u32 s8, 4096, s8
    v_add_u32 v9, s8, v9
    v_lshrrev_b32 v22, 3, v3
    v_lshlrev_b32 v22, 30, v22
    v_add_u32 v9, v22, v9
    s_setreg_imm32_b32 hwreg(HW_REG_MODE, 23, 1), 1
    v_add_u32 v10, 4096, v1
    v_add_u32 v13, 2048, v8
    s_cmp_lg_u32 s6, 0
    s_cbranch_scc1 sw_107
    v_min_u32 v23, 7, v0
    v_lshlrev_b32 v23, 7, v23
    s_mov_b32 s98, 95072768
    s_mov_b32 s99, 0
ws_108:
    buffer_load_dword v22, v23, s[44:47], s98 offen sc1
    s_add_u32 s99, s99, 1
    s_cmp_ge_u32 s99, 400000
    s_cbranch_scc1 mega_abort
    s_waitcnt vmcnt(0)
    v_cmp_gt_u32 vcc, 32, v22
    s_cbranch_vccz wt_109
    s_sleep 4
    s_branch ws_108
wt_109:
sw_107:
    s_barrier
    v_add_u32 v12, 47104, v1
    s_mov_b32 s15, 65536
    v_mov_b32 v3, -1
    v_mov_b32 v104, 0
    v_mov_b32 v105, 0
    v_mov_b32 v106, 0
    v_mov_b32 v107, 0
    v_mov_b32 v108, 0
    v_mov_b32 v109, 0
    v_mov_b32 v110, 0
    v_mov_b32 v111, 0
    v_mov_b32 v117, 0
    v_mov_b32 v119, 0
    v_lshlrev_b32 v4, 2, v0
    s_mul_i32 s72, s81, 7168
    s_add_u32 s72, s72, 1835008
    s_sub_u32 s8, s82, 28
    s_mul_i32 s71, s8, 114688
    s_add_u32 s71, s71, 16519168
    s_mov_b32 s75, 95014912
    s_mov_b32 s73, 95072640
    s_mov_b32 s64, 0
    s_add_u32 s16, s72, 14336
    s_add_u32 s20, s15, 8192
    s_add_u32 s17, s72, 18432
    s_add_u32 s21, s15, 12288
    s_add_u32 s72, s72, 28672
    s_xor_b32 s15, s15, 0x4000
    s_mov_b32 m0, s20
    s_nop 0
    buffer_load_dwordx4 v1, s[44:47], s16 offen offset:2048 sc1 lds
    buffer_load_dwordx4 v1, s[44:47], s16 offen offset:3072 sc1 lds
    s_mov_b32 m0, s21
    s_nop 0
    buffer_load_dwordx4 v1, s[44:47], s17 offen offset:0 sc1 lds
    buffer_load_dwordx4 v1, s[44:47], s17 offen offset:1024 sc1 lds
    buffer_load_dwordx4 v1, s[44:47], s17 offen offset:2048 sc1 lds
    s_mov_b32 s100, 0
    s_mov_b32 s101, -1
    v_mov_b32 v2, 0
    s_mov_b32 s9, 95072512
    s_mov_b32 s83, 0
rdv_110:
    buffer_load_dword v2, off, s[44:47], s9 sc1
    s_add_u32 s83, s83, 1
    s_cmp_ge_u32 s83, 2000000
    s_cbranch_scc1 chain_abort
    s_waitcnt vmcnt(0) lgkmcnt(0)
    v_readfirstlane_b32 s8, v2
    s_and_b32 s10, s8, 0xffff
    s_cmp_lt_u32 s10, 32
    s_cbranch_scc1 rdv_110
    s_mov_b32 s95, s8
    s_cmp_lg_u32 s6, 0
    s_cbranch_scc1 sw_111
    v_min_u32 v23, 6, v0
    v_lshlrev_b32 v23, 7, v23
    s_mov_b32 s98, 95073792
    s_mov_b32 s99, 0
ws_112:
    buffer_load_dword v22, v23, s[44:47], s98 offen sc1
    s_add_u32 s99, s99, 1
    s_cmp_ge_u32 s99, 400000
    s_cbranch_scc1 mega_abort
    s_waitcnt vmcnt(0)
    v_cmp_gt_u32 vcc, 32, v22
    s_cbranch_vccz wt_113
    s_sleep 4
    s_branch ws_112
wt_113:
sw_111:
    s_barrier
    s_mul_i32 s10, s80, 28
    s_mul_i32 s9, s81, 14
    s_add_u32 s10, s10, s9
    s_mul_i32 s10, s10, 14336
    s_add_u32 s8, s10, 3713024
    buffer_load_dwordx4 a[0:3], v1, s[44:47], s8 offen offset:0 sc1
    buffer_load_dwordx4 a[4:7], v1, s[44:47], s8 offen offset:1024 sc1
    buffer_load_dwordx4 a[8:11], v1, s[44:47], s8 offen offset:2048 sc1
    buffer_load_dwordx4 a[12:15], v1, s[44:47], s8 offen offset:3072 sc1
    s_add_u32 s8, s8, 4096
    buffer_load_dwordx4 a[16:19], v1, s[44:47], s8 offen offset:0 sc1
    buffer_load_dwordx4 a[20:23], v1, s[44:47], s8 offen offset:1024 sc1
    buffer_load_dwordx4 a[24:27], v1, s[44:47], s8 offen offset:2048 sc1
    buffer_load_dwordx4 a[28:31], v1, s[44:47], s8 offen offset:3072 sc1
    s_add_u32 s8, s8, 4096
    buffer_load_dwordx4 a[32:35], v1, s[44:47], s8 offen offset:0 sc1
    buffer_load_dwordx4 a[36:39], v1, s[44:47], s8 offen offset:1024 sc1
    buffer_load_dwordx4 a[40:43], v1, s[44:47], s8 offen offset:2048 sc1
    buffer_load_dwordx4 a[44:47], v1, s[44:47], s8 offen offset:3072 sc1
    s_add_u32 s8, s8, 4096
    buffer_load_dwordx4 a[48:51], v1, s[44:47], s8 offen offset:0 sc1
    buffer_load_dwordx4 a[52:55], v1, s[44:47], s8 offen offset:1024 sc1
    s_add_u32 s8, s10, 3727360
    buffer_load_dwordx4 a[56:59], v1, s[44:47], s8 offen offset:0 sc1
    buffer_load_dwordx4 a[60:63], v1, s[44:47], s8 offen offset:1024 sc1
    buffer_load_dwordx4 a[64:67], v1, s[44:47], s8 offen offset:2048 sc1
    buffer_load_dwordx4 a[68:71], v1, s[44:47], s8 offen offset:3072 sc1
    s_add_u32 s8, s8, 4096
    buffer_load_dwordx4 a[72:75], v1, s[44:47], s8 offen offset:0 sc1
    buffer_load_dwordx4 a[76:79], v1, s[44:47], s8 offen offset:1024 sc1
    buffer_load_dwordx4 a[80:83], v1, s[44:47], s8 offen offset:2048 sc1
    buffer_load_dwordx4 a[84:87], v1, s[44:47], s8 offen offset:3072 sc1
    s_add_u32 s8, s8, 4096
    buffer_load_dwordx4 a[88:91], v1, s[44:47], s8 offen offset:0 sc1
    buffer_load_dwordx4 a[92:95], v1, s[44:47], s8 offen offset:1024 sc1
    buffer_load_dwordx4 a[96:99], v1, s[44:47], s8 offen offset:2048 sc1
    buffer_load_dwordx4 a[100:103], v1, s[44:47], s8 offen offset:3072 sc1
    s_add_u32 s8, s8, 4096
    buffer_load_dwordx4 a[104:107], v1, s[44:47], s8 offen offset:0 sc1
    buffer_load_dwordx4 a[108:111], v1, s[44:47], s8 offen offset:1024 sc1
    s_add_u32 s8, s10, 3741696
    buffer_load_dwordx4 a[112:115], v1, s[44:47], s8 offen offset:0 sc1
    buffer_load_dwordx4 a[116:119], v1, s[44:47], s8 offen offset:1024 sc1
    buffer_load_dwordx4 a[120:123], v1, s[44:47], s8 offen offset:2048 sc1
    buffer_load_dwordx4 a[124:127], v1, s[44:47], s8 offen offset:3072 sc1
    s_add_u32 s8, s8, 4096
    buffer_load_dwordx4 a[128:131], v1, s[44:47], s8 offen offset:0 sc1
    buffer_load_dwordx4 a[132:135], v1, s[44:47], s8 offen offset:1024 sc1
    buffer_load_dwordx4 a[136:139], v1, s[44:47], s8 offen offset:2048 sc1
    buffer_load_dwordx4 a[140:143], v1, s[44:47], s8 offen offset:3072 sc1
    s_add_u32 s8, s8, 4096
    buffer_load_dwordx4 a[144:147], v1, s[44:47], s8 offen offset:0 sc1
    buffer_load_dwordx4 a[148:151], v1, s[44:47], s8 offen offset:1024 sc1
    buffer_load_dwordx4 a[152:155], v1, s[44:47], s8 offen offset:2048 sc1
    buffer_load_dwordx4 a[156:159], v1, s[44:47], s8 offen offset:3072 sc1
    s_add_u32 s8, s8, 4096
    buffer_load_dwordx4 a[160:163], v1, s[44:47], s8 offen offset:0 sc1
    buffer_load_dwordx4 a[164:167], v1, s[44:47], s8 offen offset:1024 sc1
    s_add_u32 s8, s10, 3856384
    buffer_load_dwordx4 a[168:171], v1, s[44:47], s8 offen offset:0 sc1
    buffer_load_dwordx4 a[172:175], v1, s[44:47], s8 offen offset:1024 sc1
    buffer_load_dwordx4 a[176:179], v1, s[44:47], s8 offen offset:2048 sc1
    buffer_load_dwordx4 a[180:183], v1, s[44:47], s8 offen offset:3072 sc1
    s_add_u32 s8, s8, 4096
    buffer_load_dwordx4 a[184:187], v1, s[44:47], s8 offen offset:0 sc1
    buffer_load_dwordx4 a[188:191], v1, s[44:47], s8 offen offset:1024 sc1
    buffer_load_dwordx4 a[192:195], v1, s[44:47], s8 offen offset:2048 sc1
    buffer_load_dwordx4 a[196:199], v1, s[44:47], s8 offen offset:3072 sc1
    s_add_u32 s8, s8, 4096
    buffer_load_dwordx4 a[200:203], v1, s[44:47], s8 offen offset:0 sc1
    buffer_load_dwordx4 a[204:207], v1, s[44:47], s8 offen offset:1024 sc1
    buffer_load_dwordx4 a[208:211], v1, s[44:47], s8 offen offset:2048 sc1
    buffer_load_dwordx4 a[212:215], v1, s[44:47], s8 offen offset:3072 sc1
    s_add_u32 s8, s8, 4096
    buffer_load_dwordx4 a[216:219], v1, s[44:47], s8 offen offset:0 sc1
    buffer_load_dwordx4 a[220:223], v1, s[44:47], s8 offen offset:1024 sc1
    s_waitcnt vmcnt(30)
    s_mov_b32 s8, 94898176
    buffer_load_dwordx4 v[76:79], v1, s[44:47], s8 offen offset:0 sc1
    buffer_load_dwordx4 v[76:79], v1, s[44:47], s8 offen offset:1024 sc1
    s_mov_b32 s8, 94934016
    buffer_load_dwordx4 v[76:79], v1, s[44:47], s8 offen offset:0 sc1
    buffer_load_dwordx4 v[76:79], v1, s[44:47], s8 offen offset:1024 sc1
    buffer_load_dwordx4 v[76:79], v1, s[44:47], s8 offen offset:2048 sc1
    buffer_load_dwordx4 v[76:79], v1, s[44:47], s8 offen offset:3072 sc1
    buffer_load_dwordx4 v[76:79], v10, s[44:47], s8 offen offset:0 sc1
    s_mov_b32 s8, 94906368
    buffer_load_dwordx4 v[76:79], v1, s[44:47], s8 offen offset:0 sc1
    buffer_load_dwordx4 v[76:79], v1, s[44:47], s8 offen offset:1024 sc1
    s_mov_b32 s8, 94954752
    buffer_load_dwordx4 v[76:79], v1, s[44:47], s8 offen offset:0 sc1
    buffer_load_dwordx4 v[76:79], v1, s[44:47], s8 offen offset:1024 sc1
    buffer_load_dwordx4 v[76:79], v1, s[44:47], s8 offen offset:2048 sc1
    buffer_load_dwordx4 v[76:79], v1, s[44:47], s8 offen offset:3072 sc1
    buffer_load_dwordx4 v[76:79], v10, s[44:47], s8 offen offset:0 sc1
    s_mov_b32 s8, 94914560
    buffer_load_dwordx4 v[76:79], v1, s[44:47], s8 offen offset:0 sc1
    buffer_load_dwordx4 v[76:79], v1, s[44:47], s8 offen offset:1024 sc1
    s_mov_b32 s8, 94975488
    buffer_load_dwordx4 v[76:79], v1, s[44:47], s8 offen offset:0 sc1
    buffer_load_dwordx4 v[76:79], v1, s[44:47], s8 offen offset:1024 sc1
    buffer_load_dwordx4 v[76:79], v1, s[44:47], s8 offen offset:2048 sc1
    buffer_load_dwordx4 v[76:79], v1, s[44:47], s8 offen offset:3072 sc1
    buffer_load_dwordx4 v[76:79], v10, s[44:47], s8 offen offset:0 sc1
    s_mov_b32 s8, 94922752
    buffer_load_dwordx4 v[76:79], v1, s[44:47], s8 offen offset:0 sc1
    buffer_load_dwordx4 v[76:79], v1, s[44:47], s8 offen offset:1024 sc1
    s_mov_b32 s8, 94996224
    buffer_load_dwordx4 v[76:79], v1, s[44:47], s8 offen offset:0 sc1
    buffer_load_dwordx4 v[76:79], v1, s[44:47], s8 offen offset:1024 sc1
    buffer_load_dwordx4 v[76:79], v1, s[44:47], s8 offen offset:2048 sc1
    buffer_load_dwordx4 v[76:79], v1, s[44:47], s8 offen offset:3072 sc1
    buffer_load_dwordx4 v[76:79], v10, s[44:47], s8 offen offset:0 sc1
    s_waitcnt vmcnt(0)
    s_barrier
    s_cmp_gt_u32 s95, 0xffff
    s_cbranch_scc1 ch1as
    s_branch ch1af
chw2:
    s_cmp_lg_u32 s6, 2
    s_cbranch_scc1 chw3
    s_cmp_ge_u32 s7, 28
    s_cbranch_scc1 chw2a
    s_lshr_b32 s8, s80, 2
    s_mul_i32 s12, s8, 5120
    s_bfe_u32 s8, s80, 0x10001
    s_lshl_b32 s8, s8, 9
    s_add_u32 s12, s12, s8
    s_and_b32 s8, s80, 1
    s_lshl_b32 s8, s8, 5
    s_add_u32 s12, s12, s8
    s_lshl_b32 s8, s81, 11
    s_add_u32 s12, s12, s8
    s_add_u32 s12, s12, 94928896
    s_mul_i32 s13, s7, 640
    s_add_u32 s13, s13, 94929408
    s_lshl_b32 s14, s82, 8
    s_add_u32 s14, s14, 94896128
    s_waitcnt vmcnt(0)
    s_cmp_lg_u32 s6, 0
    s_cbranch_scc1 sw_114
    v_min_u32 v23, 6, v0
    v_lshlrev_b32 v23, 7, v23
    s_mov_b32 s98, 95072768
    s_mov_b32 s99, 0
ws_115:
    buffer_load_dword v22, v23, s[44:47], s98 offen sc1
    s_add_u32 s99, s99, 1
    s_cmp_ge_u32 s99, 400000
    s_cbranch_scc1 mega_abort
    s_waitcnt vmcnt(0)
    v_cmp_gt_u32 vcc, 32, v22
    s_cbranch_vccz wt_116
    s_sleep 4
    s_branch ws_115
wt_116:
sw_114:
    s_barrier
    s_cmp_lg_u32 s6, 0
    s_cbranch_scc1 rv_117
    s_cmp_eq_u32 s5, 0
    s_cselect_b32 s8, 1, 0x10001
    s_mov_b32 s9, 95072512
    s_mov_b64 exec, 1
    v_mov_b32 v22, s8
    buffer_atomic_add v22, off, s[44:47], s9 sc1
    s_mov_b64 exec, -1
rv_117:
    s_lshl_b32 s95, s82, 4
    s_add_u32 s95, s95, 8
    s_mul_i32 s95, s95, 14336
    s_add_u32 s95, s95, 10092544
    s_waitcnt vmcnt(40)
    s_add_u32 s8, s95, 0
    buffer_load_dwordx4 a[224:227], v1, s[44:47], s8 offen offset:0 sc1
    s_add_u32 s8, s95, 0
    buffer_load_dwordx4 a[228:231], v1, s[44:47], s8 offen offset:1024 sc1
    s_add_u32 s8, s95, 0
    buffer_load_dwordx4 a[232:235], v1, s[44:47], s8 offen offset:2048 sc1
    s_add_u32 s8, s95, 0
    buffer_load_dwordx4 a[236:239], v1, s[44:47], s8 offen offset:3072 sc1
    s_add_u32 s8, s95, 4096
    buffer_load_dwordx4 a[240:243], v1, s[44:47], s8 offen offset:0 sc1
    s_add_u32 s8, s95, 4096
    buffer_load_dwordx4 a[244:247], v1, s[44:47], s8 offen offset:1024 sc1
    s_add_u32 s8, s95, 4096
    buffer_load_dwordx4 a[248:251], v1, s[44:47], s8 offen offset:2048 sc1
    s_add_u32 s8, s95, 4096
    buffer_load_dwordx4 a[252:255], v1, s[44:47], s8 offen offset:3072 sc1
    s_add_u32 s8, s95, 8192
    buffer_load_dwordx4 v[120:123], v1, s[44:47], s8 offen offset:0 sc1
    s_add_u32 s8, s95, 8192
    buffer_load_dwordx4 v[124:127], v1, s[44:47], s8 offen offset:1024 sc1
    s_add_u32 s8, s95, 8192
    buffer_load_dwordx4 v[128:131], v1, s[44:47], s8 offen offset:2048 sc1
    s_add_u32 s8, s95, 8192
    buffer_load_dwordx4 v[132:135], v1, s[44:47], s8 offen offset:3072 sc1
    s_add_u32 s8, s95, 12288
    buffer_load_dwordx4 v[136:139], v1, s[44:47], s8 offen offset:0 sc1
    s_add_u32 s8, s95, 12288
    buffer_load_dwordx4 v[140:143], v1, s[44:47], s8 offen offset:1024 sc1
    s_waitcnt vmcnt(40)
    s_add_u32 s8, s95, 12288
    buffer_load_dwordx4 v[144:147], v1, s[44:47], s8 offen offset:2048 sc1
    s_add_u32 s8, s95, 12288
    buffer_load_dwordx4 v[148:151], v1, s[44:47], s8 offen offset:3072 sc1
    s_add_u32 s8, s95, 16384
    buffer_load_dwordx4 v[152:155], v1, s[44:47], s8 offen offset:0 sc1
    s_add_u32 s8, s95, 16384
    buffer_load_dwordx4 v[156:159], v1, s[44:47], s8 offen offset:1024 sc1
    s_add_u32 s8, s95, 16384
    buffer_load_dwordx4 v[160:163], v1, s[44:47], s8 offen offset:2048 sc1
    s_add_u32 s8, s95, 16384
    buffer_load_dwordx4 v[164:167], v1, s[44:47], s8 offen offset:3072 sc1
    s_add_u32 s8, s95, 20480
    buffer_load_dwordx4 v[168:171], v1, s[44:47], s8 offen offset:0 sc1
    s_add_u32 s8, s95, 20480
    buffer_load_dwordx4 v[172:175], v1, s[44:47], s8 offen offset:1024 sc1
    s_add_u32 s8, s95, 20480
    buffer_load_dwordx4 v[176:179], v1, s[44:47], s8 offen offset:2048 sc1
    s_add_u32 s8, s95, 20480
    buffer_load_dwordx4 v[180:183], v1, s[44:47], s8 offen offset:3072 sc1
    s_add_u32 s8, s95, 24576
    buffer_load_dwordx4 v[184:187], v1, s[44:47], s8 offen offset:0 sc1
    s_add_u32 s8, s95, 24576
    buffer_load_dwordx4 v[188:191], v1, s[44:47], s8 offen offset:1024 sc1
    s_add_u32 s8, s95, 24576
    buffer_load_dwordx4 v[192:195], v1, s[44:47], s8 offen offset:2048 sc1
    s_add_u32 s8, s95, 24576
    buffer_load_dwordx4 v[196:199], v1, s[44:47], s8 offen offset:3072 sc1
    s_waitcnt vmcnt(40)
    s_add_u32 s8, s95, 28672
    buffer_load_dwordx4 v[200:203], v1, s[44:47], s8 offen offset:0 sc1
    s_add_u32 s8, s95, 28672
    buffer_load_dwordx4 v[204:207], v1, s[44:47], s8 offen offset:1024 sc1
    s_add_u32 s8, s95, 28672
    buffer_load_dwordx4 v[208:211], v1, s[44:47], s8 offen offset:2048 sc1
    s_add_u32 s8, s95, 28672
    buffer_load_dwordx4 v[212:215], v1, s[44:47], s8 offen offset:3072 sc1
    s_add_u32 s8, s95, 32768
    buffer_load_dwordx4 v[216:219], v1, s[44:47], s8 offen offset:0 sc1
    s_add_u32 s8, s95, 32768
    buffer_load_dwordx4 v[220:223], v1, s[44:47], s8 offen offset:1024 sc1
    s_add_u32 s8, s95, 32768
    buffer_load_dwordx4 v[224:227], v1, s[44:47], s8 offen offset:2048 sc1
    s_add_u32 s8, s95, 32768
    buffer_load_dwordx4 v[228:231], v1, s[44:47], s8 offen offset:3072 sc1
    s_add_u32 s8, s95, 36864
    buffer_load_dwordx4 v[232:235], v1, s[44:47], s8 offen offset:0 sc1
    s_add_u32 s8, s95, 36864
    buffer_load_dwordx4 v[236:239], v1, s[44:47], s8 offen offset:1024 sc1
    s_add_u32 s8, s95, 36864
    buffer_load_dwordx4 v[240:243], v1, s[44:47], s8 offen offset:2048 sc1
    s_add_u32 s8, s95, 36864
    buffer_load_dwordx4 v[244:247], v1, s[44:47], s8 offen offset:3072 sc1
    s_add_u32 s8, s95, 40960
    buffer_load_dwordx4 v[248:251], v1, s[44:47], s8 offen offset:0 sc1
    s_add_u32 s8, s95, 40960
    buffer_load_dwordx4 v[252:255], v1, s[44:47], s8 offen offset:1024 sc1
    s_waitcnt vmcnt(40)
    s_add_u32 s8, s95, 40960
    buffer_load_dwordx4 a[168:171], v1, s[44:47], s8 offen offset:2048 sc1
    s_add_u32 s8, s95, 40960
    buffer_load_dwordx4 a[172:175], v1, s[44:47], s8 offen offset:3072 sc1
    s_add_u32 s8, s95, 45056
    buffer_load_dwordx4 a[176:179], v1, s[44:47], s8 offen offset:0 sc1
    s_add_u32 s8, s95, 45056
    buffer_load_dwordx4 a[180:183], v1, s[44:47], s8 offen offset:1024 sc1
    s_add_u32 s8, s95, 45056
    buffer_load_dwordx4 a[184:187], v1, s[44:47], s8 offen offset:2048 sc1
    s_add_u32 s8, s95, 45056
    buffer_load_dwordx4 a[188:191], v1, s[44:47], s8 offen offset:3072 sc1
    s_add_u32 s8, s95, 49152
    buffer_load_dwordx4 a[192:195], v1, s[44:47], s8 offen offset:0 sc1
    s_add_u32 s8, s95, 49152
    buffer_load_dwordx4 a[196:199], v1, s[44:47], s8 offen offset:1024 sc1
    s_add_u32 s8, s95, 49152
    buffer_load_dwordx4 a[200:203], v1, s[44:47], s8 offen offset:2048 sc1
    s_add_u32 s8, s95, 49152
    buffer_load_dwordx4 a[204:207], v1, s[44:47], s8 offen offset:3072 sc1
    s_add_u32 s8, s95, 53248
    buffer_load_dwordx4 a[208:211], v1, s[44:47], s8 offen offset:0 sc1
    s_add_u32 s8, s95, 53248
    buffer_load_dwordx4 a[212:215], v1, s[44:47], s8 offen offset:1024 sc1
    s_add_u32 s8, s95, 53248
    buffer_load_dwordx4 a[216:219], v1, s[44:47], s8 offen offset:2048 sc1
    s_add_u32 s8, s95, 53248
    buffer_load_dwordx4 a[220:223], v1, s[44:47], s8 offen offset:3072 sc1
    v_mov_b32 v16, 0
    v_mov_b32 v17, 0
    v_lshlrev_b32 v18, 3, v0
    ds_write_b64 v18, v[16:17] offset:11776
    v_lshrrev_b32 v4, 4, v0
    v_bfe_u32 v5, v3, 1, 1
    v_mul_u32_u24 v5, 0xaaaa, v5
    v_add_u32 v5, 0x4444, v5
    v_bfe_u32 v6, v3, 2, 1
    v_lshlrev_b32 v6, 7, v6
    v_lshrrev_b32 v7, 3, v3
    v_lshl_add_u32 v6, v7, 6, v6
    v_and_b32 v7, 1, v3
    v_lshl_add_u32 v6, v7, 5, v6
    v_lshl_add_u32 v6, v4, 3, v6
    v_bfe_u32 v7, v3, 1, 1
    v_lshl_add_u32 v6, v7, 2, v6
    v_add_u32 v6, 8192, v6
    v_lshrrev_b32 v7, 2, v3
    v_lshlrev_b32 v7, 5, v7
    v_lshl_add_u32 v7, v4, 8, v7
    v_and_b32 v8, 3, v3
    v_lshl_add_u32 v7, v8, 3, v7
    v_add_u32 v7, 8192, v7
    v_bfe_u32 v8, v3, 1, 2
    v_lshlrev_b32 v8, 6, v8
    v_and_b32 v9, 1, v3
    v_lshl_add_u32 v8, v9, 4, v8
    v_lshrrev_b32 v9, 1, v4
    v_lshl_add_u32 v8, v9, 8, v8
    v_and_b32 v9, 1, v4
    v_lshl_add_u32 v8, v9, 3, v8
    s_mul_i32 s8, s81, 3584
    v_add_u32 v8, s8, v8
    v_lshlrev_b32 v11, 7, v4
    v_lshl_add_u32 v11, v3, 2, v11
    s_lshl_b32 s8, s6, 9
    s_add_u32 s8, s8, 12288
    v_add_u32 v11, s8, v11
    v_lshlrev_b32 v12, 3, v0
    v_add_u32 v12, 12288, v12
    v_lshrrev_b32 v13, 4, v0
    v_lshlrev_b32 v13, 6, v13
    v_bfe_u32 v14, v0, 2, 1
    v_lshl_add_u32 v13, v14, 5, v13
    v_bfe_u32 v14, v0, 3, 1
    v_lshl_add_u32 v13, v14, 4, v13
    v_and_b32 v14, 3, v0
    v_lshl_add_u32 v13, v14, 2, v13
    v_lshlrev_b32 v9, 6, v4
    v_and_b32 v22, 1, v3
    v_lshl_add_u32 v9, v22, 4, v9
    v_mov_b32 v14, 0x05040100
    v_mov_b32 v23, 0x03020706
    v_cmp_eq_u32 vcc, 1, v22
    s_nop 1
    v_cndmask_b32 v14, v14, v23, vcc
    v_lshrrev_b32 v22, 3, v3
    v_lshl_add_u32 v9, v22, 8, v9
    v_bfe_u32 v22, v3, 1, 2
    v_lshl_add_u32 v9, v22, 2, v9
    v_add_u32 v9, 0, v9
    s_setreg_imm32_b32 hwreg(HW_REG_MODE, 23, 1), 1
    v_add_u32 v10, 4096, v1
    s_cmp_lg_u32 s6, 0
    s_cbranch_scc1 sw_118
    v_min_u32 v23, 7, v0
    v_lshlrev_b32 v23, 7, v23
    s_mov_b32 s98, 95072768
    s_mov_b32 s99, 0
ws_119:
    buffer_load_dword v22, v23, s[44:47], s98 offen sc1
    s_add_u32 s99, s99, 1
    s_cmp_ge_u32 s99, 400000
    s_cbranch_scc1 mega_abort
    s_waitcnt vmcnt(0)
    v_cmp_gt_u32 vcc, 32, v22
    s_cbranch_vccz wt_120
    s_sleep 4
    s_branch ws_119
wt_120:
sw_118:
    s_barrier
    v_add_u32 v12, 65536, v1
    s_mov_b32 s15, 65536
    v_mov_b32 v3, -1
    v_mov_b32 v104, 0
    v_mov_b32 v105, 0
    v_mov_b32 v106, 0
    v_mov_b32 v107, 0
    v_mov_b32 v108, 0
    v_mov_b32 v109, 0
    v_mov_b32 v110, 0
    v_mov_b32 v111, 0
    v_mov_b32 v117, 0
    v_mov_b32 v119, 0
    v_lshlrev_b32 v4, 2, v0
    s_mul_i32 s72, s81, 7168
    s_add_u32 s72, s72, 1835008
    s_lshl_b32 s71, s82, 14
    s_add_u32 s71, s71, 16523264
    s_mov_b32 s75, 95014912
    s_mov_b32 s73, 95072640
    s_mov_b32 s64, 0
    s_mov_b32 s100, 0
    s_mov_b32 s101, -1
    v_mov_b32 v2, 0
    s_mov_b32 s9, 95072512
    s_mov_b32 s83, 0
rdv_121:
    buffer_load_dword v2, off, s[44:47], s9 sc1
    s_add_u32 s83, s83, 1
    s_cmp_ge_u32 s83, 2000000
    s_cbranch_scc1 chain_abort
    s_waitcnt vmcnt(0) lgkmcnt(0)
    v_readfirstlane_b32 s8, v2
    s_and_b32 s10, s8, 0xffff
    s_cmp_lt_u32 s10, 32
    s_cbranch_scc1 rdv_121
    s_mov_b32 s95, s8
    s_cmp_lg_u32 s6, 0
    s_cbranch_scc1 sw_122
    v_min_u32 v23, 6, v0
    v_lshlrev_b32 v23, 7, v23
    s_mov_b32 s98, 95073792
    s_mov_b32 s99, 0
ws_123:
    buffer_load_dword v22, v23, s[44:47], s98 offen sc1
    s_add_u32 s99, s99, 1
    s_cmp_ge_u32 s99, 400000
    s_cbranch_scc1 mega_abort
    s_waitcnt vmcnt(0)
    v_cmp_gt_u32 vcc, 32, v22
    s_cbranch_vccz wt_124
    s_sleep 4
    s_branch ws_123
wt_124:
sw_122:
    s_barrier
    s_mul_i32 s10, s80, 28
    s_mul_i32 s9, s81, 14
    s_add_u32 s10, s10, s9
    s_mul_i32 s10, s10, 14336
    s_add_u32 s8, s10, 3756032
    buffer_load_dwordx4 a[0:3], v1, s[44:47], s8 offen offset:0 sc1
    buffer_load_dwordx4 a[4:7], v1, s[44:47], s8 offen offset:1024 sc1
    buffer_load_dwordx4 a[8:11], v1, s[44:47], s8 offen offset:2048 sc1
    buffer_load_dwordx4 a[12:15], v1, s[44:47], s8 offen offset:3072 sc1
    s_add_u32 s8, s8, 4096
    buffer_load_dwordx4 a[16:19], v1, s[44:47], s8 offen offset:0 sc1
    buffer_load_dwordx4 a[20:23], v1, s[44:47], s8 offen offset:1024 sc1
    buffer_load_dwordx4 a[24:27], v1, s[44:47], s8 offen offset:2048 sc1
    buffer_load_dwordx4 a[28:31], v1, s[44:47], s8 offen offset:3072 sc1
    s_add_u32 s8, s8, 4096
    buffer_load_dwordx4 a[32:35], v1, s[44:47], s8 offen offset:0 sc1
    buffer_load_dwordx4 a[36:39], v1, s[44:47], s8 offen offset:1024 sc1
    buffer_load_dwordx4 a[40:43], v1, s[44:47], s8 offen offset:2048 sc1
    buffer_load_dwordx4 a[44:47], v1, s[44:47], s8 offen offset:3072 sc1
    s_add_u32 s8, s8, 4096
    buffer_load_dwordx4 a[48:51], v1, s[44:47], s8 offen offset:0 sc1
    buffer_load_dwordx4 a[52:55], v1, s[44:47], s8 offen offset:1024 sc1
    s_add_u32 s8, s10, 3770368
    buffer_load_dwordx4 a[56:59], v1, s[44:47], s8 offen offset:0 sc1
    buffer_load_dwordx4 a[60:63], v1, s[44:47], s8 offen offset:1024 sc1
    buffer_load_dwordx4 a[64:67], v1, s[44:47], s8 offen offset:2048 sc1
    buffer_load_dwordx4 a[68:71], v1, s[44:47], s8 offen offset:3072 sc1
    s_add_u32 s8, s8, 4096
    buffer_load_dwordx4 a[72:75], v1, s[44:47], s8 offen offset:0 sc1
    buffer_load_dwordx4 a[76:79], v1, s[44:47], s8 offen offset:1024 sc1
    buffer_load_dwordx4 a[80:83], v1, s[44:47], s8 offen offset:2048 sc1
    buffer_load_dwordx4 a[84:87], v1, s[44:47], s8 offen offset:3072 sc1
    s_add_u32 s8, s8, 4096
    buffer_load_dwordx4 a[88:91], v1, s[44:47], s8 offen offset:0 sc1
    buffer_load_dwordx4 a[92:95], v1, s[44:47], s8 offen offset:1024 sc1
    buffer_load_dwordx4 a[96:99], v1, s[44:47], s8 offen offset:2048 sc1
    buffer_load_dwordx4 a[100:103], v1, s[44:47], s8 offen offset:3072 sc1
    s_add_u32 s8, s8, 4096
    buffer_load_dwordx4 a[104:107], v1, s[44:47], s8 offen offset:0 sc1
    buffer_load_dwordx4 a[108:111], v1, s[44:47], s8 offen offset:1024 sc1
    s_add_u32 s8, s10, 3784704
    buffer_load_dwordx4 a[112:115], v1, s[44:47], s8 offen offset:0 sc1
    buffer_load_dwordx4 a[116:119], v1, s[44:47], s8 offen offset:1024 sc1
    buffer_load_dwordx4 a[120:123], v1, s[44:47], s8 offen offset:2048 sc1
    buffer_load_dwordx4 a[124:127], v1, s[44:47], s8 offen offset:3072 sc1
    s_add_u32 s8, s8, 4096
    buffer_load_dwordx4 a[128:131], v1, s[44:47], s8 offen offset:0 sc1
    buffer_load_dwordx4 a[132:135], v1, s[44:47], s8 offen offset:1024 sc1
    buffer_load_dwordx4 a[136:139], v1, s[44:47], s8 offen offset:2048 sc1
    buffer_load_dwordx4 a[140:143], v1, s[44:47], s8 offen offset:3072 sc1
    s_add_u32 s8, s8, 4096
    buffer_load_dwordx4 a[144:147], v1, s[44:47], s8 offen offset:0 sc1
    buffer_load_dwordx4 a[148:151], v1, s[44:47], s8 offen offset:1024 sc1
    buffer_load_dwordx4 a[152:155], v1, s[44:47], s8 offen offset:2048 sc1
    buffer_load_dwordx4 a[156:159], v1, s[44:47], s8 offen offset:3072 sc1
    s_add_u32 s8, s8, 4096
    buffer_load_dwordx4 a[160:163], v1, s[44:47], s8 offen offset:0 sc1
    buffer_load_dwordx4 a[164:167], v1, s[44:47], s8 offen offset:1024 sc1
    s_waitcnt vmcnt(30)
    s_mov_b32 s8, 94900224
    buffer_load_dwordx4 v[76:79], v1, s[44:47], s8 offen offset:0 sc1
    buffer_load_dwordx4 v[76:79], v1, s[44:47], s8 offen offset:1024 sc1
    s_mov_b32 s8, 94939136
    buffer_load_dwordx4 v[76:79], v1, s[44:47], s8 offen offset:0 sc1
    buffer_load_dwordx4 v[76:79], v1, s[44:47], s8 offen offset:1024 sc1
    buffer_load_dwordx4 v[76:79], v1, s[44:47], s8 offen offset:2048 sc1
    buffer_load_dwordx4 v[76:79], v1, s[44:47], s8 offen offset:3072 sc1
    buffer_load_dwordx4 v[76:79], v10, s[44:47], s8 offen offset:0 sc1
    s_mov_b32 s8, 94908416
    buffer_load_dwordx4 v[76:79], v1, s[44:47], s8 offen offset:0 sc1
    buffer_load_dwordx4 v[76:79], v1, s[44:47], s8 offen offset:1024 sc1
    s_mov_b32 s8, 94959872
    buffer_load_dwordx4 v[76:79], v1, s[44:47], s8 offen offset:0 sc1
    buffer_load_dwordx4 v[76:79], v1, s[44:47], s8 offen offset:1024 sc1
    buffer_load_dwordx4 v[76:79], v1, s[44:47], s8 offen offset:2048 sc1
    buffer_load_dwordx4 v[76:79], v1, s[44:47], s8 offen offset:3072 sc1
    buffer_load_dwordx4 v[76:79], v10, s[44:47], s8 offen offset:0 sc1
    s_mov_b32 s8, 94916608
    buffer_load_dwordx4 v[76:79], v1, s[44:47], s8 offen offset:0 sc1
    buffer_load_dwordx4 v[76:79], v1, s[44:47], s8 offen offset:1024 sc1
    s_mov_b32 s8, 94980608
    buffer_load_dwordx4 v[76:79], v1, s[44:47], s8 offen offset:0 sc1
    buffer_load_dwordx4 v[76:79], v1, s[44:47], s8 offen offset:1024 sc1
    buffer_load_dwordx4 v[76:79], v1, s[44:47], s8 offen offset:2048 sc1
    buffer_load_dwordx4 v[76:79], v1, s[44:47], s8 offen offset:3072 sc1
    buffer_load_dwordx4 v[76:79], v10, s[44:47], s8 offen offset:0 sc1
    s_mov_b32 s8, 94924800
    buffer_load_dwordx4 v[76:79], v1, s[44:47], s8 offen offset:0 sc1
    buffer_load_dwordx4 v[76:79], v1, s[44:47], s8 offen offset:1024 sc1
    s_mov_b32 s8, 95001344
    buffer_load_dwordx4 v[76:79], v1, s[44:47], s8 offen offset:0 sc1
    buffer_load_dwordx4 v[76:79], v1, s[44:47], s8 offen offset:1024 sc1
    buffer_load_dwordx4 v[76:79], v1, s[44:47], s8 offen offset:2048 sc1
    buffer_load_dwordx4 v[76:79], v1, s[44:47], s8 offen offset:3072 sc1
    buffer_load_dwordx4 v[76:79], v10, s[44:47], s8 offen offset:0 sc1
    v_lshlrev_b32 v113, 7, v0
    s_mov_b32 s99, 0
hz_125:
    buffer_load_dword v115, v113, s[44:47], s75 offen sc1
    s_waitcnt vmcnt(0)
    v_cmp_gt_u32 vcc, 28, v115
    s_ff1_i32_b64 s100, vcc
    s_cmp_eq_u32 s100, -1
    s_cselect_b32 s100, 65, s100
    s_sub_u32 s100, s100, 1
    s_cmp_ge_i32 s100, s64
    s_cbranch_scc1 hd_126
    s_sleep 1
    s_add_u32 s99, s99, 1
    s_cmp_lt_u32 s99, 400000
    s_cbranch_scc1 hz_125
    s_branch chain_abort
hd_126:
    s_mov_b32 m0, 24576
    s_nop 0
    buffer_load_dwordx4 v1, s[44:47], s71 offen offset:0 sc1 lds
    buffer_load_dwordx4 v1, s[44:47], s71 offen offset:1024 sc1 lds
    s_barrier
    s_cmp_gt_u32 s95, 0xffff
    s_cbranch_scc1 ch2bs
    s_branch ch2bf
chw2a:
    s_lshr_b32 s8, s80, 2
    s_mul_i32 s12, s8, 5120
    s_bfe_u32 s8, s80, 0x10001
    s_lshl_b32 s8, s8, 9
    s_add_u32 s12, s12, s8
    s_and_b32 s8, s80, 1
    s_lshl_b32 s8, s8, 5
    s_add_u32 s12, s12, s8
    s_lshl_b32 s8, s81, 11
    s_add_u32 s12, s12, s8
    s_add_u32 s12, s12, 94928896
    s_mul_i32 s13, s7, 640
    s_add_u32 s13, s13, 94929408
    s_lshl_b32 s14, s82, 8
    s_add_u32 s14, s14, 94896128
    s_waitcnt vmcnt(0)
    s_cmp_lg_u32 s6, 0
    s_cbranch_scc1 sw_127
    v_min_u32 v23, 6, v0
    v_lshlrev_b32 v23, 7, v23
    s_mov_b32 s98, 95072768
    s_mov_b32 s99, 0
ws_128:
    buffer_load_dword v22, v23, s[44:47], s98 offen sc1
    s_add_u32 s99, s99, 1
    s_cmp_ge_u32 s99, 400000
    s_cbranch_scc1 mega_abort
    s_waitcnt vmcnt(0)
    v_cmp_gt_u32 vcc, 32, v22
    s_cbranch_vccz wt_129
    s_sleep 4
    s_branch ws_128
wt_129:
sw_127:
    s_barrier
    s_cmp_lg_u32 s6, 0
    s_cbranch_scc1 rv_130
    s_cmp_eq_u32 s5, 0
    s_cselect_b32 s8, 1, 0x10001
    s_mov_b32 s9, 95072512
    s_mov_b64 exec, 1
    v_mov_b32 v22, s8
    buffer_atomic_add v22, off, s[44:47], s9 sc1
    s_mov_b64 exec, -1
rv_130:
    s_lshl_b32 s95, s82, 4
    s_add_u32 s95, s95, 8
    s_mul_i32 s95, s95, 14336
    s_add_u32 s95, s95, 10092544
    v_mov_b32 v16, 0
    v_mov_b32 v17, 0
    v_lshlrev_b32 v18, 3, v0
    ds_write_b64 v18, v[16:17] offset:11776
    v_lshrrev_b32 v4, 4, v0
    v_bfe_u32 v5, v3, 1, 1
    v_mul_u32_u24 v5, 0xaaaa, v5
    v_add_u32 v5, 0x4444, v5
    v_bfe_u32 v6, v3, 2, 1
    v_lshlrev_b32 v6, 7, v6
    v_lshrrev_b32 v7, 3, v3
    v_lshl_add_u32 v6, v7, 6, v6
    v_and_b32 v7, 1, v3
    v_lshl_add_u32 v6, v7, 5, v6
    v_lshl_add_u32 v6, v4, 3, v6
    v_bfe_u32 v7, v3, 1, 1
    v_lshl_add_u32 v6, v7, 2, v6
    v_add_u32 v6, 8192, v6
    v_lshrrev_b32 v7, 2, v3
    v_lshlrev_b32 v7, 5, v7
    v_lshl_add_u32 v7, v4, 8, v7
    v_and_b32 v8, 3, v3
    v_lshl_add_u32 v7, v8, 3, v7
    v_add_u32 v7, 8192, v7
    v_bfe_u32 v8, v3, 1, 2
    v_lshlrev_b32 v8, 6, v8
    v_and_b32 v9, 1, v3
    v_lshl_add_u32 v8, v9, 4, v8
    v_lshrrev_b32 v9, 1, v4
    v_lshl_add_u32 v8, v9, 8, v8
    v_and_b32 v9, 1, v4
    v_lshl_add_u32 v8, v9, 3, v8
    s_mul_i32 s8, s81, 3584
    v_add_u32 v8, s8, v8
    v_lshlrev_b32 v11, 7, v4
    v_lshl_add_u32 v11, v3, 2, v11
    s_lshl_b32 s8, s6, 9
    s_add_u32 s8, s8, 12288
    v_add_u32 v11, s8, v11
    v_lshlrev_b32 v12, 3, v0
    v_add_u32 v12, 12288, v12
    v_lshrrev_b32 v13, 4, v0
    v_lshlrev_b32 v13, 6, v13
    v_bfe_u32 v14, v0, 2, 1
    v_lshl_add_u32 v13, v14, 5, v13
    v_bfe_u32 v14, v0, 3, 1
    v_lshl_add_u32 v13, v14, 4, v13
    v_and_b32 v14, 3, v0
    v_lshl_add_u32 v13, v14, 2, v13
    v_lshlrev_b32 v9, 6, v4
    v_and_b32 v22, 1, v3
    v_lshl_add_u32 v9, v22, 4, v9
    v_mov_b32 v14, 0x05040100
    v_mov_b32 v23, 0x03020706
    v_cmp_eq_u32 vcc, 1, v22
    s_nop 1
    v_cndmask_b32 v14, v14, v23, vcc
    v_lshrrev_b32 v22, 3, v3
    v_lshl_add_u32 v9, v22, 8, v9
    v_bfe_u32 v22, v3, 1, 2
    v_lshl_add_u32 v9, v22, 2, v9
    v_add_u32 v9, 0, v9
    s_setreg_imm32_b32 hwreg(HW_REG_MODE, 23, 1), 1
    v_add_u32 v10, 4096, v1
    s_cmp_lg_u32 s6, 0
    s_cbranch_scc1 sw_131
    v_min_u32 v23, 7, v0
    v_lshlrev_b32 v23, 7, v23
    s_mov_b32 s98, 95072768
    s_mov_b32 s99, 0
ws_132:
    buffer_load_dword v22, v23, s[44:47], s98 offen sc1
    s_add_u32 s99, s99, 1
    s_cmp_ge_u32 s99, 400000
    s_cbranch_scc1 mega_abort
    s_waitcnt vmcnt(0)
    v_cmp_gt_u32 vcc, 32, v22
    s_cbranch_vccz wt_133
    s_sleep 4
    s_branch ws_132
wt_133:
sw_131:
    s_barrier
    v_add_u32 v12, 65536, v1
    s_mov_b32 s15, 65536
    v_mov_b32 v3, -1
    v_mov_b32 v104, 0
    v_mov_b32 v105, 0
    v_mov_b32 v106, 0
    v_mov_b32 v107, 0
    v_mov_b32 v108, 0
    v_mov_b32 v109, 0
    v_mov_b32 v110, 0
    v_mov_b32 v111, 0
    v_mov_b32 v117, 0
    v_mov_b32 v119, 0
    v_lshlrev_b32 v4, 2, v0
    s_mul_i32 s72, s81, 7168
    s_add_u32 s72, s72, 1835008
    s_sub_u32 s8, s82, 28
    s_mul_i32 s71, s8, 114688
    s_add_u32 s71, s71, 16523264
    s_mov_b32 s75, 95014912
    s_mov_b32 s73, 95072640
    s_mov_b32 s64, 0
    s_mov_b32 s100, 0
    s_mov_b32 s101, -1
    v_mov_b32 v2, 0
    s_mov_b32 s9, 95072512
    s_mov_b32 s83, 0
rdv_134:
    buffer_load_dword v2, off, s[44:47], s9 sc1
    s_add_u32 s83, s83, 1
    s_cmp_ge_u32 s83, 2000000
    s_cbranch_scc1 chain_abort
    s_waitcnt vmcnt(0) lgkmcnt(0)
    v_readfirstlane_b32 s8, v2
    s_and_b32 s10, s8, 0xffff
    s_cmp_lt_u32 s10, 32
    s_cbranch_scc1 rdv_134
    s_mov_b32 s95, s8
    s_cmp_lg_u32 s6, 0
    s_cbranch_scc1 sw_135
    v_min_u32 v23, 6, v0
    v_lshlrev_b32 v23, 7, v23
    s_mov_b32 s98, 95073792
    s_mov_b32 s99, 0
ws_136:
    buffer_load_dword v22, v23, s[44:47], s98 offen sc1
    s_add_u32 s99, s99, 1
    s_cmp_ge_u32 s99, 400000
    s_cbranch_scc1 mega_abort
    s_waitcnt vmcnt(0)
    v_cmp_gt_u32 vcc, 32, v22
    s_cbranch_vccz wt_137
    s_sleep 4
    s_branch ws_136
wt_137:
sw_135:
    s_barrier
    s_mul_i32 s10, s80, 28
    s_mul_i32 s9, s81, 14
    s_add_u32 s10, s10, s9
    s_mul_i32 s10, s10, 14336
    s_add_u32 s8, s10, 3756032
    buffer_load_dwordx4 a[0:3], v1, s[44:47], s8 offen offset:0 sc1
    buffer_load_dwordx4 a[4:7], v1, s[44:47], s8 offen offset:1024 sc1
    buffer_load_dwordx4 a[8:11], v1, s[44:47], s8 offen offset:2048 sc1
    buffer_load_dwordx4 a[12:15], v1, s[44:47], s8 offen offset:3072 sc1
    s_add_u32 s8, s8, 4096
    buffer_load_dwordx4 a[16:19], v1, s[44:47], s8 offen offset:0 sc1
    buffer_load_dwordx4 a[20:23], v1, s[44:47], s8 offen offset:1024 sc1
    buffer_load_dwordx4 a[24:27], v1, s[44:47], s8 offen offset:2048 sc1
    buffer_load_dwordx4 a[28:31], v1, s[44:47], s8 offen offset:3072 sc1
    s_add_u32 s8, s8, 4096
    buffer_load_dwordx4 a[32:35], v1, s[44:47], s8 offen offset:0 sc1
    buffer_load_dwordx4 a[36:39], v1, s[44:47], s8 offen offset:1024 sc1
    buffer_load_dwordx4 a[40:43], v1, s[44:47], s8 offen offset:2048 sc1
    buffer_load_dwordx4 a[44:47], v1, s[44:47], s8 offen offset:3072 sc1
    s_add_u32 s8, s8, 4096
    buffer_load_dwordx4 a[48:51], v1, s[44:47], s8 offen offset:0 sc1
    buffer_load_dwordx4 a[52:55], v1, s[44:47], s8 offen offset:1024 sc1
    s_add_u32 s8, s10, 3770368
    buffer_load_dwordx4 a[56:59], v1, s[44:47], s8 offen offset:0 sc1
    buffer_load_dwordx4 a[60:63], v1, s[44:47], s8 offen offset:1024 sc1
    buffer_load_dwordx4 a[64:67], v1, s[44:47], s8 offen offset:2048 sc1
    buffer_load_dwordx4 a[68:71], v1, s[44:47], s8 offen offset:3072 sc1
    s_add_u32 s8, s8, 4096
    buffer_load_dwordx4 a[72:75], v1, s[44:47], s8 offen offset:0 sc1
    buffer_load_dwordx4 a[76:79], v1, s[44:47], s8 offen offset:1024 sc1
    buffer_load_dwordx4 a[80:83], v1, s[44:47], s8 offen offset:2048 sc1
    buffer_load_dwordx4 a[84:87], v1, s[44:47], s8 offen offset:3072 sc1
    s_add_u32 s8, s8, 4096
    buffer_load_dwordx4 a[88:91], v1, s[44:47], s8 offen offset:0 sc1
    buffer_load_dwordx4 a[92:95], v1, s[44:47], s8 offen offset:1024 sc1
    buffer_load_dwordx4 a[96:99], v1, s[44:47], s8 offen offset:2048 sc1
    buffer_load_dwordx4 a[100:103], v1, s[44:47], s8 offen offset:3072 sc1
    s_add_u32 s8, s8, 4096
    buffer_load_dwordx4 a[104:107], v1, s[44:47], s8 offen offset:0 sc1
    buffer_load_dwordx4 a[108:111], v1, s[44:47], s8 offen offset:1024 sc1
    s_add_u32 s8, s10, 3784704
    buffer_load_dwordx4 a[112:115], v1, s[44:47], s8 offen offset:0 sc1
    buffer_load_dwordx4 a[116:119], v1, s[44:47], s8 offen offset:1024 sc1
    buffer_load_dwordx4 a[120:123], v1, s[44:47], s8 offen offset:2048 sc1
    buffer_load_dwordx4 a[124:127], v1, s[44:47], s8 offen offset:3072 sc1
    s_add_u32 s8, s8, 4096
    buffer_load_dwordx4 a[128:131], v1, s[44:47], s8 offen offset:0 sc1
    buffer_load_dwordx4 a[132:135], v1, s[44:47], s8 offen offset:1024 sc1
    buffer_load_dwordx4 a[136:139], v1, s[44:47], s8 offen offset:2048 sc1
    buffer_load_dwordx4 a[140:143], v1, s[44:47], s8 offen offset:3072 sc1
    s_add_u32 s8, s8, 4096
    buffer_load_dwordx4 a[144:147], v1, s[44:47], s8 offen offset:0 sc1
    buffer_load_dwordx4 a[148:151], v1, s[44:47], s8 offen offset:1024 sc1
    buffer_load_dwordx4 a[152:155], v1, s[44:47], s8 offen offset:2048 sc1
    buffer_load_dwordx4 a[156:159], v1, s[44:47], s8 offen offset:3072 sc1
    s_add_u32 s8, s8, 4096
    buffer_load_dwordx4 a[160:163], v1, s[44:47], s8 offen offset:0 sc1
    buffer_load_dwordx4 a[164:167], v1, s[44:47], s8 offen offset:1024 sc1
    s_waitcnt vmcnt(30)
    s_mov_b32 s8, 94900224
    buffer_load_dwordx4 v[76:79], v1, s[44:47], s8 offen offset:0 sc1
    buffer_load_dwordx4 v[76:79], v1, s[44:47], s8 offen offset:1024 sc1
    s_mov_b32 s8, 94939136
    buffer_load_dwordx4 v[76:79], v1, s[44:47], s8 offen offset:0 sc1
    buffer_load_dwordx4 v[76:79], v1, s[44:47], s8 offen offset:1024 sc1
    buffer_load_dwordx4 v[76:79], v1, s[44:47], s8 offen offset:2048 sc1
    buffer_load_dwordx4 v[76:79], v1, s[44:47], s8 offen offset:3072 sc1
    buffer_load_dwordx4 v[76:79], v10, s[44:47], s8 offen offset:0 sc1
    s_mov_b32 s8, 94908416
    buffer_load_dwordx4 v[76:79], v1, s[44:47], s8 offen offset:0 sc1
    buffer_load_dwordx4 v[76:79], v1, s[44:47], s8 offen offset:1024 sc1
    s_mov_b32 s8, 94959872
    buffer_load_dwordx4 v[76:79], v1, s[44:47], s8 offen offset:0 sc1
    buffer_load_dwordx4 v[76:79], v1, s[44:47], s8 offen offset:1024 sc1
    buffer_load_dwordx4 v[76:79], v1, s[44:47], s8 offen offset:2048 sc1
    buffer_load_dwordx4 v[76:79], v1, s[44:47], s8 offen offset:3072 sc1
    buffer_load_dwordx4 v[76:79], v10, s[44:47], s8 offen offset:0 sc1
    s_mov_b32 s8, 94916608
    buffer_load_dwordx4 v[76:79], v1, s[44:47], s8 offen offset:0 sc1
    buffer_load_dwordx4 v[76:79], v1, s[44:47], s8 offen offset:1024 sc1
    s_mov_b32 s8, 94980608
    buffer_load_dwordx4 v[76:79], v1, s[44:47], s8 offen offset:0 sc1
    buffer_load_dwordx4 v[76:79], v1, s[44:47], s8 offen offset:1024 sc1
    buffer_load_dwordx4 v[76:79], v1, s[44:47], s8 offen offset:2048 sc1
    buffer_load_dwordx4 v[76:79], v1, s[44:47], s8 offen offset:3072 sc1
    buffer_load_dwordx4 v[76:79], v10, s[44:47], s8 offen offset:0 sc1
    s_mov_b32 s8, 94924800
    buffer_load_dwordx4 v[76:79], v1, s[44:47], s8 offen offset:0 sc1
    buffer_load_dwordx4 v[76:79], v1, s[44:47], s8 offen offset:1024 sc1
    s_mov_b32 s8, 95001344
    buffer_load_dwordx4 v[76:79], v1, s[44:47], s8 offen offset:0 sc1
    buffer_load_dwordx4 v[76:79], v1, s[44:47], s8 offen offset:1024 sc1
    buffer_load_dwordx4 v[76:79], v1, s[44:47], s8 offen offset:2048 sc1
    buffer_load_dwordx4 v[76:79], v1, s[44:47], s8 offen offset:3072 sc1
    buffer_load_dwordx4 v[76:79], v10, s[44:47], s8 offen offset:0 sc1
    s_waitcnt vmcnt(0)
    s_barrier
    s_cmp_gt_u32 s95, 0xffff
    s_cbranch_scc1 ch2as
    s_branch ch2af
chw3:
    s_cmp_ge_u32 s7, 28
    s_cbranch_scc1 chw3a
    s_lshr_b32 s8, s80, 2
    s_mul_i32 s12, s8, 5120
    s_bfe_u32 s8, s80, 0x10001
    s_lshl_b32 s8, s8, 9
    s_add_u32 s12, s12, s8
    s_and_b32 s8, s80, 1
    s_lshl_b32 s8, s8, 5
    s_add_u32 s12, s12, s8
    s_lshl_b32 s8, s81, 11
    s_add_u32 s12, s12, s8
    s_add_u32 s12, s12, 94928896
    s_mul_i32 s13, s7, 640
    s_add_u32 s13, s13, 94929664
    s_lshl_b32 s14, s82, 8
    s_add_u32 s14, s14, 94896128
    s_waitcnt vmcnt(0)
    s_cmp_lg_u32 s6, 0
    s_cbranch_scc1 sw_138
    v_min_u32 v23, 6, v0
    v_lshlrev_b32 v23, 7, v23
    s_mov_b32 s98, 95072768
    s_mov_b32 s99, 0
ws_139:
    buffer_load_dword v22, v23, s[44:47], s98 offen sc1
    s_add_u32 s99, s99, 1
    s_cmp_ge_u32 s99, 400000
    s_cbranch_scc1 mega_abort
    s_waitcnt vmcnt(0)
    v_cmp_gt_u32 vcc, 32, v22
    s_cbranch_vccz wt_140
    s_sleep 4
    s_branch ws_139
wt_140:
sw_138:
    s_barrier
    s_cmp_lg_u32 s6, 0
    s_cbranch_scc1 rv_141
    s_cmp_eq_u32 s5, 0
    s_cselect_b32 s8, 1, 0x10001
    s_mov_b32 s9, 95072512
    s_mov_b64 exec, 1
    v_mov_b32 v22, s8
    buffer_atomic_add v22, off, s[44:47], s9 sc1
    s_mov_b64 exec, -1
rv_141:
    s_lshl_b32 s95, s82, 4
    s_add_u32 s95, s95, 12
    s_mul_i32 s95, s95, 14336
    s_add_u32 s95, s95, 10092544
    s_waitcnt vmcnt(40)
    s_add_u32 s8, s95, 0
    buffer_load_dwordx4 a[224:227], v1, s[44:47], s8 offen offset:0 sc1
    s_add_u32 s8, s95, 0
    buffer_load_dwordx4 a[228:231], v1, s[44:47], s8 offen offset:1024 sc1
    s_add_u32 s8, s95, 0
    buffer_load_dwordx4 a[232:235], v1, s[44:47], s8 offen offset:2048 sc1
    s_add_u32 s8, s95, 0
    buffer_load_dwordx4 a[236:239], v1, s[44:47], s8 offen offset:3072 sc1
    s_add_u32 s8, s95, 4096
    buffer_load_dwordx4 a[240:243], v1, s[44:47], s8 offen offset:0 sc1
    s_add_u32 s8, s95, 4096
    buffer_load_dwordx4 a[244:247], v1, s[44:47], s8 offen offset:1024 sc1
    s_add_u32 s8, s95, 4096
    buffer_load_dwordx4 a[248:251], v1, s[44:47], s8 offen offset:2048 sc1
    s_add_u32 s8, s95, 4096
    buffer_load_dwordx4 a[252:255], v1, s[44:47], s8 offen offset:3072 sc1
    s_add_u32 s8, s95, 8192
    buffer_load_dwordx4 v[120:123], v1, s[44:47], s8 offen offset:0 sc1
    s_add_u32 s8, s95, 8192
    buffer_load_dwordx4 v[124:127], v1, s[44:47], s8 offen offset:1024 sc1
    s_add_u32 s8, s95, 8192
    buffer_load_dwordx4 v[128:131], v1, s[44:47], s8 offen offset:2048 sc1
    s_add_u32 s8, s95, 8192
    buffer_load_dwordx4 v[132:135], v1, s[44:47], s8 offen offset:3072 sc1
    s_add_u32 s8, s95, 12288
    buffer_load_dwordx4 v[136:139], v1, s[44:47], s8 offen offset:0 sc1
    s_add_u32 s8, s95, 12288
    buffer_load_dwordx4 v[140:143], v1, s[44:47], s8 offen offset:1024 sc1
    s_waitcnt vmcnt(40)
    s_add_u32 s8, s95, 12288
    buffer_load_dwordx4 v[144:147], v1, s[44:47], s8 offen offset:2048 sc1
    s_add_u32 s8, s95, 12288
    buffer_load_dwordx4 v[148:151], v1, s[44:47], s8 offen offset:3072 sc1
    s_add_u32 s8, s95, 16384
    buffer_load_dwordx4 v[152:155], v1, s[44:47], s8 offen offset:0 sc1
    s_add_u32 s8, s95, 16384
    buffer_load_dwordx4 v[156:159], v1, s[44:47], s8 offen offset:1024 sc1
    s_add_u32 s8, s95, 16384
    buffer_load_dwordx4 v[160:163], v1, s[44:47], s8 offen offset:2048 sc1
    s_add_u32 s8, s95, 16384
    buffer_load_dwordx4 v[164:167], v1, s[44:47], s8 offen offset:3072 sc1
    s_add_u32 s8, s95, 20480
    buffer_load_dwordx4 v[168:171], v1, s[44:47], s8 offen offset:0 sc1
    s_add_u32 s8, s95, 20480
    buffer_load_dwordx4 v[172:175], v1, s[44:47], s8 offen offset:1024 sc1
    s_add_u32 s8, s95, 20480
    buffer_load_dwordx4 v[176:179], v1, s[44:47], s8 offen offset:2048 sc1
    s_add_u32 s8, s95, 20480
    buffer_load_dwordx4 v[180:183], v1, s[44:47], s8 offen offset:3072 sc1
    s_add_u32 s8, s95, 24576
    buffer_load_dwordx4 v[184:187], v1, s[44:47], s8 offen offset:0 sc1
    s_add_u32 s8, s95, 24576
    buffer_load_dwordx4 v[188:191], v1, s[44:47], s8 offen offset:1024 sc1
    s_add_u32 s8, s95, 24576
    buffer_load_dwordx4 v[192:195], v1, s[44:47], s8 offen offset:2048 sc1
    s_add_u32 s8, s95, 24576
    buffer_load_dwordx4 v[196:199], v1, s[44:47], s8 offen offset:3072 sc1
    s_waitcnt vmcnt(40)
    s_add_u32 s8, s95, 28672
    buffer_load_dwordx4 v[200:203], v1, s[44:47], s8 offen offset:0 sc1
    s_add_u32 s8, s95, 28672
    buffer_load_dwordx4 v[204:207], v1, s[44:47], s8 offen offset:1024 sc1
    s_add_u32 s8, s95, 28672
    buffer_load_dwordx4 v[208:211], v1, s[44:47], s8 offen offset:2048 sc1
    s_add_u32 s8, s95, 28672
    buffer_load_dwordx4 v[212:215], v1, s[44:47], s8 offen offset:3072 sc1
    s_add_u32 s8, s95, 32768
    buffer_load_dwordx4 v[216:219], v1, s[44:47], s8 offen offset:0 sc1
    s_add_u32 s8, s95, 32768
    buffer_load_dwordx4 v[220:223], v1, s[44:47], s8 offen offset:1024 sc1
    s_add_u32 s8, s95, 32768
    buffer_load_dwordx4 v[224:227], v1, s[44:47], s8 offen offset:2048 sc1
    s_add_u32 s8, s95, 32768
    buffer_load_dwordx4 v[228:231], v1, s[44:47], s8 offen offset:3072 sc1
    s_add_u32 s8, s95, 36864
    buffer_load_dwordx4 v[232:235], v1, s[44:47], s8 offen offset:0 sc1
    s_add_u32 s8, s95, 36864
    buffer_load_dwordx4 v[236:239], v1, s[44:47], s8 offen offset:1024 sc1
    s_add_u32 s8, s95, 36864
    buffer_load_dwordx4 v[240:243], v1, s[44:47], s8 offen offset:2048 sc1
    s_add_u32 s8, s95, 36864
    buffer_load_dwordx4 v[244:247], v1, s[44:47], s8 offen offset:3072 sc1
    s_add_u32 s8, s95, 40960
    buffer_load_dwordx4 v[248:251], v1, s[44:47], s8 offen offset:0 sc1
    s_add_u32 s8, s95, 40960
    buffer_load_dwordx4 v[252:255], v1, s[44:47], s8 offen offset:1024 sc1
    s_waitcnt vmcnt(40)
    s_add_u32 s8, s95, 40960
    buffer_load_dwordx4 a[168:171], v1, s[44:47], s8 offen offset:2048 sc1
    s_add_u32 s8, s95, 40960
    buffer_load_dwordx4 a[172:175], v1, s[44:47], s8 offen offset:3072 sc1
    s_add_u32 s8, s95, 45056
    buffer_load_dwordx4 a[176:179], v1, s[44:47], s8 offen offset:0 sc1
    s_add_u32 s8, s95, 45056
    buffer_load_dwordx4 a[180:183], v1, s[44:47], s8 offen offset:1024 sc1
    s_add_u32 s8, s95, 45056
    buffer_load_dwordx4 a[184:187], v1, s[44:47], s8 offen offset:2048 sc1
    s_add_u32 s8, s95, 45056
    buffer_load_dwordx4 a[188:191], v1, s[44:47], s8 offen offset:3072 sc1
    s_add_u32 s8, s95, 49152
    buffer_load_dwordx4 a[192:195], v1, s[44:47], s8 offen offset:0 sc1
    s_add_u32 s8, s95, 49152
    buffer_load_dwordx4 a[196:199], v1, s[44:47], s8 offen offset:1024 sc1
    s_add_u32 s8, s95, 49152
    buffer_load_dwordx4 a[200:203], v1, s[44:47], s8 offen offset:2048 sc1
    s_add_u32 s8, s95, 49152
    buffer_load_dwordx4 a[204:207], v1, s[44:47], s8 offen offset:3072 sc1
    s_add_u32 s8, s95, 53248
    buffer_load_dwordx4 a[208:211], v1, s[44:47], s8 offen offset:0 sc1
    s_add_u32 s8, s95, 53248
    buffer_load_dwordx4 a[212:215], v1, s[44:47], s8 offen offset:1024 sc1
    s_add_u32 s8, s95, 53248
    buffer_load_dwordx4 a[216:219], v1, s[44:47], s8 offen offset:2048 sc1
    s_add_u32 s8, s95, 53248
    buffer_load_dwordx4 a[220:223], v1, s[44:47], s8 offen offset:3072 sc1
    v_mov_b32 v16, 0
    v_mov_b32 v17, 0
    v_lshlrev_b32 v18, 3, v0
    ds_write_b64 v18, v[16:17] offset:11776
    v_lshrrev_b32 v4, 4, v0
    v_bfe_u32 v5, v3, 1, 1
    v_mul_u32_u24 v5, 0xaaaa, v5
    v_add_u32 v5, 0x4444, v5
    v_bfe_u32 v6, v3, 2, 1
    v_lshlrev_b32 v6, 7, v6
    v_lshrrev_b32 v7, 3, v3
    v_lshl_add_u32 v6, v7, 6, v6
    v_and_b32 v7, 1, v3
    v_lshl_add_u32 v6, v7, 5, v6
    v_lshl_add_u32 v6, v4, 3, v6
    v_bfe_u32 v7, v3, 1, 1
    v_lshl_add_u32 v6, v7, 2, v6
    v_add_u32 v6, 8192, v6
    v_lshrrev_b32 v7, 2, v3
    v_lshlrev_b32 v7, 5, v7
    v_lshl_add_u32 v7, v4, 8, v7
    v_and_b32 v8, 3, v3
    v_lshl_add_u32 v7, v8, 3, v7
    v_add_u32 v7, 8192, v7
    v_bfe_u32 v8, v3, 1, 2
    v_lshlrev_b32 v8, 6, v8
    v_and_b32 v9, 1, v3
    v_lshl_add_u32 v8, v9, 4, v8
    v_lshrrev_b32 v9, 1, v4
    v_lshl_add_u32 v8, v9, 8, v8
    v_and_b32 v9, 1, v4
    v_lshl_add_u32 v8, v9, 3, v8
    s_mul_i32 s8, s81, 3584
    v_add_u32 v8, s8, v8
    v_lshlrev_b32 v11, 7, v4
    v_lshl_add_u32 v11, v3, 2, v11
    s_lshl_b32 s8, s6, 9
    s_add_u32 s8, s8, 12288
    v_add_u32 v11, s8, v11
    v_lshlrev_b32 v12, 3, v0
    v_add_u32 v12, 12288, v12
    v_lshrrev_b32 v13, 4, v0
    v_lshlrev_b32 v13, 6, v13
    v_bfe_u32 v14, v0, 2, 1
    v_lshl_add_u32 v13, v14, 5, v13
    v_bfe_u32 v14, v0, 3, 1
    v_lshl_add_u32 v13, v14, 4, v13
    v_and_b32 v14, 3, v0
    v_lshl_add_u32 v13, v14, 2, v13
    v_lshlrev_b32 v9, 6, v4
    v_and_b32 v22, 1, v3
    v_lshl_add_u32 v9, v22, 4, v9
    v_mov_b32 v14, 0x05040100
    v_mov_b32 v23, 0x03020706
    v_cmp_eq_u32 vcc, 1, v22
    s_nop 1
    v_cndmask_b32 v14, v14, v23, vcc
    v_lshrrev_b32 v22, 3, v3
    v_lshl_add_u32 v9, v22, 8, v9
    v_bfe_u32 v22, v3, 1, 2
    v_lshl_add_u32 v9, v22, 2, v9
    v_add_u32 v9, 1024, v9
    s_setreg_imm32_b32 hwreg(HW_REG_MODE, 23, 1), 1
    v_add_u32 v10, 4096, v1
    s_cmp_lg_u32 s6, 0
    s_cbranch_scc1 sw_142
    v_min_u32 v23, 7, v0
    v_lshlrev_b32 v23, 7, v23
    s_mov_b32 s98, 95072768
    s_mov_b32 s99, 0
ws_143:
    buffer_load_dword v22, v23, s[44:47], s98 offen sc1
    s_add_u32 s99, s99, 1
    s_cmp_ge_u32 s99, 400000
    s_cbranch_scc1 mega_abort
    s_waitcnt vmcnt(0)
    v_cmp_gt_u32 vcc, 32, v22
    s_cbranch_vccz wt_144
    s_sleep 4
    s_branch ws_143
wt_144:
sw_142:
    s_barrier
    v_add_u32 v12, 73728, v1
    s_mov_b32 s15, 65536
    v_mov_b32 v3, -1
    v_mov_b32 v104, 0
    v_mov_b32 v105, 0
    v_mov_b32 v106, 0
    v_mov_b32 v107, 0
    v_mov_b32 v108, 0
    v_mov_b32 v109, 0
    v_mov_b32 v110, 0
    v_mov_b32 v111, 0
    v_mov_b32 v117, 0
    v_mov_b32 v119, 0
    v_lshlrev_b32 v4, 2, v0
    s_mul_i32 s72, s81, 7168
    s_add_u32 s72, s72, 1835008
    s_lshl_b32 s71, s82, 14
    s_add_u32 s71, s71, 16527360
    s_mov_b32 s75, 95014912
    s_mov_b32 s73, 95072640
    s_mov_b32 s64, 0
    s_mov_b32 s100, 0
    s_mov_b32 s101, -1
    v_mov_b32 v2, 0
    s_mov_b32 s9, 95072512
    s_mov_b32 s83, 0
rdv_145:
    buffer_load_dword v2, off, s[44:47], s9 sc1
    s_add_u32 s83, s83, 1
    s_cmp_ge_u32 s83, 2000000
    s_cbranch_scc1 chain_abort
    s_waitcnt vmcnt(0) lgkmcnt(0)
    v_readfirstlane_b32 s8, v2
    s_and_b32 s10, s8, 0xffff
    s_cmp_lt_u32 s10, 32
    s_cbranch_scc1 rdv_145
    s_mov_b32 s95, s8
    s_cmp_lg_u32 s6, 0
    s_cbranch_scc1 sw_146
    v_min_u32 v23, 6, v0
    v_lshlrev_b32 v23, 7, v23
    s_mov_b32 s98, 95073792
    s_mov_b32 s99, 0
ws_147:
    buffer_load_dword v22, v23, s[44:47], s98 offen sc1
    s_add_u32 s99, s99, 1
    s_cmp_ge_u32 s99, 400000
    s_cbranch_scc1 mega_abort
    s_waitcnt vmcnt(0)
    v_cmp_gt_u32 vcc, 32, v22
    s_cbranch_vccz wt_148
    s_sleep 4
    s_branch ws_147
wt_148:
sw_146:
    s_barrier
    s_mul_i32 s10, s80, 28
    s_mul_i32 s9, s81, 14
    s_add_u32 s10, s10, s9
    s_mul_i32 s10, s10, 14336
    s_add_u32 s8, s10, 3799040
    buffer_load_dwordx4 a[0:3], v1, s[44:47], s8 offen offset:0 sc1
    buffer_load_dwordx4 a[4:7], v1, s[44:47], s8 offen offset:1024 sc1
    buffer_load_dwordx4 a[8:11], v1, s[44:47], s8 offen offset:2048 sc1
    buffer_load_dwordx4 a[12:15], v1, s[44:47], s8 offen offset:3072 sc1
    s_add_u32 s8, s8, 4096
    buffer_load_dwordx4 a[16:19], v1, s[44:47], s8 offen offset:0 sc1
    buffer_load_dwordx4 a[20:23], v1, s[44:47], s8 offen offset:1024 sc1
    buffer_load_dwordx4 a[24:27], v1, s[44:47], s8 offen offset:2048 sc1
    buffer_load_dwordx4 a[28:31], v1, s[44:47], s8 offen offset:3072 sc1
    s_add_u32 s8, s8, 4096
    buffer_load_dwordx4 a[32:35], v1, s[44:47], s8 offen offset:0 sc1
    buffer_load_dwordx4 a[36:39], v1, s[44:47], s8 offen offset:1024 sc1
    buffer_load_dwordx4 a[40:43], v1, s[44:47], s8 offen offset:2048 sc1
    buffer_load_dwordx4 a[44:47], v1, s[44:47], s8 offen offset:3072 sc1
    s_add_u32 s8, s8, 4096
    buffer_load_dwordx4 a[48:51], v1, s[44:47], s8 offen offset:0 sc1
    buffer_load_dwordx4 a[52:55], v1, s[44:47], s8 offen offset:1024 sc1
    s_add_u32 s8, s10, 3813376
    buffer_load_dwordx4 a[56:59], v1, s[44:47], s8 offen offset:0 sc1
    buffer_load_dwordx4 a[60:63], v1, s[44:47], s8 offen offset:1024 sc1
    buffer_load_dwordx4 a[64:67], v1, s[44:47], s8 offen offset:2048 sc1
    buffer_load_dwordx4 a[68:71], v1, s[44:47], s8 offen offset:3072 sc1
    s_add_u32 s8, s8, 4096
    buffer_load_dwordx4 a[72:75], v1, s[44:47], s8 offen offset:0 sc1
    buffer_load_dwordx4 a[76:79], v1, s[44:47], s8 offen offset:1024 sc1
    buffer_load_dwordx4 a[80:83], v1, s[44:47], s8 offen offset:2048 sc1
    buffer_load_dwordx4 a[84:87], v1, s[44:47], s8 offen offset:3072 sc1
    s_add_u32 s8, s8, 4096
    buffer_load_dwordx4 a[88:91], v1, s[44:47], s8 offen offset:0 sc1
    buffer_load_dwordx4 a[92:95], v1, s[44:47], s8 offen offset:1024 sc1
    buffer_load_dwordx4 a[96:99], v1, s[44:47], s8 offen offset:2048 sc1
    buffer_load_dwordx4 a[100:103], v1, s[44:47], s8 offen offset:3072 sc1
    s_add_u32 s8, s8, 4096
    buffer_load_dwordx4 a[104:107], v1, s[44:47], s8 offen offset:0 sc1
    buffer_load_dwordx4 a[108:111], v1, s[44:47], s8 offen offset:1024 sc1
    s_add_u32 s8, s10, 3827712
    buffer_load_dwordx4 a[112:115], v1, s[44:47], s8 offen offset:0 sc1
    buffer_load_dwordx4 a[116:119], v1, s[44:47], s8 offen offset:1024 sc1
    buffer_load_dwordx4 a[120:123], v1, s[44:47], s8 offen offset:2048 sc1
    buffer_load_dwordx4 a[124:127], v1, s[44:47], s8 offen offset:3072 sc1
    s_add_u32 s8, s8, 4096
    buffer_load_dwordx4 a[128:131], v1, s[44:47], s8 offen offset:0 sc1
    buffer_load_dwordx4 a[132:135], v1, s[44:47], s8 offen offset:1024 sc1
    buffer_load_dwordx4 a[136:139], v1, s[44:47], s8 offen offset:2048 sc1
    buffer_load_dwordx4 a[140:143], v1, s[44:47], s8 offen offset:3072 sc1
    s_add_u32 s8, s8, 4096
    buffer_load_dwordx4 a[144:147], v1, s[44:47], s8 offen offset:0 sc1
    buffer_load_dwordx4 a[148:151], v1, s[44:47], s8 offen offset:1024 sc1
    buffer_load_dwordx4 a[152:155], v1, s[44:47], s8 offen offset:2048 sc1
    buffer_load_dwordx4 a[156:159], v1, s[44:47], s8 offen offset:3072 sc1
    s_add_u32 s8, s8, 4096
    buffer_load_dwordx4 a[160:163], v1, s[44:47], s8 offen offset:0 sc1
    buffer_load_dwordx4 a[164:167], v1, s[44:47], s8 offen offset:1024 sc1
    s_waitcnt vmcnt(30)
    s_mov_b32 s8, 94902272
    buffer_load_dwordx4 v[76:79], v1, s[44:47], s8 offen offset:0 sc1
    s_mov_b32 s8, 94944256
    buffer_load_dwordx4 v[76:79], v1, s[44:47], s8 offen offset:0 sc1
    buffer_load_dwordx4 v[76:79], v1, s[44:47], s8 offen offset:1024 sc1
    buffer_load_dwordx4 v[76:79], v1, s[44:47], s8 offen offset:2048 sc1
    buffer_load_dwordx4 v[76:79], v1, s[44:47], s8 offen offset:3072 sc1
    buffer_load_dwordx4 v[76:79], v10, s[44:47], s8 offen offset:0 sc1
    s_mov_b32 s8, 94910464
    buffer_load_dwordx4 v[76:79], v1, s[44:47], s8 offen offset:0 sc1
    s_mov_b32 s8, 94964992
    buffer_load_dwordx4 v[76:79], v1, s[44:47], s8 offen offset:0 sc1
    buffer_load_dwordx4 v[76:79], v1, s[44:47], s8 offen offset:1024 sc1
    buffer_load_dwordx4 v[76:79], v1, s[44:47], s8 offen offset:2048 sc1
    buffer_load_dwordx4 v[76:79], v1, s[44:47], s8 offen offset:3072 sc1
    buffer_load_dwordx4 v[76:79], v10, s[44:47], s8 offen offset:0 sc1
    s_mov_b32 s8, 94918656
    buffer_load_dwordx4 v[76:79], v1, s[44:47], s8 offen offset:0 sc1
    s_mov_b32 s8, 94985728
    buffer_load_dwordx4 v[76:79], v1, s[44:47], s8 offen offset:0 sc1
    buffer_load_dwordx4 v[76:79], v1, s[44:47], s8 offen offset:1024 sc1
    buffer_load_dwordx4 v[76:79], v1, s[44:47], s8 offen offset:2048 sc1
    buffer_load_dwordx4 v[76:79], v1, s[44:47], s8 offen offset:3072 sc1
    buffer_load_dwordx4 v[76:79], v10, s[44:47], s8 offen offset:0 sc1
    s_mov_b32 s8, 94926848
    buffer_load_dwordx4 v[76:79], v1, s[44:47], s8 offen offset:0 sc1
    s_mov_b32 s8, 95006464
    buffer_load_dwordx4 v[76:79], v1, s[44:47], s8 offen offset:0 sc1
    buffer_load_dwordx4 v[76:79], v1, s[44:47], s8 offen offset:1024 sc1
    buffer_load_dwordx4 v[76:79], v1, s[44:47], s8 offen offset:2048 sc1
    buffer_load_dwordx4 v[76:79], v1, s[44:47], s8 offen offset:3072 sc1
    buffer_load_dwordx4 v[76:79], v10, s[44:47], s8 offen offset:0 sc1
    v_lshlrev_b32 v113, 7, v0
    s_mov_b32 s99, 0
hz_149:
    buffer_load_dword v115, v113, s[44:47], s75 offen sc1
    s_waitcnt vmcnt(0)
    v_cmp_gt_u32 vcc, 28, v115
    s_ff1_i32_b64 s100, vcc
    s_cmp_eq_u32 s100, -1
    s_cselect_b32 s100, 65, s100
    s_sub_u32 s100, s100, 1
    s_cmp_ge_i32 s100, s64
    s_cbranch_scc1 hd_150
    s_sleep 1
    s_add_u32 s99, s99, 1
    s_cmp_lt_u32 s99, 400000
    s_cbranch_scc1 hz_149
    s_branch chain_abort
hd_150:
    s_mov_b32 m0, 28672
    s_nop 0
    buffer_load_dwordx4 v1, s[44:47], s71 offen offset:0 sc1 lds
    buffer_load_dwordx4 v1, s[44:47], s71 offen offset:1024 sc1 lds
    s_barrier
    s_cmp_gt_u32 s95, 0xffff
    s_cbranch_scc1 ch3bs
    s_branch ch3bf
chw3a:
    s_lshr_b32 s8, s80, 2
    s_mul_i32 s12, s8, 5120
    s_bfe_u32 s8, s80, 0x10001
    s_lshl_b32 s8, s8, 9
    s_add_u32 s12, s12, s8
    s_and_b32 s8, s80, 1
    s_lshl_b32 s8, s8, 5
    s_add_u32 s12, s12, s8
    s_lshl_b32 s8, s81, 11
    s_add_u32 s12, s12, s8
    s_add_u32 s12, s12, 94928896
    s_mul_i32 s13, s7, 640
    s_add_u32 s13, s13, 94929664
    s_lshl_b32 s14, s82, 8
    s_add_u32 s14, s14, 94896128
    s_waitcnt vmcnt(0)
    s_cmp_lg_u32 s6, 0
    s_cbranch_scc1 sw_151
    v_min_u32 v23, 6, v0
    v_lshlrev_b32 v23, 7, v23
    s_mov_b32 s98, 95072768
    s_mov_b32 s99, 0
ws_152:
    buffer_load_dword v22, v23, s[44:47], s98 offen sc1
    s_add_u32 s99, s99, 1
    s_cmp_ge_u32 s99, 400000
    s_cbranch_scc1 mega_abort
    s_waitcnt vmcnt(0)
    v_cmp_gt_u32 vcc, 32, v22
    s_cbranch_vccz wt_153
    s_sleep 4
    s_branch ws_152
wt_153:
sw_151:
    s_barrier
    s_cmp_lg_u32 s6, 0
    s_cbranch_scc1 rv_154
    s_cmp_eq_u32 s5, 0
    s_cselect_b32 s8, 1, 0x10001
    s_mov_b32 s9, 95072512
    s_mov_b64 exec, 1
    v_mov_b32 v22, s8
    buffer_atomic_add v22, off, s[44:47], s9 sc1
    s_mov_b64 exec, -1
rv_154:
    s_lshl_b32 s95, s82, 4
    s_add_u32 s95, s95, 12
    s_mul_i32 s95, s95, 14336
    s_add_u32 s95, s95, 10092544
    v_mov_b32 v16, 0
    v_mov_b32 v17, 0
    v_lshlrev_b32 v18, 3, v0
    ds_write_b64 v18, v[16:17] offset:11776
    v_lshrrev_b32 v4, 4, v0
    v_bfe_u32 v5, v3, 1, 1
    v_mul_u32_u24 v5, 0xaaaa, v5
    v_add_u32 v5, 0x4444, v5
    v_bfe_u32 v6, v3, 2, 1
    v_lshlrev_b32 v6, 7, v6
    v_lshrrev_b32 v7, 3, v3
    v_lshl_add_u32 v6, v7, 6, v6
    v_and_b32 v7, 1, v3
    v_lshl_add_u32 v6, v7, 5, v6
    v_lshl_add_u32 v6, v4, 3, v6
    v_bfe_u32 v7, v3, 1, 1
    v_lshl_add_u32 v6, v7, 2, v6
    v_add_u32 v6, 8192, v6
    v_lshrrev_b32 v7, 2, v3
    v_lshlrev_b32 v7, 5, v7
    v_lshl_add_u32 v7, v4, 8, v7
    v_and_b32 v8, 3, v3
    v_lshl_add_u32 v7, v8, 3, v7
    v_add_u32 v7, 8192, v7
    v_bfe_u32 v8, v3, 1, 2
    v_lshlrev_b32 v8, 6, v8
    v_and_b32 v9, 1, v3
    v_lshl_add_u32 v8, v9, 4, v8
    v_lshrrev_b32 v9, 1, v4
    v_lshl_add_u32 v8, v9, 8, v8
    v_and_b32 v9, 1, v4
    v_lshl_add_u32 v8, v9, 3, v8
    s_mul_i32 s8, s81, 3584
    v_add_u32 v8, s8, v8
    v_lshlrev_b32 v11, 7, v4
    v_lshl_add_u32 v11, v3, 2, v11
    s_lshl_b32 s8, s6, 9
    s_add_u32 s8, s8, 12288
    v_add_u32 v11, s8, v11
    v_lshlrev_b32 v12, 3, v0
    v_add_u32 v12, 12288, v12
    v_lshrrev_b32 v13, 4, v0
    v_lshlrev_b32 v13, 6, v13
    v_bfe_u32 v14, v0, 2, 1
    v_lshl_add_u32 v13, v14, 5, v13
    v_bfe_u32 v14, v0, 3, 1
    v_lshl_add_u32 v13, v14, 4, v13
    v_and_b32 v14, 3, v0
    v_lshl_add_u32 v13, v14, 2, v13
    v_lshlrev_b32 v9, 6, v4
    v_and_b32 v22, 1, v3
    v_lshl_add_u32 v9, v22, 4, v9
    v_mov_b32 v14, 0x05040100
    v_mov_b32 v23, 0x03020706
    v_cmp_eq_u32 vcc, 1, v22
    s_nop 1
    v_cndmask_b32 v14, v14, v23, vcc
    v_lshrrev_b32 v22, 3, v3
    v_lshl_add_u32 v9, v22, 8, v9
    v_bfe_u32 v22, v3, 1, 2
    v_lshl_add_u32 v9, v22, 2, v9
    v_add_u32 v9, 1024, v9
    s_setreg_imm32_b32 hwreg(HW_REG_MODE, 23, 1), 1
    v_add_u32 v10, 4096, v1
    s_cmp_lg_u32 s6, 0
    s_cbranch_scc1 sw_155
    v_min_u32 v23, 7, v0
    v_lshlrev_b32 v23, 7, v23
    s_mov_b32 s98, 95072768
    s_mov_b32 s99, 0
ws_156:
    buffer_load_dword v22, v23, s[44:47], s98 offen sc1
    s_add_u32 s99, s99, 1
    s_cmp_ge_u32 s99, 400000
    s_cbranch_scc1 mega_abort
    s_waitcnt vmcnt(0)
    v_cmp_gt_u32 vcc, 32, v22
    s_cbranch_vccz wt_157
    s_sleep 4
    s_branch ws_156
wt_157:
sw_155:
    s_barrier
    v_add_u32 v12, 73728, v1
    s_mov_b32 s15, 65536
    v_mov_b32 v3, -1
    v_mov_b32 v104, 0
    v_mov_b32 v105, 0
    v_mov_b32 v106, 0
    v_mov_b32 v107, 0
    v_mov_b32 v108, 0
    v_mov_b32 v109, 0
    v_mov_b32 v110, 0
    v_mov_b32 v111, 0
    v_mov_b32 v117, 0
    v_mov_b32 v119, 0
    v_lshlrev_b32 v4, 2, v0
    s_mul_i32 s72, s81, 7168
    s_add_u32 s72, s72, 1835008
    s_sub_u32 s8, s82, 28
    s_mul_i32 s71, s8, 114688
    s_add_u32 s71, s71, 16527360
    s_mov_b32 s75, 95014912
    s_mov_b32 s73, 95072640
    s_mov_b32 s64, 0
    s_mov_b32 s100, 0
    s_mov_b32 s101, -1
    v_mov_b32 v2, 0
    s_mov_b32 s9, 95072512
    s_mov_b32 s83, 0
rdv_158:
    buffer_load_dword v2, off, s[44:47], s9 sc1
    s_add_u32 s83, s83, 1
    s_cmp_ge_u32 s83, 2000000
    s_cbranch_scc1 chain_abort
    s_waitcnt vmcnt(0) lgkmcnt(0)
    v_readfirstlane_b32 s8, v2
    s_and_b32 s10, s8, 0xffff
    s_cmp_lt_u32 s10, 32
    s_cbranch_scc1 rdv_158
    s_mov_b32 s95, s8
    s_cmp_lg_u32 s6, 0
    s_cbranch_scc1 sw_159
    v_min_u32 v23, 6, v0
    v_lshlrev_b32 v23, 7, v23
    s_mov_b32 s98, 95073792
    s_mov_b32 s99, 0
ws_160:
    buffer_load_dword v22, v23, s[44:47], s98 offen sc1
    s_add_u32 s99, s99, 1
    s_cmp_ge_u32 s99, 400000
    s_cbranch_scc1 mega_abort
    s_waitcnt vmcnt(0)
    v_cmp_gt_u32 vcc, 32, v22
    s_cbranch_vccz wt_161
    s_sleep 4
    s_branch ws_160
wt_161:
sw_159:
    s_barrier
    s_mul_i32 s10, s80, 28
    s_mul_i32 s9, s81, 14
    s_add_u32 s10, s10, s9
    s_mul_i32 s10, s10, 14336
    s_add_u32 s8, s10, 3799040
    buffer_load_dwordx4 a[0:3], v1, s[44:47], s8 offen offset:0 sc1
    buffer_load_dwordx4 a[4:7], v1, s[44:47], s8 offen offset:1024 sc1
    buffer_load_dwordx4 a[8:11], v1, s[44:47], s8 offen offset:2048 sc1
    buffer_load_dwordx4 a[12:15], v1, s[44:47], s8 offen offset:3072 sc1
    s_add_u32 s8, s8, 4096
    buffer_load_dwordx4 a[16:19], v1, s[44:47], s8 offen offset:0 sc1
    buffer_load_dwordx4 a[20:23], v1, s[44:47], s8 offen offset:1024 sc1
    buffer_load_dwordx4 a[24:27], v1, s[44:47], s8 offen offset:2048 sc1
    buffer_load_dwordx4 a[28:31], v1, s[44:47], s8 offen offset:3072 sc1
    s_add_u32 s8, s8, 4096
    buffer_load_dwordx4 a[32:35], v1, s[44:47], s8 offen offset:0 sc1
    buffer_load_dwordx4 a[36:39], v1, s[44:47], s8 offen offset:1024 sc1
    buffer_load_dwordx4 a[40:43], v1, s[44:47], s8 offen offset:2048 sc1
    buffer_load_dwordx4 a[44:47], v1, s[44:47], s8 offen offset:3072 sc1
    s_add_u32 s8, s8, 4096
    buffer_load_dwordx4 a[48:51], v1, s[44:47], s8 offen offset:0 sc1
    buffer_load_dwordx4 a[52:55], v1, s[44:47], s8 offen offset:1024 sc1
    s_add_u32 s8, s10, 3813376
    buffer_load_dwordx4 a[56:59], v1, s[44:47], s8 offen offset:0 sc1
    buffer_load_dwordx4 a[60:63], v1, s[44:47], s8 offen offset:1024 sc1
    buffer_load_dwordx4 a[64:67], v1, s[44:47], s8 offen offset:2048 sc1
    buffer_load_dwordx4 a[68:71], v1, s[44:47], s8 offen offset:3072 sc1
    s_add_u32 s8, s8, 4096
    buffer_load_dwordx4 a[72:75], v1, s[44:47], s8 offen offset:0 sc1
    buffer_load_dwordx4 a[76:79], v1, s[44:47], s8 offen offset:1024 sc1
    buffer_load_dwordx4 a[80:83], v1, s[44:47], s8 offen offset:2048 sc1
    buffer_load_dwordx4 a[84:87], v1, s[44:47], s8 offen offset:3072 sc1
    s_add_u32 s8, s8, 4096
    buffer_load_dwordx4 a[88:91], v1, s[44:47], s8 offen offset:0 sc1
    buffer_load_dwordx4 a[92:95], v1, s[44:47], s8 offen offset:1024 sc1
    buffer_load_dwordx4 a[96:99], v1, s[44:47], s8 offen offset:2048 sc1
    buffer_load_dwordx4 a[100:103], v1, s[44:47], s8 offen offset:3072 sc1
    s_add_u32 s8, s8, 4096
    buffer_load_dwordx4 a[104:107], v1, s[44:47], s8 offen offset:0 sc1
    buffer_load_dwordx4 a[108:111], v1, s[44:47], s8 offen offset:1024 sc1
    s_add_u32 s8, s10, 3827712
    buffer_load_dwordx4 a[112:115], v1, s[44:47], s8 offen offset:0 sc1
    buffer_load_dwordx4 a[116:119], v1, s[44:47], s8 offen offset:1024 sc1
    buffer_load_dwordx4 a[120:123], v1, s[44:47], s8 offen offset:2048 sc1
    buffer_load_dwordx4 a[124:127], v1, s[44:47], s8 offen offset:3072 sc1
    s_add_u32 s8, s8, 4096
    buffer_load_dwordx4 a[128:131], v1, s[44:47], s8 offen offset:0 sc1
    buffer_load_dwordx4 a[132:135], v1, s[44:47], s8 offen offset:1024 sc1
    buffer_load_dwordx4 a[136:139], v1, s[44:47], s8 offen offset:2048 sc1
    buffer_load_dwordx4 a[140:143], v1, s[44:47], s8 offen offset:3072 sc1
    s_add_u32 s8, s8, 4096
    buffer_load_dwordx4 a[144:147], v1, s[44:47], s8 offen offset:0 sc1
    buffer_load_dwordx4 a[148:151], v1, s[44:47], s8 offen offset:1024 sc1
    buffer_load_dwordx4 a[152:155], v1, s[44:47], s8 offen offset:2048 sc1
    buffer_load_dwordx4 a[156:159], v1, s[44:47], s8 offen offset:3072 sc1
    s_add_u32 s8, s8, 4096
    buffer_load_dwordx4 a[160:163], v1, s[44:47], s8 offen offset:0 sc1
    buffer_load_dwordx4 a[164:167], v1, s[44:47], s8 offen offset:1024 sc1
    s_waitcnt vmcnt(30)
    s_mov_b32 s8, 94902272
    buffer_load_dwordx4 v[76:79], v1, s[44:47], s8 offen offset:0 sc1
    s_mov_b32 s8, 94944256
    buffer_load_dwordx4 v[76:79], v1, s[44:47], s8 offen offset:0 sc1
    buffer_load_dwordx4 v[76:79], v1, s[44:47], s8 offen offset:1024 sc1
    buffer_load_dwordx4 v[76:79], v1, s[44:47], s8 offen offset:2048 sc1
    buffer_load_dwordx4 v[76:79], v1, s[44:47], s8 offen offset:3072 sc1
    buffer_load_dwordx4 v[76:79], v10, s[44:47], s8 offen offset:0 sc1
    s_mov_b32 s8, 94910464
    buffer_load_dwordx4 v[76:79], v1, s[44:47], s8 offen offset:0 sc1
    s_mov_b32 s8, 94964992
    buffer_load_dwordx4 v[76:79], v1, s[44:47], s8 offen offset:0 sc1
    buffer_load_dwordx4 v[76:79], v1, s[44:47], s8 offen offset:1024 sc1
    buffer_load_dwordx4 v[76:79], v1, s[44:47], s8 offen offset:2048 sc1
    buffer_load_dwordx4 v[76:79], v1, s[44:47], s8 offen offset:3072 sc1
    buffer_load_dwordx4 v[76:79], v10, s[44:47], s8 offen offset:0 sc1
    s_mov_b32 s8, 94918656
    buffer_load_dwordx4 v[76:79], v1, s[44:47], s8 offen offset:0 sc1
    s_mov_b32 s8, 94985728
    buffer_load_dwordx4 v[76:79], v1, s[44:47], s8 offen offset:0 sc1
    buffer_load_dwordx4 v[76:79], v1, s[44:47], s8 offen offset:1024 sc1
    buffer_load_dwordx4 v[76:79], v1, s[44:47], s8 offen offset:2048 sc1
    buffer_load_dwordx4 v[76:79], v1, s[44:47], s8 offen offset:3072 sc1
    buffer_load_dwordx4 v[76:79], v10, s[44:47], s8 offen offset:0 sc1
    s_mov_b32 s8, 94926848
    buffer_load_dwordx4 v[76:79], v1, s[44:47], s8 offen offset:0 sc1
    s_mov_b32 s8, 95006464
    buffer_load_dwordx4 v[76:79], v1, s[44:47], s8 offen offset:0 sc1
    buffer_load_dwordx4 v[76:79], v1, s[44:47], s8 offen offset:1024 sc1
    buffer_load_dwordx4 v[76:79], v1, s[44:47], s8 offen offset:2048 sc1
    buffer_load_dwordx4 v[76:79], v1, s[44:47], s8 offen offset:3072 sc1
    buffer_load_dwordx4 v[76:79], v10, s[44:47], s8 offen offset:0 sc1
    v_lshlrev_b32 v113, 7, v0
    s_mov_b32 s99, 0
hz_162:
    buffer_load_dword v115, v113, s[44:47], s75 offen sc1
    s_waitcnt vmcnt(0)
    v_cmp_gt_u32 vcc, 28, v115
    s_ff1_i32_b64 s100, vcc
    s_cmp_eq_u32 s100, -1
    s_cselect_b32 s100, 65, s100
    s_sub_u32 s100, s100, 1
    s_max_i32 s100, s100, 0
hd_163:
    v_mov_b32 v2, s100
    buffer_store_dword v2, off, s[44:47], s73 sc1
    s_waitcnt vmcnt(0)
    s_barrier
    s_cmp_gt_u32 s95, 0xffff
    s_cbranch_scc1 ch3as
    s_branch ch3af
ch0bf:
    v_mov_b32 v44, 0
    v_mov_b32 v60, 0
    v_mov_b32 v45, 0
    v_mov_b32 v61, 0
    v_mov_b32 v46, 0
    v_mov_b32 v62, 0
    v_mov_b32 v47, 0
    v_mov_b32 v63, 0
    v_mov_b32 v48, 0
    v_mov_b32 v64, 0
    v_mov_b32 v49, 0
    v_mov_b32 v65, 0
    v_mov_b32 v50, 0
    v_mov_b32 v66, 0
    v_mov_b32 v51, 0
    v_mov_b32 v67, 0
    v_mov_b32 v52, 0
    v_mov_b32 v68, 0
    v_mov_b32 v53, 0
    v_mov_b32 v69, 0
    v_mov_b32 v54, 0
    v_mov_b32 v70, 0
    v_mov_b32 v55, 0
    v_mov_b32 v71, 0
    v_mov_b32 v56, 0
    v_mov_b32 v72, 0
    v_mov_b32 v57, 0
    v_mov_b32 v73, 0
    v_mov_b32 v58, 0
    v_mov_b32 v74, 0
    v_mov_b32 v59, 0
    v_mov_b32 v75, 0
    v_mov_b32 v112, 0
    v_mov_b32 v113, 0
    v_mov_b32 v114, 0
    v_mov_b32 v115, 0
    s_branch ch0bf_loop
.p2align 6
ch0bf_loop:
    s_and_b32 s8, s64, 3
    s_lshl_b32 s65, s8, 13
    s_add_u32 s65, s65, 94896128
    buffer_load_dwordx4 v[16:19], v1, s[44:47], s65 offen offset:0 sc1
    buffer_load_dwordx4 v[20:23], v1, s[44:47], s65 offen offset:1024 sc1
    s_mov_b32 s83, 0
    s_and_b32 s8, s64, 3
    s_mul_i32 s9, s8, 20736
    s_add_u32 s67, s9, 94928896
    s_add_u32 s66, s9, s12
    s_xor_b32 s8, s8, 2
    s_mul_i32 s9, s8, 20736
    s_add_u32 s70, s9, s13
    s_lshl_b32 s9, s8, 13
    s_add_u32 s69, s9, s14
    s_add_u32 s8, s64, 1
    s_and_b32 s8, s8, 3
    s_lshl_b32 s9, s8, 13
    s_add_u32 s68, s9, s14
    s_add_u32 s16, s72, 0
    s_add_u32 s20, s15, 0
    s_add_u32 s17, s72, 4096
    s_add_u32 s21, s15, 4096
    s_add_u32 s18, s72, 14336
    s_add_u32 s22, s15, 8192
    s_add_u32 s72, s72, 28672
    s_xor_b32 s15, s15, 0x4000
    s_add_u32 s24, s71, 0
    s_add_u32 s71, s71, 458752
    v_mov_b32 v60, 0
    v_mov_b32 v61, 0
    v_mov_b32 v62, 0
    v_mov_b32 v63, 0
    v_mov_b32 v64, 0
    v_mov_b32 v65, 0
    v_mov_b32 v66, 0
    v_mov_b32 v67, 0
    v_mov_b32 v68, 0
    v_mov_b32 v69, 0
    v_mov_b32 v70, 0
    v_mov_b32 v71, 0
    v_mov_b32 v72, 0
    v_mov_b32 v73, 0
    v_mov_b32 v74, 0
    v_mov_b32 v75, 0
ch0bf_mp:
    buffer_load_dwordx4 v[16:19], v1, s[44:47], s65 offen offset:0 sc1
    buffer_load_dwordx4 v[20:23], v1, s[44:47], s65 offen offset:1024 sc1
    s_add_u32 s83, s83, 1
    s_cmp_ge_u32 s83, 2000000
    s_cbranch_scc1 chain_abort
    s_waitcnt vmcnt(3)
    v_max3_u32 v2, v16, v17, v18
    v_max_u32 v2, v2, v19
    v_cmp_eq_u32 s[10:11], -1, v2
    s_waitcnt vmcnt(2)
    v_max3_u32 v2, v20, v21, v22
    v_max_u32 v2, v2, v23
    v_cmp_eq_u32 vcc, -1, v2
    s_cmp_lg_u64 s[10:11], 0
    s_cbranch_scc1 ch0bf_m0bad
    s_cbranch_vccnz ch0bf_mp1
ch0bf_mok:
    ds_write_b128 v1, v[16:19] offset:0
    ds_write_b128 v1, v[20:23] offset:1024
    v_smfmac_f32_16x16x64_bf16 v[44:47], v[16:19], a[0:7], v5
    v_smfmac_f32_16x16x64_bf16 v[48:51], v[16:19], a[56:63], v5
    s_waitcnt lgkmcnt(0)
    s_barrier
    s_mov_b32 m0, 16384
    ds_read_b128 v[24:27], v1 offset:2048
    ds_read_b128 v[28:31], v1 offset:3072
    ds_read_b128 v[32:35], v1 offset:4096
    ds_read_b128 v[36:39], v1 offset:5120
    ds_read_b128 v[40:43], v1 offset:6144
    v_smfmac_f32_16x16x64_bf16 v[52:55], v[16:19], a[112:119], v5
    buffer_load_dwordx4 v1, s[44:47], s24 offen offset:2048 sc1 lds
    v_smfmac_f32_16x16x64_bf16 v[44:47], v[20:23], a[8:15], v5
    buffer_load_dwordx4 v1, s[44:47], s24 offen offset:3072 sc1 lds
    s_mov_b32 m0, s20
    v_smfmac_f32_16x16x64_bf16 v[48:51], v[20:23], a[64:71], v5
    buffer_load_dwordx4 v1, s[44:47], s16 offen offset:0 sc1 lds
    v_smfmac_f32_16x16x64_bf16 v[52:55], v[20:23], a[120:127], v5
    buffer_load_dwordx4 v1, s[44:47], s16 offen offset:1024 sc1 lds
    v_smfmac_f32_16x16x64_bf16 v[60:63], v[16:19], a[224:231], v5
    buffer_load_dwordx4 v1, s[44:47], s16 offen offset:2048 sc1 lds
    v_smfmac_f32_16x16x64_bf16 v[60:63], v[20:23], a[232:239], v5
    buffer_load_dwordx4 v1, s[44:47], s16 offen offset:3072 sc1 lds
    s_mov_b32 m0, s21
    v_smfmac_f32_16x16x64_bf16 v[64:67], v[16:19], v[144:151], v5
    buffer_load_dwordx4 v1, s[44:47], s17 offen offset:0 sc1 lds
    s_waitcnt lgkmcnt(4)
    v_smfmac_f32_16x16x64_bf16 v[44:47], v[24:27], a[16:23], v5
    buffer_load_dwordx4 v1, s[44:47], s17 offen offset:1024 sc1 lds
    s_waitcnt lgkmcnt(3)
    v_smfmac_f32_16x16x64_bf16 v[44:47], v[28:31], a[24:31], v5
    buffer_load_dwordx4 v1, s[44:47], s17 offen offset:2048 sc1 lds
    s_mov_b32 m0, s22
    s_waitcnt lgkmcnt(2)
    v_smfmac_f32_16x16x64_bf16 v[44:47], v[32:35], a[32:39], v5
    buffer_load_dwordx4 v1, s[44:47], s18 offen offset:0 sc1 lds
    s_waitcnt lgkmcnt(1)
    v_smfmac_f32_16x16x64_bf16 v[44:47], v[36:39], a[40:47], v5
    buffer_load_dwordx4 v1, s[44:47], s18 offen offset:1024 sc1 lds
    s_waitcnt lgkmcnt(0)
    v_smfmac_f32_16x16x64_bf16 v[44:47], v[40:43], a[48:55], v5
    buffer_store_dword v3, v4, s[44:47], s70 offen
    v_smfmac_f32_16x16x64_bf16 v[48:51], v[24:27], a[72:79], v5
    buffer_store_dword v3, v4, s[44:47], s69 offen
    v_smfmac_f32_16x16x64_bf16 v[48:51], v[28:31], a[80:87], v5
    v_smfmac_f32_16x16x64_bf16 v[48:51], v[32:35], a[88:95], v5
    v_smfmac_f32_16x16x64_bf16 v[48:51], v[36:39], a[96:103], v5
    s_nop 1
    v_add_f32 v44, v44, v46
    v_smfmac_f32_16x16x64_bf16 v[48:51], v[40:43], a[104:111], v5
    v_add_f32 v45, v45, v47
    v_smfmac_f32_16x16x64_bf16 v[52:55], v[24:27], a[128:135], v5
    v_cvt_pk_bf16_f32 v44, v44, v45
    v_smfmac_f32_16x16x64_bf16 v[52:55], v[28:31], a[136:143], v5
    ds_write_b32 v6, v44 offset:0
    v_smfmac_f32_16x16x64_bf16 v[52:55], v[32:35], a[144:151], v5
    v_smfmac_f32_16x16x64_bf16 v[52:55], v[36:39], a[152:159], v5
    s_nop 0
    v_add_f32 v48, v48, v50
    v_smfmac_f32_16x16x64_bf16 v[52:55], v[40:43], a[160:167], v5
    v_add_f32 v49, v49, v51
    v_smfmac_f32_16x16x64_bf16 v[56:59], v[24:27], a[184:191], v5
    v_cvt_pk_bf16_f32 v48, v48, v49
    v_smfmac_f32_16x16x64_bf16 v[56:59], v[28:31], a[192:199], v5
    ds_write_b32 v6, v48 offset:256
    v_smfmac_f32_16x16x64_bf16 v[56:59], v[32:35], a[200:207], v5
    s_nop 1
    v_add_f32 v52, v52, v54
    v_smfmac_f32_16x16x64_bf16 v[56:59], v[36:39], a[208:215], v5
    v_add_f32 v53, v53, v55
    v_smfmac_f32_16x16x64_bf16 v[56:59], v[40:43], a[216:223], v5
    v_cvt_pk_bf16_f32 v52, v52, v53
    v_smfmac_f32_16x16x64_bf16 v[56:59], v[16:19], a[168:175], v5
    ds_write_b32 v6, v52 offset:512
    v_smfmac_f32_16x16x64_bf16 v[56:59], v[20:23], a[176:183], v5
    s_nop 7
    v_add_f32 v56, v56, v58
    v_add_f32 v57, v57, v59
    v_cvt_pk_bf16_f32 v56, v56, v57
    ds_write_b32 v6, v56 offset:3072
    s_waitcnt lgkmcnt(1)
    s_barrier
    ds_read_b128 v[44:47], v8 offset:0
    ds_read_b128 v[48:51], v8 offset:1024
    ds_read_b128 v[52:55], v8 offset:2048
    ds_read_b128 v[56:59], v8 offset:3072
    v_smfmac_f32_16x16x64_bf16 v[60:63], v[24:27], a[240:247], v5
    s_waitcnt lgkmcnt(4)
    s_barrier
    s_mov_b32 s83, 0
    s_mov_b32 s98, 0
    v_smfmac_f32_16x16x64_bf16 v[60:63], v[28:31], a[248:255], v5
    v_smfmac_f32_16x16x64_bf16 v[60:63], v[32:35], v[120:127], v5
    v_smfmac_f32_16x16x64_bf16 v[60:63], v[36:39], v[128:135], v5
    s_waitcnt lgkmcnt(2)
    v_smfmac_f32_16x16x64_bf16 v[72:75], v[16:19], v[44:51], v5
    ds_read_b128 v[44:47], v8 offset:4096
    ds_read_b128 v[48:51], v8 offset:5120
    v_smfmac_f32_16x16x64_bf16 v[60:63], v[40:43], v[136:143], v5
    v_smfmac_f32_16x16x64_bf16 v[64:67], v[20:23], v[152:159], v5
    v_smfmac_f32_16x16x64_bf16 v[64:67], v[24:27], v[160:167], v5
    s_waitcnt lgkmcnt(2)
    v_smfmac_f32_16x16x64_bf16 v[72:75], v[20:23], v[52:59], v5
    ds_read_b128 v[52:55], v8 offset:6144
    ds_read_b128 v[56:59], v8 offset:7168
    v_smfmac_f32_16x16x64_bf16 v[64:67], v[28:31], v[168:175], v5
    v_smfmac_f32_16x16x64_bf16 v[64:67], v[32:35], v[176:183], v5
    v_add_f32 v60, v60, v62
    v_smfmac_f32_16x16x64_bf16 v[64:67], v[36:39], v[184:191], v5
    v_add_f32 v61, v61, v63
    s_waitcnt lgkmcnt(2)
    v_smfmac_f32_16x16x64_bf16 v[72:75], v[24:27], v[44:51], v5
    ds_read_b128 v[44:47], v8 offset:8192
    ds_read_b128 v[48:51], v8 offset:9216
    v_smfmac_f32_16x16x64_bf16 v[64:67], v[40:43], v[192:199], v5
    v_cvt_pk_bf16_f32 v104, v60, v61
    v_smfmac_f32_16x16x64_bf16 v[68:71], v[16:19], v[200:207], v5
    v_mov_b32 v60, 0
    s_waitcnt lgkmcnt(2)
    v_smfmac_f32_16x16x64_bf16 v[72:75], v[28:31], v[52:59], v5
    ds_read_b128 v[52:55], v8 offset:10240
    ds_read_b128 v[56:59], v8 offset:11264
    v_smfmac_f32_16x16x64_bf16 v[68:71], v[20:23], v[208:215], v5
    v_mov_b32 v61, 0
    v_smfmac_f32_16x16x64_bf16 v[68:71], v[24:27], v[216:223], v5
    v_mov_b32 v62, 0
    s_waitcnt lgkmcnt(2)
    v_smfmac_f32_16x16x64_bf16 v[72:75], v[32:35], v[44:51], v5
    ds_read_b128 v[44:47], v8 offset:12288
    ds_read_b128 v[48:51], v8 offset:13312
    v_smfmac_f32_16x16x64_bf16 v[68:71], v[28:31], v[224:231], v5
    v_mov_b32 v63, 0
    v_smfmac_f32_16x16x64_bf16 v[68:71], v[32:35], v[232:239], v5
    s_cmp_ge_u32 s100, 64
    s_cbranch_scc0 ch0bf_hl
ch0bf_hs:
    buffer_load_dwordx4 v[76:79], v1, s[44:47], s67 offen offset:0 sc1
    buffer_load_dwordx4 v[84:87], v1, s[44:47], s67 offen offset:2048 sc1
    s_waitcnt lgkmcnt(2)
    v_smfmac_f32_16x16x64_bf16 v[72:75], v[36:39], v[52:59], v5
    v_smfmac_f32_16x16x64_bf16 v[68:71], v[36:39], v[240:247], v5
    v_add_f32 v64, v64, v66
    v_smfmac_f32_16x16x64_bf16 v[68:71], v[40:43], v[248:255], v5
    buffer_load_dwordx4 v[80:83], v1, s[44:47], s67 offen offset:1024 sc1
    buffer_load_dwordx4 v[88:91], v1, s[44:47], s67 offen offset:3072 sc1
    s_waitcnt lgkmcnt(0)
    v_smfmac_f32_16x16x64_bf16 v[72:75], v[40:43], v[44:51], v5
    buffer_load_dwordx4 v[92:95], v10, s[44:47], s67 offen offset:0 sc1
    v_add_f32 v65, v65, v67
    v_cvt_pk_bf16_f32 v105, v64, v65
    s_nop 0
    v_add_f32 v68, v68, v70
    v_add_f32 v69, v69, v71
    v_cvt_pk_bf16_f32 v108, v68, v69
    s_nop 0
    v_add_f32 v72, v72, v74
    v_add_f32 v73, v73, v75
    v_cvt_pk_bf16_f32 v109, v72, v73
    s_waitcnt vmcnt(3)
    ds_read_b128 v[44:47], v1 offset:16384
    ds_read_b128 v[48:51], v1 offset:17408
    ds_read_b128 v[52:55], v1 offset:18432
    ds_read_b128 v[56:59], v1 offset:19456
    s_cbranch_scc0 ch0bf_hu
ch0bf_hv:
    s_cmp_ge_u32 s64, s100
    v_fma_mix_f32 v102, v76, 1.0, v84 op_sel:[0,0,0] op_sel_hi:[1,0,1]
    v_fma_mix_f32 v84, v76, 1.0, v84 op_sel:[1,0,1] op_sel_hi:[1,0,1]
    v_fma_mix_f32 v76, v77, 1.0, v85 op_sel:[0,0,0] op_sel_hi:[1,0,1]
    v_fma_mix_f32 v85, v77, 1.0, v85 op_sel:[1,0,1] op_sel_hi:[1,0,1]
    v_fma_mix_f32 v77, v78, 1.0, v86 op_sel:[0,0,0] op_sel_hi:[1,0,1]
    v_fma_mix_f32 v86, v78, 1.0, v86 op_sel:[1,0,1] op_sel_hi:[1,0,1]
    v_fma_mix_f32 v78, v79, 1.0, v87 op_sel:[0,0,0] op_sel_hi:[1,0,1]
    v_fma_mix_f32 v87, v79, 1.0, v87 op_sel:[1,0,1] op_sel_hi:[1,0,1]
    v_maximum3_f32 v112, v84, v85, v86
    v_cmp_u_f32 vcc, v112, v87
    v_exp_f32 v76, v76
    v_exp_f32 v77, v77
    v_exp_f32 v78, v78
    s_cbranch_vccnz ch0bf_i0
    v_exp_f32 v79, v102
    v_exp_f32 v84, v84
    v_exp_f32 v85, v85
    v_pk_add_f32 v[96:97], v[76:77], v[78:79]
    v_exp_f32 v86, v86
    v_exp_f32 v87, v87
    v_pk_add_f32 v[96:97], v[96:97], v[84:85]
    v_pk_add_f32 v[96:97], v[96:97], v[86:87]
    s_waitcnt vmcnt(1)
    v_fma_mix_f32 v103, v80, 1.0, v88 op_sel:[0,0,0] op_sel_hi:[1,0,1]
    v_fma_mix_f32 v88, v80, 1.0, v88 op_sel:[1,0,1] op_sel_hi:[1,0,1]
    v_fma_mix_f32 v80, v81, 1.0, v89 op_sel:[0,0,0] op_sel_hi:[1,0,1]
    v_fma_mix_f32 v89, v81, 1.0, v89 op_sel:[1,0,1] op_sel_hi:[1,0,1]
    v_fma_mix_f32 v81, v82, 1.0, v90 op_sel:[0,0,0] op_sel_hi:[1,0,1]
    v_fma_mix_f32 v90, v82, 1.0, v90 op_sel:[1,0,1] op_sel_hi:[1,0,1]
    v_fma_mix_f32 v82, v83, 1.0, v91 op_sel:[0,0,0] op_sel_hi:[1,0,1]
    v_fma_mix_f32 v91, v83, 1.0, v91 op_sel:[1,0,1] op_sel_hi:[1,0,1]
    v_maximum3_f32 v114, v88, v89, v90
    v_cmp_u_f32 vcc, v114, v91
    v_exp_f32 v80, v80
    v_exp_f32 v81, v81
    v_exp_f32 v82, v82
    s_cbranch_vccnz ch0bf_i1
    v_exp_f32 v83, v103
    v_exp_f32 v88, v88
    v_exp_f32 v89, v89
    v_pk_add_f32 v[98:99], v[80:81], v[82:83]
    v_exp_f32 v90, v90
    v_exp_f32 v91, v91
    v_pk_add_f32 v[98:99], v[98:99], v[88:89]
    v_pk_add_f32 v[98:99], v[98:99], v[90:91]
    s_cbranch_scc1 ch0bf_nw
ch0bf_nw2:
    s_mov_b32 m0, 16384
    s_mov_b32 s98, 1
    s_waitcnt vmcnt(0) lgkmcnt(0)
    buffer_load_dwordx4 v1, s[44:47], s71 offen offset:0 sc1 lds
    buffer_load_dwordx4 v1, s[44:47], s71 offen offset:1024 sc1 lds
    v_fma_mix_f32 v113, v92, 1.0, v94 op_sel:[0,0,0] op_sel_hi:[1,0,1]
    v_fma_mix_f32 v94, v92, 1.0, v94 op_sel:[1,0,1] op_sel_hi:[1,0,1]
    v_fma_mix_f32 v92, v93, 1.0, v95 op_sel:[0,0,0] op_sel_hi:[1,0,1]
    v_fma_mix_f32 v95, v93, 1.0, v95 op_sel:[1,0,1] op_sel_hi:[1,0,1]
    v_cmp_u_f32 vcc, v94, v95
    v_exp_f32 v92, v92
    v_exp_f32 v93, v113
    v_exp_f32 v94, v94
    s_cbranch_vccnz ch0bf_i2
    v_exp_f32 v95, v95
    s_nop 0
    v_pk_add_f32 v[100:101], v[92:93], v[94:95]
ch0bf_w2d:
    v_pk_add_f32 v[96:97], v[96:97], v[98:99]
    v_pk_add_f32 v[96:97], v[96:97], v[100:101]
    v_add_f32 v2, v96, v97
    v_add_f32 v15, v96, v97
    s_nop 1
    v_permlane16_swap_b32 v2, v15
    v_add_f32 v2, v2, v15
    v_subrev_u32 v15, 0x17800000, v2
    v_rcp_f32 v2, v2
    v_cmp_le_u32 vcc, 0x5a000000, v15
    s_waitcnt lgkmcnt(0)
    v_pk_mul_f32 v[92:93], v[92:93], v[2:3] op_sel_hi:[1,0]
    v_pk_mul_f32 v[94:95], v[94:95], v[2:3] op_sel_hi:[1,0]
    v_cvt_pk_bf16_f32 v116, v93, v94
    v_cvt_pk_bf16_f32 v118, v92, v95
    s_cbranch_vccnz ch0bf_fb
    v_pk_mul_f32 v[76:77], v[76:77], v[2:3] op_sel_hi:[1,0]
    v_pk_mul_f32 v[78:79], v[78:79], v[2:3] op_sel_hi:[1,0]
    v_pk_mul_f32 v[84:85], v[84:85], v[2:3] op_sel_hi:[1,0]
    v_pk_mul_f32 v[86:87], v[86:87], v[2:3] op_sel_hi:[1,0]
    v_cvt_pk_bf16_f32 v96, v79, v84
    v_cvt_pk_bf16_f32 v97, v76, v85
    v_cvt_pk_bf16_f32 v98, v77, v86
    v_cvt_pk_bf16_f32 v99, v78, v87
    v_pk_mul_f32 v[80:81], v[80:81], v[2:3] op_sel_hi:[1,0]
    v_pk_mul_f32 v[82:83], v[82:83], v[2:3] op_sel_hi:[1,0]
    v_pk_mul_f32 v[88:89], v[88:89], v[2:3] op_sel_hi:[1,0]
    v_pk_mul_f32 v[90:91], v[90:91], v[2:3] op_sel_hi:[1,0]
    v_smfmac_f32_16x16x64_bf16 v[60:63], v[116:119], v[104:111], v5
    v_cvt_pk_bf16_f32 v100, v83, v88
    v_cvt_pk_bf16_f32 v101, v80, v89
    v_smfmac_f32_16x16x64_bf16 v[60:63], v[96:99], v[44:51], v5
    v_cvt_pk_bf16_f32 v102, v81, v90
    v_cvt_pk_bf16_f32 v103, v82, v91
    s_nop 1
    v_smfmac_f32_16x16x64_bf16 v[60:63], v[100:103], v[52:59], v5
ch0bf_kj:
    v_mov_b32 v44, 0
    v_mov_b32 v45, 0
    v_mov_b32 v46, 0
    v_mov_b32 v47, 0
    s_nop 3
    v_add_f32 v60, v60, v62
    v_add_f32 v61, v61, v63
    ds_write2_b32 v11, v60, v61 offset0:0 offset1:16
    v_mov_b32 v48, 0
    v_mov_b32 v49, 0
    v_mov_b32 v50, 0
    v_mov_b32 v51, 0
    v_mov_b32 v52, 0
    v_mov_b32 v53, 0
    v_mov_b32 v54, 0
    v_mov_b32 v55, 0
    v_mov_b32 v56, 0
    v_mov_b32 v57, 0
    v_mov_b32 v58, 0
    v_mov_b32 v59, 0
    v_mov_b32 v112, 0
    v_mov_b32 v113, 0
    v_mov_b32 v114, 0
    v_mov_b32 v115, 0
    s_waitcnt lgkmcnt(0)
    s_barrier
    ds_read2_b64 v[64:67], v12 offset0:0 offset1:64
    ds_read2_b64 v[68:71], v12 offset0:128 offset1:192
    s_waitcnt lgkmcnt(0)
    v_pk_add_f32 v[64:65], v[64:65], v[66:67]
    v_pk_add_f32 v[68:69], v[68:69], v[70:71]
    v_pk_add_f32 v[64:65], v[64:65], v[68:69]
    v_cvt_pk_bf16_f32 v15, v64, v65
    v_min_u32 v15, -2, v15
    buffer_store_dword v15, v13, s[44:47], s68 offen
    s_barrier
    s_add_u32 s64, s64, 1
    s_cmp_lt_u32 s64, 63
    s_cbranch_scc1 ch0bf_loop
    s_lshl_b32 s8, s82, 8
    s_add_u32 s8, s8, 92266496
    buffer_store_dword v15, v13, s[44:47], s8 offen sc1
    s_and_b32 s8, s64, 3
    s_lshl_b32 s65, s8, 13
    s_add_u32 s65, s65, 94896128
    v_mov_b32 v60, 0
    v_mov_b32 v61, 0
    v_mov_b32 v62, 0
    v_mov_b32 v63, 0
    v_mov_b32 v64, 0
    v_mov_b32 v65, 0
    v_mov_b32 v66, 0
    v_mov_b32 v67, 0
    v_mov_b32 v68, 0
    v_mov_b32 v69, 0
    v_mov_b32 v70, 0
    v_mov_b32 v71, 0
    v_mov_b32 v72, 0
    v_mov_b32 v73, 0
    v_mov_b32 v74, 0
    v_mov_b32 v75, 0
    buffer_load_dwordx4 v[76:79], v1, s[44:47], s65 offen offset:0 sc1
    buffer_load_dwordx4 v[80:83], v1, s[44:47], s65 offen offset:1024 sc1
    s_mov_b32 s83, 0
ch0bft_mp:
    buffer_load_dwordx4 v[16:19], v1, s[44:47], s65 offen offset:0 sc1
    buffer_load_dwordx4 v[20:23], v1, s[44:47], s65 offen offset:1024 sc1
    s_waitcnt vmcnt(3)
    v_max3_u32 v2, v76, v77, v78
    s_waitcnt vmcnt(2)
    v_max3_u32 v2, v2, v79, v80
    v_max3_u32 v2, v2, v81, v82
    v_max_u32 v2, v2, v83
    v_cmp_eq_u32 vcc, -1, v2
    s_cbranch_vccz ch0bft_g1
    buffer_load_dwordx4 v[76:79], v1, s[44:47], s65 offen offset:0 sc1
    buffer_load_dwordx4 v[80:83], v1, s[44:47], s65 offen offset:1024 sc1
    s_add_u32 s83, s83, 1
    s_cmp_ge_u32 s83, 2000000
    s_cbranch_scc1 chain_abort
    s_waitcnt vmcnt(3)
    v_max3_u32 v2, v16, v17, v18
    s_waitcnt vmcnt(2)
    v_max3_u32 v2, v2, v19, v20
    v_max3_u32 v2, v2, v21, v22
    v_max_u32 v2, v2, v23
    v_cmp_eq_u32 vcc, -1, v2
    s_cbranch_vccnz ch0bft_mp
ch0bft_g1:
    s_waitcnt vmcnt(0)
    ds_write_b128 v1, v[16:19] offset:0
    ds_write_b128 v1, v[20:23] offset:1024
    s_waitcnt lgkmcnt(0)
    s_barrier
    ds_read_b128 v[24:27], v1 offset:2048
    ds_read_b128 v[28:31], v1 offset:3072
    ds_read_b128 v[32:35], v1 offset:4096
    ds_read_b128 v[36:39], v1 offset:5120
    ds_read_b128 v[40:43], v1 offset:6144
    s_waitcnt lgkmcnt(0)
    ds_read_b128 v[44:47], v8 offset:0
    ds_read_b128 v[48:51], v8 offset:1024
    ds_read_b128 v[52:55], v8 offset:2048
    ds_read_b128 v[56:59], v8 offset:3072
    v_smfmac_f32_16x16x64_bf16 v[60:63], v[16:19], a[224:231], v5
    v_smfmac_f32_16x16x64_bf16 v[60:63], v[20:23], a[232:239], v5
    v_smfmac_f32_16x16x64_bf16 v[60:63], v[24:27], a[240:247], v5
    s_waitcnt lgkmcnt(2)
    v_smfmac_f32_16x16x64_bf16 v[72:75], v[16:19], v[44:51], v5
    ds_read_b128 v[44:47], v8 offset:4096
    ds_read_b128 v[48:51], v8 offset:5120
    v_smfmac_f32_16x16x64_bf16 v[60:63], v[28:31], a[248:255], v5
    v_smfmac_f32_16x16x64_bf16 v[60:63], v[32:35], v[120:127], v5
    v_smfmac_f32_16x16x64_bf16 v[60:63], v[36:39], v[128:135], v5
    s_waitcnt lgkmcnt(2)
    v_smfmac_f32_16x16x64_bf16 v[72:75], v[20:23], v[52:59], v5
    ds_read_b128 v[52:55], v8 offset:6144
    ds_read_b128 v[56:59], v8 offset:7168
    v_smfmac_f32_16x16x64_bf16 v[60:63], v[40:43], v[136:143], v5
    v_smfmac_f32_16x16x64_bf16 v[64:67], v[16:19], v[144:151], v5
    v_smfmac_f32_16x16x64_bf16 v[64:67], v[20:23], v[152:159], v5
    s_waitcnt lgkmcnt(2)
    v_smfmac_f32_16x16x64_bf16 v[72:75], v[24:27], v[44:51], v5
    ds_read_b128 v[44:47], v8 offset:8192
    ds_read_b128 v[48:51], v8 offset:9216
    v_smfmac_f32_16x16x64_bf16 v[64:67], v[24:27], v[160:167], v5
    v_smfmac_f32_16x16x64_bf16 v[64:67], v[28:31], v[168:175], v5
    v_add_f32 v60, v60, v62
    v_smfmac_f32_16x16x64_bf16 v[64:67], v[32:35], v[176:183], v5
    v_add_f32 v61, v61, v63
    s_waitcnt lgkmcnt(2)
    v_smfmac_f32_16x16x64_bf16 v[72:75], v[28:31], v[52:59], v5
    ds_read_b128 v[52:55], v8 offset:10240
    ds_read_b128 v[56:59], v8 offset:11264
    v_smfmac_f32_16x16x64_bf16 v[64:67], v[36:39], v[184:191], v5
    v_cvt_pk_bf16_f32 v104, v60, v61
    v_smfmac_f32_16x16x64_bf16 v[64:67], v[40:43], v[192:199], v5
    v_mov_b32 v60, 0
    v_smfmac_f32_16x16x64_bf16 v[68:71], v[16:19], v[200:207], v5
    v_mov_b32 v61, 0
    s_waitcnt lgkmcnt(2)
    v_smfmac_f32_16x16x64_bf16 v[72:75], v[32:35], v[44:51], v5
    ds_read_b128 v[44:47], v8 offset:12288
    ds_read_b128 v[48:51], v8 offset:13312
    v_smfmac_f32_16x16x64_bf16 v[68:71], v[20:23], v[208:215], v5
    v_mov_b32 v62, 0
    v_smfmac_f32_16x16x64_bf16 v[68:71], v[24:27], v[216:223], v5
    v_mov_b32 v63, 0
    v_smfmac_f32_16x16x64_bf16 v[68:71], v[28:31], v[224:231], v5
    v_add_f32 v64, v64, v66
    s_waitcnt lgkmcnt(2)
    v_smfmac_f32_16x16x64_bf16 v[72:75], v[36:39], v[52:59], v5
    v_smfmac_f32_16x16x64_bf16 v[68:71], v[32:35], v[232:239], v5
    v_add_f32 v65, v65, v67
    v_smfmac_f32_16x16x64_bf16 v[68:71], v[36:39], v[240:247], v5
    v_cvt_pk_bf16_f32 v105, v64, v65
    v_smfmac_f32_16x16x64_bf16 v[68:71], v[40:43], v[248:255], v5
    s_waitcnt lgkmcnt(0)
    v_smfmac_f32_16x16x64_bf16 v[72:75], v[40:43], v[44:51], v5
    s_nop 5
    v_add_f32 v68, v68, v70
    v_add_f32 v69, v69, v71
    v_cvt_pk_bf16_f32 v108, v68, v69
    v_add_f32 v72, v72, v74
    v_add_f32 v73, v73, v75
    v_cvt_pk_bf16_f32 v109, v72, v73
    v_mov_b32 v106, v108
    v_mov_b32 v107, v109
    s_lshl_b32 s8, s82, 12
    s_add_u32 s8, s8, 91635712
    buffer_store_dwordx4 v[104:107], v1, s[44:47], s8 offen sc1
    s_waitcnt vmcnt(0)
    s_barrier
    s_mov_b32 s8, 95072128
    s_mov_b64 exec, 1
    v_mov_b32 v2, 1
    buffer_atomic_add v2, off, s[44:47], s8 sc1
    s_mov_b64 exec, -1
    s_endpgm
ch0bf_mp1:
    buffer_load_dwordx4 v[20:23], v1, s[44:47], s65 offen offset:1024 sc1
    s_add_u32 s83, s83, 1
    s_cmp_ge_u32 s83, 2000000
    s_cbranch_scc1 chain_abort
    s_waitcnt vmcnt(1)
    v_max3_u32 v2, v20, v21, v22
    v_max_u32 v2, v2, v23
    v_cmp_eq_u32 vcc, -1, v2
    s_cbranch_vccnz ch0bf_mp1
    s_branch ch0bf_mok
ch0bf_m0bad:
    s_cbranch_vccnz ch0bf_mp
ch0bf_mp0:
    buffer_load_dwordx4 v[16:19], v1, s[44:47], s65 offen offset:0 sc1
    s_add_u32 s83, s83, 1
    s_cmp_ge_u32 s83, 2000000
    s_cbranch_scc1 chain_abort
    s_waitcnt vmcnt(1)
    v_max3_u32 v2, v16, v17, v18
    v_max_u32 v2, v2, v19
    v_cmp_eq_u32 vcc, -1, v2
    s_cbranch_vccnz ch0bf_mp0
    s_branch ch0bf_mok
ch0bf_hl:
    buffer_load_dword v15, off, s[44:47], s73 sc1
    s_branch ch0bf_hs
ch0bf_hu:
    v_readfirstlane_b32 s9, v15
    s_max_u32 s100, s100, s9
    s_branch ch0bf_hv
ch0bf_nw:
    v_lshlrev_b32 v100, 7, v0
    s_mov_b32 s99, 0
hz_164:
    buffer_load_dword v101, v100, s[44:47], s75 offen sc1
    s_waitcnt vmcnt(0)
    v_cmp_gt_u32 vcc, 28, v101
    s_ff1_i32_b64 s100, vcc
    s_cmp_eq_u32 s100, -1
    s_cselect_b32 s100, 65, s100
    s_sub_u32 s100, s100, 1
    s_cmp_gt_i32 s100, s64
    s_cbranch_scc1 hd_165
    s_sleep 1
    s_add_u32 s99, s99, 1
    s_cmp_lt_u32 s99, 400000
    s_cbranch_scc1 hz_164
    s_branch chain_abort
hd_165:
    s_branch ch0bf_nw2
ch0bf_k0:
    s_cmp_eq_u32 s98, 1
    s_cbranch_scc1 ch0bf_w2d
    s_cmp_ge_u32 s64, s100
    s_cbranch_scc1 ch0bf_vw
ch0bf_vok:
    s_mov_b32 m0, 16384
    s_waitcnt lgkmcnt(0)
    buffer_load_dwordx4 v1, s[44:47], s71 offen offset:0 sc1 lds
    buffer_load_dwordx4 v1, s[44:47], s71 offen offset:1024 sc1 lds
    s_branch ch0bf_w2d
ch0bf_i0:
    buffer_load_dwordx4 v[76:79], v1, s[44:47], s67 offen offset:0 sc1
    buffer_load_dwordx4 v[84:87], v1, s[44:47], s67 offen offset:2048 sc1
    s_add_u32 s83, s83, 1
    s_branch ch0bf_q120
ch0bf_i1:
    buffer_load_dwordx4 v[80:83], v1, s[44:47], s67 offen offset:1024 sc1
    buffer_load_dwordx4 v[88:91], v1, s[44:47], s67 offen offset:3072 sc1
    s_add_u32 s83, s83, 1
    s_branch ch0bf_q21
ch0bf_i2:
    buffer_load_dwordx4 v[92:95], v10, s[44:47], s67 offen offset:0 sc1
    s_add_u32 s83, s83, 1
    s_branch ch0bf_q2
ch0bf_q0:
    s_waitcnt vmcnt(0)
    v_fma_mix_f32 v102, v76, 1.0, v84 op_sel:[0,0,0] op_sel_hi:[1,0,1]
    v_fma_mix_f32 v84, v76, 1.0, v84 op_sel:[1,0,1] op_sel_hi:[1,0,1]
    v_fma_mix_f32 v76, v77, 1.0, v85 op_sel:[0,0,0] op_sel_hi:[1,0,1]
    v_fma_mix_f32 v85, v77, 1.0, v85 op_sel:[1,0,1] op_sel_hi:[1,0,1]
    v_fma_mix_f32 v77, v78, 1.0, v86 op_sel:[0,0,0] op_sel_hi:[1,0,1]
    v_fma_mix_f32 v86, v78, 1.0, v86 op_sel:[1,0,1] op_sel_hi:[1,0,1]
    v_fma_mix_f32 v78, v79, 1.0, v87 op_sel:[0,0,0] op_sel_hi:[1,0,1]
    v_fma_mix_f32 v87, v79, 1.0, v87 op_sel:[1,0,1] op_sel_hi:[1,0,1]
    v_maximum3_f32 v112, v84, v85, v86
    v_cmp_u_f32 vcc, v112, v87
    v_exp_f32 v76, v76
    v_exp_f32 v77, v77
    v_exp_f32 v78, v78
    s_cbranch_vccnz ch0bf_q0_e
    v_exp_f32 v79, v102
    v_exp_f32 v84, v84
    v_exp_f32 v85, v85
    v_pk_add_f32 v[96:97], v[76:77], v[78:79]
    v_exp_f32 v86, v86
    v_exp_f32 v87, v87
    v_pk_add_f32 v[96:97], v[96:97], v[84:85]
    v_pk_add_f32 v[96:97], v[96:97], v[86:87]
    s_branch ch0bf_k0
ch0bf_q0_e:
    buffer_load_dwordx4 v[76:79], v1, s[44:47], s67 offen offset:0 sc1
    buffer_load_dwordx4 v[84:87], v1, s[44:47], s67 offen offset:2048 sc1
    s_add_u32 s83, s83, 1
    s_and_b32 s8, s83, 63
    s_cmp_eq_u32 s8, 0
    s_cbranch_scc1 ch0bf_x
    s_branch ch0bf_q0
ch0bf_q1:
    s_waitcnt vmcnt(0)
    v_fma_mix_f32 v103, v80, 1.0, v88 op_sel:[0,0,0] op_sel_hi:[1,0,1]
    v_fma_mix_f32 v88, v80, 1.0, v88 op_sel:[1,0,1] op_sel_hi:[1,0,1]
    v_fma_mix_f32 v80, v81, 1.0, v89 op_sel:[0,0,0] op_sel_hi:[1,0,1]
    v_fma_mix_f32 v89, v81, 1.0, v89 op_sel:[1,0,1] op_sel_hi:[1,0,1]
    v_fma_mix_f32 v81, v82, 1.0, v90 op_sel:[0,0,0] op_sel_hi:[1,0,1]
    v_fma_mix_f32 v90, v82, 1.0, v90 op_sel:[1,0,1] op_sel_hi:[1,0,1]
    v_fma_mix_f32 v82, v83, 1.0, v91 op_sel:[0,0,0] op_sel_hi:[1,0,1]
    v_fma_mix_f32 v91, v83, 1.0, v91 op_sel:[1,0,1] op_sel_hi:[1,0,1]
    v_maximum3_f32 v114, v88, v89, v90
    v_cmp_u_f32 vcc, v114, v91
    v_exp_f32 v80, v80
    v_exp_f32 v81, v81
    v_exp_f32 v82, v82
    s_cbranch_vccnz ch0bf_q1_e
    v_exp_f32 v83, v103
    v_exp_f32 v88, v88
    v_exp_f32 v89, v89
    v_pk_add_f32 v[98:99], v[80:81], v[82:83]
    v_exp_f32 v90, v90
    v_exp_f32 v91, v91
    v_pk_add_f32 v[98:99], v[98:99], v[88:89]
    v_pk_add_f32 v[98:99], v[98:99], v[90:91]
    s_branch ch0bf_k0
ch0bf_q1_e:
    buffer_load_dwordx4 v[80:83], v1, s[44:47], s67 offen offset:1024 sc1
    buffer_load_dwordx4 v[88:91], v1, s[44:47], s67 offen offset:3072 sc1
    s_add_u32 s83, s83, 1
    s_and_b32 s8, s83, 63
    s_cmp_eq_u32 s8, 0
    s_cbranch_scc1 ch0bf_x
    s_branch ch0bf_q1
ch0bf_q2:
    s_waitcnt vmcnt(0)
    v_fma_mix_f32 v113, v92, 1.0, v94 op_sel:[0,0,0] op_sel_hi:[1,0,1]
    v_fma_mix_f32 v94, v92, 1.0, v94 op_sel:[1,0,1] op_sel_hi:[1,0,1]
    v_fma_mix_f32 v92, v93, 1.0, v95 op_sel:[0,0,0] op_sel_hi:[1,0,1]
    v_fma_mix_f32 v95, v93, 1.0, v95 op_sel:[1,0,1] op_sel_hi:[1,0,1]
    v_cmp_u_f32 vcc, v94, v95
    v_exp_f32 v92, v92
    v_exp_f32 v93, v113
    v_exp_f32 v94, v94
    s_cbranch_vccnz ch0bf_q2_e
    v_exp_f32 v95, v95
    s_nop 0
    v_pk_add_f32 v[100:101], v[92:93], v[94:95]
    s_branch ch0bf_k0
ch0bf_q2_e:
    buffer_load_dwordx4 v[92:95], v10, s[44:47], s67 offen offset:0 sc1
    s_add_u32 s83, s83, 1
    s_and_b32 s8, s83, 63
    s_cmp_eq_u32 s8, 0
    s_cbranch_scc1 ch0bf_x
    s_branch ch0bf_q2
ch0bf_q01:
    s_waitcnt vmcnt(2)
    v_fma_mix_f32 v102, v76, 1.0, v84 op_sel:[0,0,0] op_sel_hi:[1,0,1]
    v_fma_mix_f32 v84, v76, 1.0, v84 op_sel:[1,0,1] op_sel_hi:[1,0,1]
    v_fma_mix_f32 v76, v77, 1.0, v85 op_sel:[0,0,0] op_sel_hi:[1,0,1]
    v_fma_mix_f32 v85, v77, 1.0, v85 op_sel:[1,0,1] op_sel_hi:[1,0,1]
    v_fma_mix_f32 v77, v78, 1.0, v86 op_sel:[0,0,0] op_sel_hi:[1,0,1]
    v_fma_mix_f32 v86, v78, 1.0, v86 op_sel:[1,0,1] op_sel_hi:[1,0,1]
    v_fma_mix_f32 v78, v79, 1.0, v87 op_sel:[0,0,0] op_sel_hi:[1,0,1]
    v_fma_mix_f32 v87, v79, 1.0, v87 op_sel:[1,0,1] op_sel_hi:[1,0,1]
    v_maximum3_f32 v112, v84, v85, v86
    v_cmp_u_f32 vcc, v112, v87
    v_exp_f32 v76, v76
    v_exp_f32 v77, v77
    v_exp_f32 v78, v78
    s_cbranch_vccnz ch0bf_q01_e
    v_exp_f32 v79, v102
    v_exp_f32 v84, v84
    v_exp_f32 v85, v85
    v_pk_add_f32 v[96:97], v[76:77], v[78:79]
    v_exp_f32 v86, v86
    v_exp_f32 v87, v87
    v_pk_add_f32 v[96:97], v[96:97], v[84:85]
    v_pk_add_f32 v[96:97], v[96:97], v[86:87]
    s_branch ch0bf_q1
ch0bf_q01_e:
    buffer_load_dwordx4 v[76:79], v1, s[44:47], s67 offen offset:0 sc1
    buffer_load_dwordx4 v[84:87], v1, s[44:47], s67 offen offset:2048 sc1
    s_add_u32 s83, s83, 1
    s_and_b32 s8, s83, 63
    s_cmp_eq_u32 s8, 0
    s_cbranch_scc1 ch0bf_x
    s_branch ch0bf_q10
ch0bf_q02:
    s_waitcnt vmcnt(1)
    v_fma_mix_f32 v102, v76, 1.0, v84 op_sel:[0,0,0] op_sel_hi:[1,0,1]
    v_fma_mix_f32 v84, v76, 1.0, v84 op_sel:[1,0,1] op_sel_hi:[1,0,1]
    v_fma_mix_f32 v76, v77, 1.0, v85 op_sel:[0,0,0] op_sel_hi:[1,0,1]
    v_fma_mix_f32 v85, v77, 1.0, v85 op_sel:[1,0,1] op_sel_hi:[1,0,1]
    v_fma_mix_f32 v77, v78, 1.0, v86 op_sel:[0,0,0] op_sel_hi:[1,0,1]
    v_fma_mix_f32 v86, v78, 1.0, v86 op_sel:[1,0,1] op_sel_hi:[1,0,1]
    v_fma_mix_f32 v78, v79, 1.0, v87 op_sel:[0,0,0] op_sel_hi:[1,0,1]
    v_fma_mix_f32 v87, v79, 1.0, v87 op_sel:[1,0,1] op_sel_hi:[1,0,1]
    v_maximum3_f32 v112, v84, v85, v86
    v_cmp_u_f32 vcc, v112, v87
    v_exp_f32 v76, v76
    v_exp_f32 v77, v77
    v_exp_f32 v78, v78
    s_cbranch_vccnz ch0bf_q02_e
    v_exp_f32 v79, v102
    v_exp_f32 v84, v84
    v_exp_f32 v85, v85
    v_pk_add_f32 v[96:97], v[76:77], v[78:79]
    v_exp_f32 v86, v86
    v_exp_f32 v87, v87
    v_pk_add_f32 v[96:97], v[96:97], v[84:85]
    v_pk_add_f32 v[96:97], v[96:97], v[86:87]
    s_branch ch0bf_q2
ch0bf_q02_e:
    buffer_load_dwordx4 v[76:79], v1, s[44:47], s67 offen offset:0 sc1
    buffer_load_dwordx4 v[84:87], v1, s[44:47], s67 offen offset:2048 sc1
    s_add_u32 s83, s83, 1
    s_and_b32 s8, s83, 63
    s_cmp_eq_u32 s8, 0
    s_cbranch_scc1 ch0bf_x
    s_branch ch0bf_q20
ch0bf_q10:
    s_waitcnt vmcnt(2)
    v_fma_mix_f32 v103, v80, 1.0, v88 op_sel:[0,0,0] op_sel_hi:[1,0,1]
    v_fma_mix_f32 v88, v80, 1.0, v88 op_sel:[1,0,1] op_sel_hi:[1,0,1]
    v_fma_mix_f32 v80, v81, 1.0, v89 op_sel:[0,0,0] op_sel_hi:[1,0,1]
    v_fma_mix_f32 v89, v81, 1.0, v89 op_sel:[1,0,1] op_sel_hi:[1,0,1]
    v_fma_mix_f32 v81, v82, 1.0, v90 op_sel:[0,0,0] op_sel_hi:[1,0,1]
    v_fma_mix_f32 v90, v82, 1.0, v90 op_sel:[1,0,1] op_sel_hi:[1,0,1]
    v_fma_mix_f32 v82, v83, 1.0, v91 op_sel:[0,0,0] op_sel_hi:[1,0,1]
    v_fma_mix_f32 v91, v83, 1.0, v91 op_sel:[1,0,1] op_sel_hi:[1,0,1]
    v_maximum3_f32 v114, v88, v89, v90
    v_cmp_u_f32 vcc, v114, v91
    v_exp_f32 v80, v80
    v_exp_f32 v81, v81
    v_exp_f32 v82, v82
    s_cbranch_vccnz ch0bf_q10_e
    v_exp_f32 v83, v103
    v_exp_f32 v88, v88
    v_exp_f32 v89, v89
    v_pk_add_f32 v[98:99], v[80:81], v[82:83]
    v_exp_f32 v90, v90
    v_exp_f32 v91, v91
    v_pk_add_f32 v[98:99], v[98:99], v[88:89]
    v_pk_add_f32 v[98:99], v[98:99], v[90:91]
    s_branch ch0bf_q0
ch0bf_q10_e:
    buffer_load_dwordx4 v[80:83], v1, s[44:47], s67 offen offset:1024 sc1
    buffer_load_dwordx4 v[88:91], v1, s[44:47], s67 offen offset:3072 sc1
    s_add_u32 s83, s83, 1
    s_and_b32 s8, s83, 63
    s_cmp_eq_u32 s8, 0
    s_cbranch_scc1 ch0bf_x
    s_branch ch0bf_q01
ch0bf_q12:
    s_waitcnt vmcnt(1)
    v_fma_mix_f32 v103, v80, 1.0, v88 op_sel:[0,0,0] op_sel_hi:[1,0,1]
    v_fma_mix_f32 v88, v80, 1.0, v88 op_sel:[1,0,1] op_sel_hi:[1,0,1]
    v_fma_mix_f32 v80, v81, 1.0, v89 op_sel:[0,0,0] op_sel_hi:[1,0,1]
    v_fma_mix_f32 v89, v81, 1.0, v89 op_sel:[1,0,1] op_sel_hi:[1,0,1]
    v_fma_mix_f32 v81, v82, 1.0, v90 op_sel:[0,0,0] op_sel_hi:[1,0,1]
    v_fma_mix_f32 v90, v82, 1.0, v90 op_sel:[1,0,1] op_sel_hi:[1,0,1]
    v_fma_mix_f32 v82, v83, 1.0, v91 op_sel:[0,0,0] op_sel_hi:[1,0,1]
    v_fma_mix_f32 v91, v83, 1.0, v91 op_sel:[1,0,1] op_sel_hi:[1,0,1]
    v_maximum3_f32 v114, v88, v89, v90
    v_cmp_u_f32 vcc, v114, v91
    v_exp_f32 v80, v80
    v_exp_f32 v81, v81
    v_exp_f32 v82, v82
    s_cbranch_vccnz ch0bf_q12_e
    v_exp_f32 v83, v103
    v_exp_f32 v88, v88
    v_exp_f32 v89, v89
    v_pk_add_f32 v[98:99], v[80:81], v[82:83]
    v_exp_f32 v90, v90
    v_exp_f32 v91, v91
    v_pk_add_f32 v[98:99], v[98:99], v[88:89]
    v_pk_add_f32 v[98:99], v[98:99], v[90:91]
    s_branch ch0bf_q2
ch0bf_q12_e:
    buffer_load_dwordx4 v[80:83], v1, s[44:47], s67 offen offset:1024 sc1
    buffer_load_dwordx4 v[88:91], v1, s[44:47], s67 offen offset:3072 sc1
    s_add_u32 s83, s83, 1
    s_and_b32 s8, s83, 63
    s_cmp_eq_u32 s8, 0
    s_cbranch_scc1 ch0bf_x
    s_branch ch0bf_q21
ch0bf_q20:
    s_waitcnt vmcnt(2)
    v_fma_mix_f32 v113, v92, 1.0, v94 op_sel:[0,0,0] op_sel_hi:[1,0,1]
    v_fma_mix_f32 v94, v92, 1.0, v94 op_sel:[1,0,1] op_sel_hi:[1,0,1]
    v_fma_mix_f32 v92, v93, 1.0, v95 op_sel:[0,0,0] op_sel_hi:[1,0,1]
    v_fma_mix_f32 v95, v93, 1.0, v95 op_sel:[1,0,1] op_sel_hi:[1,0,1]
    v_cmp_u_f32 vcc, v94, v95
    v_exp_f32 v92, v92
    v_exp_f32 v93, v113
    v_exp_f32 v94, v94
    s_cbranch_vccnz ch0bf_q20_e
    v_exp_f32 v95, v95
    s_nop 0
    v_pk_add_f32 v[100:101], v[92:93], v[94:95]
    s_branch ch0bf_q0
ch0bf_q20_e:
    buffer_load_dwordx4 v[92:95], v10, s[44:47], s67 offen offset:0 sc1
    s_add_u32 s83, s83, 1
    s_and_b32 s8, s83, 63
    s_cmp_eq_u32 s8, 0
    s_cbranch_scc1 ch0bf_x
    s_branch ch0bf_q02
ch0bf_q21:
    s_waitcnt vmcnt(2)
    v_fma_mix_f32 v113, v92, 1.0, v94 op_sel:[0,0,0] op_sel_hi:[1,0,1]
    v_fma_mix_f32 v94, v92, 1.0, v94 op_sel:[1,0,1] op_sel_hi:[1,0,1]
    v_fma_mix_f32 v92, v93, 1.0, v95 op_sel:[0,0,0] op_sel_hi:[1,0,1]
    v_fma_mix_f32 v95, v93, 1.0, v95 op_sel:[1,0,1] op_sel_hi:[1,0,1]
    v_cmp_u_f32 vcc, v94, v95
    v_exp_f32 v92, v92
    v_exp_f32 v93, v113
    v_exp_f32 v94, v94
    s_cbranch_vccnz ch0bf_q21_e
    v_exp_f32 v95, v95
    s_nop 0
    v_pk_add_f32 v[100:101], v[92:93], v[94:95]
    s_branch ch0bf_q1
ch0bf_q21_e:
    buffer_load_dwordx4 v[92:95], v10, s[44:47], s67 offen offset:0 sc1
    s_add_u32 s83, s83, 1
    s_and_b32 s8, s83, 63
    s_cmp_eq_u32 s8, 0
    s_cbranch_scc1 ch0bf_x
    s_branch ch0bf_q12
ch0bf_q012:
    s_waitcnt vmcnt(3)
    v_fma_mix_f32 v102, v76, 1.0, v84 op_sel:[0,0,0] op_sel_hi:[1,0,1]
    v_fma_mix_f32 v84, v76, 1.0, v84 op_sel:[1,0,1] op_sel_hi:[1,0,1]
    v_fma_mix_f32 v76, v77, 1.0, v85 op_sel:[0,0,0] op_sel_hi:[1,0,1]
    v_fma_mix_f32 v85, v77, 1.0, v85 op_sel:[1,0,1] op_sel_hi:[1,0,1]
    v_fma_mix_f32 v77, v78, 1.0, v86 op_sel:[0,0,0] op_sel_hi:[1,0,1]
    v_fma_mix_f32 v86, v78, 1.0, v86 op_sel:[1,0,1] op_sel_hi:[1,0,1]
    v_fma_mix_f32 v78, v79, 1.0, v87 op_sel:[0,0,0] op_sel_hi:[1,0,1]
    v_fma_mix_f32 v87, v79, 1.0, v87 op_sel:[1,0,1] op_sel_hi:[1,0,1]
    v_maximum3_f32 v112, v84, v85, v86
    v_cmp_u_f32 vcc, v112, v87
    v_exp_f32 v76, v76
    v_exp_f32 v77, v77
    v_exp_f32 v78, v78
    s_cbranch_vccnz ch0bf_q012_e
    v_exp_f32 v79, v102
    v_exp_f32 v84, v84
    v_exp_f32 v85, v85
    v_pk_add_f32 v[96:97], v[76:77], v[78:79]
    v_exp_f32 v86, v86
    v_exp_f32 v87, v87
    v_pk_add_f32 v[96:97], v[96:97], v[84:85]
    v_pk_add_f32 v[96:97], v[96:97], v[86:87]
    s_branch ch0bf_q12
ch0bf_q012_e:
    buffer_load_dwordx4 v[76:79], v1, s[44:47], s67 offen offset:0 sc1
    buffer_load_dwordx4 v[84:87], v1, s[44:47], s67 offen offset:2048 sc1
    s_add_u32 s83, s83, 1
    s_and_b32 s8, s83, 63
    s_cmp_eq_u32 s8, 0
    s_cbranch_scc1 ch0bf_x
    s_branch ch0bf_q120
ch0bf_q021:
    s_waitcnt vmcnt(3)
    v_fma_mix_f32 v102, v76, 1.0, v84 op_sel:[0,0,0] op_sel_hi:[1,0,1]
    v_fma_mix_f32 v84, v76, 1.0, v84 op_sel:[1,0,1] op_sel_hi:[1,0,1]
    v_fma_mix_f32 v76, v77, 1.0, v85 op_sel:[0,0,0] op_sel_hi:[1,0,1]
    v_fma_mix_f32 v85, v77, 1.0, v85 op_sel:[1,0,1] op_sel_hi:[1,0,1]
    v_fma_mix_f32 v77, v78, 1.0, v86 op_sel:[0,0,0] op_sel_hi:[1,0,1]
    v_fma_mix_f32 v86, v78, 1.0, v86 op_sel:[1,0,1] op_sel_hi:[1,0,1]
    v_fma_mix_f32 v78, v79, 1.0, v87 op_sel:[0,0,0] op_sel_hi:[1,0,1]
    v_fma_mix_f32 v87, v79, 1.0, v87 op_sel:[1,0,1] op_sel_hi:[1,0,1]
    v_maximum3_f32 v112, v84, v85, v86
    v_cmp_u_f32 vcc, v112, v87
    v_exp_f32 v76, v76
    v_exp_f32 v77, v77
    v_exp_f32 v78, v78
    s_cbranch_vccnz ch0bf_q021_e
    v_exp_f32 v79, v102
    v_exp_f32 v84, v84
    v_exp_f32 v85, v85
    v_pk_add_f32 v[96:97], v[76:77], v[78:79]
    v_exp_f32 v86, v86
    v_exp_f32 v87, v87
    v_pk_add_f32 v[96:97], v[96:97], v[84:85]
    v_pk_add_f32 v[96:97], v[96:97], v[86:87]
    s_branch ch0bf_q21
ch0bf_q021_e:
    buffer_load_dwordx4 v[76:79], v1, s[44:47], s67 offen offset:0 sc1
    buffer_load_dwordx4 v[84:87], v1, s[44:47], s67 offen offset:2048 sc1
    s_add_u32 s83, s83, 1
    s_and_b32 s8, s83, 63
    s_cmp_eq_u32 s8, 0
    s_cbranch_scc1 ch0bf_x
    s_branch ch0bf_q210
ch0bf_q102:
    s_waitcnt vmcnt(3)
    v_fma_mix_f32 v103, v80, 1.0, v88 op_sel:[0,0,0] op_sel_hi:[1,0,1]
    v_fma_mix_f32 v88, v80, 1.0, v88 op_sel:[1,0,1] op_sel_hi:[1,0,1]
    v_fma_mix_f32 v80, v81, 1.0, v89 op_sel:[0,0,0] op_sel_hi:[1,0,1]
    v_fma_mix_f32 v89, v81, 1.0, v89 op_sel:[1,0,1] op_sel_hi:[1,0,1]
    v_fma_mix_f32 v81, v82, 1.0, v90 op_sel:[0,0,0] op_sel_hi:[1,0,1]
    v_fma_mix_f32 v90, v82, 1.0, v90 op_sel:[1,0,1] op_sel_hi:[1,0,1]
    v_fma_mix_f32 v82, v83, 1.0, v91 op_sel:[0,0,0] op_sel_hi:[1,0,1]
    v_fma_mix_f32 v91, v83, 1.0, v91 op_sel:[1,0,1] op_sel_hi:[1,0,1]
    v_maximum3_f32 v114, v88, v89, v90
    v_cmp_u_f32 vcc, v114, v91
    v_exp_f32 v80, v80
    v_exp_f32 v81, v81
    v_exp_f32 v82, v82
    s_cbranch_vccnz ch0bf_q102_e
    v_exp_f32 v83, v103
    v_exp_f32 v88, v88
    v_exp_f32 v89, v89
    v_pk_add_f32 v[98:99], v[80:81], v[82:83]
    v_exp_f32 v90, v90
    v_exp_f32 v91, v91
    v_pk_add_f32 v[98:99], v[98:99], v[88:89]
    v_pk_add_f32 v[98:99], v[98:99], v[90:91]
    s_branch ch0bf_q02
ch0bf_q102_e:
    buffer_load_dwordx4 v[80:83], v1, s[44:47], s67 offen offset:1024 sc1
    buffer_load_dwordx4 v[88:91], v1, s[44:47], s67 offen offset:3072 sc1
    s_add_u32 s83, s83, 1
    s_and_b32 s8, s83, 63
    s_cmp_eq_u32 s8, 0
    s_cbranch_scc1 ch0bf_x
    s_branch ch0bf_q021
ch0bf_q120:
    s_waitcnt vmcnt(3)
    v_fma_mix_f32 v103, v80, 1.0, v88 op_sel:[0,0,0] op_sel_hi:[1,0,1]
    v_fma_mix_f32 v88, v80, 1.0, v88 op_sel:[1,0,1] op_sel_hi:[1,0,1]
    v_fma_mix_f32 v80, v81, 1.0, v89 op_sel:[0,0,0] op_sel_hi:[1,0,1]
    v_fma_mix_f32 v89, v81, 1.0, v89 op_sel:[1,0,1] op_sel_hi:[1,0,1]
    v_fma_mix_f32 v81, v82, 1.0, v90 op_sel:[0,0,0] op_sel_hi:[1,0,1]
    v_fma_mix_f32 v90, v82, 1.0, v90 op_sel:[1,0,1] op_sel_hi:[1,0,1]
    v_fma_mix_f32 v82, v83, 1.0, v91 op_sel:[0,0,0] op_sel_hi:[1,0,1]
    v_fma_mix_f32 v91, v83, 1.0, v91 op_sel:[1,0,1] op_sel_hi:[1,0,1]
    v_maximum3_f32 v114, v88, v89, v90
    v_cmp_u_f32 vcc, v114, v91
    v_exp_f32 v80, v80
    v_exp_f32 v81, v81
    v_exp_f32 v82, v82
    s_cbranch_vccnz ch0bf_q120_e
    v_exp_f32 v83, v103
    v_exp_f32 v88, v88
    v_exp_f32 v89, v89
    v_pk_add_f32 v[98:99], v[80:81], v[82:83]
    v_exp_f32 v90, v90
    v_exp_f32 v91, v91
    v_pk_add_f32 v[98:99], v[98:99], v[88:89]
    v_pk_add_f32 v[98:99], v[98:99], v[90:91]
    s_branch ch0bf_q20
ch0bf_q120_e:
    buffer_load_dwordx4 v[80:83], v1, s[44:47], s67 offen offset:1024 sc1
    buffer_load_dwordx4 v[88:91], v1, s[44:47], s67 offen offset:3072 sc1
    s_add_u32 s83, s83, 1
    s_and_b32 s8, s83, 63
    s_cmp_eq_u32 s8, 0
    s_cbranch_scc1 ch0bf_x
    s_branch ch0bf_q201
ch0bf_q201:
    s_waitcnt vmcnt(4)
    v_fma_mix_f32 v113, v92, 1.0, v94 op_sel:[0,0,0] op_sel_hi:[1,0,1]
    v_fma_mix_f32 v94, v92, 1.0, v94 op_sel:[1,0,1] op_sel_hi:[1,0,1]
    v_fma_mix_f32 v92, v93, 1.0, v95 op_sel:[0,0,0] op_sel_hi:[1,0,1]
    v_fma_mix_f32 v95, v93, 1.0, v95 op_sel:[1,0,1] op_sel_hi:[1,0,1]
    v_cmp_u_f32 vcc, v94, v95
    v_exp_f32 v92, v92
    v_exp_f32 v93, v113
    v_exp_f32 v94, v94
    s_cbranch_vccnz ch0bf_q201_e
    v_exp_f32 v95, v95
    s_nop 0
    v_pk_add_f32 v[100:101], v[92:93], v[94:95]
    s_branch ch0bf_q01
ch0bf_q201_e:
    buffer_load_dwordx4 v[92:95], v10, s[44:47], s67 offen offset:0 sc1
    s_add_u32 s83, s83, 1
    s_and_b32 s8, s83, 63
    s_cmp_eq_u32 s8, 0
    s_cbranch_scc1 ch0bf_x
    s_branch ch0bf_q012
ch0bf_q210:
    s_waitcnt vmcnt(4)
    v_fma_mix_f32 v113, v92, 1.0, v94 op_sel:[0,0,0] op_sel_hi:[1,0,1]
    v_fma_mix_f32 v94, v92, 1.0, v94 op_sel:[1,0,1] op_sel_hi:[1,0,1]
    v_fma_mix_f32 v92, v93, 1.0, v95 op_sel:[0,0,0] op_sel_hi:[1,0,1]
    v_fma_mix_f32 v95, v93, 1.0, v95 op_sel:[1,0,1] op_sel_hi:[1,0,1]
    v_cmp_u_f32 vcc, v94, v95
    v_exp_f32 v92, v92
    v_exp_f32 v93, v113
    v_exp_f32 v94, v94
    s_cbranch_vccnz ch0bf_q210_e
    v_exp_f32 v95, v95
    v_pk_add_f32 v[100:101], v[92:93], v[94:95]
    s_branch ch0bf_q10
ch0bf_q210_e:
    buffer_load_dwordx4 v[92:95], v10, s[44:47], s67 offen offset:0 sc1
    s_add_u32 s83, s83, 1
    s_and_b32 s8, s83, 63
    s_cmp_eq_u32 s8, 0
    s_cbranch_scc1 ch0bf_x
    s_branch ch0bf_q102
ch0bf_fb:
    buffer_load_dwordx4 v[76:79], v1, s[44:47], s67 offen offset:0 sc1
    buffer_load_dwordx4 v[84:87], v1, s[44:47], s67 offen offset:2048 sc1
    buffer_load_dwordx4 v[80:83], v1, s[44:47], s67 offen offset:1024 sc1
    buffer_load_dwordx4 v[88:91], v1, s[44:47], s67 offen offset:3072 sc1
    buffer_load_dwordx4 v[92:95], v10, s[44:47], s67 offen offset:0 sc1
    s_waitcnt vmcnt(0)
    v_fma_mix_f32 v102, v76, 1.0, v84 op_sel:[0,0,0] op_sel_hi:[1,0,1]
    v_fma_mix_f32 v84, v76, 1.0, v84 op_sel:[1,0,1] op_sel_hi:[1,0,1]
    v_fma_mix_f32 v76, v77, 1.0, v85 op_sel:[0,0,0] op_sel_hi:[1,0,1]
    v_fma_mix_f32 v85, v77, 1.0, v85 op_sel:[1,0,1] op_sel_hi:[1,0,1]
    v_fma_mix_f32 v77, v78, 1.0, v86 op_sel:[0,0,0] op_sel_hi:[1,0,1]
    v_fma_mix_f32 v86, v78, 1.0, v86 op_sel:[1,0,1] op_sel_hi:[1,0,1]
    v_fma_mix_f32 v78, v79, 1.0, v87 op_sel:[0,0,0] op_sel_hi:[1,0,1]
    v_fma_mix_f32 v87, v79, 1.0, v87 op_sel:[1,0,1] op_sel_hi:[1,0,1]
    v_maximum3_f32 v112, v102, v84, v76
    v_maximum3_f32 v112, v112, v85, v77
    v_maximum3_f32 v112, v112, v86, v78
    v_maximum3_f32 v112, v112, v87, v87
    v_cmp_u_f32 vcc, v112, v112
    v_mov_b32 v79, v102
    v_pk_add_f32 v[76:77], v[76:77], v[112:113] op_sel_hi:[1,0] neg_lo:[0,1] neg_hi:[0,1]
    v_pk_add_f32 v[78:79], v[78:79], v[112:113] op_sel_hi:[1,0] neg_lo:[0,1] neg_hi:[0,1]
    v_pk_add_f32 v[84:85], v[84:85], v[112:113] op_sel_hi:[1,0] neg_lo:[0,1] neg_hi:[0,1]
    v_pk_add_f32 v[86:87], v[86:87], v[112:113] op_sel_hi:[1,0] neg_lo:[0,1] neg_hi:[0,1]
    v_exp_f32 v76, v76
    v_exp_f32 v77, v77
    v_exp_f32 v78, v78
    v_exp_f32 v79, v79
    v_exp_f32 v84, v84
    v_exp_f32 v85, v85
    v_pk_add_f32 v[96:97], v[76:77], v[78:79]
    v_exp_f32 v86, v86
    v_exp_f32 v87, v87
    v_pk_add_f32 v[96:97], v[96:97], v[84:85]
    v_pk_add_f32 v[96:97], v[96:97], v[86:87]
    v_fma_mix_f32 v103, v80, 1.0, v88 op_sel:[0,0,0] op_sel_hi:[1,0,1]
    v_fma_mix_f32 v88, v80, 1.0, v88 op_sel:[1,0,1] op_sel_hi:[1,0,1]
    v_fma_mix_f32 v80, v81, 1.0, v89 op_sel:[0,0,0] op_sel_hi:[1,0,1]
    v_fma_mix_f32 v89, v81, 1.0, v89 op_sel:[1,0,1] op_sel_hi:[1,0,1]
    v_fma_mix_f32 v81, v82, 1.0, v90 op_sel:[0,0,0] op_sel_hi:[1,0,1]
    v_fma_mix_f32 v90, v82, 1.0, v90 op_sel:[1,0,1] op_sel_hi:[1,0,1]
    v_fma_mix_f32 v82, v83, 1.0, v91 op_sel:[0,0,0] op_sel_hi:[1,0,1]
    v_fma_mix_f32 v91, v83, 1.0, v91 op_sel:[1,0,1] op_sel_hi:[1,0,1]
    v_maximum3_f32 v114, v103, v88, v80
    v_maximum3_f32 v114, v114, v89, v81
    v_maximum3_f32 v114, v114, v90, v82
    v_maximum3_f32 v114, v114, v91, v91
    v_cmp_u_f32 vcc, v114, v114
    v_mov_b32 v83, v103
    v_pk_add_f32 v[80:81], v[80:81], v[114:115] op_sel_hi:[1,0] neg_lo:[0,1] neg_hi:[0,1]
    v_pk_add_f32 v[82:83], v[82:83], v[114:115] op_sel_hi:[1,0] neg_lo:[0,1] neg_hi:[0,1]
    v_pk_add_f32 v[88:89], v[88:89], v[114:115] op_sel_hi:[1,0] neg_lo:[0,1] neg_hi:[0,1]
    v_pk_add_f32 v[90:91], v[90:91], v[114:115] op_sel_hi:[1,0] neg_lo:[0,1] neg_hi:[0,1]
    v_exp_f32 v80, v80
    v_exp_f32 v81, v81
    v_exp_f32 v82, v82
    v_exp_f32 v83, v83
    v_exp_f32 v88, v88
    v_exp_f32 v89, v89
    v_pk_add_f32 v[98:99], v[80:81], v[82:83]
    v_exp_f32 v90, v90
    v_exp_f32 v91, v91
    v_pk_add_f32 v[98:99], v[98:99], v[88:89]
    v_pk_add_f32 v[98:99], v[98:99], v[90:91]
    v_fma_mix_f32 v113, v92, 1.0, v94 op_sel:[0,0,0] op_sel_hi:[1,0,1]
    v_fma_mix_f32 v94, v92, 1.0, v94 op_sel:[1,0,1] op_sel_hi:[1,0,1]
    v_fma_mix_f32 v92, v93, 1.0, v95 op_sel:[0,0,0] op_sel_hi:[1,0,1]
    v_fma_mix_f32 v95, v93, 1.0, v95 op_sel:[1,0,1] op_sel_hi:[1,0,1]
    v_maximum3_f32 v116, v113, v94, v92
    v_maximum3_f32 v116, v116, v95, v95
    v_cmp_u_f32 vcc, v116, v116
    v_mov_b32 v93, v113
    v_pk_add_f32 v[92:93], v[92:93], v[116:117] op_sel_hi:[1,0] neg_lo:[0,1] neg_hi:[0,1]
    v_pk_add_f32 v[94:95], v[94:95], v[116:117] op_sel_hi:[1,0] neg_lo:[0,1] neg_hi:[0,1]
    v_exp_f32 v92, v92
    v_exp_f32 v93, v93
    v_exp_f32 v94, v94
    v_exp_f32 v95, v95
    s_nop 0
    v_pk_add_f32 v[100:101], v[92:93], v[94:95]
    v_max3_f32 v2, v112, v114, v116
    v_max3_f32 v15, v112, v114, v116
    v_add_f32 v96, v96, v97
    v_add_f32 v98, v98, v99
    v_add_f32 v100, v100, v101
    v_permlane16_swap_b32 v2, v15
    v_max_f32 v2, v2, v15
    v_sub_f32 v112, v112, v2
    v_sub_f32 v114, v114, v2
    v_sub_f32 v116, v116, v2
    v_exp_f32 v112, v112
    v_exp_f32 v114, v114
    v_exp_f32 v116, v116
    v_mul_f32 v2, v112, v96
    v_fmac_f32 v2, v114, v98
    v_fmac_f32 v2, v116, v100
    v_mov_b32 v15, v2
    s_nop 1
    v_permlane16_swap_b32 v2, v15
    v_add_f32 v2, v2, v15
    v_rcp_f32 v2, v2
    s_nop 0
    v_mul_f32 v116, v116, v2
    v_mul_f32 v112, v112, v2
    v_mul_f32 v114, v114, v2
    s_waitcnt lgkmcnt(0)
    v_pk_mul_f32 v[92:93], v[92:93], v[116:117] op_sel_hi:[1,0]
    v_pk_mul_f32 v[94:95], v[94:95], v[116:117] op_sel_hi:[1,0]
    v_cvt_pk_bf16_f32 v116, v93, v94
    v_cvt_pk_bf16_f32 v118, v92, v95
    v_pk_mul_f32 v[76:77], v[76:77], v[112:113] op_sel_hi:[1,0]
    v_pk_mul_f32 v[78:79], v[78:79], v[112:113] op_sel_hi:[1,0]
    v_pk_mul_f32 v[84:85], v[84:85], v[112:113] op_sel_hi:[1,0]
    v_pk_mul_f32 v[86:87], v[86:87], v[112:113] op_sel_hi:[1,0]
    v_cvt_pk_bf16_f32 v96, v79, v84
    v_cvt_pk_bf16_f32 v97, v76, v85
    v_cvt_pk_bf16_f32 v98, v77, v86
    v_cvt_pk_bf16_f32 v99, v78, v87
    v_pk_mul_f32 v[80:81], v[80:81], v[114:115] op_sel_hi:[1,0]
    v_pk_mul_f32 v[82:83], v[82:83], v[114:115] op_sel_hi:[1,0]
    v_pk_mul_f32 v[88:89], v[88:89], v[114:115] op_sel_hi:[1,0]
    v_pk_mul_f32 v[90:91], v[90:91], v[114:115] op_sel_hi:[1,0]
    v_smfmac_f32_16x16x64_bf16 v[60:63], v[116:119], v[104:111], v5
    v_cvt_pk_bf16_f32 v100, v83, v88
    v_cvt_pk_bf16_f32 v101, v80, v89
    v_smfmac_f32_16x16x64_bf16 v[60:63], v[96:99], v[44:51], v5
    v_cvt_pk_bf16_f32 v102, v81, v90
    v_cvt_pk_bf16_f32 v103, v82, v91
    s_nop 1
    v_smfmac_f32_16x16x64_bf16 v[60:63], v[100:103], v[52:59], v5
    s_branch ch0bf_kj
ch0bf_x:
    s_cmp_ge_u32 s83, 2000000
    s_cbranch_scc1 chain_abort
    buffer_load_dwordx4 v[76:79], v1, s[44:47], s67 offen offset:0 sc1
    buffer_load_dwordx4 v[84:87], v1, s[44:47], s67 offen offset:2048 sc1
    buffer_load_dwordx4 v[80:83], v1, s[44:47], s67 offen offset:1024 sc1
    buffer_load_dwordx4 v[88:91], v1, s[44:47], s67 offen offset:3072 sc1
    buffer_load_dwordx4 v[92:95], v10, s[44:47], s67 offen offset:0 sc1
    s_waitcnt vmcnt(0)
    v_pk_max_u16 v2, v76, v77
    v_pk_max_u16 v2, v2, v78
    v_pk_max_u16 v2, v2, v79
    v_pk_max_u16 v2, v2, v80
    v_pk_max_u16 v2, v2, v81
    v_pk_max_u16 v2, v2, v82
    v_pk_max_u16 v2, v2, v83
    v_pk_max_u16 v2, v2, v84
    v_pk_max_u16 v2, v2, v85
    v_pk_max_u16 v2, v2, v86
    v_pk_max_u16 v2, v2, v87
    v_pk_max_u16 v2, v2, v88
    v_pk_max_u16 v2, v2, v89
    v_pk_max_u16 v2, v2, v90
    v_pk_max_u16 v2, v2, v91
    v_pk_max_u16 v2, v2, v92
    v_pk_max_u16 v2, v2, v93
    v_pk_max_u16 v2, v2, v94
    v_pk_max_u16 v2, v2, v95
    v_lshrrev_b32 v112, 16, v2
    v_and_b32 v2, 0xffff, v2
    v_max_u32 v2, v2, v112
    v_cmp_eq_u32 vcc, 0xffff, v2
    s_cbranch_vccnz ch0bf_q012
    v_fma_mix_f32 v102, v76, 1.0, v84 op_sel:[0,0,0] op_sel_hi:[1,0,1]
    v_fma_mix_f32 v84, v76, 1.0, v84 op_sel:[1,0,1] op_sel_hi:[1,0,1]
    v_fma_mix_f32 v76, v77, 1.0, v85 op_sel:[0,0,0] op_sel_hi:[1,0,1]
    v_fma_mix_f32 v85, v77, 1.0, v85 op_sel:[1,0,1] op_sel_hi:[1,0,1]
    v_fma_mix_f32 v77, v78, 1.0, v86 op_sel:[0,0,0] op_sel_hi:[1,0,1]
    v_fma_mix_f32 v86, v78, 1.0, v86 op_sel:[1,0,1] op_sel_hi:[1,0,1]
    v_fma_mix_f32 v78, v79, 1.0, v87 op_sel:[0,0,0] op_sel_hi:[1,0,1]
    v_fma_mix_f32 v87, v79, 1.0, v87 op_sel:[1,0,1] op_sel_hi:[1,0,1]
    v_exp_f32 v76, v76
    v_exp_f32 v77, v77
    v_exp_f32 v78, v78
    v_exp_f32 v79, v102
    v_exp_f32 v84, v84
    v_exp_f32 v85, v85
    v_pk_add_f32 v[96:97], v[76:77], v[78:79]
    v_exp_f32 v86, v86
    v_exp_f32 v87, v87
    v_pk_add_f32 v[96:97], v[96:97], v[84:85]
    v_pk_add_f32 v[96:97], v[96:97], v[86:87]
    v_fma_mix_f32 v103, v80, 1.0, v88 op_sel:[0,0,0] op_sel_hi:[1,0,1]
    v_fma_mix_f32 v88, v80, 1.0, v88 op_sel:[1,0,1] op_sel_hi:[1,0,1]
    v_fma_mix_f32 v80, v81, 1.0, v89 op_sel:[0,0,0] op_sel_hi:[1,0,1]
    v_fma_mix_f32 v89, v81, 1.0, v89 op_sel:[1,0,1] op_sel_hi:[1,0,1]
    v_fma_mix_f32 v81, v82, 1.0, v90 op_sel:[0,0,0] op_sel_hi:[1,0,1]
    v_fma_mix_f32 v90, v82, 1.0, v90 op_sel:[1,0,1] op_sel_hi:[1,0,1]
    v_fma_mix_f32 v82, v83, 1.0, v91 op_sel:[0,0,0] op_sel_hi:[1,0,1]
    v_fma_mix_f32 v91, v83, 1.0, v91 op_sel:[1,0,1] op_sel_hi:[1,0,1]
    v_exp_f32 v80, v80
    v_exp_f32 v81, v81
    v_exp_f32 v82, v82
    v_exp_f32 v83, v103
    v_exp_f32 v88, v88
    v_exp_f32 v89, v89
    v_pk_add_f32 v[98:99], v[80:81], v[82:83]
    v_exp_f32 v90, v90
    v_exp_f32 v91, v91
    v_pk_add_f32 v[98:99], v[98:99], v[88:89]
    v_pk_add_f32 v[98:99], v[98:99], v[90:91]
    v_fma_mix_f32 v113, v92, 1.0, v94 op_sel:[0,0,0] op_sel_hi:[1,0,1]
    v_fma_mix_f32 v94, v92, 1.0, v94 op_sel:[1,0,1] op_sel_hi:[1,0,1]
    v_fma_mix_f32 v92, v93, 1.0, v95 op_sel:[0,0,0] op_sel_hi:[1,0,1]
    v_fma_mix_f32 v95, v93, 1.0, v95 op_sel:[1,0,1] op_sel_hi:[1,0,1]
    v_exp_f32 v92, v92
    v_exp_f32 v93, v113
    v_exp_f32 v94, v94
    v_exp_f32 v95, v95
    s_nop 0
    v_pk_add_f32 v[100:101], v[92:93], v[94:95]
    s_branch ch0bf_k0
ch0bf_vw:
    v_lshlrev_b32 v113, 7, v0
    s_mov_b32 s99, 0
hz_166:
    buffer_load_dword v115, v113, s[44:47], s75 offen sc1
    s_waitcnt vmcnt(0)
    v_cmp_gt_u32 vcc, 28, v115
    s_ff1_i32_b64 s100, vcc
    s_cmp_eq_u32 s100, -1
    s_cselect_b32 s100, 65, s100
    s_sub_u32 s100, s100, 1
    s_cmp_gt_i32 s100, s64
    s_cbranch_scc1 hd_167
    s_sleep 1
    s_add_u32 s99, s99, 1
    s_cmp_lt_u32 s99, 400000
    s_cbranch_scc1 hz_166
    s_branch chain_abort
hd_167:
    s_branch ch0bf_vok
ch0af:
    v_mov_b32 v44, 0
    v_mov_b32 v60, 0
    v_mov_b32 v45, 0
    v_mov_b32 v61, 0
    v_mov_b32 v46, 0
    v_mov_b32 v62, 0
    v_mov_b32 v47, 0
    v_mov_b32 v63, 0
    v_mov_b32 v48, 0
    v_mov_b32 v64, 0
    v_mov_b32 v49, 0
    v_mov_b32 v65, 0
    v_mov_b32 v50, 0
    v_mov_b32 v66, 0
    v_mov_b32 v51, 0
    v_mov_b32 v67, 0
    v_mov_b32 v52, 0
    v_mov_b32 v68, 0
    v_mov_b32 v53, 0
    v_mov_b32 v69, 0
    v_mov_b32 v54, 0
    v_mov_b32 v70, 0
    v_mov_b32 v55, 0
    v_mov_b32 v71, 0
    v_mov_b32 v56, 0
    v_mov_b32 v72, 0
    v_mov_b32 v57, 0
    v_mov_b32 v73, 0
    v_mov_b32 v58, 0
    v_mov_b32 v74, 0
    v_mov_b32 v59, 0
    v_mov_b32 v75, 0
    v_mov_b32 v112, 0
    v_mov_b32 v113, 0
    v_mov_b32 v114, 0
    v_mov_b32 v115, 0
    s_branch ch0af_loop
.p2align 6
ch0af_loop:
    s_and_b32 s8, s64, 3
    s_lshl_b32 s65, s8, 13
    s_add_u32 s65, s65, 94896128
    buffer_load_dwordx4 v[16:19], v1, s[44:47], s65 offen offset:0 sc1
    buffer_load_dwordx4 v[20:23], v1, s[44:47], s65 offen offset:1024 sc1
    s_mov_b32 s83, 0
    s_and_b32 s8, s64, 3
    s_mul_i32 s9, s8, 20736
    s_add_u32 s67, s9, 94928896
    s_add_u32 s66, s9, s12
    s_xor_b32 s8, s8, 2
    s_mul_i32 s9, s8, 20736
    s_add_u32 s70, s9, s13
    s_lshl_b32 s9, s8, 13
    s_add_u32 s69, s9, s14
    s_add_u32 s8, s64, 1
    s_and_b32 s8, s8, 3
    s_lshl_b32 s9, s8, 13
    s_add_u32 s68, s9, s14
    s_add_u32 s16, s72, 0
    s_add_u32 s20, s15, 0
    s_add_u32 s17, s72, 4096
    s_add_u32 s21, s15, 4096
    s_add_u32 s18, s72, 14336
    s_add_u32 s22, s15, 8192
    s_add_u32 s72, s72, 28672
    s_xor_b32 s15, s15, 0x4000
ch0af_mp:
    buffer_load_dwordx4 v[16:19], v1, s[44:47], s65 offen offset:0 sc1
    buffer_load_dwordx4 v[20:23], v1, s[44:47], s65 offen offset:1024 sc1
    s_add_u32 s83, s83, 1
    s_cmp_ge_u32 s83, 2000000
    s_cbranch_scc1 chain_abort
    s_waitcnt vmcnt(3)
    v_max3_u32 v2, v16, v17, v18
    v_max_u32 v2, v2, v19
    v_cmp_eq_u32 s[10:11], -1, v2
    s_waitcnt vmcnt(2)
    v_max3_u32 v2, v20, v21, v22
    v_max_u32 v2, v2, v23
    v_cmp_eq_u32 vcc, -1, v2
    s_cmp_lg_u64 s[10:11], 0
    s_cbranch_scc1 ch0af_m0bad
    s_cbranch_vccnz ch0af_mp1
ch0af_mok:
    ds_write_b128 v1, v[16:19] offset:0
    ds_write_b128 v1, v[20:23] offset:1024
    v_smfmac_f32_16x16x64_bf16 v[44:47], v[16:19], a[0:7], v5
    v_smfmac_f32_16x16x64_bf16 v[48:51], v[16:19], a[56:63], v5
    s_waitcnt lgkmcnt(0)
    s_barrier
    ds_read_b128 v[24:27], v1 offset:2048
    ds_read_b128 v[28:31], v1 offset:3072
    ds_read_b128 v[32:35], v1 offset:4096
    ds_read_b128 v[36:39], v1 offset:5120
    ds_read_b128 v[40:43], v1 offset:6144
    v_smfmac_f32_16x16x64_bf16 v[52:55], v[16:19], a[112:119], v5
    s_mov_b32 m0, s20
    v_smfmac_f32_16x16x64_bf16 v[44:47], v[20:23], a[8:15], v5
    buffer_load_dwordx4 v1, s[44:47], s16 offen offset:0 sc1 lds
    v_smfmac_f32_16x16x64_bf16 v[48:51], v[20:23], a[64:71], v5
    buffer_load_dwordx4 v1, s[44:47], s16 offen offset:1024 sc1 lds
    v_smfmac_f32_16x16x64_bf16 v[52:55], v[20:23], a[120:127], v5
    buffer_load_dwordx4 v1, s[44:47], s16 offen offset:2048 sc1 lds
    s_waitcnt lgkmcnt(4)
    v_smfmac_f32_16x16x64_bf16 v[44:47], v[24:27], a[16:23], v5
    buffer_load_dwordx4 v1, s[44:47], s16 offen offset:3072 sc1 lds
    s_mov_b32 m0, s21
    s_waitcnt lgkmcnt(3)
    v_smfmac_f32_16x16x64_bf16 v[44:47], v[28:31], a[24:31], v5
    buffer_load_dwordx4 v1, s[44:47], s17 offen offset:0 sc1 lds
    s_waitcnt lgkmcnt(2)
    v_smfmac_f32_16x16x64_bf16 v[44:47], v[32:35], a[32:39], v5
    buffer_load_dwordx4 v1, s[44:47], s17 offen offset:1024 sc1 lds
    s_waitcnt lgkmcnt(1)
    v_smfmac_f32_16x16x64_bf16 v[44:47], v[36:39], a[40:47], v5
    buffer_load_dwordx4 v1, s[44:47], s17 offen offset:2048 sc1 lds
    s_mov_b32 m0, s22
    s_waitcnt lgkmcnt(0)
    v_smfmac_f32_16x16x64_bf16 v[44:47], v[40:43], a[48:55], v5
    buffer_load_dwordx4 v1, s[44:47], s18 offen offset:0 sc1 lds
    v_smfmac_f32_16x16x64_bf16 v[48:51], v[24:27], a[72:79], v5
    buffer_load_dwordx4 v1, s[44:47], s18 offen offset:1024 sc1 lds
    v_smfmac_f32_16x16x64_bf16 v[48:51], v[28:31], a[80:87], v5
    buffer_store_dword v3, v4, s[44:47], s70 offen
    v_smfmac_f32_16x16x64_bf16 v[48:51], v[32:35], a[88:95], v5
    v_smfmac_f32_16x16x64_bf16 v[48:51], v[36:39], a[96:103], v5
    s_nop 0
    v_add_f32 v44, v44, v46
    v_smfmac_f32_16x16x64_bf16 v[48:51], v[40:43], a[104:111], v5
    v_add_f32 v45, v45, v47
    v_smfmac_f32_16x16x64_bf16 v[52:55], v[24:27], a[128:135], v5
    v_cvt_pk_bf16_f32 v44, v44, v45
    v_smfmac_f32_16x16x64_bf16 v[52:55], v[28:31], a[136:143], v5
    ds_write_b32 v6, v44 offset:0
    v_smfmac_f32_16x16x64_bf16 v[52:55], v[32:35], a[144:151], v5
    v_smfmac_f32_16x16x64_bf16 v[52:55], v[36:39], a[152:159], v5
    s_nop 0
    v_add_f32 v48, v48, v50
    v_smfmac_f32_16x16x64_bf16 v[52:55], v[40:43], a[160:167], v5
    v_add_f32 v49, v49, v51
    v_smfmac_f32_16x16x64_bf16 v[56:59], v[24:27], a[184:191], v5
    v_cvt_pk_bf16_f32 v48, v48, v49
    v_smfmac_f32_16x16x64_bf16 v[56:59], v[28:31], a[192:199], v5
    ds_write_b32 v6, v48 offset:256
    v_smfmac_f32_16x16x64_bf16 v[56:59], v[32:35], a[200:207], v5
    s_nop 1
    v_add_f32 v52, v52, v54
    v_smfmac_f32_16x16x64_bf16 v[56:59], v[36:39], a[208:215], v5
    v_add_f32 v53, v53, v55
    v_smfmac_f32_16x16x64_bf16 v[56:59], v[40:43], a[216:223], v5
    v_cvt_pk_bf16_f32 v52, v52, v53
    v_smfmac_f32_16x16x64_bf16 v[56:59], v[16:19], a[168:175], v5
    ds_write_b32 v6, v52 offset:512
    v_smfmac_f32_16x16x64_bf16 v[56:59], v[20:23], a[176:183], v5
    s_nop 7
    v_add_f32 v56, v56, v58
    v_add_f32 v57, v57, v59
    v_cvt_pk_bf16_f32 v56, v56, v57
    ds_write_b32 v6, v56 offset:3072
    s_waitcnt lgkmcnt(1)
    s_barrier
    s_waitcnt lgkmcnt(0)
    s_barrier
    s_lshl_b32 s8, s101, 7
    s_add_u32 s8, s8, 95055872
    s_cmp_eq_u32 s101, -1
    s_cselect_b32 s8, 0x7ffffff0, s8
    s_barrier
    buffer_store_dword v10, off, s[44:47], s8 sc1
    s_add_u32 s71, s71, 458752
    s_add_u32 s8, s72, 0
    s_mov_b32 m0, 16384
    s_nop 0
    buffer_load_dwordx4 v1, s[44:47], s8 offen offset:0 sc1 lds
    buffer_load_dwordx4 v1, s[44:47], s8 offen offset:1024 sc1 lds
    buffer_load_dwordx4 v1, s[44:47], s8 offen offset:2048 sc1 lds
    buffer_load_dwordx4 v1, s[44:47], s8 offen offset:3072 sc1 lds
    s_add_u32 s8, s72, 4096
    s_mov_b32 m0, 20480
    s_nop 0
    buffer_load_dwordx4 v1, s[44:47], s8 offen offset:0 sc1 lds
    buffer_load_dwordx4 v1, s[44:47], s8 offen offset:1024 sc1 lds
    buffer_load_dwordx4 v1, s[44:47], s8 offen offset:2048 sc1 lds
    s_add_u32 s8, s72, 14336
    s_mov_b32 m0, 24576
    s_nop 0
    buffer_load_dwordx4 v1, s[44:47], s8 offen offset:0 sc1 lds
    buffer_load_dwordx4 v1, s[44:47], s8 offen offset:1024 sc1 lds
    s_add_u32 s8, s64, s7
    s_and_b32 s8, s8, 3
    s_cmp_lg_u32 s8, 0
    s_cselect_b32 s101, -1, s64
    s_cbranch_scc1 ch0af_np
    s_lshl_b32 s8, s64, 13
    s_add_u32 s8, s8, 91750400
    buffer_store_dwordx4 v[16:19], v1, s[44:47], s8 offen offset:0 sc1
    buffer_store_dwordx4 v[20:23], v1, s[44:47], s8 offen offset:1024 sc1
ch0af_np:
    v_mov_b32 v44, 0
    v_mov_b32 v45, 0
    v_mov_b32 v46, 0
    v_mov_b32 v47, 0
    v_mov_b32 v48, 0
    v_mov_b32 v49, 0
    v_mov_b32 v50, 0
    v_mov_b32 v51, 0
    v_mov_b32 v52, 0
    v_mov_b32 v53, 0
    v_mov_b32 v54, 0
    v_mov_b32 v55, 0
    v_mov_b32 v56, 0
    v_mov_b32 v57, 0
    v_mov_b32 v58, 0
    v_mov_b32 v59, 0
    v_mov_b32 v112, 0
    v_mov_b32 v113, 0
    v_mov_b32 v114, 0
    v_mov_b32 v115, 0
    s_add_u32 s64, s64, 1
    s_cmp_lt_u32 s64, 63
    s_cbranch_scc1 ch0af_loop
    s_waitcnt vmcnt(0)
    s_barrier
    s_lshl_b32 s8, s101, 7
    s_add_u32 s8, s8, 95055872
    s_cmp_eq_u32 s101, -1
    s_cselect_b32 s8, 0x7ffffff0, s8
    buffer_store_dword v10, off, s[44:47], s8 sc1
    s_endpgm
ch0af_mp1:
    buffer_load_dwordx4 v[20:23], v1, s[44:47], s65 offen offset:1024 sc1
    s_add_u32 s83, s83, 1
    s_cmp_ge_u32 s83, 2000000
    s_cbranch_scc1 chain_abort
    s_waitcnt vmcnt(1)
    v_max3_u32 v2, v20, v21, v22
    v_max_u32 v2, v2, v23
    v_cmp_eq_u32 vcc, -1, v2
    s_cbranch_vccnz ch0af_mp1
    s_branch ch0af_mok
ch0af_m0bad:
    s_cbranch_vccnz ch0af_mp
ch0af_mp0:
    buffer_load_dwordx4 v[16:19], v1, s[44:47], s65 offen offset:0 sc1
    s_add_u32 s83, s83, 1
    s_cmp_ge_u32 s83, 2000000
    s_cbranch_scc1 chain_abort
    s_waitcnt vmcnt(1)
    v_max3_u32 v2, v16, v17, v18
    v_max_u32 v2, v2, v19
    v_cmp_eq_u32 vcc, -1, v2
    s_cbranch_vccnz ch0af_mp0
    s_branch ch0af_mok
ch1bf:
    v_mov_b32 v44, 0
    v_mov_b32 v60, 0
    v_mov_b32 v45, 0
    v_mov_b32 v61, 0
    v_mov_b32 v46, 0
    v_mov_b32 v62, 0
    v_mov_b32 v47, 0
    v_mov_b32 v63, 0
    v_mov_b32 v48, 0
    v_mov_b32 v64, 0
    v_mov_b32 v49, 0
    v_mov_b32 v65, 0
    v_mov_b32 v50, 0
    v_mov_b32 v66, 0
    v_mov_b32 v51, 0
    v_mov_b32 v67, 0
    v_mov_b32 v52, 0
    v_mov_b32 v68, 0
    v_mov_b32 v53, 0
    v_mov_b32 v69, 0
    v_mov_b32 v54, 0
    v_mov_b32 v70, 0
    v_mov_b32 v55, 0
    v_mov_b32 v71, 0
    v_mov_b32 v56, 0
    v_mov_b32 v72, 0
    v_mov_b32 v57, 0
    v_mov_b32 v73, 0
    v_mov_b32 v58, 0
    v_mov_b32 v74, 0
    v_mov_b32 v59, 0
    v_mov_b32 v75, 0
    v_mov_b32 v112, 0
    v_mov_b32 v113, 0
    v_mov_b32 v114, 0
    v_mov_b32 v115, 0
    s_branch ch1bf_loop
.p2align 6
ch1bf_loop:
    s_and_b32 s8, s64, 3
    s_lshl_b32 s65, s8, 13
    s_add_u32 s65, s65, 94898176
    buffer_load_dwordx4 v[24:27], v1, s[44:47], s65 offen offset:0 sc1
    buffer_load_dwordx4 v[28:31], v1, s[44:47], s65 offen offset:1024 sc1
    s_mov_b32 s83, 0
    s_and_b32 s8, s64, 3
    s_mul_i32 s9, s8, 20736
    s_add_u32 s67, s9, 94934016
    s_add_u32 s66, s9, s12
    s_xor_b32 s8, s8, 2
    s_mul_i32 s9, s8, 20736
    s_add_u32 s70, s9, s13
    s_add_u32 s16, s72, 14336
    s_add_u32 s20, s15, 8192
    s_add_u32 s17, s72, 18432
    s_add_u32 s21, s15, 12288
    s_add_u32 s72, s72, 28672
    s_xor_b32 s15, s15, 0x4000
    s_add_u32 s24, s71, 0
    s_add_u32 s71, s71, 458752
    v_mov_b32 v60, 0
    v_mov_b32 v61, 0
    v_mov_b32 v62, 0
    v_mov_b32 v63, 0
    v_mov_b32 v64, 0
    v_mov_b32 v65, 0
    v_mov_b32 v66, 0
    v_mov_b32 v67, 0
    v_mov_b32 v68, 0
    v_mov_b32 v69, 0
    v_mov_b32 v70, 0
    v_mov_b32 v71, 0
    v_mov_b32 v72, 0
    v_mov_b32 v73, 0
    v_mov_b32 v74, 0
    v_mov_b32 v75, 0
ch1bf_mp:
    buffer_load_dwordx4 v[24:27], v1, s[44:47], s65 offen offset:0 sc1
    buffer_load_dwordx4 v[28:31], v1, s[44:47], s65 offen offset:1024 sc1
    s_add_u32 s83, s83, 1
    s_cmp_ge_u32 s83, 2000000
    s_cbranch_scc1 chain_abort
    s_waitcnt vmcnt(3)
    v_max3_u32 v2, v24, v25, v26
    v_max_u32 v2, v2, v27
    v_cmp_eq_u32 s[10:11], -1, v2
    s_waitcnt vmcnt(2)
    v_max3_u32 v2, v28, v29, v30
    v_max_u32 v2, v2, v31
    v_cmp_eq_u32 vcc, -1, v2
    s_cmp_lg_u64 s[10:11], 0
    s_cbranch_scc1 ch1bf_m0bad
    s_cbranch_vccnz ch1bf_mp1
ch1bf_mok:
    ds_write_b128 v1, v[24:27] offset:2048
    ds_write_b128 v1, v[28:31] offset:3072
    v_smfmac_f32_16x16x64_bf16 v[44:47], v[24:27], a[16:23], v5
    v_smfmac_f32_16x16x64_bf16 v[48:51], v[24:27], a[72:79], v5
    s_waitcnt lgkmcnt(0)
    s_barrier
    s_mov_b32 m0, 20480
    ds_read_b128 v[16:19], v1 offset:0
    ds_read_b128 v[20:23], v1 offset:1024
    ds_read_b128 v[32:35], v1 offset:4096
    ds_read_b128 v[36:39], v1 offset:5120
    ds_read_b128 v[40:43], v1 offset:6144
    v_smfmac_f32_16x16x64_bf16 v[52:55], v[24:27], a[128:135], v5
    buffer_load_dwordx4 v1, s[44:47], s24 offen offset:2048 sc1 lds
    v_smfmac_f32_16x16x64_bf16 v[44:47], v[28:31], a[24:31], v5
    buffer_load_dwordx4 v1, s[44:47], s24 offen offset:3072 sc1 lds
    s_mov_b32 m0, s20
    v_smfmac_f32_16x16x64_bf16 v[48:51], v[28:31], a[80:87], v5
    buffer_load_dwordx4 v1, s[44:47], s16 offen offset:2048 sc1 lds
    v_smfmac_f32_16x16x64_bf16 v[52:55], v[28:31], a[136:143], v5
    buffer_load_dwordx4 v1, s[44:47], s16 offen offset:3072 sc1 lds
    s_mov_b32 m0, s21
    v_smfmac_f32_16x16x64_bf16 v[60:63], v[24:27], a[240:247], v5
    buffer_load_dwordx4 v1, s[44:47], s17 offen offset:0 sc1 lds
    v_smfmac_f32_16x16x64_bf16 v[60:63], v[28:31], a[248:255], v5
    buffer_load_dwordx4 v1, s[44:47], s17 offen offset:1024 sc1 lds
    v_smfmac_f32_16x16x64_bf16 v[64:67], v[24:27], v[160:167], v5
    buffer_load_dwordx4 v1, s[44:47], s17 offen offset:2048 sc1 lds
    s_waitcnt lgkmcnt(4)
    v_smfmac_f32_16x16x64_bf16 v[44:47], v[16:19], a[0:7], v5
    buffer_store_dword v3, v4, s[44:47], s70 offen
    s_waitcnt lgkmcnt(3)
    v_smfmac_f32_16x16x64_bf16 v[44:47], v[20:23], a[8:15], v5
    s_waitcnt lgkmcnt(2)
    v_smfmac_f32_16x16x64_bf16 v[44:47], v[32:35], a[32:39], v5
    ds_read2_b64 v[76:79], v8 offset0:0 offset1:4
    s_waitcnt lgkmcnt(2)
    v_smfmac_f32_16x16x64_bf16 v[44:47], v[36:39], a[40:47], v5
    ds_read2_b64 v[80:83], v8 offset0:64 offset1:68
    s_waitcnt lgkmcnt(2)
    v_smfmac_f32_16x16x64_bf16 v[44:47], v[40:43], a[48:55], v5
    ds_read2_b64 v[84:87], v8 offset0:128 offset1:132
    v_smfmac_f32_16x16x64_bf16 v[48:51], v[16:19], a[56:63], v5
    ds_read2_b64 v[88:91], v8 offset0:192 offset1:196
    v_smfmac_f32_16x16x64_bf16 v[48:51], v[20:23], a[64:71], v5
    ds_read2_b64 v[92:95], v13 offset0:0 offset1:4
    v_smfmac_f32_16x16x64_bf16 v[48:51], v[32:35], a[88:95], v5
    ds_read2_b64 v[96:99], v13 offset0:64 offset1:68
    v_smfmac_f32_16x16x64_bf16 v[48:51], v[36:39], a[96:103], v5
    v_add_f32 v44, v44, v46
    v_smfmac_f32_16x16x64_bf16 v[48:51], v[40:43], a[104:111], v5
    v_add_f32 v45, v45, v47
    v_smfmac_f32_16x16x64_bf16 v[52:55], v[16:19], a[112:119], v5
    v_cvt_pk_bf16_f32 v44, v44, v45
    v_smfmac_f32_16x16x64_bf16 v[52:55], v[20:23], a[120:127], v5
    ds_write_b32 v6, v44 offset:768
    v_smfmac_f32_16x16x64_bf16 v[52:55], v[32:35], a[144:151], v5
    ds_read2_b64 v[100:103], v13 offset0:128 offset1:132
    v_smfmac_f32_16x16x64_bf16 v[52:55], v[36:39], a[152:159], v5
    v_add_f32 v48, v48, v50
    v_smfmac_f32_16x16x64_bf16 v[52:55], v[40:43], a[160:167], v5
    v_add_f32 v49, v49, v51
    v_smfmac_f32_16x16x64_bf16 v[56:59], v[16:19], a[168:175], v5
    v_cvt_pk_bf16_f32 v48, v48, v49
    v_smfmac_f32_16x16x64_bf16 v[56:59], v[20:23], a[176:183], v5
    ds_write_b32 v6, v48 offset:1024
    v_smfmac_f32_16x16x64_bf16 v[56:59], v[32:35], a[200:207], v5
    s_nop 1
    v_add_f32 v52, v52, v54
    v_smfmac_f32_16x16x64_bf16 v[56:59], v[36:39], a[208:215], v5
    v_add_f32 v53, v53, v55
    v_smfmac_f32_16x16x64_bf16 v[56:59], v[40:43], a[216:223], v5
    v_cvt_pk_bf16_f32 v52, v52, v53
    v_smfmac_f32_16x16x64_bf16 v[56:59], v[24:27], a[184:191], v5
    ds_write_b32 v6, v52 offset:1280
    v_smfmac_f32_16x16x64_bf16 v[56:59], v[28:31], a[192:199], v5
    s_nop 7
    v_add_f32 v56, v56, v58
    v_add_f32 v57, v57, v59
    v_cvt_pk_bf16_f32 v56, v56, v57
    ds_write_b32 v6, v56 offset:3328
    s_waitcnt lgkmcnt(1)
    s_barrier
    ds_read_b64_tr_b16 v[44:45], v7 offset:0
    ds_read_b64_tr_b16 v[46:47], v7 offset:128
    ds_read_b64_tr_b16 v[48:49], v7 offset:1024
    ds_read_b64_tr_b16 v[50:51], v7 offset:1152
    ds_read_b64_tr_b16 v[52:53], v7 offset:2048
    ds_read_b64_tr_b16 v[54:55], v7 offset:2176
    s_waitcnt lgkmcnt(6)
    s_barrier
    ds_read_b64_tr_b16 v[56:57], v7 offset:3072
    ds_read_b64_tr_b16 v[58:59], v7 offset:3200
    s_waitcnt lgkmcnt(6)
    v_smfmac_f32_16x16x64_bf16 v[112:115], v[44:47], v[76:83], v5
    s_waitcnt lgkmcnt(4)
    v_smfmac_f32_16x16x64_bf16 v[112:115], v[48:51], v[84:91], v5
    s_waitcnt lgkmcnt(2)
    v_smfmac_f32_16x16x64_bf16 v[112:115], v[52:55], v[92:99], v5
    s_waitcnt lgkmcnt(0)
    v_smfmac_f32_16x16x64_bf16 v[112:115], v[56:59], v[100:107], v5
    ds_read_b128 v[44:47], v12 offset:0
    ds_read_b128 v[48:51], v12 offset:1024
    ds_read_b128 v[52:55], v12 offset:2048
    ds_read_b128 v[56:59], v12 offset:3072
    s_nop 3
    v_pk_add_f32 v[112:113], v[112:113], v[114:115]
    v_pk_mul_f32 v[112:113], v[112:113], s[78:79]
    v_cvt_pk_f16_f32 v112, v112, v113
    s_nop 1
    v_mov_b32_dpp v113, v112 quad_perm:[1,0,3,2] row_mask:0xf bank_mask:0xf
    v_perm_b32 v112, v113, v112, v14
    v_pk_min_u16 v112, v112, s77
    buffer_store_dword v112, v9, s[44:47], s66 offen
    s_mov_b32 s83, 0
    s_mov_b32 s98, 0
    v_smfmac_f32_16x16x64_bf16 v[60:63], v[16:19], a[224:231], v5
    v_smfmac_f32_16x16x64_bf16 v[60:63], v[20:23], a[232:239], v5
    v_smfmac_f32_16x16x64_bf16 v[60:63], v[32:35], v[120:127], v5
    s_waitcnt lgkmcnt(2)
    v_smfmac_f32_16x16x64_bf16 v[72:75], v[16:19], v[44:51], v5
    ds_read_b128 v[44:47], v12 offset:4096
    ds_read_b128 v[48:51], v12 offset:5120
    v_smfmac_f32_16x16x64_bf16 v[60:63], v[36:39], v[128:135], v5
    v_smfmac_f32_16x16x64_bf16 v[60:63], v[40:43], v[136:143], v5
    v_smfmac_f32_16x16x64_bf16 v[64:67], v[16:19], v[144:151], v5
    s_waitcnt lgkmcnt(2)
    v_smfmac_f32_16x16x64_bf16 v[72:75], v[20:23], v[52:59], v5
    ds_read_b128 v[52:55], v12 offset:6144
    ds_read_b128 v[56:59], v12 offset:7168
    v_smfmac_f32_16x16x64_bf16 v[64:67], v[20:23], v[152:159], v5
    v_smfmac_f32_16x16x64_bf16 v[64:67], v[28:31], v[168:175], v5
    v_smfmac_f32_16x16x64_bf16 v[64:67], v[32:35], v[176:183], v5
    v_add_f32 v60, v60, v62
    s_waitcnt lgkmcnt(2)
    v_smfmac_f32_16x16x64_bf16 v[72:75], v[24:27], v[44:51], v5
    ds_read_b128 v[44:47], v12 offset:8192
    ds_read_b128 v[48:51], v12 offset:9216
    s_cmp_ge_u32 s100, 64
    s_cbranch_scc0 ch1bf_hl
ch1bf_hs:
    buffer_load_dwordx4 v[76:79], v1, s[44:47], s67 offen offset:0 sc1
    buffer_load_dwordx4 v[84:87], v1, s[44:47], s67 offen offset:2048 sc1
    v_smfmac_f32_16x16x64_bf16 v[64:67], v[36:39], v[184:191], v5
    v_add_f32 v61, v61, v63
    v_smfmac_f32_16x16x64_bf16 v[64:67], v[40:43], v[192:199], v5
    v_cvt_pk_bf16_f32 v104, v60, v61
    v_smfmac_f32_16x16x64_bf16 v[68:71], v[16:19], v[200:207], v5
    buffer_load_dwordx4 v[80:83], v1, s[44:47], s67 offen offset:1024 sc1
    buffer_load_dwordx4 v[88:91], v1, s[44:47], s67 offen offset:3072 sc1
    s_waitcnt lgkmcnt(2)
    v_smfmac_f32_16x16x64_bf16 v[72:75], v[28:31], v[52:59], v5
    ds_read_b128 v[52:55], v12 offset:10240
    ds_read_b128 v[56:59], v12 offset:11264
    v_smfmac_f32_16x16x64_bf16 v[68:71], v[20:23], v[208:215], v5
    v_mov_b32 v60, 0
    v_smfmac_f32_16x16x64_bf16 v[68:71], v[24:27], v[216:223], v5
    buffer_load_dwordx4 v[92:95], v10, s[44:47], s67 offen offset:0 sc1
    s_waitcnt lgkmcnt(2)
    v_smfmac_f32_16x16x64_bf16 v[72:75], v[32:35], v[44:51], v5
    ds_read_b128 v[44:47], v12 offset:12288
    ds_read_b128 v[48:51], v12 offset:13312
    v_smfmac_f32_16x16x64_bf16 v[68:71], v[28:31], v[224:231], v5
    v_mov_b32 v61, 0
    v_smfmac_f32_16x16x64_bf16 v[68:71], v[32:35], v[232:239], v5
    v_mov_b32 v62, 0
    s_waitcnt lgkmcnt(2)
    v_smfmac_f32_16x16x64_bf16 v[72:75], v[36:39], v[52:59], v5
    v_smfmac_f32_16x16x64_bf16 v[68:71], v[36:39], v[240:247], v5
    v_mov_b32 v63, 0
    v_smfmac_f32_16x16x64_bf16 v[68:71], v[40:43], v[248:255], v5
    v_add_f32 v64, v64, v66
    s_waitcnt lgkmcnt(0)
    v_smfmac_f32_16x16x64_bf16 v[72:75], v[40:43], v[44:51], v5
    v_add_f32 v65, v65, v67
    v_cvt_pk_bf16_f32 v105, v64, v65
    s_nop 2
    v_add_f32 v68, v68, v70
    v_add_f32 v69, v69, v71
    v_cvt_pk_bf16_f32 v108, v68, v69
    v_add_f32 v72, v72, v74
    v_add_f32 v73, v73, v75
    v_cvt_pk_bf16_f32 v109, v72, v73
    s_waitcnt vmcnt(3)
    ds_read_b128 v[44:47], v1 offset:20480
    ds_read_b128 v[48:51], v1 offset:21504
    ds_read_b128 v[52:55], v1 offset:22528
    ds_read_b128 v[56:59], v1 offset:23552
    s_cbranch_scc0 ch1bf_hu
ch1bf_hv:
    s_cmp_ge_u32 s64, s100
    v_fma_mix_f32 v102, v76, 1.0, v84 op_sel:[0,0,0] op_sel_hi:[1,0,1]
    v_fma_mix_f32 v84, v76, 1.0, v84 op_sel:[1,0,1] op_sel_hi:[1,0,1]
    v_fma_mix_f32 v76, v77, 1.0, v85 op_sel:[0,0,0] op_sel_hi:[1,0,1]
    v_fma_mix_f32 v85, v77, 1.0, v85 op_sel:[1,0,1] op_sel_hi:[1,0,1]
    v_fma_mix_f32 v77, v78, 1.0, v86 op_sel:[0,0,0] op_sel_hi:[1,0,1]
    v_fma_mix_f32 v86, v78, 1.0, v86 op_sel:[1,0,1] op_sel_hi:[1,0,1]
    v_fma_mix_f32 v78, v79, 1.0, v87 op_sel:[0,0,0] op_sel_hi:[1,0,1]
    v_fma_mix_f32 v87, v79, 1.0, v87 op_sel:[1,0,1] op_sel_hi:[1,0,1]
    v_maximum3_f32 v112, v84, v85, v86
    v_cmp_u_f32 vcc, v112, v87
    v_exp_f32 v76, v76
    v_exp_f32 v77, v77
    v_exp_f32 v78, v78
    s_cbranch_vccnz ch1bf_i0
    v_exp_f32 v79, v102
    v_exp_f32 v84, v84
    v_exp_f32 v85, v85
    v_pk_add_f32 v[96:97], v[76:77], v[78:79]
    v_exp_f32 v86, v86
    v_exp_f32 v87, v87
    v_pk_add_f32 v[96:97], v[96:97], v[84:85]
    v_pk_add_f32 v[96:97], v[96:97], v[86:87]
    s_waitcnt vmcnt(1)
    v_fma_mix_f32 v103, v80, 1.0, v88 op_sel:[0,0,0] op_sel_hi:[1,0,1]
    v_fma_mix_f32 v88, v80, 1.0, v88 op_sel:[1,0,1] op_sel_hi:[1,0,1]
    v_fma_mix_f32 v80, v81, 1.0, v89 op_sel:[0,0,0] op_sel_hi:[1,0,1]
    v_fma_mix_f32 v89, v81, 1.0, v89 op_sel:[1,0,1] op_sel_hi:[1,0,1]
    v_fma_mix_f32 v81, v82, 1.0, v90 op_sel:[0,0,0] op_sel_hi:[1,0,1]
    v_fma_mix_f32 v90, v82, 1.0, v90 op_sel:[1,0,1] op_sel_hi:[1,0,1]
    v_fma_mix_f32 v82, v83, 1.0, v91 op_sel:[0,0,0] op_sel_hi:[1,0,1]
    v_fma_mix_f32 v91, v83, 1.0, v91 op_sel:[1,0,1] op_sel_hi:[1,0,1]
    v_maximum3_f32 v114, v88, v89, v90
    v_cmp_u_f32 vcc, v114, v91
    v_exp_f32 v80, v80
    v_exp_f32 v81, v81
    v_exp_f32 v82, v82
    s_cbranch_vccnz ch1bf_i1
    v_exp_f32 v83, v103
    v_exp_f32 v88, v88
    v_exp_f32 v89, v89
    v_pk_add_f32 v[98:99], v[80:81], v[82:83]
    v_exp_f32 v90, v90
    v_exp_f32 v91, v91
    v_pk_add_f32 v[98:99], v[98:99], v[88:89]
    v_pk_add_f32 v[98:99], v[98:99], v[90:91]
    s_cbranch_scc1 ch1bf_nw
ch1bf_nw2:
    s_mov_b32 m0, 20480
    s_mov_b32 s98, 1
    s_waitcnt vmcnt(0) lgkmcnt(0)
    buffer_load_dwordx4 v1, s[44:47], s71 offen offset:0 sc1 lds
    buffer_load_dwordx4 v1, s[44:47], s71 offen offset:1024 sc1 lds
    v_fma_mix_f32 v113, v92, 1.0, v94 op_sel:[0,0,0] op_sel_hi:[1,0,1]
    v_fma_mix_f32 v94, v92, 1.0, v94 op_sel:[1,0,1] op_sel_hi:[1,0,1]
    v_fma_mix_f32 v92, v93, 1.0, v95 op_sel:[0,0,0] op_sel_hi:[1,0,1]
    v_fma_mix_f32 v95, v93, 1.0, v95 op_sel:[1,0,1] op_sel_hi:[1,0,1]
    v_cmp_u_f32 vcc, v94, v95
    v_exp_f32 v92, v92
    v_exp_f32 v93, v113
    v_exp_f32 v94, v94
    s_cbranch_vccnz ch1bf_i2
    v_exp_f32 v95, v95
    s_nop 0
    v_pk_add_f32 v[100:101], v[92:93], v[94:95]
ch1bf_w2d:
    v_pk_add_f32 v[96:97], v[96:97], v[98:99]
    v_pk_add_f32 v[96:97], v[96:97], v[100:101]
    v_add_f32 v2, v96, v97
    v_add_f32 v15, v96, v97
    s_nop 1
    v_permlane16_swap_b32 v2, v15
    v_add_f32 v2, v2, v15
    v_subrev_u32 v15, 0x17800000, v2
    v_rcp_f32 v2, v2
    v_cmp_le_u32 vcc, 0x5a000000, v15
    s_waitcnt lgkmcnt(0)
    v_pk_mul_f32 v[92:93], v[92:93], v[2:3] op_sel_hi:[1,0]
    v_pk_mul_f32 v[94:95], v[94:95], v[2:3] op_sel_hi:[1,0]
    v_cvt_pk_bf16_f32 v116, v93, v94
    v_cvt_pk_bf16_f32 v118, v92, v95
    s_cbranch_vccnz ch1bf_fb
    v_pk_mul_f32 v[76:77], v[76:77], v[2:3] op_sel_hi:[1,0]
    v_pk_mul_f32 v[78:79], v[78:79], v[2:3] op_sel_hi:[1,0]
    v_pk_mul_f32 v[84:85], v[84:85], v[2:3] op_sel_hi:[1,0]
    v_pk_mul_f32 v[86:87], v[86:87], v[2:3] op_sel_hi:[1,0]
    v_cvt_pk_bf16_f32 v96, v79, v84
    v_cvt_pk_bf16_f32 v97, v76, v85
    v_cvt_pk_bf16_f32 v98, v77, v86
    v_cvt_pk_bf16_f32 v99, v78, v87
    v_pk_mul_f32 v[80:81], v[80:81], v[2:3] op_sel_hi:[1,0]
    v_pk_mul_f32 v[82:83], v[82:83], v[2:3] op_sel_hi:[1,0]
    v_pk_mul_f32 v[88:89], v[88:89], v[2:3] op_sel_hi:[1,0]
    v_pk_mul_f32 v[90:91], v[90:91], v[2:3] op_sel_hi:[1,0]
    v_smfmac_f32_16x16x64_bf16 v[60:63], v[116:119], v[104:111], v5
    v_cvt_pk_bf16_f32 v100, v83, v88
    v_cvt_pk_bf16_f32 v101, v80, v89
    v_smfmac_f32_16x16x64_bf16 v[60:63], v[96:99], v[44:51], v5
    v_cvt_pk_bf16_f32 v102, v81, v90
    v_cvt_pk_bf16_f32 v103, v82, v91
    s_nop 1
    v_smfmac_f32_16x16x64_bf16 v[60:63], v[100:103], v[52:59], v5
ch1bf_kj:
    v_mov_b32 v44, 0
    v_mov_b32 v45, 0
    v_mov_b32 v46, 0
    v_mov_b32 v47, 0
    s_nop 3
    v_add_f32 v60, v60, v62
    v_add_f32 v61, v61, v63
    ds_write2_b32 v11, v60, v61 offset0:0 offset1:16
    v_mov_b32 v48, 0
    v_mov_b32 v49, 0
    v_mov_b32 v50, 0
    v_mov_b32 v51, 0
    v_mov_b32 v52, 0
    v_mov_b32 v53, 0
    v_mov_b32 v54, 0
    v_mov_b32 v55, 0
    v_mov_b32 v56, 0
    v_mov_b32 v57, 0
    v_mov_b32 v58, 0
    v_mov_b32 v59, 0
    v_mov_b32 v112, 0
    v_mov_b32 v113, 0
    v_mov_b32 v114, 0
    v_mov_b32 v115, 0
    s_waitcnt lgkmcnt(0)
    s_barrier
    s_barrier
    s_add_u32 s64, s64, 1
    s_cmp_lt_u32 s64, 63
    s_cbranch_scc1 ch1bf_loop
    s_and_b32 s8, s64, 3
    s_lshl_b32 s65, s8, 13
    s_add_u32 s65, s65, 94898176
    v_mov_b32 v60, 0
    v_mov_b32 v61, 0
    v_mov_b32 v62, 0
    v_mov_b32 v63, 0
    v_mov_b32 v64, 0
    v_mov_b32 v65, 0
    v_mov_b32 v66, 0
    v_mov_b32 v67, 0
    v_mov_b32 v68, 0
    v_mov_b32 v69, 0
    v_mov_b32 v70, 0
    v_mov_b32 v71, 0
    v_mov_b32 v72, 0
    v_mov_b32 v73, 0
    v_mov_b32 v74, 0
    v_mov_b32 v75, 0
    buffer_load_dwordx4 v[76:79], v1, s[44:47], s65 offen offset:0 sc1
    buffer_load_dwordx4 v[80:83], v1, s[44:47], s65 offen offset:1024 sc1
    s_mov_b32 s83, 0
ch1bft_mp:
    buffer_load_dwordx4 v[24:27], v1, s[44:47], s65 offen offset:0 sc1
    buffer_load_dwordx4 v[28:31], v1, s[44:47], s65 offen offset:1024 sc1
    s_waitcnt vmcnt(3)
    v_max3_u32 v2, v76, v77, v78
    s_waitcnt vmcnt(2)
    v_max3_u32 v2, v2, v79, v80
    v_max3_u32 v2, v2, v81, v82
    v_max_u32 v2, v2, v83
    v_cmp_eq_u32 vcc, -1, v2
    s_cbranch_vccz ch1bft_g1
    buffer_load_dwordx4 v[76:79], v1, s[44:47], s65 offen offset:0 sc1
    buffer_load_dwordx4 v[80:83], v1, s[44:47], s65 offen offset:1024 sc1
    s_add_u32 s83, s83, 1
    s_cmp_ge_u32 s83, 2000000
    s_cbranch_scc1 chain_abort
    s_waitcnt vmcnt(3)
    v_max3_u32 v2, v24, v25, v26
    s_waitcnt vmcnt(2)
    v_max3_u32 v2, v2, v27, v28
    v_max3_u32 v2, v2, v29, v30
    v_max_u32 v2, v2, v31
    v_cmp_eq_u32 vcc, -1, v2
    s_cbranch_vccnz ch1bft_mp
ch1bft_g1:
    s_waitcnt vmcnt(0)
    ds_write_b128 v1, v[24:27] offset:2048
    ds_write_b128 v1, v[28:31] offset:3072
    s_waitcnt lgkmcnt(0)
    s_barrier
    ds_read_b128 v[16:19], v1 offset:0
    ds_read_b128 v[20:23], v1 offset:1024
    ds_read_b128 v[32:35], v1 offset:4096
    ds_read_b128 v[36:39], v1 offset:5120
    ds_read_b128 v[40:43], v1 offset:6144
    s_waitcnt lgkmcnt(0)
    ds_read_b128 v[44:47], v12 offset:0
    ds_read_b128 v[48:51], v12 offset:1024
    ds_read_b128 v[52:55], v12 offset:2048
    ds_read_b128 v[56:59], v12 offset:3072
    v_smfmac_f32_16x16x64_bf16 v[60:63], v[16:19], a[224:231], v5
    v_smfmac_f32_16x16x64_bf16 v[60:63], v[20:23], a[232:239], v5
    v_smfmac_f32_16x16x64_bf16 v[60:63], v[24:27], a[240:247], v5
    s_waitcnt lgkmcnt(2)
    v_smfmac_f32_16x16x64_bf16 v[72:75], v[16:19], v[44:51], v5
    ds_read_b128 v[44:47], v12 offset:4096
    ds_read_b128 v[48:51], v12 offset:5120
    v_smfmac_f32_16x16x64_bf16 v[60:63], v[28:31], a[248:255], v5
    v_smfmac_f32_16x16x64_bf16 v[60:63], v[32:35], v[120:127], v5
    v_smfmac_f32_16x16x64_bf16 v[60:63], v[36:39], v[128:135], v5
    s_waitcnt lgkmcnt(2)
    v_smfmac_f32_16x16x64_bf16 v[72:75], v[20:23], v[52:59], v5
    ds_read_b128 v[52:55], v12 offset:6144
    ds_read_b128 v[56:59], v12 offset:7168
    v_smfmac_f32_16x16x64_bf16 v[60:63], v[40:43], v[136:143], v5
    v_smfmac_f32_16x16x64_bf16 v[64:67], v[16:19], v[144:151], v5
    v_smfmac_f32_16x16x64_bf16 v[64:67], v[20:23], v[152:159], v5
    s_waitcnt lgkmcnt(2)
    v_smfmac_f32_16x16x64_bf16 v[72:75], v[24:27], v[44:51], v5
    ds_read_b128 v[44:47], v12 offset:8192
    ds_read_b128 v[48:51], v12 offset:9216
    v_smfmac_f32_16x16x64_bf16 v[64:67], v[24:27], v[160:167], v5
    v_smfmac_f32_16x16x64_bf16 v[64:67], v[28:31], v[168:175], v5
    v_add_f32 v60, v60, v62
    v_smfmac_f32_16x16x64_bf16 v[64:67], v[32:35], v[176:183], v5
    v_add_f32 v61, v61, v63
    s_waitcnt lgkmcnt(2)
    v_smfmac_f32_16x16x64_bf16 v[72:75], v[28:31], v[52:59], v5
    ds_read_b128 v[52:55], v12 offset:10240
    ds_read_b128 v[56:59], v12 offset:11264
    v_smfmac_f32_16x16x64_bf16 v[64:67], v[36:39], v[184:191], v5
    v_cvt_pk_bf16_f32 v104, v60, v61
    v_smfmac_f32_16x16x64_bf16 v[64:67], v[40:43], v[192:199], v5
    v_mov_b32 v60, 0
    v_smfmac_f32_16x16x64_bf16 v[68:71], v[16:19], v[200:207], v5
    v_mov_b32 v61, 0
    s_waitcnt lgkmcnt(2)
    v_smfmac_f32_16x16x64_bf16 v[72:75], v[32:35], v[44:51], v5
    ds_read_b128 v[44:47], v12 offset:12288
    ds_read_b128 v[48:51], v12 offset:13312
    v_smfmac_f32_16x16x64_bf16 v[68:71], v[20:23], v[208:215], v5
    v_mov_b32 v62, 0
    v_smfmac_f32_16x16x64_bf16 v[68:71], v[24:27], v[216:223], v5
    v_mov_b32 v63, 0
    v_smfmac_f32_16x16x64_bf16 v[68:71], v[28:31], v[224:231], v5
    v_add_f32 v64, v64, v66
    s_waitcnt lgkmcnt(2)
    v_smfmac_f32_16x16x64_bf16 v[72:75], v[36:39], v[52:59], v5
    v_smfmac_f32_16x16x64_bf16 v[68:71], v[32:35], v[232:239], v5
    v_add_f32 v65, v65, v67
    v_smfmac_f32_16x16x64_bf16 v[68:71], v[36:39], v[240:247], v5
    v_cvt_pk_bf16_f32 v105, v64, v65
    v_smfmac_f32_16x16x64_bf16 v[68:71], v[40:43], v[248:255], v5
    s_waitcnt lgkmcnt(0)
    v_smfmac_f32_16x16x64_bf16 v[72:75], v[40:43], v[44:51], v5
    s_nop 5
    v_add_f32 v68, v68, v70
    v_add_f32 v69, v69, v71
    v_cvt_pk_bf16_f32 v108, v68, v69
    v_add_f32 v72, v72, v74
    v_add_f32 v73, v73, v75
    v_cvt_pk_bf16_f32 v109, v72, v73
    v_mov_b32 v106, v108
    v_mov_b32 v107, v109
    s_lshl_b32 s8, s82, 12
    s_add_u32 s8, s8, 91636736
    buffer_store_dwordx4 v[104:107], v1, s[44:47], s8 offen sc1
    s_waitcnt vmcnt(0)
    s_barrier
    s_endpgm
ch1bf_mp1:
    buffer_load_dwordx4 v[28:31], v1, s[44:47], s65 offen offset:1024 sc1
    s_add_u32 s83, s83, 1
    s_cmp_ge_u32 s83, 2000000
    s_cbranch_scc1 chain_abort
    s_waitcnt vmcnt(1)
    v_max3_u32 v2, v28, v29, v30
    v_max_u32 v2, v2, v31
    v_cmp_eq_u32 vcc, -1, v2
    s_cbranch_vccnz ch1bf_mp1
    s_branch ch1bf_mok
ch1bf_m0bad:
    s_cbranch_vccnz ch1bf_mp
ch1bf_mp0:
    buffer_load_dwordx4 v[24:27], v1, s[44:47], s65 offen offset:0 sc1
    s_add_u32 s83, s83, 1
    s_cmp_ge_u32 s83, 2000000
    s_cbranch_scc1 chain_abort
    s_waitcnt vmcnt(1)
    v_max3_u32 v2, v24, v25, v26
    v_max_u32 v2, v2, v27
    v_cmp_eq_u32 vcc, -1, v2
    s_cbranch_vccnz ch1bf_mp0
    s_branch ch1bf_mok
ch1bf_hl:
    buffer_load_dword v15, off, s[44:47], s73 sc1
    s_branch ch1bf_hs
ch1bf_hu:
    v_readfirstlane_b32 s9, v15
    s_max_u32 s100, s100, s9
    s_branch ch1bf_hv
ch1bf_nw:
    v_lshlrev_b32 v100, 7, v0
    s_mov_b32 s99, 0
hz_168:
    buffer_load_dword v101, v100, s[44:47], s75 offen sc1
    s_waitcnt vmcnt(0)
    v_cmp_gt_u32 vcc, 28, v101
    s_ff1_i32_b64 s100, vcc
    s_cmp_eq_u32 s100, -1
    s_cselect_b32 s100, 65, s100
    s_sub_u32 s100, s100, 1
    s_cmp_gt_i32 s100, s64
    s_cbranch_scc1 hd_169
    s_sleep 1
    s_add_u32 s99, s99, 1
    s_cmp_lt_u32 s99, 400000
    s_cbranch_scc1 hz_168
    s_branch chain_abort
hd_169:
    s_branch ch1bf_nw2
ch1bf_k0:
    s_cmp_eq_u32 s98, 1
    s_cbranch_scc1 ch1bf_w2d
    s_cmp_ge_u32 s64, s100
    s_cbranch_scc1 ch1bf_vw
ch1bf_vok:
    s_mov_b32 m0, 20480
    s_waitcnt lgkmcnt(0)
    buffer_load_dwordx4 v1, s[44:47], s71 offen offset:0 sc1 lds
    buffer_load_dwordx4 v1, s[44:47], s71 offen offset:1024 sc1 lds
    s_branch ch1bf_w2d
ch1bf_i0:
    buffer_load_dwordx4 v[76:79], v1, s[44:47], s67 offen offset:0 sc1
    buffer_load_dwordx4 v[84:87], v1, s[44:47], s67 offen offset:2048 sc1
    s_add_u32 s83, s83, 1
    s_branch ch1bf_q120
ch1bf_i1:
    buffer_load_dwordx4 v[80:83], v1, s[44:47], s67 offen offset:1024 sc1
    buffer_load_dwordx4 v[88:91], v1, s[44:47], s67 offen offset:3072 sc1
    s_add_u32 s83, s83, 1
    s_branch ch1bf_q21
ch1bf_i2:
    buffer_load_dwordx4 v[92:95], v10, s[44:47], s67 offen offset:0 sc1
    s_add_u32 s83, s83, 1
    s_branch ch1bf_q2
ch1bf_q0:
    s_waitcnt vmcnt(0)
    v_fma_mix_f32 v102, v76, 1.0, v84 op_sel:[0,0,0] op_sel_hi:[1,0,1]
    v_fma_mix_f32 v84, v76, 1.0, v84 op_sel:[1,0,1] op_sel_hi:[1,0,1]
    v_fma_mix_f32 v76, v77, 1.0, v85 op_sel:[0,0,0] op_sel_hi:[1,0,1]
    v_fma_mix_f32 v85, v77, 1.0, v85 op_sel:[1,0,1] op_sel_hi:[1,0,1]
    v_fma_mix_f32 v77, v78, 1.0, v86 op_sel:[0,0,0] op_sel_hi:[1,0,1]
    v_fma_mix_f32 v86, v78, 1.0, v86 op_sel:[1,0,1] op_sel_hi:[1,0,1]
    v_fma_mix_f32 v78, v79, 1.0, v87 op_sel:[0,0,0] op_sel_hi:[1,0,1]
    v_fma_mix_f32 v87, v79, 1.0, v87 op_sel:[1,0,1] op_sel_hi:[1,0,1]
    v_maximum3_f32 v112, v84, v85, v86
    v_cmp_u_f32 vcc, v112, v87
    v_exp_f32 v76, v76
    v_exp_f32 v77, v77
    v_exp_f32 v78, v78
    s_cbranch_vccnz ch1bf_q0_e
    v_exp_f32 v79, v102
    v_exp_f32 v84, v84
    v_exp_f32 v85, v85
    v_pk_add_f32 v[96:97], v[76:77], v[78:79]
    v_exp_f32 v86, v86
    v_exp_f32 v87, v87
    v_pk_add_f32 v[96:97], v[96:97], v[84:85]
    v_pk_add_f32 v[96:97], v[96:97], v[86:87]
    s_branch ch1bf_k0
ch1bf_q0_e:
    buffer_load_dwordx4 v[76:79], v1, s[44:47], s67 offen offset:0 sc1
    buffer_load_dwordx4 v[84:87], v1, s[44:47], s67 offen offset:2048 sc1
    s_add_u32 s83, s83, 1
    s_and_b32 s8, s83, 63
    s_cmp_eq_u32 s8, 0
    s_cbranch_scc1 ch1bf_x
    s_branch ch1bf_q0
ch1bf_q1:
    s_waitcnt vmcnt(0)
    v_fma_mix_f32 v103, v80, 1.0, v88 op_sel:[0,0,0] op_sel_hi:[1,0,1]
    v_fma_mix_f32 v88, v80, 1.0, v88 op_sel:[1,0,1] op_sel_hi:[1,0,1]
    v_fma_mix_f32 v80, v81, 1.0, v89 op_sel:[0,0,0] op_sel_hi:[1,0,1]
    v_fma_mix_f32 v89, v81, 1.0, v89 op_sel:[1,0,1] op_sel_hi:[1,0,1]
    v_fma_mix_f32 v81, v82, 1.0, v90 op_sel:[0,0,0] op_sel_hi:[1,0,1]
    v_fma_mix_f32 v90, v82, 1.0, v90 op_sel:[1,0,1] op_sel_hi:[1,0,1]
    v_fma_mix_f32 v82, v83, 1.0, v91 op_sel:[0,0,0] op_sel_hi:[1,0,1]
    v_fma_mix_f32 v91, v83, 1.0, v91 op_sel:[1,0,1] op_sel_hi:[1,0,1]
    v_maximum3_f32 v114, v88, v89, v90
    v_cmp_u_f32 vcc, v114, v91
    v_exp_f32 v80, v80
    v_exp_f32 v81, v81
    v_exp_f32 v82, v82
    s_cbranch_vccnz ch1bf_q1_e
    v_exp_f32 v83, v103
    v_exp_f32 v88, v88
    v_exp_f32 v89, v89
    v_pk_add_f32 v[98:99], v[80:81], v[82:83]
    v_exp_f32 v90, v90
    v_exp_f32 v91, v91
    v_pk_add_f32 v[98:99], v[98:99], v[88:89]
    v_pk_add_f32 v[98:99], v[98:99], v[90:91]
    s_branch ch1bf_k0
ch1bf_q1_e:
    buffer_load_dwordx4 v[80:83], v1, s[44:47], s67 offen offset:1024 sc1
    buffer_load_dwordx4 v[88:91], v1, s[44:47], s67 offen offset:3072 sc1
    s_add_u32 s83, s83, 1
    s_and_b32 s8, s83, 63
    s_cmp_eq_u32 s8, 0
    s_cbranch_scc1 ch1bf_x
    s_branch ch1bf_q1
ch1bf_q2:
    s_waitcnt vmcnt(0)
    v_fma_mix_f32 v113, v92, 1.0, v94 op_sel:[0,0,0] op_sel_hi:[1,0,1]
    v_fma_mix_f32 v94, v92, 1.0, v94 op_sel:[1,0,1] op_sel_hi:[1,0,1]
    v_fma_mix_f32 v92, v93, 1.0, v95 op_sel:[0,0,0] op_sel_hi:[1,0,1]
    v_fma_mix_f32 v95, v93, 1.0, v95 op_sel:[1,0,1] op_sel_hi:[1,0,1]
    v_cmp_u_f32 vcc, v94, v95
    v_exp_f32 v92, v92
    v_exp_f32 v93, v113
    v_exp_f32 v94, v94
    s_cbranch_vccnz ch1bf_q2_e
    v_exp_f32 v95, v95
    s_nop 0
    v_pk_add_f32 v[100:101], v[92:93], v[94:95]
    s_branch ch1bf_k0
ch1bf_q2_e:
    buffer_load_dwordx4 v[92:95], v10, s[44:47], s67 offen offset:0 sc1
    s_add_u32 s83, s83, 1
    s_and_b32 s8, s83, 63
    s_cmp_eq_u32 s8, 0
    s_cbranch_scc1 ch1bf_x
    s_branch ch1bf_q2
ch1bf_q01:
    s_waitcnt vmcnt(2)
    v_fma_mix_f32 v102, v76, 1.0, v84 op_sel:[0,0,0] op_sel_hi:[1,0,1]
    v_fma_mix_f32 v84, v76, 1.0, v84 op_sel:[1,0,1] op_sel_hi:[1,0,1]
    v_fma_mix_f32 v76, v77, 1.0, v85 op_sel:[0,0,0] op_sel_hi:[1,0,1]
    v_fma_mix_f32 v85, v77, 1.0, v85 op_sel:[1,0,1] op_sel_hi:[1,0,1]
    v_fma_mix_f32 v77, v78, 1.0, v86 op_sel:[0,0,0] op_sel_hi:[1,0,1]
    v_fma_mix_f32 v86, v78, 1.0, v86 op_sel:[1,0,1] op_sel_hi:[1,0,1]
    v_fma_mix_f32 v78, v79, 1.0, v87 op_sel:[0,0,0] op_sel_hi:[1,0,1]
    v_fma_mix_f32 v87, v79, 1.0, v87 op_sel:[1,0,1] op_sel_hi:[1,0,1]
    v_maximum3_f32 v112, v84, v85, v86
    v_cmp_u_f32 vcc, v112, v87
    v_exp_f32 v76, v76
    v_exp_f32 v77, v77
    v_exp_f32 v78, v78
    s_cbranch_vccnz ch1bf_q01_e
    v_exp_f32 v79, v102
    v_exp_f32 v84, v84
    v_exp_f32 v85, v85
    v_pk_add_f32 v[96:97], v[76:77], v[78:79]
    v_exp_f32 v86, v86
    v_exp_f32 v87, v87
    v_pk_add_f32 v[96:97], v[96:97], v[84:85]
    v_pk_add_f32 v[96:97], v[96:97], v[86:87]
    s_branch ch1bf_q1
ch1bf_q01_e:
    buffer_load_dwordx4 v[76:79], v1, s[44:47], s67 offen offset:0 sc1
    buffer_load_dwordx4 v[84:87], v1, s[44:47], s67 offen offset:2048 sc1
    s_add_u32 s83, s83, 1
    s_and_b32 s8, s83, 63
    s_cmp_eq_u32 s8, 0
    s_cbranch_scc1 ch1bf_x
    s_branch ch1bf_q10
ch1bf_q02:
    s_waitcnt vmcnt(1)
    v_fma_mix_f32 v102, v76, 1.0, v84 op_sel:[0,0,0] op_sel_hi:[1,0,1]
    v_fma_mix_f32 v84, v76, 1.0, v84 op_sel:[1,0,1] op_sel_hi:[1,0,1]
    v_fma_mix_f32 v76, v77, 1.0, v85 op_sel:[0,0,0] op_sel_hi:[1,0,1]
    v_fma_mix_f32 v85, v77, 1.0, v85 op_sel:[1,0,1] op_sel_hi:[1,0,1]
    v_fma_mix_f32 v77, v78, 1.0, v86 op_sel:[0,0,0] op_sel_hi:[1,0,1]
    v_fma_mix_f32 v86, v78, 1.0, v86 op_sel:[1,0,1] op_sel_hi:[1,0,1]
    v_fma_mix_f32 v78, v79, 1.0, v87 op_sel:[0,0,0] op_sel_hi:[1,0,1]
    v_fma_mix_f32 v87, v79, 1.0, v87 op_sel:[1,0,1] op_sel_hi:[1,0,1]
    v_maximum3_f32 v112, v84, v85, v86
    v_cmp_u_f32 vcc, v112, v87
    v_exp_f32 v76, v76
    v_exp_f32 v77, v77
    v_exp_f32 v78, v78
    s_cbranch_vccnz ch1bf_q02_e
    v_exp_f32 v79, v102
    v_exp_f32 v84, v84
    v_exp_f32 v85, v85
    v_pk_add_f32 v[96:97], v[76:77], v[78:79]
    v_exp_f32 v86, v86
    v_exp_f32 v87, v87
    v_pk_add_f32 v[96:97], v[96:97], v[84:85]
    v_pk_add_f32 v[96:97], v[96:97], v[86:87]
    s_branch ch1bf_q2
ch1bf_q02_e:
    buffer_load_dwordx4 v[76:79], v1, s[44:47], s67 offen offset:0 sc1
    buffer_load_dwordx4 v[84:87], v1, s[44:47], s67 offen offset:2048 sc1
    s_add_u32 s83, s83, 1
    s_and_b32 s8, s83, 63
    s_cmp_eq_u32 s8, 0
    s_cbranch_scc1 ch1bf_x
    s_branch ch1bf_q20
ch1bf_q10:
    s_waitcnt vmcnt(2)
    v_fma_mix_f32 v103, v80, 1.0, v88 op_sel:[0,0,0] op_sel_hi:[1,0,1]
    v_fma_mix_f32 v88, v80, 1.0, v88 op_sel:[1,0,1] op_sel_hi:[1,0,1]
    v_fma_mix_f32 v80, v81, 1.0, v89 op_sel:[0,0,0] op_sel_hi:[1,0,1]
    v_fma_mix_f32 v89, v81, 1.0, v89 op_sel:[1,0,1] op_sel_hi:[1,0,1]
    v_fma_mix_f32 v81, v82, 1.0, v90 op_sel:[0,0,0] op_sel_hi:[1,0,1]
    v_fma_mix_f32 v90, v82, 1.0, v90 op_sel:[1,0,1] op_sel_hi:[1,0,1]
    v_fma_mix_f32 v82, v83, 1.0, v91 op_sel:[0,0,0] op_sel_hi:[1,0,1]
    v_fma_mix_f32 v91, v83, 1.0, v91 op_sel:[1,0,1] op_sel_hi:[1,0,1]
    v_maximum3_f32 v114, v88, v89, v90
    v_cmp_u_f32 vcc, v114, v91
    v_exp_f32 v80, v80
    v_exp_f32 v81, v81
    v_exp_f32 v82, v82
    s_cbranch_vccnz ch1bf_q10_e
    v_exp_f32 v83, v103
    v_exp_f32 v88, v88
    v_exp_f32 v89, v89
    v_pk_add_f32 v[98:99], v[80:81], v[82:83]
    v_exp_f32 v90, v90
    v_exp_f32 v91, v91
    v_pk_add_f32 v[98:99], v[98:99], v[88:89]
    v_pk_add_f32 v[98:99], v[98:99], v[90:91]
    s_branch ch1bf_q0
ch1bf_q10_e:
    buffer_load_dwordx4 v[80:83], v1, s[44:47], s67 offen offset:1024 sc1
    buffer_load_dwordx4 v[88:91], v1, s[44:47], s67 offen offset:3072 sc1
    s_add_u32 s83, s83, 1
    s_and_b32 s8, s83, 63
    s_cmp_eq_u32 s8, 0
    s_cbranch_scc1 ch1bf_x
    s_branch ch1bf_q01
ch1bf_q12:
    s_waitcnt vmcnt(1)
    v_fma_mix_f32 v103, v80, 1.0, v88 op_sel:[0,0,0] op_sel_hi:[1,0,1]
    v_fma_mix_f32 v88, v80, 1.0, v88 op_sel:[1,0,1] op_sel_hi:[1,0,1]
    v_fma_mix_f32 v80, v81, 1.0, v89 op_sel:[0,0,0] op_sel_hi:[1,0,1]
    v_fma_mix_f32 v89, v81, 1.0, v89 op_sel:[1,0,1] op_sel_hi:[1,0,1]
    v_fma_mix_f32 v81, v82, 1.0, v90 op_sel:[0,0,0] op_sel_hi:[1,0,1]
    v_fma_mix_f32 v90, v82, 1.0, v90 op_sel:[1,0,1] op_sel_hi:[1,0,1]
    v_fma_mix_f32 v82, v83, 1.0, v91 op_sel:[0,0,0] op_sel_hi:[1,0,1]
    v_fma_mix_f32 v91, v83, 1.0, v91 op_sel:[1,0,1] op_sel_hi:[1,0,1]
    v_maximum3_f32 v114, v88, v89, v90
    v_cmp_u_f32 vcc, v114, v91
    v_exp_f32 v80, v80
    v_exp_f32 v81, v81
    v_exp_f32 v82, v82
    s_cbranch_vccnz ch1bf_q12_e
    v_exp_f32 v83, v103
    v_exp_f32 v88, v88
    v_exp_f32 v89, v89
    v_pk_add_f32 v[98:99], v[80:81], v[82:83]
    v_exp_f32 v90, v90
    v_exp_f32 v91, v91
    v_pk_add_f32 v[98:99], v[98:99], v[88:89]
    v_pk_add_f32 v[98:99], v[98:99], v[90:91]
    s_branch ch1bf_q2
ch1bf_q12_e:
    buffer_load_dwordx4 v[80:83], v1, s[44:47], s67 offen offset:1024 sc1
    buffer_load_dwordx4 v[88:91], v1, s[44:47], s67 offen offset:3072 sc1
    s_add_u32 s83, s83, 1
    s_and_b32 s8, s83, 63
    s_cmp_eq_u32 s8, 0
    s_cbranch_scc1 ch1bf_x
    s_branch ch1bf_q21
ch1bf_q20:
    s_waitcnt vmcnt(2)
    v_fma_mix_f32 v113, v92, 1.0, v94 op_sel:[0,0,0] op_sel_hi:[1,0,1]
    v_fma_mix_f32 v94, v92, 1.0, v94 op_sel:[1,0,1] op_sel_hi:[1,0,1]
    v_fma_mix_f32 v92, v93, 1.0, v95 op_sel:[0,0,0] op_sel_hi:[1,0,1]
    v_fma_mix_f32 v95, v93, 1.0, v95 op_sel:[1,0,1] op_sel_hi:[1,0,1]
    v_cmp_u_f32 vcc, v94, v95
    v_exp_f32 v92, v92
    v_exp_f32 v93, v113
    v_exp_f32 v94, v94
    s_cbranch_vccnz ch1bf_q20_e
    v_exp_f32 v95, v95
    s_nop 0
    v_pk_add_f32 v[100:101], v[92:93], v[94:95]
    s_branch ch1bf_q0
ch1bf_q20_e:
    buffer_load_dwordx4 v[92:95], v10, s[44:47], s67 offen offset:0 sc1
    s_add_u32 s83, s83, 1
    s_and_b32 s8, s83, 63
    s_cmp_eq_u32 s8, 0
    s_cbranch_scc1 ch1bf_x
    s_branch ch1bf_q02
ch1bf_q21:
    s_waitcnt vmcnt(2)
    v_fma_mix_f32 v113, v92, 1.0, v94 op_sel:[0,0,0] op_sel_hi:[1,0,1]
    v_fma_mix_f32 v94, v92, 1.0, v94 op_sel:[1,0,1] op_sel_hi:[1,0,1]
    v_fma_mix_f32 v92, v93, 1.0, v95 op_sel:[0,0,0] op_sel_hi:[1,0,1]
    v_fma_mix_f32 v95, v93, 1.0, v95 op_sel:[1,0,1] op_sel_hi:[1,0,1]
    v_cmp_u_f32 vcc, v94, v95
    v_exp_f32 v92, v92
    v_exp_f32 v93, v113
    v_exp_f32 v94, v94
    s_cbranch_vccnz ch1bf_q21_e
    v_exp_f32 v95, v95
    s_nop 0
    v_pk_add_f32 v[100:101], v[92:93], v[94:95]
    s_branch ch1bf_q1
ch1bf_q21_e:
    buffer_load_dwordx4 v[92:95], v10, s[44:47], s67 offen offset:0 sc1
    s_add_u32 s83, s83, 1
    s_and_b32 s8, s83, 63
    s_cmp_eq_u32 s8, 0
    s_cbranch_scc1 ch1bf_x
    s_branch ch1bf_q12
ch1bf_q012:
    s_waitcnt vmcnt(3)
    v_fma_mix_f32 v102, v76, 1.0, v84 op_sel:[0,0,0] op_sel_hi:[1,0,1]
    v_fma_mix_f32 v84, v76, 1.0, v84 op_sel:[1,0,1] op_sel_hi:[1,0,1]
    v_fma_mix_f32 v76, v77, 1.0, v85 op_sel:[0,0,0] op_sel_hi:[1,0,1]
    v_fma_mix_f32 v85, v77, 1.0, v85 op_sel:[1,0,1] op_sel_hi:[1,0,1]
    v_fma_mix_f32 v77, v78, 1.0, v86 op_sel:[0,0,0] op_sel_hi:[1,0,1]
    v_fma_mix_f32 v86, v78, 1.0, v86 op_sel:[1,0,1] op_sel_hi:[1,0,1]
    v_fma_mix_f32 v78, v79, 1.0, v87 op_sel:[0,0,0] op_sel_hi:[1,0,1]
    v_fma_mix_f32 v87, v79, 1.0, v87 op_sel:[1,0,1] op_sel_hi:[1,0,1]
    v_maximum3_f32 v112, v84, v85, v86
    v_cmp_u_f32 vcc, v112, v87
    v_exp_f32 v76, v76
    v_exp_f32 v77, v77
    v_exp_f32 v78, v78
    s_cbranch_vccnz ch1bf_q012_e
    v_exp_f32 v79, v102
    v_exp_f32 v84, v84
    v_exp_f32 v85, v85
    v_pk_add_f32 v[96:97], v[76:77], v[78:79]
    v_exp_f32 v86, v86
    v_exp_f32 v87, v87
    v_pk_add_f32 v[96:97], v[96:97], v[84:85]
    v_pk_add_f32 v[96:97], v[96:97], v[86:87]
    s_branch ch1bf_q12
ch1bf_q012_e:
    buffer_load_dwordx4 v[76:79], v1, s[44:47], s67 offen offset:0 sc1
    buffer_load_dwordx4 v[84:87], v1, s[44:47], s67 offen offset:2048 sc1
    s_add_u32 s83, s83, 1
    s_and_b32 s8, s83, 63
    s_cmp_eq_u32 s8, 0
    s_cbranch_scc1 ch1bf_x
    s_branch ch1bf_q120
ch1bf_q021:
    s_waitcnt vmcnt(3)
    v_fma_mix_f32 v102, v76, 1.0, v84 op_sel:[0,0,0] op_sel_hi:[1,0,1]
    v_fma_mix_f32 v84, v76, 1.0, v84 op_sel:[1,0,1] op_sel_hi:[1,0,1]
    v_fma_mix_f32 v76, v77, 1.0, v85 op_sel:[0,0,0] op_sel_hi:[1,0,1]
    v_fma_mix_f32 v85, v77, 1.0, v85 op_sel:[1,0,1] op_sel_hi:[1,0,1]
    v_fma_mix_f32 v77, v78, 1.0, v86 op_sel:[0,0,0] op_sel_hi:[1,0,1]
    v_fma_mix_f32 v86, v78, 1.0, v86 op_sel:[1,0,1] op_sel_hi:[1,0,1]
    v_fma_mix_f32 v78, v79, 1.0, v87 op_sel:[0,0,0] op_sel_hi:[1,0,1]
    v_fma_mix_f32 v87, v79, 1.0, v87 op_sel:[1,0,1] op_sel_hi:[1,0,1]
    v_maximum3_f32 v112, v84, v85, v86
    v_cmp_u_f32 vcc, v112, v87
    v_exp_f32 v76, v76
    v_exp_f32 v77, v77
    v_exp_f32 v78, v78
    s_cbranch_vccnz ch1bf_q021_e
    v_exp_f32 v79, v102
    v_exp_f32 v84, v84
    v_exp_f32 v85, v85
    v_pk_add_f32 v[96:97], v[76:77], v[78:79]
    v_exp_f32 v86, v86
    v_exp_f32 v87, v87
    v_pk_add_f32 v[96:97], v[96:97], v[84:85]
    v_pk_add_f32 v[96:97], v[96:97], v[86:87]
    s_branch ch1bf_q21
ch1bf_q021_e:
    buffer_load_dwordx4 v[76:79], v1, s[44:47], s67 offen offset:0 sc1
    buffer_load_dwordx4 v[84:87], v1, s[44:47], s67 offen offset:2048 sc1
    s_add_u32 s83, s83, 1
    s_and_b32 s8, s83, 63
    s_cmp_eq_u32 s8, 0
    s_cbranch_scc1 ch1bf_x
    s_branch ch1bf_q210
ch1bf_q102:
    s_waitcnt vmcnt(3)
    v_fma_mix_f32 v103, v80, 1.0, v88 op_sel:[0,0,0] op_sel_hi:[1,0,1]
    v_fma_mix_f32 v88, v80, 1.0, v88 op_sel:[1,0,1] op_sel_hi:[1,0,1]
    v_fma_mix_f32 v80, v81, 1.0, v89 op_sel:[0,0,0] op_sel_hi:[1,0,1]
    v_fma_mix_f32 v89, v81, 1.0, v89 op_sel:[1,0,1] op_sel_hi:[1,0,1]
    v_fma_mix_f32 v81, v82, 1.0, v90 op_sel:[0,0,0] op_sel_hi:[1,0,1]
    v_fma_mix_f32 v90, v82, 1.0, v90 op_sel:[1,0,1] op_sel_hi:[1,0,1]
    v_fma_mix_f32 v82, v83, 1.0, v91 op_sel:[0,0,0] op_sel_hi:[1,0,1]
    v_fma_mix_f32 v91, v83, 1.0, v91 op_sel:[1,0,1] op_sel_hi:[1,0,1]
    v_maximum3_f32 v114, v88, v89, v90
    v_cmp_u_f32 vcc, v114, v91
    v_exp_f32 v80, v80
    v_exp_f32 v81, v81
    v_exp_f32 v82, v82
    s_cbranch_vccnz ch1bf_q102_e
    v_exp_f32 v83, v103
    v_exp_f32 v88, v88
    v_exp_f32 v89, v89
    v_pk_add_f32 v[98:99], v[80:81], v[82:83]
    v_exp_f32 v90, v90
    v_exp_f32 v91, v91
    v_pk_add_f32 v[98:99], v[98:99], v[88:89]
    v_pk_add_f32 v[98:99], v[98:99], v[90:91]
    s_branch ch1bf_q02
ch1bf_q102_e:
    buffer_load_dwordx4 v[80:83], v1, s[44:47], s67 offen offset:1024 sc1
    buffer_load_dwordx4 v[88:91], v1, s[44:47], s67 offen offset:3072 sc1
    s_add_u32 s83, s83, 1
    s_and_b32 s8, s83, 63
    s_cmp_eq_u32 s8, 0
    s_cbranch_scc1 ch1bf_x
    s_branch ch1bf_q021
ch1bf_q120:
    s_waitcnt vmcnt(3)
    v_fma_mix_f32 v103, v80, 1.0, v88 op_sel:[0,0,0] op_sel_hi:[1,0,1]
    v_fma_mix_f32 v88, v80, 1.0, v88 op_sel:[1,0,1] op_sel_hi:[1,0,1]
    v_fma_mix_f32 v80, v81, 1.0, v89 op_sel:[0,0,0] op_sel_hi:[1,0,1]
    v_fma_mix_f32 v89, v81, 1.0, v89 op_sel:[1,0,1] op_sel_hi:[1,0,1]
    v_fma_mix_f32 v81, v82, 1.0, v90 op_sel:[0,0,0] op_sel_hi:[1,0,1]
    v_fma_mix_f32 v90, v82, 1.0, v90 op_sel:[1,0,1] op_sel_hi:[1,0,1]
    v_fma_mix_f32 v82, v83, 1.0, v91 op_sel:[0,0,0] op_sel_hi:[1,0,1]
    v_fma_mix_f32 v91, v83, 1.0, v91 op_sel:[1,0,1] op_sel_hi:[1,0,1]
    v_maximum3_f32 v114, v88, v89, v90
    v_cmp_u_f32 vcc, v114, v91
    v_exp_f32 v80, v80
    v_exp_f32 v81, v81
    v_exp_f32 v82, v82
    s_cbranch_vccnz ch1bf_q120_e
    v_exp_f32 v83, v103
    v_exp_f32 v88, v88
    v_exp_f32 v89, v89
    v_pk_add_f32 v[98:99], v[80:81], v[82:83]
    v_exp_f32 v90, v90
    v_exp_f32 v91, v91
    v_pk_add_f32 v[98:99], v[98:99], v[88:89]
    v_pk_add_f32 v[98:99], v[98:99], v[90:91]
    s_branch ch1bf_q20
ch1bf_q120_e:
    buffer_load_dwordx4 v[80:83], v1, s[44:47], s67 offen offset:1024 sc1
    buffer_load_dwordx4 v[88:91], v1, s[44:47], s67 offen offset:3072 sc1
    s_add_u32 s83, s83, 1
    s_and_b32 s8, s83, 63
    s_cmp_eq_u32 s8, 0
    s_cbranch_scc1 ch1bf_x
    s_branch ch1bf_q201
ch1bf_q201:
    s_waitcnt vmcnt(4)
    v_fma_mix_f32 v113, v92, 1.0, v94 op_sel:[0,0,0] op_sel_hi:[1,0,1]
    v_fma_mix_f32 v94, v92, 1.0, v94 op_sel:[1,0,1] op_sel_hi:[1,0,1]
    v_fma_mix_f32 v92, v93, 1.0, v95 op_sel:[0,0,0] op_sel_hi:[1,0,1]
    v_fma_mix_f32 v95, v93, 1.0, v95 op_sel:[1,0,1] op_sel_hi:[1,0,1]
    v_cmp_u_f32 vcc, v94, v95
    v_exp_f32 v92, v92
    v_exp_f32 v93, v113
    v_exp_f32 v94, v94
    s_cbranch_vccnz ch1bf_q201_e
    v_exp_f32 v95, v95
    s_nop 0
    v_pk_add_f32 v[100:101], v[92:93], v[94:95]
    s_branch ch1bf_q01
ch1bf_q201_e:
    buffer_load_dwordx4 v[92:95], v10, s[44:47], s67 offen offset:0 sc1
    s_add_u32 s83, s83, 1
    s_and_b32 s8, s83, 63
    s_cmp_eq_u32 s8, 0
    s_cbranch_scc1 ch1bf_x
    s_branch ch1bf_q012
ch1bf_q210:
    s_waitcnt vmcnt(4)
    v_fma_mix_f32 v113, v92, 1.0, v94 op_sel:[0,0,0] op_sel_hi:[1,0,1]
    v_fma_mix_f32 v94, v92, 1.0, v94 op_sel:[1,0,1] op_sel_hi:[1,0,1]
    v_fma_mix_f32 v92, v93, 1.0, v95 op_sel:[0,0,0] op_sel_hi:[1,0,1]
    v_fma_mix_f32 v95, v93, 1.0, v95 op_sel:[1,0,1] op_sel_hi:[1,0,1]
    v_cmp_u_f32 vcc, v94, v95
    v_exp_f32 v92, v92
    v_exp_f32 v93, v113
    v_exp_f32 v94, v94
    s_cbranch_vccnz ch1bf_q210_e
    v_exp_f32 v95, v95
    v_pk_add_f32 v[100:101], v[92:93], v[94:95]
    s_branch ch1bf_q10
ch1bf_q210_e:
    buffer_load_dwordx4 v[92:95], v10, s[44:47], s67 offen offset:0 sc1
    s_add_u32 s83, s83, 1
    s_and_b32 s8, s83, 63
    s_cmp_eq_u32 s8, 0
    s_cbranch_scc1 ch1bf_x
    s_branch ch1bf_q102
ch1bf_fb:
    buffer_load_dwordx4 v[76:79], v1, s[44:47], s67 offen offset:0 sc1
    buffer_load_dwordx4 v[84:87], v1, s[44:47], s67 offen offset:2048 sc1
    buffer_load_dwordx4 v[80:83], v1, s[44:47], s67 offen offset:1024 sc1
    buffer_load_dwordx4 v[88:91], v1, s[44:47], s67 offen offset:3072 sc1
    buffer_load_dwordx4 v[92:95], v10, s[44:47], s67 offen offset:0 sc1
    s_waitcnt vmcnt(0)
    v_fma_mix_f32 v102, v76, 1.0, v84 op_sel:[0,0,0] op_sel_hi:[1,0,1]
    v_fma_mix_f32 v84, v76, 1.0, v84 op_sel:[1,0,1] op_sel_hi:[1,0,1]
    v_fma_mix_f32 v76, v77, 1.0, v85 op_sel:[0,0,0] op_sel_hi:[1,0,1]
    v_fma_mix_f32 v85, v77, 1.0, v85 op_sel:[1,0,1] op_sel_hi:[1,0,1]
    v_fma_mix_f32 v77, v78, 1.0, v86 op_sel:[0,0,0] op_sel_hi:[1,0,1]
    v_fma_mix_f32 v86, v78, 1.0, v86 op_sel:[1,0,1] op_sel_hi:[1,0,1]
    v_fma_mix_f32 v78, v79, 1.0, v87 op_sel:[0,0,0] op_sel_hi:[1,0,1]
    v_fma_mix_f32 v87, v79, 1.0, v87 op_sel:[1,0,1] op_sel_hi:[1,0,1]
    v_maximum3_f32 v112, v102, v84, v76
    v_maximum3_f32 v112, v112, v85, v77
    v_maximum3_f32 v112, v112, v86, v78
    v_maximum3_f32 v112, v112, v87, v87
    v_cmp_u_f32 vcc, v112, v112
    v_mov_b32 v79, v102
    v_pk_add_f32 v[76:77], v[76:77], v[112:113] op_sel_hi:[1,0] neg_lo:[0,1] neg_hi:[0,1]
    v_pk_add_f32 v[78:79], v[78:79], v[112:113] op_sel_hi:[1,0] neg_lo:[0,1] neg_hi:[0,1]
    v_pk_add_f32 v[84:85], v[84:85], v[112:113] op_sel_hi:[1,0] neg_lo:[0,1] neg_hi:[0,1]
    v_pk_add_f32 v[86:87], v[86:87], v[112:113] op_sel_hi:[1,0] neg_lo:[0,1] neg_hi:[0,1]
    v_exp_f32 v76, v76
    v_exp_f32 v77, v77
    v_exp_f32 v78, v78
    v_exp_f32 v79, v79
    v_exp_f32 v84, v84
    v_exp_f32 v85, v85
    v_pk_add_f32 v[96:97], v[76:77], v[78:79]
    v_exp_f32 v86, v86
    v_exp_f32 v87, v87
    v_pk_add_f32 v[96:97], v[96:97], v[84:85]
    v_pk_add_f32 v[96:97], v[96:97], v[86:87]
    v_fma_mix_f32 v103, v80, 1.0, v88 op_sel:[0,0,0] op_sel_hi:[1,0,1]
    v_fma_mix_f32 v88, v80, 1.0, v88 op_sel:[1,0,1] op_sel_hi:[1,0,1]
    v_fma_mix_f32 v80, v81, 1.0, v89 op_sel:[0,0,0] op_sel_hi:[1,0,1]
    v_fma_mix_f32 v89, v81, 1.0, v89 op_sel:[1,0,1] op_sel_hi:[1,0,1]
    v_fma_mix_f32 v81, v82, 1.0, v90 op_sel:[0,0,0] op_sel_hi:[1,0,1]
    v_fma_mix_f32 v90, v82, 1.0, v90 op_sel:[1,0,1] op_sel_hi:[1,0,1]
    v_fma_mix_f32 v82, v83, 1.0, v91 op_sel:[0,0,0] op_sel_hi:[1,0,1]
    v_fma_mix_f32 v91, v83, 1.0, v91 op_sel:[1,0,1] op_sel_hi:[1,0,1]
    v_maximum3_f32 v114, v103, v88, v80
    v_maximum3_f32 v114, v114, v89, v81
    v_maximum3_f32 v114, v114, v90, v82
    v_maximum3_f32 v114, v114, v91, v91
    v_cmp_u_f32 vcc, v114, v114
    v_mov_b32 v83, v103
    v_pk_add_f32 v[80:81], v[80:81], v[114:115] op_sel_hi:[1,0] neg_lo:[0,1] neg_hi:[0,1]
    v_pk_add_f32 v[82:83], v[82:83], v[114:115] op_sel_hi:[1,0] neg_lo:[0,1] neg_hi:[0,1]
    v_pk_add_f32 v[88:89], v[88:89], v[114:115] op_sel_hi:[1,0] neg_lo:[0,1] neg_hi:[0,1]
    v_pk_add_f32 v[90:91], v[90:91], v[114:115] op_sel_hi:[1,0] neg_lo:[0,1] neg_hi:[0,1]
    v_exp_f32 v80, v80
    v_exp_f32 v81, v81
    v_exp_f32 v82, v82
    v_exp_f32 v83, v83
    v_exp_f32 v88, v88
    v_exp_f32 v89, v89
    v_pk_add_f32 v[98:99], v[80:81], v[82:83]
    v_exp_f32 v90, v90
    v_exp_f32 v91, v91
    v_pk_add_f32 v[98:99], v[98:99], v[88:89]
    v_pk_add_f32 v[98:99], v[98:99], v[90:91]
    v_fma_mix_f32 v113, v92, 1.0, v94 op_sel:[0,0,0] op_sel_hi:[1,0,1]
    v_fma_mix_f32 v94, v92, 1.0, v94 op_sel:[1,0,1] op_sel_hi:[1,0,1]
    v_fma_mix_f32 v92, v93, 1.0, v95 op_sel:[0,0,0] op_sel_hi:[1,0,1]
    v_fma_mix_f32 v95, v93, 1.0, v95 op_sel:[1,0,1] op_sel_hi:[1,0,1]
    v_maximum3_f32 v116, v113, v94, v92
    v_maximum3_f32 v116, v116, v95, v95
    v_cmp_u_f32 vcc, v116, v116
    v_mov_b32 v93, v113
    v_pk_add_f32 v[92:93], v[92:93], v[116:117] op_sel_hi:[1,0] neg_lo:[0,1] neg_hi:[0,1]
    v_pk_add_f32 v[94:95], v[94:95], v[116:117] op_sel_hi:[1,0] neg_lo:[0,1] neg_hi:[0,1]
    v_exp_f32 v92, v92
    v_exp_f32 v93, v93
    v_exp_f32 v94, v94
    v_exp_f32 v95, v95
    s_nop 0
    v_pk_add_f32 v[100:101], v[92:93], v[94:95]
    v_max3_f32 v2, v112, v114, v116
    v_max3_f32 v15, v112, v114, v116
    v_add_f32 v96, v96, v97
    v_add_f32 v98, v98, v99
    v_add_f32 v100, v100, v101
    v_permlane16_swap_b32 v2, v15
    v_max_f32 v2, v2, v15
    v_sub_f32 v112, v112, v2
    v_sub_f32 v114, v114, v2
    v_sub_f32 v116, v116, v2
    v_exp_f32 v112, v112
    v_exp_f32 v114, v114
    v_exp_f32 v116, v116
    v_mul_f32 v2, v112, v96
    v_fmac_f32 v2, v114, v98
    v_fmac_f32 v2, v116, v100
    v_mov_b32 v15, v2
    s_nop 1
    v_permlane16_swap_b32 v2, v15
    v_add_f32 v2, v2, v15
    v_rcp_f32 v2, v2
    s_nop 0
    v_mul_f32 v116, v116, v2
    v_mul_f32 v112, v112, v2
    v_mul_f32 v114, v114, v2
    s_waitcnt lgkmcnt(0)
    v_pk_mul_f32 v[92:93], v[92:93], v[116:117] op_sel_hi:[1,0]
    v_pk_mul_f32 v[94:95], v[94:95], v[116:117] op_sel_hi:[1,0]
    v_cvt_pk_bf16_f32 v116, v93, v94
    v_cvt_pk_bf16_f32 v118, v92, v95
    v_pk_mul_f32 v[76:77], v[76:77], v[112:113] op_sel_hi:[1,0]
    v_pk_mul_f32 v[78:79], v[78:79], v[112:113] op_sel_hi:[1,0]
    v_pk_mul_f32 v[84:85], v[84:85], v[112:113] op_sel_hi:[1,0]
    v_pk_mul_f32 v[86:87], v[86:87], v[112:113] op_sel_hi:[1,0]
    v_cvt_pk_bf16_f32 v96, v79, v84
    v_cvt_pk_bf16_f32 v97, v76, v85
    v_cvt_pk_bf16_f32 v98, v77, v86
    v_cvt_pk_bf16_f32 v99, v78, v87
    v_pk_mul_f32 v[80:81], v[80:81], v[114:115] op_sel_hi:[1,0]
    v_pk_mul_f32 v[82:83], v[82:83], v[114:115] op_sel_hi:[1,0]
    v_pk_mul_f32 v[88:89], v[88:89], v[114:115] op_sel_hi:[1,0]
    v_pk_mul_f32 v[90:91], v[90:91], v[114:115] op_sel_hi:[1,0]
    v_smfmac_f32_16x16x64_bf16 v[60:63], v[116:119], v[104:111], v5
    v_cvt_pk_bf16_f32 v100, v83, v88
    v_cvt_pk_bf16_f32 v101, v80, v89
    v_smfmac_f32_16x16x64_bf16 v[60:63], v[96:99], v[44:51], v5
    v_cvt_pk_bf16_f32 v102, v81, v90
    v_cvt_pk_bf16_f32 v103, v82, v91
    s_nop 1
    v_smfmac_f32_16x16x64_bf16 v[60:63], v[100:103], v[52:59], v5
    s_branch ch1bf_kj
ch1bf_x:
    s_cmp_ge_u32 s83, 2000000
    s_cbranch_scc1 chain_abort
    buffer_load_dwordx4 v[76:79], v1, s[44:47], s67 offen offset:0 sc1
    buffer_load_dwordx4 v[84:87], v1, s[44:47], s67 offen offset:2048 sc1
    buffer_load_dwordx4 v[80:83], v1, s[44:47], s67 offen offset:1024 sc1
    buffer_load_dwordx4 v[88:91], v1, s[44:47], s67 offen offset:3072 sc1
    buffer_load_dwordx4 v[92:95], v10, s[44:47], s67 offen offset:0 sc1
    s_waitcnt vmcnt(0)
    v_pk_max_u16 v2, v76, v77
    v_pk_max_u16 v2, v2, v78
    v_pk_max_u16 v2, v2, v79
    v_pk_max_u16 v2, v2, v80
    v_pk_max_u16 v2, v2, v81
    v_pk_max_u16 v2, v2, v82
    v_pk_max_u16 v2, v2, v83
    v_pk_max_u16 v2, v2, v84
    v_pk_max_u16 v2, v2, v85
    v_pk_max_u16 v2, v2, v86
    v_pk_max_u16 v2, v2, v87
    v_pk_max_u16 v2, v2, v88
    v_pk_max_u16 v2, v2, v89
    v_pk_max_u16 v2, v2, v90
    v_pk_max_u16 v2, v2, v91
    v_pk_max_u16 v2, v2, v92
    v_pk_max_u16 v2, v2, v93
    v_pk_max_u16 v2, v2, v94
    v_pk_max_u16 v2, v2, v95
    v_lshrrev_b32 v112, 16, v2
    v_and_b32 v2, 0xffff, v2
    v_max_u32 v2, v2, v112
    v_cmp_eq_u32 vcc, 0xffff, v2
    s_cbranch_vccnz ch1bf_q012
    v_fma_mix_f32 v102, v76, 1.0, v84 op_sel:[0,0,0] op_sel_hi:[1,0,1]
    v_fma_mix_f32 v84, v76, 1.0, v84 op_sel:[1,0,1] op_sel_hi:[1,0,1]
    v_fma_mix_f32 v76, v77, 1.0, v85 op_sel:[0,0,0] op_sel_hi:[1,0,1]
    v_fma_mix_f32 v85, v77, 1.0, v85 op_sel:[1,0,1] op_sel_hi:[1,0,1]
    v_fma_mix_f32 v77, v78, 1.0, v86 op_sel:[0,0,0] op_sel_hi:[1,0,1]
    v_fma_mix_f32 v86, v78, 1.0, v86 op_sel:[1,0,1] op_sel_hi:[1,0,1]
    v_fma_mix_f32 v78, v79, 1.0, v87 op_sel:[0,0,0] op_sel_hi:[1,0,1]
    v_fma_mix_f32 v87, v79, 1.0, v87 op_sel:[1,0,1] op_sel_hi:[1,0,1]
    v_exp_f32 v76, v76
    v_exp_f32 v77, v77
    v_exp_f32 v78, v78
    v_exp_f32 v79, v102
    v_exp_f32 v84, v84
    v_exp_f32 v85, v85
    v_pk_add_f32 v[96:97], v[76:77], v[78:79]
    v_exp_f32 v86, v86
    v_exp_f32 v87, v87
    v_pk_add_f32 v[96:97], v[96:97], v[84:85]
    v_pk_add_f32 v[96:97], v[96:97], v[86:87]
    v_fma_mix_f32 v103, v80, 1.0, v88 op_sel:[0,0,0] op_sel_hi:[1,0,1]
    v_fma_mix_f32 v88, v80, 1.0, v88 op_sel:[1,0,1] op_sel_hi:[1,0,1]
    v_fma_mix_f32 v80, v81, 1.0, v89 op_sel:[0,0,0] op_sel_hi:[1,0,1]
    v_fma_mix_f32 v89, v81, 1.0, v89 op_sel:[1,0,1] op_sel_hi:[1,0,1]
    v_fma_mix_f32 v81, v82, 1.0, v90 op_sel:[0,0,0] op_sel_hi:[1,0,1]
    v_fma_mix_f32 v90, v82, 1.0, v90 op_sel:[1,0,1] op_sel_hi:[1,0,1]
    v_fma_mix_f32 v82, v83, 1.0, v91 op_sel:[0,0,0] op_sel_hi:[1,0,1]
    v_fma_mix_f32 v91, v83, 1.0, v91 op_sel:[1,0,1] op_sel_hi:[1,0,1]
    v_exp_f32 v80, v80
    v_exp_f32 v81, v81
    v_exp_f32 v82, v82
    v_exp_f32 v83, v103
    v_exp_f32 v88, v88
    v_exp_f32 v89, v89
    v_pk_add_f32 v[98:99], v[80:81], v[82:83]
    v_exp_f32 v90, v90
    v_exp_f32 v91, v91
    v_pk_add_f32 v[98:99], v[98:99], v[88:89]
    v_pk_add_f32 v[98:99], v[98:99], v[90:91]
    v_fma_mix_f32 v113, v92, 1.0, v94 op_sel:[0,0,0] op_sel_hi:[1,0,1]
    v_fma_mix_f32 v94, v92, 1.0, v94 op_sel:[1,0,1] op_sel_hi:[1,0,1]
    v_fma_mix_f32 v92, v93, 1.0, v95 op_sel:[0,0,0] op_sel_hi:[1,0,1]
    v_fma_mix_f32 v95, v93, 1.0, v95 op_sel:[1,0,1] op_sel_hi:[1,0,1]
    v_exp_f32 v92, v92
    v_exp_f32 v93, v113
    v_exp_f32 v94, v94
    v_exp_f32 v95, v95
    s_nop 0
    v_pk_add_f32 v[100:101], v[92:93], v[94:95]
    s_branch ch1bf_k0
ch1bf_vw:
    v_lshlrev_b32 v113, 7, v0
    s_mov_b32 s99, 0
hz_170:
    buffer_load_dword v115, v113, s[44:47], s75 offen sc1
    s_waitcnt vmcnt(0)
    v_cmp_gt_u32 vcc, 28, v115
    s_ff1_i32_b64 s100, vcc
    s_cmp_eq_u32 s100, -1
    s_cselect_b32 s100, 65, s100
    s_sub_u32 s100, s100, 1
    s_cmp_gt_i32 s100, s64
    s_cbranch_scc1 hd_171
    s_sleep 1
    s_add_u32 s99, s99, 1
    s_cmp_lt_u32 s99, 400000
    s_cbranch_scc1 hz_170
    s_branch chain_abort
hd_171:
    s_branch ch1bf_vok
ch1af:
    v_mov_b32 v44, 0
    v_mov_b32 v60, 0
    v_mov_b32 v45, 0
    v_mov_b32 v61, 0
    v_mov_b32 v46, 0
    v_mov_b32 v62, 0
    v_mov_b32 v47, 0
    v_mov_b32 v63, 0
    v_mov_b32 v48, 0
    v_mov_b32 v64, 0
    v_mov_b32 v49, 0
    v_mov_b32 v65, 0
    v_mov_b32 v50, 0
    v_mov_b32 v66, 0
    v_mov_b32 v51, 0
    v_mov_b32 v67, 0
    v_mov_b32 v52, 0
    v_mov_b32 v68, 0
    v_mov_b32 v53, 0
    v_mov_b32 v69, 0
    v_mov_b32 v54, 0
    v_mov_b32 v70, 0
    v_mov_b32 v55, 0
    v_mov_b32 v71, 0
    v_mov_b32 v56, 0
    v_mov_b32 v72, 0
    v_mov_b32 v57, 0
    v_mov_b32 v73, 0
    v_mov_b32 v58, 0
    v_mov_b32 v74, 0
    v_mov_b32 v59, 0
    v_mov_b32 v75, 0
    v_mov_b32 v112, 0
    v_mov_b32 v113, 0
    v_mov_b32 v114, 0
    v_mov_b32 v115, 0
    s_branch ch1af_loop
.p2align 6
ch1af_loop:
    s_and_b32 s8, s64, 3
    s_lshl_b32 s65, s8, 13
    s_add_u32 s65, s65, 94898176
    buffer_load_dwordx4 v[24:27], v1, s[44:47], s65 offen offset:0 sc1
    buffer_load_dwordx4 v[28:31], v1, s[44:47], s65 offen offset:1024 sc1
    s_mov_b32 s83, 0
    s_and_b32 s8, s64, 3
    s_mul_i32 s9, s8, 20736
    s_add_u32 s67, s9, 94934016
    s_add_u32 s66, s9, s12
    s_xor_b32 s8, s8, 2
    s_mul_i32 s9, s8, 20736
    s_add_u32 s70, s9, s13
    s_add_u32 s16, s72, 14336
    s_add_u32 s20, s15, 8192
    s_add_u32 s17, s72, 18432
    s_add_u32 s21, s15, 12288
    s_add_u32 s72, s72, 28672
    s_xor_b32 s15, s15, 0x4000
ch1af_mp:
    buffer_load_dwordx4 v[24:27], v1, s[44:47], s65 offen offset:0 sc1
    buffer_load_dwordx4 v[28:31], v1, s[44:47], s65 offen offset:1024 sc1
    s_add_u32 s83, s83, 1
    s_cmp_ge_u32 s83, 2000000
    s_cbranch_scc1 chain_abort
    s_waitcnt vmcnt(3)
    v_max3_u32 v2, v24, v25, v26
    v_max_u32 v2, v2, v27
    v_cmp_eq_u32 s[10:11], -1, v2
    s_waitcnt vmcnt(2)
    v_max3_u32 v2, v28, v29, v30
    v_max_u32 v2, v2, v31
    v_cmp_eq_u32 vcc, -1, v2
    s_cmp_lg_u64 s[10:11], 0
    s_cbranch_scc1 ch1af_m0bad
    s_cbranch_vccnz ch1af_mp1
ch1af_mok:
    ds_write_b128 v1, v[24:27] offset:2048
    ds_write_b128 v1, v[28:31] offset:3072
    v_smfmac_f32_16x16x64_bf16 v[44:47], v[24:27], a[16:23], v5
    v_smfmac_f32_16x16x64_bf16 v[48:51], v[24:27], a[72:79], v5
    s_waitcnt lgkmcnt(0)
    s_barrier
    ds_read_b128 v[16:19], v1 offset:0
    ds_read_b128 v[20:23], v1 offset:1024
    ds_read_b128 v[32:35], v1 offset:4096
    ds_read_b128 v[36:39], v1 offset:5120
    ds_read_b128 v[40:43], v1 offset:6144
    v_smfmac_f32_16x16x64_bf16 v[52:55], v[24:27], a[128:135], v5
    s_mov_b32 m0, s20
    v_smfmac_f32_16x16x64_bf16 v[44:47], v[28:31], a[24:31], v5
    buffer_load_dwordx4 v1, s[44:47], s16 offen offset:2048 sc1 lds
    v_smfmac_f32_16x16x64_bf16 v[48:51], v[28:31], a[80:87], v5
    buffer_load_dwordx4 v1, s[44:47], s16 offen offset:3072 sc1 lds
    s_mov_b32 m0, s21
    v_smfmac_f32_16x16x64_bf16 v[52:55], v[28:31], a[136:143], v5
    buffer_load_dwordx4 v1, s[44:47], s17 offen offset:0 sc1 lds
    s_waitcnt lgkmcnt(4)
    v_smfmac_f32_16x16x64_bf16 v[44:47], v[16:19], a[0:7], v5
    buffer_load_dwordx4 v1, s[44:47], s17 offen offset:1024 sc1 lds
    s_waitcnt lgkmcnt(3)
    v_smfmac_f32_16x16x64_bf16 v[44:47], v[20:23], a[8:15], v5
    buffer_load_dwordx4 v1, s[44:47], s17 offen offset:2048 sc1 lds
    s_waitcnt lgkmcnt(2)
    v_smfmac_f32_16x16x64_bf16 v[44:47], v[32:35], a[32:39], v5
    buffer_store_dword v3, v4, s[44:47], s70 offen
    s_waitcnt lgkmcnt(1)
    v_smfmac_f32_16x16x64_bf16 v[44:47], v[36:39], a[40:47], v5
    ds_read2_b64 v[76:79], v8 offset0:0 offset1:4
    s_waitcnt lgkmcnt(1)
    v_smfmac_f32_16x16x64_bf16 v[44:47], v[40:43], a[48:55], v5
    ds_read2_b64 v[80:83], v8 offset0:64 offset1:68
    v_smfmac_f32_16x16x64_bf16 v[48:51], v[16:19], a[56:63], v5
    ds_read2_b64 v[84:87], v8 offset0:128 offset1:132
    v_smfmac_f32_16x16x64_bf16 v[48:51], v[20:23], a[64:71], v5
    ds_read2_b64 v[88:91], v8 offset0:192 offset1:196
    v_smfmac_f32_16x16x64_bf16 v[48:51], v[32:35], a[88:95], v5
    ds_read2_b64 v[92:95], v13 offset0:0 offset1:4
    v_smfmac_f32_16x16x64_bf16 v[48:51], v[36:39], a[96:103], v5
    v_add_f32 v44, v44, v46
    v_smfmac_f32_16x16x64_bf16 v[48:51], v[40:43], a[104:111], v5
    v_add_f32 v45, v45, v47
    v_smfmac_f32_16x16x64_bf16 v[52:55], v[16:19], a[112:119], v5
    v_cvt_pk_bf16_f32 v44, v44, v45
    v_smfmac_f32_16x16x64_bf16 v[52:55], v[20:23], a[120:127], v5
    ds_write_b32 v6, v44 offset:768
    v_smfmac_f32_16x16x64_bf16 v[52:55], v[32:35], a[144:151], v5
    ds_read2_b64 v[96:99], v13 offset0:64 offset1:68
    v_smfmac_f32_16x16x64_bf16 v[52:55], v[36:39], a[152:159], v5
    v_add_f32 v48, v48, v50
    v_smfmac_f32_16x16x64_bf16 v[52:55], v[40:43], a[160:167], v5
    v_add_f32 v49, v49, v51
    v_smfmac_f32_16x16x64_bf16 v[56:59], v[16:19], a[168:175], v5
    v_cvt_pk_bf16_f32 v48, v48, v49
    v_smfmac_f32_16x16x64_bf16 v[56:59], v[20:23], a[176:183], v5
    ds_write_b32 v6, v48 offset:1024
    v_smfmac_f32_16x16x64_bf16 v[56:59], v[32:35], a[200:207], v5
    s_nop 1
    v_add_f32 v52, v52, v54
    v_smfmac_f32_16x16x64_bf16 v[56:59], v[36:39], a[208:215], v5
    v_add_f32 v53, v53, v55
    v_smfmac_f32_16x16x64_bf16 v[56:59], v[40:43], a[216:223], v5
    v_cvt_pk_bf16_f32 v52, v52, v53
    v_smfmac_f32_16x16x64_bf16 v[56:59], v[24:27], a[184:191], v5
    ds_write_b32 v6, v52 offset:1280
    v_smfmac_f32_16x16x64_bf16 v[56:59], v[28:31], a[192:199], v5
    ds_read2_b64 v[100:103], v13 offset0:128 offset1:132
    s_nop 6
    v_add_f32 v56, v56, v58
    v_add_f32 v57, v57, v59
    v_cvt_pk_bf16_f32 v56, v56, v57
    ds_write_b32 v6, v56 offset:3328
    s_waitcnt lgkmcnt(1)
    s_barrier
    ds_read_b64_tr_b16 v[44:45], v7 offset:0
    ds_read_b64_tr_b16 v[46:47], v7 offset:128
    ds_read_b64_tr_b16 v[48:49], v7 offset:1024
    ds_read_b64_tr_b16 v[50:51], v7 offset:1152
    ds_read_b64_tr_b16 v[52:53], v7 offset:2048
    ds_read_b64_tr_b16 v[54:55], v7 offset:2176
    s_waitcnt lgkmcnt(6)
    s_barrier
    ds_read_b64_tr_b16 v[56:57], v7 offset:3072
    ds_read_b64_tr_b16 v[58:59], v7 offset:3200
    s_waitcnt lgkmcnt(6)
    v_smfmac_f32_16x16x64_bf16 v[112:115], v[44:47], v[76:83], v5
    s_waitcnt lgkmcnt(4)
    v_smfmac_f32_16x16x64_bf16 v[112:115], v[48:51], v[84:91], v5
    s_waitcnt lgkmcnt(2)
    v_smfmac_f32_16x16x64_bf16 v[112:115], v[52:55], v[92:99], v5
    s_waitcnt lgkmcnt(0)
    v_smfmac_f32_16x16x64_bf16 v[112:115], v[56:59], v[100:107], v5
    s_nop 7
    v_pk_add_f32 v[112:113], v[112:113], v[114:115]
    v_pk_mul_f32 v[112:113], v[112:113], s[78:79]
    v_cvt_pk_f16_f32 v112, v112, v113
    s_nop 1
    v_mov_b32_dpp v113, v112 quad_perm:[1,0,3,2] row_mask:0xf bank_mask:0xf
    v_perm_b32 v112, v113, v112, v14
    v_pk_min_u16 v112, v112, s77
    buffer_store_dword v112, v9, s[44:47], s66 offen
    s_barrier
    s_add_u32 s71, s71, 458752
    s_add_u32 s8, s72, 14336
    s_mov_b32 m0, 24576
    s_nop 0
    buffer_load_dwordx4 v1, s[44:47], s8 offen offset:2048 sc1 lds
    buffer_load_dwordx4 v1, s[44:47], s8 offen offset:3072 sc1 lds
    s_add_u32 s8, s72, 18432
    s_mov_b32 m0, 28672
    s_nop 0
    buffer_load_dwordx4 v1, s[44:47], s8 offen offset:0 sc1 lds
    buffer_load_dwordx4 v1, s[44:47], s8 offen offset:1024 sc1 lds
    buffer_load_dwordx4 v1, s[44:47], s8 offen offset:2048 sc1 lds
    s_add_u32 s8, s64, s7
    s_and_b32 s8, s8, 3
    s_cmp_lg_u32 s8, 0
    s_cselect_b32 s101, -1, s64
    s_cbranch_scc1 ch1af_np
    s_lshl_b32 s8, s64, 13
    s_add_u32 s8, s8, 91752448
    buffer_store_dwordx4 v[24:27], v1, s[44:47], s8 offen offset:0 sc1
    buffer_store_dwordx4 v[28:31], v1, s[44:47], s8 offen offset:1024 sc1
ch1af_np:
    v_mov_b32 v44, 0
    v_mov_b32 v45, 0
    v_mov_b32 v46, 0
    v_mov_b32 v47, 0
    v_mov_b32 v48, 0
    v_mov_b32 v49, 0
    v_mov_b32 v50, 0
    v_mov_b32 v51, 0
    v_mov_b32 v52, 0
    v_mov_b32 v53, 0
    v_mov_b32 v54, 0
    v_mov_b32 v55, 0
    v_mov_b32 v56, 0
    v_mov_b32 v57, 0
    v_mov_b32 v58, 0
    v_mov_b32 v59, 0
    v_mov_b32 v112, 0
    v_mov_b32 v113, 0
    v_mov_b32 v114, 0
    v_mov_b32 v115, 0
    s_add_u32 s64, s64, 1
    s_cmp_lt_u32 s64, 63
    s_cbranch_scc1 ch1af_loop
    s_waitcnt vmcnt(0)
    s_barrier
    s_endpgm
ch1af_mp1:
    buffer_load_dwordx4 v[28:31], v1, s[44:47], s65 offen offset:1024 sc1
    s_add_u32 s83, s83, 1
    s_cmp_ge_u32 s83, 2000000
    s_cbranch_scc1 chain_abort
    s_waitcnt vmcnt(1)
    v_max3_u32 v2, v28, v29, v30
    v_max_u32 v2, v2, v31
    v_cmp_eq_u32 vcc, -1, v2
    s_cbranch_vccnz ch1af_mp1
    s_branch ch1af_mok
ch1af_m0bad:
    s_cbranch_vccnz ch1af_mp
ch1af_mp0:
    buffer_load_dwordx4 v[24:27], v1, s[44:47], s65 offen offset:0 sc1
    s_add_u32 s83, s83, 1
    s_cmp_ge_u32 s83, 2000000
    s_cbranch_scc1 chain_abort
    s_waitcnt vmcnt(1)
    v_max3_u32 v2, v24, v25, v26
    v_max_u32 v2, v2, v27
    v_cmp_eq_u32 vcc, -1, v2
    s_cbranch_vccnz ch1af_mp0
    s_branch ch1af_mok
ch2bf:
    v_mov_b32 v44, 0
    v_mov_b32 v60, 0
    v_mov_b32 v45, 0
    v_mov_b32 v61, 0
    v_mov_b32 v46, 0
    v_mov_b32 v62, 0
    v_mov_b32 v47, 0
    v_mov_b32 v63, 0
    v_mov_b32 v48, 0
    v_mov_b32 v64, 0
    v_mov_b32 v49, 0
    v_mov_b32 v65, 0
    v_mov_b32 v50, 0
    v_mov_b32 v66, 0
    v_mov_b32 v51, 0
    v_mov_b32 v67, 0
    v_mov_b32 v52, 0
    v_mov_b32 v68, 0
    v_mov_b32 v53, 0
    v_mov_b32 v69, 0
    v_mov_b32 v54, 0
    v_mov_b32 v70, 0
    v_mov_b32 v55, 0
    v_mov_b32 v71, 0
    v_mov_b32 v56, 0
    v_mov_b32 v72, 0
    v_mov_b32 v57, 0
    v_mov_b32 v73, 0
    v_mov_b32 v58, 0
    v_mov_b32 v74, 0
    v_mov_b32 v59, 0
    v_mov_b32 v75, 0
    v_mov_b32 v112, 0
    v_mov_b32 v113, 0
    v_mov_b32 v114, 0
    v_mov_b32 v115, 0
    s_branch ch2bf_loop
.p2align 6
ch2bf_loop:
    s_and_b32 s8, s64, 3
    s_lshl_b32 s65, s8, 13
    s_add_u32 s65, s65, 94900224
    buffer_load_dwordx4 v[32:35], v1, s[44:47], s65 offen offset:0 sc1
    buffer_load_dwordx4 v[36:39], v1, s[44:47], s65 offen offset:1024 sc1
    s_mov_b32 s83, 0
    s_and_b32 s8, s64, 3
    s_mul_i32 s9, s8, 20736
    s_add_u32 s67, s9, 94939136
    s_add_u32 s66, s9, s12
    s_xor_b32 s8, s8, 2
    s_mul_i32 s9, s8, 20736
    s_add_u32 s70, s9, s13
    s_add_u32 s24, s71, 0
    s_add_u32 s71, s71, 458752
    v_mov_b32 v60, 0
    v_mov_b32 v61, 0
    v_mov_b32 v62, 0
    v_mov_b32 v63, 0
    v_mov_b32 v64, 0
    v_mov_b32 v65, 0
    v_mov_b32 v66, 0
    v_mov_b32 v67, 0
    v_mov_b32 v68, 0
    v_mov_b32 v69, 0
    v_mov_b32 v70, 0
    v_mov_b32 v71, 0
    v_mov_b32 v72, 0
    v_mov_b32 v73, 0
    v_mov_b32 v74, 0
    v_mov_b32 v75, 0
ch2bf_mp:
    buffer_load_dwordx4 v[32:35], v1, s[44:47], s65 offen offset:0 sc1
    buffer_load_dwordx4 v[36:39], v1, s[44:47], s65 offen offset:1024 sc1
    s_add_u32 s83, s83, 1
    s_cmp_ge_u32 s83, 2000000
    s_cbranch_scc1 chain_abort
    s_waitcnt vmcnt(3)
    v_max3_u32 v2, v32, v33, v34
    v_max_u32 v2, v2, v35
    v_cmp_eq_u32 s[10:11], -1, v2
    s_waitcnt vmcnt(2)
    v_max3_u32 v2, v36, v37, v38
    v_max_u32 v2, v2, v39
    v_cmp_eq_u32 vcc, -1, v2
    s_cmp_lg_u64 s[10:11], 0
    s_cbranch_scc1 ch2bf_m0bad
    s_cbranch_vccnz ch2bf_mp1
ch2bf_mok:
    ds_write_b128 v1, v[32:35] offset:4096
    ds_write_b128 v1, v[36:39] offset:5120
    v_smfmac_f32_16x16x64_bf16 v[44:47], v[32:35], a[32:39], v5
    v_smfmac_f32_16x16x64_bf16 v[48:51], v[32:35], a[88:95], v5
    s_waitcnt lgkmcnt(0)
    s_barrier
    s_mov_b32 m0, 24576
    ds_read_b128 v[16:19], v1 offset:0
    ds_read_b128 v[20:23], v1 offset:1024
    ds_read_b128 v[24:27], v1 offset:2048
    ds_read_b128 v[28:31], v1 offset:3072
    ds_read_b128 v[40:43], v1 offset:6144
    v_smfmac_f32_16x16x64_bf16 v[52:55], v[32:35], a[144:151], v5
    buffer_load_dwordx4 v1, s[44:47], s24 offen offset:2048 sc1 lds
    v_smfmac_f32_16x16x64_bf16 v[44:47], v[36:39], a[40:47], v5
    buffer_load_dwordx4 v1, s[44:47], s24 offen offset:3072 sc1 lds
    v_smfmac_f32_16x16x64_bf16 v[48:51], v[36:39], a[96:103], v5
    buffer_store_dword v3, v4, s[44:47], s70 offen
    v_smfmac_f32_16x16x64_bf16 v[52:55], v[36:39], a[152:159], v5
    v_smfmac_f32_16x16x64_bf16 v[60:63], v[32:35], v[120:127], v5
    v_smfmac_f32_16x16x64_bf16 v[60:63], v[36:39], v[128:135], v5
    v_smfmac_f32_16x16x64_bf16 v[64:67], v[32:35], v[176:183], v5
    s_waitcnt lgkmcnt(4)
    v_smfmac_f32_16x16x64_bf16 v[44:47], v[16:19], a[0:7], v5
    s_waitcnt lgkmcnt(3)
    v_smfmac_f32_16x16x64_bf16 v[44:47], v[20:23], a[8:15], v5
    s_waitcnt lgkmcnt(2)
    v_smfmac_f32_16x16x64_bf16 v[44:47], v[24:27], a[16:23], v5
    ds_read_b128 v[76:79], v12 offset:0
    s_waitcnt lgkmcnt(2)
    v_smfmac_f32_16x16x64_bf16 v[44:47], v[28:31], a[24:31], v5
    ds_read_b128 v[80:83], v12 offset:1024
    s_waitcnt lgkmcnt(2)
    v_smfmac_f32_16x16x64_bf16 v[44:47], v[40:43], a[48:55], v5
    ds_read_b128 v[84:87], v12 offset:2048
    v_smfmac_f32_16x16x64_bf16 v[48:51], v[16:19], a[56:63], v5
    ds_read_b128 v[88:91], v12 offset:3072
    v_smfmac_f32_16x16x64_bf16 v[48:51], v[20:23], a[64:71], v5
    ds_read_b128 v[92:95], v12 offset:4096
    v_smfmac_f32_16x16x64_bf16 v[48:51], v[24:27], a[72:79], v5
    ds_read_b128 v[96:99], v12 offset:5120
    v_smfmac_f32_16x16x64_bf16 v[48:51], v[28:31], a[80:87], v5
    v_add_f32 v44, v44, v46
    v_smfmac_f32_16x16x64_bf16 v[48:51], v[40:43], a[104:111], v5
    v_add_f32 v45, v45, v47
    v_smfmac_f32_16x16x64_bf16 v[52:55], v[16:19], a[112:119], v5
    v_cvt_pk_bf16_f32 v44, v44, v45
    v_smfmac_f32_16x16x64_bf16 v[52:55], v[20:23], a[120:127], v5
    ds_write_b32 v6, v44 offset:1536
    v_smfmac_f32_16x16x64_bf16 v[52:55], v[24:27], a[128:135], v5
    ds_read_b128 v[100:103], v12 offset:6144
    v_smfmac_f32_16x16x64_bf16 v[52:55], v[28:31], a[136:143], v5
    v_add_f32 v48, v48, v50
    v_smfmac_f32_16x16x64_bf16 v[52:55], v[40:43], a[160:167], v5
    v_add_f32 v49, v49, v51
    v_cvt_pk_bf16_f32 v48, v48, v49
    ds_write_b32 v6, v48 offset:1792
    v_xor_b32 v12, 0x4000, v12
    s_nop 3
    v_add_f32 v52, v52, v54
    v_add_f32 v53, v53, v55
    v_cvt_pk_bf16_f32 v52, v52, v53
    ds_write_b32 v6, v52 offset:2048
    v_smfmac_f32_16x16x64_bf16 v[60:63], v[16:19], a[224:231], v5
    v_smfmac_f32_16x16x64_bf16 v[60:63], v[20:23], a[232:239], v5
    v_smfmac_f32_16x16x64_bf16 v[60:63], v[24:27], a[240:247], v5
    v_smfmac_f32_16x16x64_bf16 v[60:63], v[28:31], a[248:255], v5
    v_smfmac_f32_16x16x64_bf16 v[60:63], v[40:43], v[136:143], v5
    s_waitcnt lgkmcnt(0)
    s_barrier
    ds_read_b64_tr_b16 v[44:45], v7 offset:0
    ds_read_b64_tr_b16 v[46:47], v7 offset:128
    ds_read_b64_tr_b16 v[48:49], v7 offset:1024
    ds_read_b64_tr_b16 v[50:51], v7 offset:1152
    ds_read_b64_tr_b16 v[52:53], v7 offset:2048
    ds_read_b64_tr_b16 v[54:55], v7 offset:2176
    v_smfmac_f32_16x16x64_bf16 v[64:67], v[16:19], v[144:151], v5
    s_barrier
    ds_read_b64_tr_b16 v[56:57], v7 offset:3072
    ds_read_b64_tr_b16 v[58:59], v7 offset:3200
    s_waitcnt lgkmcnt(6)
    v_smfmac_f32_16x16x64_bf16 v[112:115], v[44:47], v[76:83], v5
    s_waitcnt lgkmcnt(4)
    v_smfmac_f32_16x16x64_bf16 v[112:115], v[48:51], v[84:91], v5
    s_waitcnt lgkmcnt(2)
    v_smfmac_f32_16x16x64_bf16 v[112:115], v[52:55], v[92:99], v5
    s_waitcnt lgkmcnt(0)
    v_smfmac_f32_16x16x64_bf16 v[112:115], v[56:59], v[100:107], v5
    s_nop 7
    v_pk_add_f32 v[112:113], v[112:113], v[114:115]
    v_pk_mul_f32 v[112:113], v[112:113], s[78:79]
    v_cvt_pk_f16_f32 v112, v112, v113
    s_nop 1
    v_mov_b32_dpp v113, v112 quad_perm:[1,0,3,2] row_mask:0xf bank_mask:0xf
    v_perm_b32 v112, v113, v112, v14
    v_pk_min_u16 v112, v112, s77
    buffer_store_dword v112, v9, s[44:47], s66 offen
    s_mov_b32 s83, 0
    s_mov_b32 s98, 0
    v_smfmac_f32_16x16x64_bf16 v[64:67], v[20:23], v[152:159], v5
    v_smfmac_f32_16x16x64_bf16 v[64:67], v[24:27], v[160:167], v5
    v_smfmac_f32_16x16x64_bf16 v[64:67], v[28:31], v[168:175], v5
    v_smfmac_f32_16x16x64_bf16 v[64:67], v[36:39], v[184:191], v5
    v_smfmac_f32_16x16x64_bf16 v[64:67], v[40:43], v[192:199], v5
    v_smfmac_f32_16x16x64_bf16 v[68:71], v[16:19], v[200:207], v5
    v_add_f32 v60, v60, v62
    v_smfmac_f32_16x16x64_bf16 v[68:71], v[20:23], v[208:215], v5
    v_add_f32 v61, v61, v63
    v_smfmac_f32_16x16x64_bf16 v[68:71], v[24:27], v[216:223], v5
    v_cvt_pk_bf16_f32 v104, v60, v61
    v_smfmac_f32_16x16x64_bf16 v[68:71], v[28:31], v[224:231], v5
    v_mov_b32 v60, 0
    v_smfmac_f32_16x16x64_bf16 v[68:71], v[32:35], v[232:239], v5
    v_mov_b32 v61, 0
    v_smfmac_f32_16x16x64_bf16 v[68:71], v[36:39], v[240:247], v5
    s_cmp_ge_u32 s100, 64
    s_cbranch_scc0 ch2bf_hl
ch2bf_hs:
    buffer_load_dwordx4 v[76:79], v1, s[44:47], s67 offen offset:0 sc1
    buffer_load_dwordx4 v[84:87], v1, s[44:47], s67 offen offset:2048 sc1
    v_smfmac_f32_16x16x64_bf16 v[68:71], v[40:43], v[248:255], v5
    v_mov_b32 v62, 0
    v_smfmac_f32_16x16x64_bf16 v[72:75], v[16:19], a[168:175], v5
    v_mov_b32 v63, 0
    v_smfmac_f32_16x16x64_bf16 v[72:75], v[20:23], a[176:183], v5
    buffer_load_dwordx4 v[80:83], v1, s[44:47], s67 offen offset:1024 sc1
    buffer_load_dwordx4 v[88:91], v1, s[44:47], s67 offen offset:3072 sc1
    v_smfmac_f32_16x16x64_bf16 v[72:75], v[24:27], a[184:191], v5
    v_add_f32 v64, v64, v66
    v_smfmac_f32_16x16x64_bf16 v[72:75], v[28:31], a[192:199], v5
    v_add_f32 v65, v65, v67
    v_smfmac_f32_16x16x64_bf16 v[72:75], v[32:35], a[200:207], v5
    buffer_load_dwordx4 v[92:95], v10, s[44:47], s67 offen offset:0 sc1
    v_smfmac_f32_16x16x64_bf16 v[72:75], v[36:39], a[208:215], v5
    v_cvt_pk_bf16_f32 v105, v64, v65
    v_smfmac_f32_16x16x64_bf16 v[72:75], v[40:43], a[216:223], v5
    v_add_f32 v68, v68, v70
    v_add_f32 v69, v69, v71
    v_cvt_pk_bf16_f32 v108, v68, v69
    s_nop 4
    v_add_f32 v72, v72, v74
    v_add_f32 v73, v73, v75
    v_cvt_pk_bf16_f32 v109, v72, v73
    s_waitcnt vmcnt(3)
    ds_read_b128 v[44:47], v1 offset:24576
    ds_read_b128 v[48:51], v1 offset:25600
    ds_read_b128 v[52:55], v1 offset:26624
    ds_read_b128 v[56:59], v1 offset:27648
    s_cbranch_scc0 ch2bf_hu
ch2bf_hv:
    s_cmp_ge_u32 s64, s100
    v_fma_mix_f32 v102, v76, 1.0, v84 op_sel:[0,0,0] op_sel_hi:[1,0,1]
    v_fma_mix_f32 v84, v76, 1.0, v84 op_sel:[1,0,1] op_sel_hi:[1,0,1]
    v_fma_mix_f32 v76, v77, 1.0, v85 op_sel:[0,0,0] op_sel_hi:[1,0,1]
    v_fma_mix_f32 v85, v77, 1.0, v85 op_sel:[1,0,1] op_sel_hi:[1,0,1]
    v_fma_mix_f32 v77, v78, 1.0, v86 op_sel:[0,0,0] op_sel_hi:[1,0,1]
    v_fma_mix_f32 v86, v78, 1.0, v86 op_sel:[1,0,1] op_sel_hi:[1,0,1]
    v_fma_mix_f32 v78, v79, 1.0, v87 op_sel:[0,0,0] op_sel_hi:[1,0,1]
    v_fma_mix_f32 v87, v79, 1.0, v87 op_sel:[1,0,1] op_sel_hi:[1,0,1]
    v_maximum3_f32 v112, v84, v85, v86
    v_cmp_u_f32 vcc, v112, v87
    v_exp_f32 v76, v76
    v_exp_f32 v77, v77
    v_exp_f32 v78, v78
    s_cbranch_vccnz ch2bf_i0
    v_exp_f32 v79, v102
    v_exp_f32 v84, v84
    v_exp_f32 v85, v85
    v_pk_add_f32 v[96:97], v[76:77], v[78:79]
    v_exp_f32 v86, v86
    v_exp_f32 v87, v87
    v_pk_add_f32 v[96:97], v[96:97], v[84:85]
    v_pk_add_f32 v[96:97], v[96:97], v[86:87]
    s_waitcnt vmcnt(1)
    v_fma_mix_f32 v103, v80, 1.0, v88 op_sel:[0,0,0] op_sel_hi:[1,0,1]
    v_fma_mix_f32 v88, v80, 1.0, v88 op_sel:[1,0,1] op_sel_hi:[1,0,1]
    v_fma_mix_f32 v80, v81, 1.0, v89 op_sel:[0,0,0] op_sel_hi:[1,0,1]
    v_fma_mix_f32 v89, v81, 1.0, v89 op_sel:[1,0,1] op_sel_hi:[1,0,1]
    v_fma_mix_f32 v81, v82, 1.0, v90 op_sel:[0,0,0] op_sel_hi:[1,0,1]
    v_fma_mix_f32 v90, v82, 1.0, v90 op_sel:[1,0,1] op_sel_hi:[1,0,1]
    v_fma_mix_f32 v82, v83, 1.0, v91 op_sel:[0,0,0] op_sel_hi:[1,0,1]
    v_fma_mix_f32 v91, v83, 1.0, v91 op_sel:[1,0,1] op_sel_hi:[1,0,1]
    v_maximum3_f32 v114, v88, v89, v90
    v_cmp_u_f32 vcc, v114, v91
    v_exp_f32 v80, v80
    v_exp_f32 v81, v81
    v_exp_f32 v82, v82
    s_cbranch_vccnz ch2bf_i1
    v_exp_f32 v83, v103
    v_exp_f32 v88, v88
    v_exp_f32 v89, v89
    v_pk_add_f32 v[98:99], v[80:81], v[82:83]
    v_exp_f32 v90, v90
    v_exp_f32 v91, v91
    v_pk_add_f32 v[98:99], v[98:99], v[88:89]
    v_pk_add_f32 v[98:99], v[98:99], v[90:91]
    s_cbranch_scc1 ch2bf_nw
ch2bf_nw2:
    s_mov_b32 m0, 24576
    s_mov_b32 s98, 1
    s_waitcnt vmcnt(0) lgkmcnt(0)
    buffer_load_dwordx4 v1, s[44:47], s71 offen offset:0 sc1 lds
    buffer_load_dwordx4 v1, s[44:47], s71 offen offset:1024 sc1 lds
    v_fma_mix_f32 v113, v92, 1.0, v94 op_sel:[0,0,0] op_sel_hi:[1,0,1]
    v_fma_mix_f32 v94, v92, 1.0, v94 op_sel:[1,0,1] op_sel_hi:[1,0,1]
    v_fma_mix_f32 v92, v93, 1.0, v95 op_sel:[0,0,0] op_sel_hi:[1,0,1]
    v_fma_mix_f32 v95, v93, 1.0, v95 op_sel:[1,0,1] op_sel_hi:[1,0,1]
    v_cmp_u_f32 vcc, v94, v95
    v_exp_f32 v92, v92
    v_exp_f32 v93, v113
    v_exp_f32 v94, v94
    s_cbranch_vccnz ch2bf_i2
    v_exp_f32 v95, v95
    s_nop 0
    v_pk_add_f32 v[100:101], v[92:93], v[94:95]
ch2bf_w2d:
    v_pk_add_f32 v[96:97], v[96:97], v[98:99]
    v_pk_add_f32 v[96:97], v[96:97], v[100:101]
    v_add_f32 v2, v96, v97
    v_add_f32 v15, v96, v97
    s_nop 1
    v_permlane16_swap_b32 v2, v15
    v_add_f32 v2, v2, v15
    v_subrev_u32 v15, 0x17800000, v2
    v_rcp_f32 v2, v2
    v_cmp_le_u32 vcc, 0x5a000000, v15
    s_waitcnt lgkmcnt(0)
    v_pk_mul_f32 v[92:93], v[92:93], v[2:3] op_sel_hi:[1,0]
    v_pk_mul_f32 v[94:95], v[94:95], v[2:3] op_sel_hi:[1,0]
    v_cvt_pk_bf16_f32 v116, v93, v94
    v_cvt_pk_bf16_f32 v118, v92, v95
    s_cbranch_vccnz ch2bf_fb
    v_pk_mul_f32 v[76:77], v[76:77], v[2:3] op_sel_hi:[1,0]
    v_pk_mul_f32 v[78:79], v[78:79], v[2:3] op_sel_hi:[1,0]
    v_pk_mul_f32 v[84:85], v[84:85], v[2:3] op_sel_hi:[1,0]
    v_pk_mul_f32 v[86:87], v[86:87], v[2:3] op_sel_hi:[1,0]
    v_cvt_pk_bf16_f32 v96, v79, v84
    v_cvt_pk_bf16_f32 v97, v76, v85
    v_cvt_pk_bf16_f32 v98, v77, v86
    v_cvt_pk_bf16_f32 v99, v78, v87
    v_pk_mul_f32 v[80:81], v[80:81], v[2:3] op_sel_hi:[1,0]
    v_pk_mul_f32 v[82:83], v[82:83], v[2:3] op_sel_hi:[1,0]
    v_pk_mul_f32 v[88:89], v[88:89], v[2:3] op_sel_hi:[1,0]
    v_pk_mul_f32 v[90:91], v[90:91], v[2:3] op_sel_hi:[1,0]
    v_smfmac_f32_16x16x64_bf16 v[60:63], v[116:119], v[104:111], v5
    v_cvt_pk_bf16_f32 v100, v83, v88
    v_cvt_pk_bf16_f32 v101, v80, v89
    v_smfmac_f32_16x16x64_bf16 v[60:63], v[96:99], v[44:51], v5
    v_cvt_pk_bf16_f32 v102, v81, v90
    v_cvt_pk_bf16_f32 v103, v82, v91
    s_nop 1
    v_smfmac_f32_16x16x64_bf16 v[60:63], v[100:103], v[52:59], v5
ch2bf_kj:
    v_mov_b32 v44, 0
    v_mov_b32 v45, 0
    v_mov_b32 v46, 0
    v_mov_b32 v47, 0
    s_nop 3
    v_add_f32 v60, v60, v62
    v_add_f32 v61, v61, v63
    ds_write2_b32 v11, v60, v61 offset0:0 offset1:16
    v_mov_b32 v48, 0
    v_mov_b32 v49, 0
    v_mov_b32 v50, 0
    v_mov_b32 v51, 0
    v_mov_b32 v52, 0
    v_mov_b32 v53, 0
    v_mov_b32 v54, 0
    v_mov_b32 v55, 0
    v_mov_b32 v112, 0
    v_mov_b32 v113, 0
    v_mov_b32 v114, 0
    v_mov_b32 v115, 0
    s_waitcnt lgkmcnt(0)
    s_barrier
    s_barrier
    s_add_u32 s64, s64, 1
    s_cmp_lt_u32 s64, 63
    s_cbranch_scc1 ch2bf_loop
    s_and_b32 s8, s64, 3
    s_lshl_b32 s65, s8, 13
    s_add_u32 s65, s65, 94900224
    v_mov_b32 v60, 0
    v_mov_b32 v61, 0
    v_mov_b32 v62, 0
    v_mov_b32 v63, 0
    v_mov_b32 v64, 0
    v_mov_b32 v65, 0
    v_mov_b32 v66, 0
    v_mov_b32 v67, 0
    v_mov_b32 v68, 0
    v_mov_b32 v69, 0
    v_mov_b32 v70, 0
    v_mov_b32 v71, 0
    v_mov_b32 v72, 0
    v_mov_b32 v73, 0
    v_mov_b32 v74, 0
    v_mov_b32 v75, 0
    buffer_load_dwordx4 v[76:79], v1, s[44:47], s65 offen offset:0 sc1
    buffer_load_dwordx4 v[80:83], v1, s[44:47], s65 offen offset:1024 sc1
    s_mov_b32 s83, 0
ch2bft_mp:
    buffer_load_dwordx4 v[32:35], v1, s[44:47], s65 offen offset:0 sc1
    buffer_load_dwordx4 v[36:39], v1, s[44:47], s65 offen offset:1024 sc1
    s_waitcnt vmcnt(3)
    v_max3_u32 v2, v76, v77, v78
    s_waitcnt vmcnt(2)
    v_max3_u32 v2, v2, v79, v80
    v_max3_u32 v2, v2, v81, v82
    v_max_u32 v2, v2, v83
    v_cmp_eq_u32 vcc, -1, v2
    s_cbranch_vccz ch2bft_g1
    buffer_load_dwordx4 v[76:79], v1, s[44:47], s65 offen offset:0 sc1
    buffer_load_dwordx4 v[80:83], v1, s[44:47], s65 offen offset:1024 sc1
    s_add_u32 s83, s83, 1
    s_cmp_ge_u32 s83, 2000000
    s_cbranch_scc1 chain_abort
    s_waitcnt vmcnt(3)
    v_max3_u32 v2, v32, v33, v34
    s_waitcnt vmcnt(2)
    v_max3_u32 v2, v2, v35, v36
    v_max3_u32 v2, v2, v37, v38
    v_max_u32 v2, v2, v39
    v_cmp_eq_u32 vcc, -1, v2
    s_cbranch_vccnz ch2bft_mp
ch2bft_g1:
    s_waitcnt vmcnt(0)
    ds_write_b128 v1, v[32:35] offset:4096
    ds_write_b128 v1, v[36:39] offset:5120
    s_waitcnt lgkmcnt(0)
    s_barrier
    ds_read_b128 v[16:19], v1 offset:0
    ds_read_b128 v[20:23], v1 offset:1024
    ds_read_b128 v[24:27], v1 offset:2048
    ds_read_b128 v[28:31], v1 offset:3072
    ds_read_b128 v[40:43], v1 offset:6144
    s_waitcnt lgkmcnt(0)
    v_smfmac_f32_16x16x64_bf16 v[60:63], v[16:19], a[224:231], v5
    v_smfmac_f32_16x16x64_bf16 v[60:63], v[20:23], a[232:239], v5
    v_smfmac_f32_16x16x64_bf16 v[60:63], v[24:27], a[240:247], v5
    v_smfmac_f32_16x16x64_bf16 v[60:63], v[28:31], a[248:255], v5
    v_smfmac_f32_16x16x64_bf16 v[60:63], v[32:35], v[120:127], v5
    v_smfmac_f32_16x16x64_bf16 v[60:63], v[36:39], v[128:135], v5
    v_smfmac_f32_16x16x64_bf16 v[60:63], v[40:43], v[136:143], v5
    v_smfmac_f32_16x16x64_bf16 v[64:67], v[16:19], v[144:151], v5
    v_smfmac_f32_16x16x64_bf16 v[64:67], v[20:23], v[152:159], v5
    v_smfmac_f32_16x16x64_bf16 v[64:67], v[24:27], v[160:167], v5
    v_smfmac_f32_16x16x64_bf16 v[64:67], v[28:31], v[168:175], v5
    v_smfmac_f32_16x16x64_bf16 v[64:67], v[32:35], v[176:183], v5
    s_nop 2
    v_add_f32 v60, v60, v62
    v_smfmac_f32_16x16x64_bf16 v[64:67], v[36:39], v[184:191], v5
    v_add_f32 v61, v61, v63
    v_smfmac_f32_16x16x64_bf16 v[64:67], v[40:43], v[192:199], v5
    v_cvt_pk_bf16_f32 v104, v60, v61
    v_smfmac_f32_16x16x64_bf16 v[68:71], v[16:19], v[200:207], v5
    v_mov_b32 v60, 0
    v_smfmac_f32_16x16x64_bf16 v[68:71], v[20:23], v[208:215], v5
    v_mov_b32 v61, 0
    v_smfmac_f32_16x16x64_bf16 v[68:71], v[24:27], v[216:223], v5
    v_mov_b32 v62, 0
    v_smfmac_f32_16x16x64_bf16 v[68:71], v[28:31], v[224:231], v5
    v_mov_b32 v63, 0
    v_smfmac_f32_16x16x64_bf16 v[68:71], v[32:35], v[232:239], v5
    v_add_f32 v64, v64, v66
    v_smfmac_f32_16x16x64_bf16 v[68:71], v[36:39], v[240:247], v5
    v_add_f32 v65, v65, v67
    v_smfmac_f32_16x16x64_bf16 v[68:71], v[40:43], v[248:255], v5
    v_cvt_pk_bf16_f32 v105, v64, v65
    v_smfmac_f32_16x16x64_bf16 v[72:75], v[16:19], a[168:175], v5
    v_smfmac_f32_16x16x64_bf16 v[72:75], v[20:23], a[176:183], v5
    v_smfmac_f32_16x16x64_bf16 v[72:75], v[24:27], a[184:191], v5
    v_smfmac_f32_16x16x64_bf16 v[72:75], v[28:31], a[192:199], v5
    v_smfmac_f32_16x16x64_bf16 v[72:75], v[32:35], a[200:207], v5
    s_nop 1
    v_add_f32 v68, v68, v70
    v_smfmac_f32_16x16x64_bf16 v[72:75], v[36:39], a[208:215], v5
    v_add_f32 v69, v69, v71
    v_smfmac_f32_16x16x64_bf16 v[72:75], v[40:43], a[216:223], v5
    v_cvt_pk_bf16_f32 v108, v68, v69
    s_nop 6
    v_add_f32 v72, v72, v74
    v_add_f32 v73, v73, v75
    v_cvt_pk_bf16_f32 v109, v72, v73
    v_mov_b32 v106, v108
    v_mov_b32 v107, v109
    s_lshl_b32 s8, s82, 12
    s_add_u32 s8, s8, 91637760
    buffer_store_dwordx4 v[104:107], v1, s[44:47], s8 offen sc1
    s_waitcnt vmcnt(0)
    s_barrier
    s_endpgm
ch2bf_mp1:
    buffer_load_dwordx4 v[36:39], v1, s[44:47], s65 offen offset:1024 sc1
    s_add_u32 s83, s83, 1
    s_cmp_ge_u32 s83, 2000000
    s_cbranch_scc1 chain_abort
    s_waitcnt vmcnt(1)
    v_max3_u32 v2, v36, v37, v38
    v_max_u32 v2, v2, v39
    v_cmp_eq_u32 vcc, -1, v2
    s_cbranch_vccnz ch2bf_mp1
    s_branch ch2bf_mok
ch2bf_m0bad:
    s_cbranch_vccnz ch2bf_mp
ch2bf_mp0:
    buffer_load_dwordx4 v[32:35], v1, s[44:47], s65 offen offset:0 sc1
    s_add_u32 s83, s83, 1
    s_cmp_ge_u32 s83, 2000000
    s_cbranch_scc1 chain_abort
    s_waitcnt vmcnt(1)
    v_max3_u32 v2, v32, v33, v34
    v_max_u32 v2, v2, v35
    v_cmp_eq_u32 vcc, -1, v2
    s_cbranch_vccnz ch2bf_mp0
    s_branch ch2bf_mok
ch2bf_hl:
    buffer_load_dword v15, off, s[44:47], s73 sc1
    s_branch ch2bf_hs
ch2bf_hu:
    v_readfirstlane_b32 s9, v15
    s_max_u32 s100, s100, s9
    s_branch ch2bf_hv
ch2bf_nw:
    v_lshlrev_b32 v100, 7, v0
    s_mov_b32 s99, 0
hz_172:
    buffer_load_dword v101, v100, s[44:47], s75 offen sc1
    s_waitcnt vmcnt(0)
    v_cmp_gt_u32 vcc, 28, v101
    s_ff1_i32_b64 s100, vcc
    s_cmp_eq_u32 s100, -1
    s_cselect_b32 s100, 65, s100
    s_sub_u32 s100, s100, 1
    s_cmp_gt_i32 s100, s64
    s_cbranch_scc1 hd_173
    s_sleep 1
    s_add_u32 s99, s99, 1
    s_cmp_lt_u32 s99, 400000
    s_cbranch_scc1 hz_172
    s_branch chain_abort
hd_173:
    s_branch ch2bf_nw2
ch2bf_k0:
    s_cmp_eq_u32 s98, 1
    s_cbranch_scc1 ch2bf_w2d
    s_cmp_ge_u32 s64, s100
    s_cbranch_scc1 ch2bf_vw
ch2bf_vok:
    s_mov_b32 m0, 24576
    s_waitcnt lgkmcnt(0)
    buffer_load_dwordx4 v1, s[44:47], s71 offen offset:0 sc1 lds
    buffer_load_dwordx4 v1, s[44:47], s71 offen offset:1024 sc1 lds
    s_branch ch2bf_w2d
ch2bf_i0:
    buffer_load_dwordx4 v[76:79], v1, s[44:47], s67 offen offset:0 sc1
    buffer_load_dwordx4 v[84:87], v1, s[44:47], s67 offen offset:2048 sc1
    s_add_u32 s83, s83, 1
    s_branch ch2bf_q120
ch2bf_i1:
    buffer_load_dwordx4 v[80:83], v1, s[44:47], s67 offen offset:1024 sc1
    buffer_load_dwordx4 v[88:91], v1, s[44:47], s67 offen offset:3072 sc1
    s_add_u32 s83, s83, 1
    s_branch ch2bf_q21
ch2bf_i2:
    buffer_load_dwordx4 v[92:95], v10, s[44:47], s67 offen offset:0 sc1
    s_add_u32 s83, s83, 1
    s_branch ch2bf_q2
ch2bf_q0:
    s_waitcnt vmcnt(0)
    v_fma_mix_f32 v102, v76, 1.0, v84 op_sel:[0,0,0] op_sel_hi:[1,0,1]
    v_fma_mix_f32 v84, v76, 1.0, v84 op_sel:[1,0,1] op_sel_hi:[1,0,1]
    v_fma_mix_f32 v76, v77, 1.0, v85 op_sel:[0,0,0] op_sel_hi:[1,0,1]
    v_fma_mix_f32 v85, v77, 1.0, v85 op_sel:[1,0,1] op_sel_hi:[1,0,1]
    v_fma_mix_f32 v77, v78, 1.0, v86 op_sel:[0,0,0] op_sel_hi:[1,0,1]
    v_fma_mix_f32 v86, v78, 1.0, v86 op_sel:[1,0,1] op_sel_hi:[1,0,1]
    v_fma_mix_f32 v78, v79, 1.0, v87 op_sel:[0,0,0] op_sel_hi:[1,0,1]
    v_fma_mix_f32 v87, v79, 1.0, v87 op_sel:[1,0,1] op_sel_hi:[1,0,1]
    v_maximum3_f32 v112, v84, v85, v86
    v_cmp_u_f32 vcc, v112, v87
    v_exp_f32 v76, v76
    v_exp_f32 v77, v77
    v_exp_f32 v78, v78
    s_cbranch_vccnz ch2bf_q0_e
    v_exp_f32 v79, v102
    v_exp_f32 v84, v84
    v_exp_f32 v85, v85
    v_pk_add_f32 v[96:97], v[76:77], v[78:79]
    v_exp_f32 v86, v86
    v_exp_f32 v87, v87
    v_pk_add_f32 v[96:97], v[96:97], v[84:85]
    v_pk_add_f32 v[96:97], v[96:97], v[86:87]
    s_branch ch2bf_k0
ch2bf_q0_e:
    buffer_load_dwordx4 v[76:79], v1, s[44:47], s67 offen offset:0 sc1
    buffer_load_dwordx4 v[84:87], v1, s[44:47], s67 offen offset:2048 sc1
    s_add_u32 s83, s83, 1
    s_and_b32 s8, s83, 63
    s_cmp_eq_u32 s8, 0
    s_cbranch_scc1 ch2bf_x
    s_branch ch2bf_q0
ch2bf_q1:
    s_waitcnt vmcnt(0)
    v_fma_mix_f32 v103, v80, 1.0, v88 op_sel:[0,0,0] op_sel_hi:[1,0,1]
    v_fma_mix_f32 v88, v80, 1.0, v88 op_sel:[1,0,1] op_sel_hi:[1,0,1]
    v_fma_mix_f32 v80, v81, 1.0, v89 op_sel:[0,0,0] op_sel_hi:[1,0,1]
    v_fma_mix_f32 v89, v81, 1.0, v89 op_sel:[1,0,1] op_sel_hi:[1,0,1]
    v_fma_mix_f32 v81, v82, 1.0, v90 op_sel:[0,0,0] op_sel_hi:[1,0,1]
    v_fma_mix_f32 v90, v82, 1.0, v90 op_sel:[1,0,1] op_sel_hi:[1,0,1]
    v_fma_mix_f32 v82, v83, 1.0, v91 op_sel:[0,0,0] op_sel_hi:[1,0,1]
    v_fma_mix_f32 v91, v83, 1.0, v91 op_sel:[1,0,1] op_sel_hi:[1,0,1]
    v_maximum3_f32 v114, v88, v89, v90
    v_cmp_u_f32 vcc, v114, v91
    v_exp_f32 v80, v80
    v_exp_f32 v81, v81
    v_exp_f32 v82, v82
    s_cbranch_vccnz ch2bf_q1_e
    v_exp_f32 v83, v103
    v_exp_f32 v88, v88
    v_exp_f32 v89, v89
    v_pk_add_f32 v[98:99], v[80:81], v[82:83]
    v_exp_f32 v90, v90
    v_exp_f32 v91, v91
    v_pk_add_f32 v[98:99], v[98:99], v[88:89]
    v_pk_add_f32 v[98:99], v[98:99], v[90:91]
    s_branch ch2bf_k0
ch2bf_q1_e:
    buffer_load_dwordx4 v[80:83], v1, s[44:47], s67 offen offset:1024 sc1
    buffer_load_dwordx4 v[88:91], v1, s[44:47], s67 offen offset:3072 sc1
    s_add_u32 s83, s83, 1
    s_and_b32 s8, s83, 63
    s_cmp_eq_u32 s8, 0
    s_cbranch_scc1 ch2bf_x
    s_branch ch2bf_q1
ch2bf_q2:
    s_waitcnt vmcnt(0)
    v_fma_mix_f32 v113, v92, 1.0, v94 op_sel:[0,0,0] op_sel_hi:[1,0,1]
    v_fma_mix_f32 v94, v92, 1.0, v94 op_sel:[1,0,1] op_sel_hi:[1,0,1]
    v_fma_mix_f32 v92, v93, 1.0, v95 op_sel:[0,0,0] op_sel_hi:[1,0,1]
    v_fma_mix_f32 v95, v93, 1.0, v95 op_sel:[1,0,1] op_sel_hi:[1,0,1]
    v_cmp_u_f32 vcc, v94, v95
    v_exp_f32 v92, v92
    v_exp_f32 v93, v113
    v_exp_f32 v94, v94
    s_cbranch_vccnz ch2bf_q2_e
    v_exp_f32 v95, v95
    s_nop 0
    v_pk_add_f32 v[100:101], v[92:93], v[94:95]
    s_branch ch2bf_k0
ch2bf_q2_e:
    buffer_load_dwordx4 v[92:95], v10, s[44:47], s67 offen offset:0 sc1
    s_add_u32 s83, s83, 1
    s_and_b32 s8, s83, 63
    s_cmp_eq_u32 s8, 0
    s_cbranch_scc1 ch2bf_x
    s_branch ch2bf_q2
ch2bf_q01:
    s_waitcnt vmcnt(2)
    v_fma_mix_f32 v102, v76, 1.0, v84 op_sel:[0,0,0] op_sel_hi:[1,0,1]
    v_fma_mix_f32 v84, v76, 1.0, v84 op_sel:[1,0,1] op_sel_hi:[1,0,1]
    v_fma_mix_f32 v76, v77, 1.0, v85 op_sel:[0,0,0] op_sel_hi:[1,0,1]
    v_fma_mix_f32 v85, v77, 1.0, v85 op_sel:[1,0,1] op_sel_hi:[1,0,1]
    v_fma_mix_f32 v77, v78, 1.0, v86 op_sel:[0,0,0] op_sel_hi:[1,0,1]
    v_fma_mix_f32 v86, v78, 1.0, v86 op_sel:[1,0,1] op_sel_hi:[1,0,1]
    v_fma_mix_f32 v78, v79, 1.0, v87 op_sel:[0,0,0] op_sel_hi:[1,0,1]
    v_fma_mix_f32 v87, v79, 1.0, v87 op_sel:[1,0,1] op_sel_hi:[1,0,1]
    v_maximum3_f32 v112, v84, v85, v86
    v_cmp_u_f32 vcc, v112, v87
    v_exp_f32 v76, v76
    v_exp_f32 v77, v77
    v_exp_f32 v78, v78
    s_cbranch_vccnz ch2bf_q01_e
    v_exp_f32 v79, v102
    v_exp_f32 v84, v84
    v_exp_f32 v85, v85
    v_pk_add_f32 v[96:97], v[76:77], v[78:79]
    v_exp_f32 v86, v86
    v_exp_f32 v87, v87
    v_pk_add_f32 v[96:97], v[96:97], v[84:85]
    v_pk_add_f32 v[96:97], v[96:97], v[86:87]
    s_branch ch2bf_q1
ch2bf_q01_e:
    buffer_load_dwordx4 v[76:79], v1, s[44:47], s67 offen offset:0 sc1
    buffer_load_dwordx4 v[84:87], v1, s[44:47], s67 offen offset:2048 sc1
    s_add_u32 s83, s83, 1
    s_and_b32 s8, s83, 63
    s_cmp_eq_u32 s8, 0
    s_cbranch_scc1 ch2bf_x
    s_branch ch2bf_q10
ch2bf_q02:
    s_waitcnt vmcnt(1)
    v_fma_mix_f32 v102, v76, 1.0, v84 op_sel:[0,0,0] op_sel_hi:[1,0,1]
    v_fma_mix_f32 v84, v76, 1.0, v84 op_sel:[1,0,1] op_sel_hi:[1,0,1]
    v_fma_mix_f32 v76, v77, 1.0, v85 op_sel:[0,0,0] op_sel_hi:[1,0,1]
    v_fma_mix_f32 v85, v77, 1.0, v85 op_sel:[1,0,1] op_sel_hi:[1,0,1]
    v_fma_mix_f32 v77, v78, 1.0, v86 op_sel:[0,0,0] op_sel_hi:[1,0,1]
    v_fma_mix_f32 v86, v78, 1.0, v86 op_sel:[1,0,1] op_sel_hi:[1,0,1]
    v_fma_mix_f32 v78, v79, 1.0, v87 op_sel:[0,0,0] op_sel_hi:[1,0,1]
    v_fma_mix_f32 v87, v79, 1.0, v87 op_sel:[1,0,1] op_sel_hi:[1,0,1]
    v_maximum3_f32 v112, v84, v85, v86
    v_cmp_u_f32 vcc, v112, v87
    v_exp_f32 v76, v76
    v_exp_f32 v77, v77
    v_exp_f32 v78, v78
    s_cbranch_vccnz ch2bf_q02_e
    v_exp_f32 v79, v102
    v_exp_f32 v84, v84
    v_exp_f32 v85, v85
    v_pk_add_f32 v[96:97], v[76:77], v[78:79]
    v_exp_f32 v86, v86
    v_exp_f32 v87, v87
    v_pk_add_f32 v[96:97], v[96:97], v[84:85]
    v_pk_add_f32 v[96:97], v[96:97], v[86:87]
    s_branch ch2bf_q2
ch2bf_q02_e:
    buffer_load_dwordx4 v[76:79], v1, s[44:47], s67 offen offset:0 sc1
    buffer_load_dwordx4 v[84:87], v1, s[44:47], s67 offen offset:2048 sc1
    s_add_u32 s83, s83, 1
    s_and_b32 s8, s83, 63
    s_cmp_eq_u32 s8, 0
    s_cbranch_scc1 ch2bf_x
    s_branch ch2bf_q20
ch2bf_q10:
    s_waitcnt vmcnt(2)
    v_fma_mix_f32 v103, v80, 1.0, v88 op_sel:[0,0,0] op_sel_hi:[1,0,1]
    v_fma_mix_f32 v88, v80, 1.0, v88 op_sel:[1,0,1] op_sel_hi:[1,0,1]
    v_fma_mix_f32 v80, v81, 1.0, v89 op_sel:[0,0,0] op_sel_hi:[1,0,1]
    v_fma_mix_f32 v89, v81, 1.0, v89 op_sel:[1,0,1] op_sel_hi:[1,0,1]
    v_fma_mix_f32 v81, v82, 1.0, v90 op_sel:[0,0,0] op_sel_hi:[1,0,1]
    v_fma_mix_f32 v90, v82, 1.0, v90 op_sel:[1,0,1] op_sel_hi:[1,0,1]
    v_fma_mix_f32 v82, v83, 1.0, v91 op_sel:[0,0,0] op_sel_hi:[1,0,1]
    v_fma_mix_f32 v91, v83, 1.0, v91 op_sel:[1,0,1] op_sel_hi:[1,0,1]
    v_maximum3_f32 v114, v88, v89, v90
    v_cmp_u_f32 vcc, v114, v91
    v_exp_f32 v80, v80
    v_exp_f32 v81, v81
    v_exp_f32 v82, v82
    s_cbranch_vccnz ch2bf_q10_e
    v_exp_f32 v83, v103
    v_exp_f32 v88, v88
    v_exp_f32 v89, v89
    v_pk_add_f32 v[98:99], v[80:81], v[82:83]
    v_exp_f32 v90, v90
    v_exp_f32 v91, v91
    v_pk_add_f32 v[98:99], v[98:99], v[88:89]
    v_pk_add_f32 v[98:99], v[98:99], v[90:91]
    s_branch ch2bf_q0
ch2bf_q10_e:
    buffer_load_dwordx4 v[80:83], v1, s[44:47], s67 offen offset:1024 sc1
    buffer_load_dwordx4 v[88:91], v1, s[44:47], s67 offen offset:3072 sc1
    s_add_u32 s83, s83, 1
    s_and_b32 s8, s83, 63
    s_cmp_eq_u32 s8, 0
    s_cbranch_scc1 ch2bf_x
    s_branch ch2bf_q01
ch2bf_q12:
    s_waitcnt vmcnt(1)
    v_fma_mix_f32 v103, v80, 1.0, v88 op_sel:[0,0,0] op_sel_hi:[1,0,1]
    v_fma_mix_f32 v88, v80, 1.0, v88 op_sel:[1,0,1] op_sel_hi:[1,0,1]
    v_fma_mix_f32 v80, v81, 1.0, v89 op_sel:[0,0,0] op_sel_hi:[1,0,1]
    v_fma_mix_f32 v89, v81, 1.0, v89 op_sel:[1,0,1] op_sel_hi:[1,0,1]
    v_fma_mix_f32 v81, v82, 1.0, v90 op_sel:[0,0,0] op_sel_hi:[1,0,1]
    v_fma_mix_f32 v90, v82, 1.0, v90 op_sel:[1,0,1] op_sel_hi:[1,0,1]
    v_fma_mix_f32 v82, v83, 1.0, v91 op_sel:[0,0,0] op_sel_hi:[1,0,1]
    v_fma_mix_f32 v91, v83, 1.0, v91 op_sel:[1,0,1] op_sel_hi:[1,0,1]
    v_maximum3_f32 v114, v88, v89, v90
    v_cmp_u_f32 vcc, v114, v91
    v_exp_f32 v80, v80
    v_exp_f32 v81, v81
    v_exp_f32 v82, v82
    s_cbranch_vccnz ch2bf_q12_e
    v_exp_f32 v83, v103
    v_exp_f32 v88, v88
    v_exp_f32 v89, v89
    v_pk_add_f32 v[98:99], v[80:81], v[82:83]
    v_exp_f32 v90, v90
    v_exp_f32 v91, v91
    v_pk_add_f32 v[98:99], v[98:99], v[88:89]
    v_pk_add_f32 v[98:99], v[98:99], v[90:91]
    s_branch ch2bf_q2
ch2bf_q12_e:
    buffer_load_dwordx4 v[80:83], v1, s[44:47], s67 offen offset:1024 sc1
    buffer_load_dwordx4 v[88:91], v1, s[44:47], s67 offen offset:3072 sc1
    s_add_u32 s83, s83, 1
    s_and_b32 s8, s83, 63
    s_cmp_eq_u32 s8, 0
    s_cbranch_scc1 ch2bf_x
    s_branch ch2bf_q21
ch2bf_q20:
    s_waitcnt vmcnt(2)
    v_fma_mix_f32 v113, v92, 1.0, v94 op_sel:[0,0,0] op_sel_hi:[1,0,1]
    v_fma_mix_f32 v94, v92, 1.0, v94 op_sel:[1,0,1] op_sel_hi:[1,0,1]
    v_fma_mix_f32 v92, v93, 1.0, v95 op_sel:[0,0,0] op_sel_hi:[1,0,1]
    v_fma_mix_f32 v95, v93, 1.0, v95 op_sel:[1,0,1] op_sel_hi:[1,0,1]
    v_cmp_u_f32 vcc, v94, v95
    v_exp_f32 v92, v92
    v_exp_f32 v93, v113
    v_exp_f32 v94, v94
    s_cbranch_vccnz ch2bf_q20_e
    v_exp_f32 v95, v95
    s_nop 0
    v_pk_add_f32 v[100:101], v[92:93], v[94:95]
    s_branch ch2bf_q0
ch2bf_q20_e:
    buffer_load_dwordx4 v[92:95], v10, s[44:47], s67 offen offset:0 sc1
    s_add_u32 s83, s83, 1
    s_and_b32 s8, s83, 63
    s_cmp_eq_u32 s8, 0
    s_cbranch_scc1 ch2bf_x
    s_branch ch2bf_q02
ch2bf_q21:
    s_waitcnt vmcnt(2)
    v_fma_mix_f32 v113, v92, 1.0, v94 op_sel:[0,0,0] op_sel_hi:[1,0,1]
    v_fma_mix_f32 v94, v92, 1.0, v94 op_sel:[1,0,1] op_sel_hi:[1,0,1]
    v_fma_mix_f32 v92, v93, 1.0, v95 op_sel:[0,0,0] op_sel_hi:[1,0,1]
    v_fma_mix_f32 v95, v93, 1.0, v95 op_sel:[1,0,1] op_sel_hi:[1,0,1]
    v_cmp_u_f32 vcc, v94, v95
    v_exp_f32 v92, v92
    v_exp_f32 v93, v113
    v_exp_f32 v94, v94
    s_cbranch_vccnz ch2bf_q21_e
    v_exp_f32 v95, v95
    s_nop 0
    v_pk_add_f32 v[100:101], v[92:93], v[94:95]
    s_branch ch2bf_q1
ch2bf_q21_e:
    buffer_load_dwordx4 v[92:95], v10, s[44:47], s67 offen offset:0 sc1
    s_add_u32 s83, s83, 1
    s_and_b32 s8, s83, 63
    s_cmp_eq_u32 s8, 0
    s_cbranch_scc1 ch2bf_x
    s_branch ch2bf_q12
ch2bf_q012:
    s_waitcnt vmcnt(3)
    v_fma_mix_f32 v102, v76, 1.0, v84 op_sel:[0,0,0] op_sel_hi:[1,0,1]
    v_fma_mix_f32 v84, v76, 1.0, v84 op_sel:[1,0,1] op_sel_hi:[1,0,1]
    v_fma_mix_f32 v76, v77, 1.0, v85 op_sel:[0,0,0] op_sel_hi:[1,0,1]
    v_fma_mix_f32 v85, v77, 1.0, v85 op_sel:[1,0,1] op_sel_hi:[1,0,1]
    v_fma_mix_f32 v77, v78, 1.0, v86 op_sel:[0,0,0] op_sel_hi:[1,0,1]
    v_fma_mix_f32 v86, v78, 1.0, v86 op_sel:[1,0,1] op_sel_hi:[1,0,1]
    v_fma_mix_f32 v78, v79, 1.0, v87 op_sel:[0,0,0] op_sel_hi:[1,0,1]
    v_fma_mix_f32 v87, v79, 1.0, v87 op_sel:[1,0,1] op_sel_hi:[1,0,1]
    v_maximum3_f32 v112, v84, v85, v86
    v_cmp_u_f32 vcc, v112, v87
    v_exp_f32 v76, v76
    v_exp_f32 v77, v77
    v_exp_f32 v78, v78
    s_cbranch_vccnz ch2bf_q012_e
    v_exp_f32 v79, v102
    v_exp_f32 v84, v84
    v_exp_f32 v85, v85
    v_pk_add_f32 v[96:97], v[76:77], v[78:79]
    v_exp_f32 v86, v86
    v_exp_f32 v87, v87
    v_pk_add_f32 v[96:97], v[96:97], v[84:85]
    v_pk_add_f32 v[96:97], v[96:97], v[86:87]
    s_branch ch2bf_q12
ch2bf_q012_e:
    buffer_load_dwordx4 v[76:79], v1, s[44:47], s67 offen offset:0 sc1
    buffer_load_dwordx4 v[84:87], v1, s[44:47], s67 offen offset:2048 sc1
    s_add_u32 s83, s83, 1
    s_and_b32 s8, s83, 63
    s_cmp_eq_u32 s8, 0
    s_cbranch_scc1 ch2bf_x
    s_branch ch2bf_q120
ch2bf_q021:
    s_waitcnt vmcnt(3)
    v_fma_mix_f32 v102, v76, 1.0, v84 op_sel:[0,0,0] op_sel_hi:[1,0,1]
    v_fma_mix_f32 v84, v76, 1.0, v84 op_sel:[1,0,1] op_sel_hi:[1,0,1]
    v_fma_mix_f32 v76, v77, 1.0, v85 op_sel:[0,0,0] op_sel_hi:[1,0,1]
    v_fma_mix_f32 v85, v77, 1.0, v85 op_sel:[1,0,1] op_sel_hi:[1,0,1]
    v_fma_mix_f32 v77, v78, 1.0, v86 op_sel:[0,0,0] op_sel_hi:[1,0,1]
    v_fma_mix_f32 v86, v78, 1.0, v86 op_sel:[1,0,1] op_sel_hi:[1,0,1]
    v_fma_mix_f32 v78, v79, 1.0, v87 op_sel:[0,0,0] op_sel_hi:[1,0,1]
    v_fma_mix_f32 v87, v79, 1.0, v87 op_sel:[1,0,1] op_sel_hi:[1,0,1]
    v_maximum3_f32 v112, v84, v85, v86
    v_cmp_u_f32 vcc, v112, v87
    v_exp_f32 v76, v76
    v_exp_f32 v77, v77
    v_exp_f32 v78, v78
    s_cbranch_vccnz ch2bf_q021_e
    v_exp_f32 v79, v102
    v_exp_f32 v84, v84
    v_exp_f32 v85, v85
    v_pk_add_f32 v[96:97], v[76:77], v[78:79]
    v_exp_f32 v86, v86
    v_exp_f32 v87, v87
    v_pk_add_f32 v[96:97], v[96:97], v[84:85]
    v_pk_add_f32 v[96:97], v[96:97], v[86:87]
    s_branch ch2bf_q21
ch2bf_q021_e:
    buffer_load_dwordx4 v[76:79], v1, s[44:47], s67 offen offset:0 sc1
    buffer_load_dwordx4 v[84:87], v1, s[44:47], s67 offen offset:2048 sc1
    s_add_u32 s83, s83, 1
    s_and_b32 s8, s83, 63
    s_cmp_eq_u32 s8, 0
    s_cbranch_scc1 ch2bf_x
    s_branch ch2bf_q210
ch2bf_q102:
    s_waitcnt vmcnt(3)
    v_fma_mix_f32 v103, v80, 1.0, v88 op_sel:[0,0,0] op_sel_hi:[1,0,1]
    v_fma_mix_f32 v88, v80, 1.0, v88 op_sel:[1,0,1] op_sel_hi:[1,0,1]
    v_fma_mix_f32 v80, v81, 1.0, v89 op_sel:[0,0,0] op_sel_hi:[1,0,1]
    v_fma_mix_f32 v89, v81, 1.0, v89 op_sel:[1,0,1] op_sel_hi:[1,0,1]
    v_fma_mix_f32 v81, v82, 1.0, v90 op_sel:[0,0,0] op_sel_hi:[1,0,1]
    v_fma_mix_f32 v90, v82, 1.0, v90 op_sel:[1,0,1] op_sel_hi:[1,0,1]
    v_fma_mix_f32 v82, v83, 1.0, v91 op_sel:[0,0,0] op_sel_hi:[1,0,1]
    v_fma_mix_f32 v91, v83, 1.0, v91 op_sel:[1,0,1] op_sel_hi:[1,0,1]
    v_maximum3_f32 v114, v88, v89, v90
    v_cmp_u_f32 vcc, v114, v91
    v_exp_f32 v80, v80
    v_exp_f32 v81, v81
    v_exp_f32 v82, v82
    s_cbranch_vccnz ch2bf_q102_e
    v_exp_f32 v83, v103
    v_exp_f32 v88, v88
    v_exp_f32 v89, v89
    v_pk_add_f32 v[98:99], v[80:81], v[82:83]
    v_exp_f32 v90, v90
    v_exp_f32 v91, v91
    v_pk_add_f32 v[98:99], v[98:99], v[88:89]
    v_pk_add_f32 v[98:99], v[98:99], v[90:91]
    s_branch ch2bf_q02
ch2bf_q102_e:
    buffer_load_dwordx4 v[80:83], v1, s[44:47], s67 offen offset:1024 sc1
    buffer_load_dwordx4 v[88:91], v1, s[44:47], s67 offen offset:3072 sc1
    s_add_u32 s83, s83, 1
    s_and_b32 s8, s83, 63
    s_cmp_eq_u32 s8, 0
    s_cbranch_scc1 ch2bf_x
    s_branch ch2bf_q021
ch2bf_q120:
    s_waitcnt vmcnt(3)
    v_fma_mix_f32 v103, v80, 1.0, v88 op_sel:[0,0,0] op_sel_hi:[1,0,1]
    v_fma_mix_f32 v88, v80, 1.0, v88 op_sel:[1,0,1] op_sel_hi:[1,0,1]
    v_fma_mix_f32 v80, v81, 1.0, v89 op_sel:[0,0,0] op_sel_hi:[1,0,1]
    v_fma_mix_f32 v89, v81, 1.0, v89 op_sel:[1,0,1] op_sel_hi:[1,0,1]
    v_fma_mix_f32 v81, v82, 1.0, v90 op_sel:[0,0,0] op_sel_hi:[1,0,1]
    v_fma_mix_f32 v90, v82, 1.0, v90 op_sel:[1,0,1] op_sel_hi:[1,0,1]
    v_fma_mix_f32 v82, v83, 1.0, v91 op_sel:[0,0,0] op_sel_hi:[1,0,1]
    v_fma_mix_f32 v91, v83, 1.0, v91 op_sel:[1,0,1] op_sel_hi:[1,0,1]
    v_maximum3_f32 v114, v88, v89, v90
    v_cmp_u_f32 vcc, v114, v91
    v_exp_f32 v80, v80
    v_exp_f32 v81, v81
    v_exp_f32 v82, v82
    s_cbranch_vccnz ch2bf_q120_e
    v_exp_f32 v83, v103
    v_exp_f32 v88, v88
    v_exp_f32 v89, v89
    v_pk_add_f32 v[98:99], v[80:81], v[82:83]
    v_exp_f32 v90, v90
    v_exp_f32 v91, v91
    v_pk_add_f32 v[98:99], v[98:99], v[88:89]
    v_pk_add_f32 v[98:99], v[98:99], v[90:91]
    s_branch ch2bf_q20
ch2bf_q120_e:
    buffer_load_dwordx4 v[80:83], v1, s[44:47], s67 offen offset:1024 sc1
    buffer_load_dwordx4 v[88:91], v1, s[44:47], s67 offen offset:3072 sc1
    s_add_u32 s83, s83, 1
    s_and_b32 s8, s83, 63
    s_cmp_eq_u32 s8, 0
    s_cbranch_scc1 ch2bf_x
    s_branch ch2bf_q201
ch2bf_q201:
    s_waitcnt vmcnt(4)
    v_fma_mix_f32 v113, v92, 1.0, v94 op_sel:[0,0,0] op_sel_hi:[1,0,1]
    v_fma_mix_f32 v94, v92, 1.0, v94 op_sel:[1,0,1] op_sel_hi:[1,0,1]
    v_fma_mix_f32 v92, v93, 1.0, v95 op_sel:[0,0,0] op_sel_hi:[1,0,1]
    v_fma_mix_f32 v95, v93, 1.0, v95 op_sel:[1,0,1] op_sel_hi:[1,0,1]
    v_cmp_u_f32 vcc, v94, v95
    v_exp_f32 v92, v92
    v_exp_f32 v93, v113
    v_exp_f32 v94, v94
    s_cbranch_vccnz ch2bf_q201_e
    v_exp_f32 v95, v95
    s_nop 0
    v_pk_add_f32 v[100:101], v[92:93], v[94:95]
    s_branch ch2bf_q01
ch2bf_q201_e:
    buffer_load_dwordx4 v[92:95], v10, s[44:47], s67 offen offset:0 sc1
    s_add_u32 s83, s83, 1
    s_and_b32 s8, s83, 63
    s_cmp_eq_u32 s8, 0
    s_cbranch_scc1 ch2bf_x
    s_branch ch2bf_q012
ch2bf_q210:
    s_waitcnt vmcnt(4)
    v_fma_mix_f32 v113, v92, 1.0, v94 op_sel:[0,0,0] op_sel_hi:[1,0,1]
    v_fma_mix_f32 v94, v92, 1.0, v94 op_sel:[1,0,1] op_sel_hi:[1,0,1]
    v_fma_mix_f32 v92, v93, 1.0, v95 op_sel:[0,0,0] op_sel_hi:[1,0,1]
    v_fma_mix_f32 v95, v93, 1.0, v95 op_sel:[1,0,1] op_sel_hi:[1,0,1]
    v_cmp_u_f32 vcc, v94, v95
    v_exp_f32 v92, v92
    v_exp_f32 v93, v113
    v_exp_f32 v94, v94
    s_cbranch_vccnz ch2bf_q210_e
    v_exp_f32 v95, v95
    v_pk_add_f32 v[100:101], v[92:93], v[94:95]
    s_branch ch2bf_q10
ch2bf_q210_e:
    buffer_load_dwordx4 v[92:95], v10, s[44:47], s67 offen offset:0 sc1
    s_add_u32 s83, s83, 1
    s_and_b32 s8, s83, 63
    s_cmp_eq_u32 s8, 0
    s_cbranch_scc1 ch2bf_x
    s_branch ch2bf_q102
ch2bf_fb:
    buffer_load_dwordx4 v[76:79], v1, s[44:47], s67 offen offset:0 sc1
    buffer_load_dwordx4 v[84:87], v1, s[44:47], s67 offen offset:2048 sc1
    buffer_load_dwordx4 v[80:83], v1, s[44:47], s67 offen offset:1024 sc1
    buffer_load_dwordx4 v[88:91], v1, s[44:47], s67 offen offset:3072 sc1
    buffer_load_dwordx4 v[92:95], v10, s[44:47], s67 offen offset:0 sc1
    s_waitcnt vmcnt(0)
    v_fma_mix_f32 v102, v76, 1.0, v84 op_sel:[0,0,0] op_sel_hi:[1,0,1]
    v_fma_mix_f32 v84, v76, 1.0, v84 op_sel:[1,0,1] op_sel_hi:[1,0,1]
    v_fma_mix_f32 v76, v77, 1.0, v85 op_sel:[0,0,0] op_sel_hi:[1,0,1]
    v_fma_mix_f32 v85, v77, 1.0, v85 op_sel:[1,0,1] op_sel_hi:[1,0,1]
    v_fma_mix_f32 v77, v78, 1.0, v86 op_sel:[0,0,0] op_sel_hi:[1,0,1]
    v_fma_mix_f32 v86, v78, 1.0, v86 op_sel:[1,0,1] op_sel_hi:[1,0,1]
    v_fma_mix_f32 v78, v79, 1.0, v87 op_sel:[0,0,0] op_sel_hi:[1,0,1]
    v_fma_mix_f32 v87, v79, 1.0, v87 op_sel:[1,0,1] op_sel_hi:[1,0,1]
    v_maximum3_f32 v112, v102, v84, v76
    v_maximum3_f32 v112, v112, v85, v77
    v_maximum3_f32 v112, v112, v86, v78
    v_maximum3_f32 v112, v112, v87, v87
    v_cmp_u_f32 vcc, v112, v112
    v_mov_b32 v79, v102
    v_pk_add_f32 v[76:77], v[76:77], v[112:113] op_sel_hi:[1,0] neg_lo:[0,1] neg_hi:[0,1]
    v_pk_add_f32 v[78:79], v[78:79], v[112:113] op_sel_hi:[1,0] neg_lo:[0,1] neg_hi:[0,1]
    v_pk_add_f32 v[84:85], v[84:85], v[112:113] op_sel_hi:[1,0] neg_lo:[0,1] neg_hi:[0,1]
    v_pk_add_f32 v[86:87], v[86:87], v[112:113] op_sel_hi:[1,0] neg_lo:[0,1] neg_hi:[0,1]
    v_exp_f32 v76, v76
    v_exp_f32 v77, v77
    v_exp_f32 v78, v78
    v_exp_f32 v79, v79
    v_exp_f32 v84, v84
    v_exp_f32 v85, v85
    v_pk_add_f32 v[96:97], v[76:77], v[78:79]
    v_exp_f32 v86, v86
    v_exp_f32 v87, v87
    v_pk_add_f32 v[96:97], v[96:97], v[84:85]
    v_pk_add_f32 v[96:97], v[96:97], v[86:87]
    v_fma_mix_f32 v103, v80, 1.0, v88 op_sel:[0,0,0] op_sel_hi:[1,0,1]
    v_fma_mix_f32 v88, v80, 1.0, v88 op_sel:[1,0,1] op_sel_hi:[1,0,1]
    v_fma_mix_f32 v80, v81, 1.0, v89 op_sel:[0,0,0] op_sel_hi:[1,0,1]
    v_fma_mix_f32 v89, v81, 1.0, v89 op_sel:[1,0,1] op_sel_hi:[1,0,1]
    v_fma_mix_f32 v81, v82, 1.0, v90 op_sel:[0,0,0] op_sel_hi:[1,0,1]
    v_fma_mix_f32 v90, v82, 1.0, v90 op_sel:[1,0,1] op_sel_hi:[1,0,1]
    v_fma_mix_f32 v82, v83, 1.0, v91 op_sel:[0,0,0] op_sel_hi:[1,0,1]
    v_fma_mix_f32 v91, v83, 1.0, v91 op_sel:[1,0,1] op_sel_hi:[1,0,1]
    v_maximum3_f32 v114, v103, v88, v80
    v_maximum3_f32 v114, v114, v89, v81
    v_maximum3_f32 v114, v114, v90, v82
    v_maximum3_f32 v114, v114, v91, v91
    v_cmp_u_f32 vcc, v114, v114
    v_mov_b32 v83, v103
    v_pk_add_f32 v[80:81], v[80:81], v[114:115] op_sel_hi:[1,0] neg_lo:[0,1] neg_hi:[0,1]
    v_pk_add_f32 v[82:83], v[82:83], v[114:115] op_sel_hi:[1,0] neg_lo:[0,1] neg_hi:[0,1]
    v_pk_add_f32 v[88:89], v[88:89], v[114:115] op_sel_hi:[1,0] neg_lo:[0,1] neg_hi:[0,1]
    v_pk_add_f32 v[90:91], v[90:91], v[114:115] op_sel_hi:[1,0] neg_lo:[0,1] neg_hi:[0,1]
    v_exp_f32 v80, v80
    v_exp_f32 v81, v81
    v_exp_f32 v82, v82
    v_exp_f32 v83, v83
    v_exp_f32 v88, v88
    v_exp_f32 v89, v89
    v_pk_add_f32 v[98:99], v[80:81], v[82:83]
    v_exp_f32 v90, v90
    v_exp_f32 v91, v91
    v_pk_add_f32 v[98:99], v[98:99], v[88:89]
    v_pk_add_f32 v[98:99], v[98:99], v[90:91]
    v_fma_mix_f32 v113, v92, 1.0, v94 op_sel:[0,0,0] op_sel_hi:[1,0,1]
    v_fma_mix_f32 v94, v92, 1.0, v94 op_sel:[1,0,1] op_sel_hi:[1,0,1]
    v_fma_mix_f32 v92, v93, 1.0, v95 op_sel:[0,0,0] op_sel_hi:[1,0,1]
    v_fma_mix_f32 v95, v93, 1.0, v95 op_sel:[1,0,1] op_sel_hi:[1,0,1]
    v_maximum3_f32 v116, v113, v94, v92
    v_maximum3_f32 v116, v116, v95, v95
    v_cmp_u_f32 vcc, v116, v116
    v_mov_b32 v93, v113
    v_pk_add_f32 v[92:93], v[92:93], v[116:117] op_sel_hi:[1,0] neg_lo:[0,1] neg_hi:[0,1]
    v_pk_add_f32 v[94:95], v[94:95], v[116:117] op_sel_hi:[1,0] neg_lo:[0,1] neg_hi:[0,1]
    v_exp_f32 v92, v92
    v_exp_f32 v93, v93
    v_exp_f32 v94, v94
    v_exp_f32 v95, v95
    s_nop 0
    v_pk_add_f32 v[100:101], v[92:93], v[94:95]
    v_max3_f32 v2, v112, v114, v116
    v_max3_f32 v15, v112, v114, v116
    v_add_f32 v96, v96, v97
    v_add_f32 v98, v98, v99
    v_add_f32 v100, v100, v101
    v_permlane16_swap_b32 v2, v15
    v_max_f32 v2, v2, v15
    v_sub_f32 v112, v112, v2
    v_sub_f32 v114, v114, v2
    v_sub_f32 v116, v116, v2
    v_exp_f32 v112, v112
    v_exp_f32 v114, v114
    v_exp_f32 v116, v116
    v_mul_f32 v2, v112, v96
    v_fmac_f32 v2, v114, v98
    v_fmac_f32 v2, v116, v100
    v_mov_b32 v15, v2
    s_nop 1
    v_permlane16_swap_b32 v2, v15
    v_add_f32 v2, v2, v15
    v_rcp_f32 v2, v2
    s_nop 0
    v_mul_f32 v116, v116, v2
    v_mul_f32 v112, v112, v2
    v_mul_f32 v114, v114, v2
    s_waitcnt lgkmcnt(0)
    v_pk_mul_f32 v[92:93], v[92:93], v[116:117] op_sel_hi:[1,0]
    v_pk_mul_f32 v[94:95], v[94:95], v[116:117] op_sel_hi:[1,0]
    v_cvt_pk_bf16_f32 v116, v93, v94
    v_cvt_pk_bf16_f32 v118, v92, v95
    v_pk_mul_f32 v[76:77], v[76:77], v[112:113] op_sel_hi:[1,0]
    v_pk_mul_f32 v[78:79], v[78:79], v[112:113] op_sel_hi:[1,0]
    v_pk_mul_f32 v[84:85], v[84:85], v[112:113] op_sel_hi:[1,0]
    v_pk_mul_f32 v[86:87], v[86:87], v[112:113] op_sel_hi:[1,0]
    v_cvt_pk_bf16_f32 v96, v79, v84
    v_cvt_pk_bf16_f32 v97, v76, v85
    v_cvt_pk_bf16_f32 v98, v77, v86
    v_cvt_pk_bf16_f32 v99, v78, v87
    v_pk_mul_f32 v[80:81], v[80:81], v[114:115] op_sel_hi:[1,0]
    v_pk_mul_f32 v[82:83], v[82:83], v[114:115] op_sel_hi:[1,0]
    v_pk_mul_f32 v[88:89], v[88:89], v[114:115] op_sel_hi:[1,0]
    v_pk_mul_f32 v[90:91], v[90:91], v[114:115] op_sel_hi:[1,0]
    v_smfmac_f32_16x16x64_bf16 v[60:63], v[116:119], v[104:111], v5
    v_cvt_pk_bf16_f32 v100, v83, v88
    v_cvt_pk_bf16_f32 v101, v80, v89
    v_smfmac_f32_16x16x64_bf16 v[60:63], v[96:99], v[44:51], v5
    v_cvt_pk_bf16_f32 v102, v81, v90
    v_cvt_pk_bf16_f32 v103, v82, v91
    s_nop 1
    v_smfmac_f32_16x16x64_bf16 v[60:63], v[100:103], v[52:59], v5
    s_branch ch2bf_kj
ch2bf_x:
    s_cmp_ge_u32 s83, 2000000
    s_cbranch_scc1 chain_abort
    buffer_load_dwordx4 v[76:79], v1, s[44:47], s67 offen offset:0 sc1
    buffer_load_dwordx4 v[84:87], v1, s[44:47], s67 offen offset:2048 sc1
    buffer_load_dwordx4 v[80:83], v1, s[44:47], s67 offen offset:1024 sc1
    buffer_load_dwordx4 v[88:91], v1, s[44:47], s67 offen offset:3072 sc1
    buffer_load_dwordx4 v[92:95], v10, s[44:47], s67 offen offset:0 sc1
    s_waitcnt vmcnt(0)
    v_pk_max_u16 v2, v76, v77
    v_pk_max_u16 v2, v2, v78
    v_pk_max_u16 v2, v2, v79
    v_pk_max_u16 v2, v2, v80
    v_pk_max_u16 v2, v2, v81
    v_pk_max_u16 v2, v2, v82
    v_pk_max_u16 v2, v2, v83
    v_pk_max_u16 v2, v2, v84
    v_pk_max_u16 v2, v2, v85
    v_pk_max_u16 v2, v2, v86
    v_pk_max_u16 v2, v2, v87
    v_pk_max_u16 v2, v2, v88
    v_pk_max_u16 v2, v2, v89
    v_pk_max_u16 v2, v2, v90
    v_pk_max_u16 v2, v2, v91
    v_pk_max_u16 v2, v2, v92
    v_pk_max_u16 v2, v2, v93
    v_pk_max_u16 v2, v2, v94
    v_pk_max_u16 v2, v2, v95
    v_lshrrev_b32 v112, 16, v2
    v_and_b32 v2, 0xffff, v2
    v_max_u32 v2, v2, v112
    v_cmp_eq_u32 vcc, 0xffff, v2
    s_cbranch_vccnz ch2bf_q012
    v_fma_mix_f32 v102, v76, 1.0, v84 op_sel:[0,0,0] op_sel_hi:[1,0,1]
    v_fma_mix_f32 v84, v76, 1.0, v84 op_sel:[1,0,1] op_sel_hi:[1,0,1]
    v_fma_mix_f32 v76, v77, 1.0, v85 op_sel:[0,0,0] op_sel_hi:[1,0,1]
    v_fma_mix_f32 v85, v77, 1.0, v85 op_sel:[1,0,1] op_sel_hi:[1,0,1]
    v_fma_mix_f32 v77, v78, 1.0, v86 op_sel:[0,0,0] op_sel_hi:[1,0,1]
    v_fma_mix_f32 v86, v78, 1.0, v86 op_sel:[1,0,1] op_sel_hi:[1,0,1]
    v_fma_mix_f32 v78, v79, 1.0, v87 op_sel:[0,0,0] op_sel_hi:[1,0,1]
    v_fma_mix_f32 v87, v79, 1.0, v87 op_sel:[1,0,1] op_sel_hi:[1,0,1]
    v_exp_f32 v76, v76
    v_exp_f32 v77, v77
    v_exp_f32 v78, v78
    v_exp_f32 v79, v102
    v_exp_f32 v84, v84
    v_exp_f32 v85, v85
    v_pk_add_f32 v[96:97], v[76:77], v[78:79]
    v_exp_f32 v86, v86
    v_exp_f32 v87, v87
    v_pk_add_f32 v[96:97], v[96:97], v[84:85]
    v_pk_add_f32 v[96:97], v[96:97], v[86:87]
    v_fma_mix_f32 v103, v80, 1.0, v88 op_sel:[0,0,0] op_sel_hi:[1,0,1]
    v_fma_mix_f32 v88, v80, 1.0, v88 op_sel:[1,0,1] op_sel_hi:[1,0,1]
    v_fma_mix_f32 v80, v81, 1.0, v89 op_sel:[0,0,0] op_sel_hi:[1,0,1]
    v_fma_mix_f32 v89, v81, 1.0, v89 op_sel:[1,0,1] op_sel_hi:[1,0,1]
    v_fma_mix_f32 v81, v82, 1.0, v90 op_sel:[0,0,0] op_sel_hi:[1,0,1]
    v_fma_mix_f32 v90, v82, 1.0, v90 op_sel:[1,0,1] op_sel_hi:[1,0,1]
    v_fma_mix_f32 v82, v83, 1.0, v91 op_sel:[0,0,0] op_sel_hi:[1,0,1]
    v_fma_mix_f32 v91, v83, 1.0, v91 op_sel:[1,0,1] op_sel_hi:[1,0,1]
    v_exp_f32 v80, v80
    v_exp_f32 v81, v81
    v_exp_f32 v82, v82
    v_exp_f32 v83, v103
    v_exp_f32 v88, v88
    v_exp_f32 v89, v89
    v_pk_add_f32 v[98:99], v[80:81], v[82:83]
    v_exp_f32 v90, v90
    v_exp_f32 v91, v91
    v_pk_add_f32 v[98:99], v[98:99], v[88:89]
    v_pk_add_f32 v[98:99], v[98:99], v[90:91]
    v_fma_mix_f32 v113, v92, 1.0, v94 op_sel:[0,0,0] op_sel_hi:[1,0,1]
    v_fma_mix_f32 v94, v92, 1.0, v94 op_sel:[1,0,1] op_sel_hi:[1,0,1]
    v_fma_mix_f32 v92, v93, 1.0, v95 op_sel:[0,0,0] op_sel_hi:[1,0,1]
    v_fma_mix_f32 v95, v93, 1.0, v95 op_sel:[1,0,1] op_sel_hi:[1,0,1]
    v_exp_f32 v92, v92
    v_exp_f32 v93, v113
    v_exp_f32 v94, v94
    v_exp_f32 v95, v95
    s_nop 0
    v_pk_add_f32 v[100:101], v[92:93], v[94:95]
    s_branch ch2bf_k0
ch2bf_vw:
    v_lshlrev_b32 v113, 7, v0
    s_mov_b32 s99, 0
hz_174:
    buffer_load_dword v115, v113, s[44:47], s75 offen sc1
    s_waitcnt vmcnt(0)
    v_cmp_gt_u32 vcc, 28, v115
    s_ff1_i32_b64 s100, vcc
    s_cmp_eq_u32 s100, -1
    s_cselect_b32 s100, 65, s100
    s_sub_u32 s100, s100, 1
    s_cmp_gt_i32 s100, s64
    s_cbranch_scc1 hd_175
    s_sleep 1
    s_add_u32 s99, s99, 1
    s_cmp_lt_u32 s99, 400000
    s_cbranch_scc1 hz_174
    s_branch chain_abort
hd_175:
    s_branch ch2bf_vok
ch2af:
    v_mov_b32 v44, 0
    v_mov_b32 v60, 0
    v_mov_b32 v45, 0
    v_mov_b32 v61, 0
    v_mov_b32 v46, 0
    v_mov_b32 v62, 0
    v_mov_b32 v47, 0
    v_mov_b32 v63, 0
    v_mov_b32 v48, 0
    v_mov_b32 v64, 0
    v_mov_b32 v49, 0
    v_mov_b32 v65, 0
    v_mov_b32 v50, 0
    v_mov_b32 v66, 0
    v_mov_b32 v51, 0
    v_mov_b32 v67, 0
    v_mov_b32 v52, 0
    v_mov_b32 v68, 0
    v_mov_b32 v53, 0
    v_mov_b32 v69, 0
    v_mov_b32 v54, 0
    v_mov_b32 v70, 0
    v_mov_b32 v55, 0
    v_mov_b32 v71, 0
    v_mov_b32 v56, 0
    v_mov_b32 v72, 0
    v_mov_b32 v57, 0
    v_mov_b32 v73, 0
    v_mov_b32 v58, 0
    v_mov_b32 v74, 0
    v_mov_b32 v59, 0
    v_mov_b32 v75, 0
    v_mov_b32 v112, 0
    v_mov_b32 v113, 0
    v_mov_b32 v114, 0
    v_mov_b32 v115, 0
    s_branch ch2af_loop
.p2align 6
ch2af_loop:
    s_and_b32 s8, s64, 3
    s_lshl_b32 s65, s8, 13
    s_add_u32 s65, s65, 94900224
    buffer_load_dwordx4 v[32:35], v1, s[44:47], s65 offen offset:0 sc1
    buffer_load_dwordx4 v[36:39], v1, s[44:47], s65 offen offset:1024 sc1
    s_mov_b32 s83, 0
    s_and_b32 s8, s64, 3
    s_mul_i32 s9, s8, 20736
    s_add_u32 s67, s9, 94939136
    s_add_u32 s66, s9, s12
    s_xor_b32 s8, s8, 2
    s_mul_i32 s9, s8, 20736
    s_add_u32 s70, s9, s13
ch2af_mp:
    buffer_load_dwordx4 v[32:35], v1, s[44:47], s65 offen offset:0 sc1
    buffer_load_dwordx4 v[36:39], v1, s[44:47], s65 offen offset:1024 sc1
    s_add_u32 s83, s83, 1
    s_cmp_ge_u32 s83, 2000000
    s_cbranch_scc1 chain_abort
    s_waitcnt vmcnt(3)
    v_max3_u32 v2, v32, v33, v34
    v_max_u32 v2, v2, v35
    v_cmp_eq_u32 s[10:11], -1, v2
    s_waitcnt vmcnt(2)
    v_max3_u32 v2, v36, v37, v38
    v_max_u32 v2, v2, v39
    v_cmp_eq_u32 vcc, -1, v2
    s_cmp_lg_u64 s[10:11], 0
    s_cbranch_scc1 ch2af_m0bad
    s_cbranch_vccnz ch2af_mp1
ch2af_mok:
    ds_write_b128 v1, v[32:35] offset:4096
    ds_write_b128 v1, v[36:39] offset:5120
    v_smfmac_f32_16x16x64_bf16 v[44:47], v[32:35], a[32:39], v5
    v_smfmac_f32_16x16x64_bf16 v[48:51], v[32:35], a[88:95], v5
    s_waitcnt lgkmcnt(0)
    s_barrier
    ds_read_b128 v[16:19], v1 offset:0
    ds_read_b128 v[20:23], v1 offset:1024
    ds_read_b128 v[24:27], v1 offset:2048
    ds_read_b128 v[28:31], v1 offset:3072
    ds_read_b128 v[40:43], v1 offset:6144
    v_smfmac_f32_16x16x64_bf16 v[52:55], v[32:35], a[144:151], v5
    buffer_store_dword v3, v4, s[44:47], s70 offen
    v_smfmac_f32_16x16x64_bf16 v[44:47], v[36:39], a[40:47], v5
    v_smfmac_f32_16x16x64_bf16 v[48:51], v[36:39], a[96:103], v5
    v_smfmac_f32_16x16x64_bf16 v[52:55], v[36:39], a[152:159], v5
    s_waitcnt lgkmcnt(4)
    v_smfmac_f32_16x16x64_bf16 v[44:47], v[16:19], a[0:7], v5
    s_waitcnt lgkmcnt(3)
    v_smfmac_f32_16x16x64_bf16 v[44:47], v[20:23], a[8:15], v5
    s_waitcnt lgkmcnt(2)
    v_smfmac_f32_16x16x64_bf16 v[44:47], v[24:27], a[16:23], v5
    ds_read_b128 v[76:79], v12 offset:0
    s_waitcnt lgkmcnt(2)
    v_smfmac_f32_16x16x64_bf16 v[44:47], v[28:31], a[24:31], v5
    ds_read_b128 v[80:83], v12 offset:1024
    s_waitcnt lgkmcnt(2)
    v_smfmac_f32_16x16x64_bf16 v[44:47], v[40:43], a[48:55], v5
    ds_read_b128 v[84:87], v12 offset:2048
    v_smfmac_f32_16x16x64_bf16 v[48:51], v[16:19], a[56:63], v5
    ds_read_b128 v[88:91], v12 offset:3072
    v_smfmac_f32_16x16x64_bf16 v[48:51], v[20:23], a[64:71], v5
    ds_read_b128 v[92:95], v12 offset:4096
    v_smfmac_f32_16x16x64_bf16 v[48:51], v[24:27], a[72:79], v5
    ds_read_b128 v[96:99], v12 offset:5120
    v_smfmac_f32_16x16x64_bf16 v[48:51], v[28:31], a[80:87], v5
    v_add_f32 v44, v44, v46
    v_smfmac_f32_16x16x64_bf16 v[48:51], v[40:43], a[104:111], v5
    v_add_f32 v45, v45, v47
    v_smfmac_f32_16x16x64_bf16 v[52:55], v[16:19], a[112:119], v5
    v_cvt_pk_bf16_f32 v44, v44, v45
    v_smfmac_f32_16x16x64_bf16 v[52:55], v[20:23], a[120:127], v5
    ds_write_b32 v6, v44 offset:1536
    v_smfmac_f32_16x16x64_bf16 v[52:55], v[24:27], a[128:135], v5
    ds_read_b128 v[100:103], v12 offset:6144
    v_smfmac_f32_16x16x64_bf16 v[52:55], v[28:31], a[136:143], v5
    v_add_f32 v48, v48, v50
    v_smfmac_f32_16x16x64_bf16 v[52:55], v[40:43], a[160:167], v5
    v_add_f32 v49, v49, v51
    v_cvt_pk_bf16_f32 v48, v48, v49
    ds_write_b32 v6, v48 offset:1792
    v_xor_b32 v12, 0x4000, v12
    s_nop 3
    v_add_f32 v52, v52, v54
    v_add_f32 v53, v53, v55
    v_cvt_pk_bf16_f32 v52, v52, v53
    ds_write_b32 v6, v52 offset:2048
    s_waitcnt lgkmcnt(0)
    s_barrier
    ds_read_b64_tr_b16 v[44:45], v7 offset:0
    ds_read_b64_tr_b16 v[46:47], v7 offset:128
    ds_read_b64_tr_b16 v[48:49], v7 offset:1024
    ds_read_b64_tr_b16 v[50:51], v7 offset:1152
    ds_read_b64_tr_b16 v[52:53], v7 offset:2048
    ds_read_b64_tr_b16 v[54:55], v7 offset:2176
    s_barrier
    ds_read_b64_tr_b16 v[56:57], v7 offset:3072
    ds_read_b64_tr_b16 v[58:59], v7 offset:3200
    s_waitcnt lgkmcnt(6)
    v_smfmac_f32_16x16x64_bf16 v[112:115], v[44:47], v[76:83], v5
    s_waitcnt lgkmcnt(4)
    v_smfmac_f32_16x16x64_bf16 v[112:115], v[48:51], v[84:91], v5
    s_waitcnt lgkmcnt(2)
    v_smfmac_f32_16x16x64_bf16 v[112:115], v[52:55], v[92:99], v5
    s_waitcnt lgkmcnt(0)
    v_smfmac_f32_16x16x64_bf16 v[112:115], v[56:59], v[100:107], v5
    s_nop 7
    v_pk_add_f32 v[112:113], v[112:113], v[114:115]
    v_pk_mul_f32 v[112:113], v[112:113], s[78:79]
    v_cvt_pk_f16_f32 v112, v112, v113
    s_nop 1
    v_mov_b32_dpp v113, v112 quad_perm:[1,0,3,2] row_mask:0xf bank_mask:0xf
    v_perm_b32 v112, v113, v112, v14
    v_pk_min_u16 v112, v112, s77
    buffer_store_dword v112, v9, s[44:47], s66 offen
    s_barrier
    s_add_u32 s71, s71, 458752
    s_add_u32 s8, s64, s7
    s_and_b32 s8, s8, 3
    s_cmp_lg_u32 s8, 0
    s_cselect_b32 s101, -1, s64
    s_cbranch_scc1 ch2af_np
    s_lshl_b32 s8, s64, 13
    s_add_u32 s8, s8, 91754496
    buffer_store_dwordx4 v[32:35], v1, s[44:47], s8 offen offset:0 sc1
    buffer_store_dwordx4 v[36:39], v1, s[44:47], s8 offen offset:1024 sc1
ch2af_np:
    v_mov_b32 v44, 0
    v_mov_b32 v45, 0
    v_mov_b32 v46, 0
    v_mov_b32 v47, 0
    v_mov_b32 v48, 0
    v_mov_b32 v49, 0
    v_mov_b32 v50, 0
    v_mov_b32 v51, 0
    v_mov_b32 v52, 0
    v_mov_b32 v53, 0
    v_mov_b32 v54, 0
    v_mov_b32 v55, 0
    v_mov_b32 v112, 0
    v_mov_b32 v113, 0
    v_mov_b32 v114, 0
    v_mov_b32 v115, 0
    s_add_u32 s64, s64, 1
    s_cmp_lt_u32 s64, 63
    s_cbranch_scc1 ch2af_loop
    s_waitcnt vmcnt(0)
    s_barrier
    s_endpgm
ch2af_mp1:
    buffer_load_dwordx4 v[36:39], v1, s[44:47], s65 offen offset:1024 sc1
    s_add_u32 s83, s83, 1
    s_cmp_ge_u32 s83, 2000000
    s_cbranch_scc1 chain_abort
    s_waitcnt vmcnt(1)
    v_max3_u32 v2, v36, v37, v38
    v_max_u32 v2, v2, v39
    v_cmp_eq_u32 vcc, -1, v2
    s_cbranch_vccnz ch2af_mp1
    s_branch ch2af_mok
ch2af_m0bad:
    s_cbranch_vccnz ch2af_mp
ch2af_mp0:
    buffer_load_dwordx4 v[32:35], v1, s[44:47], s65 offen offset:0 sc1
    s_add_u32 s83, s83, 1
    s_cmp_ge_u32 s83, 2000000
    s_cbranch_scc1 chain_abort
    s_waitcnt vmcnt(1)
    v_max3_u32 v2, v32, v33, v34
    v_max_u32 v2, v2, v35
    v_cmp_eq_u32 vcc, -1, v2
    s_cbranch_vccnz ch2af_mp0
    s_branch ch2af_mok
ch3bf:
    v_mov_b32 v44, 0
    v_mov_b32 v60, 0
    v_mov_b32 v45, 0
    v_mov_b32 v61, 0
    v_mov_b32 v46, 0
    v_mov_b32 v62, 0
    v_mov_b32 v47, 0
    v_mov_b32 v63, 0
    v_mov_b32 v48, 0
    v_mov_b32 v64, 0
    v_mov_b32 v49, 0
    v_mov_b32 v65, 0
    v_mov_b32 v50, 0
    v_mov_b32 v66, 0
    v_mov_b32 v51, 0
    v_mov_b32 v67, 0
    v_mov_b32 v52, 0
    v_mov_b32 v68, 0
    v_mov_b32 v53, 0
    v_mov_b32 v69, 0
    v_mov_b32 v54, 0
    v_mov_b32 v70, 0
    v_mov_b32 v55, 0
    v_mov_b32 v71, 0
    v_mov_b32 v56, 0
    v_mov_b32 v72, 0
    v_mov_b32 v57, 0
    v_mov_b32 v73, 0
    v_mov_b32 v58, 0
    v_mov_b32 v74, 0
    v_mov_b32 v59, 0
    v_mov_b32 v75, 0
    v_mov_b32 v112, 0
    v_mov_b32 v113, 0
    v_mov_b32 v114, 0
    v_mov_b32 v115, 0
    s_branch ch3bf_loop
.p2align 6
ch3bf_loop:
    s_and_b32 s8, s64, 3
    s_lshl_b32 s65, s8, 13
    s_add_u32 s65, s65, 94902272
    buffer_load_dwordx4 v[40:43], v1, s[44:47], s65 offen offset:0 sc1
    s_mov_b32 s83, 0
    s_and_b32 s8, s64, 3
    s_mul_i32 s9, s8, 20736
    s_add_u32 s67, s9, 94944256
    s_add_u32 s66, s9, s12
    s_xor_b32 s8, s8, 2
    s_mul_i32 s9, s8, 20736
    s_add_u32 s70, s9, s13
    s_add_u32 s24, s71, 0
    s_add_u32 s71, s71, 458752
    v_mov_b32 v60, 0
    v_mov_b32 v61, 0
    v_mov_b32 v62, 0
    v_mov_b32 v63, 0
    v_mov_b32 v64, 0
    v_mov_b32 v65, 0
    v_mov_b32 v66, 0
    v_mov_b32 v67, 0
    v_mov_b32 v68, 0
    v_mov_b32 v69, 0
    v_mov_b32 v70, 0
    v_mov_b32 v71, 0
    v_mov_b32 v72, 0
    v_mov_b32 v73, 0
    v_mov_b32 v74, 0
    v_mov_b32 v75, 0
ch3bf_mp:
    buffer_load_dwordx4 v[40:43], v1, s[44:47], s65 offen offset:0 sc1
    s_add_u32 s83, s83, 1
    s_cmp_ge_u32 s83, 2000000
    s_cbranch_scc1 chain_abort
    s_waitcnt vmcnt(1)
    v_max3_u32 v2, v40, v41, v42
    v_max_u32 v2, v2, v43
    v_cmp_eq_u32 vcc, -1, v2
    s_cbranch_vccnz ch3bf_mp
    ds_write_b128 v1, v[40:43] offset:6144
    v_smfmac_f32_16x16x64_bf16 v[44:47], v[40:43], a[48:55], v5
    v_smfmac_f32_16x16x64_bf16 v[48:51], v[40:43], a[104:111], v5
    s_waitcnt lgkmcnt(0)
    s_barrier
    s_mov_b32 m0, 28672
    ds_read_b128 v[16:19], v1 offset:0
    ds_read_b128 v[20:23], v1 offset:1024
    ds_read_b128 v[24:27], v1 offset:2048
    ds_read_b128 v[28:31], v1 offset:3072
    ds_read_b128 v[32:35], v1 offset:4096
    ds_read_b128 v[36:39], v1 offset:5120
    v_smfmac_f32_16x16x64_bf16 v[52:55], v[40:43], a[160:167], v5
    buffer_load_dwordx4 v1, s[44:47], s24 offen offset:2048 sc1 lds
    v_smfmac_f32_16x16x64_bf16 v[60:63], v[40:43], v[136:143], v5
    buffer_load_dwordx4 v1, s[44:47], s24 offen offset:3072 sc1 lds
    v_smfmac_f32_16x16x64_bf16 v[64:67], v[40:43], v[192:199], v5
    v_smfmac_f32_16x16x64_bf16 v[68:71], v[40:43], v[248:255], v5
    s_waitcnt lgkmcnt(5)
    v_smfmac_f32_16x16x64_bf16 v[44:47], v[16:19], a[0:7], v5
    s_waitcnt lgkmcnt(4)
    v_smfmac_f32_16x16x64_bf16 v[44:47], v[20:23], a[8:15], v5
    s_waitcnt lgkmcnt(3)
    v_smfmac_f32_16x16x64_bf16 v[44:47], v[24:27], a[16:23], v5
    ds_read_b128 v[76:79], v12 offset:0
    s_waitcnt lgkmcnt(3)
    v_smfmac_f32_16x16x64_bf16 v[44:47], v[28:31], a[24:31], v5
    ds_read_b128 v[80:83], v12 offset:1024
    s_waitcnt lgkmcnt(3)
    v_smfmac_f32_16x16x64_bf16 v[44:47], v[32:35], a[32:39], v5
    ds_read_b128 v[84:87], v12 offset:2048
    s_waitcnt lgkmcnt(3)
    v_smfmac_f32_16x16x64_bf16 v[44:47], v[36:39], a[40:47], v5
    ds_read_b128 v[88:91], v12 offset:3072
    v_smfmac_f32_16x16x64_bf16 v[48:51], v[16:19], a[56:63], v5
    ds_read_b128 v[92:95], v12 offset:4096
    v_smfmac_f32_16x16x64_bf16 v[48:51], v[20:23], a[64:71], v5
    ds_read_b128 v[96:99], v12 offset:5120
    v_smfmac_f32_16x16x64_bf16 v[48:51], v[24:27], a[72:79], v5
    ds_read_b128 v[100:103], v12 offset:6144
    v_smfmac_f32_16x16x64_bf16 v[48:51], v[28:31], a[80:87], v5
    v_add_f32 v44, v44, v46
    v_smfmac_f32_16x16x64_bf16 v[48:51], v[32:35], a[88:95], v5
    v_add_f32 v45, v45, v47
    v_smfmac_f32_16x16x64_bf16 v[48:51], v[36:39], a[96:103], v5
    v_cvt_pk_bf16_f32 v44, v44, v45
    v_smfmac_f32_16x16x64_bf16 v[52:55], v[16:19], a[112:119], v5
    ds_write_b32 v6, v44 offset:2304
    v_smfmac_f32_16x16x64_bf16 v[52:55], v[20:23], a[120:127], v5
    v_xor_b32 v12, 0x4000, v12
    v_smfmac_f32_16x16x64_bf16 v[52:55], v[24:27], a[128:135], v5
    v_smfmac_f32_16x16x64_bf16 v[52:55], v[28:31], a[136:143], v5
    s_nop 0
    v_add_f32 v48, v48, v50
    v_smfmac_f32_16x16x64_bf16 v[52:55], v[32:35], a[144:151], v5
    v_add_f32 v49, v49, v51
    v_smfmac_f32_16x16x64_bf16 v[52:55], v[36:39], a[152:159], v5
    v_cvt_pk_bf16_f32 v48, v48, v49
    ds_write_b32 v6, v48 offset:2560
    s_nop 5
    v_add_f32 v52, v52, v54
    v_add_f32 v53, v53, v55
    v_cvt_pk_bf16_f32 v52, v52, v53
    ds_write_b32 v6, v52 offset:2816
    v_smfmac_f32_16x16x64_bf16 v[60:63], v[16:19], a[224:231], v5
    v_smfmac_f32_16x16x64_bf16 v[60:63], v[20:23], a[232:239], v5
    v_smfmac_f32_16x16x64_bf16 v[60:63], v[24:27], a[240:247], v5
    v_smfmac_f32_16x16x64_bf16 v[60:63], v[28:31], a[248:255], v5
    v_smfmac_f32_16x16x64_bf16 v[60:63], v[32:35], v[120:127], v5
    s_waitcnt lgkmcnt(0)
    s_barrier
    ds_read_b64_tr_b16 v[44:45], v7 offset:0
    ds_read_b64_tr_b16 v[46:47], v7 offset:128
    ds_read_b64_tr_b16 v[48:49], v7 offset:1024
    ds_read_b64_tr_b16 v[50:51], v7 offset:1152
    ds_read_b64_tr_b16 v[52:53], v7 offset:2048
    ds_read_b64_tr_b16 v[54:55], v7 offset:2176
    v_smfmac_f32_16x16x64_bf16 v[60:63], v[36:39], v[128:135], v5
    s_barrier
    ds_read_b64_tr_b16 v[56:57], v7 offset:3072
    ds_read_b64_tr_b16 v[58:59], v7 offset:3200
    s_waitcnt lgkmcnt(6)
    v_smfmac_f32_16x16x64_bf16 v[112:115], v[44:47], v[76:83], v5
    s_waitcnt lgkmcnt(4)
    v_smfmac_f32_16x16x64_bf16 v[112:115], v[48:51], v[84:91], v5
    s_waitcnt lgkmcnt(2)
    v_smfmac_f32_16x16x64_bf16 v[112:115], v[52:55], v[92:99], v5
    s_waitcnt lgkmcnt(0)
    v_smfmac_f32_16x16x64_bf16 v[112:115], v[56:59], v[100:107], v5
    s_nop 7
    v_pk_add_f32 v[112:113], v[112:113], v[114:115]
    v_pk_mul_f32 v[112:113], v[112:113], s[78:79]
    v_cvt_pk_f16_f32 v112, v112, v113
    s_nop 1
    v_mov_b32_dpp v113, v112 quad_perm:[1,0,3,2] row_mask:0xf bank_mask:0xf
    v_perm_b32 v112, v113, v112, v14
    v_pk_min_u16 v112, v112, s77
    buffer_store_dword v112, v9, s[44:47], s66 offen
    s_mov_b32 s83, 0
    s_mov_b32 s98, 0
    v_smfmac_f32_16x16x64_bf16 v[64:67], v[16:19], v[144:151], v5
    v_smfmac_f32_16x16x64_bf16 v[64:67], v[20:23], v[152:159], v5
    v_smfmac_f32_16x16x64_bf16 v[64:67], v[24:27], v[160:167], v5
    v_smfmac_f32_16x16x64_bf16 v[64:67], v[28:31], v[168:175], v5
    v_smfmac_f32_16x16x64_bf16 v[64:67], v[32:35], v[176:183], v5
    v_smfmac_f32_16x16x64_bf16 v[64:67], v[36:39], v[184:191], v5
    v_add_f32 v60, v60, v62
    v_smfmac_f32_16x16x64_bf16 v[68:71], v[16:19], v[200:207], v5
    v_add_f32 v61, v61, v63
    v_smfmac_f32_16x16x64_bf16 v[68:71], v[20:23], v[208:215], v5
    v_cvt_pk_bf16_f32 v104, v60, v61
    v_smfmac_f32_16x16x64_bf16 v[68:71], v[24:27], v[216:223], v5
    v_mov_b32 v60, 0
    v_smfmac_f32_16x16x64_bf16 v[68:71], v[28:31], v[224:231], v5
    v_mov_b32 v61, 0
    v_smfmac_f32_16x16x64_bf16 v[68:71], v[32:35], v[232:239], v5
    s_cmp_ge_u32 s100, 64
    s_cbranch_scc0 ch3bf_hl
ch3bf_hs:
    buffer_load_dwordx4 v[76:79], v1, s[44:47], s67 offen offset:0 sc1
    buffer_load_dwordx4 v[84:87], v1, s[44:47], s67 offen offset:2048 sc1
    v_smfmac_f32_16x16x64_bf16 v[68:71], v[36:39], v[240:247], v5
    v_mov_b32 v62, 0
    v_smfmac_f32_16x16x64_bf16 v[72:75], v[16:19], a[168:175], v5
    v_mov_b32 v63, 0
    v_smfmac_f32_16x16x64_bf16 v[72:75], v[20:23], a[176:183], v5
    buffer_load_dwordx4 v[80:83], v1, s[44:47], s67 offen offset:1024 sc1
    buffer_load_dwordx4 v[88:91], v1, s[44:47], s67 offen offset:3072 sc1
    v_smfmac_f32_16x16x64_bf16 v[72:75], v[24:27], a[184:191], v5
    v_add_f32 v64, v64, v66
    v_smfmac_f32_16x16x64_bf16 v[72:75], v[28:31], a[192:199], v5
    v_add_f32 v65, v65, v67
    v_smfmac_f32_16x16x64_bf16 v[72:75], v[32:35], a[200:207], v5
    buffer_load_dwordx4 v[92:95], v10, s[44:47], s67 offen offset:0 sc1
    v_smfmac_f32_16x16x64_bf16 v[72:75], v[36:39], a[208:215], v5
    v_cvt_pk_bf16_f32 v105, v64, v65
    v_smfmac_f32_16x16x64_bf16 v[72:75], v[40:43], a[216:223], v5
    v_add_f32 v68, v68, v70
    v_add_f32 v69, v69, v71
    v_cvt_pk_bf16_f32 v108, v68, v69
    s_nop 4
    v_add_f32 v72, v72, v74
    v_add_f32 v73, v73, v75
    v_cvt_pk_bf16_f32 v109, v72, v73
    s_waitcnt vmcnt(3)
    ds_read_b128 v[44:47], v1 offset:28672
    ds_read_b128 v[48:51], v1 offset:29696
    ds_read_b128 v[52:55], v1 offset:30720
    ds_read_b128 v[56:59], v1 offset:31744
    s_cbranch_scc0 ch3bf_hu
ch3bf_hv:
    s_cmp_ge_u32 s64, s100
    v_fma_mix_f32 v102, v76, 1.0, v84 op_sel:[0,0,0] op_sel_hi:[1,0,1]
    v_fma_mix_f32 v84, v76, 1.0, v84 op_sel:[1,0,1] op_sel_hi:[1,0,1]
    v_fma_mix_f32 v76, v77, 1.0, v85 op_sel:[0,0,0] op_sel_hi:[1,0,1]
    v_fma_mix_f32 v85, v77, 1.0, v85 op_sel:[1,0,1] op_sel_hi:[1,0,1]
    v_fma_mix_f32 v77, v78, 1.0, v86 op_sel:[0,0,0] op_sel_hi:[1,0,1]
    v_fma_mix_f32 v86, v78, 1.0, v86 op_sel:[1,0,1] op_sel_hi:[1,0,1]
    v_fma_mix_f32 v78, v79, 1.0, v87 op_sel:[0,0,0] op_sel_hi:[1,0,1]
    v_fma_mix_f32 v87, v79, 1.0, v87 op_sel:[1,0,1] op_sel_hi:[1,0,1]
    v_maximum3_f32 v112, v84, v85, v86
    v_cmp_u_f32 vcc, v112, v87
    v_exp_f32 v76, v76
    v_exp_f32 v77, v77
    v_exp_f32 v78, v78
    s_cbranch_vccnz ch3bf_i0
    v_exp_f32 v79, v102
    v_exp_f32 v84, v84
    v_exp_f32 v85, v85
    v_pk_add_f32 v[96:97], v[76:77], v[78:79]
    v_exp_f32 v86, v86
    v_exp_f32 v87, v87
    v_pk_add_f32 v[96:97], v[96:97], v[84:85]
    v_pk_add_f32 v[96:97], v[96:97], v[86:87]
    s_waitcnt vmcnt(1)
    v_fma_mix_f32 v103, v80, 1.0, v88 op_sel:[0,0,0] op_sel_hi:[1,0,1]
    v_fma_mix_f32 v88, v80, 1.0, v88 op_sel:[1,0,1] op_sel_hi:[1,0,1]
    v_fma_mix_f32 v80, v81, 1.0, v89 op_sel:[0,0,0] op_sel_hi:[1,0,1]
    v_fma_mix_f32 v89, v81, 1.0, v89 op_sel:[1,0,1] op_sel_hi:[1,0,1]
    v_fma_mix_f32 v81, v82, 1.0, v90 op_sel:[0,0,0] op_sel_hi:[1,0,1]
    v_fma_mix_f32 v90, v82, 1.0, v90 op_sel:[1,0,1] op_sel_hi:[1,0,1]
    v_fma_mix_f32 v82, v83, 1.0, v91 op_sel:[0,0,0] op_sel_hi:[1,0,1]
    v_fma_mix_f32 v91, v83, 1.0, v91 op_sel:[1,0,1] op_sel_hi:[1,0,1]
    v_maximum3_f32 v114, v88, v89, v90
    v_cmp_u_f32 vcc, v114, v91
    v_exp_f32 v80, v80
    v_exp_f32 v81, v81
    v_exp_f32 v82, v82
    s_cbranch_vccnz ch3bf_i1
    v_exp_f32 v83, v103
    v_exp_f32 v88, v88
    v_exp_f32 v89, v89
    v_pk_add_f32 v[98:99], v[80:81], v[82:83]
    v_exp_f32 v90, v90
    v_exp_f32 v91, v91
    v_pk_add_f32 v[98:99], v[98:99], v[88:89]
    v_pk_add_f32 v[98:99], v[98:99], v[90:91]
    s_cbranch_scc1 ch3bf_nw
ch3bf_nw2:
    s_mov_b32 m0, 28672
    s_mov_b32 s98, 1
    s_waitcnt vmcnt(0) lgkmcnt(0)
    buffer_load_dwordx4 v1, s[44:47], s71 offen offset:0 sc1 lds
    buffer_load_dwordx4 v1, s[44:47], s71 offen offset:1024 sc1 lds
    v_fma_mix_f32 v113, v92, 1.0, v94 op_sel:[0,0,0] op_sel_hi:[1,0,1]
    v_fma_mix_f32 v94, v92, 1.0, v94 op_sel:[1,0,1] op_sel_hi:[1,0,1]
    v_fma_mix_f32 v92, v93, 1.0, v95 op_sel:[0,0,0] op_sel_hi:[1,0,1]
    v_fma_mix_f32 v95, v93, 1.0, v95 op_sel:[1,0,1] op_sel_hi:[1,0,1]
    v_cmp_u_f32 vcc, v94, v95
    v_exp_f32 v92, v92
    v_exp_f32 v93, v113
    v_exp_f32 v94, v94
    s_cbranch_vccnz ch3bf_i2
    v_exp_f32 v95, v95
    s_nop 0
    v_pk_add_f32 v[100:101], v[92:93], v[94:95]
ch3bf_w2d:
    v_pk_add_f32 v[96:97], v[96:97], v[98:99]
    v_pk_add_f32 v[96:97], v[96:97], v[100:101]
    v_add_f32 v2, v96, v97
    v_add_f32 v15, v96, v97
    s_nop 1
    v_permlane16_swap_b32 v2, v15
    v_add_f32 v2, v2, v15
    v_subrev_u32 v15, 0x17800000, v2
    v_rcp_f32 v2, v2
    v_cmp_le_u32 vcc, 0x5a000000, v15
    s_waitcnt lgkmcnt(0)
    v_pk_mul_f32 v[92:93], v[92:93], v[2:3] op_sel_hi:[1,0]
    v_pk_mul_f32 v[94:95], v[94:95], v[2:3] op_sel_hi:[1,0]
    v_cvt_pk_bf16_f32 v116, v93, v94
    v_cvt_pk_bf16_f32 v118, v92, v95
    s_cbranch_vccnz ch3bf_fb
    v_pk_mul_f32 v[76:77], v[76:77], v[2:3] op_sel_hi:[1,0]
    v_pk_mul_f32 v[78:79], v[78:79], v[2:3] op_sel_hi:[1,0]
    v_pk_mul_f32 v[84:85], v[84:85], v[2:3] op_sel_hi:[1,0]
    v_pk_mul_f32 v[86:87], v[86:87], v[2:3] op_sel_hi:[1,0]
    v_cvt_pk_bf16_f32 v96, v79, v84
    v_cvt_pk_bf16_f32 v97, v76, v85
    v_cvt_pk_bf16_f32 v98, v77, v86
    v_cvt_pk_bf16_f32 v99, v78, v87
    v_pk_mul_f32 v[80:81], v[80:81], v[2:3] op_sel_hi:[1,0]
    v_pk_mul_f32 v[82:83], v[82:83], v[2:3] op_sel_hi:[1,0]
    v_pk_mul_f32 v[88:89], v[88:89], v[2:3] op_sel_hi:[1,0]
    v_pk_mul_f32 v[90:91], v[90:91], v[2:3] op_sel_hi:[1,0]
    v_smfmac_f32_16x16x64_bf16 v[60:63], v[116:119], v[104:111], v5
    v_cvt_pk_bf16_f32 v100, v83, v88
    v_cvt_pk_bf16_f32 v101, v80, v89
    v_smfmac_f32_16x16x64_bf16 v[60:63], v[96:99], v[44:51], v5
    v_cvt_pk_bf16_f32 v102, v81, v90
    v_cvt_pk_bf16_f32 v103, v82, v91
    s_nop 1
    v_smfmac_f32_16x16x64_bf16 v[60:63], v[100:103], v[52:59], v5
ch3bf_kj:
    v_mov_b32 v44, 0
    v_mov_b32 v45, 0
    v_mov_b32 v46, 0
    v_mov_b32 v47, 0
    s_nop 3
    v_add_f32 v60, v60, v62
    v_add_f32 v61, v61, v63
    ds_write2_b32 v11, v60, v61 offset0:0 offset1:16
    v_mov_b32 v48, 0
    v_mov_b32 v49, 0
    v_mov_b32 v50, 0
    v_mov_b32 v51, 0
    v_mov_b32 v52, 0
    v_mov_b32 v53, 0
    v_mov_b32 v54, 0
    v_mov_b32 v55, 0
    v_mov_b32 v112, 0
    v_mov_b32 v113, 0
    v_mov_b32 v114, 0
    v_mov_b32 v115, 0
    s_waitcnt lgkmcnt(0)
    s_barrier
    s_barrier
    s_add_u32 s64, s64, 1
    s_cmp_lt_u32 s64, 63
    s_cbranch_scc1 ch3bf_loop
    s_and_b32 s8, s64, 3
    s_lshl_b32 s65, s8, 13
    s_add_u32 s65, s65, 94902272
    v_mov_b32 v60, 0
    v_mov_b32 v61, 0
    v_mov_b32 v62, 0
    v_mov_b32 v63, 0
    v_mov_b32 v64, 0
    v_mov_b32 v65, 0
    v_mov_b32 v66, 0
    v_mov_b32 v67, 0
    v_mov_b32 v68, 0
    v_mov_b32 v69, 0
    v_mov_b32 v70, 0
    v_mov_b32 v71, 0
    v_mov_b32 v72, 0
    v_mov_b32 v73, 0
    v_mov_b32 v74, 0
    v_mov_b32 v75, 0
    buffer_load_dwordx4 v[76:79], v1, s[44:47], s65 offen offset:0 sc1
    s_mov_b32 s83, 0
ch3bft_mp:
    buffer_load_dwordx4 v[40:43], v1, s[44:47], s65 offen offset:0 sc1
    s_waitcnt vmcnt(1)
    v_max3_u32 v2, v76, v77, v78
    v_max_u32 v2, v2, v79
    v_cmp_eq_u32 vcc, -1, v2
    s_cbranch_vccz ch3bft_g1
    buffer_load_dwordx4 v[76:79], v1, s[44:47], s65 offen offset:0 sc1
    s_add_u32 s83, s83, 1
    s_cmp_ge_u32 s83, 2000000
    s_cbranch_scc1 chain_abort
    s_waitcnt vmcnt(1)
    v_max3_u32 v2, v40, v41, v42
    v_max_u32 v2, v2, v43
    v_cmp_eq_u32 vcc, -1, v2
    s_cbranch_vccnz ch3bft_mp
ch3bft_g1:
    s_waitcnt vmcnt(0)
    ds_write_b128 v1, v[40:43] offset:6144
    s_waitcnt lgkmcnt(0)
    s_barrier
    ds_read_b128 v[16:19], v1 offset:0
    ds_read_b128 v[20:23], v1 offset:1024
    ds_read_b128 v[24:27], v1 offset:2048
    ds_read_b128 v[28:31], v1 offset:3072
    ds_read_b128 v[32:35], v1 offset:4096
    ds_read_b128 v[36:39], v1 offset:5120
    s_waitcnt lgkmcnt(0)
    v_smfmac_f32_16x16x64_bf16 v[60:63], v[16:19], a[224:231], v5
    v_smfmac_f32_16x16x64_bf16 v[60:63], v[20:23], a[232:239], v5
    v_smfmac_f32_16x16x64_bf16 v[60:63], v[24:27], a[240:247], v5
    v_smfmac_f32_16x16x64_bf16 v[60:63], v[28:31], a[248:255], v5
    v_smfmac_f32_16x16x64_bf16 v[60:63], v[32:35], v[120:127], v5
    v_smfmac_f32_16x16x64_bf16 v[60:63], v[36:39], v[128:135], v5
    v_smfmac_f32_16x16x64_bf16 v[60:63], v[40:43], v[136:143], v5
    v_smfmac_f32_16x16x64_bf16 v[64:67], v[16:19], v[144:151], v5
    v_smfmac_f32_16x16x64_bf16 v[64:67], v[20:23], v[152:159], v5
    v_smfmac_f32_16x16x64_bf16 v[64:67], v[24:27], v[160:167], v5
    v_smfmac_f32_16x16x64_bf16 v[64:67], v[28:31], v[168:175], v5
    v_smfmac_f32_16x16x64_bf16 v[64:67], v[32:35], v[176:183], v5
    s_nop 2
    v_add_f32 v60, v60, v62
    v_smfmac_f32_16x16x64_bf16 v[64:67], v[36:39], v[184:191], v5
    v_add_f32 v61, v61, v63
    v_smfmac_f32_16x16x64_bf16 v[64:67], v[40:43], v[192:199], v5
    v_cvt_pk_bf16_f32 v104, v60, v61
    v_smfmac_f32_16x16x64_bf16 v[68:71], v[16:19], v[200:207], v5
    v_mov_b32 v60, 0
    v_smfmac_f32_16x16x64_bf16 v[68:71], v[20:23], v[208:215], v5
    v_mov_b32 v61, 0
    v_smfmac_f32_16x16x64_bf16 v[68:71], v[24:27], v[216:223], v5
    v_mov_b32 v62, 0
    v_smfmac_f32_16x16x64_bf16 v[68:71], v[28:31], v[224:231], v5
    v_mov_b32 v63, 0
    v_smfmac_f32_16x16x64_bf16 v[68:71], v[32:35], v[232:239], v5
    v_add_f32 v64, v64, v66
    v_smfmac_f32_16x16x64_bf16 v[68:71], v[36:39], v[240:247], v5
    v_add_f32 v65, v65, v67
    v_smfmac_f32_16x16x64_bf16 v[68:71], v[40:43], v[248:255], v5
    v_cvt_pk_bf16_f32 v105, v64, v65
    v_smfmac_f32_16x16x64_bf16 v[72:75], v[16:19], a[168:175], v5
    v_smfmac_f32_16x16x64_bf16 v[72:75], v[20:23], a[176:183], v5
    v_smfmac_f32_16x16x64_bf16 v[72:75], v[24:27], a[184:191], v5
    v_smfmac_f32_16x16x64_bf16 v[72:75], v[28:31], a[192:199], v5
    v_smfmac_f32_16x16x64_bf16 v[72:75], v[32:35], a[200:207], v5
    s_nop 1
    v_add_f32 v68, v68, v70
    v_smfmac_f32_16x16x64_bf16 v[72:75], v[36:39], a[208:215], v5
    v_add_f32 v69, v69, v71
    v_smfmac_f32_16x16x64_bf16 v[72:75], v[40:43], a[216:223], v5
    v_cvt_pk_bf16_f32 v108, v68, v69
    s_nop 6
    v_add_f32 v72, v72, v74
    v_add_f32 v73, v73, v75
    v_cvt_pk_bf16_f32 v109, v72, v73
    v_mov_b32 v106, v108
    v_mov_b32 v107, v109
    s_lshl_b32 s8, s82, 12
    s_add_u32 s8, s8, 91638784
    buffer_store_dwordx4 v[104:107], v1, s[44:47], s8 offen sc1
    s_waitcnt vmcnt(0)
    s_barrier
    s_endpgm
ch3bf_hl:
    buffer_load_dword v15, off, s[44:47], s73 sc1
    s_branch ch3bf_hs
ch3bf_hu:
    v_readfirstlane_b32 s9, v15
    s_max_u32 s100, s100, s9
    s_branch ch3bf_hv
ch3bf_nw:
    v_lshlrev_b32 v100, 7, v0
    s_mov_b32 s99, 0
hz_176:
    buffer_load_dword v101, v100, s[44:47], s75 offen sc1
    s_waitcnt vmcnt(0)
    v_cmp_gt_u32 vcc, 28, v101
    s_ff1_i32_b64 s100, vcc
    s_cmp_eq_u32 s100, -1
    s_cselect_b32 s100, 65, s100
    s_sub_u32 s100, s100, 1
    s_cmp_gt_i32 s100, s64
    s_cbranch_scc1 hd_177
    s_sleep 1
    s_add_u32 s99, s99, 1
    s_cmp_lt_u32 s99, 400000
    s_cbranch_scc1 hz_176
    s_branch chain_abort
hd_177:
    s_branch ch3bf_nw2
ch3bf_k0:
    s_cmp_eq_u32 s98, 1
    s_cbranch_scc1 ch3bf_w2d
    s_cmp_ge_u32 s64, s100
    s_cbranch_scc1 ch3bf_vw
ch3bf_vok:
    s_mov_b32 m0, 28672
    s_waitcnt lgkmcnt(0)
    buffer_load_dwordx4 v1, s[44:47], s71 offen offset:0 sc1 lds
    buffer_load_dwordx4 v1, s[44:47], s71 offen offset:1024 sc1 lds
    s_branch ch3bf_w2d
ch3bf_i0:
    buffer_load_dwordx4 v[76:79], v1, s[44:47], s67 offen offset:0 sc1
    buffer_load_dwordx4 v[84:87], v1, s[44:47], s67 offen offset:2048 sc1
    s_add_u32 s83, s83, 1
    s_branch ch3bf_q120
ch3bf_i1:
    buffer_load_dwordx4 v[80:83], v1, s[44:47], s67 offen offset:1024 sc1
    buffer_load_dwordx4 v[88:91], v1, s[44:47], s67 offen offset:3072 sc1
    s_add_u32 s83, s83, 1
    s_branch ch3bf_q21
ch3bf_i2:
    buffer_load_dwordx4 v[92:95], v10, s[44:47], s67 offen offset:0 sc1
    s_add_u32 s83, s83, 1
    s_branch ch3bf_q2
ch3bf_q0:
    s_waitcnt vmcnt(0)
    v_fma_mix_f32 v102, v76, 1.0, v84 op_sel:[0,0,0] op_sel_hi:[1,0,1]
    v_fma_mix_f32 v84, v76, 1.0, v84 op_sel:[1,0,1] op_sel_hi:[1,0,1]
    v_fma_mix_f32 v76, v77, 1.0, v85 op_sel:[0,0,0] op_sel_hi:[1,0,1]
    v_fma_mix_f32 v85, v77, 1.0, v85 op_sel:[1,0,1] op_sel_hi:[1,0,1]
    v_fma_mix_f32 v77, v78, 1.0, v86 op_sel:[0,0,0] op_sel_hi:[1,0,1]
    v_fma_mix_f32 v86, v78, 1.0, v86 op_sel:[1,0,1] op_sel_hi:[1,0,1]
    v_fma_mix_f32 v78, v79, 1.0, v87 op_sel:[0,0,0] op_sel_hi:[1,0,1]
    v_fma_mix_f32 v87, v79, 1.0, v87 op_sel:[1,0,1] op_sel_hi:[1,0,1]
    v_maximum3_f32 v112, v84, v85, v86
    v_cmp_u_f32 vcc, v112, v87
    v_exp_f32 v76, v76
    v_exp_f32 v77, v77
    v_exp_f32 v78, v78
    s_cbranch_vccnz ch3bf_q0_e
    v_exp_f32 v79, v102
    v_exp_f32 v84, v84
    v_exp_f32 v85, v85
    v_pk_add_f32 v[96:97], v[76:77], v[78:79]
    v_exp_f32 v86, v86
    v_exp_f32 v87, v87
    v_pk_add_f32 v[96:97], v[96:97], v[84:85]
    v_pk_add_f32 v[96:97], v[96:97], v[86:87]
    s_branch ch3bf_k0
ch3bf_q0_e:
    buffer_load_dwordx4 v[76:79], v1, s[44:47], s67 offen offset:0 sc1
    buffer_load_dwordx4 v[84:87], v1, s[44:47], s67 offen offset:2048 sc1
    s_add_u32 s83, s83, 1
    s_and_b32 s8, s83, 63
    s_cmp_eq_u32 s8, 0
    s_cbranch_scc1 ch3bf_x
    s_branch ch3bf_q0
ch3bf_q1:
    s_waitcnt vmcnt(0)
    v_fma_mix_f32 v103, v80, 1.0, v88 op_sel:[0,0,0] op_sel_hi:[1,0,1]
    v_fma_mix_f32 v88, v80, 1.0, v88 op_sel:[1,0,1] op_sel_hi:[1,0,1]
    v_fma_mix_f32 v80, v81, 1.0, v89 op_sel:[0,0,0] op_sel_hi:[1,0,1]
    v_fma_mix_f32 v89, v81, 1.0, v89 op_sel:[1,0,1] op_sel_hi:[1,0,1]
    v_fma_mix_f32 v81, v82, 1.0, v90 op_sel:[0,0,0] op_sel_hi:[1,0,1]
    v_fma_mix_f32 v90, v82, 1.0, v90 op_sel:[1,0,1] op_sel_hi:[1,0,1]
    v_fma_mix_f32 v82, v83, 1.0, v91 op_sel:[0,0,0] op_sel_hi:[1,0,1]
    v_fma_mix_f32 v91, v83, 1.0, v91 op_sel:[1,0,1] op_sel_hi:[1,0,1]
    v_maximum3_f32 v114, v88, v89, v90
    v_cmp_u_f32 vcc, v114, v91
    v_exp_f32 v80, v80
    v_exp_f32 v81, v81
    v_exp_f32 v82, v82
    s_cbranch_vccnz ch3bf_q1_e
    v_exp_f32 v83, v103
    v_exp_f32 v88, v88
    v_exp_f32 v89, v89
    v_pk_add_f32 v[98:99], v[80:81], v[82:83]
    v_exp_f32 v90, v90
    v_exp_f32 v91, v91
    v_pk_add_f32 v[98:99], v[98:99], v[88:89]
    v_pk_add_f32 v[98:99], v[98:99], v[90:91]
    s_branch ch3bf_k0
ch3bf_q1_e:
    buffer_load_dwordx4 v[80:83], v1, s[44:47], s67 offen offset:1024 sc1
    buffer_load_dwordx4 v[88:91], v1, s[44:47], s67 offen offset:3072 sc1
    s_add_u32 s83, s83, 1
    s_and_b32 s8, s83, 63
    s_cmp_eq_u32 s8, 0
    s_cbranch_scc1 ch3bf_x
    s_branch ch3bf_q1
ch3bf_q2:
    s_waitcnt vmcnt(0)
    v_fma_mix_f32 v113, v92, 1.0, v94 op_sel:[0,0,0] op_sel_hi:[1,0,1]
    v_fma_mix_f32 v94, v92, 1.0, v94 op_sel:[1,0,1] op_sel_hi:[1,0,1]
    v_fma_mix_f32 v92, v93, 1.0, v95 op_sel:[0,0,0] op_sel_hi:[1,0,1]
    v_fma_mix_f32 v95, v93, 1.0, v95 op_sel:[1,0,1] op_sel_hi:[1,0,1]
    v_cmp_u_f32 vcc, v94, v95
    v_exp_f32 v92, v92
    v_exp_f32 v93, v113
    v_exp_f32 v94, v94
    s_cbranch_vccnz ch3bf_q2_e
    v_exp_f32 v95, v95
    s_nop 0
    v_pk_add_f32 v[100:101], v[92:93], v[94:95]
    s_branch ch3bf_k0
ch3bf_q2_e:
    buffer_load_dwordx4 v[92:95], v10, s[44:47], s67 offen offset:0 sc1
    s_add_u32 s83, s83, 1
    s_and_b32 s8, s83, 63
    s_cmp_eq_u32 s8, 0
    s_cbranch_scc1 ch3bf_x
    s_branch ch3bf_q2
ch3bf_q01:
    s_waitcnt vmcnt(2)
    v_fma_mix_f32 v102, v76, 1.0, v84 op_sel:[0,0,0] op_sel_hi:[1,0,1]
    v_fma_mix_f32 v84, v76, 1.0, v84 op_sel:[1,0,1] op_sel_hi:[1,0,1]
    v_fma_mix_f32 v76, v77, 1.0, v85 op_sel:[0,0,0] op_sel_hi:[1,0,1]
    v_fma_mix_f32 v85, v77, 1.0, v85 op_sel:[1,0,1] op_sel_hi:[1,0,1]
    v_fma_mix_f32 v77, v78, 1.0, v86 op_sel:[0,0,0] op_sel_hi:[1,0,1]
    v_fma_mix_f32 v86, v78, 1.0, v86 op_sel:[1,0,1] op_sel_hi:[1,0,1]
    v_fma_mix_f32 v78, v79, 1.0, v87 op_sel:[0,0,0] op_sel_hi:[1,0,1]
    v_fma_mix_f32 v87, v79, 1.0, v87 op_sel:[1,0,1] op_sel_hi:[1,0,1]
    v_maximum3_f32 v112, v84, v85, v86
    v_cmp_u_f32 vcc, v112, v87
    v_exp_f32 v76, v76
    v_exp_f32 v77, v77
    v_exp_f32 v78, v78
    s_cbranch_vccnz ch3bf_q01_e
    v_exp_f32 v79, v102
    v_exp_f32 v84, v84
    v_exp_f32 v85, v85
    v_pk_add_f32 v[96:97], v[76:77], v[78:79]
    v_exp_f32 v86, v86
    v_exp_f32 v87, v87
    v_pk_add_f32 v[96:97], v[96:97], v[84:85]
    v_pk_add_f32 v[96:97], v[96:97], v[86:87]
    s_branch ch3bf_q1
ch3bf_q01_e:
    buffer_load_dwordx4 v[76:79], v1, s[44:47], s67 offen offset:0 sc1
    buffer_load_dwordx4 v[84:87], v1, s[44:47], s67 offen offset:2048 sc1
    s_add_u32 s83, s83, 1
    s_and_b32 s8, s83, 63
    s_cmp_eq_u32 s8, 0
    s_cbranch_scc1 ch3bf_x
    s_branch ch3bf_q10
ch3bf_q02:
    s_waitcnt vmcnt(1)
    v_fma_mix_f32 v102, v76, 1.0, v84 op_sel:[0,0,0] op_sel_hi:[1,0,1]
    v_fma_mix_f32 v84, v76, 1.0, v84 op_sel:[1,0,1] op_sel_hi:[1,0,1]
    v_fma_mix_f32 v76, v77, 1.0, v85 op_sel:[0,0,0] op_sel_hi:[1,0,1]
    v_fma_mix_f32 v85, v77, 1.0, v85 op_sel:[1,0,1] op_sel_hi:[1,0,1]
    v_fma_mix_f32 v77, v78, 1.0, v86 op_sel:[0,0,0] op_sel_hi:[1,0,1]
    v_fma_mix_f32 v86, v78, 1.0, v86 op_sel:[1,0,1] op_sel_hi:[1,0,1]
    v_fma_mix_f32 v78, v79, 1.0, v87 op_sel:[0,0,0] op_sel_hi:[1,0,1]
    v_fma_mix_f32 v87, v79, 1.0, v87 op_sel:[1,0,1] op_sel_hi:[1,0,1]
    v_maximum3_f32 v112, v84, v85, v86
    v_cmp_u_f32 vcc, v112, v87
    v_exp_f32 v76, v76
    v_exp_f32 v77, v77
    v_exp_f32 v78, v78
    s_cbranch_vccnz ch3bf_q02_e
    v_exp_f32 v79, v102
    v_exp_f32 v84, v84
    v_exp_f32 v85, v85
    v_pk_add_f32 v[96:97], v[76:77], v[78:79]
    v_exp_f32 v86, v86
    v_exp_f32 v87, v87
    v_pk_add_f32 v[96:97], v[96:97], v[84:85]
    v_pk_add_f32 v[96:97], v[96:97], v[86:87]
    s_branch ch3bf_q2
ch3bf_q02_e:
    buffer_load_dwordx4 v[76:79], v1, s[44:47], s67 offen offset:0 sc1
    buffer_load_dwordx4 v[84:87], v1, s[44:47], s67 offen offset:2048 sc1
    s_add_u32 s83, s83, 1
    s_and_b32 s8, s83, 63
    s_cmp_eq_u32 s8, 0
    s_cbranch_scc1 ch3bf_x
    s_branch ch3bf_q20
ch3bf_q10:
    s_waitcnt vmcnt(2)
    v_fma_mix_f32 v103, v80, 1.0, v88 op_sel:[0,0,0] op_sel_hi:[1,0,1]
    v_fma_mix_f32 v88, v80, 1.0, v88 op_sel:[1,0,1] op_sel_hi:[1,0,1]
    v_fma_mix_f32 v80, v81, 1.0, v89 op_sel:[0,0,0] op_sel_hi:[1,0,1]
    v_fma_mix_f32 v89, v81, 1.0, v89 op_sel:[1,0,1] op_sel_hi:[1,0,1]
    v_fma_mix_f32 v81, v82, 1.0, v90 op_sel:[0,0,0] op_sel_hi:[1,0,1]
    v_fma_mix_f32 v90, v82, 1.0, v90 op_sel:[1,0,1] op_sel_hi:[1,0,1]
    v_fma_mix_f32 v82, v83, 1.0, v91 op_sel:[0,0,0] op_sel_hi:[1,0,1]
    v_fma_mix_f32 v91, v83, 1.0, v91 op_sel:[1,0,1] op_sel_hi:[1,0,1]
    v_maximum3_f32 v114, v88, v89, v90
    v_cmp_u_f32 vcc, v114, v91
    v_exp_f32 v80, v80
    v_exp_f32 v81, v81
    v_exp_f32 v82, v82
    s_cbranch_vccnz ch3bf_q10_e
    v_exp_f32 v83, v103
    v_exp_f32 v88, v88
    v_exp_f32 v89, v89
    v_pk_add_f32 v[98:99], v[80:81], v[82:83]
    v_exp_f32 v90, v90
    v_exp_f32 v91, v91
    v_pk_add_f32 v[98:99], v[98:99], v[88:89]
    v_pk_add_f32 v[98:99], v[98:99], v[90:91]
    s_branch ch3bf_q0
ch3bf_q10_e:
    buffer_load_dwordx4 v[80:83], v1, s[44:47], s67 offen offset:1024 sc1
    buffer_load_dwordx4 v[88:91], v1, s[44:47], s67 offen offset:3072 sc1
    s_add_u32 s83, s83, 1
    s_and_b32 s8, s83, 63
    s_cmp_eq_u32 s8, 0
    s_cbranch_scc1 ch3bf_x
    s_branch ch3bf_q01
ch3bf_q12:
    s_waitcnt vmcnt(1)
    v_fma_mix_f32 v103, v80, 1.0, v88 op_sel:[0,0,0] op_sel_hi:[1,0,1]
    v_fma_mix_f32 v88, v80, 1.0, v88 op_sel:[1,0,1] op_sel_hi:[1,0,1]
    v_fma_mix_f32 v80, v81, 1.0, v89 op_sel:[0,0,0] op_sel_hi:[1,0,1]
    v_fma_mix_f32 v89, v81, 1.0, v89 op_sel:[1,0,1] op_sel_hi:[1,0,1]
    v_fma_mix_f32 v81, v82, 1.0, v90 op_sel:[0,0,0] op_sel_hi:[1,0,1]
    v_fma_mix_f32 v90, v82, 1.0, v90 op_sel:[1,0,1] op_sel_hi:[1,0,1]
    v_fma_mix_f32 v82, v83, 1.0, v91 op_sel:[0,0,0] op_sel_hi:[1,0,1]
    v_fma_mix_f32 v91, v83, 1.0, v91 op_sel:[1,0,1] op_sel_hi:[1,0,1]
    v_maximum3_f32 v114, v88, v89, v90
    v_cmp_u_f32 vcc, v114, v91
    v_exp_f32 v80, v80
    v_exp_f32 v81, v81
    v_exp_f32 v82, v82
    s_cbranch_vccnz ch3bf_q12_e
    v_exp_f32 v83, v103
    v_exp_f32 v88, v88
    v_exp_f32 v89, v89
    v_pk_add_f32 v[98:99], v[80:81], v[82:83]
    v_exp_f32 v90, v90
    v_exp_f32 v91, v91
    v_pk_add_f32 v[98:99], v[98:99], v[88:89]
    v_pk_add_f32 v[98:99], v[98:99], v[90:91]
    s_branch ch3bf_q2
ch3bf_q12_e:
    buffer_load_dwordx4 v[80:83], v1, s[44:47], s67 offen offset:1024 sc1
    buffer_load_dwordx4 v[88:91], v1, s[44:47], s67 offen offset:3072 sc1
    s_add_u32 s83, s83, 1
    s_and_b32 s8, s83, 63
    s_cmp_eq_u32 s8, 0
    s_cbranch_scc1 ch3bf_x
    s_branch ch3bf_q21
ch3bf_q20:
    s_waitcnt vmcnt(2)
    v_fma_mix_f32 v113, v92, 1.0, v94 op_sel:[0,0,0] op_sel_hi:[1,0,1]
    v_fma_mix_f32 v94, v92, 1.0, v94 op_sel:[1,0,1] op_sel_hi:[1,0,1]
    v_fma_mix_f32 v92, v93, 1.0, v95 op_sel:[0,0,0] op_sel_hi:[1,0,1]
    v_fma_mix_f32 v95, v93, 1.0, v95 op_sel:[1,0,1] op_sel_hi:[1,0,1]
    v_cmp_u_f32 vcc, v94, v95
    v_exp_f32 v92, v92
    v_exp_f32 v93, v113
    v_exp_f32 v94, v94
    s_cbranch_vccnz ch3bf_q20_e
    v_exp_f32 v95, v95
    s_nop 0
    v_pk_add_f32 v[100:101], v[92:93], v[94:95]
    s_branch ch3bf_q0
ch3bf_q20_e:
    buffer_load_dwordx4 v[92:95], v10, s[44:47], s67 offen offset:0 sc1
    s_add_u32 s83, s83, 1
    s_and_b32 s8, s83, 63
    s_cmp_eq_u32 s8, 0
    s_cbranch_scc1 ch3bf_x
    s_branch ch3bf_q02
ch3bf_q21:
    s_waitcnt vmcnt(2)
    v_fma_mix_f32 v113, v92, 1.0, v94 op_sel:[0,0,0] op_sel_hi:[1,0,1]
    v_fma_mix_f32 v94, v92, 1.0, v94 op_sel:[1,0,1] op_sel_hi:[1,0,1]
    v_fma_mix_f32 v92, v93, 1.0, v95 op_sel:[0,0,0] op_sel_hi:[1,0,1]
    v_fma_mix_f32 v95, v93, 1.0, v95 op_sel:[1,0,1] op_sel_hi:[1,0,1]
    v_cmp_u_f32 vcc, v94, v95
    v_exp_f32 v92, v92
    v_exp_f32 v93, v113
    v_exp_f32 v94, v94
    s_cbranch_vccnz ch3bf_q21_e
    v_exp_f32 v95, v95
    s_nop 0
    v_pk_add_f32 v[100:101], v[92:93], v[94:95]
    s_branch ch3bf_q1
ch3bf_q21_e:
    buffer_load_dwordx4 v[92:95], v10, s[44:47], s67 offen offset:0 sc1
    s_add_u32 s83, s83, 1
    s_and_b32 s8, s83, 63
    s_cmp_eq_u32 s8, 0
    s_cbranch_scc1 ch3bf_x
    s_branch ch3bf_q12
ch3bf_q012:
    s_waitcnt vmcnt(3)
    v_fma_mix_f32 v102, v76, 1.0, v84 op_sel:[0,0,0] op_sel_hi:[1,0,1]
    v_fma_mix_f32 v84, v76, 1.0, v84 op_sel:[1,0,1] op_sel_hi:[1,0,1]
    v_fma_mix_f32 v76, v77, 1.0, v85 op_sel:[0,0,0] op_sel_hi:[1,0,1]
    v_fma_mix_f32 v85, v77, 1.0, v85 op_sel:[1,0,1] op_sel_hi:[1,0,1]
    v_fma_mix_f32 v77, v78, 1.0, v86 op_sel:[0,0,0] op_sel_hi:[1,0,1]
    v_fma_mix_f32 v86, v78, 1.0, v86 op_sel:[1,0,1] op_sel_hi:[1,0,1]
    v_fma_mix_f32 v78, v79, 1.0, v87 op_sel:[0,0,0] op_sel_hi:[1,0,1]
    v_fma_mix_f32 v87, v79, 1.0, v87 op_sel:[1,0,1] op_sel_hi:[1,0,1]
    v_maximum3_f32 v112, v84, v85, v86
    v_cmp_u_f32 vcc, v112, v87
    v_exp_f32 v76, v76
    v_exp_f32 v77, v77
    v_exp_f32 v78, v78
    s_cbranch_vccnz ch3bf_q012_e
    v_exp_f32 v79, v102
    v_exp_f32 v84, v84
    v_exp_f32 v85, v85
    v_pk_add_f32 v[96:97], v[76:77], v[78:79]
    v_exp_f32 v86, v86
    v_exp_f32 v87, v87
    v_pk_add_f32 v[96:97], v[96:97], v[84:85]
    v_pk_add_f32 v[96:97], v[96:97], v[86:87]
    s_branch ch3bf_q12
ch3bf_q012_e:
    buffer_load_dwordx4 v[76:79], v1, s[44:47], s67 offen offset:0 sc1
    buffer_load_dwordx4 v[84:87], v1, s[44:47], s67 offen offset:2048 sc1
    s_add_u32 s83, s83, 1
    s_and_b32 s8, s83, 63
    s_cmp_eq_u32 s8, 0
    s_cbranch_scc1 ch3bf_x
    s_branch ch3bf_q120
ch3bf_q021:
    s_waitcnt vmcnt(3)
    v_fma_mix_f32 v102, v76, 1.0, v84 op_sel:[0,0,0] op_sel_hi:[1,0,1]
    v_fma_mix_f32 v84, v76, 1.0, v84 op_sel:[1,0,1] op_sel_hi:[1,0,1]
    v_fma_mix_f32 v76, v77, 1.0, v85 op_sel:[0,0,0] op_sel_hi:[1,0,1]
    v_fma_mix_f32 v85, v77, 1.0, v85 op_sel:[1,0,1] op_sel_hi:[1,0,1]
    v_fma_mix_f32 v77, v78, 1.0, v86 op_sel:[0,0,0] op_sel_hi:[1,0,1]
    v_fma_mix_f32 v86, v78, 1.0, v86 op_sel:[1,0,1] op_sel_hi:[1,0,1]
    v_fma_mix_f32 v78, v79, 1.0, v87 op_sel:[0,0,0] op_sel_hi:[1,0,1]
    v_fma_mix_f32 v87, v79, 1.0, v87 op_sel:[1,0,1] op_sel_hi:[1,0,1]
    v_maximum3_f32 v112, v84, v85, v86
    v_cmp_u_f32 vcc, v112, v87
    v_exp_f32 v76, v76
    v_exp_f32 v77, v77
    v_exp_f32 v78, v78
    s_cbranch_vccnz ch3bf_q021_e
    v_exp_f32 v79, v102
    v_exp_f32 v84, v84
    v_exp_f32 v85, v85
    v_pk_add_f32 v[96:97], v[76:77], v[78:79]
    v_exp_f32 v86, v86
    v_exp_f32 v87, v87
    v_pk_add_f32 v[96:97], v[96:97], v[84:85]
    v_pk_add_f32 v[96:97], v[96:97], v[86:87]
    s_branch ch3bf_q21
ch3bf_q021_e:
    buffer_load_dwordx4 v[76:79], v1, s[44:47], s67 offen offset:0 sc1
    buffer_load_dwordx4 v[84:87], v1, s[44:47], s67 offen offset:2048 sc1
    s_add_u32 s83, s83, 1
    s_and_b32 s8, s83, 63
    s_cmp_eq_u32 s8, 0
    s_cbranch_scc1 ch3bf_x
    s_branch ch3bf_q210
ch3bf_q102:
    s_waitcnt vmcnt(3)
    v_fma_mix_f32 v103, v80, 1.0, v88 op_sel:[0,0,0] op_sel_hi:[1,0,1]
    v_fma_mix_f32 v88, v80, 1.0, v88 op_sel:[1,0,1] op_sel_hi:[1,0,1]
    v_fma_mix_f32 v80, v81, 1.0, v89 op_sel:[0,0,0] op_sel_hi:[1,0,1]
    v_fma_mix_f32 v89, v81, 1.0, v89 op_sel:[1,0,1] op_sel_hi:[1,0,1]
    v_fma_mix_f32 v81, v82, 1.0, v90 op_sel:[0,0,0] op_sel_hi:[1,0,1]
    v_fma_mix_f32 v90, v82, 1.0, v90 op_sel:[1,0,1] op_sel_hi:[1,0,1]
    v_fma_mix_f32 v82, v83, 1.0, v91 op_sel:[0,0,0] op_sel_hi:[1,0,1]
    v_fma_mix_f32 v91, v83, 1.0, v91 op_sel:[1,0,1] op_sel_hi:[1,0,1]
    v_maximum3_f32 v114, v88, v89, v90
    v_cmp_u_f32 vcc, v114, v91
    v_exp_f32 v80, v80
    v_exp_f32 v81, v81
    v_exp_f32 v82, v82
    s_cbranch_vccnz ch3bf_q102_e
    v_exp_f32 v83, v103
    v_exp_f32 v88, v88
    v_exp_f32 v89, v89
    v_pk_add_f32 v[98:99], v[80:81], v[82:83]
    v_exp_f32 v90, v90
    v_exp_f32 v91, v91
    v_pk_add_f32 v[98:99], v[98:99], v[88:89]
    v_pk_add_f32 v[98:99], v[98:99], v[90:91]
    s_branch ch3bf_q02
ch3bf_q102_e:
    buffer_load_dwordx4 v[80:83], v1, s[44:47], s67 offen offset:1024 sc1
    buffer_load_dwordx4 v[88:91], v1, s[44:47], s67 offen offset:3072 sc1
    s_add_u32 s83, s83, 1
    s_and_b32 s8, s83, 63
    s_cmp_eq_u32 s8, 0
    s_cbranch_scc1 ch3bf_x
    s_branch ch3bf_q021
ch3bf_q120:
    s_waitcnt vmcnt(3)
    v_fma_mix_f32 v103, v80, 1.0, v88 op_sel:[0,0,0] op_sel_hi:[1,0,1]
    v_fma_mix_f32 v88, v80, 1.0, v88 op_sel:[1,0,1] op_sel_hi:[1,0,1]
    v_fma_mix_f32 v80, v81, 1.0, v89 op_sel:[0,0,0] op_sel_hi:[1,0,1]
    v_fma_mix_f32 v89, v81, 1.0, v89 op_sel:[1,0,1] op_sel_hi:[1,0,1]
    v_fma_mix_f32 v81, v82, 1.0, v90 op_sel:[0,0,0] op_sel_hi:[1,0,1]
    v_fma_mix_f32 v90, v82, 1.0, v90 op_sel:[1,0,1] op_sel_hi:[1,0,1]
    v_fma_mix_f32 v82, v83, 1.0, v91 op_sel:[0,0,0] op_sel_hi:[1,0,1]
    v_fma_mix_f32 v91, v83, 1.0, v91 op_sel:[1,0,1] op_sel_hi:[1,0,1]
    v_maximum3_f32 v114, v88, v89, v90
    v_cmp_u_f32 vcc, v114, v91
    v_exp_f32 v80, v80
    v_exp_f32 v81, v81
    v_exp_f32 v82, v82
    s_cbranch_vccnz ch3bf_q120_e
    v_exp_f32 v83, v103
    v_exp_f32 v88, v88
    v_exp_f32 v89, v89
    v_pk_add_f32 v[98:99], v[80:81], v[82:83]
    v_exp_f32 v90, v90
    v_exp_f32 v91, v91
    v_pk_add_f32 v[98:99], v[98:99], v[88:89]
    v_pk_add_f32 v[98:99], v[98:99], v[90:91]
    s_branch ch3bf_q20
ch3bf_q120_e:
    buffer_load_dwordx4 v[80:83], v1, s[44:47], s67 offen offset:1024 sc1
    buffer_load_dwordx4 v[88:91], v1, s[44:47], s67 offen offset:3072 sc1
    s_add_u32 s83, s83, 1
    s_and_b32 s8, s83, 63
    s_cmp_eq_u32 s8, 0
    s_cbranch_scc1 ch3bf_x
    s_branch ch3bf_q201
ch3bf_q201:
    s_waitcnt vmcnt(4)
    v_fma_mix_f32 v113, v92, 1.0, v94 op_sel:[0,0,0] op_sel_hi:[1,0,1]
    v_fma_mix_f32 v94, v92, 1.0, v94 op_sel:[1,0,1] op_sel_hi:[1,0,1]
    v_fma_mix_f32 v92, v93, 1.0, v95 op_sel:[0,0,0] op_sel_hi:[1,0,1]
    v_fma_mix_f32 v95, v93, 1.0, v95 op_sel:[1,0,1] op_sel_hi:[1,0,1]
    v_cmp_u_f32 vcc, v94, v95
    v_exp_f32 v92, v92
    v_exp_f32 v93, v113
    v_exp_f32 v94, v94
    s_cbranch_vccnz ch3bf_q201_e
    v_exp_f32 v95, v95
    s_nop 0
    v_pk_add_f32 v[100:101], v[92:93], v[94:95]
    s_branch ch3bf_q01
ch3bf_q201_e:
    buffer_load_dwordx4 v[92:95], v10, s[44:47], s67 offen offset:0 sc1
    s_add_u32 s83, s83, 1
    s_and_b32 s8, s83, 63
    s_cmp_eq_u32 s8, 0
    s_cbranch_scc1 ch3bf_x
    s_branch ch3bf_q012
ch3bf_q210:
    s_waitcnt vmcnt(4)
    v_fma_mix_f32 v113, v92, 1.0, v94 op_sel:[0,0,0] op_sel_hi:[1,0,1]
    v_fma_mix_f32 v94, v92, 1.0, v94 op_sel:[1,0,1] op_sel_hi:[1,0,1]
    v_fma_mix_f32 v92, v93, 1.0, v95 op_sel:[0,0,0] op_sel_hi:[1,0,1]
    v_fma_mix_f32 v95, v93, 1.0, v95 op_sel:[1,0,1] op_sel_hi:[1,0,1]
    v_cmp_u_f32 vcc, v94, v95
    v_exp_f32 v92, v92
    v_exp_f32 v93, v113
    v_exp_f32 v94, v94
    s_cbranch_vccnz ch3bf_q210_e
    v_exp_f32 v95, v95
    v_pk_add_f32 v[100:101], v[92:93], v[94:95]
    s_branch ch3bf_q10
ch3bf_q210_e:
    buffer_load_dwordx4 v[92:95], v10, s[44:47], s67 offen offset:0 sc1
    s_add_u32 s83, s83, 1
    s_and_b32 s8, s83, 63
    s_cmp_eq_u32 s8, 0
    s_cbranch_scc1 ch3bf_x
    s_branch ch3bf_q102
ch3bf_fb:
    buffer_load_dwordx4 v[76:79], v1, s[44:47], s67 offen offset:0 sc1
    buffer_load_dwordx4 v[84:87], v1, s[44:47], s67 offen offset:2048 sc1
    buffer_load_dwordx4 v[80:83], v1, s[44:47], s67 offen offset:1024 sc1
    buffer_load_dwordx4 v[88:91], v1, s[44:47], s67 offen offset:3072 sc1
    buffer_load_dwordx4 v[92:95], v10, s[44:47], s67 offen offset:0 sc1
    s_waitcnt vmcnt(0)
    v_fma_mix_f32 v102, v76, 1.0, v84 op_sel:[0,0,0] op_sel_hi:[1,0,1]
    v_fma_mix_f32 v84, v76, 1.0, v84 op_sel:[1,0,1] op_sel_hi:[1,0,1]
    v_fma_mix_f32 v76, v77, 1.0, v85 op_sel:[0,0,0] op_sel_hi:[1,0,1]
    v_fma_mix_f32 v85, v77, 1.0, v85 op_sel:[1,0,1] op_sel_hi:[1,0,1]
    v_fma_mix_f32 v77, v78, 1.0, v86 op_sel:[0,0,0] op_sel_hi:[1,0,1]
    v_fma_mix_f32 v86, v78, 1.0, v86 op_sel:[1,0,1] op_sel_hi:[1,0,1]
    v_fma_mix_f32 v78, v79, 1.0, v87 op_sel:[0,0,0] op_sel_hi:[1,0,1]
    v_fma_mix_f32 v87, v79, 1.0, v87 op_sel:[1,0,1] op_sel_hi:[1,0,1]
    v_maximum3_f32 v112, v102, v84, v76
    v_maximum3_f32 v112, v112, v85, v77
    v_maximum3_f32 v112, v112, v86, v78
    v_maximum3_f32 v112, v112, v87, v87
    v_cmp_u_f32 vcc, v112, v112
    v_mov_b32 v79, v102
    v_pk_add_f32 v[76:77], v[76:77], v[112:113] op_sel_hi:[1,0] neg_lo:[0,1] neg_hi:[0,1]
    v_pk_add_f32 v[78:79], v[78:79], v[112:113] op_sel_hi:[1,0] neg_lo:[0,1] neg_hi:[0,1]
    v_pk_add_f32 v[84:85], v[84:85], v[112:113] op_sel_hi:[1,0] neg_lo:[0,1] neg_hi:[0,1]
    v_pk_add_f32 v[86:87], v[86:87], v[112:113] op_sel_hi:[1,0] neg_lo:[0,1] neg_hi:[0,1]
    v_exp_f32 v76, v76
    v_exp_f32 v77, v77
    v_exp_f32 v78, v78
    v_exp_f32 v79, v79
    v_exp_f32 v84, v84
    v_exp_f32 v85, v85
    v_pk_add_f32 v[96:97], v[76:77], v[78:79]
    v_exp_f32 v86, v86
    v_exp_f32 v87, v87
    v_pk_add_f32 v[96:97], v[96:97], v[84:85]
    v_pk_add_f32 v[96:97], v[96:97], v[86:87]
    v_fma_mix_f32 v103, v80, 1.0, v88 op_sel:[0,0,0] op_sel_hi:[1,0,1]
    v_fma_mix_f32 v88, v80, 1.0, v88 op_sel:[1,0,1] op_sel_hi:[1,0,1]
    v_fma_mix_f32 v80, v81, 1.0, v89 op_sel:[0,0,0] op_sel_hi:[1,0,1]
    v_fma_mix_f32 v89, v81, 1.0, v89 op_sel:[1,0,1] op_sel_hi:[1,0,1]
    v_fma_mix_f32 v81, v82, 1.0, v90 op_sel:[0,0,0] op_sel_hi:[1,0,1]
    v_fma_mix_f32 v90, v82, 1.0, v90 op_sel:[1,0,1] op_sel_hi:[1,0,1]
    v_fma_mix_f32 v82, v83, 1.0, v91 op_sel:[0,0,0] op_sel_hi:[1,0,1]
    v_fma_mix_f32 v91, v83, 1.0, v91 op_sel:[1,0,1] op_sel_hi:[1,0,1]
    v_maximum3_f32 v114, v103, v88, v80
    v_maximum3_f32 v114, v114, v89, v81
    v_maximum3_f32 v114, v114, v90, v82
    v_maximum3_f32 v114, v114, v91, v91
    v_cmp_u_f32 vcc, v114, v114
    v_mov_b32 v83, v103
    v_pk_add_f32 v[80:81], v[80:81], v[114:115] op_sel_hi:[1,0] neg_lo:[0,1] neg_hi:[0,1]
    v_pk_add_f32 v[82:83], v[82:83], v[114:115] op_sel_hi:[1,0] neg_lo:[0,1] neg_hi:[0,1]
    v_pk_add_f32 v[88:89], v[88:89], v[114:115] op_sel_hi:[1,0] neg_lo:[0,1] neg_hi:[0,1]
    v_pk_add_f32 v[90:91], v[90:91], v[114:115] op_sel_hi:[1,0] neg_lo:[0,1] neg_hi:[0,1]
    v_exp_f32 v80, v80
    v_exp_f32 v81, v81
    v_exp_f32 v82, v82
    v_exp_f32 v83, v83
    v_exp_f32 v88, v88
    v_exp_f32 v89, v89
    v_pk_add_f32 v[98:99], v[80:81], v[82:83]
    v_exp_f32 v90, v90
    v_exp_f32 v91, v91
    v_pk_add_f32 v[98:99], v[98:99], v[88:89]
    v_pk_add_f32 v[98:99], v[98:99], v[90:91]
    v_fma_mix_f32 v113, v92, 1.0, v94 op_sel:[0,0,0] op_sel_hi:[1,0,1]
    v_fma_mix_f32 v94, v92, 1.0, v94 op_sel:[1,0,1] op_sel_hi:[1,0,1]
    v_fma_mix_f32 v92, v93, 1.0, v95 op_sel:[0,0,0] op_sel_hi:[1,0,1]
    v_fma_mix_f32 v95, v93, 1.0, v95 op_sel:[1,0,1] op_sel_hi:[1,0,1]
    v_maximum3_f32 v116, v113, v94, v92
    v_maximum3_f32 v116, v116, v95, v95
    v_cmp_u_f32 vcc, v116, v116
    v_mov_b32 v93, v113
    v_pk_add_f32 v[92:93], v[92:93], v[116:117] op_sel_hi:[1,0] neg_lo:[0,1] neg_hi:[0,1]
    v_pk_add_f32 v[94:95], v[94:95], v[116:117] op_sel_hi:[1,0] neg_lo:[0,1] neg_hi:[0,1]
    v_exp_f32 v92, v92
    v_exp_f32 v93, v93
    v_exp_f32 v94, v94
    v_exp_f32 v95, v95
    s_nop 0
    v_pk_add_f32 v[100:101], v[92:93], v[94:95]
    v_max3_f32 v2, v112, v114, v116
    v_max3_f32 v15, v112, v114, v116
    v_add_f32 v96, v96, v97
    v_add_f32 v98, v98, v99
    v_add_f32 v100, v100, v101
    v_permlane16_swap_b32 v2, v15
    v_max_f32 v2, v2, v15
    v_sub_f32 v112, v112, v2
    v_sub_f32 v114, v114, v2
    v_sub_f32 v116, v116, v2
    v_exp_f32 v112, v112
    v_exp_f32 v114, v114
    v_exp_f32 v116, v116
    v_mul_f32 v2, v112, v96
    v_fmac_f32 v2, v114, v98
    v_fmac_f32 v2, v116, v100
    v_mov_b32 v15, v2
    s_nop 1
    v_permlane16_swap_b32 v2, v15
    v_add_f32 v2, v2, v15
    v_rcp_f32 v2, v2
    s_nop 0
    v_mul_f32 v116, v116, v2
    v_mul_f32 v112, v112, v2
    v_mul_f32 v114, v114, v2
    s_waitcnt lgkmcnt(0)
    v_pk_mul_f32 v[92:93], v[92:93], v[116:117] op_sel_hi:[1,0]
    v_pk_mul_f32 v[94:95], v[94:95], v[116:117] op_sel_hi:[1,0]
    v_cvt_pk_bf16_f32 v116, v93, v94
    v_cvt_pk_bf16_f32 v118, v92, v95
    v_pk_mul_f32 v[76:77], v[76:77], v[112:113] op_sel_hi:[1,0]
    v_pk_mul_f32 v[78:79], v[78:79], v[112:113] op_sel_hi:[1,0]
    v_pk_mul_f32 v[84:85], v[84:85], v[112:113] op_sel_hi:[1,0]
    v_pk_mul_f32 v[86:87], v[86:87], v[112:113] op_sel_hi:[1,0]
    v_cvt_pk_bf16_f32 v96, v79, v84
    v_cvt_pk_bf16_f32 v97, v76, v85
    v_cvt_pk_bf16_f32 v98, v77, v86
    v_cvt_pk_bf16_f32 v99, v78, v87
    v_pk_mul_f32 v[80:81], v[80:81], v[114:115] op_sel_hi:[1,0]
    v_pk_mul_f32 v[82:83], v[82:83], v[114:115] op_sel_hi:[1,0]
    v_pk_mul_f32 v[88:89], v[88:89], v[114:115] op_sel_hi:[1,0]
    v_pk_mul_f32 v[90:91], v[90:91], v[114:115] op_sel_hi:[1,0]
    v_smfmac_f32_16x16x64_bf16 v[60:63], v[116:119], v[104:111], v5
    v_cvt_pk_bf16_f32 v100, v83, v88
    v_cvt_pk_bf16_f32 v101, v80, v89
    v_smfmac_f32_16x16x64_bf16 v[60:63], v[96:99], v[44:51], v5
    v_cvt_pk_bf16_f32 v102, v81, v90
    v_cvt_pk_bf16_f32 v103, v82, v91
    s_nop 1
    v_smfmac_f32_16x16x64_bf16 v[60:63], v[100:103], v[52:59], v5
    s_branch ch3bf_kj
ch3bf_x:
    s_cmp_ge_u32 s83, 2000000
    s_cbranch_scc1 chain_abort
    buffer_load_dwordx4 v[76:79], v1, s[44:47], s67 offen offset:0 sc1
    buffer_load_dwordx4 v[84:87], v1, s[44:47], s67 offen offset:2048 sc1
    buffer_load_dwordx4 v[80:83], v1, s[44:47], s67 offen offset:1024 sc1
    buffer_load_dwordx4 v[88:91], v1, s[44:47], s67 offen offset:3072 sc1
    buffer_load_dwordx4 v[92:95], v10, s[44:47], s67 offen offset:0 sc1
    s_waitcnt vmcnt(0)
    v_pk_max_u16 v2, v76, v77
    v_pk_max_u16 v2, v2, v78
    v_pk_max_u16 v2, v2, v79
    v_pk_max_u16 v2, v2, v80
    v_pk_max_u16 v2, v2, v81
    v_pk_max_u16 v2, v2, v82
    v_pk_max_u16 v2, v2, v83
    v_pk_max_u16 v2, v2, v84
    v_pk_max_u16 v2, v2, v85
    v_pk_max_u16 v2, v2, v86
    v_pk_max_u16 v2, v2, v87
    v_pk_max_u16 v2, v2, v88
    v_pk_max_u16 v2, v2, v89
    v_pk_max_u16 v2, v2, v90
    v_pk_max_u16 v2, v2, v91
    v_pk_max_u16 v2, v2, v92
    v_pk_max_u16 v2, v2, v93
    v_pk_max_u16 v2, v2, v94
    v_pk_max_u16 v2, v2, v95
    v_lshrrev_b32 v112, 16, v2
    v_and_b32 v2, 0xffff, v2
    v_max_u32 v2, v2, v112
    v_cmp_eq_u32 vcc, 0xffff, v2
    s_cbranch_vccnz ch3bf_q012
    v_fma_mix_f32 v102, v76, 1.0, v84 op_sel:[0,0,0] op_sel_hi:[1,0,1]
    v_fma_mix_f32 v84, v76, 1.0, v84 op_sel:[1,0,1] op_sel_hi:[1,0,1]
    v_fma_mix_f32 v76, v77, 1.0, v85 op_sel:[0,0,0] op_sel_hi:[1,0,1]
    v_fma_mix_f32 v85, v77, 1.0, v85 op_sel:[1,0,1] op_sel_hi:[1,0,1]
    v_fma_mix_f32 v77, v78, 1.0, v86 op_sel:[0,0,0] op_sel_hi:[1,0,1]
    v_fma_mix_f32 v86, v78, 1.0, v86 op_sel:[1,0,1] op_sel_hi:[1,0,1]
    v_fma_mix_f32 v78, v79, 1.0, v87 op_sel:[0,0,0] op_sel_hi:[1,0,1]
    v_fma_mix_f32 v87, v79, 1.0, v87 op_sel:[1,0,1] op_sel_hi:[1,0,1]
    v_exp_f32 v76, v76
    v_exp_f32 v77, v77
    v_exp_f32 v78, v78
    v_exp_f32 v79, v102
    v_exp_f32 v84, v84
    v_exp_f32 v85, v85
    v_pk_add_f32 v[96:97], v[76:77], v[78:79]
    v_exp_f32 v86, v86
    v_exp_f32 v87, v87
    v_pk_add_f32 v[96:97], v[96:97], v[84:85]
    v_pk_add_f32 v[96:97], v[96:97], v[86:87]
    v_fma_mix_f32 v103, v80, 1.0, v88 op_sel:[0,0,0] op_sel_hi:[1,0,1]
    v_fma_mix_f32 v88, v80, 1.0, v88 op_sel:[1,0,1] op_sel_hi:[1,0,1]
    v_fma_mix_f32 v80, v81, 1.0, v89 op_sel:[0,0,0] op_sel_hi:[1,0,1]
    v_fma_mix_f32 v89, v81, 1.0, v89 op_sel:[1,0,1] op_sel_hi:[1,0,1]
    v_fma_mix_f32 v81, v82, 1.0, v90 op_sel:[0,0,0] op_sel_hi:[1,0,1]
    v_fma_mix_f32 v90, v82, 1.0, v90 op_sel:[1,0,1] op_sel_hi:[1,0,1]
    v_fma_mix_f32 v82, v83, 1.0, v91 op_sel:[0,0,0] op_sel_hi:[1,0,1]
    v_fma_mix_f32 v91, v83, 1.0, v91 op_sel:[1,0,1] op_sel_hi:[1,0,1]
    v_exp_f32 v80, v80
    v_exp_f32 v81, v81
    v_exp_f32 v82, v82
    v_exp_f32 v83, v103
    v_exp_f32 v88, v88
    v_exp_f32 v89, v89
    v_pk_add_f32 v[98:99], v[80:81], v[82:83]
    v_exp_f32 v90, v90
    v_exp_f32 v91, v91
    v_pk_add_f32 v[98:99], v[98:99], v[88:89]
    v_pk_add_f32 v[98:99], v[98:99], v[90:91]
    v_fma_mix_f32 v113, v92, 1.0, v94 op_sel:[0,0,0] op_sel_hi:[1,0,1]
    v_fma_mix_f32 v94, v92, 1.0, v94 op_sel:[1,0,1] op_sel_hi:[1,0,1]
    v_fma_mix_f32 v92, v93, 1.0, v95 op_sel:[0,0,0] op_sel_hi:[1,0,1]
    v_fma_mix_f32 v95, v93, 1.0, v95 op_sel:[1,0,1] op_sel_hi:[1,0,1]
    v_exp_f32 v92, v92
    v_exp_f32 v93, v113
    v_exp_f32 v94, v94
    v_exp_f32 v95, v95
    s_nop 0
    v_pk_add_f32 v[100:101], v[92:93], v[94:95]
    s_branch ch3bf_k0
ch3bf_vw:
    v_lshlrev_b32 v113, 7, v0
    s_mov_b32 s99, 0
hz_178:
    buffer_load_dword v115, v113, s[44:47], s75 offen sc1
    s_waitcnt vmcnt(0)
    v_cmp_gt_u32 vcc, 28, v115
    s_ff1_i32_b64 s100, vcc
    s_cmp_eq_u32 s100, -1
    s_cselect_b32 s100, 65, s100
    s_sub_u32 s100, s100, 1
    s_cmp_gt_i32 s100, s64
    s_cbranch_scc1 hd_179
    s_sleep 1
    s_add_u32 s99, s99, 1
    s_cmp_lt_u32 s99, 400000
    s_cbranch_scc1 hz_178
    s_branch chain_abort
hd_179:
    s_branch ch3bf_vok
ch3af:
    v_mov_b32 v44, 0
    v_mov_b32 v60, 0
    v_mov_b32 v45, 0
    v_mov_b32 v61, 0
    v_mov_b32 v46, 0
    v_mov_b32 v62, 0
    v_mov_b32 v47, 0
    v_mov_b32 v63, 0
    v_mov_b32 v48, 0
    v_mov_b32 v64, 0
    v_mov_b32 v49, 0
    v_mov_b32 v65, 0
    v_mov_b32 v50, 0
    v_mov_b32 v66, 0
    v_mov_b32 v51, 0
    v_mov_b32 v67, 0
    v_mov_b32 v52, 0
    v_mov_b32 v68, 0
    v_mov_b32 v53, 0
    v_mov_b32 v69, 0
    v_mov_b32 v54, 0
    v_mov_b32 v70, 0
    v_mov_b32 v55, 0
    v_mov_b32 v71, 0
    v_mov_b32 v56, 0
    v_mov_b32 v72, 0
    v_mov_b32 v57, 0
    v_mov_b32 v73, 0
    v_mov_b32 v58, 0
    v_mov_b32 v74, 0
    v_mov_b32 v59, 0
    v_mov_b32 v75, 0
    v_mov_b32 v112, 0
    v_mov_b32 v113, 0
    v_mov_b32 v114, 0
    v_mov_b32 v115, 0
    s_branch ch3af_loop
.p2align 6
ch3af_loop:
    s_and_b32 s8, s64, 3
    s_lshl_b32 s65, s8, 13
    s_add_u32 s65, s65, 94902272
    buffer_load_dwordx4 v[40:43], v1, s[44:47], s65 offen offset:0 sc1
    s_mov_b32 s83, 0
    s_and_b32 s8, s64, 3
    s_mul_i32 s9, s8, 20736
    s_add_u32 s67, s9, 94944256
    s_add_u32 s66, s9, s12
    s_xor_b32 s8, s8, 2
    s_mul_i32 s9, s8, 20736
    s_add_u32 s70, s9, s13
ch3af_mp:
    buffer_load_dwordx4 v[40:43], v1, s[44:47], s65 offen offset:0 sc1
    s_add_u32 s83, s83, 1
    s_cmp_ge_u32 s83, 2000000
    s_cbranch_scc1 chain_abort
    s_waitcnt vmcnt(1)
    v_max3_u32 v2, v40, v41, v42
    v_max_u32 v2, v2, v43
    v_cmp_eq_u32 vcc, -1, v2
    s_cbranch_vccnz ch3af_mp
    ds_write_b128 v1, v[40:43] offset:6144
    v_smfmac_f32_16x16x64_bf16 v[44:47], v[40:43], a[48:55], v5
    v_smfmac_f32_16x16x64_bf16 v[48:51], v[40:43], a[104:111], v5
    s_waitcnt lgkmcnt(0)
    s_barrier
    ds_read_b128 v[16:19], v1 offset:0
    ds_read_b128 v[20:23], v1 offset:1024
    ds_read_b128 v[24:27], v1 offset:2048
    ds_read_b128 v[28:31], v1 offset:3072
    ds_read_b128 v[32:35], v1 offset:4096
    ds_read_b128 v[36:39], v1 offset:5120
    v_smfmac_f32_16x16x64_bf16 v[52:55], v[40:43], a[160:167], v5
    s_waitcnt lgkmcnt(5)
    v_smfmac_f32_16x16x64_bf16 v[44:47], v[16:19], a[0:7], v5
    s_waitcnt lgkmcnt(4)
    v_smfmac_f32_16x16x64_bf16 v[44:47], v[20:23], a[8:15], v5
    s_waitcnt lgkmcnt(3)
    v_smfmac_f32_16x16x64_bf16 v[44:47], v[24:27], a[16:23], v5
    ds_read_b128 v[76:79], v12 offset:0
    s_waitcnt lgkmcnt(3)
    v_smfmac_f32_16x16x64_bf16 v[44:47], v[28:31], a[24:31], v5
    ds_read_b128 v[80:83], v12 offset:1024
    s_waitcnt lgkmcnt(3)
    v_smfmac_f32_16x16x64_bf16 v[44:47], v[32:35], a[32:39], v5
    ds_read_b128 v[84:87], v12 offset:2048
    s_waitcnt lgkmcnt(3)
    v_smfmac_f32_16x16x64_bf16 v[44:47], v[36:39], a[40:47], v5
    ds_read_b128 v[88:91], v12 offset:3072
    v_smfmac_f32_16x16x64_bf16 v[48:51], v[16:19], a[56:63], v5
    ds_read_b128 v[92:95], v12 offset:4096
    v_smfmac_f32_16x16x64_bf16 v[48:51], v[20:23], a[64:71], v5
    ds_read_b128 v[96:99], v12 offset:5120
    v_smfmac_f32_16x16x64_bf16 v[48:51], v[24:27], a[72:79], v5
    ds_read_b128 v[100:103], v12 offset:6144
    v_smfmac_f32_16x16x64_bf16 v[48:51], v[28:31], a[80:87], v5
    v_add_f32 v44, v44, v46
    v_smfmac_f32_16x16x64_bf16 v[48:51], v[32:35], a[88:95], v5
    v_add_f32 v45, v45, v47
    v_smfmac_f32_16x16x64_bf16 v[48:51], v[36:39], a[96:103], v5
    v_cvt_pk_bf16_f32 v44, v44, v45
    v_smfmac_f32_16x16x64_bf16 v[52:55], v[16:19], a[112:119], v5
    ds_write_b32 v6, v44 offset:2304
    v_smfmac_f32_16x16x64_bf16 v[52:55], v[20:23], a[120:127], v5
    v_xor_b32 v12, 0x4000, v12
    v_smfmac_f32_16x16x64_bf16 v[52:55], v[24:27], a[128:135], v5
    v_smfmac_f32_16x16x64_bf16 v[52:55], v[28:31], a[136:143], v5
    s_nop 0
    v_add_f32 v48, v48, v50
    v_smfmac_f32_16x16x64_bf16 v[52:55], v[32:35], a[144:151], v5
    v_add_f32 v49, v49, v51
    v_smfmac_f32_16x16x64_bf16 v[52:55], v[36:39], a[152:159], v5
    v_cvt_pk_bf16_f32 v48, v48, v49
    ds_write_b32 v6, v48 offset:2560
    s_nop 5
    v_add_f32 v52, v52, v54
    v_add_f32 v53, v53, v55
    v_cvt_pk_bf16_f32 v52, v52, v53
    ds_write_b32 v6, v52 offset:2816
    s_waitcnt lgkmcnt(0)
    s_barrier
    ds_read_b64_tr_b16 v[44:45], v7 offset:0
    ds_read_b64_tr_b16 v[46:47], v7 offset:128
    ds_read_b64_tr_b16 v[48:49], v7 offset:1024
    ds_read_b64_tr_b16 v[50:51], v7 offset:1152
    ds_read_b64_tr_b16 v[52:53], v7 offset:2048
    ds_read_b64_tr_b16 v[54:55], v7 offset:2176
    s_barrier
    ds_read_b64_tr_b16 v[56:57], v7 offset:3072
    ds_read_b64_tr_b16 v[58:59], v7 offset:3200
    s_waitcnt lgkmcnt(6)
    v_smfmac_f32_16x16x64_bf16 v[112:115], v[44:47], v[76:83], v5
    s_waitcnt lgkmcnt(4)
    v_smfmac_f32_16x16x64_bf16 v[112:115], v[48:51], v[84:91], v5
    s_waitcnt lgkmcnt(2)
    v_smfmac_f32_16x16x64_bf16 v[112:115], v[52:55], v[92:99], v5
    s_waitcnt lgkmcnt(0)
    v_smfmac_f32_16x16x64_bf16 v[112:115], v[56:59], v[100:107], v5
    s_nop 7
    v_pk_add_f32 v[112:113], v[112:113], v[114:115]
    v_pk_mul_f32 v[112:113], v[112:113], s[78:79]
    v_cvt_pk_f16_f32 v112, v112, v113
    s_nop 1
    v_mov_b32_dpp v113, v112 quad_perm:[1,0,3,2] row_mask:0xf bank_mask:0xf
    v_perm_b32 v112, v113, v112, v14
    v_pk_min_u16 v112, v112, s77
    buffer_store_dword v112, v9, s[44:47], s66 offen
    s_barrier
    s_cmp_ge_u32 s100, 64
    s_cbranch_scc1 ch3af_hk
    s_cmp_lg_u32 s7, 31
    s_cbranch_scc1 ch3af_hk
    v_lshlrev_b32 v113, 7, v0
    s_mov_b32 s99, 0
hz_180:
    buffer_load_dword v115, v113, s[44:47], s75 offen sc1
    s_waitcnt vmcnt(0)
    v_cmp_gt_u32 vcc, 28, v115
    s_ff1_i32_b64 s100, vcc
    s_cmp_eq_u32 s100, -1
    s_cselect_b32 s100, 65, s100
    s_sub_u32 s100, s100, 1
    s_max_i32 s100, s100, 0
hd_181:
    v_mov_b32 v2, s100
    buffer_store_dword v2, off, s[44:47], s73
ch3af_hk:
    s_add_u32 s71, s71, 458752
    s_add_u32 s8, s64, s7
    s_and_b32 s8, s8, 3
    s_cmp_lg_u32 s8, 0
    s_cselect_b32 s101, -1, s64
    s_cbranch_scc1 ch3af_np
    s_lshl_b32 s8, s64, 13
    s_add_u32 s8, s8, 91756544
    buffer_store_dwordx4 v[40:43], v1, s[44:47], s8 offen offset:0 sc1
ch3af_np:
    v_mov_b32 v44, 0
    v_mov_b32 v45, 0
    v_mov_b32 v46, 0
    v_mov_b32 v47, 0
    v_mov_b32 v48, 0
    v_mov_b32 v49, 0
    v_mov_b32 v50, 0
    v_mov_b32 v51, 0
    v_mov_b32 v52, 0
    v_mov_b32 v53, 0
    v_mov_b32 v54, 0
    v_mov_b32 v55, 0
    v_mov_b32 v112, 0
    v_mov_b32 v113, 0
    v_mov_b32 v114, 0
    v_mov_b32 v115, 0
    s_add_u32 s64, s64, 1
    s_cmp_lt_u32 s64, 63
    s_cbranch_scc1 ch3af_loop
    s_waitcnt vmcnt(0)
    s_barrier
    s_endpgm
chain_abort:
    s_mov_b32 s60, s40
    s_and_b32 s61, s41, 0xffff
    s_mov_b32 s62, 0x100
    s_mov_b32 s63, 0x20000
    v_mov_b32 v2, 0
    v_mov_b32 v5, 3735879692
    buffer_store_dword v5, v2, s[60:63], 0 offen offset:48
    s_endpgm
code_hi:
ch0bs:
    v_mov_b32 v44, 0
    v_mov_b32 v60, 0
    v_mov_b32 v45, 0
    v_mov_b32 v61, 0
    v_mov_b32 v46, 0
    v_mov_b32 v62, 0
    v_mov_b32 v47, 0
    v_mov_b32 v63, 0
    v_mov_b32 v48, 0
    v_mov_b32 v64, 0
    v_mov_b32 v49, 0
    v_mov_b32 v65, 0
    v_mov_b32 v50, 0
    v_mov_b32 v66, 0
    v_mov_b32 v51, 0
    v_mov_b32 v67, 0
    v_mov_b32 v52, 0
    v_mov_b32 v68, 0
    v_mov_b32 v53, 0
    v_mov_b32 v69, 0
    v_mov_b32 v54, 0
    v_mov_b32 v70, 0
    v_mov_b32 v55, 0
    v_mov_b32 v71, 0
    v_mov_b32 v56, 0
    v_mov_b32 v72, 0
    v_mov_b32 v57, 0
    v_mov_b32 v73, 0
    v_mov_b32 v58, 0
    v_mov_b32 v74, 0
    v_mov_b32 v59, 0
    v_mov_b32 v75, 0
    v_mov_b32 v112, 0
    v_mov_b32 v113, 0
    v_mov_b32 v114, 0
    v_mov_b32 v115, 0
    s_branch ch0bs_loop
.p2align 6
ch0bs_loop:
    s_and_b32 s8, s64, 3
    s_lshl_b32 s65, s8, 13
    s_add_u32 s65, s65, 94896128
    buffer_load_dwordx4 v[16:19], v1, s[44:47], s65 offen offset:0 sc1
    buffer_load_dwordx4 v[20:23], v1, s[44:47], s65 offen offset:1024 sc1
    s_mov_b32 s83, 0
    s_and_b32 s8, s64, 3
    s_mul_i32 s9, s8, 20736
    s_add_u32 s67, s9, 94928896
    s_add_u32 s66, s9, s12
    s_xor_b32 s8, s8, 2
    s_mul_i32 s9, s8, 20736
    s_add_u32 s70, s9, s13
    s_lshl_b32 s9, s8, 13
    s_add_u32 s69, s9, s14
    s_add_u32 s8, s64, 1
    s_and_b32 s8, s8, 3
    s_lshl_b32 s9, s8, 13
    s_add_u32 s68, s9, s14
    s_add_u32 s16, s72, 0
    s_add_u32 s20, s15, 0
    s_add_u32 s17, s72, 4096
    s_add_u32 s21, s15, 4096
    s_add_u32 s18, s72, 14336
    s_add_u32 s22, s15, 8192
    s_add_u32 s72, s72, 28672
    s_xor_b32 s15, s15, 0x4000
    s_add_u32 s24, s71, 0
    s_add_u32 s71, s71, 458752
    v_mov_b32 v60, 0
    v_mov_b32 v61, 0
    v_mov_b32 v62, 0
    v_mov_b32 v63, 0
    v_mov_b32 v64, 0
    v_mov_b32 v65, 0
    v_mov_b32 v66, 0
    v_mov_b32 v67, 0
    v_mov_b32 v68, 0
    v_mov_b32 v69, 0
    v_mov_b32 v70, 0
    v_mov_b32 v71, 0
    v_mov_b32 v72, 0
    v_mov_b32 v73, 0
    v_mov_b32 v74, 0
    v_mov_b32 v75, 0
ch0bs_mp:
    buffer_load_dwordx4 v[16:19], v1, s[44:47], s65 offen offset:0 sc1
    buffer_load_dwordx4 v[20:23], v1, s[44:47], s65 offen offset:1024 sc1
    s_add_u32 s83, s83, 1
    s_cmp_ge_u32 s83, 2000000
    s_cbranch_scc1 chain_abort
    s_waitcnt vmcnt(3)
    v_max3_u32 v2, v16, v17, v18
    v_max_u32 v2, v2, v19
    v_cmp_eq_u32 s[10:11], -1, v2
    s_waitcnt vmcnt(2)
    v_max3_u32 v2, v20, v21, v22
    v_max_u32 v2, v2, v23
    v_cmp_eq_u32 vcc, -1, v2
    s_cmp_lg_u64 s[10:11], 0
    s_cbranch_scc1 ch0bs_m0bad
    s_cbranch_vccnz ch0bs_mp1
ch0bs_mok:
    ds_write_b128 v1, v[16:19] offset:0
    ds_write_b128 v1, v[20:23] offset:1024
    v_smfmac_f32_16x16x64_bf16 v[44:47], v[16:19], a[0:7], v5
    v_smfmac_f32_16x16x64_bf16 v[48:51], v[16:19], a[56:63], v5
    s_waitcnt lgkmcnt(0)
    s_barrier
    s_mov_b32 m0, 16384
    ds_read_b128 v[24:27], v1 offset:2048
    ds_read_b128 v[28:31], v1 offset:3072
    ds_read_b128 v[32:35], v1 offset:4096
    ds_read_b128 v[36:39], v1 offset:5120
    ds_read_b128 v[40:43], v1 offset:6144
    v_smfmac_f32_16x16x64_bf16 v[52:55], v[16:19], a[112:119], v5
    buffer_load_dwordx4 v1, s[44:47], s24 offen offset:2048 sc1 lds
    v_smfmac_f32_16x16x64_bf16 v[44:47], v[20:23], a[8:15], v5
    buffer_load_dwordx4 v1, s[44:47], s24 offen offset:3072 sc1 lds
    s_mov_b32 m0, s20
    v_smfmac_f32_16x16x64_bf16 v[48:51], v[20:23], a[64:71], v5
    buffer_load_dwordx4 v1, s[44:47], s16 offen offset:0 sc1 lds
    v_smfmac_f32_16x16x64_bf16 v[52:55], v[20:23], a[120:127], v5
    buffer_load_dwordx4 v1, s[44:47], s16 offen offset:1024 sc1 lds
    v_smfmac_f32_16x16x64_bf16 v[60:63], v[16:19], a[224:231], v5
    buffer_load_dwordx4 v1, s[44:47], s16 offen offset:2048 sc1 lds
    v_smfmac_f32_16x16x64_bf16 v[60:63], v[20:23], a[232:239], v5
    buffer_load_dwordx4 v1, s[44:47], s16 offen offset:3072 sc1 lds
    s_mov_b32 m0, s21
    v_smfmac_f32_16x16x64_bf16 v[64:67], v[16:19], v[144:151], v5
    buffer_load_dwordx4 v1, s[44:47], s17 offen offset:0 sc1 lds
    s_waitcnt lgkmcnt(4)
    v_smfmac_f32_16x16x64_bf16 v[44:47], v[24:27], a[16:23], v5
    buffer_load_dwordx4 v1, s[44:47], s17 offen offset:1024 sc1 lds
    s_waitcnt lgkmcnt(3)
    v_smfmac_f32_16x16x64_bf16 v[44:47], v[28:31], a[24:31], v5
    buffer_load_dwordx4 v1, s[44:47], s17 offen offset:2048 sc1 lds
    s_mov_b32 m0, s22
    s_waitcnt lgkmcnt(2)
    v_smfmac_f32_16x16x64_bf16 v[44:47], v[32:35], a[32:39], v5
    buffer_load_dwordx4 v1, s[44:47], s18 offen offset:0 sc1 lds
    s_waitcnt lgkmcnt(1)
    v_smfmac_f32_16x16x64_bf16 v[44:47], v[36:39], a[40:47], v5
    buffer_load_dwordx4 v1, s[44:47], s18 offen offset:1024 sc1 lds
    s_waitcnt lgkmcnt(0)
    v_smfmac_f32_16x16x64_bf16 v[44:47], v[40:43], a[48:55], v5
    buffer_store_dword v3, v4, s[44:47], s70 offen sc1
    v_smfmac_f32_16x16x64_bf16 v[48:51], v[24:27], a[72:79], v5
    buffer_store_dword v3, v4, s[44:47], s69 offen sc1
    v_smfmac_f32_16x16x64_bf16 v[48:51], v[28:31], a[80:87], v5
    v_smfmac_f32_16x16x64_bf16 v[48:51], v[32:35], a[88:95], v5
    v_smfmac_f32_16x16x64_bf16 v[48:51], v[36:39], a[96:103], v5
    s_nop 1
    v_add_f32 v44, v44, v46
    v_smfmac_f32_16x16x64_bf16 v[48:51], v[40:43], a[104:111], v5
    v_add_f32 v45, v45, v47
    v_smfmac_f32_16x16x64_bf16 v[52:55], v[24:27], a[128:135], v5
    v_cvt_pk_bf16_f32 v44, v44, v45
    v_smfmac_f32_16x16x64_bf16 v[52:55], v[28:31], a[136:143], v5
    ds_write_b32 v6, v44 offset:0
    v_smfmac_f32_16x16x64_bf16 v[52:55], v[32:35], a[144:151], v5
    v_smfmac_f32_16x16x64_bf16 v[52:55], v[36:39], a[152:159], v5
    s_nop 0
    v_add_f32 v48, v48, v50
    v_smfmac_f32_16x16x64_bf16 v[52:55], v[40:43], a[160:167], v5
    v_add_f32 v49, v49, v51
    v_smfmac_f32_16x16x64_bf16 v[56:59], v[24:27], a[184:191], v5
    v_cvt_pk_bf16_f32 v48, v48, v49
    v_smfmac_f32_16x16x64_bf16 v[56:59], v[28:31], a[192:199], v5
    ds_write_b32 v6, v48 offset:256
    v_smfmac_f32_16x16x64_bf16 v[56:59], v[32:35], a[200:207], v5
    s_nop 1
    v_add_f32 v52, v52, v54
    v_smfmac_f32_16x16x64_bf16 v[56:59], v[36:39], a[208:215], v5
    v_add_f32 v53, v53, v55
    v_smfmac_f32_16x16x64_bf16 v[56:59], v[40:43], a[216:223], v5
    v_cvt_pk_bf16_f32 v52, v52, v53
    v_smfmac_f32_16x16x64_bf16 v[56:59], v[16:19], a[168:175], v5
    ds_write_b32 v6, v52 offset:512
    v_smfmac_f32_16x16x64_bf16 v[56:59], v[20:23], a[176:183], v5
    s_nop 7
    v_add_f32 v56, v56, v58
    v_add_f32 v57, v57, v59
    v_cvt_pk_bf16_f32 v56, v56, v57
    ds_write_b32 v6, v56 offset:3072
    s_waitcnt lgkmcnt(1)
    s_barrier
    ds_read_b128 v[44:47], v8 offset:0
    ds_read_b128 v[48:51], v8 offset:1024
    ds_read_b128 v[52:55], v8 offset:2048
    ds_read_b128 v[56:59], v8 offset:3072
    v_smfmac_f32_16x16x64_bf16 v[60:63], v[24:27], a[240:247], v5
    s_waitcnt lgkmcnt(4)
    s_barrier
    s_mov_b32 s83, 0
    s_mov_b32 s98, 0
    v_smfmac_f32_16x16x64_bf16 v[60:63], v[28:31], a[248:255], v5
    v_smfmac_f32_16x16x64_bf16 v[60:63], v[32:35], v[120:127], v5
    v_smfmac_f32_16x16x64_bf16 v[60:63], v[36:39], v[128:135], v5
    s_waitcnt lgkmcnt(2)
    v_smfmac_f32_16x16x64_bf16 v[72:75], v[16:19], v[44:51], v5
    ds_read_b128 v[44:47], v8 offset:4096
    ds_read_b128 v[48:51], v8 offset:5120
    v_smfmac_f32_16x16x64_bf16 v[60:63], v[40:43], v[136:143], v5
    v_smfmac_f32_16x16x64_bf16 v[64:67], v[20:23], v[152:159], v5
    v_smfmac_f32_16x16x64_bf16 v[64:67], v[24:27], v[160:167], v5
    s_waitcnt lgkmcnt(2)
    v_smfmac_f32_16x16x64_bf16 v[72:75], v[20:23], v[52:59], v5
    ds_read_b128 v[52:55], v8 offset:6144
    ds_read_b128 v[56:59], v8 offset:7168
    v_smfmac_f32_16x16x64_bf16 v[64:67], v[28:31], v[168:175], v5
    v_smfmac_f32_16x16x64_bf16 v[64:67], v[32:35], v[176:183], v5
    v_add_f32 v60, v60, v62
    v_smfmac_f32_16x16x64_bf16 v[64:67], v[36:39], v[184:191], v5
    v_add_f32 v61, v61, v63
    s_waitcnt lgkmcnt(2)
    v_smfmac_f32_16x16x64_bf16 v[72:75], v[24:27], v[44:51], v5
    ds_read_b128 v[44:47], v8 offset:8192
    ds_read_b128 v[48:51], v8 offset:9216
    v_smfmac_f32_16x16x64_bf16 v[64:67], v[40:43], v[192:199], v5
    v_cvt_pk_bf16_f32 v104, v60, v61
    v_smfmac_f32_16x16x64_bf16 v[68:71], v[16:19], v[200:207], v5
    v_mov_b32 v60, 0
    s_waitcnt lgkmcnt(2)
    v_smfmac_f32_16x16x64_bf16 v[72:75], v[28:31], v[52:59], v5
    ds_read_b128 v[52:55], v8 offset:10240
    ds_read_b128 v[56:59], v8 offset:11264
    v_smfmac_f32_16x16x64_bf16 v[68:71], v[20:23], v[208:215], v5
    v_mov_b32 v61, 0
    v_smfmac_f32_16x16x64_bf16 v[68:71], v[24:27], v[216:223], v5
    v_mov_b32 v62, 0
    s_waitcnt lgkmcnt(2)
    v_smfmac_f32_16x16x64_bf16 v[72:75], v[32:35], v[44:51], v5
    ds_read_b128 v[44:47], v8 offset:12288
    ds_read_b128 v[48:51], v8 offset:13312
    v_smfmac_f32_16x16x64_bf16 v[68:71], v[28:31], v[224:231], v5
    v_mov_b32 v63, 0
    v_smfmac_f32_16x16x64_bf16 v[68:71], v[32:35], v[232:239], v5
    s_cmp_ge_u32 s100, 64
    s_cbranch_scc0 ch0bs_hl
ch0bs_hs:
    buffer_load_dwordx4 v[76:79], v1, s[44:47], s67 offen offset:0 sc1
    buffer_load_dwordx4 v[84:87], v1, s[44:47], s67 offen offset:2048 sc1
    s_waitcnt lgkmcnt(2)
    v_smfmac_f32_16x16x64_bf16 v[72:75], v[36:39], v[52:59], v5
    v_smfmac_f32_16x16x64_bf16 v[68:71], v[36:39], v[240:247], v5
    v_add_f32 v64, v64, v66
    v_smfmac_f32_16x16x64_bf16 v[68:71], v[40:43], v[248:255], v5
    buffer_load_dwordx4 v[80:83], v1, s[44:47], s67 offen offset:1024 sc1
    buffer_load_dwordx4 v[88:91], v1, s[44:47], s67 offen offset:3072 sc1
    s_waitcnt lgkmcnt(0)
    v_smfmac_f32_16x16x64_bf16 v[72:75], v[40:43], v[44:51], v5
    buffer_load_dwordx4 v[92:95], v10, s[44:47], s67 offen offset:0 sc1
    v_add_f32 v65, v65, v67
    v_cvt_pk_bf16_f32 v105, v64, v65
    s_nop 0
    v_add_f32 v68, v68, v70
    v_add_f32 v69, v69, v71
    v_cvt_pk_bf16_f32 v108, v68, v69
    s_nop 0
    v_add_f32 v72, v72, v74
    v_add_f32 v73, v73, v75
    v_cvt_pk_bf16_f32 v109, v72, v73
    s_waitcnt vmcnt(3)
    ds_read_b128 v[44:47], v1 offset:16384
    ds_read_b128 v[48:51], v1 offset:17408
    ds_read_b128 v[52:55], v1 offset:18432
    ds_read_b128 v[56:59], v1 offset:19456
    s_cbranch_scc0 ch0bs_hu
ch0bs_hv:
    s_cmp_ge_u32 s64, s100
    v_fma_mix_f32 v102, v76, 1.0, v84 op_sel:[0,0,0] op_sel_hi:[1,0,1]
    v_fma_mix_f32 v84, v76, 1.0, v84 op_sel:[1,0,1] op_sel_hi:[1,0,1]
    v_fma_mix_f32 v76, v77, 1.0, v85 op_sel:[0,0,0] op_sel_hi:[1,0,1]
    v_fma_mix_f32 v85, v77, 1.0, v85 op_sel:[1,0,1] op_sel_hi:[1,0,1]
    v_fma_mix_f32 v77, v78, 1.0, v86 op_sel:[0,0,0] op_sel_hi:[1,0,1]
    v_fma_mix_f32 v86, v78, 1.0, v86 op_sel:[1,0,1] op_sel_hi:[1,0,1]
    v_fma_mix_f32 v78, v79, 1.0, v87 op_sel:[0,0,0] op_sel_hi:[1,0,1]
    v_fma_mix_f32 v87, v79, 1.0, v87 op_sel:[1,0,1] op_sel_hi:[1,0,1]
    v_maximum3_f32 v112, v84, v85, v86
    v_cmp_u_f32 vcc, v112, v87
    v_exp_f32 v76, v76
    v_exp_f32 v77, v77
    v_exp_f32 v78, v78
    s_cbranch_vccnz ch0bs_i0
    v_exp_f32 v79, v102
    v_exp_f32 v84, v84
    v_exp_f32 v85, v85
    v_pk_add_f32 v[96:97], v[76:77], v[78:79]
    v_exp_f32 v86, v86
    v_exp_f32 v87, v87
    v_pk_add_f32 v[96:97], v[96:97], v[84:85]
    v_pk_add_f32 v[96:97], v[96:97], v[86:87]
    s_waitcnt vmcnt(1)
    v_fma_mix_f32 v103, v80, 1.0, v88 op_sel:[0,0,0] op_sel_hi:[1,0,1]
    v_fma_mix_f32 v88, v80, 1.0, v88 op_sel:[1,0,1] op_sel_hi:[1,0,1]
    v_fma_mix_f32 v80, v81, 1.0, v89 op_sel:[0,0,0] op_sel_hi:[1,0,1]
    v_fma_mix_f32 v89, v81, 1.0, v89 op_sel:[1,0,1] op_sel_hi:[1,0,1]
    v_fma_mix_f32 v81, v82, 1.0, v90 op_sel:[0,0,0] op_sel_hi:[1,0,1]
    v_fma_mix_f32 v90, v82, 1.0, v90 op_sel:[1,0,1] op_sel_hi:[1,0,1]
    v_fma_mix_f32 v82, v83, 1.0, v91 op_sel:[0,0,0] op_sel_hi:[1,0,1]
    v_fma_mix_f32 v91, v83, 1.0, v91 op_sel:[1,0,1] op_sel_hi:[1,0,1]
    v_maximum3_f32 v114, v88, v89, v90
    v_cmp_u_f32 vcc, v114, v91
    v_exp_f32 v80, v80
    v_exp_f32 v81, v81
    v_exp_f32 v82, v82
    s_cbranch_vccnz ch0bs_i1
    v_exp_f32 v83, v103
    v_exp_f32 v88, v88
    v_exp_f32 v89, v89
    v_pk_add_f32 v[98:99], v[80:81], v[82:83]
    v_exp_f32 v90, v90
    v_exp_f32 v91, v91
    v_pk_add_f32 v[98:99], v[98:99], v[88:89]
    v_pk_add_f32 v[98:99], v[98:99], v[90:91]
    s_cbranch_scc1 ch0bs_nw
ch0bs_nw2:
    s_mov_b32 m0, 16384
    s_mov_b32 s98, 1
    s_waitcnt vmcnt(0) lgkmcnt(0)
    buffer_load_dwordx4 v1, s[44:47], s71 offen offset:0 sc1 lds
    buffer_load_dwordx4 v1, s[44:47], s71 offen offset:1024 sc1 lds
    v_fma_mix_f32 v113, v92, 1.0, v94 op_sel:[0,0,0] op_sel_hi:[1,0,1]
    v_fma_mix_f32 v94, v92, 1.0, v94 op_sel:[1,0,1] op_sel_hi:[1,0,1]
    v_fma_mix_f32 v92, v93, 1.0, v95 op_sel:[0,0,0] op_sel_hi:[1,0,1]
    v_fma_mix_f32 v95, v93, 1.0, v95 op_sel:[1,0,1] op_sel_hi:[1,0,1]
    v_cmp_u_f32 vcc, v94, v95
    v_exp_f32 v92, v92
    v_exp_f32 v93, v113
    v_exp_f32 v94, v94
    s_cbranch_vccnz ch0bs_i2
    v_exp_f32 v95, v95
    s_nop 0
    v_pk_add_f32 v[100:101], v[92:93], v[94:95]
ch0bs_w2d:
    v_pk_add_f32 v[96:97], v[96:97], v[98:99]
    v_pk_add_f32 v[96:97], v[96:97], v[100:101]
    v_add_f32 v2, v96, v97
    v_add_f32 v15, v96, v97
    s_nop 1
    v_permlane16_swap_b32 v2, v15
    v_add_f32 v2, v2, v15
    v_subrev_u32 v15, 0x17800000, v2
    v_rcp_f32 v2, v2
    v_cmp_le_u32 vcc, 0x5a000000, v15
    s_waitcnt lgkmcnt(0)
    v_pk_mul_f32 v[92:93], v[92:93], v[2:3] op_sel_hi:[1,0]
    v_pk_mul_f32 v[94:95], v[94:95], v[2:3] op_sel_hi:[1,0]
    v_cvt_pk_bf16_f32 v116, v93, v94
    v_cvt_pk_bf16_f32 v118, v92, v95
    s_cbranch_vccnz ch0bs_fb
    v_pk_mul_f32 v[76:77], v[76:77], v[2:3] op_sel_hi:[1,0]
    v_pk_mul_f32 v[78:79], v[78:79], v[2:3] op_sel_hi:[1,0]
    v_pk_mul_f32 v[84:85], v[84:85], v[2:3] op_sel_hi:[1,0]
    v_pk_mul_f32 v[86:87], v[86:87], v[2:3] op_sel_hi:[1,0]
    v_cvt_pk_bf16_f32 v96, v79, v84
    v_cvt_pk_bf16_f32 v97, v76, v85
    v_cvt_pk_bf16_f32 v98, v77, v86
    v_cvt_pk_bf16_f32 v99, v78, v87
    v_pk_mul_f32 v[80:81], v[80:81], v[2:3] op_sel_hi:[1,0]
    v_pk_mul_f32 v[82:83], v[82:83], v[2:3] op_sel_hi:[1,0]
    v_pk_mul_f32 v[88:89], v[88:89], v[2:3] op_sel_hi:[1,0]
    v_pk_mul_f32 v[90:91], v[90:91], v[2:3] op_sel_hi:[1,0]
    v_smfmac_f32_16x16x64_bf16 v[60:63], v[116:119], v[104:111], v5
    v_cvt_pk_bf16_f32 v100, v83, v88
    v_cvt_pk_bf16_f32 v101, v80, v89
    v_smfmac_f32_16x16x64_bf16 v[60:63], v[96:99], v[44:51], v5
    v_cvt_pk_bf16_f32 v102, v81, v90
    v_cvt_pk_bf16_f32 v103, v82, v91
    s_nop 1
    v_smfmac_f32_16x16x64_bf16 v[60:63], v[100:103], v[52:59], v5
ch0bs_kj:
    v_mov_b32 v44, 0
    v_mov_b32 v45, 0
    v_mov_b32 v46, 0
    v_mov_b32 v47, 0
    s_nop 3
    v_add_f32 v60, v60, v62
    v_add_f32 v61, v61, v63
    ds_write2_b32 v11, v60, v61 offset0:0 offset1:16
    v_mov_b32 v48, 0
    v_mov_b32 v49, 0
    v_mov_b32 v50, 0
    v_mov_b32 v51, 0
    v_mov_b32 v52, 0
    v_mov_b32 v53, 0
    v_mov_b32 v54, 0
    v_mov_b32 v55, 0
    v_mov_b32 v56, 0
    v_mov_b32 v57, 0
    v_mov_b32 v58, 0
    v_mov_b32 v59, 0
    v_mov_b32 v112, 0
    v_mov_b32 v113, 0
    v_mov_b32 v114, 0
    v_mov_b32 v115, 0
    s_waitcnt lgkmcnt(0)
    s_barrier
    ds_read2_b64 v[64:67], v12 offset0:0 offset1:64
    ds_read2_b64 v[68:71], v12 offset0:128 offset1:192
    s_waitcnt lgkmcnt(0)
    v_pk_add_f32 v[64:65], v[64:65], v[66:67]
    v_pk_add_f32 v[68:69], v[68:69], v[70:71]
    v_pk_add_f32 v[64:65], v[64:65], v[68:69]
    v_cvt_pk_bf16_f32 v15, v64, v65
    v_min_u32 v15, -2, v15
    buffer_store_dword v15, v13, s[44:47], s68 offen sc1
    s_barrier
    s_add_u32 s64, s64, 1
    s_cmp_lt_u32 s64, 63
    s_cbranch_scc1 ch0bs_loop
    s_lshl_b32 s8, s82, 8
    s_add_u32 s8, s8, 92266496
    buffer_store_dword v15, v13, s[44:47], s8 offen sc1
    s_and_b32 s8, s64, 3
    s_lshl_b32 s65, s8, 13
    s_add_u32 s65, s65, 94896128
    v_mov_b32 v60, 0
    v_mov_b32 v61, 0
    v_mov_b32 v62, 0
    v_mov_b32 v63, 0
    v_mov_b32 v64, 0
    v_mov_b32 v65, 0
    v_mov_b32 v66, 0
    v_mov_b32 v67, 0
    v_mov_b32 v68, 0
    v_mov_b32 v69, 0
    v_mov_b32 v70, 0
    v_mov_b32 v71, 0
    v_mov_b32 v72, 0
    v_mov_b32 v73, 0
    v_mov_b32 v74, 0
    v_mov_b32 v75, 0
    buffer_load_dwordx4 v[76:79], v1, s[44:47], s65 offen offset:0 sc1
    buffer_load_dwordx4 v[80:83], v1, s[44:47], s65 offen offset:1024 sc1
    s_mov_b32 s83, 0
ch0bst_mp:
    buffer_load_dwordx4 v[16:19], v1, s[44:47], s65 offen offset:0 sc1
    buffer_load_dwordx4 v[20:23], v1, s[44:47], s65 offen offset:1024 sc1
    s_waitcnt vmcnt(3)
    v_max3_u32 v2, v76, v77, v78
    s_waitcnt vmcnt(2)
    v_max3_u32 v2, v2, v79, v80
    v_max3_u32 v2, v2, v81, v82
    v_max_u32 v2, v2, v83
    v_cmp_eq_u32 vcc, -1, v2
    s_cbranch_vccz ch0bst_g1
    buffer_load_dwordx4 v[76:79], v1, s[44:47], s65 offen offset:0 sc1
    buffer_load_dwordx4 v[80:83], v1, s[44:47], s65 offen offset:1024 sc1
    s_add_u32 s83, s83, 1
    s_cmp_ge_u32 s83, 2000000
    s_cbranch_scc1 chain_abort
    s_waitcnt vmcnt(3)
    v_max3_u32 v2, v16, v17, v18
    s_waitcnt vmcnt(2)
    v_max3_u32 v2, v2, v19, v20
    v_max3_u32 v2, v2, v21, v22
    v_max_u32 v2, v2, v23
    v_cmp_eq_u32 vcc, -1, v2
    s_cbranch_vccnz ch0bst_mp
ch0bst_g1:
    s_waitcnt vmcnt(0)
    ds_write_b128 v1, v[16:19] offset:0
    ds_write_b128 v1, v[20:23] offset:1024
    s_waitcnt lgkmcnt(0)
    s_barrier
    ds_read_b128 v[24:27], v1 offset:2048
    ds_read_b128 v[28:31], v1 offset:3072
    ds_read_b128 v[32:35], v1 offset:4096
    ds_read_b128 v[36:39], v1 offset:5120
    ds_read_b128 v[40:43], v1 offset:6144
    s_waitcnt lgkmcnt(0)
    ds_read_b128 v[44:47], v8 offset:0
    ds_read_b128 v[48:51], v8 offset:1024
    ds_read_b128 v[52:55], v8 offset:2048
    ds_read_b128 v[56:59], v8 offset:3072
    v_smfmac_f32_16x16x64_bf16 v[60:63], v[16:19], a[224:231], v5
    v_smfmac_f32_16x16x64_bf16 v[60:63], v[20:23], a[232:239], v5
    v_smfmac_f32_16x16x64_bf16 v[60:63], v[24:27], a[240:247], v5
    s_waitcnt lgkmcnt(2)
    v_smfmac_f32_16x16x64_bf16 v[72:75], v[16:19], v[44:51], v5
    ds_read_b128 v[44:47], v8 offset:4096
    ds_read_b128 v[48:51], v8 offset:5120
    v_smfmac_f32_16x16x64_bf16 v[60:63], v[28:31], a[248:255], v5
    v_smfmac_f32_16x16x64_bf16 v[60:63], v[32:35], v[120:127], v5
    v_smfmac_f32_16x16x64_bf16 v[60:63], v[36:39], v[128:135], v5
    s_waitcnt lgkmcnt(2)
    v_smfmac_f32_16x16x64_bf16 v[72:75], v[20:23], v[52:59], v5
    ds_read_b128 v[52:55], v8 offset:6144
    ds_read_b128 v[56:59], v8 offset:7168
    v_smfmac_f32_16x16x64_bf16 v[60:63], v[40:43], v[136:143], v5
    v_smfmac_f32_16x16x64_bf16 v[64:67], v[16:19], v[144:151], v5
    v_smfmac_f32_16x16x64_bf16 v[64:67], v[20:23], v[152:159], v5
    s_waitcnt lgkmcnt(2)
    v_smfmac_f32_16x16x64_bf16 v[72:75], v[24:27], v[44:51], v5
    ds_read_b128 v[44:47], v8 offset:8192
    ds_read_b128 v[48:51], v8 offset:9216
    v_smfmac_f32_16x16x64_bf16 v[64:67], v[24:27], v[160:167], v5
    v_smfmac_f32_16x16x64_bf16 v[64:67], v[28:31], v[168:175], v5
    v_add_f32 v60, v60, v62
    v_smfmac_f32_16x16x64_bf16 v[64:67], v[32:35], v[176:183], v5
    v_add_f32 v61, v61, v63
    s_waitcnt lgkmcnt(2)
    v_smfmac_f32_16x16x64_bf16 v[72:75], v[28:31], v[52:59], v5
    ds_read_b128 v[52:55], v8 offset:10240
    ds_read_b128 v[56:59], v8 offset:11264
    v_smfmac_f32_16x16x64_bf16 v[64:67], v[36:39], v[184:191], v5
    v_cvt_pk_bf16_f32 v104, v60, v61
    v_smfmac_f32_16x16x64_bf16 v[64:67], v[40:43], v[192:199], v5
    v_mov_b32 v60, 0
    v_smfmac_f32_16x16x64_bf16 v[68:71], v[16:19], v[200:207], v5
    v_mov_b32 v61, 0
    s_waitcnt lgkmcnt(2)
    v_smfmac_f32_16x16x64_bf16 v[72:75], v[32:35], v[44:51], v5
    ds_read_b128 v[44:47], v8 offset:12288
    ds_read_b128 v[48:51], v8 offset:13312
    v_smfmac_f32_16x16x64_bf16 v[68:71], v[20:23], v[208:215], v5
    v_mov_b32 v62, 0
    v_smfmac_f32_16x16x64_bf16 v[68:71], v[24:27], v[216:223], v5
    v_mov_b32 v63, 0
    v_smfmac_f32_16x16x64_bf16 v[68:71], v[28:31], v[224:231], v5
    v_add_f32 v64, v64, v66
    s_waitcnt lgkmcnt(2)
    v_smfmac_f32_16x16x64_bf16 v[72:75], v[36:39], v[52:59], v5
    v_smfmac_f32_16x16x64_bf16 v[68:71], v[32:35], v[232:239], v5
    v_add_f32 v65, v65, v67
    v_smfmac_f32_16x16x64_bf16 v[68:71], v[36:39], v[240:247], v5
    v_cvt_pk_bf16_f32 v105, v64, v65
    v_smfmac_f32_16x16x64_bf16 v[68:71], v[40:43], v[248:255], v5
    s_waitcnt lgkmcnt(0)
    v_smfmac_f32_16x16x64_bf16 v[72:75], v[40:43], v[44:51], v5
    s_nop 5
    v_add_f32 v68, v68, v70
    v_add_f32 v69, v69, v71
    v_cvt_pk_bf16_f32 v108, v68, v69
    v_add_f32 v72, v72, v74
    v_add_f32 v73, v73, v75
    v_cvt_pk_bf16_f32 v109, v72, v73
    v_mov_b32 v106, v108
    v_mov_b32 v107, v109
    s_lshl_b32 s8, s82, 12
    s_add_u32 s8, s8, 91635712
    buffer_store_dwordx4 v[104:107], v1, s[44:47], s8 offen sc1
    s_waitcnt vmcnt(0)
    s_barrier
    s_mov_b32 s8, 95072128
    s_mov_b64 exec, 1
    v_mov_b32 v2, 1
    buffer_atomic_add v2, off, s[44:47], s8 sc1
    s_mov_b64 exec, -1
    s_endpgm
ch0bs_mp1:
    buffer_load_dwordx4 v[20:23], v1, s[44:47], s65 offen offset:1024 sc1
    s_add_u32 s83, s83, 1
    s_cmp_ge_u32 s83, 2000000
    s_cbranch_scc1 chain_abort
    s_waitcnt vmcnt(1)
    v_max3_u32 v2, v20, v21, v22
    v_max_u32 v2, v2, v23
    v_cmp_eq_u32 vcc, -1, v2
    s_cbranch_vccnz ch0bs_mp1
    s_branch ch0bs_mok
ch0bs_m0bad:
    s_cbranch_vccnz ch0bs_mp
ch0bs_mp0:
    buffer_load_dwordx4 v[16:19], v1, s[44:47], s65 offen offset:0 sc1
    s_add_u32 s83, s83, 1
    s_cmp_ge_u32 s83, 2000000
    s_cbranch_scc1 chain_abort
    s_waitcnt vmcnt(1)
    v_max3_u32 v2, v16, v17, v18
    v_max_u32 v2, v2, v19
    v_cmp_eq_u32 vcc, -1, v2
    s_cbranch_vccnz ch0bs_mp0
    s_branch ch0bs_mok
ch0bs_hl:
    buffer_load_dword v15, off, s[44:47], s73 sc1
    s_branch ch0bs_hs
ch0bs_hu:
    v_readfirstlane_b32 s9, v15
    s_max_u32 s100, s100, s9
    s_branch ch0bs_hv
ch0bs_nw:
    v_lshlrev_b32 v100, 7, v0
    s_mov_b32 s99, 0
hz_182:
    buffer_load_dword v101, v100, s[44:47], s75 offen sc1
    s_waitcnt vmcnt(0)
    v_cmp_gt_u32 vcc, 28, v101
    s_ff1_i32_b64 s100, vcc
    s_cmp_eq_u32 s100, -1
    s_cselect_b32 s100, 65, s100
    s_sub_u32 s100, s100, 1
    s_cmp_gt_i32 s100, s64
    s_cbranch_scc1 hd_183
    s_sleep 1
    s_add_u32 s99, s99, 1
    s_cmp_lt_u32 s99, 400000
    s_cbranch_scc1 hz_182
    s_branch chain_abort
hd_183:
    s_branch ch0bs_nw2
ch0bs_k0:
    s_cmp_eq_u32 s98, 1
    s_cbranch_scc1 ch0bs_w2d
    s_cmp_ge_u32 s64, s100
    s_cbranch_scc1 ch0bs_vw
ch0bs_vok:
    s_mov_b32 m0, 16384
    s_waitcnt lgkmcnt(0)
    buffer_load_dwordx4 v1, s[44:47], s71 offen offset:0 sc1 lds
    buffer_load_dwordx4 v1, s[44:47], s71 offen offset:1024 sc1 lds
    s_branch ch0bs_w2d
ch0bs_i0:
    buffer_load_dwordx4 v[76:79], v1, s[44:47], s67 offen offset:0 sc1
    buffer_load_dwordx4 v[84:87], v1, s[44:47], s67 offen offset:2048 sc1
    s_add_u32 s83, s83, 1
    s_branch ch0bs_q120
ch0bs_i1:
    buffer_load_dwordx4 v[80:83], v1, s[44:47], s67 offen offset:1024 sc1
    buffer_load_dwordx4 v[88:91], v1, s[44:47], s67 offen offset:3072 sc1
    s_add_u32 s83, s83, 1
    s_branch ch0bs_q21
ch0bs_i2:
    buffer_load_dwordx4 v[92:95], v10, s[44:47], s67 offen offset:0 sc1
    s_add_u32 s83, s83, 1
    s_branch ch0bs_q2
ch0bs_q0:
    s_waitcnt vmcnt(0)
    v_fma_mix_f32 v102, v76, 1.0, v84 op_sel:[0,0,0] op_sel_hi:[1,0,1]
    v_fma_mix_f32 v84, v76, 1.0, v84 op_sel:[1,0,1] op_sel_hi:[1,0,1]
    v_fma_mix_f32 v76, v77, 1.0, v85 op_sel:[0,0,0] op_sel_hi:[1,0,1]
    v_fma_mix_f32 v85, v77, 1.0, v85 op_sel:[1,0,1] op_sel_hi:[1,0,1]
    v_fma_mix_f32 v77, v78, 1.0, v86 op_sel:[0,0,0] op_sel_hi:[1,0,1]
    v_fma_mix_f32 v86, v78, 1.0, v86 op_sel:[1,0,1] op_sel_hi:[1,0,1]
    v_fma_mix_f32 v78, v79, 1.0, v87 op_sel:[0,0,0] op_sel_hi:[1,0,1]
    v_fma_mix_f32 v87, v79, 1.0, v87 op_sel:[1,0,1] op_sel_hi:[1,0,1]
    v_maximum3_f32 v112, v84, v85, v86
    v_cmp_u_f32 vcc, v112, v87
    v_exp_f32 v76, v76
    v_exp_f32 v77, v77
    v_exp_f32 v78, v78
    s_cbranch_vccnz ch0bs_q0_e
    v_exp_f32 v79, v102
    v_exp_f32 v84, v84
    v_exp_f32 v85, v85
    v_pk_add_f32 v[96:97], v[76:77], v[78:79]
    v_exp_f32 v86, v86
    v_exp_f32 v87, v87
    v_pk_add_f32 v[96:97], v[96:97], v[84:85]
    v_pk_add_f32 v[96:97], v[96:97], v[86:87]
    s_branch ch0bs_k0
ch0bs_q0_e:
    buffer_load_dwordx4 v[76:79], v1, s[44:47], s67 offen offset:0 sc1
    buffer_load_dwordx4 v[84:87], v1, s[44:47], s67 offen offset:2048 sc1
    s_add_u32 s83, s83, 1
    s_and_b32 s8, s83, 63
    s_cmp_eq_u32 s8, 0
    s_cbranch_scc1 ch0bs_x
    s_branch ch0bs_q0
ch0bs_q1:
    s_waitcnt vmcnt(0)
    v_fma_mix_f32 v103, v80, 1.0, v88 op_sel:[0,0,0] op_sel_hi:[1,0,1]
    v_fma_mix_f32 v88, v80, 1.0, v88 op_sel:[1,0,1] op_sel_hi:[1,0,1]
    v_fma_mix_f32 v80, v81, 1.0, v89 op_sel:[0,0,0] op_sel_hi:[1,0,1]
    v_fma_mix_f32 v89, v81, 1.0, v89 op_sel:[1,0,1] op_sel_hi:[1,0,1]
    v_fma_mix_f32 v81, v82, 1.0, v90 op_sel:[0,0,0] op_sel_hi:[1,0,1]
    v_fma_mix_f32 v90, v82, 1.0, v90 op_sel:[1,0,1] op_sel_hi:[1,0,1]
    v_fma_mix_f32 v82, v83, 1.0, v91 op_sel:[0,0,0] op_sel_hi:[1,0,1]
    v_fma_mix_f32 v91, v83, 1.0, v91 op_sel:[1,0,1] op_sel_hi:[1,0,1]
    v_maximum3_f32 v114, v88, v89, v90
    v_cmp_u_f32 vcc, v114, v91
    v_exp_f32 v80, v80
    v_exp_f32 v81, v81
    v_exp_f32 v82, v82
    s_cbranch_vccnz ch0bs_q1_e
    v_exp_f32 v83, v103
    v_exp_f32 v88, v88
    v_exp_f32 v89, v89
    v_pk_add_f32 v[98:99], v[80:81], v[82:83]
    v_exp_f32 v90, v90
    v_exp_f32 v91, v91
    v_pk_add_f32 v[98:99], v[98:99], v[88:89]
    v_pk_add_f32 v[98:99], v[98:99], v[90:91]
    s_branch ch0bs_k0
ch0bs_q1_e:
    buffer_load_dwordx4 v[80:83], v1, s[44:47], s67 offen offset:1024 sc1
    buffer_load_dwordx4 v[88:91], v1, s[44:47], s67 offen offset:3072 sc1
    s_add_u32 s83, s83, 1
    s_and_b32 s8, s83, 63
    s_cmp_eq_u32 s8, 0
    s_cbranch_scc1 ch0bs_x
    s_branch ch0bs_q1
ch0bs_q2:
    s_waitcnt vmcnt(0)
    v_fma_mix_f32 v113, v92, 1.0, v94 op_sel:[0,0,0] op_sel_hi:[1,0,1]
    v_fma_mix_f32 v94, v92, 1.0, v94 op_sel:[1,0,1] op_sel_hi:[1,0,1]
    v_fma_mix_f32 v92, v93, 1.0, v95 op_sel:[0,0,0] op_sel_hi:[1,0,1]
    v_fma_mix_f32 v95, v93, 1.0, v95 op_sel:[1,0,1] op_sel_hi:[1,0,1]
    v_cmp_u_f32 vcc, v94, v95
    v_exp_f32 v92, v92
    v_exp_f32 v93, v113
    v_exp_f32 v94, v94
    s_cbranch_vccnz ch0bs_q2_e
    v_exp_f32 v95, v95
    s_nop 0
    v_pk_add_f32 v[100:101], v[92:93], v[94:95]
    s_branch ch0bs_k0
ch0bs_q2_e:
    buffer_load_dwordx4 v[92:95], v10, s[44:47], s67 offen offset:0 sc1
    s_add_u32 s83, s83, 1
    s_and_b32 s8, s83, 63
    s_cmp_eq_u32 s8, 0
    s_cbranch_scc1 ch0bs_x
    s_branch ch0bs_q2
ch0bs_q01:
    s_waitcnt vmcnt(2)
    v_fma_mix_f32 v102, v76, 1.0, v84 op_sel:[0,0,0] op_sel_hi:[1,0,1]
    v_fma_mix_f32 v84, v76, 1.0, v84 op_sel:[1,0,1] op_sel_hi:[1,0,1]
    v_fma_mix_f32 v76, v77, 1.0, v85 op_sel:[0,0,0] op_sel_hi:[1,0,1]
    v_fma_mix_f32 v85, v77, 1.0, v85 op_sel:[1,0,1] op_sel_hi:[1,0,1]
    v_fma_mix_f32 v77, v78, 1.0, v86 op_sel:[0,0,0] op_sel_hi:[1,0,1]
    v_fma_mix_f32 v86, v78, 1.0, v86 op_sel:[1,0,1] op_sel_hi:[1,0,1]
    v_fma_mix_f32 v78, v79, 1.0, v87 op_sel:[0,0,0] op_sel_hi:[1,0,1]
    v_fma_mix_f32 v87, v79, 1.0, v87 op_sel:[1,0,1] op_sel_hi:[1,0,1]
    v_maximum3_f32 v112, v84, v85, v86
    v_cmp_u_f32 vcc, v112, v87
    v_exp_f32 v76, v76
    v_exp_f32 v77, v77
    v_exp_f32 v78, v78
    s_cbranch_vccnz ch0bs_q01_e
    v_exp_f32 v79, v102
    v_exp_f32 v84, v84
    v_exp_f32 v85, v85
    v_pk_add_f32 v[96:97], v[76:77], v[78:79]
    v_exp_f32 v86, v86
    v_exp_f32 v87, v87
    v_pk_add_f32 v[96:97], v[96:97], v[84:85]
    v_pk_add_f32 v[96:97], v[96:97], v[86:87]
    s_branch ch0bs_q1
ch0bs_q01_e:
    buffer_load_dwordx4 v[76:79], v1, s[44:47], s67 offen offset:0 sc1
    buffer_load_dwordx4 v[84:87], v1, s[44:47], s67 offen offset:2048 sc1
    s_add_u32 s83, s83, 1
    s_and_b32 s8, s83, 63
    s_cmp_eq_u32 s8, 0
    s_cbranch_scc1 ch0bs_x
    s_branch ch0bs_q10
ch0bs_q02:
    s_waitcnt vmcnt(1)
    v_fma_mix_f32 v102, v76, 1.0, v84 op_sel:[0,0,0] op_sel_hi:[1,0,1]
    v_fma_mix_f32 v84, v76, 1.0, v84 op_sel:[1,0,1] op_sel_hi:[1,0,1]
    v_fma_mix_f32 v76, v77, 1.0, v85 op_sel:[0,0,0] op_sel_hi:[1,0,1]
    v_fma_mix_f32 v85, v77, 1.0, v85 op_sel:[1,0,1] op_sel_hi:[1,0,1]
    v_fma_mix_f32 v77, v78, 1.0, v86 op_sel:[0,0,0] op_sel_hi:[1,0,1]
    v_fma_mix_f32 v86, v78, 1.0, v86 op_sel:[1,0,1] op_sel_hi:[1,0,1]
    v_fma_mix_f32 v78, v79, 1.0, v87 op_sel:[0,0,0] op_sel_hi:[1,0,1]
    v_fma_mix_f32 v87, v79, 1.0, v87 op_sel:[1,0,1] op_sel_hi:[1,0,1]
    v_maximum3_f32 v112, v84, v85, v86
    v_cmp_u_f32 vcc, v112, v87
    v_exp_f32 v76, v76
    v_exp_f32 v77, v77
    v_exp_f32 v78, v78
    s_cbranch_vccnz ch0bs_q02_e
    v_exp_f32 v79, v102
    v_exp_f32 v84, v84
    v_exp_f32 v85, v85
    v_pk_add_f32 v[96:97], v[76:77], v[78:79]
    v_exp_f32 v86, v86
    v_exp_f32 v87, v87
    v_pk_add_f32 v[96:97], v[96:97], v[84:85]
    v_pk_add_f32 v[96:97], v[96:97], v[86:87]
    s_branch ch0bs_q2
ch0bs_q02_e:
    buffer_load_dwordx4 v[76:79], v1, s[44:47], s67 offen offset:0 sc1
    buffer_load_dwordx4 v[84:87], v1, s[44:47], s67 offen offset:2048 sc1
    s_add_u32 s83, s83, 1
    s_and_b32 s8, s83, 63
    s_cmp_eq_u32 s8, 0
    s_cbranch_scc1 ch0bs_x
    s_branch ch0bs_q20
ch0bs_q10:
    s_waitcnt vmcnt(2)
    v_fma_mix_f32 v103, v80, 1.0, v88 op_sel:[0,0,0] op_sel_hi:[1,0,1]
    v_fma_mix_f32 v88, v80, 1.0, v88 op_sel:[1,0,1] op_sel_hi:[1,0,1]
    v_fma_mix_f32 v80, v81, 1.0, v89 op_sel:[0,0,0] op_sel_hi:[1,0,1]
    v_fma_mix_f32 v89, v81, 1.0, v89 op_sel:[1,0,1] op_sel_hi:[1,0,1]
    v_fma_mix_f32 v81, v82, 1.0, v90 op_sel:[0,0,0] op_sel_hi:[1,0,1]
    v_fma_mix_f32 v90, v82, 1.0, v90 op_sel:[1,0,1] op_sel_hi:[1,0,1]
    v_fma_mix_f32 v82, v83, 1.0, v91 op_sel:[0,0,0] op_sel_hi:[1,0,1]
    v_fma_mix_f32 v91, v83, 1.0, v91 op_sel:[1,0,1] op_sel_hi:[1,0,1]
    v_maximum3_f32 v114, v88, v89, v90
    v_cmp_u_f32 vcc, v114, v91
    v_exp_f32 v80, v80
    v_exp_f32 v81, v81
    v_exp_f32 v82, v82
    s_cbranch_vccnz ch0bs_q10_e
    v_exp_f32 v83, v103
    v_exp_f32 v88, v88
    v_exp_f32 v89, v89
    v_pk_add_f32 v[98:99], v[80:81], v[82:83]
    v_exp_f32 v90, v90
    v_exp_f32 v91, v91
    v_pk_add_f32 v[98:99], v[98:99], v[88:89]
    v_pk_add_f32 v[98:99], v[98:99], v[90:91]
    s_branch ch0bs_q0
ch0bs_q10_e:
    buffer_load_dwordx4 v[80:83], v1, s[44:47], s67 offen offset:1024 sc1
    buffer_load_dwordx4 v[88:91], v1, s[44:47], s67 offen offset:3072 sc1
    s_add_u32 s83, s83, 1
    s_and_b32 s8, s83, 63
    s_cmp_eq_u32 s8, 0
    s_cbranch_scc1 ch0bs_x
    s_branch ch0bs_q01
ch0bs_q12:
    s_waitcnt vmcnt(1)
    v_fma_mix_f32 v103, v80, 1.0, v88 op_sel:[0,0,0] op_sel_hi:[1,0,1]
    v_fma_mix_f32 v88, v80, 1.0, v88 op_sel:[1,0,1] op_sel_hi:[1,0,1]
    v_fma_mix_f32 v80, v81, 1.0, v89 op_sel:[0,0,0] op_sel_hi:[1,0,1]
    v_fma_mix_f32 v89, v81, 1.0, v89 op_sel:[1,0,1] op_sel_hi:[1,0,1]
    v_fma_mix_f32 v81, v82, 1.0, v90 op_sel:[0,0,0] op_sel_hi:[1,0,1]
    v_fma_mix_f32 v90, v82, 1.0, v90 op_sel:[1,0,1] op_sel_hi:[1,0,1]
    v_fma_mix_f32 v82, v83, 1.0, v91 op_sel:[0,0,0] op_sel_hi:[1,0,1]
    v_fma_mix_f32 v91, v83, 1.0, v91 op_sel:[1,0,1] op_sel_hi:[1,0,1]
    v_maximum3_f32 v114, v88, v89, v90
    v_cmp_u_f32 vcc, v114, v91
    v_exp_f32 v80, v80
    v_exp_f32 v81, v81
    v_exp_f32 v82, v82
    s_cbranch_vccnz ch0bs_q12_e
    v_exp_f32 v83, v103
    v_exp_f32 v88, v88
    v_exp_f32 v89, v89
    v_pk_add_f32 v[98:99], v[80:81], v[82:83]
    v_exp_f32 v90, v90
    v_exp_f32 v91, v91
    v_pk_add_f32 v[98:99], v[98:99], v[88:89]
    v_pk_add_f32 v[98:99], v[98:99], v[90:91]
    s_branch ch0bs_q2
ch0bs_q12_e:
    buffer_load_dwordx4 v[80:83], v1, s[44:47], s67 offen offset:1024 sc1
    buffer_load_dwordx4 v[88:91], v1, s[44:47], s67 offen offset:3072 sc1
    s_add_u32 s83, s83, 1
    s_and_b32 s8, s83, 63
    s_cmp_eq_u32 s8, 0
    s_cbranch_scc1 ch0bs_x
    s_branch ch0bs_q21
ch0bs_q20:
    s_waitcnt vmcnt(2)
    v_fma_mix_f32 v113, v92, 1.0, v94 op_sel:[0,0,0] op_sel_hi:[1,0,1]
    v_fma_mix_f32 v94, v92, 1.0, v94 op_sel:[1,0,1] op_sel_hi:[1,0,1]
    v_fma_mix_f32 v92, v93, 1.0, v95 op_sel:[0,0,0] op_sel_hi:[1,0,1]
    v_fma_mix_f32 v95, v93, 1.0, v95 op_sel:[1,0,1] op_sel_hi:[1,0,1]
    v_cmp_u_f32 vcc, v94, v95
    v_exp_f32 v92, v92
    v_exp_f32 v93, v113
    v_exp_f32 v94, v94
    s_cbranch_vccnz ch0bs_q20_e
    v_exp_f32 v95, v95
    s_nop 0
    v_pk_add_f32 v[100:101], v[92:93], v[94:95]
    s_branch ch0bs_q0
ch0bs_q20_e:
    buffer_load_dwordx4 v[92:95], v10, s[44:47], s67 offen offset:0 sc1
    s_add_u32 s83, s83, 1
    s_and_b32 s8, s83, 63
    s_cmp_eq_u32 s8, 0
    s_cbranch_scc1 ch0bs_x
    s_branch ch0bs_q02
ch0bs_q21:
    s_waitcnt vmcnt(2)
    v_fma_mix_f32 v113, v92, 1.0, v94 op_sel:[0,0,0] op_sel_hi:[1,0,1]
    v_fma_mix_f32 v94, v92, 1.0, v94 op_sel:[1,0,1] op_sel_hi:[1,0,1]
    v_fma_mix_f32 v92, v93, 1.0, v95 op_sel:[0,0,0] op_sel_hi:[1,0,1]
    v_fma_mix_f32 v95, v93, 1.0, v95 op_sel:[1,0,1] op_sel_hi:[1,0,1]
    v_cmp_u_f32 vcc, v94, v95
    v_exp_f32 v92, v92
    v_exp_f32 v93, v113
    v_exp_f32 v94, v94
    s_cbranch_vccnz ch0bs_q21_e
    v_exp_f32 v95, v95
    s_nop 0
    v_pk_add_f32 v[100:101], v[92:93], v[94:95]
    s_branch ch0bs_q1
ch0bs_q21_e:
    buffer_load_dwordx4 v[92:95], v10, s[44:47], s67 offen offset:0 sc1
    s_add_u32 s83, s83, 1
    s_and_b32 s8, s83, 63
    s_cmp_eq_u32 s8, 0
    s_cbranch_scc1 ch0bs_x
    s_branch ch0bs_q12
ch0bs_q012:
    s_waitcnt vmcnt(3)
    v_fma_mix_f32 v102, v76, 1.0, v84 op_sel:[0,0,0] op_sel_hi:[1,0,1]
    v_fma_mix_f32 v84, v76, 1.0, v84 op_sel:[1,0,1] op_sel_hi:[1,0,1]
    v_fma_mix_f32 v76, v77, 1.0, v85 op_sel:[0,0,0] op_sel_hi:[1,0,1]
    v_fma_mix_f32 v85, v77, 1.0, v85 op_sel:[1,0,1] op_sel_hi:[1,0,1]
    v_fma_mix_f32 v77, v78, 1.0, v86 op_sel:[0,0,0] op_sel_hi:[1,0,1]
    v_fma_mix_f32 v86, v78, 1.0, v86 op_sel:[1,0,1] op_sel_hi:[1,0,1]
    v_fma_mix_f32 v78, v79, 1.0, v87 op_sel:[0,0,0] op_sel_hi:[1,0,1]
    v_fma_mix_f32 v87, v79, 1.0, v87 op_sel:[1,0,1] op_sel_hi:[1,0,1]
    v_maximum3_f32 v112, v84, v85, v86
    v_cmp_u_f32 vcc, v112, v87
    v_exp_f32 v76, v76
    v_exp_f32 v77, v77
    v_exp_f32 v78, v78
    s_cbranch_vccnz ch0bs_q012_e
    v_exp_f32 v79, v102
    v_exp_f32 v84, v84
    v_exp_f32 v85, v85
    v_pk_add_f32 v[96:97], v[76:77], v[78:79]
    v_exp_f32 v86, v86
    v_exp_f32 v87, v87
    v_pk_add_f32 v[96:97], v[96:97], v[84:85]
    v_pk_add_f32 v[96:97], v[96:97], v[86:87]
    s_branch ch0bs_q12
ch0bs_q012_e:
    buffer_load_dwordx4 v[76:79], v1, s[44:47], s67 offen offset:0 sc1
    buffer_load_dwordx4 v[84:87], v1, s[44:47], s67 offen offset:2048 sc1
    s_add_u32 s83, s83, 1
    s_and_b32 s8, s83, 63
    s_cmp_eq_u32 s8, 0
    s_cbranch_scc1 ch0bs_x
    s_branch ch0bs_q120
ch0bs_q021:
    s_waitcnt vmcnt(3)
    v_fma_mix_f32 v102, v76, 1.0, v84 op_sel:[0,0,0] op_sel_hi:[1,0,1]
    v_fma_mix_f32 v84, v76, 1.0, v84 op_sel:[1,0,1] op_sel_hi:[1,0,1]
    v_fma_mix_f32 v76, v77, 1.0, v85 op_sel:[0,0,0] op_sel_hi:[1,0,1]
    v_fma_mix_f32 v85, v77, 1.0, v85 op_sel:[1,0,1] op_sel_hi:[1,0,1]
    v_fma_mix_f32 v77, v78, 1.0, v86 op_sel:[0,0,0] op_sel_hi:[1,0,1]
    v_fma_mix_f32 v86, v78, 1.0, v86 op_sel:[1,0,1] op_sel_hi:[1,0,1]
    v_fma_mix_f32 v78, v79, 1.0, v87 op_sel:[0,0,0] op_sel_hi:[1,0,1]
    v_fma_mix_f32 v87, v79, 1.0, v87 op_sel:[1,0,1] op_sel_hi:[1,0,1]
    v_maximum3_f32 v112, v84, v85, v86
    v_cmp_u_f32 vcc, v112, v87
    v_exp_f32 v76, v76
    v_exp_f32 v77, v77
    v_exp_f32 v78, v78
    s_cbranch_vccnz ch0bs_q021_e
    v_exp_f32 v79, v102
    v_exp_f32 v84, v84
    v_exp_f32 v85, v85
    v_pk_add_f32 v[96:97], v[76:77], v[78:79]
    v_exp_f32 v86, v86
    v_exp_f32 v87, v87
    v_pk_add_f32 v[96:97], v[96:97], v[84:85]
    v_pk_add_f32 v[96:97], v[96:97], v[86:87]
    s_branch ch0bs_q21
ch0bs_q021_e:
    buffer_load_dwordx4 v[76:79], v1, s[44:47], s67 offen offset:0 sc1
    buffer_load_dwordx4 v[84:87], v1, s[44:47], s67 offen offset:2048 sc1
    s_add_u32 s83, s83, 1
    s_and_b32 s8, s83, 63
    s_cmp_eq_u32 s8, 0
    s_cbranch_scc1 ch0bs_x
    s_branch ch0bs_q210
ch0bs_q102:
    s_waitcnt vmcnt(3)
    v_fma_mix_f32 v103, v80, 1.0, v88 op_sel:[0,0,0] op_sel_hi:[1,0,1]
    v_fma_mix_f32 v88, v80, 1.0, v88 op_sel:[1,0,1] op_sel_hi:[1,0,1]
    v_fma_mix_f32 v80, v81, 1.0, v89 op_sel:[0,0,0] op_sel_hi:[1,0,1]
    v_fma_mix_f32 v89, v81, 1.0, v89 op_sel:[1,0,1] op_sel_hi:[1,0,1]
    v_fma_mix_f32 v81, v82, 1.0, v90 op_sel:[0,0,0] op_sel_hi:[1,0,1]
    v_fma_mix_f32 v90, v82, 1.0, v90 op_sel:[1,0,1] op_sel_hi:[1,0,1]
    v_fma_mix_f32 v82, v83, 1.0, v91 op_sel:[0,0,0] op_sel_hi:[1,0,1]
    v_fma_mix_f32 v91, v83, 1.0, v91 op_sel:[1,0,1] op_sel_hi:[1,0,1]
    v_maximum3_f32 v114, v88, v89, v90
    v_cmp_u_f32 vcc, v114, v91
    v_exp_f32 v80, v80
    v_exp_f32 v81, v81
    v_exp_f32 v82, v82
    s_cbranch_vccnz ch0bs_q102_e
    v_exp_f32 v83, v103
    v_exp_f32 v88, v88
    v_exp_f32 v89, v89
    v_pk_add_f32 v[98:99], v[80:81], v[82:83]
    v_exp_f32 v90, v90
    v_exp_f32 v91, v91
    v_pk_add_f32 v[98:99], v[98:99], v[88:89]
    v_pk_add_f32 v[98:99], v[98:99], v[90:91]
    s_branch ch0bs_q02
ch0bs_q102_e:
    buffer_load_dwordx4 v[80:83], v1, s[44:47], s67 offen offset:1024 sc1
    buffer_load_dwordx4 v[88:91], v1, s[44:47], s67 offen offset:3072 sc1
    s_add_u32 s83, s83, 1
    s_and_b32 s8, s83, 63
    s_cmp_eq_u32 s8, 0
    s_cbranch_scc1 ch0bs_x
    s_branch ch0bs_q021
ch0bs_q120:
    s_waitcnt vmcnt(3)
    v_fma_mix_f32 v103, v80, 1.0, v88 op_sel:[0,0,0] op_sel_hi:[1,0,1]
    v_fma_mix_f32 v88, v80, 1.0, v88 op_sel:[1,0,1] op_sel_hi:[1,0,1]
    v_fma_mix_f32 v80, v81, 1.0, v89 op_sel:[0,0,0] op_sel_hi:[1,0,1]
    v_fma_mix_f32 v89, v81, 1.0, v89 op_sel:[1,0,1] op_sel_hi:[1,0,1]
    v_fma_mix_f32 v81, v82, 1.0, v90 op_sel:[0,0,0] op_sel_hi:[1,0,1]
    v_fma_mix_f32 v90, v82, 1.0, v90 op_sel:[1,0,1] op_sel_hi:[1,0,1]
    v_fma_mix_f32 v82, v83, 1.0, v91 op_sel:[0,0,0] op_sel_hi:[1,0,1]
    v_fma_mix_f32 v91, v83, 1.0, v91 op_sel:[1,0,1] op_sel_hi:[1,0,1]
    v_maximum3_f32 v114, v88, v89, v90
    v_cmp_u_f32 vcc, v114, v91
    v_exp_f32 v80, v80
    v_exp_f32 v81, v81
    v_exp_f32 v82, v82
    s_cbranch_vccnz ch0bs_q120_e
    v_exp_f32 v83, v103
    v_exp_f32 v88, v88
    v_exp_f32 v89, v89
    v_pk_add_f32 v[98:99], v[80:81], v[82:83]
    v_exp_f32 v90, v90
    v_exp_f32 v91, v91
    v_pk_add_f32 v[98:99], v[98:99], v[88:89]
    v_pk_add_f32 v[98:99], v[98:99], v[90:91]
    s_branch ch0bs_q20
ch0bs_q120_e:
    buffer_load_dwordx4 v[80:83], v1, s[44:47], s67 offen offset:1024 sc1
    buffer_load_dwordx4 v[88:91], v1, s[44:47], s67 offen offset:3072 sc1
    s_add_u32 s83, s83, 1
    s_and_b32 s8, s83, 63
    s_cmp_eq_u32 s8, 0
    s_cbranch_scc1 ch0bs_x
    s_branch ch0bs_q201
ch0bs_q201:
    s_waitcnt vmcnt(4)
    v_fma_mix_f32 v113, v92, 1.0, v94 op_sel:[0,0,0] op_sel_hi:[1,0,1]
    v_fma_mix_f32 v94, v92, 1.0, v94 op_sel:[1,0,1] op_sel_hi:[1,0,1]
    v_fma_mix_f32 v92, v93, 1.0, v95 op_sel:[0,0,0] op_sel_hi:[1,0,1]
    v_fma_mix_f32 v95, v93, 1.0, v95 op_sel:[1,0,1] op_sel_hi:[1,0,1]
    v_cmp_u_f32 vcc, v94, v95
    v_exp_f32 v92, v92
    v_exp_f32 v93, v113
    v_exp_f32 v94, v94
    s_cbranch_vccnz ch0bs_q201_e
    v_exp_f32 v95, v95
    s_nop 0
    v_pk_add_f32 v[100:101], v[92:93], v[94:95]
    s_branch ch0bs_q01
ch0bs_q201_e:
    buffer_load_dwordx4 v[92:95], v10, s[44:47], s67 offen offset:0 sc1
    s_add_u32 s83, s83, 1
    s_and_b32 s8, s83, 63
    s_cmp_eq_u32 s8, 0
    s_cbranch_scc1 ch0bs_x
    s_branch ch0bs_q012
ch0bs_q210:
    s_waitcnt vmcnt(4)
    v_fma_mix_f32 v113, v92, 1.0, v94 op_sel:[0,0,0] op_sel_hi:[1,0,1]
    v_fma_mix_f32 v94, v92, 1.0, v94 op_sel:[1,0,1] op_sel_hi:[1,0,1]
    v_fma_mix_f32 v92, v93, 1.0, v95 op_sel:[0,0,0] op_sel_hi:[1,0,1]
    v_fma_mix_f32 v95, v93, 1.0, v95 op_sel:[1,0,1] op_sel_hi:[1,0,1]
    v_cmp_u_f32 vcc, v94, v95
    v_exp_f32 v92, v92
    v_exp_f32 v93, v113
    v_exp_f32 v94, v94
    s_cbranch_vccnz ch0bs_q210_e
    v_exp_f32 v95, v95
    v_pk_add_f32 v[100:101], v[92:93], v[94:95]
    s_branch ch0bs_q10
ch0bs_q210_e:
    buffer_load_dwordx4 v[92:95], v10, s[44:47], s67 offen offset:0 sc1
    s_add_u32 s83, s83, 1
    s_and_b32 s8, s83, 63
    s_cmp_eq_u32 s8, 0
    s_cbranch_scc1 ch0bs_x
    s_branch ch0bs_q102
ch0bs_fb:
    buffer_load_dwordx4 v[76:79], v1, s[44:47], s67 offen offset:0 sc1
    buffer_load_dwordx4 v[84:87], v1, s[44:47], s67 offen offset:2048 sc1
    buffer_load_dwordx4 v[80:83], v1, s[44:47], s67 offen offset:1024 sc1
    buffer_load_dwordx4 v[88:91], v1, s[44:47], s67 offen offset:3072 sc1
    buffer_load_dwordx4 v[92:95], v10, s[44:47], s67 offen offset:0 sc1
    s_waitcnt vmcnt(0)
    v_fma_mix_f32 v102, v76, 1.0, v84 op_sel:[0,0,0] op_sel_hi:[1,0,1]
    v_fma_mix_f32 v84, v76, 1.0, v84 op_sel:[1,0,1] op_sel_hi:[1,0,1]
    v_fma_mix_f32 v76, v77, 1.0, v85 op_sel:[0,0,0] op_sel_hi:[1,0,1]
    v_fma_mix_f32 v85, v77, 1.0, v85 op_sel:[1,0,1] op_sel_hi:[1,0,1]
    v_fma_mix_f32 v77, v78, 1.0, v86 op_sel:[0,0,0] op_sel_hi:[1,0,1]
    v_fma_mix_f32 v86, v78, 1.0, v86 op_sel:[1,0,1] op_sel_hi:[1,0,1]
    v_fma_mix_f32 v78, v79, 1.0, v87 op_sel:[0,0,0] op_sel_hi:[1,0,1]
    v_fma_mix_f32 v87, v79, 1.0, v87 op_sel:[1,0,1] op_sel_hi:[1,0,1]
    v_maximum3_f32 v112, v102, v84, v76
    v_maximum3_f32 v112, v112, v85, v77
    v_maximum3_f32 v112, v112, v86, v78
    v_maximum3_f32 v112, v112, v87, v87
    v_cmp_u_f32 vcc, v112, v112
    v_mov_b32 v79, v102
    v_pk_add_f32 v[76:77], v[76:77], v[112:113] op_sel_hi:[1,0] neg_lo:[0,1] neg_hi:[0,1]
    v_pk_add_f32 v[78:79], v[78:79], v[112:113] op_sel_hi:[1,0] neg_lo:[0,1] neg_hi:[0,1]
    v_pk_add_f32 v[84:85], v[84:85], v[112:113] op_sel_hi:[1,0] neg_lo:[0,1] neg_hi:[0,1]
    v_pk_add_f32 v[86:87], v[86:87], v[112:113] op_sel_hi:[1,0] neg_lo:[0,1] neg_hi:[0,1]
    v_exp_f32 v76, v76
    v_exp_f32 v77, v77
    v_exp_f32 v78, v78
    v_exp_f32 v79, v79
    v_exp_f32 v84, v84
    v_exp_f32 v85, v85
    v_pk_add_f32 v[96:97], v[76:77], v[78:79]
    v_exp_f32 v86, v86
    v_exp_f32 v87, v87
    v_pk_add_f32 v[96:97], v[96:97], v[84:85]
    v_pk_add_f32 v[96:97], v[96:97], v[86:87]
    v_fma_mix_f32 v103, v80, 1.0, v88 op_sel:[0,0,0] op_sel_hi:[1,0,1]
    v_fma_mix_f32 v88, v80, 1.0, v88 op_sel:[1,0,1] op_sel_hi:[1,0,1]
    v_fma_mix_f32 v80, v81, 1.0, v89 op_sel:[0,0,0] op_sel_hi:[1,0,1]
    v_fma_mix_f32 v89, v81, 1.0, v89 op_sel:[1,0,1] op_sel_hi:[1,0,1]
    v_fma_mix_f32 v81, v82, 1.0, v90 op_sel:[0,0,0] op_sel_hi:[1,0,1]
    v_fma_mix_f32 v90, v82, 1.0, v90 op_sel:[1,0,1] op_sel_hi:[1,0,1]
    v_fma_mix_f32 v82, v83, 1.0, v91 op_sel:[0,0,0] op_sel_hi:[1,0,1]
    v_fma_mix_f32 v91, v83, 1.0, v91 op_sel:[1,0,1] op_sel_hi:[1,0,1]
    v_maximum3_f32 v114, v103, v88, v80
    v_maximum3_f32 v114, v114, v89, v81
    v_maximum3_f32 v114, v114, v90, v82
    v_maximum3_f32 v114, v114, v91, v91
    v_cmp_u_f32 vcc, v114, v114
    v_mov_b32 v83, v103
    v_pk_add_f32 v[80:81], v[80:81], v[114:115] op_sel_hi:[1,0] neg_lo:[0,1] neg_hi:[0,1]
    v_pk_add_f32 v[82:83], v[82:83], v[114:115] op_sel_hi:[1,0] neg_lo:[0,1] neg_hi:[0,1]
    v_pk_add_f32 v[88:89], v[88:89], v[114:115] op_sel_hi:[1,0] neg_lo:[0,1] neg_hi:[0,1]
    v_pk_add_f32 v[90:91], v[90:91], v[114:115] op_sel_hi:[1,0] neg_lo:[0,1] neg_hi:[0,1]
    v_exp_f32 v80, v80
    v_exp_f32 v81, v81
    v_exp_f32 v82, v82
    v_exp_f32 v83, v83
    v_exp_f32 v88, v88
    v_exp_f32 v89, v89
    v_pk_add_f32 v[98:99], v[80:81], v[82:83]
    v_exp_f32 v90, v90
    v_exp_f32 v91, v91
    v_pk_add_f32 v[98:99], v[98:99], v[88:89]
    v_pk_add_f32 v[98:99], v[98:99], v[90:91]
    v_fma_mix_f32 v113, v92, 1.0, v94 op_sel:[0,0,0] op_sel_hi:[1,0,1]
    v_fma_mix_f32 v94, v92, 1.0, v94 op_sel:[1,0,1] op_sel_hi:[1,0,1]
    v_fma_mix_f32 v92, v93, 1.0, v95 op_sel:[0,0,0] op_sel_hi:[1,0,1]
    v_fma_mix_f32 v95, v93, 1.0, v95 op_sel:[1,0,1] op_sel_hi:[1,0,1]
    v_maximum3_f32 v116, v113, v94, v92
    v_maximum3_f32 v116, v116, v95, v95
    v_cmp_u_f32 vcc, v116, v116
    v_mov_b32 v93, v113
    v_pk_add_f32 v[92:93], v[92:93], v[116:117] op_sel_hi:[1,0] neg_lo:[0,1] neg_hi:[0,1]
    v_pk_add_f32 v[94:95], v[94:95], v[116:117] op_sel_hi:[1,0] neg_lo:[0,1] neg_hi:[0,1]
    v_exp_f32 v92, v92
    v_exp_f32 v93, v93
    v_exp_f32 v94, v94
    v_exp_f32 v95, v95
    s_nop 0
    v_pk_add_f32 v[100:101], v[92:93], v[94:95]
    v_max3_f32 v2, v112, v114, v116
    v_max3_f32 v15, v112, v114, v116
    v_add_f32 v96, v96, v97
    v_add_f32 v98, v98, v99
    v_add_f32 v100, v100, v101
    v_permlane16_swap_b32 v2, v15
    v_max_f32 v2, v2, v15
    v_sub_f32 v112, v112, v2
    v_sub_f32 v114, v114, v2
    v_sub_f32 v116, v116, v2
    v_exp_f32 v112, v112
    v_exp_f32 v114, v114
    v_exp_f32 v116, v116
    v_mul_f32 v2, v112, v96
    v_fmac_f32 v2, v114, v98
    v_fmac_f32 v2, v116, v100
    v_mov_b32 v15, v2
    s_nop 1
    v_permlane16_swap_b32 v2, v15
    v_add_f32 v2, v2, v15
    v_rcp_f32 v2, v2
    s_nop 0
    v_mul_f32 v116, v116, v2
    v_mul_f32 v112, v112, v2
    v_mul_f32 v114, v114, v2
    s_waitcnt lgkmcnt(0)
    v_pk_mul_f32 v[92:93], v[92:93], v[116:117] op_sel_hi:[1,0]
    v_pk_mul_f32 v[94:95], v[94:95], v[116:117] op_sel_hi:[1,0]
    v_cvt_pk_bf16_f32 v116, v93, v94
    v_cvt_pk_bf16_f32 v118, v92, v95
    v_pk_mul_f32 v[76:77], v[76:77], v[112:113] op_sel_hi:[1,0]
    v_pk_mul_f32 v[78:79], v[78:79], v[112:113] op_sel_hi:[1,0]
    v_pk_mul_f32 v[84:85], v[84:85], v[112:113] op_sel_hi:[1,0]
    v_pk_mul_f32 v[86:87], v[86:87], v[112:113] op_sel_hi:[1,0]
    v_cvt_pk_bf16_f32 v96, v79, v84
    v_cvt_pk_bf16_f32 v97, v76, v85
    v_cvt_pk_bf16_f32 v98, v77, v86
    v_cvt_pk_bf16_f32 v99, v78, v87
    v_pk_mul_f32 v[80:81], v[80:81], v[114:115] op_sel_hi:[1,0]
    v_pk_mul_f32 v[82:83], v[82:83], v[114:115] op_sel_hi:[1,0]
    v_pk_mul_f32 v[88:89], v[88:89], v[114:115] op_sel_hi:[1,0]
    v_pk_mul_f32 v[90:91], v[90:91], v[114:115] op_sel_hi:[1,0]
    v_smfmac_f32_16x16x64_bf16 v[60:63], v[116:119], v[104:111], v5
    v_cvt_pk_bf16_f32 v100, v83, v88
    v_cvt_pk_bf16_f32 v101, v80, v89
    v_smfmac_f32_16x16x64_bf16 v[60:63], v[96:99], v[44:51], v5
    v_cvt_pk_bf16_f32 v102, v81, v90
    v_cvt_pk_bf16_f32 v103, v82, v91
    s_nop 1
    v_smfmac_f32_16x16x64_bf16 v[60:63], v[100:103], v[52:59], v5
    s_branch ch0bs_kj
ch0bs_x:
    s_cmp_ge_u32 s83, 2000000
    s_cbranch_scc1 chain_abort
    buffer_load_dwordx4 v[76:79], v1, s[44:47], s67 offen offset:0 sc1
    buffer_load_dwordx4 v[84:87], v1, s[44:47], s67 offen offset:2048 sc1
    buffer_load_dwordx4 v[80:83], v1, s[44:47], s67 offen offset:1024 sc1
    buffer_load_dwordx4 v[88:91], v1, s[44:47], s67 offen offset:3072 sc1
    buffer_load_dwordx4 v[92:95], v10, s[44:47], s67 offen offset:0 sc1
    s_waitcnt vmcnt(0)
    v_pk_max_u16 v2, v76, v77
    v_pk_max_u16 v2, v2, v78
    v_pk_max_u16 v2, v2, v79
    v_pk_max_u16 v2, v2, v80
    v_pk_max_u16 v2, v2, v81
    v_pk_max_u16 v2, v2, v82
    v_pk_max_u16 v2, v2, v83
    v_pk_max_u16 v2, v2, v84
    v_pk_max_u16 v2, v2, v85
    v_pk_max_u16 v2, v2, v86
    v_pk_max_u16 v2, v2, v87
    v_pk_max_u16 v2, v2, v88
    v_pk_max_u16 v2, v2, v89
    v_pk_max_u16 v2, v2, v90
    v_pk_max_u16 v2, v2, v91
    v_pk_max_u16 v2, v2, v92
    v_pk_max_u16 v2, v2, v93
    v_pk_max_u16 v2, v2, v94
    v_pk_max_u16 v2, v2, v95
    v_lshrrev_b32 v112, 16, v2
    v_and_b32 v2, 0xffff, v2
    v_max_u32 v2, v2, v112
    v_cmp_eq_u32 vcc, 0xffff, v2
    s_cbranch_vccnz ch0bs_q012
    v_fma_mix_f32 v102, v76, 1.0, v84 op_sel:[0,0,0] op_sel_hi:[1,0,1]
    v_fma_mix_f32 v84, v76, 1.0, v84 op_sel:[1,0,1] op_sel_hi:[1,0,1]
    v_fma_mix_f32 v76, v77, 1.0, v85 op_sel:[0,0,0] op_sel_hi:[1,0,1]
    v_fma_mix_f32 v85, v77, 1.0, v85 op_sel:[1,0,1] op_sel_hi:[1,0,1]
    v_fma_mix_f32 v77, v78, 1.0, v86 op_sel:[0,0,0] op_sel_hi:[1,0,1]
    v_fma_mix_f32 v86, v78, 1.0, v86 op_sel:[1,0,1] op_sel_hi:[1,0,1]
    v_fma_mix_f32 v78, v79, 1.0, v87 op_sel:[0,0,0] op_sel_hi:[1,0,1]
    v_fma_mix_f32 v87, v79, 1.0, v87 op_sel:[1,0,1] op_sel_hi:[1,0,1]
    v_exp_f32 v76, v76
    v_exp_f32 v77, v77
    v_exp_f32 v78, v78
    v_exp_f32 v79, v102
    v_exp_f32 v84, v84
    v_exp_f32 v85, v85
    v_pk_add_f32 v[96:97], v[76:77], v[78:79]
    v_exp_f32 v86, v86
    v_exp_f32 v87, v87
    v_pk_add_f32 v[96:97], v[96:97], v[84:85]
    v_pk_add_f32 v[96:97], v[96:97], v[86:87]
    v_fma_mix_f32 v103, v80, 1.0, v88 op_sel:[0,0,0] op_sel_hi:[1,0,1]
    v_fma_mix_f32 v88, v80, 1.0, v88 op_sel:[1,0,1] op_sel_hi:[1,0,1]
    v_fma_mix_f32 v80, v81, 1.0, v89 op_sel:[0,0,0] op_sel_hi:[1,0,1]
    v_fma_mix_f32 v89, v81, 1.0, v89 op_sel:[1,0,1] op_sel_hi:[1,0,1]
    v_fma_mix_f32 v81, v82, 1.0, v90 op_sel:[0,0,0] op_sel_hi:[1,0,1]
    v_fma_mix_f32 v90, v82, 1.0, v90 op_sel:[1,0,1] op_sel_hi:[1,0,1]
    v_fma_mix_f32 v82, v83, 1.0, v91 op_sel:[0,0,0] op_sel_hi:[1,0,1]
    v_fma_mix_f32 v91, v83, 1.0, v91 op_sel:[1,0,1] op_sel_hi:[1,0,1]
    v_exp_f32 v80, v80
    v_exp_f32 v81, v81
    v_exp_f32 v82, v82
    v_exp_f32 v83, v103
    v_exp_f32 v88, v88
    v_exp_f32 v89, v89
    v_pk_add_f32 v[98:99], v[80:81], v[82:83]
    v_exp_f32 v90, v90
    v_exp_f32 v91, v91
    v_pk_add_f32 v[98:99], v[98:99], v[88:89]
    v_pk_add_f32 v[98:99], v[98:99], v[90:91]
    v_fma_mix_f32 v113, v92, 1.0, v94 op_sel:[0,0,0] op_sel_hi:[1,0,1]
    v_fma_mix_f32 v94, v92, 1.0, v94 op_sel:[1,0,1] op_sel_hi:[1,0,1]
    v_fma_mix_f32 v92, v93, 1.0, v95 op_sel:[0,0,0] op_sel_hi:[1,0,1]
    v_fma_mix_f32 v95, v93, 1.0, v95 op_sel:[1,0,1] op_sel_hi:[1,0,1]
    v_exp_f32 v92, v92
    v_exp_f32 v93, v113
    v_exp_f32 v94, v94
    v_exp_f32 v95, v95
    s_nop 0
    v_pk_add_f32 v[100:101], v[92:93], v[94:95]
    s_branch ch0bs_k0
ch0bs_vw:
    v_lshlrev_b32 v113, 7, v0
    s_mov_b32 s99, 0
hz_184:
    buffer_load_dword v115, v113, s[44:47], s75 offen sc1
    s_waitcnt vmcnt(0)
    v_cmp_gt_u32 vcc, 28, v115
    s_ff1_i32_b64 s100, vcc
    s_cmp_eq_u32 s100, -1
    s_cselect_b32 s100, 65, s100
    s_sub_u32 s100, s100, 1
    s_cmp_gt_i32 s100, s64
    s_cbranch_scc1 hd_185
    s_sleep 1
    s_add_u32 s99, s99, 1
    s_cmp_lt_u32 s99, 400000
    s_cbranch_scc1 hz_184
    s_branch chain_abort
hd_185:
    s_branch ch0bs_vok
ch0as:
    v_mov_b32 v44, 0
    v_mov_b32 v60, 0
    v_mov_b32 v45, 0
    v_mov_b32 v61, 0
    v_mov_b32 v46, 0
    v_mov_b32 v62, 0
    v_mov_b32 v47, 0
    v_mov_b32 v63, 0
    v_mov_b32 v48, 0
    v_mov_b32 v64, 0
    v_mov_b32 v49, 0
    v_mov_b32 v65, 0
    v_mov_b32 v50, 0
    v_mov_b32 v66, 0
    v_mov_b32 v51, 0
    v_mov_b32 v67, 0
    v_mov_b32 v52, 0
    v_mov_b32 v68, 0
    v_mov_b32 v53, 0
    v_mov_b32 v69, 0
    v_mov_b32 v54, 0
    v_mov_b32 v70, 0
    v_mov_b32 v55, 0
    v_mov_b32 v71, 0
    v_mov_b32 v56, 0
    v_mov_b32 v72, 0
    v_mov_b32 v57, 0
    v_mov_b32 v73, 0
    v_mov_b32 v58, 0
    v_mov_b32 v74, 0
    v_mov_b32 v59, 0
    v_mov_b32 v75, 0
    v_mov_b32 v112, 0
    v_mov_b32 v113, 0
    v_mov_b32 v114, 0
    v_mov_b32 v115, 0
    s_branch ch0as_loop
.p2align 6
ch0as_loop:
    s_and_b32 s8, s64, 3
    s_lshl_b32 s65, s8, 13
    s_add_u32 s65, s65, 94896128
    buffer_load_dwordx4 v[16:19], v1, s[44:47], s65 offen offset:0 sc1
    buffer_load_dwordx4 v[20:23], v1, s[44:47], s65 offen offset:1024 sc1
    s_mov_b32 s83, 0
    s_and_b32 s8, s64, 3
    s_mul_i32 s9, s8, 20736
    s_add_u32 s67, s9, 94928896
    s_add_u32 s66, s9, s12
    s_xor_b32 s8, s8, 2
    s_mul_i32 s9, s8, 20736
    s_add_u32 s70, s9, s13
    s_lshl_b32 s9, s8, 13
    s_add_u32 s69, s9, s14
    s_add_u32 s8, s64, 1
    s_and_b32 s8, s8, 3
    s_lshl_b32 s9, s8, 13
    s_add_u32 s68, s9, s14
    s_add_u32 s16, s72, 0
    s_add_u32 s20, s15, 0
    s_add_u32 s17, s72, 4096
    s_add_u32 s21, s15, 4096
    s_add_u32 s18, s72, 14336
    s_add_u32 s22, s15, 8192
    s_add_u32 s72, s72, 28672
    s_xor_b32 s15, s15, 0x4000
ch0as_mp:
    buffer_load_dwordx4 v[16:19], v1, s[44:47], s65 offen offset:0 sc1
    buffer_load_dwordx4 v[20:23], v1, s[44:47], s65 offen offset:1024 sc1
    s_add_u32 s83, s83, 1
    s_cmp_ge_u32 s83, 2000000
    s_cbranch_scc1 chain_abort
    s_waitcnt vmcnt(3)
    v_max3_u32 v2, v16, v17, v18
    v_max_u32 v2, v2, v19
    v_cmp_eq_u32 s[10:11], -1, v2
    s_waitcnt vmcnt(2)
    v_max3_u32 v2, v20, v21, v22
    v_max_u32 v2, v2, v23
    v_cmp_eq_u32 vcc, -1, v2
    s_cmp_lg_u64 s[10:11], 0
    s_cbranch_scc1 ch0as_m0bad
    s_cbranch_vccnz ch0as_mp1
ch0as_mok:
    ds_write_b128 v1, v[16:19] offset:0
    ds_write_b128 v1, v[20:23] offset:1024
    v_smfmac_f32_16x16x64_bf16 v[44:47], v[16:19], a[0:7], v5
    v_smfmac_f32_16x16x64_bf16 v[48:51], v[16:19], a[56:63], v5
    s_waitcnt lgkmcnt(0)
    s_barrier
    ds_read_b128 v[24:27], v1 offset:2048
    ds_read_b128 v[28:31], v1 offset:3072
    ds_read_b128 v[32:35], v1 offset:4096
    ds_read_b128 v[36:39], v1 offset:5120
    ds_read_b128 v[40:43], v1 offset:6144
    v_smfmac_f32_16x16x64_bf16 v[52:55], v[16:19], a[112:119], v5
    s_mov_b32 m0, s20
    v_smfmac_f32_16x16x64_bf16 v[44:47], v[20:23], a[8:15], v5
    buffer_load_dwordx4 v1, s[44:47], s16 offen offset:0 sc1 lds
    v_smfmac_f32_16x16x64_bf16 v[48:51], v[20:23], a[64:71], v5
    buffer_load_dwordx4 v1, s[44:47], s16 offen offset:1024 sc1 lds
    v_smfmac_f32_16x16x64_bf16 v[52:55], v[20:23], a[120:127], v5
    buffer_load_dwordx4 v1, s[44:47], s16 offen offset:2048 sc1 lds
    s_waitcnt lgkmcnt(4)
    v_smfmac_f32_16x16x64_bf16 v[44:47], v[24:27], a[16:23], v5
    buffer_load_dwordx4 v1, s[44:47], s16 offen offset:3072 sc1 lds
    s_mov_b32 m0, s21
    s_waitcnt lgkmcnt(3)
    v_smfmac_f32_16x16x64_bf16 v[44:47], v[28:31], a[24:31], v5
    buffer_load_dwordx4 v1, s[44:47], s17 offen offset:0 sc1 lds
    s_waitcnt lgkmcnt(2)
    v_smfmac_f32_16x16x64_bf16 v[44:47], v[32:35], a[32:39], v5
    buffer_load_dwordx4 v1, s[44:47], s17 offen offset:1024 sc1 lds
    s_waitcnt lgkmcnt(1)
    v_smfmac_f32_16x16x64_bf16 v[44:47], v[36:39], a[40:47], v5
    buffer_load_dwordx4 v1, s[44:47], s17 offen offset:2048 sc1 lds
    s_mov_b32 m0, s22
    s_waitcnt lgkmcnt(0)
    v_smfmac_f32_16x16x64_bf16 v[44:47], v[40:43], a[48:55], v5
    buffer_load_dwordx4 v1, s[44:47], s18 offen offset:0 sc1 lds
    v_smfmac_f32_16x16x64_bf16 v[48:51], v[24:27], a[72:79], v5
    buffer_load_dwordx4 v1, s[44:47], s18 offen offset:1024 sc1 lds
    v_smfmac_f32_16x16x64_bf16 v[48:51], v[28:31], a[80:87], v5
    buffer_store_dword v3, v4, s[44:47], s70 offen sc1
    v_smfmac_f32_16x16x64_bf16 v[48:51], v[32:35], a[88:95], v5
    v_smfmac_f32_16x16x64_bf16 v[48:51], v[36:39], a[96:103], v5
    s_nop 0
    v_add_f32 v44, v44, v46
    v_smfmac_f32_16x16x64_bf16 v[48:51], v[40:43], a[104:111], v5
    v_add_f32 v45, v45, v47
    v_smfmac_f32_16x16x64_bf16 v[52:55], v[24:27], a[128:135], v5
    v_cvt_pk_bf16_f32 v44, v44, v45
    v_smfmac_f32_16x16x64_bf16 v[52:55], v[28:31], a[136:143], v5
    ds_write_b32 v6, v44 offset:0
    v_smfmac_f32_16x16x64_bf16 v[52:55], v[32:35], a[144:151], v5
    v_smfmac_f32_16x16x64_bf16 v[52:55], v[36:39], a[152:159], v5
    s_nop 0
    v_add_f32 v48, v48, v50
    v_smfmac_f32_16x16x64_bf16 v[52:55], v[40:43], a[160:167], v5
    v_add_f32 v49, v49, v51
    v_smfmac_f32_16x16x64_bf16 v[56:59], v[24:27], a[184:191], v5
    v_cvt_pk_bf16_f32 v48, v48, v49
    v_smfmac_f32_16x16x64_bf16 v[56:59], v[28:31], a[192:199], v5
    ds_write_b32 v6, v48 offset:256
    v_smfmac_f32_16x16x64_bf16 v[56:59], v[32:35], a[200:207], v5
    s_nop 1
    v_add_f32 v52, v52, v54
    v_smfmac_f32_16x16x64_bf16 v[56:59], v[36:39], a[208:215], v5
    v_add_f32 v53, v53, v55
    v_smfmac_f32_16x16x64_bf16 v[56:59], v[40:43], a[216:223], v5
    v_cvt_pk_bf16_f32 v52, v52, v53
    v_smfmac_f32_16x16x64_bf16 v[56:59], v[16:19], a[168:175], v5
    ds_write_b32 v6, v52 offset:512
    v_smfmac_f32_16x16x64_bf16 v[56:59], v[20:23], a[176:183], v5
    s_nop 7
    v_add_f32 v56, v56, v58
    v_add_f32 v57, v57, v59
    v_cvt_pk_bf16_f32 v56, v56, v57
    ds_write_b32 v6, v56 offset:3072
    s_waitcnt lgkmcnt(1)
    s_barrier
    s_waitcnt lgkmcnt(0)
    s_barrier
    s_lshl_b32 s8, s101, 7
    s_add_u32 s8, s8, 95055872
    s_cmp_eq_u32 s101, -1
    s_cselect_b32 s8, 0x7ffffff0, s8
    s_barrier
    buffer_store_dword v10, off, s[44:47], s8 sc1
    s_add_u32 s71, s71, 458752
    s_add_u32 s8, s72, 0
    s_mov_b32 m0, 16384
    s_nop 0
    buffer_load_dwordx4 v1, s[44:47], s8 offen offset:0 sc1 lds
    buffer_load_dwordx4 v1, s[44:47], s8 offen offset:1024 sc1 lds
    buffer_load_dwordx4 v1, s[44:47], s8 offen offset:2048 sc1 lds
    buffer_load_dwordx4 v1, s[44:47], s8 offen offset:3072 sc1 lds
    s_add_u32 s8, s72, 4096
    s_mov_b32 m0, 20480
    s_nop 0
    buffer_load_dwordx4 v1, s[44:47], s8 offen offset:0 sc1 lds
    buffer_load_dwordx4 v1, s[44:47], s8 offen offset:1024 sc1 lds
    buffer_load_dwordx4 v1, s[44:47], s8 offen offset:2048 sc1 lds
    s_add_u32 s8, s72, 14336
    s_mov_b32 m0, 24576
    s_nop 0
    buffer_load_dwordx4 v1, s[44:47], s8 offen offset:0 sc1 lds
    buffer_load_dwordx4 v1, s[44:47], s8 offen offset:1024 sc1 lds
    s_add_u32 s8, s64, s7
    s_and_b32 s8, s8, 3
    s_cmp_lg_u32 s8, 0
    s_cselect_b32 s101, -1, s64
    s_cbranch_scc1 ch0as_np
    s_lshl_b32 s8, s64, 13
    s_add_u32 s8, s8, 91750400
    buffer_store_dwordx4 v[16:19], v1, s[44:47], s8 offen offset:0 sc1
    buffer_store_dwordx4 v[20:23], v1, s[44:47], s8 offen offset:1024 sc1
ch0as_np:
    v_mov_b32 v44, 0
    v_mov_b32 v45, 0
    v_mov_b32 v46, 0
    v_mov_b32 v47, 0
    v_mov_b32 v48, 0
    v_mov_b32 v49, 0
    v_mov_b32 v50, 0
    v_mov_b32 v51, 0
    v_mov_b32 v52, 0
    v_mov_b32 v53, 0
    v_mov_b32 v54, 0
    v_mov_b32 v55, 0
    v_mov_b32 v56, 0
    v_mov_b32 v57, 0
    v_mov_b32 v58, 0
    v_mov_b32 v59, 0
    v_mov_b32 v112, 0
    v_mov_b32 v113, 0
    v_mov_b32 v114, 0
    v_mov_b32 v115, 0
    s_add_u32 s64, s64, 1
    s_cmp_lt_u32 s64, 63
    s_cbranch_scc1 ch0as_loop
    s_waitcnt vmcnt(0)
    s_barrier
    s_lshl_b32 s8, s101, 7
    s_add_u32 s8, s8, 95055872
    s_cmp_eq_u32 s101, -1
    s_cselect_b32 s8, 0x7ffffff0, s8
    buffer_store_dword v10, off, s[44:47], s8 sc1
    s_endpgm
ch0as_mp1:
    buffer_load_dwordx4 v[20:23], v1, s[44:47], s65 offen offset:1024 sc1
    s_add_u32 s83, s83, 1
    s_cmp_ge_u32 s83, 2000000
    s_cbranch_scc1 chain_abort
    s_waitcnt vmcnt(1)
    v_max3_u32 v2, v20, v21, v22
    v_max_u32 v2, v2, v23
    v_cmp_eq_u32 vcc, -1, v2
    s_cbranch_vccnz ch0as_mp1
    s_branch ch0as_mok
ch0as_m0bad:
    s_cbranch_vccnz ch0as_mp
ch0as_mp0:
    buffer_load_dwordx4 v[16:19], v1, s[44:47], s65 offen offset:0 sc1
    s_add_u32 s83, s83, 1
    s_cmp_ge_u32 s83, 2000000
    s_cbranch_scc1 chain_abort
    s_waitcnt vmcnt(1)
    v_max3_u32 v2, v16, v17, v18
    v_max_u32 v2, v2, v19
    v_cmp_eq_u32 vcc, -1, v2
    s_cbranch_vccnz ch0as_mp0
    s_branch ch0as_mok
ch1bs:
    v_mov_b32 v44, 0
    v_mov_b32 v60, 0
    v_mov_b32 v45, 0
    v_mov_b32 v61, 0
    v_mov_b32 v46, 0
    v_mov_b32 v62, 0
    v_mov_b32 v47, 0
    v_mov_b32 v63, 0
    v_mov_b32 v48, 0
    v_mov_b32 v64, 0
    v_mov_b32 v49, 0
    v_mov_b32 v65, 0
    v_mov_b32 v50, 0
    v_mov_b32 v66, 0
    v_mov_b32 v51, 0
    v_mov_b32 v67, 0
    v_mov_b32 v52, 0
    v_mov_b32 v68, 0
    v_mov_b32 v53, 0
    v_mov_b32 v69, 0
    v_mov_b32 v54, 0
    v_mov_b32 v70, 0
    v_mov_b32 v55, 0
    v_mov_b32 v71, 0
    v_mov_b32 v56, 0
    v_mov_b32 v72, 0
    v_mov_b32 v57, 0
    v_mov_b32 v73, 0
    v_mov_b32 v58, 0
    v_mov_b32 v74, 0
    v_mov_b32 v59, 0
    v_mov_b32 v75, 0
    v_mov_b32 v112, 0
    v_mov_b32 v113, 0
    v_mov_b32 v114, 0
    v_mov_b32 v115, 0
    s_branch ch1bs_loop
.p2align 6
ch1bs_loop:
    s_and_b32 s8, s64, 3
    s_lshl_b32 s65, s8, 13
    s_add_u32 s65, s65, 94898176
    buffer_load_dwordx4 v[24:27], v1, s[44:47], s65 offen offset:0 sc1
    buffer_load_dwordx4 v[28:31], v1, s[44:47], s65 offen offset:1024 sc1
    s_mov_b32 s83, 0
    s_and_b32 s8, s64, 3
    s_mul_i32 s9, s8, 20736
    s_add_u32 s67, s9, 94934016
    s_add_u32 s66, s9, s12
    s_xor_b32 s8, s8, 2
    s_mul_i32 s9, s8, 20736
    s_add_u32 s70, s9, s13
    s_add_u32 s16, s72, 14336
    s_add_u32 s20, s15, 8192
    s_add_u32 s17, s72, 18432
    s_add_u32 s21, s15, 12288
    s_add_u32 s72, s72, 28672
    s_xor_b32 s15, s15, 0x4000
    s_add_u32 s24, s71, 0
    s_add_u32 s71, s71, 458752
    v_mov_b32 v60, 0
    v_mov_b32 v61, 0
    v_mov_b32 v62, 0
    v_mov_b32 v63, 0
    v_mov_b32 v64, 0
    v_mov_b32 v65, 0
    v_mov_b32 v66, 0
    v_mov_b32 v67, 0
    v_mov_b32 v68, 0
    v_mov_b32 v69, 0
    v_mov_b32 v70, 0
    v_mov_b32 v71, 0
    v_mov_b32 v72, 0
    v_mov_b32 v73, 0
    v_mov_b32 v74, 0
    v_mov_b32 v75, 0
ch1bs_mp:
    buffer_load_dwordx4 v[24:27], v1, s[44:47], s65 offen offset:0 sc1
    buffer_load_dwordx4 v[28:31], v1, s[44:47], s65 offen offset:1024 sc1
    s_add_u32 s83, s83, 1
    s_cmp_ge_u32 s83, 2000000
    s_cbranch_scc1 chain_abort
    s_waitcnt vmcnt(3)
    v_max3_u32 v2, v24, v25, v26
    v_max_u32 v2, v2, v27
    v_cmp_eq_u32 s[10:11], -1, v2
    s_waitcnt vmcnt(2)
    v_max3_u32 v2, v28, v29, v30
    v_max_u32 v2, v2, v31
    v_cmp_eq_u32 vcc, -1, v2
    s_cmp_lg_u64 s[10:11], 0
    s_cbranch_scc1 ch1bs_m0bad
    s_cbranch_vccnz ch1bs_mp1
ch1bs_mok:
    ds_write_b128 v1, v[24:27] offset:2048
    ds_write_b128 v1, v[28:31] offset:3072
    v_smfmac_f32_16x16x64_bf16 v[44:47], v[24:27], a[16:23], v5
    v_smfmac_f32_16x16x64_bf16 v[48:51], v[24:27], a[72:79], v5
    s_waitcnt lgkmcnt(0)
    s_barrier
    s_mov_b32 m0, 20480
    ds_read_b128 v[16:19], v1 offset:0
    ds_read_b128 v[20:23], v1 offset:1024
    ds_read_b128 v[32:35], v1 offset:4096
    ds_read_b128 v[36:39], v1 offset:5120
    ds_read_b128 v[40:43], v1 offset:6144
    v_smfmac_f32_16x16x64_bf16 v[52:55], v[24:27], a[128:135], v5
    buffer_load_dwordx4 v1, s[44:47], s24 offen offset:2048 sc1 lds
    v_smfmac_f32_16x16x64_bf16 v[44:47], v[28:31], a[24:31], v5
    buffer_load_dwordx4 v1, s[44:47], s24 offen offset:3072 sc1 lds
    s_mov_b32 m0, s20
    v_smfmac_f32_16x16x64_bf16 v[48:51], v[28:31], a[80:87], v5
    buffer_load_dwordx4 v1, s[44:47], s16 offen offset:2048 sc1 lds
    v_smfmac_f32_16x16x64_bf16 v[52:55], v[28:31], a[136:143], v5
    buffer_load_dwordx4 v1, s[44:47], s16 offen offset:3072 sc1 lds
    s_mov_b32 m0, s21
    v_smfmac_f32_16x16x64_bf16 v[60:63], v[24:27], a[240:247], v5
    buffer_load_dwordx4 v1, s[44:47], s17 offen offset:0 sc1 lds
    v_smfmac_f32_16x16x64_bf16 v[60:63], v[28:31], a[248:255], v5
    buffer_load_dwordx4 v1, s[44:47], s17 offen offset:1024 sc1 lds
    v_smfmac_f32_16x16x64_bf16 v[64:67], v[24:27], v[160:167], v5
    buffer_load_dwordx4 v1, s[44:47], s17 offen offset:2048 sc1 lds
    s_waitcnt lgkmcnt(4)
    v_smfmac_f32_16x16x64_bf16 v[44:47], v[16:19], a[0:7], v5
    buffer_store_dword v3, v4, s[44:47], s70 offen sc1
    s_waitcnt lgkmcnt(3)
    v_smfmac_f32_16x16x64_bf16 v[44:47], v[20:23], a[8:15], v5
    s_waitcnt lgkmcnt(2)
    v_smfmac_f32_16x16x64_bf16 v[44:47], v[32:35], a[32:39], v5
    ds_read2_b64 v[76:79], v8 offset0:0 offset1:4
    s_waitcnt lgkmcnt(2)
    v_smfmac_f32_16x16x64_bf16 v[44:47], v[36:39], a[40:47], v5
    ds_read2_b64 v[80:83], v8 offset0:64 offset1:68
    s_waitcnt lgkmcnt(2)
    v_smfmac_f32_16x16x64_bf16 v[44:47], v[40:43], a[48:55], v5
    ds_read2_b64 v[84:87], v8 offset0:128 offset1:132
    v_smfmac_f32_16x16x64_bf16 v[48:51], v[16:19], a[56:63], v5
    ds_read2_b64 v[88:91], v8 offset0:192 offset1:196
    v_smfmac_f32_16x16x64_bf16 v[48:51], v[20:23], a[64:71], v5
    ds_read2_b64 v[92:95], v13 offset0:0 offset1:4
    v_smfmac_f32_16x16x64_bf16 v[48:51], v[32:35], a[88:95], v5
    ds_read2_b64 v[96:99], v13 offset0:64 offset1:68
    v_smfmac_f32_16x16x64_bf16 v[48:51], v[36:39], a[96:103], v5
    v_add_f32 v44, v44, v46
    v_smfmac_f32_16x16x64_bf16 v[48:51], v[40:43], a[104:111], v5
    v_add_f32 v45, v45, v47
    v_smfmac_f32_16x16x64_bf16 v[52:55], v[16:19], a[112:119], v5
    v_cvt_pk_bf16_f32 v44, v44, v45
    v_smfmac_f32_16x16x64_bf16 v[52:55], v[20:23], a[120:127], v5
    ds_write_b32 v6, v44 offset:768
    v_smfmac_f32_16x16x64_bf16 v[52:55], v[32:35], a[144:151], v5
    ds_read2_b64 v[100:103], v13 offset0:128 offset1:132
    v_smfmac_f32_16x16x64_bf16 v[52:55], v[36:39], a[152:159], v5
    v_add_f32 v48, v48, v50
    v_smfmac_f32_16x16x64_bf16 v[52:55], v[40:43], a[160:167], v5
    v_add_f32 v49, v49, v51
    v_smfmac_f32_16x16x64_bf16 v[56:59], v[16:19], a[168:175], v5
    v_cvt_pk_bf16_f32 v48, v48, v49
    v_smfmac_f32_16x16x64_bf16 v[56:59], v[20:23], a[176:183], v5
    ds_write_b32 v6, v48 offset:1024
    v_smfmac_f32_16x16x64_bf16 v[56:59], v[32:35], a[200:207], v5
    s_nop 1
    v_add_f32 v52, v52, v54
    v_smfmac_f32_16x16x64_bf16 v[56:59], v[36:39], a[208:215], v5
    v_add_f32 v53, v53, v55
    v_smfmac_f32_16x16x64_bf16 v[56:59], v[40:43], a[216:223], v5
    v_cvt_pk_bf16_f32 v52, v52, v53
    v_smfmac_f32_16x16x64_bf16 v[56:59], v[24:27], a[184:191], v5
    ds_write_b32 v6, v52 offset:1280
    v_smfmac_f32_16x16x64_bf16 v[56:59], v[28:31], a[192:199], v5
    s_nop 7
    v_add_f32 v56, v56, v58
    v_add_f32 v57, v57, v59
    v_cvt_pk_bf16_f32 v56, v56, v57
    ds_write_b32 v6, v56 offset:3328
    s_waitcnt lgkmcnt(1)
    s_barrier
    ds_read_b64_tr_b16 v[44:45], v7 offset:0
    ds_read_b64_tr_b16 v[46:47], v7 offset:128
    ds_read_b64_tr_b16 v[48:49], v7 offset:1024
    ds_read_b64_tr_b16 v[50:51], v7 offset:1152
    ds_read_b64_tr_b16 v[52:53], v7 offset:2048
    ds_read_b64_tr_b16 v[54:55], v7 offset:2176
    s_waitcnt lgkmcnt(6)
    s_barrier
    ds_read_b64_tr_b16 v[56:57], v7 offset:3072
    ds_read_b64_tr_b16 v[58:59], v7 offset:3200
    s_waitcnt lgkmcnt(6)
    v_smfmac_f32_16x16x64_bf16 v[112:115], v[44:47], v[76:83], v5
    s_waitcnt lgkmcnt(4)
    v_smfmac_f32_16x16x64_bf16 v[112:115], v[48:51], v[84:91], v5
    s_waitcnt lgkmcnt(2)
    v_smfmac_f32_16x16x64_bf16 v[112:115], v[52:55], v[92:99], v5
    s_waitcnt lgkmcnt(0)
    v_smfmac_f32_16x16x64_bf16 v[112:115], v[56:59], v[100:107], v5
    ds_read_b128 v[44:47], v12 offset:0
    ds_read_b128 v[48:51], v12 offset:1024
    ds_read_b128 v[52:55], v12 offset:2048
    ds_read_b128 v[56:59], v12 offset:3072
    s_nop 3
    v_pk_add_f32 v[112:113], v[112:113], v[114:115]
    v_pk_mul_f32 v[112:113], v[112:113], s[78:79]
    v_cvt_pk_f16_f32 v112, v112, v113
    s_nop 1
    v_mov_b32_dpp v113, v112 quad_perm:[1,0,3,2] row_mask:0xf bank_mask:0xf
    v_perm_b32 v112, v113, v112, v14
    v_pk_min_u16 v112, v112, s77
    buffer_store_dword v112, v9, s[44:47], s66 offen sc1
    s_mov_b32 s83, 0
    s_mov_b32 s98, 0
    v_smfmac_f32_16x16x64_bf16 v[60:63], v[16:19], a[224:231], v5
    v_smfmac_f32_16x16x64_bf16 v[60:63], v[20:23], a[232:239], v5
    v_smfmac_f32_16x16x64_bf16 v[60:63], v[32:35], v[120:127], v5
    s_waitcnt lgkmcnt(2)
    v_smfmac_f32_16x16x64_bf16 v[72:75], v[16:19], v[44:51], v5
    ds_read_b128 v[44:47], v12 offset:4096
    ds_read_b128 v[48:51], v12 offset:5120
    v_smfmac_f32_16x16x64_bf16 v[60:63], v[36:39], v[128:135], v5
    v_smfmac_f32_16x16x64_bf16 v[60:63], v[40:43], v[136:143], v5
    v_smfmac_f32_16x16x64_bf16 v[64:67], v[16:19], v[144:151], v5
    s_waitcnt lgkmcnt(2)
    v_smfmac_f32_16x16x64_bf16 v[72:75], v[20:23], v[52:59], v5
    ds_read_b128 v[52:55], v12 offset:6144
    ds_read_b128 v[56:59], v12 offset:7168
    v_smfmac_f32_16x16x64_bf16 v[64:67], v[20:23], v[152:159], v5
    v_smfmac_f32_16x16x64_bf16 v[64:67], v[28:31], v[168:175], v5
    v_smfmac_f32_16x16x64_bf16 v[64:67], v[32:35], v[176:183], v5
    v_add_f32 v60, v60, v62
    s_waitcnt lgkmcnt(2)
    v_smfmac_f32_16x16x64_bf16 v[72:75], v[24:27], v[44:51], v5
    ds_read_b128 v[44:47], v12 offset:8192
    ds_read_b128 v[48:51], v12 offset:9216
    s_cmp_ge_u32 s100, 64
    s_cbranch_scc0 ch1bs_hl
ch1bs_hs:
    buffer_load_dwordx4 v[76:79], v1, s[44:47], s67 offen offset:0 sc1
    buffer_load_dwordx4 v[84:87], v1, s[44:47], s67 offen offset:2048 sc1
    v_smfmac_f32_16x16x64_bf16 v[64:67], v[36:39], v[184:191], v5
    v_add_f32 v61, v61, v63
    v_smfmac_f32_16x16x64_bf16 v[64:67], v[40:43], v[192:199], v5
    v_cvt_pk_bf16_f32 v104, v60, v61
    v_smfmac_f32_16x16x64_bf16 v[68:71], v[16:19], v[200:207], v5
    buffer_load_dwordx4 v[80:83], v1, s[44:47], s67 offen offset:1024 sc1
    buffer_load_dwordx4 v[88:91], v1, s[44:47], s67 offen offset:3072 sc1
    s_waitcnt lgkmcnt(2)
    v_smfmac_f32_16x16x64_bf16 v[72:75], v[28:31], v[52:59], v5
    ds_read_b128 v[52:55], v12 offset:10240
    ds_read_b128 v[56:59], v12 offset:11264
    v_smfmac_f32_16x16x64_bf16 v[68:71], v[20:23], v[208:215], v5
    v_mov_b32 v60, 0
    v_smfmac_f32_16x16x64_bf16 v[68:71], v[24:27], v[216:223], v5
    buffer_load_dwordx4 v[92:95], v10, s[44:47], s67 offen offset:0 sc1
    s_waitcnt lgkmcnt(2)
    v_smfmac_f32_16x16x64_bf16 v[72:75], v[32:35], v[44:51], v5
    ds_read_b128 v[44:47], v12 offset:12288
    ds_read_b128 v[48:51], v12 offset:13312
    v_smfmac_f32_16x16x64_bf16 v[68:71], v[28:31], v[224:231], v5
    v_mov_b32 v61, 0
    v_smfmac_f32_16x16x64_bf16 v[68:71], v[32:35], v[232:239], v5
    v_mov_b32 v62, 0
    s_waitcnt lgkmcnt(2)
    v_smfmac_f32_16x16x64_bf16 v[72:75], v[36:39], v[52:59], v5
    v_smfmac_f32_16x16x64_bf16 v[68:71], v[36:39], v[240:247], v5
    v_mov_b32 v63, 0
    v_smfmac_f32_16x16x64_bf16 v[68:71], v[40:43], v[248:255], v5
    v_add_f32 v64, v64, v66
    s_waitcnt lgkmcnt(0)
    v_smfmac_f32_16x16x64_bf16 v[72:75], v[40:43], v[44:51], v5
    v_add_f32 v65, v65, v67
    v_cvt_pk_bf16_f32 v105, v64, v65
    s_nop 2
    v_add_f32 v68, v68, v70
    v_add_f32 v69, v69, v71
    v_cvt_pk_bf16_f32 v108, v68, v69
    v_add_f32 v72, v72, v74
    v_add_f32 v73, v73, v75
    v_cvt_pk_bf16_f32 v109, v72, v73
    s_waitcnt vmcnt(3)
    ds_read_b128 v[44:47], v1 offset:20480
    ds_read_b128 v[48:51], v1 offset:21504
    ds_read_b128 v[52:55], v1 offset:22528
    ds_read_b128 v[56:59], v1 offset:23552
    s_cbranch_scc0 ch1bs_hu
ch1bs_hv:
    s_cmp_ge_u32 s64, s100
    v_fma_mix_f32 v102, v76, 1.0, v84 op_sel:[0,0,0] op_sel_hi:[1,0,1]
    v_fma_mix_f32 v84, v76, 1.0, v84 op_sel:[1,0,1] op_sel_hi:[1,0,1]
    v_fma_mix_f32 v76, v77, 1.0, v85 op_sel:[0,0,0] op_sel_hi:[1,0,1]
    v_fma_mix_f32 v85, v77, 1.0, v85 op_sel:[1,0,1] op_sel_hi:[1,0,1]
    v_fma_mix_f32 v77, v78, 1.0, v86 op_sel:[0,0,0] op_sel_hi:[1,0,1]
    v_fma_mix_f32 v86, v78, 1.0, v86 op_sel:[1,0,1] op_sel_hi:[1,0,1]
    v_fma_mix_f32 v78, v79, 1.0, v87 op_sel:[0,0,0] op_sel_hi:[1,0,1]
    v_fma_mix_f32 v87, v79, 1.0, v87 op_sel:[1,0,1] op_sel_hi:[1,0,1]
    v_maximum3_f32 v112, v84, v85, v86
    v_cmp_u_f32 vcc, v112, v87
    v_exp_f32 v76, v76
    v_exp_f32 v77, v77
    v_exp_f32 v78, v78
    s_cbranch_vccnz ch1bs_i0
    v_exp_f32 v79, v102
    v_exp_f32 v84, v84
    v_exp_f32 v85, v85
    v_pk_add_f32 v[96:97], v[76:77], v[78:79]
    v_exp_f32 v86, v86
    v_exp_f32 v87, v87
    v_pk_add_f32 v[96:97], v[96:97], v[84:85]
    v_pk_add_f32 v[96:97], v[96:97], v[86:87]
    s_waitcnt vmcnt(1)
    v_fma_mix_f32 v103, v80, 1.0, v88 op_sel:[0,0,0] op_sel_hi:[1,0,1]
    v_fma_mix_f32 v88, v80, 1.0, v88 op_sel:[1,0,1] op_sel_hi:[1,0,1]
    v_fma_mix_f32 v80, v81, 1.0, v89 op_sel:[0,0,0] op_sel_hi:[1,0,1]
    v_fma_mix_f32 v89, v81, 1.0, v89 op_sel:[1,0,1] op_sel_hi:[1,0,1]
    v_fma_mix_f32 v81, v82, 1.0, v90 op_sel:[0,0,0] op_sel_hi:[1,0,1]
    v_fma_mix_f32 v90, v82, 1.0, v90 op_sel:[1,0,1] op_sel_hi:[1,0,1]
    v_fma_mix_f32 v82, v83, 1.0, v91 op_sel:[0,0,0] op_sel_hi:[1,0,1]
    v_fma_mix_f32 v91, v83, 1.0, v91 op_sel:[1,0,1] op_sel_hi:[1,0,1]
    v_maximum3_f32 v114, v88, v89, v90
    v_cmp_u_f32 vcc, v114, v91
    v_exp_f32 v80, v80
    v_exp_f32 v81, v81
    v_exp_f32 v82, v82
    s_cbranch_vccnz ch1bs_i1
    v_exp_f32 v83, v103
    v_exp_f32 v88, v88
    v_exp_f32 v89, v89
    v_pk_add_f32 v[98:99], v[80:81], v[82:83]
    v_exp_f32 v90, v90
    v_exp_f32 v91, v91
    v_pk_add_f32 v[98:99], v[98:99], v[88:89]
    v_pk_add_f32 v[98:99], v[98:99], v[90:91]
    s_cbranch_scc1 ch1bs_nw
ch1bs_nw2:
    s_mov_b32 m0, 20480
    s_mov_b32 s98, 1
    s_waitcnt vmcnt(0) lgkmcnt(0)
    buffer_load_dwordx4 v1, s[44:47], s71 offen offset:0 sc1 lds
    buffer_load_dwordx4 v1, s[44:47], s71 offen offset:1024 sc1 lds
    v_fma_mix_f32 v113, v92, 1.0, v94 op_sel:[0,0,0] op_sel_hi:[1,0,1]
    v_fma_mix_f32 v94, v92, 1.0, v94 op_sel:[1,0,1] op_sel_hi:[1,0,1]
    v_fma_mix_f32 v92, v93, 1.0, v95 op_sel:[0,0,0] op_sel_hi:[1,0,1]
    v_fma_mix_f32 v95, v93, 1.0, v95 op_sel:[1,0,1] op_sel_hi:[1,0,1]
    v_cmp_u_f32 vcc, v94, v95
    v_exp_f32 v92, v92
    v_exp_f32 v93, v113
    v_exp_f32 v94, v94
    s_cbranch_vccnz ch1bs_i2
    v_exp_f32 v95, v95
    s_nop 0
    v_pk_add_f32 v[100:101], v[92:93], v[94:95]
ch1bs_w2d:
    v_pk_add_f32 v[96:97], v[96:97], v[98:99]
    v_pk_add_f32 v[96:97], v[96:97], v[100:101]
    v_add_f32 v2, v96, v97
    v_add_f32 v15, v96, v97
    s_nop 1
    v_permlane16_swap_b32 v2, v15
    v_add_f32 v2, v2, v15
    v_subrev_u32 v15, 0x17800000, v2
    v_rcp_f32 v2, v2
    v_cmp_le_u32 vcc, 0x5a000000, v15
    s_waitcnt lgkmcnt(0)
    v_pk_mul_f32 v[92:93], v[92:93], v[2:3] op_sel_hi:[1,0]
    v_pk_mul_f32 v[94:95], v[94:95], v[2:3] op_sel_hi:[1,0]
    v_cvt_pk_bf16_f32 v116, v93, v94
    v_cvt_pk_bf16_f32 v118, v92, v95
    s_cbranch_vccnz ch1bs_fb
    v_pk_mul_f32 v[76:77], v[76:77], v[2:3] op_sel_hi:[1,0]
    v_pk_mul_f32 v[78:79], v[78:79], v[2:3] op_sel_hi:[1,0]
    v_pk_mul_f32 v[84:85], v[84:85], v[2:3] op_sel_hi:[1,0]
    v_pk_mul_f32 v[86:87], v[86:87], v[2:3] op_sel_hi:[1,0]
    v_cvt_pk_bf16_f32 v96, v79, v84
    v_cvt_pk_bf16_f32 v97, v76, v85
    v_cvt_pk_bf16_f32 v98, v77, v86
    v_cvt_pk_bf16_f32 v99, v78, v87
    v_pk_mul_f32 v[80:81], v[80:81], v[2:3] op_sel_hi:[1,0]
    v_pk_mul_f32 v[82:83], v[82:83], v[2:3] op_sel_hi:[1,0]
    v_pk_mul_f32 v[88:89], v[88:89], v[2:3] op_sel_hi:[1,0]
    v_pk_mul_f32 v[90:91], v[90:91], v[2:3] op_sel_hi:[1,0]
    v_smfmac_f32_16x16x64_bf16 v[60:63], v[116:119], v[104:111], v5
    v_cvt_pk_bf16_f32 v100, v83, v88
    v_cvt_pk_bf16_f32 v101, v80, v89
    v_smfmac_f32_16x16x64_bf16 v[60:63], v[96:99], v[44:51], v5
    v_cvt_pk_bf16_f32 v102, v81, v90
    v_cvt_pk_bf16_f32 v103, v82, v91
    s_nop 1
    v_smfmac_f32_16x16x64_bf16 v[60:63], v[100:103], v[52:59], v5
ch1bs_kj:
    v_mov_b32 v44, 0
    v_mov_b32 v45, 0
    v_mov_b32 v46, 0
    v_mov_b32 v47, 0
    s_nop 3
    v_add_f32 v60, v60, v62
    v_add_f32 v61, v61, v63
    ds_write2_b32 v11, v60, v61 offset0:0 offset1:16
    v_mov_b32 v48, 0
    v_mov_b32 v49, 0
    v_mov_b32 v50, 0
    v_mov_b32 v51, 0
    v_mov_b32 v52, 0
    v_mov_b32 v53, 0
    v_mov_b32 v54, 0
    v_mov_b32 v55, 0
    v_mov_b32 v56, 0
    v_mov_b32 v57, 0
    v_mov_b32 v58, 0
    v_mov_b32 v59, 0
    v_mov_b32 v112, 0
    v_mov_b32 v113, 0
    v_mov_b32 v114, 0
    v_mov_b32 v115, 0
    s_waitcnt lgkmcnt(0)
    s_barrier
    s_barrier
    s_add_u32 s64, s64, 1
    s_cmp_lt_u32 s64, 63
    s_cbranch_scc1 ch1bs_loop
    s_and_b32 s8, s64, 3
    s_lshl_b32 s65, s8, 13
    s_add_u32 s65, s65, 94898176
    v_mov_b32 v60, 0
    v_mov_b32 v61, 0
    v_mov_b32 v62, 0
    v_mov_b32 v63, 0
    v_mov_b32 v64, 0
    v_mov_b32 v65, 0
    v_mov_b32 v66, 0
    v_mov_b32 v67, 0
    v_mov_b32 v68, 0
    v_mov_b32 v69, 0
    v_mov_b32 v70, 0
    v_mov_b32 v71, 0
    v_mov_b32 v72, 0
    v_mov_b32 v73, 0
    v_mov_b32 v74, 0
    v_mov_b32 v75, 0
    buffer_load_dwordx4 v[76:79], v1, s[44:47], s65 offen offset:0 sc1
    buffer_load_dwordx4 v[80:83], v1, s[44:47], s65 offen offset:1024 sc1
    s_mov_b32 s83, 0
ch1bst_mp:
    buffer_load_dwordx4 v[24:27], v1, s[44:47], s65 offen offset:0 sc1
    buffer_load_dwordx4 v[28:31], v1, s[44:47], s65 offen offset:1024 sc1
    s_waitcnt vmcnt(3)
    v_max3_u32 v2, v76, v77, v78
    s_waitcnt vmcnt(2)
    v_max3_u32 v2, v2, v79, v80
    v_max3_u32 v2, v2, v81, v82
    v_max_u32 v2, v2, v83
    v_cmp_eq_u32 vcc, -1, v2
    s_cbranch_vccz ch1bst_g1
    buffer_load_dwordx4 v[76:79], v1, s[44:47], s65 offen offset:0 sc1
    buffer_load_dwordx4 v[80:83], v1, s[44:47], s65 offen offset:1024 sc1
    s_add_u32 s83, s83, 1
    s_cmp_ge_u32 s83, 2000000
    s_cbranch_scc1 chain_abort
    s_waitcnt vmcnt(3)
    v_max3_u32 v2, v24, v25, v26
    s_waitcnt vmcnt(2)
    v_max3_u32 v2, v2, v27, v28
    v_max3_u32 v2, v2, v29, v30
    v_max_u32 v2, v2, v31
    v_cmp_eq_u32 vcc, -1, v2
    s_cbranch_vccnz ch1bst_mp
ch1bst_g1:
    s_waitcnt vmcnt(0)
    ds_write_b128 v1, v[24:27] offset:2048
    ds_write_b128 v1, v[28:31] offset:3072
    s_waitcnt lgkmcnt(0)
    s_barrier
    ds_read_b128 v[16:19], v1 offset:0
    ds_read_b128 v[20:23], v1 offset:1024
    ds_read_b128 v[32:35], v1 offset:4096
    ds_read_b128 v[36:39], v1 offset:5120
    ds_read_b128 v[40:43], v1 offset:6144
    s_waitcnt lgkmcnt(0)
    ds_read_b128 v[44:47], v12 offset:0
    ds_read_b128 v[48:51], v12 offset:1024
    ds_read_b128 v[52:55], v12 offset:2048
    ds_read_b128 v[56:59], v12 offset:3072
    v_smfmac_f32_16x16x64_bf16 v[60:63], v[16:19], a[224:231], v5
    v_smfmac_f32_16x16x64_bf16 v[60:63], v[20:23], a[232:239], v5
    v_smfmac_f32_16x16x64_bf16 v[60:63], v[24:27], a[240:247], v5
    s_waitcnt lgkmcnt(2)
    v_smfmac_f32_16x16x64_bf16 v[72:75], v[16:19], v[44:51], v5
    ds_read_b128 v[44:47], v12 offset:4096
    ds_read_b128 v[48:51], v12 offset:5120
    v_smfmac_f32_16x16x64_bf16 v[60:63], v[28:31], a[248:255], v5
    v_smfmac_f32_16x16x64_bf16 v[60:63], v[32:35], v[120:127], v5
    v_smfmac_f32_16x16x64_bf16 v[60:63], v[36:39], v[128:135], v5
    s_waitcnt lgkmcnt(2)
    v_smfmac_f32_16x16x64_bf16 v[72:75], v[20:23], v[52:59], v5
    ds_read_b128 v[52:55], v12 offset:6144
    ds_read_b128 v[56:59], v12 offset:7168
    v_smfmac_f32_16x16x64_bf16 v[60:63], v[40:43], v[136:143], v5
    v_smfmac_f32_16x16x64_bf16 v[64:67], v[16:19], v[144:151], v5
    v_smfmac_f32_16x16x64_bf16 v[64:67], v[20:23], v[152:159], v5
    s_waitcnt lgkmcnt(2)
    v_smfmac_f32_16x16x64_bf16 v[72:75], v[24:27], v[44:51], v5
    ds_read_b128 v[44:47], v12 offset:8192
    ds_read_b128 v[48:51], v12 offset:9216
    v_smfmac_f32_16x16x64_bf16 v[64:67], v[24:27], v[160:167], v5
    v_smfmac_f32_16x16x64_bf16 v[64:67], v[28:31], v[168:175], v5
    v_add_f32 v60, v60, v62
    v_smfmac_f32_16x16x64_bf16 v[64:67], v[32:35], v[176:183], v5
    v_add_f32 v61, v61, v63
    s_waitcnt lgkmcnt(2)
    v_smfmac_f32_16x16x64_bf16 v[72:75], v[28:31], v[52:59], v5
    ds_read_b128 v[52:55], v12 offset:10240
    ds_read_b128 v[56:59], v12 offset:11264
    v_smfmac_f32_16x16x64_bf16 v[64:67], v[36:39], v[184:191], v5
    v_cvt_pk_bf16_f32 v104, v60, v61
    v_smfmac_f32_16x16x64_bf16 v[64:67], v[40:43], v[192:199], v5
    v_mov_b32 v60, 0
    v_smfmac_f32_16x16x64_bf16 v[68:71], v[16:19], v[200:207], v5
    v_mov_b32 v61, 0
    s_waitcnt lgkmcnt(2)
    v_smfmac_f32_16x16x64_bf16 v[72:75], v[32:35], v[44:51], v5
    ds_read_b128 v[44:47], v12 offset:12288
    ds_read_b128 v[48:51], v12 offset:13312
    v_smfmac_f32_16x16x64_bf16 v[68:71], v[20:23], v[208:215], v5
    v_mov_b32 v62, 0
    v_smfmac_f32_16x16x64_bf16 v[68:71], v[24:27], v[216:223], v5
    v_mov_b32 v63, 0
    v_smfmac_f32_16x16x64_bf16 v[68:71], v[28:31], v[224:231], v5
    v_add_f32 v64, v64, v66
    s_waitcnt lgkmcnt(2)
    v_smfmac_f32_16x16x64_bf16 v[72:75], v[36:39], v[52:59], v5
    v_smfmac_f32_16x16x64_bf16 v[68:71], v[32:35], v[232:239], v5
    v_add_f32 v65, v65, v67
    v_smfmac_f32_16x16x64_bf16 v[68:71], v[36:39], v[240:247], v5
    v_cvt_pk_bf16_f32 v105, v64, v65
    v_smfmac_f32_16x16x64_bf16 v[68:71], v[40:43], v[248:255], v5
    s_waitcnt lgkmcnt(0)
    v_smfmac_f32_16x16x64_bf16 v[72:75], v[40:43], v[44:51], v5
    s_nop 5
    v_add_f32 v68, v68, v70
    v_add_f32 v69, v69, v71
    v_cvt_pk_bf16_f32 v108, v68, v69
    v_add_f32 v72, v72, v74
    v_add_f32 v73, v73, v75
    v_cvt_pk_bf16_f32 v109, v72, v73
    v_mov_b32 v106, v108
    v_mov_b32 v107, v109
    s_lshl_b32 s8, s82, 12
    s_add_u32 s8, s8, 91636736
    buffer_store_dwordx4 v[104:107], v1, s[44:47], s8 offen sc1
    s_waitcnt vmcnt(0)
    s_barrier
    s_endpgm
ch1bs_mp1:
    buffer_load_dwordx4 v[28:31], v1, s[44:47], s65 offen offset:1024 sc1
    s_add_u32 s83, s83, 1
    s_cmp_ge_u32 s83, 2000000
    s_cbranch_scc1 chain_abort
    s_waitcnt vmcnt(1)
    v_max3_u32 v2, v28, v29, v30
    v_max_u32 v2, v2, v31
    v_cmp_eq_u32 vcc, -1, v2
    s_cbranch_vccnz ch1bs_mp1
    s_branch ch1bs_mok
ch1bs_m0bad:
    s_cbranch_vccnz ch1bs_mp
ch1bs_mp0:
    buffer_load_dwordx4 v[24:27], v1, s[44:47], s65 offen offset:0 sc1
    s_add_u32 s83, s83, 1
    s_cmp_ge_u32 s83, 2000000
    s_cbranch_scc1 chain_abort
    s_waitcnt vmcnt(1)
    v_max3_u32 v2, v24, v25, v26
    v_max_u32 v2, v2, v27
    v_cmp_eq_u32 vcc, -1, v2
    s_cbranch_vccnz ch1bs_mp0
    s_branch ch1bs_mok
ch1bs_hl:
    buffer_load_dword v15, off, s[44:47], s73 sc1
    s_branch ch1bs_hs
ch1bs_hu:
    v_readfirstlane_b32 s9, v15
    s_max_u32 s100, s100, s9
    s_branch ch1bs_hv
ch1bs_nw:
    v_lshlrev_b32 v100, 7, v0
    s_mov_b32 s99, 0
hz_186:
    buffer_load_dword v101, v100, s[44:47], s75 offen sc1
    s_waitcnt vmcnt(0)
    v_cmp_gt_u32 vcc, 28, v101
    s_ff1_i32_b64 s100, vcc
    s_cmp_eq_u32 s100, -1
    s_cselect_b32 s100, 65, s100
    s_sub_u32 s100, s100, 1
    s_cmp_gt_i32 s100, s64
    s_cbranch_scc1 hd_187
    s_sleep 1
    s_add_u32 s99, s99, 1
    s_cmp_lt_u32 s99, 400000
    s_cbranch_scc1 hz_186
    s_branch chain_abort
hd_187:
    s_branch ch1bs_nw2
ch1bs_k0:
    s_cmp_eq_u32 s98, 1
    s_cbranch_scc1 ch1bs_w2d
    s_cmp_ge_u32 s64, s100
    s_cbranch_scc1 ch1bs_vw
ch1bs_vok:
    s_mov_b32 m0, 20480
    s_waitcnt lgkmcnt(0)
    buffer_load_dwordx4 v1, s[44:47], s71 offen offset:0 sc1 lds
    buffer_load_dwordx4 v1, s[44:47], s71 offen offset:1024 sc1 lds
    s_branch ch1bs_w2d
ch1bs_i0:
    buffer_load_dwordx4 v[76:79], v1, s[44:47], s67 offen offset:0 sc1
    buffer_load_dwordx4 v[84:87], v1, s[44:47], s67 offen offset:2048 sc1
    s_add_u32 s83, s83, 1
    s_branch ch1bs_q120
ch1bs_i1:
    buffer_load_dwordx4 v[80:83], v1, s[44:47], s67 offen offset:1024 sc1
    buffer_load_dwordx4 v[88:91], v1, s[44:47], s67 offen offset:3072 sc1
    s_add_u32 s83, s83, 1
    s_branch ch1bs_q21
ch1bs_i2:
    buffer_load_dwordx4 v[92:95], v10, s[44:47], s67 offen offset:0 sc1
    s_add_u32 s83, s83, 1
    s_branch ch1bs_q2
ch1bs_q0:
    s_waitcnt vmcnt(0)
    v_fma_mix_f32 v102, v76, 1.0, v84 op_sel:[0,0,0] op_sel_hi:[1,0,1]
    v_fma_mix_f32 v84, v76, 1.0, v84 op_sel:[1,0,1] op_sel_hi:[1,0,1]
    v_fma_mix_f32 v76, v77, 1.0, v85 op_sel:[0,0,0] op_sel_hi:[1,0,1]
    v_fma_mix_f32 v85, v77, 1.0, v85 op_sel:[1,0,1] op_sel_hi:[1,0,1]
    v_fma_mix_f32 v77, v78, 1.0, v86 op_sel:[0,0,0] op_sel_hi:[1,0,1]
    v_fma_mix_f32 v86, v78, 1.0, v86 op_sel:[1,0,1] op_sel_hi:[1,0,1]
    v_fma_mix_f32 v78, v79, 1.0, v87 op_sel:[0,0,0] op_sel_hi:[1,0,1]
    v_fma_mix_f32 v87, v79, 1.0, v87 op_sel:[1,0,1] op_sel_hi:[1,0,1]
    v_maximum3_f32 v112, v84, v85, v86
    v_cmp_u_f32 vcc, v112, v87
    v_exp_f32 v76, v76
    v_exp_f32 v77, v77
    v_exp_f32 v78, v78
    s_cbranch_vccnz ch1bs_q0_e
    v_exp_f32 v79, v102
    v_exp_f32 v84, v84
    v_exp_f32 v85, v85
    v_pk_add_f32 v[96:97], v[76:77], v[78:79]
    v_exp_f32 v86, v86
    v_exp_f32 v87, v87
    v_pk_add_f32 v[96:97], v[96:97], v[84:85]
    v_pk_add_f32 v[96:97], v[96:97], v[86:87]
    s_branch ch1bs_k0
ch1bs_q0_e:
    buffer_load_dwordx4 v[76:79], v1, s[44:47], s67 offen offset:0 sc1
    buffer_load_dwordx4 v[84:87], v1, s[44:47], s67 offen offset:2048 sc1
    s_add_u32 s83, s83, 1
    s_and_b32 s8, s83, 63
    s_cmp_eq_u32 s8, 0
    s_cbranch_scc1 ch1bs_x
    s_branch ch1bs_q0
ch1bs_q1:
    s_waitcnt vmcnt(0)
    v_fma_mix_f32 v103, v80, 1.0, v88 op_sel:[0,0,0] op_sel_hi:[1,0,1]
    v_fma_mix_f32 v88, v80, 1.0, v88 op_sel:[1,0,1] op_sel_hi:[1,0,1]
    v_fma_mix_f32 v80, v81, 1.0, v89 op_sel:[0,0,0] op_sel_hi:[1,0,1]
    v_fma_mix_f32 v89, v81, 1.0, v89 op_sel:[1,0,1] op_sel_hi:[1,0,1]
    v_fma_mix_f32 v81, v82, 1.0, v90 op_sel:[0,0,0] op_sel_hi:[1,0,1]
    v_fma_mix_f32 v90, v82, 1.0, v90 op_sel:[1,0,1] op_sel_hi:[1,0,1]
    v_fma_mix_f32 v82, v83, 1.0, v91 op_sel:[0,0,0] op_sel_hi:[1,0,1]
    v_fma_mix_f32 v91, v83, 1.0, v91 op_sel:[1,0,1] op_sel_hi:[1,0,1]
    v_maximum3_f32 v114, v88, v89, v90
    v_cmp_u_f32 vcc, v114, v91
    v_exp_f32 v80, v80
    v_exp_f32 v81, v81
    v_exp_f32 v82, v82
    s_cbranch_vccnz ch1bs_q1_e
    v_exp_f32 v83, v103
    v_exp_f32 v88, v88
    v_exp_f32 v89, v89
    v_pk_add_f32 v[98:99], v[80:81], v[82:83]
    v_exp_f32 v90, v90
    v_exp_f32 v91, v91
    v_pk_add_f32 v[98:99], v[98:99], v[88:89]
    v_pk_add_f32 v[98:99], v[98:99], v[90:91]
    s_branch ch1bs_k0
ch1bs_q1_e:
    buffer_load_dwordx4 v[80:83], v1, s[44:47], s67 offen offset:1024 sc1
    buffer_load_dwordx4 v[88:91], v1, s[44:47], s67 offen offset:3072 sc1
    s_add_u32 s83, s83, 1
    s_and_b32 s8, s83, 63
    s_cmp_eq_u32 s8, 0
    s_cbranch_scc1 ch1bs_x
    s_branch ch1bs_q1
ch1bs_q2:
    s_waitcnt vmcnt(0)
    v_fma_mix_f32 v113, v92, 1.0, v94 op_sel:[0,0,0] op_sel_hi:[1,0,1]
    v_fma_mix_f32 v94, v92, 1.0, v94 op_sel:[1,0,1] op_sel_hi:[1,0,1]
    v_fma_mix_f32 v92, v93, 1.0, v95 op_sel:[0,0,0] op_sel_hi:[1,0,1]
    v_fma_mix_f32 v95, v93, 1.0, v95 op_sel:[1,0,1] op_sel_hi:[1,0,1]
    v_cmp_u_f32 vcc, v94, v95
    v_exp_f32 v92, v92
    v_exp_f32 v93, v113
    v_exp_f32 v94, v94
    s_cbranch_vccnz ch1bs_q2_e
    v_exp_f32 v95, v95
    s_nop 0
    v_pk_add_f32 v[100:101], v[92:93], v[94:95]
    s_branch ch1bs_k0
ch1bs_q2_e:
    buffer_load_dwordx4 v[92:95], v10, s[44:47], s67 offen offset:0 sc1
    s_add_u32 s83, s83, 1
    s_and_b32 s8, s83, 63
    s_cmp_eq_u32 s8, 0
    s_cbranch_scc1 ch1bs_x
    s_branch ch1bs_q2
ch1bs_q01:
    s_waitcnt vmcnt(2)
    v_fma_mix_f32 v102, v76, 1.0, v84 op_sel:[0,0,0] op_sel_hi:[1,0,1]
    v_fma_mix_f32 v84, v76, 1.0, v84 op_sel:[1,0,1] op_sel_hi:[1,0,1]
    v_fma_mix_f32 v76, v77, 1.0, v85 op_sel:[0,0,0] op_sel_hi:[1,0,1]
    v_fma_mix_f32 v85, v77, 1.0, v85 op_sel:[1,0,1] op_sel_hi:[1,0,1]
    v_fma_mix_f32 v77, v78, 1.0, v86 op_sel:[0,0,0] op_sel_hi:[1,0,1]
    v_fma_mix_f32 v86, v78, 1.0, v86 op_sel:[1,0,1] op_sel_hi:[1,0,1]
    v_fma_mix_f32 v78, v79, 1.0, v87 op_sel:[0,0,0] op_sel_hi:[1,0,1]
    v_fma_mix_f32 v87, v79, 1.0, v87 op_sel:[1,0,1] op_sel_hi:[1,0,1]
    v_maximum3_f32 v112, v84, v85, v86
    v_cmp_u_f32 vcc, v112, v87
    v_exp_f32 v76, v76
    v_exp_f32 v77, v77
    v_exp_f32 v78, v78
    s_cbranch_vccnz ch1bs_q01_e
    v_exp_f32 v79, v102
    v_exp_f32 v84, v84
    v_exp_f32 v85, v85
    v_pk_add_f32 v[96:97], v[76:77], v[78:79]
    v_exp_f32 v86, v86
    v_exp_f32 v87, v87
    v_pk_add_f32 v[96:97], v[96:97], v[84:85]
    v_pk_add_f32 v[96:97], v[96:97], v[86:87]
    s_branch ch1bs_q1
ch1bs_q01_e:
    buffer_load_dwordx4 v[76:79], v1, s[44:47], s67 offen offset:0 sc1
    buffer_load_dwordx4 v[84:87], v1, s[44:47], s67 offen offset:2048 sc1
    s_add_u32 s83, s83, 1
    s_and_b32 s8, s83, 63
    s_cmp_eq_u32 s8, 0
    s_cbranch_scc1 ch1bs_x
    s_branch ch1bs_q10
ch1bs_q02:
    s_waitcnt vmcnt(1)
    v_fma_mix_f32 v102, v76, 1.0, v84 op_sel:[0,0,0] op_sel_hi:[1,0,1]
    v_fma_mix_f32 v84, v76, 1.0, v84 op_sel:[1,0,1] op_sel_hi:[1,0,1]
    v_fma_mix_f32 v76, v77, 1.0, v85 op_sel:[0,0,0] op_sel_hi:[1,0,1]
    v_fma_mix_f32 v85, v77, 1.0, v85 op_sel:[1,0,1] op_sel_hi:[1,0,1]
    v_fma_mix_f32 v77, v78, 1.0, v86 op_sel:[0,0,0] op_sel_hi:[1,0,1]
    v_fma_mix_f32 v86, v78, 1.0, v86 op_sel:[1,0,1] op_sel_hi:[1,0,1]
    v_fma_mix_f32 v78, v79, 1.0, v87 op_sel:[0,0,0] op_sel_hi:[1,0,1]
    v_fma_mix_f32 v87, v79, 1.0, v87 op_sel:[1,0,1] op_sel_hi:[1,0,1]
    v_maximum3_f32 v112, v84, v85, v86
    v_cmp_u_f32 vcc, v112, v87
    v_exp_f32 v76, v76
    v_exp_f32 v77, v77
    v_exp_f32 v78, v78
    s_cbranch_vccnz ch1bs_q02_e
    v_exp_f32 v79, v102
    v_exp_f32 v84, v84
    v_exp_f32 v85, v85
    v_pk_add_f32 v[96:97], v[76:77], v[78:79]
    v_exp_f32 v86, v86
    v_exp_f32 v87, v87
    v_pk_add_f32 v[96:97], v[96:97], v[84:85]
    v_pk_add_f32 v[96:97], v[96:97], v[86:87]
    s_branch ch1bs_q2
ch1bs_q02_e:
    buffer_load_dwordx4 v[76:79], v1, s[44:47], s67 offen offset:0 sc1
    buffer_load_dwordx4 v[84:87], v1, s[44:47], s67 offen offset:2048 sc1
    s_add_u32 s83, s83, 1
    s_and_b32 s8, s83, 63
    s_cmp_eq_u32 s8, 0
    s_cbranch_scc1 ch1bs_x
    s_branch ch1bs_q20
ch1bs_q10:
    s_waitcnt vmcnt(2)
    v_fma_mix_f32 v103, v80, 1.0, v88 op_sel:[0,0,0] op_sel_hi:[1,0,1]
    v_fma_mix_f32 v88, v80, 1.0, v88 op_sel:[1,0,1] op_sel_hi:[1,0,1]
    v_fma_mix_f32 v80, v81, 1.0, v89 op_sel:[0,0,0] op_sel_hi:[1,0,1]
    v_fma_mix_f32 v89, v81, 1.0, v89 op_sel:[1,0,1] op_sel_hi:[1,0,1]
    v_fma_mix_f32 v81, v82, 1.0, v90 op_sel:[0,0,0] op_sel_hi:[1,0,1]
    v_fma_mix_f32 v90, v82, 1.0, v90 op_sel:[1,0,1] op_sel_hi:[1,0,1]
    v_fma_mix_f32 v82, v83, 1.0, v91 op_sel:[0,0,0] op_sel_hi:[1,0,1]
    v_fma_mix_f32 v91, v83, 1.0, v91 op_sel:[1,0,1] op_sel_hi:[1,0,1]
    v_maximum3_f32 v114, v88, v89, v90
    v_cmp_u_f32 vcc, v114, v91
    v_exp_f32 v80, v80
    v_exp_f32 v81, v81
    v_exp_f32 v82, v82
    s_cbranch_vccnz ch1bs_q10_e
    v_exp_f32 v83, v103
    v_exp_f32 v88, v88
    v_exp_f32 v89, v89
    v_pk_add_f32 v[98:99], v[80:81], v[82:83]
    v_exp_f32 v90, v90
    v_exp_f32 v91, v91
    v_pk_add_f32 v[98:99], v[98:99], v[88:89]
    v_pk_add_f32 v[98:99], v[98:99], v[90:91]
    s_branch ch1bs_q0
ch1bs_q10_e:
    buffer_load_dwordx4 v[80:83], v1, s[44:47], s67 offen offset:1024 sc1
    buffer_load_dwordx4 v[88:91], v1, s[44:47], s67 offen offset:3072 sc1
    s_add_u32 s83, s83, 1
    s_and_b32 s8, s83, 63
    s_cmp_eq_u32 s8, 0
    s_cbranch_scc1 ch1bs_x
    s_branch ch1bs_q01
ch1bs_q12:
    s_waitcnt vmcnt(1)
    v_fma_mix_f32 v103, v80, 1.0, v88 op_sel:[0,0,0] op_sel_hi:[1,0,1]
    v_fma_mix_f32 v88, v80, 1.0, v88 op_sel:[1,0,1] op_sel_hi:[1,0,1]
    v_fma_mix_f32 v80, v81, 1.0, v89 op_sel:[0,0,0] op_sel_hi:[1,0,1]
    v_fma_mix_f32 v89, v81, 1.0, v89 op_sel:[1,0,1] op_sel_hi:[1,0,1]
    v_fma_mix_f32 v81, v82, 1.0, v90 op_sel:[0,0,0] op_sel_hi:[1,0,1]
    v_fma_mix_f32 v90, v82, 1.0, v90 op_sel:[1,0,1] op_sel_hi:[1,0,1]
    v_fma_mix_f32 v82, v83, 1.0, v91 op_sel:[0,0,0] op_sel_hi:[1,0,1]
    v_fma_mix_f32 v91, v83, 1.0, v91 op_sel:[1,0,1] op_sel_hi:[1,0,1]
    v_maximum3_f32 v114, v88, v89, v90
    v_cmp_u_f32 vcc, v114, v91
    v_exp_f32 v80, v80
    v_exp_f32 v81, v81
    v_exp_f32 v82, v82
    s_cbranch_vccnz ch1bs_q12_e
    v_exp_f32 v83, v103
    v_exp_f32 v88, v88
    v_exp_f32 v89, v89
    v_pk_add_f32 v[98:99], v[80:81], v[82:83]
    v_exp_f32 v90, v90
    v_exp_f32 v91, v91
    v_pk_add_f32 v[98:99], v[98:99], v[88:89]
    v_pk_add_f32 v[98:99], v[98:99], v[90:91]
    s_branch ch1bs_q2
ch1bs_q12_e:
    buffer_load_dwordx4 v[80:83], v1, s[44:47], s67 offen offset:1024 sc1
    buffer_load_dwordx4 v[88:91], v1, s[44:47], s67 offen offset:3072 sc1
    s_add_u32 s83, s83, 1
    s_and_b32 s8, s83, 63
    s_cmp_eq_u32 s8, 0
    s_cbranch_scc1 ch1bs_x
    s_branch ch1bs_q21
ch1bs_q20:
    s_waitcnt vmcnt(2)
    v_fma_mix_f32 v113, v92, 1.0, v94 op_sel:[0,0,0] op_sel_hi:[1,0,1]
    v_fma_mix_f32 v94, v92, 1.0, v94 op_sel:[1,0,1] op_sel_hi:[1,0,1]
    v_fma_mix_f32 v92, v93, 1.0, v95 op_sel:[0,0,0] op_sel_hi:[1,0,1]
    v_fma_mix_f32 v95, v93, 1.0, v95 op_sel:[1,0,1] op_sel_hi:[1,0,1]
    v_cmp_u_f32 vcc, v94, v95
    v_exp_f32 v92, v92
    v_exp_f32 v93, v113
    v_exp_f32 v94, v94
    s_cbranch_vccnz ch1bs_q20_e
    v_exp_f32 v95, v95
    s_nop 0
    v_pk_add_f32 v[100:101], v[92:93], v[94:95]
    s_branch ch1bs_q0
ch1bs_q20_e:
    buffer_load_dwordx4 v[92:95], v10, s[44:47], s67 offen offset:0 sc1
    s_add_u32 s83, s83, 1
    s_and_b32 s8, s83, 63
    s_cmp_eq_u32 s8, 0
    s_cbranch_scc1 ch1bs_x
    s_branch ch1bs_q02
ch1bs_q21:
    s_waitcnt vmcnt(2)
    v_fma_mix_f32 v113, v92, 1.0, v94 op_sel:[0,0,0] op_sel_hi:[1,0,1]
    v_fma_mix_f32 v94, v92, 1.0, v94 op_sel:[1,0,1] op_sel_hi:[1,0,1]
    v_fma_mix_f32 v92, v93, 1.0, v95 op_sel:[0,0,0] op_sel_hi:[1,0,1]
    v_fma_mix_f32 v95, v93, 1.0, v95 op_sel:[1,0,1] op_sel_hi:[1,0,1]
    v_cmp_u_f32 vcc, v94, v95
    v_exp_f32 v92, v92
    v_exp_f32 v93, v113
    v_exp_f32 v94, v94
    s_cbranch_vccnz ch1bs_q21_e
    v_exp_f32 v95, v95
    s_nop 0
    v_pk_add_f32 v[100:101], v[92:93], v[94:95]
    s_branch ch1bs_q1
ch1bs_q21_e:
    buffer_load_dwordx4 v[92:95], v10, s[44:47], s67 offen offset:0 sc1
    s_add_u32 s83, s83, 1
    s_and_b32 s8, s83, 63
    s_cmp_eq_u32 s8, 0
    s_cbranch_scc1 ch1bs_x
    s_branch ch1bs_q12
ch1bs_q012:
    s_waitcnt vmcnt(3)
    v_fma_mix_f32 v102, v76, 1.0, v84 op_sel:[0,0,0] op_sel_hi:[1,0,1]
    v_fma_mix_f32 v84, v76, 1.0, v84 op_sel:[1,0,1] op_sel_hi:[1,0,1]
    v_fma_mix_f32 v76, v77, 1.0, v85 op_sel:[0,0,0] op_sel_hi:[1,0,1]
    v_fma_mix_f32 v85, v77, 1.0, v85 op_sel:[1,0,1] op_sel_hi:[1,0,1]
    v_fma_mix_f32 v77, v78, 1.0, v86 op_sel:[0,0,0] op_sel_hi:[1,0,1]
    v_fma_mix_f32 v86, v78, 1.0, v86 op_sel:[1,0,1] op_sel_hi:[1,0,1]
    v_fma_mix_f32 v78, v79, 1.0, v87 op_sel:[0,0,0] op_sel_hi:[1,0,1]
    v_fma_mix_f32 v87, v79, 1.0, v87 op_sel:[1,0,1] op_sel_hi:[1,0,1]
    v_maximum3_f32 v112, v84, v85, v86
    v_cmp_u_f32 vcc, v112, v87
    v_exp_f32 v76, v76
    v_exp_f32 v77, v77
    v_exp_f32 v78, v78
    s_cbranch_vccnz ch1bs_q012_e
    v_exp_f32 v79, v102
    v_exp_f32 v84, v84
    v_exp_f32 v85, v85
    v_pk_add_f32 v[96:97], v[76:77], v[78:79]
    v_exp_f32 v86, v86
    v_exp_f32 v87, v87
    v_pk_add_f32 v[96:97], v[96:97], v[84:85]
    v_pk_add_f32 v[96:97], v[96:97], v[86:87]
    s_branch ch1bs_q12
ch1bs_q012_e:
    buffer_load_dwordx4 v[76:79], v1, s[44:47], s67 offen offset:0 sc1
    buffer_load_dwordx4 v[84:87], v1, s[44:47], s67 offen offset:2048 sc1
    s_add_u32 s83, s83, 1
    s_and_b32 s8, s83, 63
    s_cmp_eq_u32 s8, 0
    s_cbranch_scc1 ch1bs_x
    s_branch ch1bs_q120
ch1bs_q021:
    s_waitcnt vmcnt(3)
    v_fma_mix_f32 v102, v76, 1.0, v84 op_sel:[0,0,0] op_sel_hi:[1,0,1]
    v_fma_mix_f32 v84, v76, 1.0, v84 op_sel:[1,0,1] op_sel_hi:[1,0,1]
    v_fma_mix_f32 v76, v77, 1.0, v85 op_sel:[0,0,0] op_sel_hi:[1,0,1]
    v_fma_mix_f32 v85, v77, 1.0, v85 op_sel:[1,0,1] op_sel_hi:[1,0,1]
    v_fma_mix_f32 v77, v78, 1.0, v86 op_sel:[0,0,0] op_sel_hi:[1,0,1]
    v_fma_mix_f32 v86, v78, 1.0, v86 op_sel:[1,0,1] op_sel_hi:[1,0,1]
    v_fma_mix_f32 v78, v79, 1.0, v87 op_sel:[0,0,0] op_sel_hi:[1,0,1]
    v_fma_mix_f32 v87, v79, 1.0, v87 op_sel:[1,0,1] op_sel_hi:[1,0,1]
    v_maximum3_f32 v112, v84, v85, v86
    v_cmp_u_f32 vcc, v112, v87
    v_exp_f32 v76, v76
    v_exp_f32 v77, v77
    v_exp_f32 v78, v78
    s_cbranch_vccnz ch1bs_q021_e
    v_exp_f32 v79, v102
    v_exp_f32 v84, v84
    v_exp_f32 v85, v85
    v_pk_add_f32 v[96:97], v[76:77], v[78:79]
    v_exp_f32 v86, v86
    v_exp_f32 v87, v87
    v_pk_add_f32 v[96:97], v[96:97], v[84:85]
    v_pk_add_f32 v[96:97], v[96:97], v[86:87]
    s_branch ch1bs_q21
ch1bs_q021_e:
    buffer_load_dwordx4 v[76:79], v1, s[44:47], s67 offen offset:0 sc1
    buffer_load_dwordx4 v[84:87], v1, s[44:47], s67 offen offset:2048 sc1
    s_add_u32 s83, s83, 1
    s_and_b32 s8, s83, 63
    s_cmp_eq_u32 s8, 0
    s_cbranch_scc1 ch1bs_x
    s_branch ch1bs_q210
ch1bs_q102:
    s_waitcnt vmcnt(3)
    v_fma_mix_f32 v103, v80, 1.0, v88 op_sel:[0,0,0] op_sel_hi:[1,0,1]
    v_fma_mix_f32 v88, v80, 1.0, v88 op_sel:[1,0,1] op_sel_hi:[1,0,1]
    v_fma_mix_f32 v80, v81, 1.0, v89 op_sel:[0,0,0] op_sel_hi:[1,0,1]
    v_fma_mix_f32 v89, v81, 1.0, v89 op_sel:[1,0,1] op_sel_hi:[1,0,1]
    v_fma_mix_f32 v81, v82, 1.0, v90 op_sel:[0,0,0] op_sel_hi:[1,0,1]
    v_fma_mix_f32 v90, v82, 1.0, v90 op_sel:[1,0,1] op_sel_hi:[1,0,1]
    v_fma_mix_f32 v82, v83, 1.0, v91 op_sel:[0,0,0] op_sel_hi:[1,0,1]
    v_fma_mix_f32 v91, v83, 1.0, v91 op_sel:[1,0,1] op_sel_hi:[1,0,1]
    v_maximum3_f32 v114, v88, v89, v90
    v_cmp_u_f32 vcc, v114, v91
    v_exp_f32 v80, v80
    v_exp_f32 v81, v81
    v_exp_f32 v82, v82
    s_cbranch_vccnz ch1bs_q102_e
    v_exp_f32 v83, v103
    v_exp_f32 v88, v88
    v_exp_f32 v89, v89
    v_pk_add_f32 v[98:99], v[80:81], v[82:83]
    v_exp_f32 v90, v90
    v_exp_f32 v91, v91
    v_pk_add_f32 v[98:99], v[98:99], v[88:89]
    v_pk_add_f32 v[98:99], v[98:99], v[90:91]
    s_branch ch1bs_q02
ch1bs_q102_e:
    buffer_load_dwordx4 v[80:83], v1, s[44:47], s67 offen offset:1024 sc1
    buffer_load_dwordx4 v[88:91], v1, s[44:47], s67 offen offset:3072 sc1
    s_add_u32 s83, s83, 1
    s_and_b32 s8, s83, 63
    s_cmp_eq_u32 s8, 0
    s_cbranch_scc1 ch1bs_x
    s_branch ch1bs_q021
ch1bs_q120:
    s_waitcnt vmcnt(3)
    v_fma_mix_f32 v103, v80, 1.0, v88 op_sel:[0,0,0] op_sel_hi:[1,0,1]
    v_fma_mix_f32 v88, v80, 1.0, v88 op_sel:[1,0,1] op_sel_hi:[1,0,1]
    v_fma_mix_f32 v80, v81, 1.0, v89 op_sel:[0,0,0] op_sel_hi:[1,0,1]
    v_fma_mix_f32 v89, v81, 1.0, v89 op_sel:[1,0,1] op_sel_hi:[1,0,1]
    v_fma_mix_f32 v81, v82, 1.0, v90 op_sel:[0,0,0] op_sel_hi:[1,0,1]
    v_fma_mix_f32 v90, v82, 1.0, v90 op_sel:[1,0,1] op_sel_hi:[1,0,1]
    v_fma_mix_f32 v82, v83, 1.0, v91 op_sel:[0,0,0] op_sel_hi:[1,0,1]
    v_fma_mix_f32 v91, v83, 1.0, v91 op_sel:[1,0,1] op_sel_hi:[1,0,1]
    v_maximum3_f32 v114, v88, v89, v90
    v_cmp_u_f32 vcc, v114, v91
    v_exp_f32 v80, v80
    v_exp_f32 v81, v81
    v_exp_f32 v82, v82
    s_cbranch_vccnz ch1bs_q120_e
    v_exp_f32 v83, v103
    v_exp_f32 v88, v88
    v_exp_f32 v89, v89
    v_pk_add_f32 v[98:99], v[80:81], v[82:83]
    v_exp_f32 v90, v90
    v_exp_f32 v91, v91
    v_pk_add_f32 v[98:99], v[98:99], v[88:89]
    v_pk_add_f32 v[98:99], v[98:99], v[90:91]
    s_branch ch1bs_q20
ch1bs_q120_e:
    buffer_load_dwordx4 v[80:83], v1, s[44:47], s67 offen offset:1024 sc1
    buffer_load_dwordx4 v[88:91], v1, s[44:47], s67 offen offset:3072 sc1
    s_add_u32 s83, s83, 1
    s_and_b32 s8, s83, 63
    s_cmp_eq_u32 s8, 0
    s_cbranch_scc1 ch1bs_x
    s_branch ch1bs_q201
ch1bs_q201:
    s_waitcnt vmcnt(4)
    v_fma_mix_f32 v113, v92, 1.0, v94 op_sel:[0,0,0] op_sel_hi:[1,0,1]
    v_fma_mix_f32 v94, v92, 1.0, v94 op_sel:[1,0,1] op_sel_hi:[1,0,1]
    v_fma_mix_f32 v92, v93, 1.0, v95 op_sel:[0,0,0] op_sel_hi:[1,0,1]
    v_fma_mix_f32 v95, v93, 1.0, v95 op_sel:[1,0,1] op_sel_hi:[1,0,1]
    v_cmp_u_f32 vcc, v94, v95
    v_exp_f32 v92, v92
    v_exp_f32 v93, v113
    v_exp_f32 v94, v94
    s_cbranch_vccnz ch1bs_q201_e
    v_exp_f32 v95, v95
    s_nop 0
    v_pk_add_f32 v[100:101], v[92:93], v[94:95]
    s_branch ch1bs_q01
ch1bs_q201_e:
    buffer_load_dwordx4 v[92:95], v10, s[44:47], s67 offen offset:0 sc1
    s_add_u32 s83, s83, 1
    s_and_b32 s8, s83, 63
    s_cmp_eq_u32 s8, 0
    s_cbranch_scc1 ch1bs_x
    s_branch ch1bs_q012
ch1bs_q210:
    s_waitcnt vmcnt(4)
    v_fma_mix_f32 v113, v92, 1.0, v94 op_sel:[0,0,0] op_sel_hi:[1,0,1]
    v_fma_mix_f32 v94, v92, 1.0, v94 op_sel:[1,0,1] op_sel_hi:[1,0,1]
    v_fma_mix_f32 v92, v93, 1.0, v95 op_sel:[0,0,0] op_sel_hi:[1,0,1]
    v_fma_mix_f32 v95, v93, 1.0, v95 op_sel:[1,0,1] op_sel_hi:[1,0,1]
    v_cmp_u_f32 vcc, v94, v95
    v_exp_f32 v92, v92
    v_exp_f32 v93, v113
    v_exp_f32 v94, v94
    s_cbranch_vccnz ch1bs_q210_e
    v_exp_f32 v95, v95
    v_pk_add_f32 v[100:101], v[92:93], v[94:95]
    s_branch ch1bs_q10
ch1bs_q210_e:
    buffer_load_dwordx4 v[92:95], v10, s[44:47], s67 offen offset:0 sc1
    s_add_u32 s83, s83, 1
    s_and_b32 s8, s83, 63
    s_cmp_eq_u32 s8, 0
    s_cbranch_scc1 ch1bs_x
    s_branch ch1bs_q102
ch1bs_fb:
    buffer_load_dwordx4 v[76:79], v1, s[44:47], s67 offen offset:0 sc1
    buffer_load_dwordx4 v[84:87], v1, s[44:47], s67 offen offset:2048 sc1
    buffer_load_dwordx4 v[80:83], v1, s[44:47], s67 offen offset:1024 sc1
    buffer_load_dwordx4 v[88:91], v1, s[44:47], s67 offen offset:3072 sc1
    buffer_load_dwordx4 v[92:95], v10, s[44:47], s67 offen offset:0 sc1
    s_waitcnt vmcnt(0)
    v_fma_mix_f32 v102, v76, 1.0, v84 op_sel:[0,0,0] op_sel_hi:[1,0,1]
    v_fma_mix_f32 v84, v76, 1.0, v84 op_sel:[1,0,1] op_sel_hi:[1,0,1]
    v_fma_mix_f32 v76, v77, 1.0, v85 op_sel:[0,0,0] op_sel_hi:[1,0,1]
    v_fma_mix_f32 v85, v77, 1.0, v85 op_sel:[1,0,1] op_sel_hi:[1,0,1]
    v_fma_mix_f32 v77, v78, 1.0, v86 op_sel:[0,0,0] op_sel_hi:[1,0,1]
    v_fma_mix_f32 v86, v78, 1.0, v86 op_sel:[1,0,1] op_sel_hi:[1,0,1]
    v_fma_mix_f32 v78, v79, 1.0, v87 op_sel:[0,0,0] op_sel_hi:[1,0,1]
    v_fma_mix_f32 v87, v79, 1.0, v87 op_sel:[1,0,1] op_sel_hi:[1,0,1]
    v_maximum3_f32 v112, v102, v84, v76
    v_maximum3_f32 v112, v112, v85, v77
    v_maximum3_f32 v112, v112, v86, v78
    v_maximum3_f32 v112, v112, v87, v87
    v_cmp_u_f32 vcc, v112, v112
    v_mov_b32 v79, v102
    v_pk_add_f32 v[76:77], v[76:77], v[112:113] op_sel_hi:[1,0] neg_lo:[0,1] neg_hi:[0,1]
    v_pk_add_f32 v[78:79], v[78:79], v[112:113] op_sel_hi:[1,0] neg_lo:[0,1] neg_hi:[0,1]
    v_pk_add_f32 v[84:85], v[84:85], v[112:113] op_sel_hi:[1,0] neg_lo:[0,1] neg_hi:[0,1]
    v_pk_add_f32 v[86:87], v[86:87], v[112:113] op_sel_hi:[1,0] neg_lo:[0,1] neg_hi:[0,1]
    v_exp_f32 v76, v76
    v_exp_f32 v77, v77
    v_exp_f32 v78, v78
    v_exp_f32 v79, v79
    v_exp_f32 v84, v84
    v_exp_f32 v85, v85
    v_pk_add_f32 v[96:97], v[76:77], v[78:79]
    v_exp_f32 v86, v86
    v_exp_f32 v87, v87
    v_pk_add_f32 v[96:97], v[96:97], v[84:85]
    v_pk_add_f32 v[96:97], v[96:97], v[86:87]
    v_fma_mix_f32 v103, v80, 1.0, v88 op_sel:[0,0,0] op_sel_hi:[1,0,1]
    v_fma_mix_f32 v88, v80, 1.0, v88 op_sel:[1,0,1] op_sel_hi:[1,0,1]
    v_fma_mix_f32 v80, v81, 1.0, v89 op_sel:[0,0,0] op_sel_hi:[1,0,1]
    v_fma_mix_f32 v89, v81, 1.0, v89 op_sel:[1,0,1] op_sel_hi:[1,0,1]
    v_fma_mix_f32 v81, v82, 1.0, v90 op_sel:[0,0,0] op_sel_hi:[1,0,1]
    v_fma_mix_f32 v90, v82, 1.0, v90 op_sel:[1,0,1] op_sel_hi:[1,0,1]
    v_fma_mix_f32 v82, v83, 1.0, v91 op_sel:[0,0,0] op_sel_hi:[1,0,1]
    v_fma_mix_f32 v91, v83, 1.0, v91 op_sel:[1,0,1] op_sel_hi:[1,0,1]
    v_maximum3_f32 v114, v103, v88, v80
    v_maximum3_f32 v114, v114, v89, v81
    v_maximum3_f32 v114, v114, v90, v82
    v_maximum3_f32 v114, v114, v91, v91
    v_cmp_u_f32 vcc, v114, v114
    v_mov_b32 v83, v103
    v_pk_add_f32 v[80:81], v[80:81], v[114:115] op_sel_hi:[1,0] neg_lo:[0,1] neg_hi:[0,1]
    v_pk_add_f32 v[82:83], v[82:83], v[114:115] op_sel_hi:[1,0] neg_lo:[0,1] neg_hi:[0,1]
    v_pk_add_f32 v[88:89], v[88:89], v[114:115] op_sel_hi:[1,0] neg_lo:[0,1] neg_hi:[0,1]
    v_pk_add_f32 v[90:91], v[90:91], v[114:115] op_sel_hi:[1,0] neg_lo:[0,1] neg_hi:[0,1]
    v_exp_f32 v80, v80
    v_exp_f32 v81, v81
    v_exp_f32 v82, v82
    v_exp_f32 v83, v83
    v_exp_f32 v88, v88
    v_exp_f32 v89, v89
    v_pk_add_f32 v[98:99], v[80:81], v[82:83]
    v_exp_f32 v90, v90
    v_exp_f32 v91, v91
    v_pk_add_f32 v[98:99], v[98:99], v[88:89]
    v_pk_add_f32 v[98:99], v[98:99], v[90:91]
    v_fma_mix_f32 v113, v92, 1.0, v94 op_sel:[0,0,0] op_sel_hi:[1,0,1]
    v_fma_mix_f32 v94, v92, 1.0, v94 op_sel:[1,0,1] op_sel_hi:[1,0,1]
    v_fma_mix_f32 v92, v93, 1.0, v95 op_sel:[0,0,0] op_sel_hi:[1,0,1]
    v_fma_mix_f32 v95, v93, 1.0, v95 op_sel:[1,0,1] op_sel_hi:[1,0,1]
    v_maximum3_f32 v116, v113, v94, v92
    v_maximum3_f32 v116, v116, v95, v95
    v_cmp_u_f32 vcc, v116, v116
    v_mov_b32 v93, v113
    v_pk_add_f32 v[92:93], v[92:93], v[116:117] op_sel_hi:[1,0] neg_lo:[0,1] neg_hi:[0,1]
    v_pk_add_f32 v[94:95], v[94:95], v[116:117] op_sel_hi:[1,0] neg_lo:[0,1] neg_hi:[0,1]
    v_exp_f32 v92, v92
    v_exp_f32 v93, v93
    v_exp_f32 v94, v94
    v_exp_f32 v95, v95
    s_nop 0
    v_pk_add_f32 v[100:101], v[92:93], v[94:95]
    v_max3_f32 v2, v112, v114, v116
    v_max3_f32 v15, v112, v114, v116
    v_add_f32 v96, v96, v97
    v_add_f32 v98, v98, v99
    v_add_f32 v100, v100, v101
    v_permlane16_swap_b32 v2, v15
    v_max_f32 v2, v2, v15
    v_sub_f32 v112, v112, v2
    v_sub_f32 v114, v114, v2
    v_sub_f32 v116, v116, v2
    v_exp_f32 v112, v112
    v_exp_f32 v114, v114
    v_exp_f32 v116, v116
    v_mul_f32 v2, v112, v96
    v_fmac_f32 v2, v114, v98
    v_fmac_f32 v2, v116, v100
    v_mov_b32 v15, v2
    s_nop 1
    v_permlane16_swap_b32 v2, v15
    v_add_f32 v2, v2, v15
    v_rcp_f32 v2, v2
    s_nop 0
    v_mul_f32 v116, v116, v2
    v_mul_f32 v112, v112, v2
    v_mul_f32 v114, v114, v2
    s_waitcnt lgkmcnt(0)
    v_pk_mul_f32 v[92:93], v[92:93], v[116:117] op_sel_hi:[1,0]
    v_pk_mul_f32 v[94:95], v[94:95], v[116:117] op_sel_hi:[1,0]
    v_cvt_pk_bf16_f32 v116, v93, v94
    v_cvt_pk_bf16_f32 v118, v92, v95
    v_pk_mul_f32 v[76:77], v[76:77], v[112:113] op_sel_hi:[1,0]
    v_pk_mul_f32 v[78:79], v[78:79], v[112:113] op_sel_hi:[1,0]
    v_pk_mul_f32 v[84:85], v[84:85], v[112:113] op_sel_hi:[1,0]
    v_pk_mul_f32 v[86:87], v[86:87], v[112:113] op_sel_hi:[1,0]
    v_cvt_pk_bf16_f32 v96, v79, v84
    v_cvt_pk_bf16_f32 v97, v76, v85
    v_cvt_pk_bf16_f32 v98, v77, v86
    v_cvt_pk_bf16_f32 v99, v78, v87
    v_pk_mul_f32 v[80:81], v[80:81], v[114:115] op_sel_hi:[1,0]
    v_pk_mul_f32 v[82:83], v[82:83], v[114:115] op_sel_hi:[1,0]
    v_pk_mul_f32 v[88:89], v[88:89], v[114:115] op_sel_hi:[1,0]
    v_pk_mul_f32 v[90:91], v[90:91], v[114:115] op_sel_hi:[1,0]
    v_smfmac_f32_16x16x64_bf16 v[60:63], v[116:119], v[104:111], v5
    v_cvt_pk_bf16_f32 v100, v83, v88
    v_cvt_pk_bf16_f32 v101, v80, v89
    v_smfmac_f32_16x16x64_bf16 v[60:63], v[96:99], v[44:51], v5
    v_cvt_pk_bf16_f32 v102, v81, v90
    v_cvt_pk_bf16_f32 v103, v82, v91
    s_nop 1
    v_smfmac_f32_16x16x64_bf16 v[60:63], v[100:103], v[52:59], v5
    s_branch ch1bs_kj
ch1bs_x:
    s_cmp_ge_u32 s83, 2000000
    s_cbranch_scc1 chain_abort
    buffer_load_dwordx4 v[76:79], v1, s[44:47], s67 offen offset:0 sc1
    buffer_load_dwordx4 v[84:87], v1, s[44:47], s67 offen offset:2048 sc1
    buffer_load_dwordx4 v[80:83], v1, s[44:47], s67 offen offset:1024 sc1
    buffer_load_dwordx4 v[88:91], v1, s[44:47], s67 offen offset:3072 sc1
    buffer_load_dwordx4 v[92:95], v10, s[44:47], s67 offen offset:0 sc1
    s_waitcnt vmcnt(0)
    v_pk_max_u16 v2, v76, v77
    v_pk_max_u16 v2, v2, v78
    v_pk_max_u16 v2, v2, v79
    v_pk_max_u16 v2, v2, v80
    v_pk_max_u16 v2, v2, v81
    v_pk_max_u16 v2, v2, v82
    v_pk_max_u16 v2, v2, v83
    v_pk_max_u16 v2, v2, v84
    v_pk_max_u16 v2, v2, v85
    v_pk_max_u16 v2, v2, v86
    v_pk_max_u16 v2, v2, v87
    v_pk_max_u16 v2, v2, v88
    v_pk_max_u16 v2, v2, v89
    v_pk_max_u16 v2, v2, v90
    v_pk_max_u16 v2, v2, v91
    v_pk_max_u16 v2, v2, v92
    v_pk_max_u16 v2, v2, v93
    v_pk_max_u16 v2, v2, v94
    v_pk_max_u16 v2, v2, v95
    v_lshrrev_b32 v112, 16, v2
    v_and_b32 v2, 0xffff, v2
    v_max_u32 v2, v2, v112
    v_cmp_eq_u32 vcc, 0xffff, v2
    s_cbranch_vccnz ch1bs_q012
    v_fma_mix_f32 v102, v76, 1.0, v84 op_sel:[0,0,0] op_sel_hi:[1,0,1]
    v_fma_mix_f32 v84, v76, 1.0, v84 op_sel:[1,0,1] op_sel_hi:[1,0,1]
    v_fma_mix_f32 v76, v77, 1.0, v85 op_sel:[0,0,0] op_sel_hi:[1,0,1]
    v_fma_mix_f32 v85, v77, 1.0, v85 op_sel:[1,0,1] op_sel_hi:[1,0,1]
    v_fma_mix_f32 v77, v78, 1.0, v86 op_sel:[0,0,0] op_sel_hi:[1,0,1]
    v_fma_mix_f32 v86, v78, 1.0, v86 op_sel:[1,0,1] op_sel_hi:[1,0,1]
    v_fma_mix_f32 v78, v79, 1.0, v87 op_sel:[0,0,0] op_sel_hi:[1,0,1]
    v_fma_mix_f32 v87, v79, 1.0, v87 op_sel:[1,0,1] op_sel_hi:[1,0,1]
    v_exp_f32 v76, v76
    v_exp_f32 v77, v77
    v_exp_f32 v78, v78
    v_exp_f32 v79, v102
    v_exp_f32 v84, v84
    v_exp_f32 v85, v85
    v_pk_add_f32 v[96:97], v[76:77], v[78:79]
    v_exp_f32 v86, v86
    v_exp_f32 v87, v87
    v_pk_add_f32 v[96:97], v[96:97], v[84:85]
    v_pk_add_f32 v[96:97], v[96:97], v[86:87]
    v_fma_mix_f32 v103, v80, 1.0, v88 op_sel:[0,0,0] op_sel_hi:[1,0,1]
    v_fma_mix_f32 v88, v80, 1.0, v88 op_sel:[1,0,1] op_sel_hi:[1,0,1]
    v_fma_mix_f32 v80, v81, 1.0, v89 op_sel:[0,0,0] op_sel_hi:[1,0,1]
    v_fma_mix_f32 v89, v81, 1.0, v89 op_sel:[1,0,1] op_sel_hi:[1,0,1]
    v_fma_mix_f32 v81, v82, 1.0, v90 op_sel:[0,0,0] op_sel_hi:[1,0,1]
    v_fma_mix_f32 v90, v82, 1.0, v90 op_sel:[1,0,1] op_sel_hi:[1,0,1]
    v_fma_mix_f32 v82, v83, 1.0, v91 op_sel:[0,0,0] op_sel_hi:[1,0,1]
    v_fma_mix_f32 v91, v83, 1.0, v91 op_sel:[1,0,1] op_sel_hi:[1,0,1]
    v_exp_f32 v80, v80
    v_exp_f32 v81, v81
    v_exp_f32 v82, v82
    v_exp_f32 v83, v103
    v_exp_f32 v88, v88
    v_exp_f32 v89, v89
    v_pk_add_f32 v[98:99], v[80:81], v[82:83]
    v_exp_f32 v90, v90
    v_exp_f32 v91, v91
    v_pk_add_f32 v[98:99], v[98:99], v[88:89]
    v_pk_add_f32 v[98:99], v[98:99], v[90:91]
    v_fma_mix_f32 v113, v92, 1.0, v94 op_sel:[0,0,0] op_sel_hi:[1,0,1]
    v_fma_mix_f32 v94, v92, 1.0, v94 op_sel:[1,0,1] op_sel_hi:[1,0,1]
    v_fma_mix_f32 v92, v93, 1.0, v95 op_sel:[0,0,0] op_sel_hi:[1,0,1]
    v_fma_mix_f32 v95, v93, 1.0, v95 op_sel:[1,0,1] op_sel_hi:[1,0,1]
    v_exp_f32 v92, v92
    v_exp_f32 v93, v113
    v_exp_f32 v94, v94
    v_exp_f32 v95, v95
    s_nop 0
    v_pk_add_f32 v[100:101], v[92:93], v[94:95]
    s_branch ch1bs_k0
ch1bs_vw:
    v_lshlrev_b32 v113, 7, v0
    s_mov_b32 s99, 0
hz_188:
    buffer_load_dword v115, v113, s[44:47], s75 offen sc1
    s_waitcnt vmcnt(0)
    v_cmp_gt_u32 vcc, 28, v115
    s_ff1_i32_b64 s100, vcc
    s_cmp_eq_u32 s100, -1
    s_cselect_b32 s100, 65, s100
    s_sub_u32 s100, s100, 1
    s_cmp_gt_i32 s100, s64
    s_cbranch_scc1 hd_189
    s_sleep 1
    s_add_u32 s99, s99, 1
    s_cmp_lt_u32 s99, 400000
    s_cbranch_scc1 hz_188
    s_branch chain_abort
hd_189:
    s_branch ch1bs_vok
ch1as:
    v_mov_b32 v44, 0
    v_mov_b32 v60, 0
    v_mov_b32 v45, 0
    v_mov_b32 v61, 0
    v_mov_b32 v46, 0
    v_mov_b32 v62, 0
    v_mov_b32 v47, 0
    v_mov_b32 v63, 0
    v_mov_b32 v48, 0
    v_mov_b32 v64, 0
    v_mov_b32 v49, 0
    v_mov_b32 v65, 0
    v_mov_b32 v50, 0
    v_mov_b32 v66, 0
    v_mov_b32 v51, 0
    v_mov_b32 v67, 0
    v_mov_b32 v52, 0
    v_mov_b32 v68, 0
    v_mov_b32 v53, 0
    v_mov_b32 v69, 0
    v_mov_b32 v54, 0
    v_mov_b32 v70, 0
    v_mov_b32 v55, 0
    v_mov_b32 v71, 0
    v_mov_b32 v56, 0
    v_mov_b32 v72, 0
    v_mov_b32 v57, 0
    v_mov_b32 v73, 0
    v_mov_b32 v58, 0
    v_mov_b32 v74, 0
    v_mov_b32 v59, 0
    v_mov_b32 v75, 0
    v_mov_b32 v112, 0
    v_mov_b32 v113, 0
    v_mov_b32 v114, 0
    v_mov_b32 v115, 0
    s_branch ch1as_loop
.p2align 6
ch1as_loop:
    s_and_b32 s8, s64, 3
    s_lshl_b32 s65, s8, 13
    s_add_u32 s65, s65, 94898176
    buffer_load_dwordx4 v[24:27], v1, s[44:47], s65 offen offset:0 sc1
    buffer_load_dwordx4 v[28:31], v1, s[44:47], s65 offen offset:1024 sc1
    s_mov_b32 s83, 0
    s_and_b32 s8, s64, 3
    s_mul_i32 s9, s8, 20736
    s_add_u32 s67, s9, 94934016
    s_add_u32 s66, s9, s12
    s_xor_b32 s8, s8, 2
    s_mul_i32 s9, s8, 20736
    s_add_u32 s70, s9, s13
    s_add_u32 s16, s72, 14336
    s_add_u32 s20, s15, 8192
    s_add_u32 s17, s72, 18432
    s_add_u32 s21, s15, 12288
    s_add_u32 s72, s72, 28672
    s_xor_b32 s15, s15, 0x4000
ch1as_mp:
    buffer_load_dwordx4 v[24:27], v1, s[44:47], s65 offen offset:0 sc1
    buffer_load_dwordx4 v[28:31], v1, s[44:47], s65 offen offset:1024 sc1
    s_add_u32 s83, s83, 1
    s_cmp_ge_u32 s83, 2000000
    s_cbranch_scc1 chain_abort
    s_waitcnt vmcnt(3)
    v_max3_u32 v2, v24, v25, v26
    v_max_u32 v2, v2, v27
    v_cmp_eq_u32 s[10:11], -1, v2
    s_waitcnt vmcnt(2)
    v_max3_u32 v2, v28, v29, v30
    v_max_u32 v2, v2, v31
    v_cmp_eq_u32 vcc, -1, v2
    s_cmp_lg_u64 s[10:11], 0
    s_cbranch_scc1 ch1as_m0bad
    s_cbranch_vccnz ch1as_mp1
ch1as_mok:
    ds_write_b128 v1, v[24:27] offset:2048
    ds_write_b128 v1, v[28:31] offset:3072
    v_smfmac_f32_16x16x64_bf16 v[44:47], v[24:27], a[16:23], v5
    v_smfmac_f32_16x16x64_bf16 v[48:51], v[24:27], a[72:79], v5
    s_waitcnt lgkmcnt(0)
    s_barrier
    ds_read_b128 v[16:19], v1 offset:0
    ds_read_b128 v[20:23], v1 offset:1024
    ds_read_b128 v[32:35], v1 offset:4096
    ds_read_b128 v[36:39], v1 offset:5120
    ds_read_b128 v[40:43], v1 offset:6144
    v_smfmac_f32_16x16x64_bf16 v[52:55], v[24:27], a[128:135], v5
    s_mov_b32 m0, s20
    v_smfmac_f32_16x16x64_bf16 v[44:47], v[28:31], a[24:31], v5
    buffer_load_dwordx4 v1, s[44:47], s16 offen offset:2048 sc1 lds
    v_smfmac_f32_16x16x64_bf16 v[48:51], v[28:31], a[80:87], v5
    buffer_load_dwordx4 v1, s[44:47], s16 offen offset:3072 sc1 lds
    s_mov_b32 m0, s21
    v_smfmac_f32_16x16x64_bf16 v[52:55], v[28:31], a[136:143], v5
    buffer_load_dwordx4 v1, s[44:47], s17 offen offset:0 sc1 lds
    s_waitcnt lgkmcnt(4)
    v_smfmac_f32_16x16x64_bf16 v[44:47], v[16:19], a[0:7], v5
    buffer_load_dwordx4 v1, s[44:47], s17 offen offset:1024 sc1 lds
    s_waitcnt lgkmcnt(3)
    v_smfmac_f32_16x16x64_bf16 v[44:47], v[20:23], a[8:15], v5
    buffer_load_dwordx4 v1, s[44:47], s17 offen offset:2048 sc1 lds
    s_waitcnt lgkmcnt(2)
    v_smfmac_f32_16x16x64_bf16 v[44:47], v[32:35], a[32:39], v5
    buffer_store_dword v3, v4, s[44:47], s70 offen sc1
    s_waitcnt lgkmcnt(1)
    v_smfmac_f32_16x16x64_bf16 v[44:47], v[36:39], a[40:47], v5
    ds_read2_b64 v[76:79], v8 offset0:0 offset1:4
    s_waitcnt lgkmcnt(1)
    v_smfmac_f32_16x16x64_bf16 v[44:47], v[40:43], a[48:55], v5
    ds_read2_b64 v[80:83], v8 offset0:64 offset1:68
    v_smfmac_f32_16x16x64_bf16 v[48:51], v[16:19], a[56:63], v5
    ds_read2_b64 v[84:87], v8 offset0:128 offset1:132
    v_smfmac_f32_16x16x64_bf16 v[48:51], v[20:23], a[64:71], v5
    ds_read2_b64 v[88:91], v8 offset0:192 offset1:196
    v_smfmac_f32_16x16x64_bf16 v[48:51], v[32:35], a[88:95], v5
    ds_read2_b64 v[92:95], v13 offset0:0 offset1:4
    v_smfmac_f32_16x16x64_bf16 v[48:51], v[36:39], a[96:103], v5
    v_add_f32 v44, v44, v46
    v_smfmac_f32_16x16x64_bf16 v[48:51], v[40:43], a[104:111], v5
    v_add_f32 v45, v45, v47
    v_smfmac_f32_16x16x64_bf16 v[52:55], v[16:19], a[112:119], v5
    v_cvt_pk_bf16_f32 v44, v44, v45
    v_smfmac_f32_16x16x64_bf16 v[52:55], v[20:23], a[120:127], v5
    ds_write_b32 v6, v44 offset:768
    v_smfmac_f32_16x16x64_bf16 v[52:55], v[32:35], a[144:151], v5
    ds_read2_b64 v[96:99], v13 offset0:64 offset1:68
    v_smfmac_f32_16x16x64_bf16 v[52:55], v[36:39], a[152:159], v5
    v_add_f32 v48, v48, v50
    v_smfmac_f32_16x16x64_bf16 v[52:55], v[40:43], a[160:167], v5
    v_add_f32 v49, v49, v51
    v_smfmac_f32_16x16x64_bf16 v[56:59], v[16:19], a[168:175], v5
    v_cvt_pk_bf16_f32 v48, v48, v49
    v_smfmac_f32_16x16x64_bf16 v[56:59], v[20:23], a[176:183], v5
    ds_write_b32 v6, v48 offset:1024
    v_smfmac_f32_16x16x64_bf16 v[56:59], v[32:35], a[200:207], v5
    s_nop 1
    v_add_f32 v52, v52, v54
    v_smfmac_f32_16x16x64_bf16 v[56:59], v[36:39], a[208:215], v5
    v_add_f32 v53, v53, v55
    v_smfmac_f32_16x16x64_bf16 v[56:59], v[40:43], a[216:223], v5
    v_cvt_pk_bf16_f32 v52, v52, v53
    v_smfmac_f32_16x16x64_bf16 v[56:59], v[24:27], a[184:191], v5
    ds_write_b32 v6, v52 offset:1280
    v_smfmac_f32_16x16x64_bf16 v[56:59], v[28:31], a[192:199], v5
    ds_read2_b64 v[100:103], v13 offset0:128 offset1:132
    s_nop 6
    v_add_f32 v56, v56, v58
    v_add_f32 v57, v57, v59
    v_cvt_pk_bf16_f32 v56, v56, v57
    ds_write_b32 v6, v56 offset:3328
    s_waitcnt lgkmcnt(1)
    s_barrier
    ds_read_b64_tr_b16 v[44:45], v7 offset:0
    ds_read_b64_tr_b16 v[46:47], v7 offset:128
    ds_read_b64_tr_b16 v[48:49], v7 offset:1024
    ds_read_b64_tr_b16 v[50:51], v7 offset:1152
    ds_read_b64_tr_b16 v[52:53], v7 offset:2048
    ds_read_b64_tr_b16 v[54:55], v7 offset:2176
    s_waitcnt lgkmcnt(6)
    s_barrier
    ds_read_b64_tr_b16 v[56:57], v7 offset:3072
    ds_read_b64_tr_b16 v[58:59], v7 offset:3200
    s_waitcnt lgkmcnt(6)
    v_smfmac_f32_16x16x64_bf16 v[112:115], v[44:47], v[76:83], v5
    s_waitcnt lgkmcnt(4)
    v_smfmac_f32_16x16x64_bf16 v[112:115], v[48:51], v[84:91], v5
    s_waitcnt lgkmcnt(2)
    v_smfmac_f32_16x16x64_bf16 v[112:115], v[52:55], v[92:99], v5
    s_waitcnt lgkmcnt(0)
    v_smfmac_f32_16x16x64_bf16 v[112:115], v[56:59], v[100:107], v5
    s_nop 7
    v_pk_add_f32 v[112:113], v[112:113], v[114:115]
    v_pk_mul_f32 v[112:113], v[112:113], s[78:79]
    v_cvt_pk_f16_f32 v112, v112, v113
    s_nop 1
    v_mov_b32_dpp v113, v112 quad_perm:[1,0,3,2] row_mask:0xf bank_mask:0xf
    v_perm_b32 v112, v113, v112, v14
    v_pk_min_u16 v112, v112, s77
    buffer_store_dword v112, v9, s[44:47], s66 offen sc1
    s_barrier
    s_add_u32 s71, s71, 458752
    s_add_u32 s8, s72, 14336
    s_mov_b32 m0, 24576
    s_nop 0
    buffer_load_dwordx4 v1, s[44:47], s8 offen offset:2048 sc1 lds
    buffer_load_dwordx4 v1, s[44:47], s8 offen offset:3072 sc1 lds
    s_add_u32 s8, s72, 18432
    s_mov_b32 m0, 28672
    s_nop 0
    buffer_load_dwordx4 v1, s[44:47], s8 offen offset:0 sc1 lds
    buffer_load_dwordx4 v1, s[44:47], s8 offen offset:1024 sc1 lds
    buffer_load_dwordx4 v1, s[44:47], s8 offen offset:2048 sc1 lds
    s_add_u32 s8, s64, s7
    s_and_b32 s8, s8, 3
    s_cmp_lg_u32 s8, 0
    s_cselect_b32 s101, -1, s64
    s_cbranch_scc1 ch1as_np
    s_lshl_b32 s8, s64, 13
    s_add_u32 s8, s8, 91752448
    buffer_store_dwordx4 v[24:27], v1, s[44:47], s8 offen offset:0 sc1
    buffer_store_dwordx4 v[28:31], v1, s[44:47], s8 offen offset:1024 sc1
ch1as_np:
    v_mov_b32 v44, 0
    v_mov_b32 v45, 0
    v_mov_b32 v46, 0
    v_mov_b32 v47, 0
    v_mov_b32 v48, 0
    v_mov_b32 v49, 0
    v_mov_b32 v50, 0
    v_mov_b32 v51, 0
    v_mov_b32 v52, 0
    v_mov_b32 v53, 0
    v_mov_b32 v54, 0
    v_mov_b32 v55, 0
    v_mov_b32 v56, 0
    v_mov_b32 v57, 0
    v_mov_b32 v58, 0
    v_mov_b32 v59, 0
    v_mov_b32 v112, 0
    v_mov_b32 v113, 0
    v_mov_b32 v114, 0
    v_mov_b32 v115, 0
    s_add_u32 s64, s64, 1
    s_cmp_lt_u32 s64, 63
    s_cbranch_scc1 ch1as_loop
    s_waitcnt vmcnt(0)
    s_barrier
    s_endpgm
ch1as_mp1:
    buffer_load_dwordx4 v[28:31], v1, s[44:47], s65 offen offset:1024 sc1
    s_add_u32 s83, s83, 1
    s_cmp_ge_u32 s83, 2000000
    s_cbranch_scc1 chain_abort
    s_waitcnt vmcnt(1)
    v_max3_u32 v2, v28, v29, v30
    v_max_u32 v2, v2, v31
    v_cmp_eq_u32 vcc, -1, v2
    s_cbranch_vccnz ch1as_mp1
    s_branch ch1as_mok
ch1as_m0bad:
    s_cbranch_vccnz ch1as_mp
ch1as_mp0:
    buffer_load_dwordx4 v[24:27], v1, s[44:47], s65 offen offset:0 sc1
    s_add_u32 s83, s83, 1
    s_cmp_ge_u32 s83, 2000000
    s_cbranch_scc1 chain_abort
    s_waitcnt vmcnt(1)
    v_max3_u32 v2, v24, v25, v26
    v_max_u32 v2, v2, v27
    v_cmp_eq_u32 vcc, -1, v2
    s_cbranch_vccnz ch1as_mp0
    s_branch ch1as_mok
ch2bs:
    v_mov_b32 v44, 0
    v_mov_b32 v60, 0
    v_mov_b32 v45, 0
    v_mov_b32 v61, 0
    v_mov_b32 v46, 0
    v_mov_b32 v62, 0
    v_mov_b32 v47, 0
    v_mov_b32 v63, 0
    v_mov_b32 v48, 0
    v_mov_b32 v64, 0
    v_mov_b32 v49, 0
    v_mov_b32 v65, 0
    v_mov_b32 v50, 0
    v_mov_b32 v66, 0
    v_mov_b32 v51, 0
    v_mov_b32 v67, 0
    v_mov_b32 v52, 0
    v_mov_b32 v68, 0
    v_mov_b32 v53, 0
    v_mov_b32 v69, 0
    v_mov_b32 v54, 0
    v_mov_b32 v70, 0
    v_mov_b32 v55, 0
    v_mov_b32 v71, 0
    v_mov_b32 v56, 0
    v_mov_b32 v72, 0
    v_mov_b32 v57, 0
    v_mov_b32 v73, 0
    v_mov_b32 v58, 0
    v_mov_b32 v74, 0
    v_mov_b32 v59, 0
    v_mov_b32 v75, 0
    v_mov_b32 v112, 0
    v_mov_b32 v113, 0
    v_mov_b32 v114, 0
    v_mov_b32 v115, 0
    s_branch ch2bs_loop
.p2align 6
ch2bs_loop:
    s_and_b32 s8, s64, 3
    s_lshl_b32 s65, s8, 13
    s_add_u32 s65, s65, 94900224
    buffer_load_dwordx4 v[32:35], v1, s[44:47], s65 offen offset:0 sc1
    buffer_load_dwordx4 v[36:39], v1, s[44:47], s65 offen offset:1024 sc1
    s_mov_b32 s83, 0
    s_and_b32 s8, s64, 3
    s_mul_i32 s9, s8, 20736
    s_add_u32 s67, s9, 94939136
    s_add_u32 s66, s9, s12
    s_xor_b32 s8, s8, 2
    s_mul_i32 s9, s8, 20736
    s_add_u32 s70, s9, s13
    s_add_u32 s24, s71, 0
    s_add_u32 s71, s71, 458752
    v_mov_b32 v60, 0
    v_mov_b32 v61, 0
    v_mov_b32 v62, 0
    v_mov_b32 v63, 0
    v_mov_b32 v64, 0
    v_mov_b32 v65, 0
    v_mov_b32 v66, 0
    v_mov_b32 v67, 0
    v_mov_b32 v68, 0
    v_mov_b32 v69, 0
    v_mov_b32 v70, 0
    v_mov_b32 v71, 0
    v_mov_b32 v72, 0
    v_mov_b32 v73, 0
    v_mov_b32 v74, 0
    v_mov_b32 v75, 0
ch2bs_mp:
    buffer_load_dwordx4 v[32:35], v1, s[44:47], s65 offen offset:0 sc1
    buffer_load_dwordx4 v[36:39], v1, s[44:47], s65 offen offset:1024 sc1
    s_add_u32 s83, s83, 1
    s_cmp_ge_u32 s83, 2000000
    s_cbranch_scc1 chain_abort
    s_waitcnt vmcnt(3)
    v_max3_u32 v2, v32, v33, v34
    v_max_u32 v2, v2, v35
    v_cmp_eq_u32 s[10:11], -1, v2
    s_waitcnt vmcnt(2)
    v_max3_u32 v2, v36, v37, v38
    v_max_u32 v2, v2, v39
    v_cmp_eq_u32 vcc, -1, v2
    s_cmp_lg_u64 s[10:11], 0
    s_cbranch_scc1 ch2bs_m0bad
    s_cbranch_vccnz ch2bs_mp1
ch2bs_mok:
    ds_write_b128 v1, v[32:35] offset:4096
    ds_write_b128 v1, v[36:39] offset:5120
    v_smfmac_f32_16x16x64_bf16 v[44:47], v[32:35], a[32:39], v5
    v_smfmac_f32_16x16x64_bf16 v[48:51], v[32:35], a[88:95], v5
    s_waitcnt lgkmcnt(0)
    s_barrier
    s_mov_b32 m0, 24576
    ds_read_b128 v[16:19], v1 offset:0
    ds_read_b128 v[20:23], v1 offset:1024
    ds_read_b128 v[24:27], v1 offset:2048
    ds_read_b128 v[28:31], v1 offset:3072
    ds_read_b128 v[40:43], v1 offset:6144
    v_smfmac_f32_16x16x64_bf16 v[52:55], v[32:35], a[144:151], v5
    buffer_load_dwordx4 v1, s[44:47], s24 offen offset:2048 sc1 lds
    v_smfmac_f32_16x16x64_bf16 v[44:47], v[36:39], a[40:47], v5
    buffer_load_dwordx4 v1, s[44:47], s24 offen offset:3072 sc1 lds
    v_smfmac_f32_16x16x64_bf16 v[48:51], v[36:39], a[96:103], v5
    buffer_store_dword v3, v4, s[44:47], s70 offen sc1
    v_smfmac_f32_16x16x64_bf16 v[52:55], v[36:39], a[152:159], v5
    v_smfmac_f32_16x16x64_bf16 v[60:63], v[32:35], v[120:127], v5
    v_smfmac_f32_16x16x64_bf16 v[60:63], v[36:39], v[128:135], v5
    v_smfmac_f32_16x16x64_bf16 v[64:67], v[32:35], v[176:183], v5
    s_waitcnt lgkmcnt(4)
    v_smfmac_f32_16x16x64_bf16 v[44:47], v[16:19], a[0:7], v5
    s_waitcnt lgkmcnt(3)
    v_smfmac_f32_16x16x64_bf16 v[44:47], v[20:23], a[8:15], v5
    s_waitcnt lgkmcnt(2)
    v_smfmac_f32_16x16x64_bf16 v[44:47], v[24:27], a[16:23], v5
    ds_read_b128 v[76:79], v12 offset:0
    s_waitcnt lgkmcnt(2)
    v_smfmac_f32_16x16x64_bf16 v[44:47], v[28:31], a[24:31], v5
    ds_read_b128 v[80:83], v12 offset:1024
    s_waitcnt lgkmcnt(2)
    v_smfmac_f32_16x16x64_bf16 v[44:47], v[40:43], a[48:55], v5
    ds_read_b128 v[84:87], v12 offset:2048
    v_smfmac_f32_16x16x64_bf16 v[48:51], v[16:19], a[56:63], v5
    ds_read_b128 v[88:91], v12 offset:3072
    v_smfmac_f32_16x16x64_bf16 v[48:51], v[20:23], a[64:71], v5
    ds_read_b128 v[92:95], v12 offset:4096
    v_smfmac_f32_16x16x64_bf16 v[48:51], v[24:27], a[72:79], v5
    ds_read_b128 v[96:99], v12 offset:5120
    v_smfmac_f32_16x16x64_bf16 v[48:51], v[28:31], a[80:87], v5
    v_add_f32 v44, v44, v46
    v_smfmac_f32_16x16x64_bf16 v[48:51], v[40:43], a[104:111], v5
    v_add_f32 v45, v45, v47
    v_smfmac_f32_16x16x64_bf16 v[52:55], v[16:19], a[112:119], v5
    v_cvt_pk_bf16_f32 v44, v44, v45
    v_smfmac_f32_16x16x64_bf16 v[52:55], v[20:23], a[120:127], v5
    ds_write_b32 v6, v44 offset:1536
    v_smfmac_f32_16x16x64_bf16 v[52:55], v[24:27], a[128:135], v5
    ds_read_b128 v[100:103], v12 offset:6144
    v_smfmac_f32_16x16x64_bf16 v[52:55], v[28:31], a[136:143], v5
    v_add_f32 v48, v48, v50
    v_smfmac_f32_16x16x64_bf16 v[52:55], v[40:43], a[160:167], v5
    v_add_f32 v49, v49, v51
    v_cvt_pk_bf16_f32 v48, v48, v49
    ds_write_b32 v6, v48 offset:1792
    v_xor_b32 v12, 0x4000, v12
    s_nop 3
    v_add_f32 v52, v52, v54
    v_add_f32 v53, v53, v55
    v_cvt_pk_bf16_f32 v52, v52, v53
    ds_write_b32 v6, v52 offset:2048
    v_smfmac_f32_16x16x64_bf16 v[60:63], v[16:19], a[224:231], v5
    v_smfmac_f32_16x16x64_bf16 v[60:63], v[20:23], a[232:239], v5
    v_smfmac_f32_16x16x64_bf16 v[60:63], v[24:27], a[240:247], v5
    v_smfmac_f32_16x16x64_bf16 v[60:63], v[28:31], a[248:255], v5
    v_smfmac_f32_16x16x64_bf16 v[60:63], v[40:43], v[136:143], v5
    s_waitcnt lgkmcnt(0)
    s_barrier
    ds_read_b64_tr_b16 v[44:45], v7 offset:0
    ds_read_b64_tr_b16 v[46:47], v7 offset:128
    ds_read_b64_tr_b16 v[48:49], v7 offset:1024
    ds_read_b64_tr_b16 v[50:51], v7 offset:1152
    ds_read_b64_tr_b16 v[52:53], v7 offset:2048
    ds_read_b64_tr_b16 v[54:55], v7 offset:2176
    v_smfmac_f32_16x16x64_bf16 v[64:67], v[16:19], v[144:151], v5
    s_barrier
    ds_read_b64_tr_b16 v[56:57], v7 offset:3072
    ds_read_b64_tr_b16 v[58:59], v7 offset:3200
    s_waitcnt lgkmcnt(6)
    v_smfmac_f32_16x16x64_bf16 v[112:115], v[44:47], v[76:83], v5
    s_waitcnt lgkmcnt(4)
    v_smfmac_f32_16x16x64_bf16 v[112:115], v[48:51], v[84:91], v5
    s_waitcnt lgkmcnt(2)
    v_smfmac_f32_16x16x64_bf16 v[112:115], v[52:55], v[92:99], v5
    s_waitcnt lgkmcnt(0)
    v_smfmac_f32_16x16x64_bf16 v[112:115], v[56:59], v[100:107], v5
    s_nop 7
    v_pk_add_f32 v[112:113], v[112:113], v[114:115]
    v_pk_mul_f32 v[112:113], v[112:113], s[78:79]
    v_cvt_pk_f16_f32 v112, v112, v113
    s_nop 1
    v_mov_b32_dpp v113, v112 quad_perm:[1,0,3,2] row_mask:0xf bank_mask:0xf
    v_perm_b32 v112, v113, v112, v14
    v_pk_min_u16 v112, v112, s77
    buffer_store_dword v112, v9, s[44:47], s66 offen sc1
    s_mov_b32 s83, 0
    s_mov_b32 s98, 0
    v_smfmac_f32_16x16x64_bf16 v[64:67], v[20:23], v[152:159], v5
    v_smfmac_f32_16x16x64_bf16 v[64:67], v[24:27], v[160:167], v5
    v_smfmac_f32_16x16x64_bf16 v[64:67], v[28:31], v[168:175], v5
    v_smfmac_f32_16x16x64_bf16 v[64:67], v[36:39], v[184:191], v5
    v_smfmac_f32_16x16x64_bf16 v[64:67], v[40:43], v[192:199], v5
    v_smfmac_f32_16x16x64_bf16 v[68:71], v[16:19], v[200:207], v5
    v_add_f32 v60, v60, v62
    v_smfmac_f32_16x16x64_bf16 v[68:71], v[20:23], v[208:215], v5
    v_add_f32 v61, v61, v63
    v_smfmac_f32_16x16x64_bf16 v[68:71], v[24:27], v[216:223], v5
    v_cvt_pk_bf16_f32 v104, v60, v61
    v_smfmac_f32_16x16x64_bf16 v[68:71], v[28:31], v[224:231], v5
    v_mov_b32 v60, 0
    v_smfmac_f32_16x16x64_bf16 v[68:71], v[32:35], v[232:239], v5
    v_mov_b32 v61, 0
    v_smfmac_f32_16x16x64_bf16 v[68:71], v[36:39], v[240:247], v5
    s_cmp_ge_u32 s100, 64
    s_cbranch_scc0 ch2bs_hl
ch2bs_hs:
    buffer_load_dwordx4 v[76:79], v1, s[44:47], s67 offen offset:0 sc1
    buffer_load_dwordx4 v[84:87], v1, s[44:47], s67 offen offset:2048 sc1
    v_smfmac_f32_16x16x64_bf16 v[68:71], v[40:43], v[248:255], v5
    v_mov_b32 v62, 0
    v_smfmac_f32_16x16x64_bf16 v[72:75], v[16:19], a[168:175], v5
    v_mov_b32 v63, 0
    v_smfmac_f32_16x16x64_bf16 v[72:75], v[20:23], a[176:183], v5
    buffer_load_dwordx4 v[80:83], v1, s[44:47], s67 offen offset:1024 sc1
    buffer_load_dwordx4 v[88:91], v1, s[44:47], s67 offen offset:3072 sc1
    v_smfmac_f32_16x16x64_bf16 v[72:75], v[24:27], a[184:191], v5
    v_add_f32 v64, v64, v66
    v_smfmac_f32_16x16x64_bf16 v[72:75], v[28:31], a[192:199], v5
    v_add_f32 v65, v65, v67
    v_smfmac_f32_16x16x64_bf16 v[72:75], v[32:35], a[200:207], v5
    buffer_load_dwordx4 v[92:95], v10, s[44:47], s67 offen offset:0 sc1
    v_smfmac_f32_16x16x64_bf16 v[72:75], v[36:39], a[208:215], v5
    v_cvt_pk_bf16_f32 v105, v64, v65
    v_smfmac_f32_16x16x64_bf16 v[72:75], v[40:43], a[216:223], v5
    v_add_f32 v68, v68, v70
    v_add_f32 v69, v69, v71
    v_cvt_pk_bf16_f32 v108, v68, v69
    s_nop 4
    v_add_f32 v72, v72, v74
    v_add_f32 v73, v73, v75
    v_cvt_pk_bf16_f32 v109, v72, v73
    s_waitcnt vmcnt(3)
    ds_read_b128 v[44:47], v1 offset:24576
    ds_read_b128 v[48:51], v1 offset:25600
    ds_read_b128 v[52:55], v1 offset:26624
    ds_read_b128 v[56:59], v1 offset:27648
    s_cbranch_scc0 ch2bs_hu
ch2bs_hv:
    s_cmp_ge_u32 s64, s100
    v_fma_mix_f32 v102, v76, 1.0, v84 op_sel:[0,0,0] op_sel_hi:[1,0,1]
    v_fma_mix_f32 v84, v76, 1.0, v84 op_sel:[1,0,1] op_sel_hi:[1,0,1]
    v_fma_mix_f32 v76, v77, 1.0, v85 op_sel:[0,0,0] op_sel_hi:[1,0,1]
    v_fma_mix_f32 v85, v77, 1.0, v85 op_sel:[1,0,1] op_sel_hi:[1,0,1]
    v_fma_mix_f32 v77, v78, 1.0, v86 op_sel:[0,0,0] op_sel_hi:[1,0,1]
    v_fma_mix_f32 v86, v78, 1.0, v86 op_sel:[1,0,1] op_sel_hi:[1,0,1]
    v_fma_mix_f32 v78, v79, 1.0, v87 op_sel:[0,0,0] op_sel_hi:[1,0,1]
    v_fma_mix_f32 v87, v79, 1.0, v87 op_sel:[1,0,1] op_sel_hi:[1,0,1]
    v_maximum3_f32 v112, v84, v85, v86
    v_cmp_u_f32 vcc, v112, v87
    v_exp_f32 v76, v76
    v_exp_f32 v77, v77
    v_exp_f32 v78, v78
    s_cbranch_vccnz ch2bs_i0
    v_exp_f32 v79, v102
    v_exp_f32 v84, v84
    v_exp_f32 v85, v85
    v_pk_add_f32 v[96:97], v[76:77], v[78:79]
    v_exp_f32 v86, v86
    v_exp_f32 v87, v87
    v_pk_add_f32 v[96:97], v[96:97], v[84:85]
    v_pk_add_f32 v[96:97], v[96:97], v[86:87]
    s_waitcnt vmcnt(1)
    v_fma_mix_f32 v103, v80, 1.0, v88 op_sel:[0,0,0] op_sel_hi:[1,0,1]
    v_fma_mix_f32 v88, v80, 1.0, v88 op_sel:[1,0,1] op_sel_hi:[1,0,1]
    v_fma_mix_f32 v80, v81, 1.0, v89 op_sel:[0,0,0] op_sel_hi:[1,0,1]
    v_fma_mix_f32 v89, v81, 1.0, v89 op_sel:[1,0,1] op_sel_hi:[1,0,1]
    v_fma_mix_f32 v81, v82, 1.0, v90 op_sel:[0,0,0] op_sel_hi:[1,0,1]
    v_fma_mix_f32 v90, v82, 1.0, v90 op_sel:[1,0,1] op_sel_hi:[1,0,1]
    v_fma_mix_f32 v82, v83, 1.0, v91 op_sel:[0,0,0] op_sel_hi:[1,0,1]
    v_fma_mix_f32 v91, v83, 1.0, v91 op_sel:[1,0,1] op_sel_hi:[1,0,1]
    v_maximum3_f32 v114, v88, v89, v90
    v_cmp_u_f32 vcc, v114, v91
    v_exp_f32 v80, v80
    v_exp_f32 v81, v81
    v_exp_f32 v82, v82
    s_cbranch_vccnz ch2bs_i1
    v_exp_f32 v83, v103
    v_exp_f32 v88, v88
    v_exp_f32 v89, v89
    v_pk_add_f32 v[98:99], v[80:81], v[82:83]
    v_exp_f32 v90, v90
    v_exp_f32 v91, v91
    v_pk_add_f32 v[98:99], v[98:99], v[88:89]
    v_pk_add_f32 v[98:99], v[98:99], v[90:91]
    s_cbranch_scc1 ch2bs_nw
ch2bs_nw2:
    s_mov_b32 m0, 24576
    s_mov_b32 s98, 1
    s_waitcnt vmcnt(0) lgkmcnt(0)
    buffer_load_dwordx4 v1, s[44:47], s71 offen offset:0 sc1 lds
    buffer_load_dwordx4 v1, s[44:47], s71 offen offset:1024 sc1 lds
    v_fma_mix_f32 v113, v92, 1.0, v94 op_sel:[0,0,0] op_sel_hi:[1,0,1]
    v_fma_mix_f32 v94, v92, 1.0, v94 op_sel:[1,0,1] op_sel_hi:[1,0,1]
    v_fma_mix_f32 v92, v93, 1.0, v95 op_sel:[0,0,0] op_sel_hi:[1,0,1]
    v_fma_mix_f32 v95, v93, 1.0, v95 op_sel:[1,0,1] op_sel_hi:[1,0,1]
    v_cmp_u_f32 vcc, v94, v95
    v_exp_f32 v92, v92
    v_exp_f32 v93, v113
    v_exp_f32 v94, v94
    s_cbranch_vccnz ch2bs_i2
    v_exp_f32 v95, v95
    s_nop 0
    v_pk_add_f32 v[100:101], v[92:93], v[94:95]
ch2bs_w2d:
    v_pk_add_f32 v[96:97], v[96:97], v[98:99]
    v_pk_add_f32 v[96:97], v[96:97], v[100:101]
    v_add_f32 v2, v96, v97
    v_add_f32 v15, v96, v97
    s_nop 1
    v_permlane16_swap_b32 v2, v15
    v_add_f32 v2, v2, v15
    v_subrev_u32 v15, 0x17800000, v2
    v_rcp_f32 v2, v2
    v_cmp_le_u32 vcc, 0x5a000000, v15
    s_waitcnt lgkmcnt(0)
    v_pk_mul_f32 v[92:93], v[92:93], v[2:3] op_sel_hi:[1,0]
    v_pk_mul_f32 v[94:95], v[94:95], v[2:3] op_sel_hi:[1,0]
    v_cvt_pk_bf16_f32 v116, v93, v94
    v_cvt_pk_bf16_f32 v118, v92, v95
    s_cbranch_vccnz ch2bs_fb
    v_pk_mul_f32 v[76:77], v[76:77], v[2:3] op_sel_hi:[1,0]
    v_pk_mul_f32 v[78:79], v[78:79], v[2:3] op_sel_hi:[1,0]
    v_pk_mul_f32 v[84:85], v[84:85], v[2:3] op_sel_hi:[1,0]
    v_pk_mul_f32 v[86:87], v[86:87], v[2:3] op_sel_hi:[1,0]
    v_cvt_pk_bf16_f32 v96, v79, v84
    v_cvt_pk_bf16_f32 v97, v76, v85
    v_cvt_pk_bf16_f32 v98, v77, v86
    v_cvt_pk_bf16_f32 v99, v78, v87
    v_pk_mul_f32 v[80:81], v[80:81], v[2:3] op_sel_hi:[1,0]
    v_pk_mul_f32 v[82:83], v[82:83], v[2:3] op_sel_hi:[1,0]
    v_pk_mul_f32 v[88:89], v[88:89], v[2:3] op_sel_hi:[1,0]
    v_pk_mul_f32 v[90:91], v[90:91], v[2:3] op_sel_hi:[1,0]
    v_smfmac_f32_16x16x64_bf16 v[60:63], v[116:119], v[104:111], v5
    v_cvt_pk_bf16_f32 v100, v83, v88
    v_cvt_pk_bf16_f32 v101, v80, v89
    v_smfmac_f32_16x16x64_bf16 v[60:63], v[96:99], v[44:51], v5
    v_cvt_pk_bf16_f32 v102, v81, v90
    v_cvt_pk_bf16_f32 v103, v82, v91
    s_nop 1
    v_smfmac_f32_16x16x64_bf16 v[60:63], v[100:103], v[52:59], v5
ch2bs_kj:
    v_mov_b32 v44, 0
    v_mov_b32 v45, 0
    v_mov_b32 v46, 0
    v_mov_b32 v47, 0
    s_nop 3
    v_add_f32 v60, v60, v62
    v_add_f32 v61, v61, v63
    ds_write2_b32 v11, v60, v61 offset0:0 offset1:16
    v_mov_b32 v48, 0
    v_mov_b32 v49, 0
    v_mov_b32 v50, 0
    v_mov_b32 v51, 0
    v_mov_b32 v52, 0
    v_mov_b32 v53, 0
    v_mov_b32 v54, 0
    v_mov_b32 v55, 0
    v_mov_b32 v112, 0
    v_mov_b32 v113, 0
    v_mov_b32 v114, 0
    v_mov_b32 v115, 0
    s_waitcnt lgkmcnt(0)
    s_barrier
    s_barrier
    s_add_u32 s64, s64, 1
    s_cmp_lt_u32 s64, 63
    s_cbranch_scc1 ch2bs_loop
    s_and_b32 s8, s64, 3
    s_lshl_b32 s65, s8, 13
    s_add_u32 s65, s65, 94900224
    v_mov_b32 v60, 0
    v_mov_b32 v61, 0
    v_mov_b32 v62, 0
    v_mov_b32 v63, 0
    v_mov_b32 v64, 0
    v_mov_b32 v65, 0
    v_mov_b32 v66, 0
    v_mov_b32 v67, 0
    v_mov_b32 v68, 0
    v_mov_b32 v69, 0
    v_mov_b32 v70, 0
    v_mov_b32 v71, 0
    v_mov_b32 v72, 0
    v_mov_b32 v73, 0
    v_mov_b32 v74, 0
    v_mov_b32 v75, 0
    buffer_load_dwordx4 v[76:79], v1, s[44:47], s65 offen offset:0 sc1
    buffer_load_dwordx4 v[80:83], v1, s[44:47], s65 offen offset:1024 sc1
    s_mov_b32 s83, 0
ch2bst_mp:
    buffer_load_dwordx4 v[32:35], v1, s[44:47], s65 offen offset:0 sc1
    buffer_load_dwordx4 v[36:39], v1, s[44:47], s65 offen offset:1024 sc1
    s_waitcnt vmcnt(3)
    v_max3_u32 v2, v76, v77, v78
    s_waitcnt vmcnt(2)
    v_max3_u32 v2, v2, v79, v80
    v_max3_u32 v2, v2, v81, v82
    v_max_u32 v2, v2, v83
    v_cmp_eq_u32 vcc, -1, v2
    s_cbranch_vccz ch2bst_g1
    buffer_load_dwordx4 v[76:79], v1, s[44:47], s65 offen offset:0 sc1
    buffer_load_dwordx4 v[80:83], v1, s[44:47], s65 offen offset:1024 sc1
    s_add_u32 s83, s83, 1
    s_cmp_ge_u32 s83, 2000000
    s_cbranch_scc1 chain_abort
    s_waitcnt vmcnt(3)
    v_max3_u32 v2, v32, v33, v34
    s_waitcnt vmcnt(2)
    v_max3_u32 v2, v2, v35, v36
    v_max3_u32 v2, v2, v37, v38
    v_max_u32 v2, v2, v39
    v_cmp_eq_u32 vcc, -1, v2
    s_cbranch_vccnz ch2bst_mp
ch2bst_g1:
    s_waitcnt vmcnt(0)
    ds_write_b128 v1, v[32:35] offset:4096
    ds_write_b128 v1, v[36:39] offset:5120
    s_waitcnt lgkmcnt(0)
    s_barrier
    ds_read_b128 v[16:19], v1 offset:0
    ds_read_b128 v[20:23], v1 offset:1024
    ds_read_b128 v[24:27], v1 offset:2048
    ds_read_b128 v[28:31], v1 offset:3072
    ds_read_b128 v[40:43], v1 offset:6144
    s_waitcnt lgkmcnt(0)
    v_smfmac_f32_16x16x64_bf16 v[60:63], v[16:19], a[224:231], v5
    v_smfmac_f32_16x16x64_bf16 v[60:63], v[20:23], a[232:239], v5
    v_smfmac_f32_16x16x64_bf16 v[60:63], v[24:27], a[240:247], v5
    v_smfmac_f32_16x16x64_bf16 v[60:63], v[28:31], a[248:255], v5
    v_smfmac_f32_16x16x64_bf16 v[60:63], v[32:35], v[120:127], v5
    v_smfmac_f32_16x16x64_bf16 v[60:63], v[36:39], v[128:135], v5
    v_smfmac_f32_16x16x64_bf16 v[60:63], v[40:43], v[136:143], v5
    v_smfmac_f32_16x16x64_bf16 v[64:67], v[16:19], v[144:151], v5
    v_smfmac_f32_16x16x64_bf16 v[64:67], v[20:23], v[152:159], v5
    v_smfmac_f32_16x16x64_bf16 v[64:67], v[24:27], v[160:167], v5
    v_smfmac_f32_16x16x64_bf16 v[64:67], v[28:31], v[168:175], v5
    v_smfmac_f32_16x16x64_bf16 v[64:67], v[32:35], v[176:183], v5
    s_nop 2
    v_add_f32 v60, v60, v62
    v_smfmac_f32_16x16x64_bf16 v[64:67], v[36:39], v[184:191], v5
    v_add_f32 v61, v61, v63
    v_smfmac_f32_16x16x64_bf16 v[64:67], v[40:43], v[192:199], v5
    v_cvt_pk_bf16_f32 v104, v60, v61
    v_smfmac_f32_16x16x64_bf16 v[68:71], v[16:19], v[200:207], v5
    v_mov_b32 v60, 0
    v_smfmac_f32_16x16x64_bf16 v[68:71], v[20:23], v[208:215], v5
    v_mov_b32 v61, 0
    v_smfmac_f32_16x16x64_bf16 v[68:71], v[24:27], v[216:223], v5
    v_mov_b32 v62, 0
    v_smfmac_f32_16x16x64_bf16 v[68:71], v[28:31], v[224:231], v5
    v_mov_b32 v63, 0
    v_smfmac_f32_16x16x64_bf16 v[68:71], v[32:35], v[232:239], v5
    v_add_f32 v64, v64, v66
    v_smfmac_f32_16x16x64_bf16 v[68:71], v[36:39], v[240:247], v5
    v_add_f32 v65, v65, v67
    v_smfmac_f32_16x16x64_bf16 v[68:71], v[40:43], v[248:255], v5
    v_cvt_pk_bf16_f32 v105, v64, v65
    v_smfmac_f32_16x16x64_bf16 v[72:75], v[16:19], a[168:175], v5
    v_smfmac_f32_16x16x64_bf16 v[72:75], v[20:23], a[176:183], v5
    v_smfmac_f32_16x16x64_bf16 v[72:75], v[24:27], a[184:191], v5
    v_smfmac_f32_16x16x64_bf16 v[72:75], v[28:31], a[192:199], v5
    v_smfmac_f32_16x16x64_bf16 v[72:75], v[32:35], a[200:207], v5
    s_nop 1
    v_add_f32 v68, v68, v70
    v_smfmac_f32_16x16x64_bf16 v[72:75], v[36:39], a[208:215], v5
    v_add_f32 v69, v69, v71
    v_smfmac_f32_16x16x64_bf16 v[72:75], v[40:43], a[216:223], v5
    v_cvt_pk_bf16_f32 v108, v68, v69
    s_nop 6
    v_add_f32 v72, v72, v74
    v_add_f32 v73, v73, v75
    v_cvt_pk_bf16_f32 v109, v72, v73
    v_mov_b32 v106, v108
    v_mov_b32 v107, v109
    s_lshl_b32 s8, s82, 12
    s_add_u32 s8, s8, 91637760
    buffer_store_dwordx4 v[104:107], v1, s[44:47], s8 offen sc1
    s_waitcnt vmcnt(0)
    s_barrier
    s_endpgm
ch2bs_mp1:
    buffer_load_dwordx4 v[36:39], v1, s[44:47], s65 offen offset:1024 sc1
    s_add_u32 s83, s83, 1
    s_cmp_ge_u32 s83, 2000000
    s_cbranch_scc1 chain_abort
    s_waitcnt vmcnt(1)
    v_max3_u32 v2, v36, v37, v38
    v_max_u32 v2, v2, v39
    v_cmp_eq_u32 vcc, -1, v2
    s_cbranch_vccnz ch2bs_mp1
    s_branch ch2bs_mok
ch2bs_m0bad:
    s_cbranch_vccnz ch2bs_mp
ch2bs_mp0:
    buffer_load_dwordx4 v[32:35], v1, s[44:47], s65 offen offset:0 sc1
    s_add_u32 s83, s83, 1
    s_cmp_ge_u32 s83, 2000000
    s_cbranch_scc1 chain_abort
    s_waitcnt vmcnt(1)
    v_max3_u32 v2, v32, v33, v34
    v_max_u32 v2, v2, v35
    v_cmp_eq_u32 vcc, -1, v2
    s_cbranch_vccnz ch2bs_mp0
    s_branch ch2bs_mok
ch2bs_hl:
    buffer_load_dword v15, off, s[44:47], s73 sc1
    s_branch ch2bs_hs
ch2bs_hu:
    v_readfirstlane_b32 s9, v15
    s_max_u32 s100, s100, s9
    s_branch ch2bs_hv
ch2bs_nw:
    v_lshlrev_b32 v100, 7, v0
    s_mov_b32 s99, 0
hz_190:
    buffer_load_dword v101, v100, s[44:47], s75 offen sc1
    s_waitcnt vmcnt(0)
    v_cmp_gt_u32 vcc, 28, v101
    s_ff1_i32_b64 s100, vcc
    s_cmp_eq_u32 s100, -1
    s_cselect_b32 s100, 65, s100
    s_sub_u32 s100, s100, 1
    s_cmp_gt_i32 s100, s64
    s_cbranch_scc1 hd_191
    s_sleep 1
    s_add_u32 s99, s99, 1
    s_cmp_lt_u32 s99, 400000
    s_cbranch_scc1 hz_190
    s_branch chain_abort
hd_191:
    s_branch ch2bs_nw2
ch2bs_k0:
    s_cmp_eq_u32 s98, 1
    s_cbranch_scc1 ch2bs_w2d
    s_cmp_ge_u32 s64, s100
    s_cbranch_scc1 ch2bs_vw
ch2bs_vok:
    s_mov_b32 m0, 24576
    s_waitcnt lgkmcnt(0)
    buffer_load_dwordx4 v1, s[44:47], s71 offen offset:0 sc1 lds
    buffer_load_dwordx4 v1, s[44:47], s71 offen offset:1024 sc1 lds
    s_branch ch2bs_w2d
ch2bs_i0:
    buffer_load_dwordx4 v[76:79], v1, s[44:47], s67 offen offset:0 sc1
    buffer_load_dwordx4 v[84:87], v1, s[44:47], s67 offen offset:2048 sc1
    s_add_u32 s83, s83, 1
    s_branch ch2bs_q120
ch2bs_i1:
    buffer_load_dwordx4 v[80:83], v1, s[44:47], s67 offen offset:1024 sc1
    buffer_load_dwordx4 v[88:91], v1, s[44:47], s67 offen offset:3072 sc1
    s_add_u32 s83, s83, 1
    s_branch ch2bs_q21
ch2bs_i2:
    buffer_load_dwordx4 v[92:95], v10, s[44:47], s67 offen offset:0 sc1
    s_add_u32 s83, s83, 1
    s_branch ch2bs_q2
ch2bs_q0:
    s_waitcnt vmcnt(0)
    v_fma_mix_f32 v102, v76, 1.0, v84 op_sel:[0,0,0] op_sel_hi:[1,0,1]
    v_fma_mix_f32 v84, v76, 1.0, v84 op_sel:[1,0,1] op_sel_hi:[1,0,1]
    v_fma_mix_f32 v76, v77, 1.0, v85 op_sel:[0,0,0] op_sel_hi:[1,0,1]
    v_fma_mix_f32 v85, v77, 1.0, v85 op_sel:[1,0,1] op_sel_hi:[1,0,1]
    v_fma_mix_f32 v77, v78, 1.0, v86 op_sel:[0,0,0] op_sel_hi:[1,0,1]
    v_fma_mix_f32 v86, v78, 1.0, v86 op_sel:[1,0,1] op_sel_hi:[1,0,1]
    v_fma_mix_f32 v78, v79, 1.0, v87 op_sel:[0,0,0] op_sel_hi:[1,0,1]
    v_fma_mix_f32 v87, v79, 1.0, v87 op_sel:[1,0,1] op_sel_hi:[1,0,1]
    v_maximum3_f32 v112, v84, v85, v86
    v_cmp_u_f32 vcc, v112, v87
    v_exp_f32 v76, v76
    v_exp_f32 v77, v77
    v_exp_f32 v78, v78
    s_cbranch_vccnz ch2bs_q0_e
    v_exp_f32 v79, v102
    v_exp_f32 v84, v84
    v_exp_f32 v85, v85
    v_pk_add_f32 v[96:97], v[76:77], v[78:79]
    v_exp_f32 v86, v86
    v_exp_f32 v87, v87
    v_pk_add_f32 v[96:97], v[96:97], v[84:85]
    v_pk_add_f32 v[96:97], v[96:97], v[86:87]
    s_branch ch2bs_k0
ch2bs_q0_e:
    buffer_load_dwordx4 v[76:79], v1, s[44:47], s67 offen offset:0 sc1
    buffer_load_dwordx4 v[84:87], v1, s[44:47], s67 offen offset:2048 sc1
    s_add_u32 s83, s83, 1
    s_and_b32 s8, s83, 63
    s_cmp_eq_u32 s8, 0
    s_cbranch_scc1 ch2bs_x
    s_branch ch2bs_q0
ch2bs_q1:
    s_waitcnt vmcnt(0)
    v_fma_mix_f32 v103, v80, 1.0, v88 op_sel:[0,0,0] op_sel_hi:[1,0,1]
    v_fma_mix_f32 v88, v80, 1.0, v88 op_sel:[1,0,1] op_sel_hi:[1,0,1]
    v_fma_mix_f32 v80, v81, 1.0, v89 op_sel:[0,0,0] op_sel_hi:[1,0,1]
    v_fma_mix_f32 v89, v81, 1.0, v89 op_sel:[1,0,1] op_sel_hi:[1,0,1]
    v_fma_mix_f32 v81, v82, 1.0, v90 op_sel:[0,0,0] op_sel_hi:[1,0,1]
    v_fma_mix_f32 v90, v82, 1.0, v90 op_sel:[1,0,1] op_sel_hi:[1,0,1]
    v_fma_mix_f32 v82, v83, 1.0, v91 op_sel:[0,0,0] op_sel_hi:[1,0,1]
    v_fma_mix_f32 v91, v83, 1.0, v91 op_sel:[1,0,1] op_sel_hi:[1,0,1]
    v_maximum3_f32 v114, v88, v89, v90
    v_cmp_u_f32 vcc, v114, v91
    v_exp_f32 v80, v80
    v_exp_f32 v81, v81
    v_exp_f32 v82, v82
    s_cbranch_vccnz ch2bs_q1_e
    v_exp_f32 v83, v103
    v_exp_f32 v88, v88
    v_exp_f32 v89, v89
    v_pk_add_f32 v[98:99], v[80:81], v[82:83]
    v_exp_f32 v90, v90
    v_exp_f32 v91, v91
    v_pk_add_f32 v[98:99], v[98:99], v[88:89]
    v_pk_add_f32 v[98:99], v[98:99], v[90:91]
    s_branch ch2bs_k0
ch2bs_q1_e:
    buffer_load_dwordx4 v[80:83], v1, s[44:47], s67 offen offset:1024 sc1
    buffer_load_dwordx4 v[88:91], v1, s[44:47], s67 offen offset:3072 sc1
    s_add_u32 s83, s83, 1
    s_and_b32 s8, s83, 63
    s_cmp_eq_u32 s8, 0
    s_cbranch_scc1 ch2bs_x
    s_branch ch2bs_q1
ch2bs_q2:
    s_waitcnt vmcnt(0)
    v_fma_mix_f32 v113, v92, 1.0, v94 op_sel:[0,0,0] op_sel_hi:[1,0,1]
    v_fma_mix_f32 v94, v92, 1.0, v94 op_sel:[1,0,1] op_sel_hi:[1,0,1]
    v_fma_mix_f32 v92, v93, 1.0, v95 op_sel:[0,0,0] op_sel_hi:[1,0,1]
    v_fma_mix_f32 v95, v93, 1.0, v95 op_sel:[1,0,1] op_sel_hi:[1,0,1]
    v_cmp_u_f32 vcc, v94, v95
    v_exp_f32 v92, v92
    v_exp_f32 v93, v113
    v_exp_f32 v94, v94
    s_cbranch_vccnz ch2bs_q2_e
    v_exp_f32 v95, v95
    s_nop 0
    v_pk_add_f32 v[100:101], v[92:93], v[94:95]
    s_branch ch2bs_k0
ch2bs_q2_e:
    buffer_load_dwordx4 v[92:95], v10, s[44:47], s67 offen offset:0 sc1
    s_add_u32 s83, s83, 1
    s_and_b32 s8, s83, 63
    s_cmp_eq_u32 s8, 0
    s_cbranch_scc1 ch2bs_x
    s_branch ch2bs_q2
ch2bs_q01:
    s_waitcnt vmcnt(2)
    v_fma_mix_f32 v102, v76, 1.0, v84 op_sel:[0,0,0] op_sel_hi:[1,0,1]
    v_fma_mix_f32 v84, v76, 1.0, v84 op_sel:[1,0,1] op_sel_hi:[1,0,1]
    v_fma_mix_f32 v76, v77, 1.0, v85 op_sel:[0,0,0] op_sel_hi:[1,0,1]
    v_fma_mix_f32 v85, v77, 1.0, v85 op_sel:[1,0,1] op_sel_hi:[1,0,1]
    v_fma_mix_f32 v77, v78, 1.0, v86 op_sel:[0,0,0] op_sel_hi:[1,0,1]
    v_fma_mix_f32 v86, v78, 1.0, v86 op_sel:[1,0,1] op_sel_hi:[1,0,1]
    v_fma_mix_f32 v78, v79, 1.0, v87 op_sel:[0,0,0] op_sel_hi:[1,0,1]
    v_fma_mix_f32 v87, v79, 1.0, v87 op_sel:[1,0,1] op_sel_hi:[1,0,1]
    v_maximum3_f32 v112, v84, v85, v86
    v_cmp_u_f32 vcc, v112, v87
    v_exp_f32 v76, v76
    v_exp_f32 v77, v77
    v_exp_f32 v78, v78
    s_cbranch_vccnz ch2bs_q01_e
    v_exp_f32 v79, v102
    v_exp_f32 v84, v84
    v_exp_f32 v85, v85
    v_pk_add_f32 v[96:97], v[76:77], v[78:79]
    v_exp_f32 v86, v86
    v_exp_f32 v87, v87
    v_pk_add_f32 v[96:97], v[96:97], v[84:85]
    v_pk_add_f32 v[96:97], v[96:97], v[86:87]
    s_branch ch2bs_q1
ch2bs_q01_e:
    buffer_load_dwordx4 v[76:79], v1, s[44:47], s67 offen offset:0 sc1
    buffer_load_dwordx4 v[84:87], v1, s[44:47], s67 offen offset:2048 sc1
    s_add_u32 s83, s83, 1
    s_and_b32 s8, s83, 63
    s_cmp_eq_u32 s8, 0
    s_cbranch_scc1 ch2bs_x
    s_branch ch2bs_q10
ch2bs_q02:
    s_waitcnt vmcnt(1)
    v_fma_mix_f32 v102, v76, 1.0, v84 op_sel:[0,0,0] op_sel_hi:[1,0,1]
    v_fma_mix_f32 v84, v76, 1.0, v84 op_sel:[1,0,1] op_sel_hi:[1,0,1]
    v_fma_mix_f32 v76, v77, 1.0, v85 op_sel:[0,0,0] op_sel_hi:[1,0,1]
    v_fma_mix_f32 v85, v77, 1.0, v85 op_sel:[1,0,1] op_sel_hi:[1,0,1]
    v_fma_mix_f32 v77, v78, 1.0, v86 op_sel:[0,0,0] op_sel_hi:[1,0,1]
    v_fma_mix_f32 v86, v78, 1.0, v86 op_sel:[1,0,1] op_sel_hi:[1,0,1]
    v_fma_mix_f32 v78, v79, 1.0, v87 op_sel:[0,0,0] op_sel_hi:[1,0,1]
    v_fma_mix_f32 v87, v79, 1.0, v87 op_sel:[1,0,1] op_sel_hi:[1,0,1]
    v_maximum3_f32 v112, v84, v85, v86
    v_cmp_u_f32 vcc, v112, v87
    v_exp_f32 v76, v76
    v_exp_f32 v77, v77
    v_exp_f32 v78, v78
    s_cbranch_vccnz ch2bs_q02_e
    v_exp_f32 v79, v102
    v_exp_f32 v84, v84
    v_exp_f32 v85, v85
    v_pk_add_f32 v[96:97], v[76:77], v[78:79]
    v_exp_f32 v86, v86
    v_exp_f32 v87, v87
    v_pk_add_f32 v[96:97], v[96:97], v[84:85]
    v_pk_add_f32 v[96:97], v[96:97], v[86:87]
    s_branch ch2bs_q2
ch2bs_q02_e:
    buffer_load_dwordx4 v[76:79], v1, s[44:47], s67 offen offset:0 sc1
    buffer_load_dwordx4 v[84:87], v1, s[44:47], s67 offen offset:2048 sc1
    s_add_u32 s83, s83, 1
    s_and_b32 s8, s83, 63
    s_cmp_eq_u32 s8, 0
    s_cbranch_scc1 ch2bs_x
    s_branch ch2bs_q20
ch2bs_q10:
    s_waitcnt vmcnt(2)
    v_fma_mix_f32 v103, v80, 1.0, v88 op_sel:[0,0,0] op_sel_hi:[1,0,1]
    v_fma_mix_f32 v88, v80, 1.0, v88 op_sel:[1,0,1] op_sel_hi:[1,0,1]
    v_fma_mix_f32 v80, v81, 1.0, v89 op_sel:[0,0,0] op_sel_hi:[1,0,1]
    v_fma_mix_f32 v89, v81, 1.0, v89 op_sel:[1,0,1] op_sel_hi:[1,0,1]
    v_fma_mix_f32 v81, v82, 1.0, v90 op_sel:[0,0,0] op_sel_hi:[1,0,1]
    v_fma_mix_f32 v90, v82, 1.0, v90 op_sel:[1,0,1] op_sel_hi:[1,0,1]
    v_fma_mix_f32 v82, v83, 1.0, v91 op_sel:[0,0,0] op_sel_hi:[1,0,1]
    v_fma_mix_f32 v91, v83, 1.0, v91 op_sel:[1,0,1] op_sel_hi:[1,0,1]
    v_maximum3_f32 v114, v88, v89, v90
    v_cmp_u_f32 vcc, v114, v91
    v_exp_f32 v80, v80
    v_exp_f32 v81, v81
    v_exp_f32 v82, v82
    s_cbranch_vccnz ch2bs_q10_e
    v_exp_f32 v83, v103
    v_exp_f32 v88, v88
    v_exp_f32 v89, v89
    v_pk_add_f32 v[98:99], v[80:81], v[82:83]
    v_exp_f32 v90, v90
    v_exp_f32 v91, v91
    v_pk_add_f32 v[98:99], v[98:99], v[88:89]
    v_pk_add_f32 v[98:99], v[98:99], v[90:91]
    s_branch ch2bs_q0
ch2bs_q10_e:
    buffer_load_dwordx4 v[80:83], v1, s[44:47], s67 offen offset:1024 sc1
    buffer_load_dwordx4 v[88:91], v1, s[44:47], s67 offen offset:3072 sc1
    s_add_u32 s83, s83, 1
    s_and_b32 s8, s83, 63
    s_cmp_eq_u32 s8, 0
    s_cbranch_scc1 ch2bs_x
    s_branch ch2bs_q01
ch2bs_q12:
    s_waitcnt vmcnt(1)
    v_fma_mix_f32 v103, v80, 1.0, v88 op_sel:[0,0,0] op_sel_hi:[1,0,1]
    v_fma_mix_f32 v88, v80, 1.0, v88 op_sel:[1,0,1] op_sel_hi:[1,0,1]
    v_fma_mix_f32 v80, v81, 1.0, v89 op_sel:[0,0,0] op_sel_hi:[1,0,1]
    v_fma_mix_f32 v89, v81, 1.0, v89 op_sel:[1,0,1] op_sel_hi:[1,0,1]
    v_fma_mix_f32 v81, v82, 1.0, v90 op_sel:[0,0,0] op_sel_hi:[1,0,1]
    v_fma_mix_f32 v90, v82, 1.0, v90 op_sel:[1,0,1] op_sel_hi:[1,0,1]
    v_fma_mix_f32 v82, v83, 1.0, v91 op_sel:[0,0,0] op_sel_hi:[1,0,1]
    v_fma_mix_f32 v91, v83, 1.0, v91 op_sel:[1,0,1] op_sel_hi:[1,0,1]
    v_maximum3_f32 v114, v88, v89, v90
    v_cmp_u_f32 vcc, v114, v91
    v_exp_f32 v80, v80
    v_exp_f32 v81, v81
    v_exp_f32 v82, v82
    s_cbranch_vccnz ch2bs_q12_e
    v_exp_f32 v83, v103
    v_exp_f32 v88, v88
    v_exp_f32 v89, v89
    v_pk_add_f32 v[98:99], v[80:81], v[82:83]
    v_exp_f32 v90, v90
    v_exp_f32 v91, v91
    v_pk_add_f32 v[98:99], v[98:99], v[88:89]
    v_pk_add_f32 v[98:99], v[98:99], v[90:91]
    s_branch ch2bs_q2
ch2bs_q12_e:
    buffer_load_dwordx4 v[80:83], v1, s[44:47], s67 offen offset:1024 sc1
    buffer_load_dwordx4 v[88:91], v1, s[44:47], s67 offen offset:3072 sc1
    s_add_u32 s83, s83, 1
    s_and_b32 s8, s83, 63
    s_cmp_eq_u32 s8, 0
    s_cbranch_scc1 ch2bs_x
    s_branch ch2bs_q21
ch2bs_q20:
    s_waitcnt vmcnt(2)
    v_fma_mix_f32 v113, v92, 1.0, v94 op_sel:[0,0,0] op_sel_hi:[1,0,1]
    v_fma_mix_f32 v94, v92, 1.0, v94 op_sel:[1,0,1] op_sel_hi:[1,0,1]
    v_fma_mix_f32 v92, v93, 1.0, v95 op_sel:[0,0,0] op_sel_hi:[1,0,1]
    v_fma_mix_f32 v95, v93, 1.0, v95 op_sel:[1,0,1] op_sel_hi:[1,0,1]
    v_cmp_u_f32 vcc, v94, v95
    v_exp_f32 v92, v92
    v_exp_f32 v93, v113
    v_exp_f32 v94, v94
    s_cbranch_vccnz ch2bs_q20_e
    v_exp_f32 v95, v95
    s_nop 0
    v_pk_add_f32 v[100:101], v[92:93], v[94:95]
    s_branch ch2bs_q0
ch2bs_q20_e:
    buffer_load_dwordx4 v[92:95], v10, s[44:47], s67 offen offset:0 sc1
    s_add_u32 s83, s83, 1
    s_and_b32 s8, s83, 63
    s_cmp_eq_u32 s8, 0
    s_cbranch_scc1 ch2bs_x
    s_branch ch2bs_q02
ch2bs_q21:
    s_waitcnt vmcnt(2)
    v_fma_mix_f32 v113, v92, 1.0, v94 op_sel:[0,0,0] op_sel_hi:[1,0,1]
    v_fma_mix_f32 v94, v92, 1.0, v94 op_sel:[1,0,1] op_sel_hi:[1,0,1]
    v_fma_mix_f32 v92, v93, 1.0, v95 op_sel:[0,0,0] op_sel_hi:[1,0,1]
    v_fma_mix_f32 v95, v93, 1.0, v95 op_sel:[1,0,1] op_sel_hi:[1,0,1]
    v_cmp_u_f32 vcc, v94, v95
    v_exp_f32 v92, v92
    v_exp_f32 v93, v113
    v_exp_f32 v94, v94
    s_cbranch_vccnz ch2bs_q21_e
    v_exp_f32 v95, v95
    s_nop 0
    v_pk_add_f32 v[100:101], v[92:93], v[94:95]
    s_branch ch2bs_q1
ch2bs_q21_e:
    buffer_load_dwordx4 v[92:95], v10, s[44:47], s67 offen offset:0 sc1
    s_add_u32 s83, s83, 1
    s_and_b32 s8, s83, 63
    s_cmp_eq_u32 s8, 0
    s_cbranch_scc1 ch2bs_x
    s_branch ch2bs_q12
ch2bs_q012:
    s_waitcnt vmcnt(3)
    v_fma_mix_f32 v102, v76, 1.0, v84 op_sel:[0,0,0] op_sel_hi:[1,0,1]
    v_fma_mix_f32 v84, v76, 1.0, v84 op_sel:[1,0,1] op_sel_hi:[1,0,1]
    v_fma_mix_f32 v76, v77, 1.0, v85 op_sel:[0,0,0] op_sel_hi:[1,0,1]
    v_fma_mix_f32 v85, v77, 1.0, v85 op_sel:[1,0,1] op_sel_hi:[1,0,1]
    v_fma_mix_f32 v77, v78, 1.0, v86 op_sel:[0,0,0] op_sel_hi:[1,0,1]
    v_fma_mix_f32 v86, v78, 1.0, v86 op_sel:[1,0,1] op_sel_hi:[1,0,1]
    v_fma_mix_f32 v78, v79, 1.0, v87 op_sel:[0,0,0] op_sel_hi:[1,0,1]
    v_fma_mix_f32 v87, v79, 1.0, v87 op_sel:[1,0,1] op_sel_hi:[1,0,1]
    v_maximum3_f32 v112, v84, v85, v86
    v_cmp_u_f32 vcc, v112, v87
    v_exp_f32 v76, v76
    v_exp_f32 v77, v77
    v_exp_f32 v78, v78
    s_cbranch_vccnz ch2bs_q012_e
    v_exp_f32 v79, v102
    v_exp_f32 v84, v84
    v_exp_f32 v85, v85
    v_pk_add_f32 v[96:97], v[76:77], v[78:79]
    v_exp_f32 v86, v86
    v_exp_f32 v87, v87
    v_pk_add_f32 v[96:97], v[96:97], v[84:85]
    v_pk_add_f32 v[96:97], v[96:97], v[86:87]
    s_branch ch2bs_q12
ch2bs_q012_e:
    buffer_load_dwordx4 v[76:79], v1, s[44:47], s67 offen offset:0 sc1
    buffer_load_dwordx4 v[84:87], v1, s[44:47], s67 offen offset:2048 sc1
    s_add_u32 s83, s83, 1
    s_and_b32 s8, s83, 63
    s_cmp_eq_u32 s8, 0
    s_cbranch_scc1 ch2bs_x
    s_branch ch2bs_q120
ch2bs_q021:
    s_waitcnt vmcnt(3)
    v_fma_mix_f32 v102, v76, 1.0, v84 op_sel:[0,0,0] op_sel_hi:[1,0,1]
    v_fma_mix_f32 v84, v76, 1.0, v84 op_sel:[1,0,1] op_sel_hi:[1,0,1]
    v_fma_mix_f32 v76, v77, 1.0, v85 op_sel:[0,0,0] op_sel_hi:[1,0,1]
    v_fma_mix_f32 v85, v77, 1.0, v85 op_sel:[1,0,1] op_sel_hi:[1,0,1]
    v_fma_mix_f32 v77, v78, 1.0, v86 op_sel:[0,0,0] op_sel_hi:[1,0,1]
    v_fma_mix_f32 v86, v78, 1.0, v86 op_sel:[1,0,1] op_sel_hi:[1,0,1]
    v_fma_mix_f32 v78, v79, 1.0, v87 op_sel:[0,0,0] op_sel_hi:[1,0,1]
    v_fma_mix_f32 v87, v79, 1.0, v87 op_sel:[1,0,1] op_sel_hi:[1,0,1]
    v_maximum3_f32 v112, v84, v85, v86
    v_cmp_u_f32 vcc, v112, v87
    v_exp_f32 v76, v76
    v_exp_f32 v77, v77
    v_exp_f32 v78, v78
    s_cbranch_vccnz ch2bs_q021_e
    v_exp_f32 v79, v102
    v_exp_f32 v84, v84
    v_exp_f32 v85, v85
    v_pk_add_f32 v[96:97], v[76:77], v[78:79]
    v_exp_f32 v86, v86
    v_exp_f32 v87, v87
    v_pk_add_f32 v[96:97], v[96:97], v[84:85]
    v_pk_add_f32 v[96:97], v[96:97], v[86:87]
    s_branch ch2bs_q21
ch2bs_q021_e:
    buffer_load_dwordx4 v[76:79], v1, s[44:47], s67 offen offset:0 sc1
    buffer_load_dwordx4 v[84:87], v1, s[44:47], s67 offen offset:2048 sc1
    s_add_u32 s83, s83, 1
    s_and_b32 s8, s83, 63
    s_cmp_eq_u32 s8, 0
    s_cbranch_scc1 ch2bs_x
    s_branch ch2bs_q210
ch2bs_q102:
    s_waitcnt vmcnt(3)
    v_fma_mix_f32 v103, v80, 1.0, v88 op_sel:[0,0,0] op_sel_hi:[1,0,1]
    v_fma_mix_f32 v88, v80, 1.0, v88 op_sel:[1,0,1] op_sel_hi:[1,0,1]
    v_fma_mix_f32 v80, v81, 1.0, v89 op_sel:[0,0,0] op_sel_hi:[1,0,1]
    v_fma_mix_f32 v89, v81, 1.0, v89 op_sel:[1,0,1] op_sel_hi:[1,0,1]
    v_fma_mix_f32 v81, v82, 1.0, v90 op_sel:[0,0,0] op_sel_hi:[1,0,1]
    v_fma_mix_f32 v90, v82, 1.0, v90 op_sel:[1,0,1] op_sel_hi:[1,0,1]
    v_fma_mix_f32 v82, v83, 1.0, v91 op_sel:[0,0,0] op_sel_hi:[1,0,1]
    v_fma_mix_f32 v91, v83, 1.0, v91 op_sel:[1,0,1] op_sel_hi:[1,0,1]
    v_maximum3_f32 v114, v88, v89, v90
    v_cmp_u_f32 vcc, v114, v91
    v_exp_f32 v80, v80
    v_exp_f32 v81, v81
    v_exp_f32 v82, v82
    s_cbranch_vccnz ch2bs_q102_e
    v_exp_f32 v83, v103
    v_exp_f32 v88, v88
    v_exp_f32 v89, v89
    v_pk_add_f32 v[98:99], v[80:81], v[82:83]
    v_exp_f32 v90, v90
    v_exp_f32 v91, v91
    v_pk_add_f32 v[98:99], v[98:99], v[88:89]
    v_pk_add_f32 v[98:99], v[98:99], v[90:91]
    s_branch ch2bs_q02
ch2bs_q102_e:
    buffer_load_dwordx4 v[80:83], v1, s[44:47], s67 offen offset:1024 sc1
    buffer_load_dwordx4 v[88:91], v1, s[44:47], s67 offen offset:3072 sc1
    s_add_u32 s83, s83, 1
    s_and_b32 s8, s83, 63
    s_cmp_eq_u32 s8, 0
    s_cbranch_scc1 ch2bs_x
    s_branch ch2bs_q021
ch2bs_q120:
    s_waitcnt vmcnt(3)
    v_fma_mix_f32 v103, v80, 1.0, v88 op_sel:[0,0,0] op_sel_hi:[1,0,1]
    v_fma_mix_f32 v88, v80, 1.0, v88 op_sel:[1,0,1] op_sel_hi:[1,0,1]
    v_fma_mix_f32 v80, v81, 1.0, v89 op_sel:[0,0,0] op_sel_hi:[1,0,1]
    v_fma_mix_f32 v89, v81, 1.0, v89 op_sel:[1,0,1] op_sel_hi:[1,0,1]
    v_fma_mix_f32 v81, v82, 1.0, v90 op_sel:[0,0,0] op_sel_hi:[1,0,1]
    v_fma_mix_f32 v90, v82, 1.0, v90 op_sel:[1,0,1] op_sel_hi:[1,0,1]
    v_fma_mix_f32 v82, v83, 1.0, v91 op_sel:[0,0,0] op_sel_hi:[1,0,1]
    v_fma_mix_f32 v91, v83, 1.0, v91 op_sel:[1,0,1] op_sel_hi:[1,0,1]
    v_maximum3_f32 v114, v88, v89, v90
    v_cmp_u_f32 vcc, v114, v91
    v_exp_f32 v80, v80
    v_exp_f32 v81, v81
    v_exp_f32 v82, v82
    s_cbranch_vccnz ch2bs_q120_e
    v_exp_f32 v83, v103
    v_exp_f32 v88, v88
    v_exp_f32 v89, v89
    v_pk_add_f32 v[98:99], v[80:81], v[82:83]
    v_exp_f32 v90, v90
    v_exp_f32 v91, v91
    v_pk_add_f32 v[98:99], v[98:99], v[88:89]
    v_pk_add_f32 v[98:99], v[98:99], v[90:91]
    s_branch ch2bs_q20
ch2bs_q120_e:
    buffer_load_dwordx4 v[80:83], v1, s[44:47], s67 offen offset:1024 sc1
    buffer_load_dwordx4 v[88:91], v1, s[44:47], s67 offen offset:3072 sc1
    s_add_u32 s83, s83, 1
    s_and_b32 s8, s83, 63
    s_cmp_eq_u32 s8, 0
    s_cbranch_scc1 ch2bs_x
    s_branch ch2bs_q201
ch2bs_q201:
    s_waitcnt vmcnt(4)
    v_fma_mix_f32 v113, v92, 1.0, v94 op_sel:[0,0,0] op_sel_hi:[1,0,1]
    v_fma_mix_f32 v94, v92, 1.0, v94 op_sel:[1,0,1] op_sel_hi:[1,0,1]
    v_fma_mix_f32 v92, v93, 1.0, v95 op_sel:[0,0,0] op_sel_hi:[1,0,1]
    v_fma_mix_f32 v95, v93, 1.0, v95 op_sel:[1,0,1] op_sel_hi:[1,0,1]
    v_cmp_u_f32 vcc, v94, v95
    v_exp_f32 v92, v92
    v_exp_f32 v93, v113
    v_exp_f32 v94, v94
    s_cbranch_vccnz ch2bs_q201_e
    v_exp_f32 v95, v95
    s_nop 0
    v_pk_add_f32 v[100:101], v[92:93], v[94:95]
    s_branch ch2bs_q01
ch2bs_q201_e:
    buffer_load_dwordx4 v[92:95], v10, s[44:47], s67 offen offset:0 sc1
    s_add_u32 s83, s83, 1
    s_and_b32 s8, s83, 63
    s_cmp_eq_u32 s8, 0
    s_cbranch_scc1 ch2bs_x
    s_branch ch2bs_q012
ch2bs_q210:
    s_waitcnt vmcnt(4)
    v_fma_mix_f32 v113, v92, 1.0, v94 op_sel:[0,0,0] op_sel_hi:[1,0,1]
    v_fma_mix_f32 v94, v92, 1.0, v94 op_sel:[1,0,1] op_sel_hi:[1,0,1]
    v_fma_mix_f32 v92, v93, 1.0, v95 op_sel:[0,0,0] op_sel_hi:[1,0,1]
    v_fma_mix_f32 v95, v93, 1.0, v95 op_sel:[1,0,1] op_sel_hi:[1,0,1]
    v_cmp_u_f32 vcc, v94, v95
    v_exp_f32 v92, v92
    v_exp_f32 v93, v113
    v_exp_f32 v94, v94
    s_cbranch_vccnz ch2bs_q210_e
    v_exp_f32 v95, v95
    v_pk_add_f32 v[100:101], v[92:93], v[94:95]
    s_branch ch2bs_q10
ch2bs_q210_e:
    buffer_load_dwordx4 v[92:95], v10, s[44:47], s67 offen offset:0 sc1
    s_add_u32 s83, s83, 1
    s_and_b32 s8, s83, 63
    s_cmp_eq_u32 s8, 0
    s_cbranch_scc1 ch2bs_x
    s_branch ch2bs_q102
ch2bs_fb:
    buffer_load_dwordx4 v[76:79], v1, s[44:47], s67 offen offset:0 sc1
    buffer_load_dwordx4 v[84:87], v1, s[44:47], s67 offen offset:2048 sc1
    buffer_load_dwordx4 v[80:83], v1, s[44:47], s67 offen offset:1024 sc1
    buffer_load_dwordx4 v[88:91], v1, s[44:47], s67 offen offset:3072 sc1
    buffer_load_dwordx4 v[92:95], v10, s[44:47], s67 offen offset:0 sc1
    s_waitcnt vmcnt(0)
    v_fma_mix_f32 v102, v76, 1.0, v84 op_sel:[0,0,0] op_sel_hi:[1,0,1]
    v_fma_mix_f32 v84, v76, 1.0, v84 op_sel:[1,0,1] op_sel_hi:[1,0,1]
    v_fma_mix_f32 v76, v77, 1.0, v85 op_sel:[0,0,0] op_sel_hi:[1,0,1]
    v_fma_mix_f32 v85, v77, 1.0, v85 op_sel:[1,0,1] op_sel_hi:[1,0,1]
    v_fma_mix_f32 v77, v78, 1.0, v86 op_sel:[0,0,0] op_sel_hi:[1,0,1]
    v_fma_mix_f32 v86, v78, 1.0, v86 op_sel:[1,0,1] op_sel_hi:[1,0,1]
    v_fma_mix_f32 v78, v79, 1.0, v87 op_sel:[0,0,0] op_sel_hi:[1,0,1]
    v_fma_mix_f32 v87, v79, 1.0, v87 op_sel:[1,0,1] op_sel_hi:[1,0,1]
    v_maximum3_f32 v112, v102, v84, v76
    v_maximum3_f32 v112, v112, v85, v77
    v_maximum3_f32 v112, v112, v86, v78
    v_maximum3_f32 v112, v112, v87, v87
    v_cmp_u_f32 vcc, v112, v112
    v_mov_b32 v79, v102
    v_pk_add_f32 v[76:77], v[76:77], v[112:113] op_sel_hi:[1,0] neg_lo:[0,1] neg_hi:[0,1]
    v_pk_add_f32 v[78:79], v[78:79], v[112:113] op_sel_hi:[1,0] neg_lo:[0,1] neg_hi:[0,1]
    v_pk_add_f32 v[84:85], v[84:85], v[112:113] op_sel_hi:[1,0] neg_lo:[0,1] neg_hi:[0,1]
    v_pk_add_f32 v[86:87], v[86:87], v[112:113] op_sel_hi:[1,0] neg_lo:[0,1] neg_hi:[0,1]
    v_exp_f32 v76, v76
    v_exp_f32 v77, v77
    v_exp_f32 v78, v78
    v_exp_f32 v79, v79
    v_exp_f32 v84, v84
    v_exp_f32 v85, v85
    v_pk_add_f32 v[96:97], v[76:77], v[78:79]
    v_exp_f32 v86, v86
    v_exp_f32 v87, v87
    v_pk_add_f32 v[96:97], v[96:97], v[84:85]
    v_pk_add_f32 v[96:97], v[96:97], v[86:87]
    v_fma_mix_f32 v103, v80, 1.0, v88 op_sel:[0,0,0] op_sel_hi:[1,0,1]
    v_fma_mix_f32 v88, v80, 1.0, v88 op_sel:[1,0,1] op_sel_hi:[1,0,1]
    v_fma_mix_f32 v80, v81, 1.0, v89 op_sel:[0,0,0] op_sel_hi:[1,0,1]
    v_fma_mix_f32 v89, v81, 1.0, v89 op_sel:[1,0,1] op_sel_hi:[1,0,1]
    v_fma_mix_f32 v81, v82, 1.0, v90 op_sel:[0,0,0] op_sel_hi:[1,0,1]
    v_fma_mix_f32 v90, v82, 1.0, v90 op_sel:[1,0,1] op_sel_hi:[1,0,1]
    v_fma_mix_f32 v82, v83, 1.0, v91 op_sel:[0,0,0] op_sel_hi:[1,0,1]
    v_fma_mix_f32 v91, v83, 1.0, v91 op_sel:[1,0,1] op_sel_hi:[1,0,1]
    v_maximum3_f32 v114, v103, v88, v80
    v_maximum3_f32 v114, v114, v89, v81
    v_maximum3_f32 v114, v114, v90, v82
    v_maximum3_f32 v114, v114, v91, v91
    v_cmp_u_f32 vcc, v114, v114
    v_mov_b32 v83, v103
    v_pk_add_f32 v[80:81], v[80:81], v[114:115] op_sel_hi:[1,0] neg_lo:[0,1] neg_hi:[0,1]
    v_pk_add_f32 v[82:83], v[82:83], v[114:115] op_sel_hi:[1,0] neg_lo:[0,1] neg_hi:[0,1]
    v_pk_add_f32 v[88:89], v[88:89], v[114:115] op_sel_hi:[1,0] neg_lo:[0,1] neg_hi:[0,1]
    v_pk_add_f32 v[90:91], v[90:91], v[114:115] op_sel_hi:[1,0] neg_lo:[0,1] neg_hi:[0,1]
    v_exp_f32 v80, v80
    v_exp_f32 v81, v81
    v_exp_f32 v82, v82
    v_exp_f32 v83, v83
    v_exp_f32 v88, v88
    v_exp_f32 v89, v89
    v_pk_add_f32 v[98:99], v[80:81], v[82:83]
    v_exp_f32 v90, v90
    v_exp_f32 v91, v91
    v_pk_add_f32 v[98:99], v[98:99], v[88:89]
    v_pk_add_f32 v[98:99], v[98:99], v[90:91]
    v_fma_mix_f32 v113, v92, 1.0, v94 op_sel:[0,0,0] op_sel_hi:[1,0,1]
    v_fma_mix_f32 v94, v92, 1.0, v94 op_sel:[1,0,1] op_sel_hi:[1,0,1]
    v_fma_mix_f32 v92, v93, 1.0, v95 op_sel:[0,0,0] op_sel_hi:[1,0,1]
    v_fma_mix_f32 v95, v93, 1.0, v95 op_sel:[1,0,1] op_sel_hi:[1,0,1]
    v_maximum3_f32 v116, v113, v94, v92
    v_maximum3_f32 v116, v116, v95, v95
    v_cmp_u_f32 vcc, v116, v116
    v_mov_b32 v93, v113
    v_pk_add_f32 v[92:93], v[92:93], v[116:117] op_sel_hi:[1,0] neg_lo:[0,1] neg_hi:[0,1]
    v_pk_add_f32 v[94:95], v[94:95], v[116:117] op_sel_hi:[1,0] neg_lo:[0,1] neg_hi:[0,1]
    v_exp_f32 v92, v92
    v_exp_f32 v93, v93
    v_exp_f32 v94, v94
    v_exp_f32 v95, v95
    s_nop 0
    v_pk_add_f32 v[100:101], v[92:93], v[94:95]
    v_max3_f32 v2, v112, v114, v116
    v_max3_f32 v15, v112, v114, v116
    v_add_f32 v96, v96, v97
    v_add_f32 v98, v98, v99
    v_add_f32 v100, v100, v101
    v_permlane16_swap_b32 v2, v15
    v_max_f32 v2, v2, v15
    v_sub_f32 v112, v112, v2
    v_sub_f32 v114, v114, v2
    v_sub_f32 v116, v116, v2
    v_exp_f32 v112, v112
    v_exp_f32 v114, v114
    v_exp_f32 v116, v116
    v_mul_f32 v2, v112, v96
    v_fmac_f32 v2, v114, v98
    v_fmac_f32 v2, v116, v100
    v_mov_b32 v15, v2
    s_nop 1
    v_permlane16_swap_b32 v2, v15
    v_add_f32 v2, v2, v15
    v_rcp_f32 v2, v2
    s_nop 0
    v_mul_f32 v116, v116, v2
    v_mul_f32 v112, v112, v2
    v_mul_f32 v114, v114, v2
    s_waitcnt lgkmcnt(0)
    v_pk_mul_f32 v[92:93], v[92:93], v[116:117] op_sel_hi:[1,0]
    v_pk_mul_f32 v[94:95], v[94:95], v[116:117] op_sel_hi:[1,0]
    v_cvt_pk_bf16_f32 v116, v93, v94
    v_cvt_pk_bf16_f32 v118, v92, v95
    v_pk_mul_f32 v[76:77], v[76:77], v[112:113] op_sel_hi:[1,0]
    v_pk_mul_f32 v[78:79], v[78:79], v[112:113] op_sel_hi:[1,0]
    v_pk_mul_f32 v[84:85], v[84:85], v[112:113] op_sel_hi:[1,0]
    v_pk_mul_f32 v[86:87], v[86:87], v[112:113] op_sel_hi:[1,0]
    v_cvt_pk_bf16_f32 v96, v79, v84
    v_cvt_pk_bf16_f32 v97, v76, v85
    v_cvt_pk_bf16_f32 v98, v77, v86
    v_cvt_pk_bf16_f32 v99, v78, v87
    v_pk_mul_f32 v[80:81], v[80:81], v[114:115] op_sel_hi:[1,0]
    v_pk_mul_f32 v[82:83], v[82:83], v[114:115] op_sel_hi:[1,0]
    v_pk_mul_f32 v[88:89], v[88:89], v[114:115] op_sel_hi:[1,0]
    v_pk_mul_f32 v[90:91], v[90:91], v[114:115] op_sel_hi:[1,0]
    v_smfmac_f32_16x16x64_bf16 v[60:63], v[116:119], v[104:111], v5
    v_cvt_pk_bf16_f32 v100, v83, v88
    v_cvt_pk_bf16_f32 v101, v80, v89
    v_smfmac_f32_16x16x64_bf16 v[60:63], v[96:99], v[44:51], v5
    v_cvt_pk_bf16_f32 v102, v81, v90
    v_cvt_pk_bf16_f32 v103, v82, v91
    s_nop 1
    v_smfmac_f32_16x16x64_bf16 v[60:63], v[100:103], v[52:59], v5
    s_branch ch2bs_kj
ch2bs_x:
    s_cmp_ge_u32 s83, 2000000
    s_cbranch_scc1 chain_abort
    buffer_load_dwordx4 v[76:79], v1, s[44:47], s67 offen offset:0 sc1
    buffer_load_dwordx4 v[84:87], v1, s[44:47], s67 offen offset:2048 sc1
    buffer_load_dwordx4 v[80:83], v1, s[44:47], s67 offen offset:1024 sc1
    buffer_load_dwordx4 v[88:91], v1, s[44:47], s67 offen offset:3072 sc1
    buffer_load_dwordx4 v[92:95], v10, s[44:47], s67 offen offset:0 sc1
    s_waitcnt vmcnt(0)
    v_pk_max_u16 v2, v76, v77
    v_pk_max_u16 v2, v2, v78
    v_pk_max_u16 v2, v2, v79
    v_pk_max_u16 v2, v2, v80
    v_pk_max_u16 v2, v2, v81
    v_pk_max_u16 v2, v2, v82
    v_pk_max_u16 v2, v2, v83
    v_pk_max_u16 v2, v2, v84
    v_pk_max_u16 v2, v2, v85
    v_pk_max_u16 v2, v2, v86
    v_pk_max_u16 v2, v2, v87
    v_pk_max_u16 v2, v2, v88
    v_pk_max_u16 v2, v2, v89
    v_pk_max_u16 v2, v2, v90
    v_pk_max_u16 v2, v2, v91
    v_pk_max_u16 v2, v2, v92
    v_pk_max_u16 v2, v2, v93
    v_pk_max_u16 v2, v2, v94
    v_pk_max_u16 v2, v2, v95
    v_lshrrev_b32 v112, 16, v2
    v_and_b32 v2, 0xffff, v2
    v_max_u32 v2, v2, v112
    v_cmp_eq_u32 vcc, 0xffff, v2
    s_cbranch_vccnz ch2bs_q012
    v_fma_mix_f32 v102, v76, 1.0, v84 op_sel:[0,0,0] op_sel_hi:[1,0,1]
    v_fma_mix_f32 v84, v76, 1.0, v84 op_sel:[1,0,1] op_sel_hi:[1,0,1]
    v_fma_mix_f32 v76, v77, 1.0, v85 op_sel:[0,0,0] op_sel_hi:[1,0,1]
    v_fma_mix_f32 v85, v77, 1.0, v85 op_sel:[1,0,1] op_sel_hi:[1,0,1]
    v_fma_mix_f32 v77, v78, 1.0, v86 op_sel:[0,0,0] op_sel_hi:[1,0,1]
    v_fma_mix_f32 v86, v78, 1.0, v86 op_sel:[1,0,1] op_sel_hi:[1,0,1]
    v_fma_mix_f32 v78, v79, 1.0, v87 op_sel:[0,0,0] op_sel_hi:[1,0,1]
    v_fma_mix_f32 v87, v79, 1.0, v87 op_sel:[1,0,1] op_sel_hi:[1,0,1]
    v_exp_f32 v76, v76
    v_exp_f32 v77, v77
    v_exp_f32 v78, v78
    v_exp_f32 v79, v102
    v_exp_f32 v84, v84
    v_exp_f32 v85, v85
    v_pk_add_f32 v[96:97], v[76:77], v[78:79]
    v_exp_f32 v86, v86
    v_exp_f32 v87, v87
    v_pk_add_f32 v[96:97], v[96:97], v[84:85]
    v_pk_add_f32 v[96:97], v[96:97], v[86:87]
    v_fma_mix_f32 v103, v80, 1.0, v88 op_sel:[0,0,0] op_sel_hi:[1,0,1]
    v_fma_mix_f32 v88, v80, 1.0, v88 op_sel:[1,0,1] op_sel_hi:[1,0,1]
    v_fma_mix_f32 v80, v81, 1.0, v89 op_sel:[0,0,0] op_sel_hi:[1,0,1]
    v_fma_mix_f32 v89, v81, 1.0, v89 op_sel:[1,0,1] op_sel_hi:[1,0,1]
    v_fma_mix_f32 v81, v82, 1.0, v90 op_sel:[0,0,0] op_sel_hi:[1,0,1]
    v_fma_mix_f32 v90, v82, 1.0, v90 op_sel:[1,0,1] op_sel_hi:[1,0,1]
    v_fma_mix_f32 v82, v83, 1.0, v91 op_sel:[0,0,0] op_sel_hi:[1,0,1]
    v_fma_mix_f32 v91, v83, 1.0, v91 op_sel:[1,0,1] op_sel_hi:[1,0,1]
    v_exp_f32 v80, v80
    v_exp_f32 v81, v81
    v_exp_f32 v82, v82
    v_exp_f32 v83, v103
    v_exp_f32 v88, v88
    v_exp_f32 v89, v89
    v_pk_add_f32 v[98:99], v[80:81], v[82:83]
    v_exp_f32 v90, v90
    v_exp_f32 v91, v91
    v_pk_add_f32 v[98:99], v[98:99], v[88:89]
    v_pk_add_f32 v[98:99], v[98:99], v[90:91]
    v_fma_mix_f32 v113, v92, 1.0, v94 op_sel:[0,0,0] op_sel_hi:[1,0,1]
    v_fma_mix_f32 v94, v92, 1.0, v94 op_sel:[1,0,1] op_sel_hi:[1,0,1]
    v_fma_mix_f32 v92, v93, 1.0, v95 op_sel:[0,0,0] op_sel_hi:[1,0,1]
    v_fma_mix_f32 v95, v93, 1.0, v95 op_sel:[1,0,1] op_sel_hi:[1,0,1]
    v_exp_f32 v92, v92
    v_exp_f32 v93, v113
    v_exp_f32 v94, v94
    v_exp_f32 v95, v95
    s_nop 0
    v_pk_add_f32 v[100:101], v[92:93], v[94:95]
    s_branch ch2bs_k0
ch2bs_vw:
    v_lshlrev_b32 v113, 7, v0
    s_mov_b32 s99, 0
hz_192:
    buffer_load_dword v115, v113, s[44:47], s75 offen sc1
    s_waitcnt vmcnt(0)
    v_cmp_gt_u32 vcc, 28, v115
    s_ff1_i32_b64 s100, vcc
    s_cmp_eq_u32 s100, -1
    s_cselect_b32 s100, 65, s100
    s_sub_u32 s100, s100, 1
    s_cmp_gt_i32 s100, s64
    s_cbranch_scc1 hd_193
    s_sleep 1
    s_add_u32 s99, s99, 1
    s_cmp_lt_u32 s99, 400000
    s_cbranch_scc1 hz_192
    s_branch chain_abort
hd_193:
    s_branch ch2bs_vok
ch2as:
    v_mov_b32 v44, 0
    v_mov_b32 v60, 0
    v_mov_b32 v45, 0
    v_mov_b32 v61, 0
    v_mov_b32 v46, 0
    v_mov_b32 v62, 0
    v_mov_b32 v47, 0
    v_mov_b32 v63, 0
    v_mov_b32 v48, 0
    v_mov_b32 v64, 0
    v_mov_b32 v49, 0
    v_mov_b32 v65, 0
    v_mov_b32 v50, 0
    v_mov_b32 v66, 0
    v_mov_b32 v51, 0
    v_mov_b32 v67, 0
    v_mov_b32 v52, 0
    v_mov_b32 v68, 0
    v_mov_b32 v53, 0
    v_mov_b32 v69, 0
    v_mov_b32 v54, 0
    v_mov_b32 v70, 0
    v_mov_b32 v55, 0
    v_mov_b32 v71, 0
    v_mov_b32 v56, 0
    v_mov_b32 v72, 0
    v_mov_b32 v57, 0
    v_mov_b32 v73, 0
    v_mov_b32 v58, 0
    v_mov_b32 v74, 0
    v_mov_b32 v59, 0
    v_mov_b32 v75, 0
    v_mov_b32 v112, 0
    v_mov_b32 v113, 0
    v_mov_b32 v114, 0
    v_mov_b32 v115, 0
    s_branch ch2as_loop
.p2align 6
ch2as_loop:
    s_and_b32 s8, s64, 3
    s_lshl_b32 s65, s8, 13
    s_add_u32 s65, s65, 94900224
    buffer_load_dwordx4 v[32:35], v1, s[44:47], s65 offen offset:0 sc1
    buffer_load_dwordx4 v[36:39], v1, s[44:47], s65 offen offset:1024 sc1
    s_mov_b32 s83, 0
    s_and_b32 s8, s64, 3
    s_mul_i32 s9, s8, 20736
    s_add_u32 s67, s9, 94939136
    s_add_u32 s66, s9, s12
    s_xor_b32 s8, s8, 2
    s_mul_i32 s9, s8, 20736
    s_add_u32 s70, s9, s13
ch2as_mp:
    buffer_load_dwordx4 v[32:35], v1, s[44:47], s65 offen offset:0 sc1
    buffer_load_dwordx4 v[36:39], v1, s[44:47], s65 offen offset:1024 sc1
    s_add_u32 s83, s83, 1
    s_cmp_ge_u32 s83, 2000000
    s_cbranch_scc1 chain_abort
    s_waitcnt vmcnt(3)
    v_max3_u32 v2, v32, v33, v34
    v_max_u32 v2, v2, v35
    v_cmp_eq_u32 s[10:11], -1, v2
    s_waitcnt vmcnt(2)
    v_max3_u32 v2, v36, v37, v38
    v_max_u32 v2, v2, v39
    v_cmp_eq_u32 vcc, -1, v2
    s_cmp_lg_u64 s[10:11], 0
    s_cbranch_scc1 ch2as_m0bad
    s_cbranch_vccnz ch2as_mp1
ch2as_mok:
    ds_write_b128 v1, v[32:35] offset:4096
    ds_write_b128 v1, v[36:39] offset:5120
    v_smfmac_f32_16x16x64_bf16 v[44:47], v[32:35], a[32:39], v5
    v_smfmac_f32_16x16x64_bf16 v[48:51], v[32:35], a[88:95], v5
    s_waitcnt lgkmcnt(0)
    s_barrier
    ds_read_b128 v[16:19], v1 offset:0
    ds_read_b128 v[20:23], v1 offset:1024
    ds_read_b128 v[24:27], v1 offset:2048
    ds_read_b128 v[28:31], v1 offset:3072
    ds_read_b128 v[40:43], v1 offset:6144
    v_smfmac_f32_16x16x64_bf16 v[52:55], v[32:35], a[144:151], v5
    buffer_store_dword v3, v4, s[44:47], s70 offen sc1
    v_smfmac_f32_16x16x64_bf16 v[44:47], v[36:39], a[40:47], v5
    v_smfmac_f32_16x16x64_bf16 v[48:51], v[36:39], a[96:103], v5
    v_smfmac_f32_16x16x64_bf16 v[52:55], v[36:39], a[152:159], v5
    s_waitcnt lgkmcnt(4)
    v_smfmac_f32_16x16x64_bf16 v[44:47], v[16:19], a[0:7], v5
    s_waitcnt lgkmcnt(3)
    v_smfmac_f32_16x16x64_bf16 v[44:47], v[20:23], a[8:15], v5
    s_waitcnt lgkmcnt(2)
    v_smfmac_f32_16x16x64_bf16 v[44:47], v[24:27], a[16:23], v5
    ds_read_b128 v[76:79], v12 offset:0
    s_waitcnt lgkmcnt(2)
    v_smfmac_f32_16x16x64_bf16 v[44:47], v[28:31], a[24:31], v5
    ds_read_b128 v[80:83], v12 offset:1024
    s_waitcnt lgkmcnt(2)
    v_smfmac_f32_16x16x64_bf16 v[44:47], v[40:43], a[48:55], v5
    ds_read_b128 v[84:87], v12 offset:2048
    v_smfmac_f32_16x16x64_bf16 v[48:51], v[16:19], a[56:63], v5
    ds_read_b128 v[88:91], v12 offset:3072
    v_smfmac_f32_16x16x64_bf16 v[48:51], v[20:23], a[64:71], v5
    ds_read_b128 v[92:95], v12 offset:4096
    v_smfmac_f32_16x16x64_bf16 v[48:51], v[24:27], a[72:79], v5
    ds_read_b128 v[96:99], v12 offset:5120
    v_smfmac_f32_16x16x64_bf16 v[48:51], v[28:31], a[80:87], v5
    v_add_f32 v44, v44, v46
    v_smfmac_f32_16x16x64_bf16 v[48:51], v[40:43], a[104:111], v5
    v_add_f32 v45, v45, v47
    v_smfmac_f32_16x16x64_bf16 v[52:55], v[16:19], a[112:119], v5
    v_cvt_pk_bf16_f32 v44, v44, v45
    v_smfmac_f32_16x16x64_bf16 v[52:55], v[20:23], a[120:127], v5
    ds_write_b32 v6, v44 offset:1536
    v_smfmac_f32_16x16x64_bf16 v[52:55], v[24:27], a[128:135], v5
    ds_read_b128 v[100:103], v12 offset:6144
    v_smfmac_f32_16x16x64_bf16 v[52:55], v[28:31], a[136:143], v5
    v_add_f32 v48, v48, v50
    v_smfmac_f32_16x16x64_bf16 v[52:55], v[40:43], a[160:167], v5
    v_add_f32 v49, v49, v51
    v_cvt_pk_bf16_f32 v48, v48, v49
    ds_write_b32 v6, v48 offset:1792
    v_xor_b32 v12, 0x4000, v12
    s_nop 3
    v_add_f32 v52, v52, v54
    v_add_f32 v53, v53, v55
    v_cvt_pk_bf16_f32 v52, v52, v53
    ds_write_b32 v6, v52 offset:2048
    s_waitcnt lgkmcnt(0)
    s_barrier
    ds_read_b64_tr_b16 v[44:45], v7 offset:0
    ds_read_b64_tr_b16 v[46:47], v7 offset:128
    ds_read_b64_tr_b16 v[48:49], v7 offset:1024
    ds_read_b64_tr_b16 v[50:51], v7 offset:1152
    ds_read_b64_tr_b16 v[52:53], v7 offset:2048
    ds_read_b64_tr_b16 v[54:55], v7 offset:2176
    s_barrier
    ds_read_b64_tr_b16 v[56:57], v7 offset:3072
    ds_read_b64_tr_b16 v[58:59], v7 offset:3200
    s_waitcnt lgkmcnt(6)
    v_smfmac_f32_16x16x64_bf16 v[112:115], v[44:47], v[76:83], v5
    s_waitcnt lgkmcnt(4)
    v_smfmac_f32_16x16x64_bf16 v[112:115], v[48:51], v[84:91], v5
    s_waitcnt lgkmcnt(2)
    v_smfmac_f32_16x16x64_bf16 v[112:115], v[52:55], v[92:99], v5
    s_waitcnt lgkmcnt(0)
    v_smfmac_f32_16x16x64_bf16 v[112:115], v[56:59], v[100:107], v5
    s_nop 7
    v_pk_add_f32 v[112:113], v[112:113], v[114:115]
    v_pk_mul_f32 v[112:113], v[112:113], s[78:79]
    v_cvt_pk_f16_f32 v112, v112, v113
    s_nop 1
    v_mov_b32_dpp v113, v112 quad_perm:[1,0,3,2] row_mask:0xf bank_mask:0xf
    v_perm_b32 v112, v113, v112, v14
    v_pk_min_u16 v112, v112, s77
    buffer_store_dword v112, v9, s[44:47], s66 offen sc1
    s_barrier
    s_add_u32 s71, s71, 458752
    s_add_u32 s8, s64, s7
    s_and_b32 s8, s8, 3
    s_cmp_lg_u32 s8, 0
    s_cselect_b32 s101, -1, s64
    s_cbranch_scc1 ch2as_np
    s_lshl_b32 s8, s64, 13
    s_add_u32 s8, s8, 91754496
    buffer_store_dwordx4 v[32:35], v1, s[44:47], s8 offen offset:0 sc1
    buffer_store_dwordx4 v[36:39], v1, s[44:47], s8 offen offset:1024 sc1
ch2as_np:
    v_mov_b32 v44, 0
    v_mov_b32 v45, 0
    v_mov_b32 v46, 0
    v_mov_b32 v47, 0
    v_mov_b32 v48, 0
    v_mov_b32 v49, 0
    v_mov_b32 v50, 0
    v_mov_b32 v51, 0
    v_mov_b32 v52, 0
    v_mov_b32 v53, 0
    v_mov_b32 v54, 0
    v_mov_b32 v55, 0
    v_mov_b32 v112, 0
    v_mov_b32 v113, 0
    v_mov_b32 v114, 0
    v_mov_b32 v115, 0
    s_add_u32 s64, s64, 1
    s_cmp_lt_u32 s64, 63
    s_cbranch_scc1 ch2as_loop
    s_waitcnt vmcnt(0)
    s_barrier
    s_endpgm
ch2as_mp1:
    buffer_load_dwordx4 v[36:39], v1, s[44:47], s65 offen offset:1024 sc1
    s_add_u32 s83, s83, 1
    s_cmp_ge_u32 s83, 2000000
    s_cbranch_scc1 chain_abort
    s_waitcnt vmcnt(1)
    v_max3_u32 v2, v36, v37, v38
    v_max_u32 v2, v2, v39
    v_cmp_eq_u32 vcc, -1, v2
    s_cbranch_vccnz ch2as_mp1
    s_branch ch2as_mok
ch2as_m0bad:
    s_cbranch_vccnz ch2as_mp
ch2as_mp0:
    buffer_load_dwordx4 v[32:35], v1, s[44:47], s65 offen offset:0 sc1
    s_add_u32 s83, s83, 1
    s_cmp_ge_u32 s83, 2000000
    s_cbranch_scc1 chain_abort
    s_waitcnt vmcnt(1)
    v_max3_u32 v2, v32, v33, v34
    v_max_u32 v2, v2, v35
    v_cmp_eq_u32 vcc, -1, v2
    s_cbranch_vccnz ch2as_mp0
    s_branch ch2as_mok
ch3bs:
    v_mov_b32 v44, 0
    v_mov_b32 v60, 0
    v_mov_b32 v45, 0
    v_mov_b32 v61, 0
    v_mov_b32 v46, 0
    v_mov_b32 v62, 0
    v_mov_b32 v47, 0
    v_mov_b32 v63, 0
    v_mov_b32 v48, 0
    v_mov_b32 v64, 0
    v_mov_b32 v49, 0
    v_mov_b32 v65, 0
    v_mov_b32 v50, 0
    v_mov_b32 v66, 0
    v_mov_b32 v51, 0
    v_mov_b32 v67, 0
    v_mov_b32 v52, 0
    v_mov_b32 v68, 0
    v_mov_b32 v53, 0
    v_mov_b32 v69, 0
    v_mov_b32 v54, 0
    v_mov_b32 v70, 0
    v_mov_b32 v55, 0
    v_mov_b32 v71, 0
    v_mov_b32 v56, 0
    v_mov_b32 v72, 0
    v_mov_b32 v57, 0
    v_mov_b32 v73, 0
    v_mov_b32 v58, 0
    v_mov_b32 v74, 0
    v_mov_b32 v59, 0
    v_mov_b32 v75, 0
    v_mov_b32 v112, 0
    v_mov_b32 v113, 0
    v_mov_b32 v114, 0
    v_mov_b32 v115, 0
    s_branch ch3bs_loop
.p2align 6
ch3bs_loop:
    s_and_b32 s8, s64, 3
    s_lshl_b32 s65, s8, 13
    s_add_u32 s65, s65, 94902272
    buffer_load_dwordx4 v[40:43], v1, s[44:47], s65 offen offset:0 sc1
    s_mov_b32 s83, 0
    s_and_b32 s8, s64, 3
    s_mul_i32 s9, s8, 20736
    s_add_u32 s67, s9, 94944256
    s_add_u32 s66, s9, s12
    s_xor_b32 s8, s8, 2
    s_mul_i32 s9, s8, 20736
    s_add_u32 s70, s9, s13
    s_add_u32 s24, s71, 0
    s_add_u32 s71, s71, 458752
    v_mov_b32 v60, 0
    v_mov_b32 v61, 0
    v_mov_b32 v62, 0
    v_mov_b32 v63, 0
    v_mov_b32 v64, 0
    v_mov_b32 v65, 0
    v_mov_b32 v66, 0
    v_mov_b32 v67, 0
    v_mov_b32 v68, 0
    v_mov_b32 v69, 0
    v_mov_b32 v70, 0
    v_mov_b32 v71, 0
    v_mov_b32 v72, 0
    v_mov_b32 v73, 0
    v_mov_b32 v74, 0
    v_mov_b32 v75, 0
ch3bs_mp:
    buffer_load_dwordx4 v[40:43], v1, s[44:47], s65 offen offset:0 sc1
    s_add_u32 s83, s83, 1
    s_cmp_ge_u32 s83, 2000000
    s_cbranch_scc1 chain_abort
    s_waitcnt vmcnt(1)
    v_max3_u32 v2, v40, v41, v42
    v_max_u32 v2, v2, v43
    v_cmp_eq_u32 vcc, -1, v2
    s_cbranch_vccnz ch3bs_mp
    ds_write_b128 v1, v[40:43] offset:6144
    v_smfmac_f32_16x16x64_bf16 v[44:47], v[40:43], a[48:55], v5
    v_smfmac_f32_16x16x64_bf16 v[48:51], v[40:43], a[104:111], v5
    s_waitcnt lgkmcnt(0)
    s_barrier
    s_mov_b32 m0, 28672
    ds_read_b128 v[16:19], v1 offset:0
    ds_read_b128 v[20:23], v1 offset:1024
    ds_read_b128 v[24:27], v1 offset:2048
    ds_read_b128 v[28:31], v1 offset:3072
    ds_read_b128 v[32:35], v1 offset:4096
    ds_read_b128 v[36:39], v1 offset:5120
    v_smfmac_f32_16x16x64_bf16 v[52:55], v[40:43], a[160:167], v5
    buffer_load_dwordx4 v1, s[44:47], s24 offen offset:2048 sc1 lds
    v_smfmac_f32_16x16x64_bf16 v[60:63], v[40:43], v[136:143], v5
    buffer_load_dwordx4 v1, s[44:47], s24 offen offset:3072 sc1 lds
    v_smfmac_f32_16x16x64_bf16 v[64:67], v[40:43], v[192:199], v5
    v_smfmac_f32_16x16x64_bf16 v[68:71], v[40:43], v[248:255], v5
    s_waitcnt lgkmcnt(5)
    v_smfmac_f32_16x16x64_bf16 v[44:47], v[16:19], a[0:7], v5
    s_waitcnt lgkmcnt(4)
    v_smfmac_f32_16x16x64_bf16 v[44:47], v[20:23], a[8:15], v5
    s_waitcnt lgkmcnt(3)
    v_smfmac_f32_16x16x64_bf16 v[44:47], v[24:27], a[16:23], v5
    ds_read_b128 v[76:79], v12 offset:0
    s_waitcnt lgkmcnt(3)
    v_smfmac_f32_16x16x64_bf16 v[44:47], v[28:31], a[24:31], v5
    ds_read_b128 v[80:83], v12 offset:1024
    s_waitcnt lgkmcnt(3)
    v_smfmac_f32_16x16x64_bf16 v[44:47], v[32:35], a[32:39], v5
    ds_read_b128 v[84:87], v12 offset:2048
    s_waitcnt lgkmcnt(3)
    v_smfmac_f32_16x16x64_bf16 v[44:47], v[36:39], a[40:47], v5
    ds_read_b128 v[88:91], v12 offset:3072
    v_smfmac_f32_16x16x64_bf16 v[48:51], v[16:19], a[56:63], v5
    ds_read_b128 v[92:95], v12 offset:4096
    v_smfmac_f32_16x16x64_bf16 v[48:51], v[20:23], a[64:71], v5
    ds_read_b128 v[96:99], v12 offset:5120
    v_smfmac_f32_16x16x64_bf16 v[48:51], v[24:27], a[72:79], v5
    ds_read_b128 v[100:103], v12 offset:6144
    v_smfmac_f32_16x16x64_bf16 v[48:51], v[28:31], a[80:87], v5
    v_add_f32 v44, v44, v46
    v_smfmac_f32_16x16x64_bf16 v[48:51], v[32:35], a[88:95], v5
    v_add_f32 v45, v45, v47
    v_smfmac_f32_16x16x64_bf16 v[48:51], v[36:39], a[96:103], v5
    v_cvt_pk_bf16_f32 v44, v44, v45
    v_smfmac_f32_16x16x64_bf16 v[52:55], v[16:19], a[112:119], v5
    ds_write_b32 v6, v44 offset:2304
    v_smfmac_f32_16x16x64_bf16 v[52:55], v[20:23], a[120:127], v5
    v_xor_b32 v12, 0x4000, v12
    v_smfmac_f32_16x16x64_bf16 v[52:55], v[24:27], a[128:135], v5
    v_smfmac_f32_16x16x64_bf16 v[52:55], v[28:31], a[136:143], v5
    s_nop 0
    v_add_f32 v48, v48, v50
    v_smfmac_f32_16x16x64_bf16 v[52:55], v[32:35], a[144:151], v5
    v_add_f32 v49, v49, v51
    v_smfmac_f32_16x16x64_bf16 v[52:55], v[36:39], a[152:159], v5
    v_cvt_pk_bf16_f32 v48, v48, v49
    ds_write_b32 v6, v48 offset:2560
    s_nop 5
    v_add_f32 v52, v52, v54
    v_add_f32 v53, v53, v55
    v_cvt_pk_bf16_f32 v52, v52, v53
    ds_write_b32 v6, v52 offset:2816
    v_smfmac_f32_16x16x64_bf16 v[60:63], v[16:19], a[224:231], v5
    v_smfmac_f32_16x16x64_bf16 v[60:63], v[20:23], a[232:239], v5
    v_smfmac_f32_16x16x64_bf16 v[60:63], v[24:27], a[240:247], v5
    v_smfmac_f32_16x16x64_bf16 v[60:63], v[28:31], a[248:255], v5
    v_smfmac_f32_16x16x64_bf16 v[60:63], v[32:35], v[120:127], v5
    s_waitcnt lgkmcnt(0)
    s_barrier
    ds_read_b64_tr_b16 v[44:45], v7 offset:0
    ds_read_b64_tr_b16 v[46:47], v7 offset:128
    ds_read_b64_tr_b16 v[48:49], v7 offset:1024
    ds_read_b64_tr_b16 v[50:51], v7 offset:1152
    ds_read_b64_tr_b16 v[52:53], v7 offset:2048
    ds_read_b64_tr_b16 v[54:55], v7 offset:2176
    v_smfmac_f32_16x16x64_bf16 v[60:63], v[36:39], v[128:135], v5
    s_barrier
    ds_read_b64_tr_b16 v[56:57], v7 offset:3072
    ds_read_b64_tr_b16 v[58:59], v7 offset:3200
    s_waitcnt lgkmcnt(6)
    v_smfmac_f32_16x16x64_bf16 v[112:115], v[44:47], v[76:83], v5
    s_waitcnt lgkmcnt(4)
    v_smfmac_f32_16x16x64_bf16 v[112:115], v[48:51], v[84:91], v5
    s_waitcnt lgkmcnt(2)
    v_smfmac_f32_16x16x64_bf16 v[112:115], v[52:55], v[92:99], v5
    s_waitcnt lgkmcnt(0)
    v_smfmac_f32_16x16x64_bf16 v[112:115], v[56:59], v[100:107], v5
    s_nop 7
    v_pk_add_f32 v[112:113], v[112:113], v[114:115]
    v_pk_mul_f32 v[112:113], v[112:113], s[78:79]
    v_cvt_pk_f16_f32 v112, v112, v113
    s_nop 1
    v_mov_b32_dpp v113, v112 quad_perm:[1,0,3,2] row_mask:0xf bank_mask:0xf
    v_perm_b32 v112, v113, v112, v14
    v_pk_min_u16 v112, v112, s77
    buffer_store_dword v112, v9, s[44:47], s66 offen sc1
    s_mov_b32 s83, 0
    s_mov_b32 s98, 0
    v_smfmac_f32_16x16x64_bf16 v[64:67], v[16:19], v[144:151], v5
    v_smfmac_f32_16x16x64_bf16 v[64:67], v[20:23], v[152:159], v5
    v_smfmac_f32_16x16x64_bf16 v[64:67], v[24:27], v[160:167], v5
    v_smfmac_f32_16x16x64_bf16 v[64:67], v[28:31], v[168:175], v5
    v_smfmac_f32_16x16x64_bf16 v[64:67], v[32:35], v[176:183], v5
    v_smfmac_f32_16x16x64_bf16 v[64:67], v[36:39], v[184:191], v5
    v_add_f32 v60, v60, v62
    v_smfmac_f32_16x16x64_bf16 v[68:71], v[16:19], v[200:207], v5
    v_add_f32 v61, v61, v63
    v_smfmac_f32_16x16x64_bf16 v[68:71], v[20:23], v[208:215], v5
    v_cvt_pk_bf16_f32 v104, v60, v61
    v_smfmac_f32_16x16x64_bf16 v[68:71], v[24:27], v[216:223], v5
    v_mov_b32 v60, 0
    v_smfmac_f32_16x16x64_bf16 v[68:71], v[28:31], v[224:231], v5
    v_mov_b32 v61, 0
    v_smfmac_f32_16x16x64_bf16 v[68:71], v[32:35], v[232:239], v5
    s_cmp_ge_u32 s100, 64
    s_cbranch_scc0 ch3bs_hl
ch3bs_hs:
    buffer_load_dwordx4 v[76:79], v1, s[44:47], s67 offen offset:0 sc1
    buffer_load_dwordx4 v[84:87], v1, s[44:47], s67 offen offset:2048 sc1
    v_smfmac_f32_16x16x64_bf16 v[68:71], v[36:39], v[240:247], v5
    v_mov_b32 v62, 0
    v_smfmac_f32_16x16x64_bf16 v[72:75], v[16:19], a[168:175], v5
    v_mov_b32 v63, 0
    v_smfmac_f32_16x16x64_bf16 v[72:75], v[20:23], a[176:183], v5
    buffer_load_dwordx4 v[80:83], v1, s[44:47], s67 offen offset:1024 sc1
    buffer_load_dwordx4 v[88:91], v1, s[44:47], s67 offen offset:3072 sc1
    v_smfmac_f32_16x16x64_bf16 v[72:75], v[24:27], a[184:191], v5
    v_add_f32 v64, v64, v66
    v_smfmac_f32_16x16x64_bf16 v[72:75], v[28:31], a[192:199], v5
    v_add_f32 v65, v65, v67
    v_smfmac_f32_16x16x64_bf16 v[72:75], v[32:35], a[200:207], v5
    buffer_load_dwordx4 v[92:95], v10, s[44:47], s67 offen offset:0 sc1
    v_smfmac_f32_16x16x64_bf16 v[72:75], v[36:39], a[208:215], v5
    v_cvt_pk_bf16_f32 v105, v64, v65
    v_smfmac_f32_16x16x64_bf16 v[72:75], v[40:43], a[216:223], v5
    v_add_f32 v68, v68, v70
    v_add_f32 v69, v69, v71
    v_cvt_pk_bf16_f32 v108, v68, v69
    s_nop 4
    v_add_f32 v72, v72, v74
    v_add_f32 v73, v73, v75
    v_cvt_pk_bf16_f32 v109, v72, v73
    s_waitcnt vmcnt(3)
    ds_read_b128 v[44:47], v1 offset:28672
    ds_read_b128 v[48:51], v1 offset:29696
    ds_read_b128 v[52:55], v1 offset:30720
    ds_read_b128 v[56:59], v1 offset:31744
    s_cbranch_scc0 ch3bs_hu
ch3bs_hv:
    s_cmp_ge_u32 s64, s100
    v_fma_mix_f32 v102, v76, 1.0, v84 op_sel:[0,0,0] op_sel_hi:[1,0,1]
    v_fma_mix_f32 v84, v76, 1.0, v84 op_sel:[1,0,1] op_sel_hi:[1,0,1]
    v_fma_mix_f32 v76, v77, 1.0, v85 op_sel:[0,0,0] op_sel_hi:[1,0,1]
    v_fma_mix_f32 v85, v77, 1.0, v85 op_sel:[1,0,1] op_sel_hi:[1,0,1]
    v_fma_mix_f32 v77, v78, 1.0, v86 op_sel:[0,0,0] op_sel_hi:[1,0,1]
    v_fma_mix_f32 v86, v78, 1.0, v86 op_sel:[1,0,1] op_sel_hi:[1,0,1]
    v_fma_mix_f32 v78, v79, 1.0, v87 op_sel:[0,0,0] op_sel_hi:[1,0,1]
    v_fma_mix_f32 v87, v79, 1.0, v87 op_sel:[1,0,1] op_sel_hi:[1,0,1]
    v_maximum3_f32 v112, v84, v85, v86
    v_cmp_u_f32 vcc, v112, v87
    v_exp_f32 v76, v76
    v_exp_f32 v77, v77
    v_exp_f32 v78, v78
    s_cbranch_vccnz ch3bs_i0
    v_exp_f32 v79, v102
    v_exp_f32 v84, v84
    v_exp_f32 v85, v85
    v_pk_add_f32 v[96:97], v[76:77], v[78:79]
    v_exp_f32 v86, v86
    v_exp_f32 v87, v87
    v_pk_add_f32 v[96:97], v[96:97], v[84:85]
    v_pk_add_f32 v[96:97], v[96:97], v[86:87]
    s_waitcnt vmcnt(1)
    v_fma_mix_f32 v103, v80, 1.0, v88 op_sel:[0,0,0] op_sel_hi:[1,0,1]
    v_fma_mix_f32 v88, v80, 1.0, v88 op_sel:[1,0,1] op_sel_hi:[1,0,1]
    v_fma_mix_f32 v80, v81, 1.0, v89 op_sel:[0,0,0] op_sel_hi:[1,0,1]
    v_fma_mix_f32 v89, v81, 1.0, v89 op_sel:[1,0,1] op_sel_hi:[1,0,1]
    v_fma_mix_f32 v81, v82, 1.0, v90 op_sel:[0,0,0] op_sel_hi:[1,0,1]
    v_fma_mix_f32 v90, v82, 1.0, v90 op_sel:[1,0,1] op_sel_hi:[1,0,1]
    v_fma_mix_f32 v82, v83, 1.0, v91 op_sel:[0,0,0] op_sel_hi:[1,0,1]
    v_fma_mix_f32 v91, v83, 1.0, v91 op_sel:[1,0,1] op_sel_hi:[1,0,1]
    v_maximum3_f32 v114, v88, v89, v90
    v_cmp_u_f32 vcc, v114, v91
    v_exp_f32 v80, v80
    v_exp_f32 v81, v81
    v_exp_f32 v82, v82
    s_cbranch_vccnz ch3bs_i1
    v_exp_f32 v83, v103
    v_exp_f32 v88, v88
    v_exp_f32 v89, v89
    v_pk_add_f32 v[98:99], v[80:81], v[82:83]
    v_exp_f32 v90, v90
    v_exp_f32 v91, v91
    v_pk_add_f32 v[98:99], v[98:99], v[88:89]
    v_pk_add_f32 v[98:99], v[98:99], v[90:91]
    s_cbranch_scc1 ch3bs_nw
ch3bs_nw2:
    s_mov_b32 m0, 28672
    s_mov_b32 s98, 1
    s_waitcnt vmcnt(0) lgkmcnt(0)
    buffer_load_dwordx4 v1, s[44:47], s71 offen offset:0 sc1 lds
    buffer_load_dwordx4 v1, s[44:47], s71 offen offset:1024 sc1 lds
    v_fma_mix_f32 v113, v92, 1.0, v94 op_sel:[0,0,0] op_sel_hi:[1,0,1]
    v_fma_mix_f32 v94, v92, 1.0, v94 op_sel:[1,0,1] op_sel_hi:[1,0,1]
    v_fma_mix_f32 v92, v93, 1.0, v95 op_sel:[0,0,0] op_sel_hi:[1,0,1]
    v_fma_mix_f32 v95, v93, 1.0, v95 op_sel:[1,0,1] op_sel_hi:[1,0,1]
    v_cmp_u_f32 vcc, v94, v95
    v_exp_f32 v92, v92
    v_exp_f32 v93, v113
    v_exp_f32 v94, v94
    s_cbranch_vccnz ch3bs_i2
    v_exp_f32 v95, v95
    s_nop 0
    v_pk_add_f32 v[100:101], v[92:93], v[94:95]
ch3bs_w2d:
    v_pk_add_f32 v[96:97], v[96:97], v[98:99]
    v_pk_add_f32 v[96:97], v[96:97], v[100:101]
    v_add_f32 v2, v96, v97
    v_add_f32 v15, v96, v97
    s_nop 1
    v_permlane16_swap_b32 v2, v15
    v_add_f32 v2, v2, v15
    v_subrev_u32 v15, 0x17800000, v2
    v_rcp_f32 v2, v2
    v_cmp_le_u32 vcc, 0x5a000000, v15
    s_waitcnt lgkmcnt(0)
    v_pk_mul_f32 v[92:93], v[92:93], v[2:3] op_sel_hi:[1,0]
    v_pk_mul_f32 v[94:95], v[94:95], v[2:3] op_sel_hi:[1,0]
    v_cvt_pk_bf16_f32 v116, v93, v94
    v_cvt_pk_bf16_f32 v118, v92, v95
    s_cbranch_vccnz ch3bs_fb
    v_pk_mul_f32 v[76:77], v[76:77], v[2:3] op_sel_hi:[1,0]
    v_pk_mul_f32 v[78:79], v[78:79], v[2:3] op_sel_hi:[1,0]
    v_pk_mul_f32 v[84:85], v[84:85], v[2:3] op_sel_hi:[1,0]
    v_pk_mul_f32 v[86:87], v[86:87], v[2:3] op_sel_hi:[1,0]
    v_cvt_pk_bf16_f32 v96, v79, v84
    v_cvt_pk_bf16_f32 v97, v76, v85
    v_cvt_pk_bf16_f32 v98, v77, v86
    v_cvt_pk_bf16_f32 v99, v78, v87
    v_pk_mul_f32 v[80:81], v[80:81], v[2:3] op_sel_hi:[1,0]
    v_pk_mul_f32 v[82:83], v[82:83], v[2:3] op_sel_hi:[1,0]
    v_pk_mul_f32 v[88:89], v[88:89], v[2:3] op_sel_hi:[1,0]
    v_pk_mul_f32 v[90:91], v[90:91], v[2:3] op_sel_hi:[1,0]
    v_smfmac_f32_16x16x64_bf16 v[60:63], v[116:119], v[104:111], v5
    v_cvt_pk_bf16_f32 v100, v83, v88
    v_cvt_pk_bf16_f32 v101, v80, v89
    v_smfmac_f32_16x16x64_bf16 v[60:63], v[96:99], v[44:51], v5
    v_cvt_pk_bf16_f32 v102, v81, v90
    v_cvt_pk_bf16_f32 v103, v82, v91
    s_nop 1
    v_smfmac_f32_16x16x64_bf16 v[60:63], v[100:103], v[52:59], v5
ch3bs_kj:
    v_mov_b32 v44, 0
    v_mov_b32 v45, 0
    v_mov_b32 v46, 0
    v_mov_b32 v47, 0
    s_nop 3
    v_add_f32 v60, v60, v62
    v_add_f32 v61, v61, v63
    ds_write2_b32 v11, v60, v61 offset0:0 offset1:16
    v_mov_b32 v48, 0
    v_mov_b32 v49, 0
    v_mov_b32 v50, 0
    v_mov_b32 v51, 0
    v_mov_b32 v52, 0
    v_mov_b32 v53, 0
    v_mov_b32 v54, 0
    v_mov_b32 v55, 0
    v_mov_b32 v112, 0
    v_mov_b32 v113, 0
    v_mov_b32 v114, 0
    v_mov_b32 v115, 0
    s_waitcnt lgkmcnt(0)
    s_barrier
    s_barrier
    s_add_u32 s64, s64, 1
    s_cmp_lt_u32 s64, 63
    s_cbranch_scc1 ch3bs_loop
    s_and_b32 s8, s64, 3
    s_lshl_b32 s65, s8, 13
    s_add_u32 s65, s65, 94902272
    v_mov_b32 v60, 0
    v_mov_b32 v61, 0
    v_mov_b32 v62, 0
    v_mov_b32 v63, 0
    v_mov_b32 v64, 0
    v_mov_b32 v65, 0
    v_mov_b32 v66, 0
    v_mov_b32 v67, 0
    v_mov_b32 v68, 0
    v_mov_b32 v69, 0
    v_mov_b32 v70, 0
    v_mov_b32 v71, 0
    v_mov_b32 v72, 0
    v_mov_b32 v73, 0
    v_mov_b32 v74, 0
    v_mov_b32 v75, 0
    buffer_load_dwordx4 v[76:79], v1, s[44:47], s65 offen offset:0 sc1
    s_mov_b32 s83, 0
ch3bst_mp:
    buffer_load_dwordx4 v[40:43], v1, s[44:47], s65 offen offset:0 sc1
    s_waitcnt vmcnt(1)
    v_max3_u32 v2, v76, v77, v78
    v_max_u32 v2, v2, v79
    v_cmp_eq_u32 vcc, -1, v2
    s_cbranch_vccz ch3bst_g1
    buffer_load_dwordx4 v[76:79], v1, s[44:47], s65 offen offset:0 sc1
    s_add_u32 s83, s83, 1
    s_cmp_ge_u32 s83, 2000000
    s_cbranch_scc1 chain_abort
    s_waitcnt vmcnt(1)
    v_max3_u32 v2, v40, v41, v42
    v_max_u32 v2, v2, v43
    v_cmp_eq_u32 vcc, -1, v2
    s_cbranch_vccnz ch3bst_mp
ch3bst_g1:
    s_waitcnt vmcnt(0)
    ds_write_b128 v1, v[40:43] offset:6144
    s_waitcnt lgkmcnt(0)
    s_barrier
    ds_read_b128 v[16:19], v1 offset:0
    ds_read_b128 v[20:23], v1 offset:1024
    ds_read_b128 v[24:27], v1 offset:2048
    ds_read_b128 v[28:31], v1 offset:3072
    ds_read_b128 v[32:35], v1 offset:4096
    ds_read_b128 v[36:39], v1 offset:5120
    s_waitcnt lgkmcnt(0)
    v_smfmac_f32_16x16x64_bf16 v[60:63], v[16:19], a[224:231], v5
    v_smfmac_f32_16x16x64_bf16 v[60:63], v[20:23], a[232:239], v5
    v_smfmac_f32_16x16x64_bf16 v[60:63], v[24:27], a[240:247], v5
    v_smfmac_f32_16x16x64_bf16 v[60:63], v[28:31], a[248:255], v5
    v_smfmac_f32_16x16x64_bf16 v[60:63], v[32:35], v[120:127], v5
    v_smfmac_f32_16x16x64_bf16 v[60:63], v[36:39], v[128:135], v5
    v_smfmac_f32_16x16x64_bf16 v[60:63], v[40:43], v[136:143], v5
    v_smfmac_f32_16x16x64_bf16 v[64:67], v[16:19], v[144:151], v5
    v_smfmac_f32_16x16x64_bf16 v[64:67], v[20:23], v[152:159], v5
    v_smfmac_f32_16x16x64_bf16 v[64:67], v[24:27], v[160:167], v5
    v_smfmac_f32_16x16x64_bf16 v[64:67], v[28:31], v[168:175], v5
    v_smfmac_f32_16x16x64_bf16 v[64:67], v[32:35], v[176:183], v5
    s_nop 2
    v_add_f32 v60, v60, v62
    v_smfmac_f32_16x16x64_bf16 v[64:67], v[36:39], v[184:191], v5
    v_add_f32 v61, v61, v63
    v_smfmac_f32_16x16x64_bf16 v[64:67], v[40:43], v[192:199], v5
    v_cvt_pk_bf16_f32 v104, v60, v61
    v_smfmac_f32_16x16x64_bf16 v[68:71], v[16:19], v[200:207], v5
    v_mov_b32 v60, 0
    v_smfmac_f32_16x16x64_bf16 v[68:71], v[20:23], v[208:215], v5
    v_mov_b32 v61, 0
    v_smfmac_f32_16x16x64_bf16 v[68:71], v[24:27], v[216:223], v5
    v_mov_b32 v62, 0
    v_smfmac_f32_16x16x64_bf16 v[68:71], v[28:31], v[224:231], v5
    v_mov_b32 v63, 0
    v_smfmac_f32_16x16x64_bf16 v[68:71], v[32:35], v[232:239], v5
    v_add_f32 v64, v64, v66
    v_smfmac_f32_16x16x64_bf16 v[68:71], v[36:39], v[240:247], v5
    v_add_f32 v65, v65, v67
    v_smfmac_f32_16x16x64_bf16 v[68:71], v[40:43], v[248:255], v5
    v_cvt_pk_bf16_f32 v105, v64, v65
    v_smfmac_f32_16x16x64_bf16 v[72:75], v[16:19], a[168:175], v5
    v_smfmac_f32_16x16x64_bf16 v[72:75], v[20:23], a[176:183], v5
    v_smfmac_f32_16x16x64_bf16 v[72:75], v[24:27], a[184:191], v5
    v_smfmac_f32_16x16x64_bf16 v[72:75], v[28:31], a[192:199], v5
    v_smfmac_f32_16x16x64_bf16 v[72:75], v[32:35], a[200:207], v5
    s_nop 1
    v_add_f32 v68, v68, v70
    v_smfmac_f32_16x16x64_bf16 v[72:75], v[36:39], a[208:215], v5
    v_add_f32 v69, v69, v71
    v_smfmac_f32_16x16x64_bf16 v[72:75], v[40:43], a[216:223], v5
    v_cvt_pk_bf16_f32 v108, v68, v69
    s_nop 6
    v_add_f32 v72, v72, v74
    v_add_f32 v73, v73, v75
    v_cvt_pk_bf16_f32 v109, v72, v73
    v_mov_b32 v106, v108
    v_mov_b32 v107, v109
    s_lshl_b32 s8, s82, 12
    s_add_u32 s8, s8, 91638784
    buffer_store_dwordx4 v[104:107], v1, s[44:47], s8 offen sc1
    s_waitcnt vmcnt(0)
    s_barrier
    s_endpgm
ch3bs_hl:
    buffer_load_dword v15, off, s[44:47], s73 sc1
    s_branch ch3bs_hs
ch3bs_hu:
    v_readfirstlane_b32 s9, v15
    s_max_u32 s100, s100, s9
    s_branch ch3bs_hv
ch3bs_nw:
    v_lshlrev_b32 v100, 7, v0
    s_mov_b32 s99, 0
hz_194:
    buffer_load_dword v101, v100, s[44:47], s75 offen sc1
    s_waitcnt vmcnt(0)
    v_cmp_gt_u32 vcc, 28, v101
    s_ff1_i32_b64 s100, vcc
    s_cmp_eq_u32 s100, -1
    s_cselect_b32 s100, 65, s100
    s_sub_u32 s100, s100, 1
    s_cmp_gt_i32 s100, s64
    s_cbranch_scc1 hd_195
    s_sleep 1
    s_add_u32 s99, s99, 1
    s_cmp_lt_u32 s99, 400000
    s_cbranch_scc1 hz_194
    s_branch chain_abort
hd_195:
    s_branch ch3bs_nw2
ch3bs_k0:
    s_cmp_eq_u32 s98, 1
    s_cbranch_scc1 ch3bs_w2d
    s_cmp_ge_u32 s64, s100
    s_cbranch_scc1 ch3bs_vw
ch3bs_vok:
    s_mov_b32 m0, 28672
    s_waitcnt lgkmcnt(0)
    buffer_load_dwordx4 v1, s[44:47], s71 offen offset:0 sc1 lds
    buffer_load_dwordx4 v1, s[44:47], s71 offen offset:1024 sc1 lds
    s_branch ch3bs_w2d
ch3bs_i0:
    buffer_load_dwordx4 v[76:79], v1, s[44:47], s67 offen offset:0 sc1
    buffer_load_dwordx4 v[84:87], v1, s[44:47], s67 offen offset:2048 sc1
    s_add_u32 s83, s83, 1
    s_branch ch3bs_q120
ch3bs_i1:
    buffer_load_dwordx4 v[80:83], v1, s[44:47], s67 offen offset:1024 sc1
    buffer_load_dwordx4 v[88:91], v1, s[44:47], s67 offen offset:3072 sc1
    s_add_u32 s83, s83, 1
    s_branch ch3bs_q21
ch3bs_i2:
    buffer_load_dwordx4 v[92:95], v10, s[44:47], s67 offen offset:0 sc1
    s_add_u32 s83, s83, 1
    s_branch ch3bs_q2
ch3bs_q0:
    s_waitcnt vmcnt(0)
    v_fma_mix_f32 v102, v76, 1.0, v84 op_sel:[0,0,0] op_sel_hi:[1,0,1]
    v_fma_mix_f32 v84, v76, 1.0, v84 op_sel:[1,0,1] op_sel_hi:[1,0,1]
    v_fma_mix_f32 v76, v77, 1.0, v85 op_sel:[0,0,0] op_sel_hi:[1,0,1]
    v_fma_mix_f32 v85, v77, 1.0, v85 op_sel:[1,0,1] op_sel_hi:[1,0,1]
    v_fma_mix_f32 v77, v78, 1.0, v86 op_sel:[0,0,0] op_sel_hi:[1,0,1]
    v_fma_mix_f32 v86, v78, 1.0, v86 op_sel:[1,0,1] op_sel_hi:[1,0,1]
    v_fma_mix_f32 v78, v79, 1.0, v87 op_sel:[0,0,0] op_sel_hi:[1,0,1]
    v_fma_mix_f32 v87, v79, 1.0, v87 op_sel:[1,0,1] op_sel_hi:[1,0,1]
    v_maximum3_f32 v112, v84, v85, v86
    v_cmp_u_f32 vcc, v112, v87
    v_exp_f32 v76, v76
    v_exp_f32 v77, v77
    v_exp_f32 v78, v78
    s_cbranch_vccnz ch3bs_q0_e
    v_exp_f32 v79, v102
    v_exp_f32 v84, v84
    v_exp_f32 v85, v85
    v_pk_add_f32 v[96:97], v[76:77], v[78:79]
    v_exp_f32 v86, v86
    v_exp_f32 v87, v87
    v_pk_add_f32 v[96:97], v[96:97], v[84:85]
    v_pk_add_f32 v[96:97], v[96:97], v[86:87]
    s_branch ch3bs_k0
ch3bs_q0_e:
    buffer_load_dwordx4 v[76:79], v1, s[44:47], s67 offen offset:0 sc1
    buffer_load_dwordx4 v[84:87], v1, s[44:47], s67 offen offset:2048 sc1
    s_add_u32 s83, s83, 1
    s_and_b32 s8, s83, 63
    s_cmp_eq_u32 s8, 0
    s_cbranch_scc1 ch3bs_x
    s_branch ch3bs_q0
ch3bs_q1:
    s_waitcnt vmcnt(0)
    v_fma_mix_f32 v103, v80, 1.0, v88 op_sel:[0,0,0] op_sel_hi:[1,0,1]
    v_fma_mix_f32 v88, v80, 1.0, v88 op_sel:[1,0,1] op_sel_hi:[1,0,1]
    v_fma_mix_f32 v80, v81, 1.0, v89 op_sel:[0,0,0] op_sel_hi:[1,0,1]
    v_fma_mix_f32 v89, v81, 1.0, v89 op_sel:[1,0,1] op_sel_hi:[1,0,1]
    v_fma_mix_f32 v81, v82, 1.0, v90 op_sel:[0,0,0] op_sel_hi:[1,0,1]
    v_fma_mix_f32 v90, v82, 1.0, v90 op_sel:[1,0,1] op_sel_hi:[1,0,1]
    v_fma_mix_f32 v82, v83, 1.0, v91 op_sel:[0,0,0] op_sel_hi:[1,0,1]
    v_fma_mix_f32 v91, v83, 1.0, v91 op_sel:[1,0,1] op_sel_hi:[1,0,1]
    v_maximum3_f32 v114, v88, v89, v90
    v_cmp_u_f32 vcc, v114, v91
    v_exp_f32 v80, v80
    v_exp_f32 v81, v81
    v_exp_f32 v82, v82
    s_cbranch_vccnz ch3bs_q1_e
    v_exp_f32 v83, v103
    v_exp_f32 v88, v88
    v_exp_f32 v89, v89
    v_pk_add_f32 v[98:99], v[80:81], v[82:83]
    v_exp_f32 v90, v90
    v_exp_f32 v91, v91
    v_pk_add_f32 v[98:99], v[98:99], v[88:89]
    v_pk_add_f32 v[98:99], v[98:99], v[90:91]
    s_branch ch3bs_k0
ch3bs_q1_e:
    buffer_load_dwordx4 v[80:83], v1, s[44:47], s67 offen offset:1024 sc1
    buffer_load_dwordx4 v[88:91], v1, s[44:47], s67 offen offset:3072 sc1
    s_add_u32 s83, s83, 1
    s_and_b32 s8, s83, 63
    s_cmp_eq_u32 s8, 0
    s_cbranch_scc1 ch3bs_x
    s_branch ch3bs_q1
ch3bs_q2:
    s_waitcnt vmcnt(0)
    v_fma_mix_f32 v113, v92, 1.0, v94 op_sel:[0,0,0] op_sel_hi:[1,0,1]
    v_fma_mix_f32 v94, v92, 1.0, v94 op_sel:[1,0,1] op_sel_hi:[1,0,1]
    v_fma_mix_f32 v92, v93, 1.0, v95 op_sel:[0,0,0] op_sel_hi:[1,0,1]
    v_fma_mix_f32 v95, v93, 1.0, v95 op_sel:[1,0,1] op_sel_hi:[1,0,1]
    v_cmp_u_f32 vcc, v94, v95
    v_exp_f32 v92, v92
    v_exp_f32 v93, v113
    v_exp_f32 v94, v94
    s_cbranch_vccnz ch3bs_q2_e
    v_exp_f32 v95, v95
    s_nop 0
    v_pk_add_f32 v[100:101], v[92:93], v[94:95]
    s_branch ch3bs_k0
ch3bs_q2_e:
    buffer_load_dwordx4 v[92:95], v10, s[44:47], s67 offen offset:0 sc1
    s_add_u32 s83, s83, 1
    s_and_b32 s8, s83, 63
    s_cmp_eq_u32 s8, 0
    s_cbranch_scc1 ch3bs_x
    s_branch ch3bs_q2
ch3bs_q01:
    s_waitcnt vmcnt(2)
    v_fma_mix_f32 v102, v76, 1.0, v84 op_sel:[0,0,0] op_sel_hi:[1,0,1]
    v_fma_mix_f32 v84, v76, 1.0, v84 op_sel:[1,0,1] op_sel_hi:[1,0,1]
    v_fma_mix_f32 v76, v77, 1.0, v85 op_sel:[0,0,0] op_sel_hi:[1,0,1]
    v_fma_mix_f32 v85, v77, 1.0, v85 op_sel:[1,0,1] op_sel_hi:[1,0,1]
    v_fma_mix_f32 v77, v78, 1.0, v86 op_sel:[0,0,0] op_sel_hi:[1,0,1]
    v_fma_mix_f32 v86, v78, 1.0, v86 op_sel:[1,0,1] op_sel_hi:[1,0,1]
    v_fma_mix_f32 v78, v79, 1.0, v87 op_sel:[0,0,0] op_sel_hi:[1,0,1]
    v_fma_mix_f32 v87, v79, 1.0, v87 op_sel:[1,0,1] op_sel_hi:[1,0,1]
    v_maximum3_f32 v112, v84, v85, v86
    v_cmp_u_f32 vcc, v112, v87
    v_exp_f32 v76, v76
    v_exp_f32 v77, v77
    v_exp_f32 v78, v78
    s_cbranch_vccnz ch3bs_q01_e
    v_exp_f32 v79, v102
    v_exp_f32 v84, v84
    v_exp_f32 v85, v85
    v_pk_add_f32 v[96:97], v[76:77], v[78:79]
    v_exp_f32 v86, v86
    v_exp_f32 v87, v87
    v_pk_add_f32 v[96:97], v[96:97], v[84:85]
    v_pk_add_f32 v[96:97], v[96:97], v[86:87]
    s_branch ch3bs_q1
ch3bs_q01_e:
    buffer_load_dwordx4 v[76:79], v1, s[44:47], s67 offen offset:0 sc1
    buffer_load_dwordx4 v[84:87], v1, s[44:47], s67 offen offset:2048 sc1
    s_add_u32 s83, s83, 1
    s_and_b32 s8, s83, 63
    s_cmp_eq_u32 s8, 0
    s_cbranch_scc1 ch3bs_x
    s_branch ch3bs_q10
ch3bs_q02:
    s_waitcnt vmcnt(1)
    v_fma_mix_f32 v102, v76, 1.0, v84 op_sel:[0,0,0] op_sel_hi:[1,0,1]
    v_fma_mix_f32 v84, v76, 1.0, v84 op_sel:[1,0,1] op_sel_hi:[1,0,1]
    v_fma_mix_f32 v76, v77, 1.0, v85 op_sel:[0,0,0] op_sel_hi:[1,0,1]
    v_fma_mix_f32 v85, v77, 1.0, v85 op_sel:[1,0,1] op_sel_hi:[1,0,1]
    v_fma_mix_f32 v77, v78, 1.0, v86 op_sel:[0,0,0] op_sel_hi:[1,0,1]
    v_fma_mix_f32 v86, v78, 1.0, v86 op_sel:[1,0,1] op_sel_hi:[1,0,1]
    v_fma_mix_f32 v78, v79, 1.0, v87 op_sel:[0,0,0] op_sel_hi:[1,0,1]
    v_fma_mix_f32 v87, v79, 1.0, v87 op_sel:[1,0,1] op_sel_hi:[1,0,1]
    v_maximum3_f32 v112, v84, v85, v86
    v_cmp_u_f32 vcc, v112, v87
    v_exp_f32 v76, v76
    v_exp_f32 v77, v77
    v_exp_f32 v78, v78
    s_cbranch_vccnz ch3bs_q02_e
    v_exp_f32 v79, v102
    v_exp_f32 v84, v84
    v_exp_f32 v85, v85
    v_pk_add_f32 v[96:97], v[76:77], v[78:79]
    v_exp_f32 v86, v86
    v_exp_f32 v87, v87
    v_pk_add_f32 v[96:97], v[96:97], v[84:85]
    v_pk_add_f32 v[96:97], v[96:97], v[86:87]
    s_branch ch3bs_q2
ch3bs_q02_e:
    buffer_load_dwordx4 v[76:79], v1, s[44:47], s67 offen offset:0 sc1
    buffer_load_dwordx4 v[84:87], v1, s[44:47], s67 offen offset:2048 sc1
    s_add_u32 s83, s83, 1
    s_and_b32 s8, s83, 63
    s_cmp_eq_u32 s8, 0
    s_cbranch_scc1 ch3bs_x
    s_branch ch3bs_q20
ch3bs_q10:
    s_waitcnt vmcnt(2)
    v_fma_mix_f32 v103, v80, 1.0, v88 op_sel:[0,0,0] op_sel_hi:[1,0,1]
    v_fma_mix_f32 v88, v80, 1.0, v88 op_sel:[1,0,1] op_sel_hi:[1,0,1]
    v_fma_mix_f32 v80, v81, 1.0, v89 op_sel:[0,0,0] op_sel_hi:[1,0,1]
    v_fma_mix_f32 v89, v81, 1.0, v89 op_sel:[1,0,1] op_sel_hi:[1,0,1]
    v_fma_mix_f32 v81, v82, 1.0, v90 op_sel:[0,0,0] op_sel_hi:[1,0,1]
    v_fma_mix_f32 v90, v82, 1.0, v90 op_sel:[1,0,1] op_sel_hi:[1,0,1]
    v_fma_mix_f32 v82, v83, 1.0, v91 op_sel:[0,0,0] op_sel_hi:[1,0,1]
    v_fma_mix_f32 v91, v83, 1.0, v91 op_sel:[1,0,1] op_sel_hi:[1,0,1]
    v_maximum3_f32 v114, v88, v89, v90
    v_cmp_u_f32 vcc, v114, v91
    v_exp_f32 v80, v80
    v_exp_f32 v81, v81
    v_exp_f32 v82, v82
    s_cbranch_vccnz ch3bs_q10_e
    v_exp_f32 v83, v103
    v_exp_f32 v88, v88
    v_exp_f32 v89, v89
    v_pk_add_f32 v[98:99], v[80:81], v[82:83]
    v_exp_f32 v90, v90
    v_exp_f32 v91, v91
    v_pk_add_f32 v[98:99], v[98:99], v[88:89]
    v_pk_add_f32 v[98:99], v[98:99], v[90:91]
    s_branch ch3bs_q0
ch3bs_q10_e:
    buffer_load_dwordx4 v[80:83], v1, s[44:47], s67 offen offset:1024 sc1
    buffer_load_dwordx4 v[88:91], v1, s[44:47], s67 offen offset:3072 sc1
    s_add_u32 s83, s83, 1
    s_and_b32 s8, s83, 63
    s_cmp_eq_u32 s8, 0
    s_cbranch_scc1 ch3bs_x
    s_branch ch3bs_q01
ch3bs_q12:
    s_waitcnt vmcnt(1)
    v_fma_mix_f32 v103, v80, 1.0, v88 op_sel:[0,0,0] op_sel_hi:[1,0,1]
    v_fma_mix_f32 v88, v80, 1.0, v88 op_sel:[1,0,1] op_sel_hi:[1,0,1]
    v_fma_mix_f32 v80, v81, 1.0, v89 op_sel:[0,0,0] op_sel_hi:[1,0,1]
    v_fma_mix_f32 v89, v81, 1.0, v89 op_sel:[1,0,1] op_sel_hi:[1,0,1]
    v_fma_mix_f32 v81, v82, 1.0, v90 op_sel:[0,0,0] op_sel_hi:[1,0,1]
    v_fma_mix_f32 v90, v82, 1.0, v90 op_sel:[1,0,1] op_sel_hi:[1,0,1]
    v_fma_mix_f32 v82, v83, 1.0, v91 op_sel:[0,0,0] op_sel_hi:[1,0,1]
    v_fma_mix_f32 v91, v83, 1.0, v91 op_sel:[1,0,1] op_sel_hi:[1,0,1]
    v_maximum3_f32 v114, v88, v89, v90
    v_cmp_u_f32 vcc, v114, v91
    v_exp_f32 v80, v80
    v_exp_f32 v81, v81
    v_exp_f32 v82, v82
    s_cbranch_vccnz ch3bs_q12_e
    v_exp_f32 v83, v103
    v_exp_f32 v88, v88
    v_exp_f32 v89, v89
    v_pk_add_f32 v[98:99], v[80:81], v[82:83]
    v_exp_f32 v90, v90
    v_exp_f32 v91, v91
    v_pk_add_f32 v[98:99], v[98:99], v[88:89]
    v_pk_add_f32 v[98:99], v[98:99], v[90:91]
    s_branch ch3bs_q2
ch3bs_q12_e:
    buffer_load_dwordx4 v[80:83], v1, s[44:47], s67 offen offset:1024 sc1
    buffer_load_dwordx4 v[88:91], v1, s[44:47], s67 offen offset:3072 sc1
    s_add_u32 s83, s83, 1
    s_and_b32 s8, s83, 63
    s_cmp_eq_u32 s8, 0
    s_cbranch_scc1 ch3bs_x
    s_branch ch3bs_q21
ch3bs_q20:
    s_waitcnt vmcnt(2)
    v_fma_mix_f32 v113, v92, 1.0, v94 op_sel:[0,0,0] op_sel_hi:[1,0,1]
    v_fma_mix_f32 v94, v92, 1.0, v94 op_sel:[1,0,1] op_sel_hi:[1,0,1]
    v_fma_mix_f32 v92, v93, 1.0, v95 op_sel:[0,0,0] op_sel_hi:[1,0,1]
    v_fma_mix_f32 v95, v93, 1.0, v95 op_sel:[1,0,1] op_sel_hi:[1,0,1]
    v_cmp_u_f32 vcc, v94, v95
    v_exp_f32 v92, v92
    v_exp_f32 v93, v113
    v_exp_f32 v94, v94
    s_cbranch_vccnz ch3bs_q20_e
    v_exp_f32 v95, v95
    s_nop 0
    v_pk_add_f32 v[100:101], v[92:93], v[94:95]
    s_branch ch3bs_q0
ch3bs_q20_e:
    buffer_load_dwordx4 v[92:95], v10, s[44:47], s67 offen offset:0 sc1
    s_add_u32 s83, s83, 1
    s_and_b32 s8, s83, 63
    s_cmp_eq_u32 s8, 0
    s_cbranch_scc1 ch3bs_x
    s_branch ch3bs_q02
ch3bs_q21:
    s_waitcnt vmcnt(2)
    v_fma_mix_f32 v113, v92, 1.0, v94 op_sel:[0,0,0] op_sel_hi:[1,0,1]
    v_fma_mix_f32 v94, v92, 1.0, v94 op_sel:[1,0,1] op_sel_hi:[1,0,1]
    v_fma_mix_f32 v92, v93, 1.0, v95 op_sel:[0,0,0] op_sel_hi:[1,0,1]
    v_fma_mix_f32 v95, v93, 1.0, v95 op_sel:[1,0,1] op_sel_hi:[1,0,1]
    v_cmp_u_f32 vcc, v94, v95
    v_exp_f32 v92, v92
    v_exp_f32 v93, v113
    v_exp_f32 v94, v94
    s_cbranch_vccnz ch3bs_q21_e
    v_exp_f32 v95, v95
    s_nop 0
    v_pk_add_f32 v[100:101], v[92:93], v[94:95]
    s_branch ch3bs_q1
ch3bs_q21_e:
    buffer_load_dwordx4 v[92:95], v10, s[44:47], s67 offen offset:0 sc1
    s_add_u32 s83, s83, 1
    s_and_b32 s8, s83, 63
    s_cmp_eq_u32 s8, 0
    s_cbranch_scc1 ch3bs_x
    s_branch ch3bs_q12
ch3bs_q012:
    s_waitcnt vmcnt(3)
    v_fma_mix_f32 v102, v76, 1.0, v84 op_sel:[0,0,0] op_sel_hi:[1,0,1]
    v_fma_mix_f32 v84, v76, 1.0, v84 op_sel:[1,0,1] op_sel_hi:[1,0,1]
    v_fma_mix_f32 v76, v77, 1.0, v85 op_sel:[0,0,0] op_sel_hi:[1,0,1]
    v_fma_mix_f32 v85, v77, 1.0, v85 op_sel:[1,0,1] op_sel_hi:[1,0,1]
    v_fma_mix_f32 v77, v78, 1.0, v86 op_sel:[0,0,0] op_sel_hi:[1,0,1]
    v_fma_mix_f32 v86, v78, 1.0, v86 op_sel:[1,0,1] op_sel_hi:[1,0,1]
    v_fma_mix_f32 v78, v79, 1.0, v87 op_sel:[0,0,0] op_sel_hi:[1,0,1]
    v_fma_mix_f32 v87, v79, 1.0, v87 op_sel:[1,0,1] op_sel_hi:[1,0,1]
    v_maximum3_f32 v112, v84, v85, v86
    v_cmp_u_f32 vcc, v112, v87
    v_exp_f32 v76, v76
    v_exp_f32 v77, v77
    v_exp_f32 v78, v78
    s_cbranch_vccnz ch3bs_q012_e
    v_exp_f32 v79, v102
    v_exp_f32 v84, v84
    v_exp_f32 v85, v85
    v_pk_add_f32 v[96:97], v[76:77], v[78:79]
    v_exp_f32 v86, v86
    v_exp_f32 v87, v87
    v_pk_add_f32 v[96:97], v[96:97], v[84:85]
    v_pk_add_f32 v[96:97], v[96:97], v[86:87]
    s_branch ch3bs_q12
ch3bs_q012_e:
    buffer_load_dwordx4 v[76:79], v1, s[44:47], s67 offen offset:0 sc1
    buffer_load_dwordx4 v[84:87], v1, s[44:47], s67 offen offset:2048 sc1
    s_add_u32 s83, s83, 1
    s_and_b32 s8, s83, 63
    s_cmp_eq_u32 s8, 0
    s_cbranch_scc1 ch3bs_x
    s_branch ch3bs_q120
ch3bs_q021:
    s_waitcnt vmcnt(3)
    v_fma_mix_f32 v102, v76, 1.0, v84 op_sel:[0,0,0] op_sel_hi:[1,0,1]
    v_fma_mix_f32 v84, v76, 1.0, v84 op_sel:[1,0,1] op_sel_hi:[1,0,1]
    v_fma_mix_f32 v76, v77, 1.0, v85 op_sel:[0,0,0] op_sel_hi:[1,0,1]
    v_fma_mix_f32 v85, v77, 1.0, v85 op_sel:[1,0,1] op_sel_hi:[1,0,1]
    v_fma_mix_f32 v77, v78, 1.0, v86 op_sel:[0,0,0] op_sel_hi:[1,0,1]
    v_fma_mix_f32 v86, v78, 1.0, v86 op_sel:[1,0,1] op_sel_hi:[1,0,1]
    v_fma_mix_f32 v78, v79, 1.0, v87 op_sel:[0,0,0] op_sel_hi:[1,0,1]
    v_fma_mix_f32 v87, v79, 1.0, v87 op_sel:[1,0,1] op_sel_hi:[1,0,1]
    v_maximum3_f32 v112, v84, v85, v86
    v_cmp_u_f32 vcc, v112, v87
    v_exp_f32 v76, v76
    v_exp_f32 v77, v77
    v_exp_f32 v78, v78
    s_cbranch_vccnz ch3bs_q021_e
    v_exp_f32 v79, v102
    v_exp_f32 v84, v84
    v_exp_f32 v85, v85
    v_pk_add_f32 v[96:97], v[76:77], v[78:79]
    v_exp_f32 v86, v86
    v_exp_f32 v87, v87
    v_pk_add_f32 v[96:97], v[96:97], v[84:85]
    v_pk_add_f32 v[96:97], v[96:97], v[86:87]
    s_branch ch3bs_q21
ch3bs_q021_e:
    buffer_load_dwordx4 v[76:79], v1, s[44:47], s67 offen offset:0 sc1
    buffer_load_dwordx4 v[84:87], v1, s[44:47], s67 offen offset:2048 sc1
    s_add_u32 s83, s83, 1
    s_and_b32 s8, s83, 63
    s_cmp_eq_u32 s8, 0
    s_cbranch_scc1 ch3bs_x
    s_branch ch3bs_q210
ch3bs_q102:
    s_waitcnt vmcnt(3)
    v_fma_mix_f32 v103, v80, 1.0, v88 op_sel:[0,0,0] op_sel_hi:[1,0,1]
    v_fma_mix_f32 v88, v80, 1.0, v88 op_sel:[1,0,1] op_sel_hi:[1,0,1]
    v_fma_mix_f32 v80, v81, 1.0, v89 op_sel:[0,0,0] op_sel_hi:[1,0,1]
    v_fma_mix_f32 v89, v81, 1.0, v89 op_sel:[1,0,1] op_sel_hi:[1,0,1]
    v_fma_mix_f32 v81, v82, 1.0, v90 op_sel:[0,0,0] op_sel_hi:[1,0,1]
    v_fma_mix_f32 v90, v82, 1.0, v90 op_sel:[1,0,1] op_sel_hi:[1,0,1]
    v_fma_mix_f32 v82, v83, 1.0, v91 op_sel:[0,0,0] op_sel_hi:[1,0,1]
    v_fma_mix_f32 v91, v83, 1.0, v91 op_sel:[1,0,1] op_sel_hi:[1,0,1]
    v_maximum3_f32 v114, v88, v89, v90
    v_cmp_u_f32 vcc, v114, v91
    v_exp_f32 v80, v80
    v_exp_f32 v81, v81
    v_exp_f32 v82, v82
    s_cbranch_vccnz ch3bs_q102_e
    v_exp_f32 v83, v103
    v_exp_f32 v88, v88
    v_exp_f32 v89, v89
    v_pk_add_f32 v[98:99], v[80:81], v[82:83]
    v_exp_f32 v90, v90
    v_exp_f32 v91, v91
    v_pk_add_f32 v[98:99], v[98:99], v[88:89]
    v_pk_add_f32 v[98:99], v[98:99], v[90:91]
    s_branch ch3bs_q02
ch3bs_q102_e:
    buffer_load_dwordx4 v[80:83], v1, s[44:47], s67 offen offset:1024 sc1
    buffer_load_dwordx4 v[88:91], v1, s[44:47], s67 offen offset:3072 sc1
    s_add_u32 s83, s83, 1
    s_and_b32 s8, s83, 63
    s_cmp_eq_u32 s8, 0
    s_cbranch_scc1 ch3bs_x
    s_branch ch3bs_q021
ch3bs_q120:
    s_waitcnt vmcnt(3)
    v_fma_mix_f32 v103, v80, 1.0, v88 op_sel:[0,0,0] op_sel_hi:[1,0,1]
    v_fma_mix_f32 v88, v80, 1.0, v88 op_sel:[1,0,1] op_sel_hi:[1,0,1]
    v_fma_mix_f32 v80, v81, 1.0, v89 op_sel:[0,0,0] op_sel_hi:[1,0,1]
    v_fma_mix_f32 v89, v81, 1.0, v89 op_sel:[1,0,1] op_sel_hi:[1,0,1]
    v_fma_mix_f32 v81, v82, 1.0, v90 op_sel:[0,0,0] op_sel_hi:[1,0,1]
    v_fma_mix_f32 v90, v82, 1.0, v90 op_sel:[1,0,1] op_sel_hi:[1,0,1]
    v_fma_mix_f32 v82, v83, 1.0, v91 op_sel:[0,0,0] op_sel_hi:[1,0,1]
    v_fma_mix_f32 v91, v83, 1.0, v91 op_sel:[1,0,1] op_sel_hi:[1,0,1]
    v_maximum3_f32 v114, v88, v89, v90
    v_cmp_u_f32 vcc, v114, v91
    v_exp_f32 v80, v80
    v_exp_f32 v81, v81
    v_exp_f32 v82, v82
    s_cbranch_vccnz ch3bs_q120_e
    v_exp_f32 v83, v103
    v_exp_f32 v88, v88
    v_exp_f32 v89, v89
    v_pk_add_f32 v[98:99], v[80:81], v[82:83]
    v_exp_f32 v90, v90
    v_exp_f32 v91, v91
    v_pk_add_f32 v[98:99], v[98:99], v[88:89]
    v_pk_add_f32 v[98:99], v[98:99], v[90:91]
    s_branch ch3bs_q20
ch3bs_q120_e:
    buffer_load_dwordx4 v[80:83], v1, s[44:47], s67 offen offset:1024 sc1
    buffer_load_dwordx4 v[88:91], v1, s[44:47], s67 offen offset:3072 sc1
    s_add_u32 s83, s83, 1
    s_and_b32 s8, s83, 63
    s_cmp_eq_u32 s8, 0
    s_cbranch_scc1 ch3bs_x
    s_branch ch3bs_q201
ch3bs_q201:
    s_waitcnt vmcnt(4)
    v_fma_mix_f32 v113, v92, 1.0, v94 op_sel:[0,0,0] op_sel_hi:[1,0,1]
    v_fma_mix_f32 v94, v92, 1.0, v94 op_sel:[1,0,1] op_sel_hi:[1,0,1]
    v_fma_mix_f32 v92, v93, 1.0, v95 op_sel:[0,0,0] op_sel_hi:[1,0,1]
    v_fma_mix_f32 v95, v93, 1.0, v95 op_sel:[1,0,1] op_sel_hi:[1,0,1]
    v_cmp_u_f32 vcc, v94, v95
    v_exp_f32 v92, v92
    v_exp_f32 v93, v113
    v_exp_f32 v94, v94
    s_cbranch_vccnz ch3bs_q201_e
    v_exp_f32 v95, v95
    s_nop 0
    v_pk_add_f32 v[100:101], v[92:93], v[94:95]
    s_branch ch3bs_q01
ch3bs_q201_e:
    buffer_load_dwordx4 v[92:95], v10, s[44:47], s67 offen offset:0 sc1
    s_add_u32 s83, s83, 1
    s_and_b32 s8, s83, 63
    s_cmp_eq_u32 s8, 0
    s_cbranch_scc1 ch3bs_x
    s_branch ch3bs_q012
ch3bs_q210:
    s_waitcnt vmcnt(4)
    v_fma_mix_f32 v113, v92, 1.0, v94 op_sel:[0,0,0] op_sel_hi:[1,0,1]
    v_fma_mix_f32 v94, v92, 1.0, v94 op_sel:[1,0,1] op_sel_hi:[1,0,1]
    v_fma_mix_f32 v92, v93, 1.0, v95 op_sel:[0,0,0] op_sel_hi:[1,0,1]
    v_fma_mix_f32 v95, v93, 1.0, v95 op_sel:[1,0,1] op_sel_hi:[1,0,1]
    v_cmp_u_f32 vcc, v94, v95
    v_exp_f32 v92, v92
    v_exp_f32 v93, v113
    v_exp_f32 v94, v94
    s_cbranch_vccnz ch3bs_q210_e
    v_exp_f32 v95, v95
    v_pk_add_f32 v[100:101], v[92:93], v[94:95]
    s_branch ch3bs_q10
ch3bs_q210_e:
    buffer_load_dwordx4 v[92:95], v10, s[44:47], s67 offen offset:0 sc1
    s_add_u32 s83, s83, 1
    s_and_b32 s8, s83, 63
    s_cmp_eq_u32 s8, 0
    s_cbranch_scc1 ch3bs_x
    s_branch ch3bs_q102
ch3bs_fb:
    buffer_load_dwordx4 v[76:79], v1, s[44:47], s67 offen offset:0 sc1
    buffer_load_dwordx4 v[84:87], v1, s[44:47], s67 offen offset:2048 sc1
    buffer_load_dwordx4 v[80:83], v1, s[44:47], s67 offen offset:1024 sc1
    buffer_load_dwordx4 v[88:91], v1, s[44:47], s67 offen offset:3072 sc1
    buffer_load_dwordx4 v[92:95], v10, s[44:47], s67 offen offset:0 sc1
    s_waitcnt vmcnt(0)
    v_fma_mix_f32 v102, v76, 1.0, v84 op_sel:[0,0,0] op_sel_hi:[1,0,1]
    v_fma_mix_f32 v84, v76, 1.0, v84 op_sel:[1,0,1] op_sel_hi:[1,0,1]
    v_fma_mix_f32 v76, v77, 1.0, v85 op_sel:[0,0,0] op_sel_hi:[1,0,1]
    v_fma_mix_f32 v85, v77, 1.0, v85 op_sel:[1,0,1] op_sel_hi:[1,0,1]
    v_fma_mix_f32 v77, v78, 1.0, v86 op_sel:[0,0,0] op_sel_hi:[1,0,1]
    v_fma_mix_f32 v86, v78, 1.0, v86 op_sel:[1,0,1] op_sel_hi:[1,0,1]
    v_fma_mix_f32 v78, v79, 1.0, v87 op_sel:[0,0,0] op_sel_hi:[1,0,1]
    v_fma_mix_f32 v87, v79, 1.0, v87 op_sel:[1,0,1] op_sel_hi:[1,0,1]
    v_maximum3_f32 v112, v102, v84, v76
    v_maximum3_f32 v112, v112, v85, v77
    v_maximum3_f32 v112, v112, v86, v78
    v_maximum3_f32 v112, v112, v87, v87
    v_cmp_u_f32 vcc, v112, v112
    v_mov_b32 v79, v102
    v_pk_add_f32 v[76:77], v[76:77], v[112:113] op_sel_hi:[1,0] neg_lo:[0,1] neg_hi:[0,1]
    v_pk_add_f32 v[78:79], v[78:79], v[112:113] op_sel_hi:[1,0] neg_lo:[0,1] neg_hi:[0,1]
    v_pk_add_f32 v[84:85], v[84:85], v[112:113] op_sel_hi:[1,0] neg_lo:[0,1] neg_hi:[0,1]
    v_pk_add_f32 v[86:87], v[86:87], v[112:113] op_sel_hi:[1,0] neg_lo:[0,1] neg_hi:[0,1]
    v_exp_f32 v76, v76
    v_exp_f32 v77, v77
    v_exp_f32 v78, v78
    v_exp_f32 v79, v79
    v_exp_f32 v84, v84
    v_exp_f32 v85, v85
    v_pk_add_f32 v[96:97], v[76:77], v[78:79]
    v_exp_f32 v86, v86
    v_exp_f32 v87, v87
    v_pk_add_f32 v[96:97], v[96:97], v[84:85]
    v_pk_add_f32 v[96:97], v[96:97], v[86:87]
    v_fma_mix_f32 v103, v80, 1.0, v88 op_sel:[0,0,0] op_sel_hi:[1,0,1]
    v_fma_mix_f32 v88, v80, 1.0, v88 op_sel:[1,0,1] op_sel_hi:[1,0,1]
    v_fma_mix_f32 v80, v81, 1.0, v89 op_sel:[0,0,0] op_sel_hi:[1,0,1]
    v_fma_mix_f32 v89, v81, 1.0, v89 op_sel:[1,0,1] op_sel_hi:[1,0,1]
    v_fma_mix_f32 v81, v82, 1.0, v90 op_sel:[0,0,0] op_sel_hi:[1,0,1]
    v_fma_mix_f32 v90, v82, 1.0, v90 op_sel:[1,0,1] op_sel_hi:[1,0,1]
    v_fma_mix_f32 v82, v83, 1.0, v91 op_sel:[0,0,0] op_sel_hi:[1,0,1]
    v_fma_mix_f32 v91, v83, 1.0, v91 op_sel:[1,0,1] op_sel_hi:[1,0,1]
    v_maximum3_f32 v114, v103, v88, v80
    v_maximum3_f32 v114, v114, v89, v81
    v_maximum3_f32 v114, v114, v90, v82
    v_maximum3_f32 v114, v114, v91, v91
    v_cmp_u_f32 vcc, v114, v114
    v_mov_b32 v83, v103
    v_pk_add_f32 v[80:81], v[80:81], v[114:115] op_sel_hi:[1,0] neg_lo:[0,1] neg_hi:[0,1]
    v_pk_add_f32 v[82:83], v[82:83], v[114:115] op_sel_hi:[1,0] neg_lo:[0,1] neg_hi:[0,1]
    v_pk_add_f32 v[88:89], v[88:89], v[114:115] op_sel_hi:[1,0] neg_lo:[0,1] neg_hi:[0,1]
    v_pk_add_f32 v[90:91], v[90:91], v[114:115] op_sel_hi:[1,0] neg_lo:[0,1] neg_hi:[0,1]
    v_exp_f32 v80, v80
    v_exp_f32 v81, v81
    v_exp_f32 v82, v82
    v_exp_f32 v83, v83
    v_exp_f32 v88, v88
    v_exp_f32 v89, v89
    v_pk_add_f32 v[98:99], v[80:81], v[82:83]
    v_exp_f32 v90, v90
    v_exp_f32 v91, v91
    v_pk_add_f32 v[98:99], v[98:99], v[88:89]
    v_pk_add_f32 v[98:99], v[98:99], v[90:91]
    v_fma_mix_f32 v113, v92, 1.0, v94 op_sel:[0,0,0] op_sel_hi:[1,0,1]
    v_fma_mix_f32 v94, v92, 1.0, v94 op_sel:[1,0,1] op_sel_hi:[1,0,1]
    v_fma_mix_f32 v92, v93, 1.0, v95 op_sel:[0,0,0] op_sel_hi:[1,0,1]
    v_fma_mix_f32 v95, v93, 1.0, v95 op_sel:[1,0,1] op_sel_hi:[1,0,1]
    v_maximum3_f32 v116, v113, v94, v92
    v_maximum3_f32 v116, v116, v95, v95
    v_cmp_u_f32 vcc, v116, v116
    v_mov_b32 v93, v113
    v_pk_add_f32 v[92:93], v[92:93], v[116:117] op_sel_hi:[1,0] neg_lo:[0,1] neg_hi:[0,1]
    v_pk_add_f32 v[94:95], v[94:95], v[116:117] op_sel_hi:[1,0] neg_lo:[0,1] neg_hi:[0,1]
    v_exp_f32 v92, v92
    v_exp_f32 v93, v93
    v_exp_f32 v94, v94
    v_exp_f32 v95, v95
    s_nop 0
    v_pk_add_f32 v[100:101], v[92:93], v[94:95]
    v_max3_f32 v2, v112, v114, v116
    v_max3_f32 v15, v112, v114, v116
    v_add_f32 v96, v96, v97
    v_add_f32 v98, v98, v99
    v_add_f32 v100, v100, v101
    v_permlane16_swap_b32 v2, v15
    v_max_f32 v2, v2, v15
    v_sub_f32 v112, v112, v2
    v_sub_f32 v114, v114, v2
    v_sub_f32 v116, v116, v2
    v_exp_f32 v112, v112
    v_exp_f32 v114, v114
    v_exp_f32 v116, v116
    v_mul_f32 v2, v112, v96
    v_fmac_f32 v2, v114, v98
    v_fmac_f32 v2, v116, v100
    v_mov_b32 v15, v2
    s_nop 1
    v_permlane16_swap_b32 v2, v15
    v_add_f32 v2, v2, v15
    v_rcp_f32 v2, v2
    s_nop 0
    v_mul_f32 v116, v116, v2
    v_mul_f32 v112, v112, v2
    v_mul_f32 v114, v114, v2
    s_waitcnt lgkmcnt(0)
    v_pk_mul_f32 v[92:93], v[92:93], v[116:117] op_sel_hi:[1,0]
    v_pk_mul_f32 v[94:95], v[94:95], v[116:117] op_sel_hi:[1,0]
    v_cvt_pk_bf16_f32 v116, v93, v94
    v_cvt_pk_bf16_f32 v118, v92, v95
    v_pk_mul_f32 v[76:77], v[76:77], v[112:113] op_sel_hi:[1,0]
    v_pk_mul_f32 v[78:79], v[78:79], v[112:113] op_sel_hi:[1,0]
    v_pk_mul_f32 v[84:85], v[84:85], v[112:113] op_sel_hi:[1,0]
    v_pk_mul_f32 v[86:87], v[86:87], v[112:113] op_sel_hi:[1,0]
    v_cvt_pk_bf16_f32 v96, v79, v84
    v_cvt_pk_bf16_f32 v97, v76, v85
    v_cvt_pk_bf16_f32 v98, v77, v86
    v_cvt_pk_bf16_f32 v99, v78, v87
    v_pk_mul_f32 v[80:81], v[80:81], v[114:115] op_sel_hi:[1,0]
    v_pk_mul_f32 v[82:83], v[82:83], v[114:115] op_sel_hi:[1,0]
    v_pk_mul_f32 v[88:89], v[88:89], v[114:115] op_sel_hi:[1,0]
    v_pk_mul_f32 v[90:91], v[90:91], v[114:115] op_sel_hi:[1,0]
    v_smfmac_f32_16x16x64_bf16 v[60:63], v[116:119], v[104:111], v5
    v_cvt_pk_bf16_f32 v100, v83, v88
    v_cvt_pk_bf16_f32 v101, v80, v89
    v_smfmac_f32_16x16x64_bf16 v[60:63], v[96:99], v[44:51], v5
    v_cvt_pk_bf16_f32 v102, v81, v90
    v_cvt_pk_bf16_f32 v103, v82, v91
    s_nop 1
    v_smfmac_f32_16x16x64_bf16 v[60:63], v[100:103], v[52:59], v5
    s_branch ch3bs_kj
ch3bs_x:
    s_cmp_ge_u32 s83, 2000000
    s_cbranch_scc1 chain_abort
    buffer_load_dwordx4 v[76:79], v1, s[44:47], s67 offen offset:0 sc1
    buffer_load_dwordx4 v[84:87], v1, s[44:47], s67 offen offset:2048 sc1
    buffer_load_dwordx4 v[80:83], v1, s[44:47], s67 offen offset:1024 sc1
    buffer_load_dwordx4 v[88:91], v1, s[44:47], s67 offen offset:3072 sc1
    buffer_load_dwordx4 v[92:95], v10, s[44:47], s67 offen offset:0 sc1
    s_waitcnt vmcnt(0)
    v_pk_max_u16 v2, v76, v77
    v_pk_max_u16 v2, v2, v78
    v_pk_max_u16 v2, v2, v79
    v_pk_max_u16 v2, v2, v80
    v_pk_max_u16 v2, v2, v81
    v_pk_max_u16 v2, v2, v82
    v_pk_max_u16 v2, v2, v83
    v_pk_max_u16 v2, v2, v84
    v_pk_max_u16 v2, v2, v85
    v_pk_max_u16 v2, v2, v86
    v_pk_max_u16 v2, v2, v87
    v_pk_max_u16 v2, v2, v88
    v_pk_max_u16 v2, v2, v89
    v_pk_max_u16 v2, v2, v90
    v_pk_max_u16 v2, v2, v91
    v_pk_max_u16 v2, v2, v92
    v_pk_max_u16 v2, v2, v93
    v_pk_max_u16 v2, v2, v94
    v_pk_max_u16 v2, v2, v95
    v_lshrrev_b32 v112, 16, v2
    v_and_b32 v2, 0xffff, v2
    v_max_u32 v2, v2, v112
    v_cmp_eq_u32 vcc, 0xffff, v2
    s_cbranch_vccnz ch3bs_q012
    v_fma_mix_f32 v102, v76, 1.0, v84 op_sel:[0,0,0] op_sel_hi:[1,0,1]
    v_fma_mix_f32 v84, v76, 1.0, v84 op_sel:[1,0,1] op_sel_hi:[1,0,1]
    v_fma_mix_f32 v76, v77, 1.0, v85 op_sel:[0,0,0] op_sel_hi:[1,0,1]
    v_fma_mix_f32 v85, v77, 1.0, v85 op_sel:[1,0,1] op_sel_hi:[1,0,1]
    v_fma_mix_f32 v77, v78, 1.0, v86 op_sel:[0,0,0] op_sel_hi:[1,0,1]
    v_fma_mix_f32 v86, v78, 1.0, v86 op_sel:[1,0,1] op_sel_hi:[1,0,1]
    v_fma_mix_f32 v78, v79, 1.0, v87 op_sel:[0,0,0] op_sel_hi:[1,0,1]
    v_fma_mix_f32 v87, v79, 1.0, v87 op_sel:[1,0,1] op_sel_hi:[1,0,1]
    v_exp_f32 v76, v76
    v_exp_f32 v77, v77
    v_exp_f32 v78, v78
    v_exp_f32 v79, v102
    v_exp_f32 v84, v84
    v_exp_f32 v85, v85
    v_pk_add_f32 v[96:97], v[76:77], v[78:79]
    v_exp_f32 v86, v86
    v_exp_f32 v87, v87
    v_pk_add_f32 v[96:97], v[96:97], v[84:85]
    v_pk_add_f32 v[96:97], v[96:97], v[86:87]
    v_fma_mix_f32 v103, v80, 1.0, v88 op_sel:[0,0,0] op_sel_hi:[1,0,1]
    v_fma_mix_f32 v88, v80, 1.0, v88 op_sel:[1,0,1] op_sel_hi:[1,0,1]
    v_fma_mix_f32 v80, v81, 1.0, v89 op_sel:[0,0,0] op_sel_hi:[1,0,1]
    v_fma_mix_f32 v89, v81, 1.0, v89 op_sel:[1,0,1] op_sel_hi:[1,0,1]
    v_fma_mix_f32 v81, v82, 1.0, v90 op_sel:[0,0,0] op_sel_hi:[1,0,1]
    v_fma_mix_f32 v90, v82, 1.0, v90 op_sel:[1,0,1] op_sel_hi:[1,0,1]
    v_fma_mix_f32 v82, v83, 1.0, v91 op_sel:[0,0,0] op_sel_hi:[1,0,1]
    v_fma_mix_f32 v91, v83, 1.0, v91 op_sel:[1,0,1] op_sel_hi:[1,0,1]
    v_exp_f32 v80, v80
    v_exp_f32 v81, v81
    v_exp_f32 v82, v82
    v_exp_f32 v83, v103
    v_exp_f32 v88, v88
    v_exp_f32 v89, v89
    v_pk_add_f32 v[98:99], v[80:81], v[82:83]
    v_exp_f32 v90, v90
    v_exp_f32 v91, v91
    v_pk_add_f32 v[98:99], v[98:99], v[88:89]
    v_pk_add_f32 v[98:99], v[98:99], v[90:91]
    v_fma_mix_f32 v113, v92, 1.0, v94 op_sel:[0,0,0] op_sel_hi:[1,0,1]
    v_fma_mix_f32 v94, v92, 1.0, v94 op_sel:[1,0,1] op_sel_hi:[1,0,1]
    v_fma_mix_f32 v92, v93, 1.0, v95 op_sel:[0,0,0] op_sel_hi:[1,0,1]
    v_fma_mix_f32 v95, v93, 1.0, v95 op_sel:[1,0,1] op_sel_hi:[1,0,1]
    v_exp_f32 v92, v92
    v_exp_f32 v93, v113
    v_exp_f32 v94, v94
    v_exp_f32 v95, v95
    s_nop 0
    v_pk_add_f32 v[100:101], v[92:93], v[94:95]
    s_branch ch3bs_k0
ch3bs_vw:
    v_lshlrev_b32 v113, 7, v0
    s_mov_b32 s99, 0
hz_196:
    buffer_load_dword v115, v113, s[44:47], s75 offen sc1
    s_waitcnt vmcnt(0)
    v_cmp_gt_u32 vcc, 28, v115
    s_ff1_i32_b64 s100, vcc
    s_cmp_eq_u32 s100, -1
    s_cselect_b32 s100, 65, s100
    s_sub_u32 s100, s100, 1
    s_cmp_gt_i32 s100, s64
    s_cbranch_scc1 hd_197
    s_sleep 1
    s_add_u32 s99, s99, 1
    s_cmp_lt_u32 s99, 400000
    s_cbranch_scc1 hz_196
    s_branch chain_abort
hd_197:
    s_branch ch3bs_vok
ch3as:
    v_mov_b32 v44, 0
    v_mov_b32 v60, 0
    v_mov_b32 v45, 0
    v_mov_b32 v61, 0
    v_mov_b32 v46, 0
    v_mov_b32 v62, 0
    v_mov_b32 v47, 0
    v_mov_b32 v63, 0
    v_mov_b32 v48, 0
    v_mov_b32 v64, 0
    v_mov_b32 v49, 0
    v_mov_b32 v65, 0
    v_mov_b32 v50, 0
    v_mov_b32 v66, 0
    v_mov_b32 v51, 0
    v_mov_b32 v67, 0
    v_mov_b32 v52, 0
    v_mov_b32 v68, 0
    v_mov_b32 v53, 0
    v_mov_b32 v69, 0
    v_mov_b32 v54, 0
    v_mov_b32 v70, 0
    v_mov_b32 v55, 0
    v_mov_b32 v71, 0
    v_mov_b32 v56, 0
    v_mov_b32 v72, 0
    v_mov_b32 v57, 0
    v_mov_b32 v73, 0
    v_mov_b32 v58, 0
    v_mov_b32 v74, 0
    v_mov_b32 v59, 0
    v_mov_b32 v75, 0
    v_mov_b32 v112, 0
    v_mov_b32 v113, 0
    v_mov_b32 v114, 0
    v_mov_b32 v115, 0
    s_branch ch3as_loop
.p2align 6
ch3as_loop:
    s_and_b32 s8, s64, 3
    s_lshl_b32 s65, s8, 13
    s_add_u32 s65, s65, 94902272
    buffer_load_dwordx4 v[40:43], v1, s[44:47], s65 offen offset:0 sc1
    s_mov_b32 s83, 0
    s_and_b32 s8, s64, 3
    s_mul_i32 s9, s8, 20736
    s_add_u32 s67, s9, 94944256
    s_add_u32 s66, s9, s12
    s_xor_b32 s8, s8, 2
    s_mul_i32 s9, s8, 20736
    s_add_u32 s70, s9, s13
ch3as_mp:
    buffer_load_dwordx4 v[40:43], v1, s[44:47], s65 offen offset:0 sc1
    s_add_u32 s83, s83, 1
    s_cmp_ge_u32 s83, 2000000
    s_cbranch_scc1 chain_abort
    s_waitcnt vmcnt(1)
    v_max3_u32 v2, v40, v41, v42
    v_max_u32 v2, v2, v43
    v_cmp_eq_u32 vcc, -1, v2
    s_cbranch_vccnz ch3as_mp
    ds_write_b128 v1, v[40:43] offset:6144
    v_smfmac_f32_16x16x64_bf16 v[44:47], v[40:43], a[48:55], v5
    v_smfmac_f32_16x16x64_bf16 v[48:51], v[40:43], a[104:111], v5
    s_waitcnt lgkmcnt(0)
    s_barrier
    ds_read_b128 v[16:19], v1 offset:0
    ds_read_b128 v[20:23], v1 offset:1024
    ds_read_b128 v[24:27], v1 offset:2048
    ds_read_b128 v[28:31], v1 offset:3072
    ds_read_b128 v[32:35], v1 offset:4096
    ds_read_b128 v[36:39], v1 offset:5120
    v_smfmac_f32_16x16x64_bf16 v[52:55], v[40:43], a[160:167], v5
    s_waitcnt lgkmcnt(5)
    v_smfmac_f32_16x16x64_bf16 v[44:47], v[16:19], a[0:7], v5
    s_waitcnt lgkmcnt(4)
    v_smfmac_f32_16x16x64_bf16 v[44:47], v[20:23], a[8:15], v5
    s_waitcnt lgkmcnt(3)
    v_smfmac_f32_16x16x64_bf16 v[44:47], v[24:27], a[16:23], v5
    ds_read_b128 v[76:79], v12 offset:0
    s_waitcnt lgkmcnt(3)
    v_smfmac_f32_16x16x64_bf16 v[44:47], v[28:31], a[24:31], v5
    ds_read_b128 v[80:83], v12 offset:1024
    s_waitcnt lgkmcnt(3)
    v_smfmac_f32_16x16x64_bf16 v[44:47], v[32:35], a[32:39], v5
    ds_read_b128 v[84:87], v12 offset:2048
    s_waitcnt lgkmcnt(3)
    v_smfmac_f32_16x16x64_bf16 v[44:47], v[36:39], a[40:47], v5
    ds_read_b128 v[88:91], v12 offset:3072
    v_smfmac_f32_16x16x64_bf16 v[48:51], v[16:19], a[56:63], v5
    ds_read_b128 v[92:95], v12 offset:4096
    v_smfmac_f32_16x16x64_bf16 v[48:51], v[20:23], a[64:71], v5
    ds_read_b128 v[96:99], v12 offset:5120
    v_smfmac_f32_16x16x64_bf16 v[48:51], v[24:27], a[72:79], v5
    ds_read_b128 v[100:103], v12 offset:6144
    v_smfmac_f32_16x16x64_bf16 v[48:51], v[28:31], a[80:87], v5
    v_add_f32 v44, v44, v46
    v_smfmac_f32_16x16x64_bf16 v[48:51], v[32:35], a[88:95], v5
    v_add_f32 v45, v45, v47
    v_smfmac_f32_16x16x64_bf16 v[48:51], v[36:39], a[96:103], v5
    v_cvt_pk_bf16_f32 v44, v44, v45
    v_smfmac_f32_16x16x64_bf16 v[52:55], v[16:19], a[112:119], v5
    ds_write_b32 v6, v44 offset:2304
    v_smfmac_f32_16x16x64_bf16 v[52:55], v[20:23], a[120:127], v5
    v_xor_b32 v12, 0x4000, v12
    v_smfmac_f32_16x16x64_bf16 v[52:55], v[24:27], a[128:135], v5
    v_smfmac_f32_16x16x64_bf16 v[52:55], v[28:31], a[136:143], v5
    s_nop 0
    v_add_f32 v48, v48, v50
    v_smfmac_f32_16x16x64_bf16 v[52:55], v[32:35], a[144:151], v5
    v_add_f32 v49, v49, v51
    v_smfmac_f32_16x16x64_bf16 v[52:55], v[36:39], a[152:159], v5
    v_cvt_pk_bf16_f32 v48, v48, v49
    ds_write_b32 v6, v48 offset:2560
    s_nop 5
    v_add_f32 v52, v52, v54
    v_add_f32 v53, v53, v55
    v_cvt_pk_bf16_f32 v52, v52, v53
    ds_write_b32 v6, v52 offset:2816
    s_waitcnt lgkmcnt(0)
    s_barrier
    ds_read_b64_tr_b16 v[44:45], v7 offset:0
    ds_read_b64_tr_b16 v[46:47], v7 offset:128
    ds_read_b64_tr_b16 v[48:49], v7 offset:1024
    ds_read_b64_tr_b16 v[50:51], v7 offset:1152
    ds_read_b64_tr_b16 v[52:53], v7 offset:2048
    ds_read_b64_tr_b16 v[54:55], v7 offset:2176
    s_barrier
    ds_read_b64_tr_b16 v[56:57], v7 offset:3072
    ds_read_b64_tr_b16 v[58:59], v7 offset:3200
    s_waitcnt lgkmcnt(6)
    v_smfmac_f32_16x16x64_bf16 v[112:115], v[44:47], v[76:83], v5
    s_waitcnt lgkmcnt(4)
    v_smfmac_f32_16x16x64_bf16 v[112:115], v[48:51], v[84:91], v5
    s_waitcnt lgkmcnt(2)
    v_smfmac_f32_16x16x64_bf16 v[112:115], v[52:55], v[92:99], v5
    s_waitcnt lgkmcnt(0)
    v_smfmac_f32_16x16x64_bf16 v[112:115], v[56:59], v[100:107], v5
    s_nop 7
    v_pk_add_f32 v[112:113], v[112:113], v[114:115]
    v_pk_mul_f32 v[112:113], v[112:113], s[78:79]
    v_cvt_pk_f16_f32 v112, v112, v113
    s_nop 1
    v_mov_b32_dpp v113, v112 quad_perm:[1,0,3,2] row_mask:0xf bank_mask:0xf
    v_perm_b32 v112, v113, v112, v14
    v_pk_min_u16 v112, v112, s77
    buffer_store_dword v112, v9, s[44:47], s66 offen sc1
    s_barrier
    s_cmp_ge_u32 s100, 64
    s_cbranch_scc1 ch3as_hk
    s_cmp_lg_u32 s7, 31
    s_cbranch_scc1 ch3as_hk
    v_lshlrev_b32 v113, 7, v0
    s_mov_b32 s99, 0
hz_198:
    buffer_load_dword v115, v113, s[44:47], s75 offen sc1
    s_waitcnt vmcnt(0)
    v_cmp_gt_u32 vcc, 28, v115
    s_ff1_i32_b64 s100, vcc
    s_cmp_eq_u32 s100, -1
    s_cselect_b32 s100, 65, s100
    s_sub_u32 s100, s100, 1
    s_max_i32 s100, s100, 0
hd_199:
    v_mov_b32 v2, s100
    buffer_store_dword v2, off, s[44:47], s73 sc1
ch3as_hk:
    s_add_u32 s71, s71, 458752
    s_add_u32 s8, s64, s7
    s_and_b32 s8, s8, 3
    s_cmp_lg_u32 s8, 0
    s_cselect_b32 s101, -1, s64
    s_cbranch_scc1 ch3as_np
    s_lshl_b32 s8, s64, 13
    s_add_u32 s8, s8, 91756544
    buffer_store_dwordx4 v[40:43], v1, s[44:47], s8 offen offset:0 sc1
ch3as_np:
    v_mov_b32 v44, 0
    v_mov_b32 v45, 0
    v_mov_b32 v46, 0
    v_mov_b32 v47, 0
    v_mov_b32 v48, 0
    v_mov_b32 v49, 0
    v_mov_b32 v50, 0
    v_mov_b32 v51, 0
    v_mov_b32 v52, 0
    v_mov_b32 v53, 0
    v_mov_b32 v54, 0
    v_mov_b32 v55, 0
    v_mov_b32 v112, 0
    v_mov_b32 v113, 0
    v_mov_b32 v114, 0
    v_mov_b32 v115, 0
    s_add_u32 s64, s64, 1
    s_cmp_lt_u32 s64, 63
    s_cbranch_scc1 ch3as_loop
    s_waitcnt vmcnt(0)
    s_barrier
    s_endpgm
.section .rodata,"a"
.p2align 6
.amdhsa_kernel main_kernel
  .amdhsa_next_free_vgpr 512
  .amdhsa_next_free_sgpr 102
  .amdhsa_accum_offset 256
  .amdhsa_group_segment_fixed_size 0
  .amdhsa_kernarg_size 112
  .amdhsa_user_sgpr_count 2
  .amdhsa_user_sgpr_kernarg_segment_ptr 1
  .amdhsa_system_sgpr_workgroup_id_x 1
  .amdhsa_float_denorm_mode_32 3
.end_amdhsa_kernel
.text
```
